```python
import torch

def _softmax(x, axis=-1):
    return torch.softmax(x, dim=axis)
def _gelu(x):
    return torch.nn.functional.gelu(x, approximate="tanh")
def _silu(x):
    return torch.nn.functional.silu(x)
def _sigmoid(x):
    return torch.sigmoid(x)
def _layernorm(x, axis=-1, eps=1e-5):
    m = x.mean(dim=axis, keepdim=True)
    v = x.var(dim=axis, keepdim=True, unbiased=False)
    return (x - m) / torch.sqrt(v + eps)
def _scatter_add(tgt, idx, src, axis=0):
    return tgt.clone().index_add_(axis, idx, src)
def _segment_sum(src, seg, n):
    out = torch.zeros((n,) + src.shape[1:], dtype=src.dtype)
    return out.index_add_(0, seg, src)
def _pad(x, pw):
    flat = tuple(v for pair in reversed(pw) for v in pair)
    return torch.nn.functional.pad(x, flat)

kernel_name = 'gated_mix__ssm_conv_s5__moe_arch_mod__prompt'

def setup_inputs():

    _w = (lambda a: (lambda t: t.to(torch.bfloat16) if t.is_floating_point() else t)(torch.as_tensor(a)))
    def _A_setup():
        B, S, D = 1, 2048, 1024
        P = D
        Lambda_re = -0.5 * (lambda _x: torch.exp(torch.as_tensor(_x)))((lambda *s: torch.randn(*s, dtype=torch.bfloat16) * 0.8)(P))
        Lambda_im = (lambda *s: torch.randn(*s, dtype=torch.bfloat16) * 0.8)(P) * 1.0
        B_re = (lambda *s: torch.randn(*s, dtype=torch.bfloat16) * 0.8)(P, D) * (D ** -0.5)
        B_im = (lambda *s: torch.randn(*s, dtype=torch.bfloat16) * 0.8)(P, D) * (D ** -0.5)
        C_re = (lambda *s: torch.randn(*s, dtype=torch.bfloat16) * 0.8)(D, P) * (P ** -0.5)
        C_im = (lambda *s: torch.randn(*s, dtype=torch.bfloat16) * 0.8)(D, P) * (P ** -0.5)
        log_dt = (lambda *s: torch.randn(*s, dtype=torch.bfloat16) * 0.8)(P) * 0.3 - 2.0
        Dskip = (lambda *s: torch.randn(*s, dtype=torch.bfloat16) * 0.8)(D)
        return {
            "x": _w((lambda *s: torch.randn(*s, dtype=torch.bfloat16) * 0.05)(B, S, D)),
            "Lambda_re": _w(Lambda_re),
            "Lambda_im": _w(Lambda_im),
            "B_re": _w(B_re),
            "B_im": _w(B_im),
            "C_re": _w(C_re),
            "C_im": _w(C_im),
            "log_dt": _w(log_dt),
            "Dskip": _w(Dskip),
        }
    _A_in = _A_setup()

    def _B_setup():
        B, S, D, F, C = 1, 2048, 1024, 3584, 8
        return {
            "x": _w((lambda *s: torch.randn(*s, dtype=torch.bfloat16) * 0.05)(B, S, D)),
            "w_r": _w((lambda *s: torch.randn(*s, dtype=torch.bfloat16) * 1.6)(D)),
            "w_gate": _w((lambda *s: torch.randn(*s, dtype=torch.bfloat16) * 0.1)(D, F)),
            "w_up": _w((lambda *s: torch.randn(*s, dtype=torch.bfloat16) * 0.1)(D, F)),
            "w_down": _w((lambda *s: torch.randn(*s, dtype=torch.bfloat16) * 0.1)(F, D)),
        }
    _B_in = _B_setup()

    return {
        "A_x": _A_in["x"],
        "A_Lambda_re": _A_in["Lambda_re"],
        "A_Lambda_im": _A_in["Lambda_im"],
        "A_B_re": _A_in["B_re"],
        "A_B_im": _A_in["B_im"],
        "A_C_re": _A_in["C_re"],
        "A_C_im": _A_in["C_im"],
        "A_log_dt": _A_in["log_dt"],
        "A_Dskip": _A_in["Dskip"],
        "B_x": _B_in["x"],
        "B_w_r": _B_in["w_r"],
        "B_w_gate": _B_in["w_gate"],
        "B_w_up": _B_in["w_up"],
        "B_w_down": _B_in["w_down"],
        "gate_w": _w((lambda *s: torch.randn(*s, dtype=torch.bfloat16) * 0.05)(1024) * 16.0),
    }

def reference(A_x, A_Lambda_re, A_Lambda_im, A_B_re, A_B_im, A_C_re, A_C_im, A_log_dt, A_Dskip, B_x, B_w_r, B_w_gate, B_w_up, B_w_down, gate_w):
    def _A_ref(x, Lambda_re, Lambda_im, B_re, B_im, C_re, C_im, log_dt, Dskip):
        Bsz, L, H = x.shape
        Lam = Lambda_re + 1j * Lambda_im
        Bmat = B_re + 1j * B_im
        Cmat = C_re + 1j * C_im
        dt = torch.exp(log_dt)
        Lam_bar = torch.exp(dt * Lam)
        B_bar = ((Lam_bar - 1.0) / Lam)[:, None] * Bmat
        Bu = torch.einsum("bld,pd->blp", x + 0j, B_bar)
        h = torch.zeros_like(Bu[:, 0, :])
        hs = []
        for t in range(L):
            h = Lam_bar[None, :] * h + Bu[:, t, :]
            hs.append(h)
        hseq = torch.stack(hs, 1)
        y = 2.0 * torch.einsum("blp,dp->bld", hseq, Cmat).real + x * Dskip[None, None, :]
        return y

    def _B_ref(x, w_r, w_gate, w_up, w_down):
        B, S, D = x.shape
        C = 8
        r = x @ w_r
        idx = torch.argsort(-r, axis=-1)[:, :C]
        idx_e = (lambda x, n, axis: torch.repeat_interleave(x, n, dim=axis))(idx.reshape(B, C, 1), D, axis=2)
        x_sel = (lambda x, i, axis: torch.take_along_dim(x, i, dim=axis))(x, idx_e, axis=1)
        g = _silu(x_sel @ w_gate)
        u = x_sel @ w_up
        y = (g * u) @ w_down
        r_sel = _sigmoid((lambda x, i, axis: torch.take_along_dim(x, i, dim=axis))(r, idx, axis=1))
        y = y * r_sel.reshape(B, C, 1)
        b_off = (torch.arange(B) * S).reshape(B, 1)
        flat_idx = (idx + b_off).reshape(B * C)
        zero = (x * 0.0).reshape(B * S, D)
        upd = _scatter_add(zero, flat_idx, y.reshape(B * C, D), axis=0)
        return x + upd.reshape(B, S, D)

    x = A_x
    g = _sigmoid((x * gate_w).sum(-1, keepdims=True))
    a = _A_ref(x, A_Lambda_re, A_Lambda_im, A_B_re, A_B_im, A_C_re, A_C_im, A_log_dt, A_Dskip)
    b = _B_ref(x, B_w_r, B_w_gate, B_w_up, B_w_down)
    return g * a + (1 - g) * b
```

```asm
; @launch kernel=k1_kernel grid=(512,1,1) block=(256,1,1) lds=81920
; @launch kernel=k2_kernel grid=(480,1,1) block=(256,1,1) lds=81920
.amdgcn_target "amdgcn-amd-amdhsa--gfx950"
.text
.globl k1_kernel
.p2align 8
.type k1_kernel,@function
k1_kernel:
    s_cmp_ge_u32 s2, 256
    s_cbranch_scc0 L_k1_gemm
    s_cmp_ge_u32 s2, 512
    s_cbranch_scc0 L_k1_side
    s_endpgm
L_k1_gemm:
    s_load_dwordx2 s[4:5], s[0:1], 0
    s_load_dwordx4 s[28:31], s[0:1], 8
    s_load_dwordx4 s[32:35], s[0:1], 24
    s_load_dwordx2 s[36:37], s[0:1], 56
    s_load_dwordx4 s[40:43], s[0:1], 128
    v_lshrrev_b32 v48, 6, v0
    v_and_b32 v46, 63, v0
    v_readfirstlane_b32 s18, v48
    s_and_b32 s3, s2, 7
    s_lshr_b32 s38, s2, 3
    s_lshr_b32 s16, s3, 1
    s_lshl_b32 s16, s16, 2
    s_and_b32 s39, s38, 3
    s_add_u32 s16, s16, s39
    s_and_b32 s17, s3, 1
    s_lshl_b32 s17, s17, 3
    s_lshr_b32 s39, s38, 2
    s_add_u32 s17, s17, s39
    s_and_b32 s19, s18, 1
    s_lshr_b32 s20, s18, 1
    v_lshrrev_b32 v47, 5, v46
    v_lshrrev_b32 v48, 3, v46
    v_and_b32 v49, 7, v46
    v_lshrrev_b32 v50, 1, v48
    v_xor_b32 v49, v49, v50
    v_lshlrev_b32 v49, 4, v49
    v_lshrrev_b32 v50, 2, v48
    v_lshlrev_b32 v50, 5, v50
    v_and_b32 v51, 1, v48
    v_lshl_add_u32 v50, v51, 4, v50
    v_bfe_u32 v51, v48, 1, 1
    v_add_u32 v50, v50, v51
    s_lshl_b32 s38, s20, 6
    s_lshl_b32 s39, s19, 3
    s_add_u32 s38, s38, s39
    s_lshl_b32 s39, s16, 7
    s_add_u32 s38, s38, s39
    v_add_u32 v50, s38, v50
    v_lshl_add_u32 v50, v50, 11, v49
    v_add_u32 v8, 3072, v50
    v_xor_b32 v51, 64, v50
    v_add_u32 v9, 6144, v51
    v_add_u32 v10, 9216, v50
    v_xor_b32 v51, 64, v50
    v_add_u32 v11, 12288, v51
    s_lshl_b32 s38, s17, 6
    s_lshl_b32 s39, s20, 5
    s_add_u32 s38, s38, s39
    v_add_u32 v50, s38, v48
    v_lshl_add_u32 v50, v50, 11, v49
    v_add_u32 v12, 3072, v50
    v_xor_b32 v51, 64, v50
    v_add_u32 v13, 18432, v51
    v_add_u32 v14, 33792, v50
    v_xor_b32 v51, 64, v50
    v_add_u32 v15, 49152, v51
    s_waitcnt lgkmcnt(0)
    s_sub_u32 s4, s4, 3072
    s_subb_u32 s5, s5, 0
    s_mov_b32 s6, 4197376
    s_mov_b32 s7, 0x20000
    s_cmp_eq_u32 s19, 0
    s_cselect_b32 s8, s32, s34
    s_cselect_b32 s9, s33, s35
    s_sub_u32 s8, s8, 3072
    s_subb_u32 s9, s9, 0
    s_mov_b32 s10, 2100224
    s_mov_b32 s11, 0x20000
    s_mov_b32 s12, s42
    s_mov_b32 s13, s43
    s_mov_b32 s14, 16777216
    s_mov_b32 s15, 0x20000
    s_lshl_b32 s38, s17, 13
    s_add_u32 s38, s38, 8388608
    s_add_u32 s24, s42, s38
    s_addc_u32 s25, s43, 0
    s_mov_b32 s26, 8192
    s_mov_b32 s27, 0x20000
    s_mov_b32 s22, s40
    s_mov_b32 s23, s41
    s_lshl_b32 s44, s18, 12
    s_and_b32 s45, s2, 7
    s_mul_i32 s45, s45, 128
    s_mul_i32 s38, s16, 1024
    s_add_u32 s45, s45, s38
    s_mul_i32 s38, s17, 1024
    s_add_u32 s45, s45, s38
    v_and_b32 v50, 31, v46
    v_lshlrev_b32 v56, 3, v50
    s_sub_u32 s38, 15, s16
    s_lshl_b32 s38, s38, 9
    s_lshl_b32 s39, s20, 8
    s_add_u32 s38, s38, s39
    v_add_u32 v56, s38, v56
    v_mov_b32 v58, -1
    v_mov_b32 v59, -1
    buffer_store_dwordx2 v[58:59], v56, s[24:27], 0 offen sc1
    s_add_u32 m0, s44, 0
    s_add_u32 s21, s45, 0
    s_and_b32 s21, s21, 2047
    buffer_load_dwordx4 v8, s[4:7], s21 offen offset:0 lds
    buffer_load_dwordx4 v9, s[4:7], s21 offen offset:1024 lds
    buffer_load_dwordx4 v10, s[4:7], s21 offen offset:2048 lds
    buffer_load_dwordx4 v11, s[4:7], s21 offen offset:3072 lds
    s_add_u32 m0, s44, 16384
    s_add_u32 s21, s45, 0
    s_and_b32 s21, s21, 2047
    buffer_load_dwordx4 v12, s[8:11], s21 offen offset:0 lds
    buffer_load_dwordx4 v13, s[8:11], s21 offen offset:1024 lds
    buffer_load_dwordx4 v14, s[8:11], s21 offen offset:2048 lds
    buffer_load_dwordx4 v15, s[8:11], s21 offen offset:3072 lds
    s_add_u32 m0, s44, 32768
    s_add_u32 s21, s45, 128
    s_and_b32 s21, s21, 2047
    buffer_load_dwordx4 v8, s[4:7], s21 offen offset:0 lds
    buffer_load_dwordx4 v9, s[4:7], s21 offen offset:1024 lds
    buffer_load_dwordx4 v10, s[4:7], s21 offen offset:2048 lds
    buffer_load_dwordx4 v11, s[4:7], s21 offen offset:3072 lds
    s_add_u32 m0, s44, 49152
    s_add_u32 s21, s45, 128
    s_and_b32 s21, s21, 2047
    buffer_load_dwordx4 v12, s[8:11], s21 offen offset:0 lds
    buffer_load_dwordx4 v13, s[8:11], s21 offen offset:1024 lds
    buffer_load_dwordx4 v14, s[8:11], s21 offen offset:2048 lds
    buffer_load_dwordx4 v15, s[8:11], s21 offen offset:3072 lds
    s_add_u32 m0, s44, 65536
    s_add_u32 s21, s45, 256
    s_and_b32 s21, s21, 2047
    buffer_load_dwordx4 v8, s[4:7], s21 offen offset:0 lds
    buffer_load_dwordx4 v9, s[4:7], s21 offen offset:1024 lds
    buffer_load_dwordx4 v10, s[4:7], s21 offen offset:2048 lds
    buffer_load_dwordx4 v11, s[4:7], s21 offen offset:3072 lds
    s_lshl_b32 s38, s17, 6
    s_lshl_b32 s39, s20, 5
    s_add_u32 s38, s38, s39
    v_add_lshl_u32 v51, s38, v50, 1
    global_load_ushort v60, v51, s[28:29]
    global_load_ushort v61, v51, s[30:31]
    global_load_ushort v62, v51, s[36:37]
    v_bfe_u32 v51, v46, 1, 3
    v_xor_b32 v51, v51, v47
    v_lshlrev_b32 v51, 4, v51
    v_lshl_add_u32 v51, v50, 7, v51
    s_lshl_b32 s38, s19, 13
    s_lshl_b32 s39, s20, 13
    v_xor_b32 v48, 0, v51
    v_add_u32 v16, s38, v48
    v_add_u32 v20, s39, v48
    v_add_u32 v24, 0x10000, v16
    v_add_u32 v28, 0x10000, v20
    v_xor_b32 v48, 32, v51
    v_add_u32 v17, s38, v48
    v_add_u32 v21, s39, v48
    v_add_u32 v25, 0x10000, v17
    v_add_u32 v29, 0x10000, v21
    v_xor_b32 v48, 64, v51
    v_add_u32 v18, s38, v48
    v_add_u32 v22, s39, v48
    v_add_u32 v26, 0x10000, v18
    v_add_u32 v30, 0x10000, v22
    v_xor_b32 v48, 96, v51
    v_add_u32 v19, s38, v48
    v_add_u32 v23, s39, v48
    v_add_u32 v27, 0x10000, v19
    v_add_u32 v31, 0x10000, v23
    s_waitcnt vmcnt(15) lgkmcnt(0)
    s_barrier
    ds_read_b128 v[128:131], v16 offset:0
    ds_read_b128 v[132:135], v16 offset:4096
    ds_read_b128 v[136:139], v20 offset:16384
    ds_read_b128 v[140:143], v20 offset:20480
    ds_read_b128 v[144:147], v17 offset:0
    ds_read_b128 v[148:151], v17 offset:4096
    ds_read_b128 v[152:155], v21 offset:16384
    ds_read_b128 v[156:159], v21 offset:20480
    s_waitcnt lgkmcnt(4)
    v_mfma_f32_32x32x16_bf16 v[64:79], v[128:131], v[136:139], 0
    v_mfma_f32_32x32x16_bf16 v[80:95], v[128:131], v[140:143], 0
    v_mfma_f32_32x32x16_bf16 v[96:111], v[132:135], v[136:139], 0
    v_mfma_f32_32x32x16_bf16 v[112:127], v[132:135], v[140:143], 0
    ds_read_b128 v[128:131], v18 offset:0
    ds_read_b128 v[132:135], v18 offset:4096
    ds_read_b128 v[136:139], v22 offset:16384
    ds_read_b128 v[140:143], v22 offset:20480
    s_waitcnt lgkmcnt(4)
    v_mfma_f32_32x32x16_bf16 v[64:79], v[144:147], v[152:155], v[64:79]
    v_mfma_f32_32x32x16_bf16 v[80:95], v[144:147], v[156:159], v[80:95]
    v_mfma_f32_32x32x16_bf16 v[96:111], v[148:151], v[152:155], v[96:111]
    v_mfma_f32_32x32x16_bf16 v[112:127], v[148:151], v[156:159], v[112:127]
    ds_read_b128 v[144:147], v19 offset:0
    ds_read_b128 v[148:151], v19 offset:4096
    ds_read_b128 v[152:155], v23 offset:16384
    ds_read_b128 v[156:159], v23 offset:20480
    s_waitcnt lgkmcnt(4)
    v_mfma_f32_32x32x16_bf16 v[64:79], v[128:131], v[136:139], v[64:79]
    v_mfma_f32_32x32x16_bf16 v[80:95], v[128:131], v[140:143], v[80:95]
    v_mfma_f32_32x32x16_bf16 v[96:111], v[132:135], v[136:139], v[96:111]
    v_mfma_f32_32x32x16_bf16 v[112:127], v[132:135], v[140:143], v[112:127]
    s_waitcnt vmcnt(7) lgkmcnt(0)
    s_barrier
    ds_read_b128 v[128:131], v16 offset:32768
    ds_read_b128 v[132:135], v16 offset:36864
    ds_read_b128 v[136:139], v20 offset:49152
    ds_read_b128 v[140:143], v20 offset:53248
    v_mfma_f32_32x32x16_bf16 v[64:79], v[144:147], v[152:155], v[64:79]
    s_add_u32 m0, s44, 0
    s_add_u32 s21, s45, 256
    s_and_b32 s21, s21, 2047
    buffer_load_dwordx4 v12, s[8:11], s21 offen offset:0 lds
    v_mfma_f32_32x32x16_bf16 v[80:95], v[144:147], v[156:159], v[80:95]
    v_mfma_f32_32x32x16_bf16 v[96:111], v[148:151], v[152:155], v[96:111]
    buffer_load_dwordx4 v13, s[8:11], s21 offen offset:1024 lds
    v_mfma_f32_32x32x16_bf16 v[112:127], v[148:151], v[156:159], v[112:127]
    ds_read_b128 v[144:147], v17 offset:32768
    ds_read_b128 v[148:151], v17 offset:36864
    ds_read_b128 v[152:155], v21 offset:49152
    ds_read_b128 v[156:159], v21 offset:53248
    s_waitcnt lgkmcnt(4)
    v_mfma_f32_32x32x16_bf16 v[64:79], v[128:131], v[136:139], v[64:79]
    buffer_load_dwordx4 v14, s[8:11], s21 offen offset:2048 lds
    v_mfma_f32_32x32x16_bf16 v[80:95], v[128:131], v[140:143], v[80:95]
    v_mfma_f32_32x32x16_bf16 v[96:111], v[132:135], v[136:139], v[96:111]
    buffer_load_dwordx4 v15, s[8:11], s21 offen offset:3072 lds
    v_mfma_f32_32x32x16_bf16 v[112:127], v[132:135], v[140:143], v[112:127]
    ds_read_b128 v[128:131], v18 offset:32768
    ds_read_b128 v[132:135], v18 offset:36864
    ds_read_b128 v[136:139], v22 offset:49152
    ds_read_b128 v[140:143], v22 offset:53248
    s_waitcnt lgkmcnt(4)
    v_mfma_f32_32x32x16_bf16 v[64:79], v[144:147], v[152:155], v[64:79]
    s_add_u32 m0, s44, 16384
    s_add_u32 s21, s45, 384
    s_and_b32 s21, s21, 2047
    buffer_load_dwordx4 v8, s[4:7], s21 offen offset:0 lds
    v_mfma_f32_32x32x16_bf16 v[80:95], v[144:147], v[156:159], v[80:95]
    v_mfma_f32_32x32x16_bf16 v[96:111], v[148:151], v[152:155], v[96:111]
    buffer_load_dwordx4 v9, s[4:7], s21 offen offset:1024 lds
    v_mfma_f32_32x32x16_bf16 v[112:127], v[148:151], v[156:159], v[112:127]
    ds_read_b128 v[144:147], v19 offset:32768
    ds_read_b128 v[148:151], v19 offset:36864
    ds_read_b128 v[152:155], v23 offset:49152
    ds_read_b128 v[156:159], v23 offset:53248
    s_waitcnt lgkmcnt(4)
    v_mfma_f32_32x32x16_bf16 v[64:79], v[128:131], v[136:139], v[64:79]
    buffer_load_dwordx4 v10, s[4:7], s21 offen offset:2048 lds
    v_mfma_f32_32x32x16_bf16 v[80:95], v[128:131], v[140:143], v[80:95]
    v_mfma_f32_32x32x16_bf16 v[96:111], v[132:135], v[136:139], v[96:111]
    buffer_load_dwordx4 v11, s[4:7], s21 offen offset:3072 lds
    v_mfma_f32_32x32x16_bf16 v[112:127], v[132:135], v[140:143], v[112:127]
    s_cmp_lg_u32 s18, 0
    s_cbranch_scc1 L_k1_nosig
    s_lshl_b32 s38, s17, 2
    v_mov_b32 v58, s38
    v_mov_b32 v59, 1
    s_mov_b64 exec, 1
    global_atomic_add v58, v59, s[22:23] sc1
    s_mov_b64 exec, -1
L_k1_nosig:
    s_waitcnt vmcnt(4) lgkmcnt(0)
    s_barrier
    ds_read_b128 v[128:131], v24 offset:0
    ds_read_b128 v[132:135], v24 offset:4096
    ds_read_b128 v[136:139], v20 offset:0
    ds_read_b128 v[140:143], v20 offset:4096
    v_mfma_f32_32x32x16_bf16 v[64:79], v[144:147], v[152:155], v[64:79]
    s_add_u32 m0, s44, 32768
    s_add_u32 s21, s45, 384
    s_and_b32 s21, s21, 2047
    buffer_load_dwordx4 v12, s[8:11], s21 offen offset:0 lds
    v_mfma_f32_32x32x16_bf16 v[80:95], v[144:147], v[156:159], v[80:95]
    v_mfma_f32_32x32x16_bf16 v[96:111], v[148:151], v[152:155], v[96:111]
    buffer_load_dwordx4 v13, s[8:11], s21 offen offset:1024 lds
    v_mfma_f32_32x32x16_bf16 v[112:127], v[148:151], v[156:159], v[112:127]
    ds_read_b128 v[144:147], v25 offset:0
    ds_read_b128 v[148:151], v25 offset:4096
    ds_read_b128 v[152:155], v21 offset:0
    ds_read_b128 v[156:159], v21 offset:4096
    s_waitcnt lgkmcnt(4)
    v_mfma_f32_32x32x16_bf16 v[64:79], v[128:131], v[136:139], v[64:79]
    buffer_load_dwordx4 v14, s[8:11], s21 offen offset:2048 lds
    v_mfma_f32_32x32x16_bf16 v[80:95], v[128:131], v[140:143], v[80:95]
    v_mfma_f32_32x32x16_bf16 v[96:111], v[132:135], v[136:139], v[96:111]
    buffer_load_dwordx4 v15, s[8:11], s21 offen offset:3072 lds
    v_mfma_f32_32x32x16_bf16 v[112:127], v[132:135], v[140:143], v[112:127]
    ds_read_b128 v[128:131], v26 offset:0
    ds_read_b128 v[132:135], v26 offset:4096
    ds_read_b128 v[136:139], v22 offset:0
    ds_read_b128 v[140:143], v22 offset:4096
    s_waitcnt lgkmcnt(4)
    v_mfma_f32_32x32x16_bf16 v[64:79], v[144:147], v[152:155], v[64:79]
    s_add_u32 m0, s44, 49152
    s_add_u32 s21, s45, 512
    s_and_b32 s21, s21, 2047
    buffer_load_dwordx4 v8, s[4:7], s21 offen offset:0 lds
    v_mfma_f32_32x32x16_bf16 v[80:95], v[144:147], v[156:159], v[80:95]
    v_mfma_f32_32x32x16_bf16 v[96:111], v[148:151], v[152:155], v[96:111]
    buffer_load_dwordx4 v9, s[4:7], s21 offen offset:1024 lds
    v_mfma_f32_32x32x16_bf16 v[112:127], v[148:151], v[156:159], v[112:127]
    ds_read_b128 v[144:147], v27 offset:0
    ds_read_b128 v[148:151], v27 offset:4096
    ds_read_b128 v[152:155], v23 offset:0
    ds_read_b128 v[156:159], v23 offset:4096
    s_waitcnt lgkmcnt(4)
    v_mfma_f32_32x32x16_bf16 v[64:79], v[128:131], v[136:139], v[64:79]
    buffer_load_dwordx4 v10, s[4:7], s21 offen offset:2048 lds
    v_mfma_f32_32x32x16_bf16 v[80:95], v[128:131], v[140:143], v[80:95]
    v_mfma_f32_32x32x16_bf16 v[96:111], v[132:135], v[136:139], v[96:111]
    buffer_load_dwordx4 v11, s[4:7], s21 offen offset:3072 lds
    v_mfma_f32_32x32x16_bf16 v[112:127], v[132:135], v[140:143], v[112:127]
    s_waitcnt vmcnt(4) lgkmcnt(0)
    s_barrier
    ds_read_b128 v[128:131], v16 offset:16384
    ds_read_b128 v[132:135], v16 offset:20480
    ds_read_b128 v[136:139], v20 offset:32768
    ds_read_b128 v[140:143], v20 offset:36864
    v_mfma_f32_32x32x16_bf16 v[64:79], v[144:147], v[152:155], v[64:79]
    s_add_u32 m0, s44, 65536
    s_add_u32 s21, s45, 512
    s_and_b32 s21, s21, 2047
    buffer_load_dwordx4 v12, s[8:11], s21 offen offset:0 lds
    v_lshlrev_b32 v60, 16, v60
    v_lshlrev_b32 v61, 16, v61
    v_lshlrev_b32 v62, 16, v62
    v_mul_f32 v48, 1069066811, v62
    v_exp_f32 v48, v48
    s_nop 0
    v_mfma_f32_32x32x16_bf16 v[80:95], v[144:147], v[156:159], v[80:95]
    v_cvt_pk_bf16_f32 v48, v48, v48
    v_lshlrev_b32 v48, 16, v48
    v_mul_f32 v49, v48, v60
    v_mul_f32 v50, v48, v61
    v_mul_f32 v49, 1069066811, v49
    v_exp_f32 v49, v49
    v_mfma_f32_32x32x16_bf16 v[96:111], v[148:151], v[152:155], v[96:111]
    buffer_load_dwordx4 v13, s[8:11], s21 offen offset:1024 lds
    v_mul_f32 v50, 1042479491, v50
    v_rndne_f32 v51, v50
    v_sub_f32 v50, v50, v51
    v_cos_f32 v51, v50
    v_sin_f32 v52, v50
    v_mul_f32 v53, v60, v60
    v_mfma_f32_32x32x16_bf16 v[112:127], v[148:151], v[156:159], v[112:127]
    v_mul_f32 v32, v49, v51
    v_mul_f32 v33, v49, v52
    v_fma_f32 v53, v61, v61, v53
    v_rcp_f32 v53, v53
    v_add_f32 v48, -1.0, v32
    v_add_f32 v53, v53, v53
    ds_read_b128 v[144:147], v17 offset:16384
    ds_read_b128 v[148:151], v17 offset:20480
    ds_read_b128 v[152:155], v21 offset:32768
    ds_read_b128 v[156:159], v21 offset:36864
    s_waitcnt lgkmcnt(4)
    v_mfma_f32_32x32x16_bf16 v[64:79], v[128:131], v[136:139], v[64:79]
    buffer_load_dwordx4 v14, s[8:11], s21 offen offset:2048 lds
    v_mul_f32 v49, v48, v60
    v_fma_f32 v49, v33, v61, v49
    v_mul_f32 v50, v33, v60
    v_fma_f32 v50, -v48, v61, v50
    v_mul_f32 v34, v49, v53
    v_mul_f32 v35, v50, v53
    v_mfma_f32_32x32x16_bf16 v[80:95], v[128:131], v[140:143], v[80:95]
    v_mul_f32 v48, v33, v33
    v_fma_f32 v48, v32, v32, -v48
    v_mul_f32 v49, v32, v33
    v_add_f32 v49, v49, v49
    v_mul_f32 v50, v49, v49
    v_fma_f32 v50, v48, v48, -v50
    v_mfma_f32_32x32x16_bf16 v[96:111], v[132:135], v[136:139], v[96:111]
    buffer_load_dwordx4 v15, s[8:11], s21 offen offset:3072 lds
    v_mul_f32 v51, v48, v49
    v_add_f32 v51, v51, v51
    v_mul_f32 v48, v51, v51
    v_fma_f32 v48, v50, v50, -v48
    v_mul_f32 v49, v50, v51
    v_add_f32 v49, v49, v49
    v_mfma_f32_32x32x16_bf16 v[112:127], v[132:135], v[140:143], v[112:127]
    v_mul_f32 v36, v49, v49
    v_fma_f32 v36, v48, v48, -v36
    v_mul_f32 v37, v48, v49
    v_add_f32 v37, v37, v37
    v_mul_f32 v48, v37, v37
    v_fma_f32 v48, v36, v36, -v48
    ds_read_b128 v[128:131], v18 offset:16384
    ds_read_b128 v[132:135], v18 offset:20480
    ds_read_b128 v[136:139], v22 offset:32768
    ds_read_b128 v[140:143], v22 offset:36864
    s_waitcnt lgkmcnt(4)
    v_mfma_f32_32x32x16_bf16 v[64:79], v[144:147], v[152:155], v[64:79]
    s_add_u32 m0, s44, 0
    s_add_u32 s21, s45, 640
    s_and_b32 s21, s21, 2047
    buffer_load_dwordx4 v8, s[4:7], s21 offen offset:0 lds
    v_mul_f32 v49, v36, v37
    v_add_f32 v49, v49, v49
    v_mul_f32 v50, v49, v49
    v_fma_f32 v50, v48, v48, -v50
    v_mul_f32 v51, v48, v49
    v_add_f32 v51, v51, v51
    v_mfma_f32_32x32x16_bf16 v[80:95], v[144:147], v[156:159], v[80:95]
    v_mul_f32 v38, v51, v51
    v_fma_f32 v38, v50, v50, -v38
    v_mul_f32 v39, v50, v51
    v_add_f32 v39, v39, v39
    v_mul_f32 v40, v39, v39
    v_fma_f32 v40, v38, v38, -v40
    v_mfma_f32_32x32x16_bf16 v[96:111], v[148:151], v[152:155], v[96:111]
    buffer_load_dwordx4 v9, s[4:7], s21 offen offset:1024 lds
    v_mul_f32 v41, v38, v39
    v_add_f32 v41, v41, v41
    v_cmp_eq_u32 vcc, 1, v47
    s_cmp_eq_u32 s19, 1
    s_cselect_b64 s[38:39], -1, 0
    v_cndmask_b32 v48, 1.0, v48, vcc
    v_mfma_f32_32x32x16_bf16 v[112:127], v[148:151], v[156:159], v[112:127]
    v_cndmask_b32 v49, 0, v49, vcc
    v_cndmask_b32 v50, 1.0, v50, s[38:39]
    v_cndmask_b32 v51, 0, v51, s[38:39]
    v_mul_f32 v42, v48, v50
    v_mul_f32 v44, v48, v51
    v_fma_f32 v42, -v49, v51, v42
    ds_read_b128 v[144:147], v19 offset:16384
    ds_read_b128 v[148:151], v19 offset:20480
    ds_read_b128 v[152:155], v23 offset:32768
    ds_read_b128 v[156:159], v23 offset:36864
    s_waitcnt lgkmcnt(4)
    v_mfma_f32_32x32x16_bf16 v[64:79], v[128:131], v[136:139], v[64:79]
    buffer_load_dwordx4 v10, s[4:7], s21 offen offset:2048 lds
    v_fma_f32 v44, v49, v50, v44
    v_mul_f32 v43, v42, v36
    v_mul_f32 v45, v42, v37
    v_fma_f32 v43, -v44, v37, v43
    v_fma_f32 v45, v44, v36, v45
    v_mfma_f32_32x32x16_bf16 v[80:95], v[128:131], v[140:143], v[80:95]
    v_mfma_f32_32x32x16_bf16 v[96:111], v[132:135], v[136:139], v[96:111]
    buffer_load_dwordx4 v11, s[4:7], s21 offen offset:3072 lds
    v_mfma_f32_32x32x16_bf16 v[112:127], v[132:135], v[140:143], v[112:127]
    s_waitcnt vmcnt(4) lgkmcnt(0)
    s_barrier
    ds_read_b128 v[128:131], v16 offset:49152
    ds_read_b128 v[132:135], v16 offset:53248
    ds_read_b128 v[136:139], v28 offset:0
    ds_read_b128 v[140:143], v28 offset:4096
    v_mfma_f32_32x32x16_bf16 v[64:79], v[144:147], v[152:155], v[64:79]
    s_add_u32 m0, s44, 16384
    s_add_u32 s21, s45, 640
    s_and_b32 s21, s21, 2047
    buffer_load_dwordx4 v12, s[8:11], s21 offen offset:0 lds
    v_mfma_f32_32x32x16_bf16 v[80:95], v[144:147], v[156:159], v[80:95]
    v_mfma_f32_32x32x16_bf16 v[96:111], v[148:151], v[152:155], v[96:111]
    buffer_load_dwordx4 v13, s[8:11], s21 offen offset:1024 lds
    v_mfma_f32_32x32x16_bf16 v[112:127], v[148:151], v[156:159], v[112:127]
    ds_read_b128 v[144:147], v17 offset:49152
    ds_read_b128 v[148:151], v17 offset:53248
    ds_read_b128 v[152:155], v29 offset:0
    ds_read_b128 v[156:159], v29 offset:4096
    s_waitcnt lgkmcnt(4)
    v_mfma_f32_32x32x16_bf16 v[64:79], v[128:131], v[136:139], v[64:79]
    buffer_load_dwordx4 v14, s[8:11], s21 offen offset:2048 lds
    v_mfma_f32_32x32x16_bf16 v[80:95], v[128:131], v[140:143], v[80:95]
    v_mfma_f32_32x32x16_bf16 v[96:111], v[132:135], v[136:139], v[96:111]
    buffer_load_dwordx4 v15, s[8:11], s21 offen offset:3072 lds
    v_mfma_f32_32x32x16_bf16 v[112:127], v[132:135], v[140:143], v[112:127]
    ds_read_b128 v[128:131], v18 offset:49152
    ds_read_b128 v[132:135], v18 offset:53248
    ds_read_b128 v[136:139], v30 offset:0
    ds_read_b128 v[140:143], v30 offset:4096
    s_waitcnt lgkmcnt(4)
    v_mfma_f32_32x32x16_bf16 v[64:79], v[144:147], v[152:155], v[64:79]
    s_add_u32 m0, s44, 32768
    s_add_u32 s21, s45, 768
    s_and_b32 s21, s21, 2047
    buffer_load_dwordx4 v8, s[4:7], s21 offen offset:0 lds
    v_mfma_f32_32x32x16_bf16 v[80:95], v[144:147], v[156:159], v[80:95]
    v_mfma_f32_32x32x16_bf16 v[96:111], v[148:151], v[152:155], v[96:111]
    buffer_load_dwordx4 v9, s[4:7], s21 offen offset:1024 lds
    v_mfma_f32_32x32x16_bf16 v[112:127], v[148:151], v[156:159], v[112:127]
    ds_read_b128 v[144:147], v19 offset:49152
    ds_read_b128 v[148:151], v19 offset:53248
    ds_read_b128 v[152:155], v31 offset:0
    ds_read_b128 v[156:159], v31 offset:4096
    s_waitcnt lgkmcnt(4)
    v_mfma_f32_32x32x16_bf16 v[64:79], v[128:131], v[136:139], v[64:79]
    buffer_load_dwordx4 v10, s[4:7], s21 offen offset:2048 lds
    v_mfma_f32_32x32x16_bf16 v[80:95], v[128:131], v[140:143], v[80:95]
    v_mfma_f32_32x32x16_bf16 v[96:111], v[132:135], v[136:139], v[96:111]
    buffer_load_dwordx4 v11, s[4:7], s21 offen offset:3072 lds
    v_mfma_f32_32x32x16_bf16 v[112:127], v[132:135], v[140:143], v[112:127]
    s_waitcnt vmcnt(4) lgkmcnt(0)
    s_barrier
    ds_read_b128 v[128:131], v16 offset:0
    ds_read_b128 v[132:135], v16 offset:4096
    ds_read_b128 v[136:139], v20 offset:16384
    ds_read_b128 v[140:143], v20 offset:20480
    v_mfma_f32_32x32x16_bf16 v[64:79], v[144:147], v[152:155], v[64:79]
    s_add_u32 m0, s44, 49152
    s_add_u32 s21, s45, 768
    s_and_b32 s21, s21, 2047
    buffer_load_dwordx4 v12, s[8:11], s21 offen offset:0 lds
    v_mfma_f32_32x32x16_bf16 v[80:95], v[144:147], v[156:159], v[80:95]
    v_mfma_f32_32x32x16_bf16 v[96:111], v[148:151], v[152:155], v[96:111]
    buffer_load_dwordx4 v13, s[8:11], s21 offen offset:1024 lds
    v_mfma_f32_32x32x16_bf16 v[112:127], v[148:151], v[156:159], v[112:127]
    ds_read_b128 v[144:147], v17 offset:0
    ds_read_b128 v[148:151], v17 offset:4096
    ds_read_b128 v[152:155], v21 offset:16384
    ds_read_b128 v[156:159], v21 offset:20480
    s_waitcnt lgkmcnt(4)
    v_mfma_f32_32x32x16_bf16 v[64:79], v[128:131], v[136:139], v[64:79]
    buffer_load_dwordx4 v14, s[8:11], s21 offen offset:2048 lds
    v_mfma_f32_32x32x16_bf16 v[80:95], v[128:131], v[140:143], v[80:95]
    v_mfma_f32_32x32x16_bf16 v[96:111], v[132:135], v[136:139], v[96:111]
    buffer_load_dwordx4 v15, s[8:11], s21 offen offset:3072 lds
    v_mfma_f32_32x32x16_bf16 v[112:127], v[132:135], v[140:143], v[112:127]
    ds_read_b128 v[128:131], v18 offset:0
    ds_read_b128 v[132:135], v18 offset:4096
    ds_read_b128 v[136:139], v22 offset:16384
    ds_read_b128 v[140:143], v22 offset:20480
    s_waitcnt lgkmcnt(4)
    v_mfma_f32_32x32x16_bf16 v[64:79], v[144:147], v[152:155], v[64:79]
    s_add_u32 m0, s44, 65536
    s_add_u32 s21, s45, 896
    s_and_b32 s21, s21, 2047
    buffer_load_dwordx4 v8, s[4:7], s21 offen offset:0 lds
    v_mfma_f32_32x32x16_bf16 v[80:95], v[144:147], v[156:159], v[80:95]
    v_mfma_f32_32x32x16_bf16 v[96:111], v[148:151], v[152:155], v[96:111]
    buffer_load_dwordx4 v9, s[4:7], s21 offen offset:1024 lds
    v_mfma_f32_32x32x16_bf16 v[112:127], v[148:151], v[156:159], v[112:127]
    ds_read_b128 v[144:147], v19 offset:0
    ds_read_b128 v[148:151], v19 offset:4096
    ds_read_b128 v[152:155], v23 offset:16384
    ds_read_b128 v[156:159], v23 offset:20480
    s_waitcnt lgkmcnt(4)
    v_mfma_f32_32x32x16_bf16 v[64:79], v[128:131], v[136:139], v[64:79]
    buffer_load_dwordx4 v10, s[4:7], s21 offen offset:2048 lds
    v_mfma_f32_32x32x16_bf16 v[80:95], v[128:131], v[140:143], v[80:95]
    v_mfma_f32_32x32x16_bf16 v[96:111], v[132:135], v[136:139], v[96:111]
    buffer_load_dwordx4 v11, s[4:7], s21 offen offset:3072 lds
    v_mfma_f32_32x32x16_bf16 v[112:127], v[132:135], v[140:143], v[112:127]
    s_waitcnt vmcnt(4) lgkmcnt(0)
    s_barrier
    ds_read_b128 v[128:131], v16 offset:32768
    ds_read_b128 v[132:135], v16 offset:36864
    ds_read_b128 v[136:139], v20 offset:49152
    ds_read_b128 v[140:143], v20 offset:53248
    v_mfma_f32_32x32x16_bf16 v[64:79], v[144:147], v[152:155], v[64:79]
    s_add_u32 m0, s44, 0
    s_add_u32 s21, s45, 896
    s_and_b32 s21, s21, 2047
    buffer_load_dwordx4 v12, s[8:11], s21 offen offset:0 lds
    v_mfma_f32_32x32x16_bf16 v[80:95], v[144:147], v[156:159], v[80:95]
    v_mfma_f32_32x32x16_bf16 v[96:111], v[148:151], v[152:155], v[96:111]
    buffer_load_dwordx4 v13, s[8:11], s21 offen offset:1024 lds
    v_mfma_f32_32x32x16_bf16 v[112:127], v[148:151], v[156:159], v[112:127]
    ds_read_b128 v[144:147], v17 offset:32768
    ds_read_b128 v[148:151], v17 offset:36864
    ds_read_b128 v[152:155], v21 offset:49152
    ds_read_b128 v[156:159], v21 offset:53248
    s_waitcnt lgkmcnt(4)
    v_mfma_f32_32x32x16_bf16 v[64:79], v[128:131], v[136:139], v[64:79]
    buffer_load_dwordx4 v14, s[8:11], s21 offen offset:2048 lds
    v_mfma_f32_32x32x16_bf16 v[80:95], v[128:131], v[140:143], v[80:95]
    v_mfma_f32_32x32x16_bf16 v[96:111], v[132:135], v[136:139], v[96:111]
    buffer_load_dwordx4 v15, s[8:11], s21 offen offset:3072 lds
    v_mfma_f32_32x32x16_bf16 v[112:127], v[132:135], v[140:143], v[112:127]
    ds_read_b128 v[128:131], v18 offset:32768
    ds_read_b128 v[132:135], v18 offset:36864
    ds_read_b128 v[136:139], v22 offset:49152
    ds_read_b128 v[140:143], v22 offset:53248
    s_waitcnt lgkmcnt(4)
    v_mfma_f32_32x32x16_bf16 v[64:79], v[144:147], v[152:155], v[64:79]
    s_add_u32 m0, s44, 16384
    s_add_u32 s21, s45, 1024
    s_and_b32 s21, s21, 2047
    buffer_load_dwordx4 v8, s[4:7], s21 offen offset:0 lds
    v_mfma_f32_32x32x16_bf16 v[80:95], v[144:147], v[156:159], v[80:95]
    v_mfma_f32_32x32x16_bf16 v[96:111], v[148:151], v[152:155], v[96:111]
    buffer_load_dwordx4 v9, s[4:7], s21 offen offset:1024 lds
    v_mfma_f32_32x32x16_bf16 v[112:127], v[148:151], v[156:159], v[112:127]
    ds_read_b128 v[144:147], v19 offset:32768
    ds_read_b128 v[148:151], v19 offset:36864
    ds_read_b128 v[152:155], v23 offset:49152
    ds_read_b128 v[156:159], v23 offset:53248
    s_waitcnt lgkmcnt(4)
    v_mfma_f32_32x32x16_bf16 v[64:79], v[128:131], v[136:139], v[64:79]
    buffer_load_dwordx4 v10, s[4:7], s21 offen offset:2048 lds
    v_mfma_f32_32x32x16_bf16 v[80:95], v[128:131], v[140:143], v[80:95]
    v_mfma_f32_32x32x16_bf16 v[96:111], v[132:135], v[136:139], v[96:111]
    buffer_load_dwordx4 v11, s[4:7], s21 offen offset:3072 lds
    v_mfma_f32_32x32x16_bf16 v[112:127], v[132:135], v[140:143], v[112:127]
    s_waitcnt vmcnt(4) lgkmcnt(0)
    s_barrier
    ds_read_b128 v[128:131], v24 offset:0
    ds_read_b128 v[132:135], v24 offset:4096
    ds_read_b128 v[136:139], v20 offset:0
    ds_read_b128 v[140:143], v20 offset:4096
    v_mfma_f32_32x32x16_bf16 v[64:79], v[144:147], v[152:155], v[64:79]
    s_add_u32 m0, s44, 32768
    s_add_u32 s21, s45, 1024
    s_and_b32 s21, s21, 2047
    buffer_load_dwordx4 v12, s[8:11], s21 offen offset:0 lds
    v_mfma_f32_32x32x16_bf16 v[80:95], v[144:147], v[156:159], v[80:95]
    v_mfma_f32_32x32x16_bf16 v[96:111], v[148:151], v[152:155], v[96:111]
    buffer_load_dwordx4 v13, s[8:11], s21 offen offset:1024 lds
    v_mfma_f32_32x32x16_bf16 v[112:127], v[148:151], v[156:159], v[112:127]
    ds_read_b128 v[144:147], v25 offset:0
    ds_read_b128 v[148:151], v25 offset:4096
    ds_read_b128 v[152:155], v21 offset:0
    ds_read_b128 v[156:159], v21 offset:4096
    s_waitcnt lgkmcnt(4)
    v_mfma_f32_32x32x16_bf16 v[64:79], v[128:131], v[136:139], v[64:79]
    buffer_load_dwordx4 v14, s[8:11], s21 offen offset:2048 lds
    v_mfma_f32_32x32x16_bf16 v[80:95], v[128:131], v[140:143], v[80:95]
    v_mfma_f32_32x32x16_bf16 v[96:111], v[132:135], v[136:139], v[96:111]
    buffer_load_dwordx4 v15, s[8:11], s21 offen offset:3072 lds
    v_mfma_f32_32x32x16_bf16 v[112:127], v[132:135], v[140:143], v[112:127]
    ds_read_b128 v[128:131], v26 offset:0
    ds_read_b128 v[132:135], v26 offset:4096
    ds_read_b128 v[136:139], v22 offset:0
    ds_read_b128 v[140:143], v22 offset:4096
    s_waitcnt lgkmcnt(4)
    v_mfma_f32_32x32x16_bf16 v[64:79], v[144:147], v[152:155], v[64:79]
    s_add_u32 m0, s44, 49152
    s_add_u32 s21, s45, 1152
    s_and_b32 s21, s21, 2047
    buffer_load_dwordx4 v8, s[4:7], s21 offen offset:0 lds
    v_mfma_f32_32x32x16_bf16 v[80:95], v[144:147], v[156:159], v[80:95]
    v_mfma_f32_32x32x16_bf16 v[96:111], v[148:151], v[152:155], v[96:111]
    buffer_load_dwordx4 v9, s[4:7], s21 offen offset:1024 lds
    v_mfma_f32_32x32x16_bf16 v[112:127], v[148:151], v[156:159], v[112:127]
    ds_read_b128 v[144:147], v27 offset:0
    ds_read_b128 v[148:151], v27 offset:4096
    ds_read_b128 v[152:155], v23 offset:0
    ds_read_b128 v[156:159], v23 offset:4096
    s_waitcnt lgkmcnt(4)
    v_mfma_f32_32x32x16_bf16 v[64:79], v[128:131], v[136:139], v[64:79]
    buffer_load_dwordx4 v10, s[4:7], s21 offen offset:2048 lds
    v_mfma_f32_32x32x16_bf16 v[80:95], v[128:131], v[140:143], v[80:95]
    v_mfma_f32_32x32x16_bf16 v[96:111], v[132:135], v[136:139], v[96:111]
    buffer_load_dwordx4 v11, s[4:7], s21 offen offset:3072 lds
    v_mfma_f32_32x32x16_bf16 v[112:127], v[132:135], v[140:143], v[112:127]
    s_waitcnt vmcnt(4) lgkmcnt(0)
    s_barrier
    ds_read_b128 v[128:131], v16 offset:16384
    ds_read_b128 v[132:135], v16 offset:20480
    ds_read_b128 v[136:139], v20 offset:32768
    ds_read_b128 v[140:143], v20 offset:36864
    v_mfma_f32_32x32x16_bf16 v[64:79], v[144:147], v[152:155], v[64:79]
    s_add_u32 m0, s44, 65536
    s_add_u32 s21, s45, 1152
    s_and_b32 s21, s21, 2047
    buffer_load_dwordx4 v12, s[8:11], s21 offen offset:0 lds
    v_mfma_f32_32x32x16_bf16 v[80:95], v[144:147], v[156:159], v[80:95]
    v_mfma_f32_32x32x16_bf16 v[96:111], v[148:151], v[152:155], v[96:111]
    buffer_load_dwordx4 v13, s[8:11], s21 offen offset:1024 lds
    v_mfma_f32_32x32x16_bf16 v[112:127], v[148:151], v[156:159], v[112:127]
    ds_read_b128 v[144:147], v17 offset:16384
    ds_read_b128 v[148:151], v17 offset:20480
    ds_read_b128 v[152:155], v21 offset:32768
    ds_read_b128 v[156:159], v21 offset:36864
    s_waitcnt lgkmcnt(4)
    v_mfma_f32_32x32x16_bf16 v[64:79], v[128:131], v[136:139], v[64:79]
    buffer_load_dwordx4 v14, s[8:11], s21 offen offset:2048 lds
    v_mfma_f32_32x32x16_bf16 v[80:95], v[128:131], v[140:143], v[80:95]
    v_mfma_f32_32x32x16_bf16 v[96:111], v[132:135], v[136:139], v[96:111]
    buffer_load_dwordx4 v15, s[8:11], s21 offen offset:3072 lds
    v_mfma_f32_32x32x16_bf16 v[112:127], v[132:135], v[140:143], v[112:127]
    ds_read_b128 v[128:131], v18 offset:16384
    ds_read_b128 v[132:135], v18 offset:20480
    ds_read_b128 v[136:139], v22 offset:32768
    ds_read_b128 v[140:143], v22 offset:36864
    s_waitcnt lgkmcnt(4)
    v_mfma_f32_32x32x16_bf16 v[64:79], v[144:147], v[152:155], v[64:79]
    s_add_u32 m0, s44, 0
    s_add_u32 s21, s45, 1280
    s_and_b32 s21, s21, 2047
    buffer_load_dwordx4 v8, s[4:7], s21 offen offset:0 lds
    v_mfma_f32_32x32x16_bf16 v[80:95], v[144:147], v[156:159], v[80:95]
    v_mfma_f32_32x32x16_bf16 v[96:111], v[148:151], v[152:155], v[96:111]
    buffer_load_dwordx4 v9, s[4:7], s21 offen offset:1024 lds
    v_mfma_f32_32x32x16_bf16 v[112:127], v[148:151], v[156:159], v[112:127]
    ds_read_b128 v[144:147], v19 offset:16384
    ds_read_b128 v[148:151], v19 offset:20480
    ds_read_b128 v[152:155], v23 offset:32768
    ds_read_b128 v[156:159], v23 offset:36864
    s_waitcnt lgkmcnt(4)
    v_mfma_f32_32x32x16_bf16 v[64:79], v[128:131], v[136:139], v[64:79]
    buffer_load_dwordx4 v10, s[4:7], s21 offen offset:2048 lds
    v_mfma_f32_32x32x16_bf16 v[80:95], v[128:131], v[140:143], v[80:95]
    v_mfma_f32_32x32x16_bf16 v[96:111], v[132:135], v[136:139], v[96:111]
    buffer_load_dwordx4 v11, s[4:7], s21 offen offset:3072 lds
    v_mfma_f32_32x32x16_bf16 v[112:127], v[132:135], v[140:143], v[112:127]
    s_waitcnt vmcnt(4) lgkmcnt(0)
    s_barrier
    ds_read_b128 v[128:131], v16 offset:49152
    ds_read_b128 v[132:135], v16 offset:53248
    ds_read_b128 v[136:139], v28 offset:0
    ds_read_b128 v[140:143], v28 offset:4096
    v_mfma_f32_32x32x16_bf16 v[64:79], v[144:147], v[152:155], v[64:79]
    s_add_u32 m0, s44, 16384
    s_add_u32 s21, s45, 1280
    s_and_b32 s21, s21, 2047
    buffer_load_dwordx4 v12, s[8:11], s21 offen offset:0 lds
    v_mfma_f32_32x32x16_bf16 v[80:95], v[144:147], v[156:159], v[80:95]
    v_mfma_f32_32x32x16_bf16 v[96:111], v[148:151], v[152:155], v[96:111]
    buffer_load_dwordx4 v13, s[8:11], s21 offen offset:1024 lds
    v_mfma_f32_32x32x16_bf16 v[112:127], v[148:151], v[156:159], v[112:127]
    ds_read_b128 v[144:147], v17 offset:49152
    ds_read_b128 v[148:151], v17 offset:53248
    ds_read_b128 v[152:155], v29 offset:0
    ds_read_b128 v[156:159], v29 offset:4096
    s_waitcnt lgkmcnt(4)
    v_mfma_f32_32x32x16_bf16 v[64:79], v[128:131], v[136:139], v[64:79]
    buffer_load_dwordx4 v14, s[8:11], s21 offen offset:2048 lds
    v_mfma_f32_32x32x16_bf16 v[80:95], v[128:131], v[140:143], v[80:95]
    v_mfma_f32_32x32x16_bf16 v[96:111], v[132:135], v[136:139], v[96:111]
    buffer_load_dwordx4 v15, s[8:11], s21 offen offset:3072 lds
    v_mfma_f32_32x32x16_bf16 v[112:127], v[132:135], v[140:143], v[112:127]
    ds_read_b128 v[128:131], v18 offset:49152
    ds_read_b128 v[132:135], v18 offset:53248
    ds_read_b128 v[136:139], v30 offset:0
    ds_read_b128 v[140:143], v30 offset:4096
    s_waitcnt lgkmcnt(4)
    v_mfma_f32_32x32x16_bf16 v[64:79], v[144:147], v[152:155], v[64:79]
    s_add_u32 m0, s44, 32768
    s_add_u32 s21, s45, 1408
    s_and_b32 s21, s21, 2047
    buffer_load_dwordx4 v8, s[4:7], s21 offen offset:0 lds
    v_mfma_f32_32x32x16_bf16 v[80:95], v[144:147], v[156:159], v[80:95]
    v_mfma_f32_32x32x16_bf16 v[96:111], v[148:151], v[152:155], v[96:111]
    buffer_load_dwordx4 v9, s[4:7], s21 offen offset:1024 lds
    v_mfma_f32_32x32x16_bf16 v[112:127], v[148:151], v[156:159], v[112:127]
    ds_read_b128 v[144:147], v19 offset:49152
    ds_read_b128 v[148:151], v19 offset:53248
    ds_read_b128 v[152:155], v31 offset:0
    ds_read_b128 v[156:159], v31 offset:4096
    s_waitcnt lgkmcnt(4)
    v_mfma_f32_32x32x16_bf16 v[64:79], v[128:131], v[136:139], v[64:79]
    buffer_load_dwordx4 v10, s[4:7], s21 offen offset:2048 lds
    v_mfma_f32_32x32x16_bf16 v[80:95], v[128:131], v[140:143], v[80:95]
    v_mfma_f32_32x32x16_bf16 v[96:111], v[132:135], v[136:139], v[96:111]
    buffer_load_dwordx4 v11, s[4:7], s21 offen offset:3072 lds
    v_mfma_f32_32x32x16_bf16 v[112:127], v[132:135], v[140:143], v[112:127]
    s_waitcnt vmcnt(4) lgkmcnt(0)
    s_barrier
    ds_read_b128 v[128:131], v16 offset:0
    ds_read_b128 v[132:135], v16 offset:4096
    ds_read_b128 v[136:139], v20 offset:16384
    ds_read_b128 v[140:143], v20 offset:20480
    v_mfma_f32_32x32x16_bf16 v[64:79], v[144:147], v[152:155], v[64:79]
    s_add_u32 m0, s44, 49152
    s_add_u32 s21, s45, 1408
    s_and_b32 s21, s21, 2047
    buffer_load_dwordx4 v12, s[8:11], s21 offen offset:0 lds
    v_mfma_f32_32x32x16_bf16 v[80:95], v[144:147], v[156:159], v[80:95]
    v_mfma_f32_32x32x16_bf16 v[96:111], v[148:151], v[152:155], v[96:111]
    buffer_load_dwordx4 v13, s[8:11], s21 offen offset:1024 lds
    v_mfma_f32_32x32x16_bf16 v[112:127], v[148:151], v[156:159], v[112:127]
    ds_read_b128 v[144:147], v17 offset:0
    ds_read_b128 v[148:151], v17 offset:4096
    ds_read_b128 v[152:155], v21 offset:16384
    ds_read_b128 v[156:159], v21 offset:20480
    s_waitcnt lgkmcnt(4)
    v_mfma_f32_32x32x16_bf16 v[64:79], v[128:131], v[136:139], v[64:79]
    buffer_load_dwordx4 v14, s[8:11], s21 offen offset:2048 lds
    v_mfma_f32_32x32x16_bf16 v[80:95], v[128:131], v[140:143], v[80:95]
    v_mfma_f32_32x32x16_bf16 v[96:111], v[132:135], v[136:139], v[96:111]
    buffer_load_dwordx4 v15, s[8:11], s21 offen offset:3072 lds
    v_mfma_f32_32x32x16_bf16 v[112:127], v[132:135], v[140:143], v[112:127]
    ds_read_b128 v[128:131], v18 offset:0
    ds_read_b128 v[132:135], v18 offset:4096
    ds_read_b128 v[136:139], v22 offset:16384
    ds_read_b128 v[140:143], v22 offset:20480
    s_waitcnt lgkmcnt(4)
    v_mfma_f32_32x32x16_bf16 v[64:79], v[144:147], v[152:155], v[64:79]
    s_add_u32 m0, s44, 65536
    s_add_u32 s21, s45, 1536
    s_and_b32 s21, s21, 2047
    buffer_load_dwordx4 v8, s[4:7], s21 offen offset:0 lds
    v_mfma_f32_32x32x16_bf16 v[80:95], v[144:147], v[156:159], v[80:95]
    v_mfma_f32_32x32x16_bf16 v[96:111], v[148:151], v[152:155], v[96:111]
    buffer_load_dwordx4 v9, s[4:7], s21 offen offset:1024 lds
    v_mfma_f32_32x32x16_bf16 v[112:127], v[148:151], v[156:159], v[112:127]
    ds_read_b128 v[144:147], v19 offset:0
    ds_read_b128 v[148:151], v19 offset:4096
    ds_read_b128 v[152:155], v23 offset:16384
    ds_read_b128 v[156:159], v23 offset:20480
    s_waitcnt lgkmcnt(4)
    v_mfma_f32_32x32x16_bf16 v[64:79], v[128:131], v[136:139], v[64:79]
    buffer_load_dwordx4 v10, s[4:7], s21 offen offset:2048 lds
    v_mfma_f32_32x32x16_bf16 v[80:95], v[128:131], v[140:143], v[80:95]
    v_mfma_f32_32x32x16_bf16 v[96:111], v[132:135], v[136:139], v[96:111]
    buffer_load_dwordx4 v11, s[4:7], s21 offen offset:3072 lds
    v_mfma_f32_32x32x16_bf16 v[112:127], v[132:135], v[140:143], v[112:127]
    s_waitcnt vmcnt(4) lgkmcnt(0)
    s_barrier
    ds_read_b128 v[128:131], v16 offset:32768
    ds_read_b128 v[132:135], v16 offset:36864
    ds_read_b128 v[136:139], v20 offset:49152
    ds_read_b128 v[140:143], v20 offset:53248
    v_mfma_f32_32x32x16_bf16 v[64:79], v[144:147], v[152:155], v[64:79]
    s_add_u32 m0, s44, 0
    s_add_u32 s21, s45, 1536
    s_and_b32 s21, s21, 2047
    buffer_load_dwordx4 v12, s[8:11], s21 offen offset:0 lds
    v_mfma_f32_32x32x16_bf16 v[80:95], v[144:147], v[156:159], v[80:95]
    v_mfma_f32_32x32x16_bf16 v[96:111], v[148:151], v[152:155], v[96:111]
    buffer_load_dwordx4 v13, s[8:11], s21 offen offset:1024 lds
    v_mfma_f32_32x32x16_bf16 v[112:127], v[148:151], v[156:159], v[112:127]
    ds_read_b128 v[144:147], v17 offset:32768
    ds_read_b128 v[148:151], v17 offset:36864
    ds_read_b128 v[152:155], v21 offset:49152
    ds_read_b128 v[156:159], v21 offset:53248
    s_waitcnt lgkmcnt(4)
    v_mfma_f32_32x32x16_bf16 v[64:79], v[128:131], v[136:139], v[64:79]
    buffer_load_dwordx4 v14, s[8:11], s21 offen offset:2048 lds
    v_mfma_f32_32x32x16_bf16 v[80:95], v[128:131], v[140:143], v[80:95]
    v_mfma_f32_32x32x16_bf16 v[96:111], v[132:135], v[136:139], v[96:111]
    buffer_load_dwordx4 v15, s[8:11], s21 offen offset:3072 lds
    v_mfma_f32_32x32x16_bf16 v[112:127], v[132:135], v[140:143], v[112:127]
    ds_read_b128 v[128:131], v18 offset:32768
    ds_read_b128 v[132:135], v18 offset:36864
    ds_read_b128 v[136:139], v22 offset:49152
    ds_read_b128 v[140:143], v22 offset:53248
    s_waitcnt lgkmcnt(4)
    v_mfma_f32_32x32x16_bf16 v[64:79], v[144:147], v[152:155], v[64:79]
    s_add_u32 m0, s44, 16384
    s_add_u32 s21, s45, 1664
    s_and_b32 s21, s21, 2047
    buffer_load_dwordx4 v8, s[4:7], s21 offen offset:0 lds
    v_mfma_f32_32x32x16_bf16 v[80:95], v[144:147], v[156:159], v[80:95]
    v_mfma_f32_32x32x16_bf16 v[96:111], v[148:151], v[152:155], v[96:111]
    buffer_load_dwordx4 v9, s[4:7], s21 offen offset:1024 lds
    v_mfma_f32_32x32x16_bf16 v[112:127], v[148:151], v[156:159], v[112:127]
    ds_read_b128 v[144:147], v19 offset:32768
    ds_read_b128 v[148:151], v19 offset:36864
    ds_read_b128 v[152:155], v23 offset:49152
    ds_read_b128 v[156:159], v23 offset:53248
    s_waitcnt lgkmcnt(4)
    v_mfma_f32_32x32x16_bf16 v[64:79], v[128:131], v[136:139], v[64:79]
    buffer_load_dwordx4 v10, s[4:7], s21 offen offset:2048 lds
    v_mfma_f32_32x32x16_bf16 v[80:95], v[128:131], v[140:143], v[80:95]
    v_mfma_f32_32x32x16_bf16 v[96:111], v[132:135], v[136:139], v[96:111]
    buffer_load_dwordx4 v11, s[4:7], s21 offen offset:3072 lds
    v_mfma_f32_32x32x16_bf16 v[112:127], v[132:135], v[140:143], v[112:127]
    s_waitcnt vmcnt(4) lgkmcnt(0)
    s_barrier
    ds_read_b128 v[128:131], v24 offset:0
    ds_read_b128 v[132:135], v24 offset:4096
    ds_read_b128 v[136:139], v20 offset:0
    ds_read_b128 v[140:143], v20 offset:4096
    v_mfma_f32_32x32x16_bf16 v[64:79], v[144:147], v[152:155], v[64:79]
    s_add_u32 m0, s44, 32768
    s_add_u32 s21, s45, 1664
    s_and_b32 s21, s21, 2047
    buffer_load_dwordx4 v12, s[8:11], s21 offen offset:0 lds
    v_mfma_f32_32x32x16_bf16 v[80:95], v[144:147], v[156:159], v[80:95]
    v_mfma_f32_32x32x16_bf16 v[96:111], v[148:151], v[152:155], v[96:111]
    buffer_load_dwordx4 v13, s[8:11], s21 offen offset:1024 lds
    v_mfma_f32_32x32x16_bf16 v[112:127], v[148:151], v[156:159], v[112:127]
    ds_read_b128 v[144:147], v25 offset:0
    ds_read_b128 v[148:151], v25 offset:4096
    ds_read_b128 v[152:155], v21 offset:0
    ds_read_b128 v[156:159], v21 offset:4096
    s_waitcnt lgkmcnt(4)
    v_mfma_f32_32x32x16_bf16 v[64:79], v[128:131], v[136:139], v[64:79]
    buffer_load_dwordx4 v14, s[8:11], s21 offen offset:2048 lds
    v_mfma_f32_32x32x16_bf16 v[80:95], v[128:131], v[140:143], v[80:95]
    v_mfma_f32_32x32x16_bf16 v[96:111], v[132:135], v[136:139], v[96:111]
    buffer_load_dwordx4 v15, s[8:11], s21 offen offset:3072 lds
    v_mfma_f32_32x32x16_bf16 v[112:127], v[132:135], v[140:143], v[112:127]
    ds_read_b128 v[128:131], v26 offset:0
    ds_read_b128 v[132:135], v26 offset:4096
    ds_read_b128 v[136:139], v22 offset:0
    ds_read_b128 v[140:143], v22 offset:4096
    s_waitcnt lgkmcnt(4)
    v_mfma_f32_32x32x16_bf16 v[64:79], v[144:147], v[152:155], v[64:79]
    s_add_u32 m0, s44, 49152
    s_add_u32 s21, s45, 1792
    s_and_b32 s21, s21, 2047
    buffer_load_dwordx4 v8, s[4:7], s21 offen offset:0 lds
    v_mfma_f32_32x32x16_bf16 v[80:95], v[144:147], v[156:159], v[80:95]
    v_mfma_f32_32x32x16_bf16 v[96:111], v[148:151], v[152:155], v[96:111]
    buffer_load_dwordx4 v9, s[4:7], s21 offen offset:1024 lds
    v_mfma_f32_32x32x16_bf16 v[112:127], v[148:151], v[156:159], v[112:127]
    ds_read_b128 v[144:147], v27 offset:0
    ds_read_b128 v[148:151], v27 offset:4096
    ds_read_b128 v[152:155], v23 offset:0
    ds_read_b128 v[156:159], v23 offset:4096
    s_waitcnt lgkmcnt(4)
    v_mfma_f32_32x32x16_bf16 v[64:79], v[128:131], v[136:139], v[64:79]
    buffer_load_dwordx4 v10, s[4:7], s21 offen offset:2048 lds
    v_mfma_f32_32x32x16_bf16 v[80:95], v[128:131], v[140:143], v[80:95]
    v_mfma_f32_32x32x16_bf16 v[96:111], v[132:135], v[136:139], v[96:111]
    buffer_load_dwordx4 v11, s[4:7], s21 offen offset:3072 lds
    v_mfma_f32_32x32x16_bf16 v[112:127], v[132:135], v[140:143], v[112:127]
    s_waitcnt vmcnt(4) lgkmcnt(0)
    s_barrier
    ds_read_b128 v[128:131], v16 offset:16384
    ds_read_b128 v[132:135], v16 offset:20480
    ds_read_b128 v[136:139], v20 offset:32768
    ds_read_b128 v[140:143], v20 offset:36864
    v_mfma_f32_32x32x16_bf16 v[64:79], v[144:147], v[152:155], v[64:79]
    s_add_u32 m0, s44, 65536
    s_add_u32 s21, s45, 1792
    s_and_b32 s21, s21, 2047
    buffer_load_dwordx4 v12, s[8:11], s21 offen offset:0 lds
    v_mfma_f32_32x32x16_bf16 v[80:95], v[144:147], v[156:159], v[80:95]
    v_mfma_f32_32x32x16_bf16 v[96:111], v[148:151], v[152:155], v[96:111]
    buffer_load_dwordx4 v13, s[8:11], s21 offen offset:1024 lds
    v_mfma_f32_32x32x16_bf16 v[112:127], v[148:151], v[156:159], v[112:127]
    ds_read_b128 v[144:147], v17 offset:16384
    ds_read_b128 v[148:151], v17 offset:20480
    ds_read_b128 v[152:155], v21 offset:32768
    ds_read_b128 v[156:159], v21 offset:36864
    s_waitcnt lgkmcnt(4)
    v_mfma_f32_32x32x16_bf16 v[64:79], v[128:131], v[136:139], v[64:79]
    buffer_load_dwordx4 v14, s[8:11], s21 offen offset:2048 lds
    v_mfma_f32_32x32x16_bf16 v[80:95], v[128:131], v[140:143], v[80:95]
    v_mfma_f32_32x32x16_bf16 v[96:111], v[132:135], v[136:139], v[96:111]
    buffer_load_dwordx4 v15, s[8:11], s21 offen offset:3072 lds
    v_mfma_f32_32x32x16_bf16 v[112:127], v[132:135], v[140:143], v[112:127]
    ds_read_b128 v[128:131], v18 offset:16384
    ds_read_b128 v[132:135], v18 offset:20480
    ds_read_b128 v[136:139], v22 offset:32768
    ds_read_b128 v[140:143], v22 offset:36864
    s_waitcnt lgkmcnt(4)
    v_mfma_f32_32x32x16_bf16 v[64:79], v[144:147], v[152:155], v[64:79]
    s_add_u32 m0, s44, 0
    s_add_u32 s21, s45, 1920
    s_and_b32 s21, s21, 2047
    buffer_load_dwordx4 v8, s[4:7], s21 offen offset:0 lds
    v_mfma_f32_32x32x16_bf16 v[80:95], v[144:147], v[156:159], v[80:95]
    v_mfma_f32_32x32x16_bf16 v[96:111], v[148:151], v[152:155], v[96:111]
    buffer_load_dwordx4 v9, s[4:7], s21 offen offset:1024 lds
    v_mfma_f32_32x32x16_bf16 v[112:127], v[148:151], v[156:159], v[112:127]
    ds_read_b128 v[144:147], v19 offset:16384
    ds_read_b128 v[148:151], v19 offset:20480
    ds_read_b128 v[152:155], v23 offset:32768
    ds_read_b128 v[156:159], v23 offset:36864
    s_waitcnt lgkmcnt(4)
    v_mfma_f32_32x32x16_bf16 v[64:79], v[128:131], v[136:139], v[64:79]
    buffer_load_dwordx4 v10, s[4:7], s21 offen offset:2048 lds
    v_mfma_f32_32x32x16_bf16 v[80:95], v[128:131], v[140:143], v[80:95]
    v_mfma_f32_32x32x16_bf16 v[96:111], v[132:135], v[136:139], v[96:111]
    buffer_load_dwordx4 v11, s[4:7], s21 offen offset:3072 lds
    v_mfma_f32_32x32x16_bf16 v[112:127], v[132:135], v[140:143], v[112:127]
    s_waitcnt vmcnt(4) lgkmcnt(0)
    s_barrier
    ds_read_b128 v[128:131], v16 offset:49152
    ds_read_b128 v[132:135], v16 offset:53248
    ds_read_b128 v[136:139], v28 offset:0
    ds_read_b128 v[140:143], v28 offset:4096
    v_mfma_f32_32x32x16_bf16 v[64:79], v[144:147], v[152:155], v[64:79]
    s_add_u32 m0, s44, 16384
    s_add_u32 s21, s45, 1920
    s_and_b32 s21, s21, 2047
    buffer_load_dwordx4 v12, s[8:11], s21 offen offset:0 lds
    v_mfma_f32_32x32x16_bf16 v[80:95], v[144:147], v[156:159], v[80:95]
    v_mfma_f32_32x32x16_bf16 v[96:111], v[148:151], v[152:155], v[96:111]
    buffer_load_dwordx4 v13, s[8:11], s21 offen offset:1024 lds
    v_mfma_f32_32x32x16_bf16 v[112:127], v[148:151], v[156:159], v[112:127]
    ds_read_b128 v[144:147], v17 offset:49152
    ds_read_b128 v[148:151], v17 offset:53248
    ds_read_b128 v[152:155], v29 offset:0
    ds_read_b128 v[156:159], v29 offset:4096
    s_waitcnt lgkmcnt(4)
    v_mfma_f32_32x32x16_bf16 v[64:79], v[128:131], v[136:139], v[64:79]
    buffer_load_dwordx4 v14, s[8:11], s21 offen offset:2048 lds
    v_mfma_f32_32x32x16_bf16 v[80:95], v[128:131], v[140:143], v[80:95]
    v_mfma_f32_32x32x16_bf16 v[96:111], v[132:135], v[136:139], v[96:111]
    buffer_load_dwordx4 v15, s[8:11], s21 offen offset:3072 lds
    v_mfma_f32_32x32x16_bf16 v[112:127], v[132:135], v[140:143], v[112:127]
    ds_read_b128 v[128:131], v18 offset:49152
    ds_read_b128 v[132:135], v18 offset:53248
    ds_read_b128 v[136:139], v30 offset:0
    ds_read_b128 v[140:143], v30 offset:4096
    s_waitcnt lgkmcnt(4)
    v_mfma_f32_32x32x16_bf16 v[64:79], v[144:147], v[152:155], v[64:79]
    v_mfma_f32_32x32x16_bf16 v[80:95], v[144:147], v[156:159], v[80:95]
    v_mfma_f32_32x32x16_bf16 v[96:111], v[148:151], v[152:155], v[96:111]
    v_mfma_f32_32x32x16_bf16 v[112:127], v[148:151], v[156:159], v[112:127]
    ds_read_b128 v[144:147], v19 offset:49152
    ds_read_b128 v[148:151], v19 offset:53248
    ds_read_b128 v[152:155], v31 offset:0
    ds_read_b128 v[156:159], v31 offset:4096
    s_waitcnt lgkmcnt(4)
    v_mfma_f32_32x32x16_bf16 v[64:79], v[128:131], v[136:139], v[64:79]
    v_mfma_f32_32x32x16_bf16 v[80:95], v[128:131], v[140:143], v[80:95]
    v_mfma_f32_32x32x16_bf16 v[96:111], v[132:135], v[136:139], v[96:111]
    v_mfma_f32_32x32x16_bf16 v[112:127], v[132:135], v[140:143], v[112:127]
    s_waitcnt vmcnt(0) lgkmcnt(0)
    s_barrier
    ds_read_b128 v[128:131], v16 offset:0
    ds_read_b128 v[132:135], v16 offset:4096
    ds_read_b128 v[136:139], v20 offset:16384
    ds_read_b128 v[140:143], v20 offset:20480
    v_mfma_f32_32x32x16_bf16 v[64:79], v[144:147], v[152:155], v[64:79]
    v_mfma_f32_32x32x16_bf16 v[80:95], v[144:147], v[156:159], v[80:95]
    v_mfma_f32_32x32x16_bf16 v[96:111], v[148:151], v[152:155], v[96:111]
    v_mfma_f32_32x32x16_bf16 v[112:127], v[148:151], v[156:159], v[112:127]
    ds_read_b128 v[144:147], v17 offset:0
    ds_read_b128 v[148:151], v17 offset:4096
    ds_read_b128 v[152:155], v21 offset:16384
    ds_read_b128 v[156:159], v21 offset:20480
    s_waitcnt lgkmcnt(4)
    v_mfma_f32_32x32x16_bf16 v[64:79], v[128:131], v[136:139], v[64:79]
    v_mfma_f32_32x32x16_bf16 v[80:95], v[128:131], v[140:143], v[80:95]
    v_mfma_f32_32x32x16_bf16 v[96:111], v[132:135], v[136:139], v[96:111]
    v_mfma_f32_32x32x16_bf16 v[112:127], v[132:135], v[140:143], v[112:127]
    ds_read_b128 v[128:131], v18 offset:0
    ds_read_b128 v[132:135], v18 offset:4096
    ds_read_b128 v[136:139], v22 offset:16384
    ds_read_b128 v[140:143], v22 offset:20480
    s_waitcnt lgkmcnt(4)
    v_mfma_f32_32x32x16_bf16 v[64:79], v[144:147], v[152:155], v[64:79]
    v_mfma_f32_32x32x16_bf16 v[80:95], v[144:147], v[156:159], v[80:95]
    v_mfma_f32_32x32x16_bf16 v[96:111], v[148:151], v[152:155], v[96:111]
    v_mfma_f32_32x32x16_bf16 v[112:127], v[148:151], v[156:159], v[112:127]
    ds_read_b128 v[144:147], v19 offset:0
    ds_read_b128 v[148:151], v19 offset:4096
    ds_read_b128 v[152:155], v23 offset:16384
    ds_read_b128 v[156:159], v23 offset:20480
    s_waitcnt lgkmcnt(4)
    v_mfma_f32_32x32x16_bf16 v[64:79], v[128:131], v[136:139], v[64:79]
    v_mfma_f32_32x32x16_bf16 v[80:95], v[128:131], v[140:143], v[80:95]
    v_mfma_f32_32x32x16_bf16 v[96:111], v[132:135], v[136:139], v[96:111]
    v_mfma_f32_32x32x16_bf16 v[112:127], v[132:135], v[140:143], v[112:127]
    s_lshl_b32 s38, s17, 2
    v_mov_b32 v58, s38
    global_load_dword v57, v58, s[22:23] sc1
    s_waitcnt lgkmcnt(0)
    v_mfma_f32_32x32x16_bf16 v[64:79], v[144:147], v[152:155], v[64:79]
    v_mfma_f32_32x32x16_bf16 v[80:95], v[144:147], v[156:159], v[80:95]
    v_mfma_f32_32x32x16_bf16 v[96:111], v[148:151], v[152:155], v[96:111]
    v_mfma_f32_32x32x16_bf16 v[112:127], v[148:151], v[156:159], v[112:127]
    v_and_b32 v128, 31, v46
    s_lshl_b32 s38, s20, 8
    s_add_u32 s38, s38, 32768
    v_lshl_add_u32 v130, v128, 3, s38
    s_lshl_b32 s39, s19, 11
    v_lshl_add_u32 v129, v47, 10, v130
    v_add_u32 v129, s39, v129
    v_lshl_add_u32 v131, v47, 9, v56
    v_add_u32 v131, 512, v131
    v_add_u32 v132, 4096, v131
    s_mul_i32 s38, s18, 9216
    s_add_u32 s38, s38, 36864
    v_mul_u32_u24 v133, 144, v128
    v_lshl_add_u32 v133, v47, 6, v133
    v_add_u32 v133, s38, v133
    v_bfe_u32 v134, v46, 2, 2
    v_lshl_add_u32 v134, v47, 3, v134
    v_mul_u32_u24 v134, 144, v134
    v_bfe_u32 v136, v46, 4, 1
    v_lshl_add_u32 v134, v136, 5, v134
    v_and_b32 v136, 3, v46
    v_lshl_add_u32 v134, v136, 3, v134
    v_add_u32 v134, s38, v134
    v_lshlrev_b32 v135, 4, v46
    v_pk_fma_f32 v[52:53], v[32:33], v[80:81], v[66:67] op_sel:[1,0,0] op_sel_hi:[1,1,1] neg_lo:[1,0,0] neg_hi:[1,0,0]
    v_pk_fma_f32 v[54:55], v[32:33], v[64:65], v[82:83] op_sel:[1,0,0] op_sel_hi:[1,1,1]
    v_pk_fma_f32 v[48:49], v[32:33], v[64:65], v[52:53] op_sel:[0,0,0] op_sel_hi:[0,1,1]
    v_pk_fma_f32 v[50:51], v[32:33], v[80:81], v[54:55] op_sel:[0,0,0] op_sel_hi:[0,1,1]
    v_pk_fma_f32 v[52:53], v[32:33], v[50:51], v[68:69] op_sel:[1,0,0] op_sel_hi:[1,1,1] neg_lo:[1,0,0] neg_hi:[1,0,0]
    v_pk_fma_f32 v[54:55], v[32:33], v[48:49], v[84:85] op_sel:[1,0,0] op_sel_hi:[1,1,1]
    v_pk_fma_f32 v[48:49], v[32:33], v[48:49], v[52:53] op_sel:[0,0,0] op_sel_hi:[0,1,1]
    v_pk_fma_f32 v[50:51], v[32:33], v[50:51], v[54:55] op_sel:[0,0,0] op_sel_hi:[0,1,1]
    v_pk_fma_f32 v[52:53], v[32:33], v[50:51], v[70:71] op_sel:[1,0,0] op_sel_hi:[1,1,1] neg_lo:[1,0,0] neg_hi:[1,0,0]
    v_pk_fma_f32 v[54:55], v[32:33], v[48:49], v[86:87] op_sel:[1,0,0] op_sel_hi:[1,1,1]
    v_pk_fma_f32 v[48:49], v[32:33], v[48:49], v[52:53] op_sel:[0,0,0] op_sel_hi:[0,1,1]
    v_pk_fma_f32 v[50:51], v[32:33], v[50:51], v[54:55] op_sel:[0,0,0] op_sel_hi:[0,1,1]
    v_pk_fma_f32 v[52:53], v[32:33], v[50:51], v[72:73] op_sel:[1,0,0] op_sel_hi:[1,1,1] neg_lo:[1,0,0] neg_hi:[1,0,0]
    v_pk_fma_f32 v[54:55], v[32:33], v[48:49], v[88:89] op_sel:[1,0,0] op_sel_hi:[1,1,1]
    v_pk_fma_f32 v[48:49], v[32:33], v[48:49], v[52:53] op_sel:[0,0,0] op_sel_hi:[0,1,1]
    v_pk_fma_f32 v[50:51], v[32:33], v[50:51], v[54:55] op_sel:[0,0,0] op_sel_hi:[0,1,1]
    v_pk_fma_f32 v[52:53], v[32:33], v[50:51], v[74:75] op_sel:[1,0,0] op_sel_hi:[1,1,1] neg_lo:[1,0,0] neg_hi:[1,0,0]
    v_pk_fma_f32 v[54:55], v[32:33], v[48:49], v[90:91] op_sel:[1,0,0] op_sel_hi:[1,1,1]
    v_pk_fma_f32 v[48:49], v[32:33], v[48:49], v[52:53] op_sel:[0,0,0] op_sel_hi:[0,1,1]
    v_pk_fma_f32 v[50:51], v[32:33], v[50:51], v[54:55] op_sel:[0,0,0] op_sel_hi:[0,1,1]
    v_pk_fma_f32 v[52:53], v[32:33], v[50:51], v[76:77] op_sel:[1,0,0] op_sel_hi:[1,1,1] neg_lo:[1,0,0] neg_hi:[1,0,0]
    v_pk_fma_f32 v[54:55], v[32:33], v[48:49], v[92:93] op_sel:[1,0,0] op_sel_hi:[1,1,1]
    v_pk_fma_f32 v[48:49], v[32:33], v[48:49], v[52:53] op_sel:[0,0,0] op_sel_hi:[0,1,1]
    v_pk_fma_f32 v[50:51], v[32:33], v[50:51], v[54:55] op_sel:[0,0,0] op_sel_hi:[0,1,1]
    v_pk_fma_f32 v[52:53], v[32:33], v[50:51], v[78:79] op_sel:[1,0,0] op_sel_hi:[1,1,1] neg_lo:[1,0,0] neg_hi:[1,0,0]
    v_pk_fma_f32 v[54:55], v[32:33], v[48:49], v[94:95] op_sel:[1,0,0] op_sel_hi:[1,1,1]
    v_pk_fma_f32 v[48:49], v[32:33], v[48:49], v[52:53] op_sel:[0,0,0] op_sel_hi:[0,1,1]
    v_pk_fma_f32 v[50:51], v[32:33], v[50:51], v[54:55] op_sel:[0,0,0] op_sel_hi:[0,1,1]
    v_pk_fma_f32 v[52:53], v[32:33], v[50:51], v[96:97] op_sel:[1,0,0] op_sel_hi:[1,1,1] neg_lo:[1,0,0] neg_hi:[1,0,0]
    v_pk_fma_f32 v[54:55], v[32:33], v[48:49], v[112:113] op_sel:[1,0,0] op_sel_hi:[1,1,1]
    v_pk_fma_f32 v[48:49], v[32:33], v[48:49], v[52:53] op_sel:[0,0,0] op_sel_hi:[0,1,1]
    v_pk_fma_f32 v[50:51], v[32:33], v[50:51], v[54:55] op_sel:[0,0,0] op_sel_hi:[0,1,1]
    v_pk_fma_f32 v[52:53], v[32:33], v[50:51], v[98:99] op_sel:[1,0,0] op_sel_hi:[1,1,1] neg_lo:[1,0,0] neg_hi:[1,0,0]
    v_pk_fma_f32 v[54:55], v[32:33], v[48:49], v[114:115] op_sel:[1,0,0] op_sel_hi:[1,1,1]
    v_pk_fma_f32 v[48:49], v[32:33], v[48:49], v[52:53] op_sel:[0,0,0] op_sel_hi:[0,1,1]
    v_pk_fma_f32 v[50:51], v[32:33], v[50:51], v[54:55] op_sel:[0,0,0] op_sel_hi:[0,1,1]
    v_pk_fma_f32 v[52:53], v[32:33], v[50:51], v[100:101] op_sel:[1,0,0] op_sel_hi:[1,1,1] neg_lo:[1,0,0] neg_hi:[1,0,0]
    v_pk_fma_f32 v[54:55], v[32:33], v[48:49], v[116:117] op_sel:[1,0,0] op_sel_hi:[1,1,1]
    v_pk_fma_f32 v[48:49], v[32:33], v[48:49], v[52:53] op_sel:[0,0,0] op_sel_hi:[0,1,1]
    v_pk_fma_f32 v[50:51], v[32:33], v[50:51], v[54:55] op_sel:[0,0,0] op_sel_hi:[0,1,1]
    v_pk_fma_f32 v[52:53], v[32:33], v[50:51], v[102:103] op_sel:[1,0,0] op_sel_hi:[1,1,1] neg_lo:[1,0,0] neg_hi:[1,0,0]
    v_pk_fma_f32 v[54:55], v[32:33], v[48:49], v[118:119] op_sel:[1,0,0] op_sel_hi:[1,1,1]
    v_pk_fma_f32 v[48:49], v[32:33], v[48:49], v[52:53] op_sel:[0,0,0] op_sel_hi:[0,1,1]
    v_pk_fma_f32 v[50:51], v[32:33], v[50:51], v[54:55] op_sel:[0,0,0] op_sel_hi:[0,1,1]
    v_pk_fma_f32 v[52:53], v[32:33], v[50:51], v[104:105] op_sel:[1,0,0] op_sel_hi:[1,1,1] neg_lo:[1,0,0] neg_hi:[1,0,0]
    v_pk_fma_f32 v[54:55], v[32:33], v[48:49], v[120:121] op_sel:[1,0,0] op_sel_hi:[1,1,1]
    v_pk_fma_f32 v[48:49], v[32:33], v[48:49], v[52:53] op_sel:[0,0,0] op_sel_hi:[0,1,1]
    v_pk_fma_f32 v[50:51], v[32:33], v[50:51], v[54:55] op_sel:[0,0,0] op_sel_hi:[0,1,1]
    v_pk_fma_f32 v[52:53], v[32:33], v[50:51], v[106:107] op_sel:[1,0,0] op_sel_hi:[1,1,1] neg_lo:[1,0,0] neg_hi:[1,0,0]
    v_pk_fma_f32 v[54:55], v[32:33], v[48:49], v[122:123] op_sel:[1,0,0] op_sel_hi:[1,1,1]
    v_pk_fma_f32 v[48:49], v[32:33], v[48:49], v[52:53] op_sel:[0,0,0] op_sel_hi:[0,1,1]
    v_pk_fma_f32 v[50:51], v[32:33], v[50:51], v[54:55] op_sel:[0,0,0] op_sel_hi:[0,1,1]
    v_pk_fma_f32 v[52:53], v[32:33], v[50:51], v[108:109] op_sel:[1,0,0] op_sel_hi:[1,1,1] neg_lo:[1,0,0] neg_hi:[1,0,0]
    v_pk_fma_f32 v[54:55], v[32:33], v[48:49], v[124:125] op_sel:[1,0,0] op_sel_hi:[1,1,1]
    v_pk_fma_f32 v[48:49], v[32:33], v[48:49], v[52:53] op_sel:[0,0,0] op_sel_hi:[0,1,1]
    v_pk_fma_f32 v[50:51], v[32:33], v[50:51], v[54:55] op_sel:[0,0,0] op_sel_hi:[0,1,1]
    v_pk_fma_f32 v[52:53], v[32:33], v[50:51], v[110:111] op_sel:[1,0,0] op_sel_hi:[1,1,1] neg_lo:[1,0,0] neg_hi:[1,0,0]
    v_pk_fma_f32 v[54:55], v[32:33], v[48:49], v[126:127] op_sel:[1,0,0] op_sel_hi:[1,1,1]
    v_pk_fma_f32 v[48:49], v[32:33], v[48:49], v[52:53] op_sel:[0,0,0] op_sel_hi:[0,1,1]
    v_pk_fma_f32 v[50:51], v[32:33], v[50:51], v[54:55] op_sel:[0,0,0] op_sel_hi:[0,1,1]
    ds_write_b64 v129, v[48:49]
    ds_write_b64 v129, v[50:51] offset:512
    s_waitcnt vmcnt(0) lgkmcnt(0)
    s_barrier
    ds_read_b64 v[208:209], v130 offset:0
    ds_read_b64 v[210:211], v130 offset:512
    ds_read_b64 v[212:213], v130 offset:1024
    ds_read_b64 v[214:215], v130 offset:1536
    ds_read_b64 v[216:217], v130 offset:2048
    ds_read_b64 v[218:219], v130 offset:2560
    ds_read_b64 v[220:221], v130 offset:3072
    ds_read_b64 v[222:223], v130 offset:3584
L_k1_clr:
    v_readfirstlane_b32 s38, v57
    s_nop 1
    s_cmp_ge_u32 s38, 16
    s_cbranch_scc1 L_k1_clr_ok
    s_sleep 2
    global_load_dword v57, v58, s[22:23] sc1
    s_waitcnt vmcnt(0)
    s_branch L_k1_clr
L_k1_clr_ok:
    s_waitcnt lgkmcnt(0)
    v_fma_f32 v228, -v37, v210, v209
    v_fma_f32 v229, v37, v208, v211
    v_fma_f32 v228, v36, v208, v228
    v_fma_f32 v229, v36, v210, v229
    v_fma_f32 v230, -v37, v229, v212
    v_fma_f32 v231, v37, v228, v214
    v_fma_f32 v230, v36, v228, v230
    v_fma_f32 v231, v36, v229, v231
    v_fma_f32 v232, -v37, v231, v213
    v_fma_f32 v233, v37, v230, v215
    v_fma_f32 v232, v36, v230, v232
    v_fma_f32 v233, v36, v231, v233
    v_fma_f32 v234, -v37, v233, v216
    v_fma_f32 v235, v37, v232, v218
    v_fma_f32 v234, v36, v232, v234
    v_fma_f32 v235, v36, v233, v235
    v_fma_f32 v236, -v37, v235, v217
    v_fma_f32 v237, v37, v234, v219
    v_fma_f32 v236, v36, v234, v236
    v_fma_f32 v237, v36, v235, v237
    v_fma_f32 v238, -v37, v237, v220
    v_fma_f32 v239, v37, v236, v222
    v_fma_f32 v238, v36, v236, v238
    v_fma_f32 v239, v36, v237, v239
    v_fma_f32 v240, -v37, v239, v221
    v_fma_f32 v241, v37, v238, v223
    v_fma_f32 v240, v36, v238, v240
    v_fma_f32 v241, v36, v239, v241
    s_mov_b32 s38, 0xfffffffe
    v_min_u32 v52, s38, v240
    v_min_u32 v53, s38, v241
    s_cmp_lg_u32 s19, 0
    s_cbranch_scc1 L_k1_nopub
    buffer_store_dwordx2 v[52:53], v56, s[24:27], 0 offen sc1
L_k1_nopub:
    buffer_load_dwordx2 v[192:193], v131, s[24:27], 0 offen offset:0 sc1
    buffer_load_dwordx2 v[194:195], v131, s[24:27], 0 offen offset:1024 sc1
    buffer_load_dwordx2 v[196:197], v131, s[24:27], 0 offen offset:2048 sc1
    buffer_load_dwordx2 v[198:199], v131, s[24:27], 0 offen offset:3072 sc1
    buffer_load_dwordx2 v[200:201], v132, s[24:27], 0 offen offset:0 sc1
    buffer_load_dwordx2 v[202:203], v132, s[24:27], 0 offen offset:1024 sc1
    buffer_load_dwordx2 v[204:205], v132, s[24:27], 0 offen offset:2048 sc1
    buffer_load_dwordx2 v[206:207], v132, s[24:27], 0 offen offset:3072 sc1
    v_cmp_eq_u32 vcc, 1, v47
    s_cmp_eq_u32 s19, 1
    s_cselect_b64 s[38:39], -1, 0
    v_cndmask_b32 v48, 0, v228, vcc
    v_cndmask_b32 v136, v232, v236, vcc
    v_cndmask_b32 v48, v48, v136, s[38:39]
    v_cndmask_b32 v50, 0, v229, vcc
    v_cndmask_b32 v136, v233, v237, vcc
    v_cndmask_b32 v50, v50, v136, s[38:39]
    v_cndmask_b32 v49, v208, v230, vcc
    v_cndmask_b32 v136, v234, v238, vcc
    v_cndmask_b32 v49, v49, v136, s[38:39]
    v_cndmask_b32 v51, v210, v231, vcc
    v_cndmask_b32 v136, v235, v239, vcc
    v_cndmask_b32 v51, v51, v136, s[38:39]
    v_pk_mul_f32 v[160:161], v[34:35], v[80:81] op_sel:[0,0] op_sel_hi:[0,1]
    v_pk_fma_f32 v[160:161], v[34:35], v[64:65], v[160:161] op_sel:[1,0,0] op_sel_hi:[1,1,1]
    v_pk_mul_f32 v[64:65], v[34:35], v[64:65] op_sel:[0,0] op_sel_hi:[0,1]
    v_pk_fma_f32 v[64:65], v[34:35], v[80:81], v[64:65] op_sel:[1,0,0] op_sel_hi:[1,1,1] neg_lo:[1,0,0] neg_hi:[1,0,0]
    v_pk_mul_f32 v[162:163], v[34:35], v[82:83] op_sel:[0,0] op_sel_hi:[0,1]
    v_pk_fma_f32 v[162:163], v[34:35], v[66:67], v[162:163] op_sel:[1,0,0] op_sel_hi:[1,1,1]
    v_pk_mul_f32 v[66:67], v[34:35], v[66:67] op_sel:[0,0] op_sel_hi:[0,1]
    v_pk_fma_f32 v[66:67], v[34:35], v[82:83], v[66:67] op_sel:[1,0,0] op_sel_hi:[1,1,1] neg_lo:[1,0,0] neg_hi:[1,0,0]
    v_pk_mul_f32 v[164:165], v[34:35], v[84:85] op_sel:[0,0] op_sel_hi:[0,1]
    v_pk_fma_f32 v[164:165], v[34:35], v[68:69], v[164:165] op_sel:[1,0,0] op_sel_hi:[1,1,1]
    v_pk_mul_f32 v[68:69], v[34:35], v[68:69] op_sel:[0,0] op_sel_hi:[0,1]
    v_pk_fma_f32 v[68:69], v[34:35], v[84:85], v[68:69] op_sel:[1,0,0] op_sel_hi:[1,1,1] neg_lo:[1,0,0] neg_hi:[1,0,0]
    v_pk_mul_f32 v[166:167], v[34:35], v[86:87] op_sel:[0,0] op_sel_hi:[0,1]
    v_pk_fma_f32 v[166:167], v[34:35], v[70:71], v[166:167] op_sel:[1,0,0] op_sel_hi:[1,1,1]
    v_pk_mul_f32 v[70:71], v[34:35], v[70:71] op_sel:[0,0] op_sel_hi:[0,1]
    v_pk_fma_f32 v[70:71], v[34:35], v[86:87], v[70:71] op_sel:[1,0,0] op_sel_hi:[1,1,1] neg_lo:[1,0,0] neg_hi:[1,0,0]
    v_pk_mul_f32 v[168:169], v[34:35], v[88:89] op_sel:[0,0] op_sel_hi:[0,1]
    v_pk_fma_f32 v[168:169], v[34:35], v[72:73], v[168:169] op_sel:[1,0,0] op_sel_hi:[1,1,1]
    v_pk_mul_f32 v[72:73], v[34:35], v[72:73] op_sel:[0,0] op_sel_hi:[0,1]
    v_pk_fma_f32 v[72:73], v[34:35], v[88:89], v[72:73] op_sel:[1,0,0] op_sel_hi:[1,1,1] neg_lo:[1,0,0] neg_hi:[1,0,0]
    v_pk_mul_f32 v[170:171], v[34:35], v[90:91] op_sel:[0,0] op_sel_hi:[0,1]
    v_pk_fma_f32 v[170:171], v[34:35], v[74:75], v[170:171] op_sel:[1,0,0] op_sel_hi:[1,1,1]
    v_pk_mul_f32 v[74:75], v[34:35], v[74:75] op_sel:[0,0] op_sel_hi:[0,1]
    v_pk_fma_f32 v[74:75], v[34:35], v[90:91], v[74:75] op_sel:[1,0,0] op_sel_hi:[1,1,1] neg_lo:[1,0,0] neg_hi:[1,0,0]
    v_pk_mul_f32 v[172:173], v[34:35], v[92:93] op_sel:[0,0] op_sel_hi:[0,1]
    v_pk_fma_f32 v[172:173], v[34:35], v[76:77], v[172:173] op_sel:[1,0,0] op_sel_hi:[1,1,1]
    v_pk_mul_f32 v[76:77], v[34:35], v[76:77] op_sel:[0,0] op_sel_hi:[0,1]
    v_pk_fma_f32 v[76:77], v[34:35], v[92:93], v[76:77] op_sel:[1,0,0] op_sel_hi:[1,1,1] neg_lo:[1,0,0] neg_hi:[1,0,0]
    v_pk_mul_f32 v[174:175], v[34:35], v[94:95] op_sel:[0,0] op_sel_hi:[0,1]
    v_pk_fma_f32 v[174:175], v[34:35], v[78:79], v[174:175] op_sel:[1,0,0] op_sel_hi:[1,1,1]
    v_pk_mul_f32 v[78:79], v[34:35], v[78:79] op_sel:[0,0] op_sel_hi:[0,1]
    v_pk_fma_f32 v[78:79], v[34:35], v[94:95], v[78:79] op_sel:[1,0,0] op_sel_hi:[1,1,1] neg_lo:[1,0,0] neg_hi:[1,0,0]
    v_pk_mul_f32 v[176:177], v[34:35], v[112:113] op_sel:[0,0] op_sel_hi:[0,1]
    v_pk_fma_f32 v[176:177], v[34:35], v[96:97], v[176:177] op_sel:[1,0,0] op_sel_hi:[1,1,1]
    v_pk_mul_f32 v[96:97], v[34:35], v[96:97] op_sel:[0,0] op_sel_hi:[0,1]
    v_pk_fma_f32 v[96:97], v[34:35], v[112:113], v[96:97] op_sel:[1,0,0] op_sel_hi:[1,1,1] neg_lo:[1,0,0] neg_hi:[1,0,0]
    v_pk_mul_f32 v[178:179], v[34:35], v[114:115] op_sel:[0,0] op_sel_hi:[0,1]
    v_pk_fma_f32 v[178:179], v[34:35], v[98:99], v[178:179] op_sel:[1,0,0] op_sel_hi:[1,1,1]
    v_pk_mul_f32 v[98:99], v[34:35], v[98:99] op_sel:[0,0] op_sel_hi:[0,1]
    v_pk_fma_f32 v[98:99], v[34:35], v[114:115], v[98:99] op_sel:[1,0,0] op_sel_hi:[1,1,1] neg_lo:[1,0,0] neg_hi:[1,0,0]
    v_pk_mul_f32 v[180:181], v[34:35], v[116:117] op_sel:[0,0] op_sel_hi:[0,1]
    v_pk_fma_f32 v[180:181], v[34:35], v[100:101], v[180:181] op_sel:[1,0,0] op_sel_hi:[1,1,1]
    v_pk_mul_f32 v[100:101], v[34:35], v[100:101] op_sel:[0,0] op_sel_hi:[0,1]
    v_pk_fma_f32 v[100:101], v[34:35], v[116:117], v[100:101] op_sel:[1,0,0] op_sel_hi:[1,1,1] neg_lo:[1,0,0] neg_hi:[1,0,0]
    v_pk_mul_f32 v[182:183], v[34:35], v[118:119] op_sel:[0,0] op_sel_hi:[0,1]
    v_pk_fma_f32 v[182:183], v[34:35], v[102:103], v[182:183] op_sel:[1,0,0] op_sel_hi:[1,1,1]
    v_pk_mul_f32 v[102:103], v[34:35], v[102:103] op_sel:[0,0] op_sel_hi:[0,1]
    v_pk_fma_f32 v[102:103], v[34:35], v[118:119], v[102:103] op_sel:[1,0,0] op_sel_hi:[1,1,1] neg_lo:[1,0,0] neg_hi:[1,0,0]
    v_pk_mul_f32 v[184:185], v[34:35], v[120:121] op_sel:[0,0] op_sel_hi:[0,1]
    v_pk_fma_f32 v[184:185], v[34:35], v[104:105], v[184:185] op_sel:[1,0,0] op_sel_hi:[1,1,1]
    v_pk_mul_f32 v[104:105], v[34:35], v[104:105] op_sel:[0,0] op_sel_hi:[0,1]
    v_pk_fma_f32 v[104:105], v[34:35], v[120:121], v[104:105] op_sel:[1,0,0] op_sel_hi:[1,1,1] neg_lo:[1,0,0] neg_hi:[1,0,0]
    v_pk_mul_f32 v[186:187], v[34:35], v[122:123] op_sel:[0,0] op_sel_hi:[0,1]
    v_pk_fma_f32 v[186:187], v[34:35], v[106:107], v[186:187] op_sel:[1,0,0] op_sel_hi:[1,1,1]
    v_pk_mul_f32 v[106:107], v[34:35], v[106:107] op_sel:[0,0] op_sel_hi:[0,1]
    v_pk_fma_f32 v[106:107], v[34:35], v[122:123], v[106:107] op_sel:[1,0,0] op_sel_hi:[1,1,1] neg_lo:[1,0,0] neg_hi:[1,0,0]
    v_pk_mul_f32 v[188:189], v[34:35], v[124:125] op_sel:[0,0] op_sel_hi:[0,1]
    v_pk_fma_f32 v[188:189], v[34:35], v[108:109], v[188:189] op_sel:[1,0,0] op_sel_hi:[1,1,1]
    v_pk_mul_f32 v[108:109], v[34:35], v[108:109] op_sel:[0,0] op_sel_hi:[0,1]
    v_pk_fma_f32 v[108:109], v[34:35], v[124:125], v[108:109] op_sel:[1,0,0] op_sel_hi:[1,1,1] neg_lo:[1,0,0] neg_hi:[1,0,0]
    v_pk_mul_f32 v[190:191], v[34:35], v[126:127] op_sel:[0,0] op_sel_hi:[0,1]
    v_pk_fma_f32 v[190:191], v[34:35], v[110:111], v[190:191] op_sel:[1,0,0] op_sel_hi:[1,1,1]
    v_pk_mul_f32 v[110:111], v[34:35], v[110:111] op_sel:[0,0] op_sel_hi:[0,1]
    v_pk_fma_f32 v[110:111], v[34:35], v[126:127], v[110:111] op_sel:[1,0,0] op_sel_hi:[1,1,1] neg_lo:[1,0,0] neg_hi:[1,0,0]
L_k1_poll:
    s_waitcnt vmcnt(0)
    v_max3_u32 v136, v192, v193, v194
    v_max3_u32 v136, v136, v195, v196
    v_max3_u32 v136, v136, v197, v198
    v_max3_u32 v136, v136, v199, v200
    v_max3_u32 v136, v136, v201, v202
    v_max3_u32 v136, v136, v203, v204
    v_max3_u32 v136, v136, v205, v206
    v_max_u32 v136, v136, v207
    v_cmp_eq_u32 vcc, -1, v136
    s_nop 1
    s_cmp_eq_u64 vcc, 0
    s_cbranch_scc1 L_k1_got
    buffer_load_dwordx2 v[192:193], v131, s[24:27], 0 offen offset:0 sc1
    buffer_load_dwordx2 v[194:195], v131, s[24:27], 0 offen offset:1024 sc1
    buffer_load_dwordx2 v[196:197], v131, s[24:27], 0 offen offset:2048 sc1
    buffer_load_dwordx2 v[198:199], v131, s[24:27], 0 offen offset:3072 sc1
    buffer_load_dwordx2 v[200:201], v132, s[24:27], 0 offen offset:0 sc1
    buffer_load_dwordx2 v[202:203], v132, s[24:27], 0 offen offset:1024 sc1
    buffer_load_dwordx2 v[204:205], v132, s[24:27], 0 offen offset:2048 sc1
    buffer_load_dwordx2 v[206:207], v132, s[24:27], 0 offen offset:3072 sc1
    s_branch L_k1_poll
L_k1_got:
    v_fma_f32 v204, -v41, v207, v204
    v_fma_f32 v205, v41, v206, v205
    v_fma_f32 v204, v40, v206, v204
    v_fma_f32 v205, v40, v207, v205
    v_fma_f32 v202, -v41, v205, v202
    v_fma_f32 v203, v41, v204, v203
    v_fma_f32 v202, v40, v204, v202
    v_fma_f32 v203, v40, v205, v203
    v_fma_f32 v200, -v41, v203, v200
    v_fma_f32 v201, v41, v202, v201
    v_fma_f32 v200, v40, v202, v200
    v_fma_f32 v201, v40, v203, v201
    v_fma_f32 v198, -v41, v201, v198
    v_fma_f32 v199, v41, v200, v199
    v_fma_f32 v198, v40, v200, v198
    v_fma_f32 v199, v40, v201, v199
    v_fma_f32 v196, -v41, v199, v196
    v_fma_f32 v197, v41, v198, v197
    v_fma_f32 v196, v40, v198, v196
    v_fma_f32 v197, v40, v199, v197
    v_fma_f32 v194, -v41, v197, v194
    v_fma_f32 v195, v41, v196, v195
    v_fma_f32 v194, v40, v196, v194
    v_fma_f32 v195, v40, v197, v195
    v_fma_f32 v192, -v41, v195, v192
    v_fma_f32 v193, v41, v194, v193
    v_fma_f32 v192, v40, v194, v192
    v_fma_f32 v193, v40, v195, v193
    v_mov_b32 v194, v192
    v_mov_b32 v195, v193
    s_nop 1
    v_permlane32_swap_b32 v192, v194
    v_permlane32_swap_b32 v193, v195
    s_nop 0
    v_fma_f32 v192, -v39, v195, v192
    v_fma_f32 v193, v39, v194, v193
    v_fma_f32 v192, v38, v194, v192
    v_fma_f32 v193, v38, v195, v193
    v_pk_fma_f32 v[48:49], v[192:193], v[42:43], v[48:49] op_sel:[0,0,0] op_sel_hi:[0,1,1]
    v_pk_fma_f32 v[50:51], v[192:193], v[44:45], v[50:51] op_sel:[0,0,0] op_sel_hi:[0,1,1]
    v_pk_fma_f32 v[48:49], v[192:193], v[44:45], v[48:49] op_sel:[1,0,0] op_sel_hi:[1,1,1] neg_lo:[1,0,0] neg_hi:[1,0,0]
    v_pk_fma_f32 v[50:51], v[192:193], v[42:43], v[50:51] op_sel:[1,0,0] op_sel_hi:[1,1,1]
    v_pk_mul_f32 v[52:53], v[34:35], v[48:49] op_sel:[0,0] op_sel_hi:[0,1]
    v_pk_mul_f32 v[54:55], v[34:35], v[50:51] op_sel:[0,0] op_sel_hi:[0,1]
    v_pk_fma_f32 v[52:53], v[34:35], v[50:51], v[52:53] op_sel:[1,0,0] op_sel_hi:[1,1,1] neg_lo:[1,0,0] neg_hi:[1,0,0]
    v_pk_fma_f32 v[54:55], v[34:35], v[48:49], v[54:55] op_sel:[1,0,0] op_sel_hi:[1,1,1]
    v_pk_fma_f32 v[64:65], v[32:33], v[54:55], v[64:65] op_sel:[1,0,0] op_sel_hi:[1,1,1] neg_lo:[1,0,0] neg_hi:[1,0,0]
    v_pk_fma_f32 v[160:161], v[32:33], v[52:53], v[160:161] op_sel:[1,0,0] op_sel_hi:[1,1,1]
    v_pk_fma_f32 v[64:65], v[32:33], v[52:53], v[64:65] op_sel:[0,0,0] op_sel_hi:[0,1,1]
    v_pk_fma_f32 v[160:161], v[32:33], v[54:55], v[160:161] op_sel:[0,0,0] op_sel_hi:[0,1,1]
    v_pk_fma_f32 v[66:67], v[32:33], v[160:161], v[66:67] op_sel:[1,0,0] op_sel_hi:[1,1,1] neg_lo:[1,0,0] neg_hi:[1,0,0]
    v_pk_fma_f32 v[162:163], v[32:33], v[64:65], v[162:163] op_sel:[1,0,0] op_sel_hi:[1,1,1]
    v_pk_fma_f32 v[66:67], v[32:33], v[64:65], v[66:67] op_sel:[0,0,0] op_sel_hi:[0,1,1]
    v_pk_fma_f32 v[162:163], v[32:33], v[160:161], v[162:163] op_sel:[0,0,0] op_sel_hi:[0,1,1]
    v_cvt_pk_bf16_f32 v192, v64, v66
    v_cvt_pk_bf16_f32 v208, -v160, -v162
    v_cvt_pk_bf16_f32 v200, v65, v67
    v_cvt_pk_bf16_f32 v216, -v161, -v163
    v_pk_fma_f32 v[68:69], v[32:33], v[162:163], v[68:69] op_sel:[1,0,0] op_sel_hi:[1,1,1] neg_lo:[1,0,0] neg_hi:[1,0,0]
    v_pk_fma_f32 v[164:165], v[32:33], v[66:67], v[164:165] op_sel:[1,0,0] op_sel_hi:[1,1,1]
    v_pk_fma_f32 v[68:69], v[32:33], v[66:67], v[68:69] op_sel:[0,0,0] op_sel_hi:[0,1,1]
    v_pk_fma_f32 v[164:165], v[32:33], v[162:163], v[164:165] op_sel:[0,0,0] op_sel_hi:[0,1,1]
    v_pk_fma_f32 v[70:71], v[32:33], v[164:165], v[70:71] op_sel:[1,0,0] op_sel_hi:[1,1,1] neg_lo:[1,0,0] neg_hi:[1,0,0]
    v_pk_fma_f32 v[166:167], v[32:33], v[68:69], v[166:167] op_sel:[1,0,0] op_sel_hi:[1,1,1]
    v_pk_fma_f32 v[70:71], v[32:33], v[68:69], v[70:71] op_sel:[0,0,0] op_sel_hi:[0,1,1]
    v_pk_fma_f32 v[166:167], v[32:33], v[164:165], v[166:167] op_sel:[0,0,0] op_sel_hi:[0,1,1]
    v_cvt_pk_bf16_f32 v193, v68, v70
    v_cvt_pk_bf16_f32 v209, -v164, -v166
    v_cvt_pk_bf16_f32 v201, v69, v71
    v_cvt_pk_bf16_f32 v217, -v165, -v167
    v_pk_fma_f32 v[72:73], v[32:33], v[166:167], v[72:73] op_sel:[1,0,0] op_sel_hi:[1,1,1] neg_lo:[1,0,0] neg_hi:[1,0,0]
    v_pk_fma_f32 v[168:169], v[32:33], v[70:71], v[168:169] op_sel:[1,0,0] op_sel_hi:[1,1,1]
    v_pk_fma_f32 v[72:73], v[32:33], v[70:71], v[72:73] op_sel:[0,0,0] op_sel_hi:[0,1,1]
    v_pk_fma_f32 v[168:169], v[32:33], v[166:167], v[168:169] op_sel:[0,0,0] op_sel_hi:[0,1,1]
    v_pk_fma_f32 v[74:75], v[32:33], v[168:169], v[74:75] op_sel:[1,0,0] op_sel_hi:[1,1,1] neg_lo:[1,0,0] neg_hi:[1,0,0]
    v_pk_fma_f32 v[170:171], v[32:33], v[72:73], v[170:171] op_sel:[1,0,0] op_sel_hi:[1,1,1]
    v_pk_fma_f32 v[74:75], v[32:33], v[72:73], v[74:75] op_sel:[0,0,0] op_sel_hi:[0,1,1]
    v_pk_fma_f32 v[170:171], v[32:33], v[168:169], v[170:171] op_sel:[0,0,0] op_sel_hi:[0,1,1]
    v_cvt_pk_bf16_f32 v194, v72, v74
    v_cvt_pk_bf16_f32 v210, -v168, -v170
    v_cvt_pk_bf16_f32 v202, v73, v75
    v_cvt_pk_bf16_f32 v218, -v169, -v171
    v_pk_fma_f32 v[76:77], v[32:33], v[170:171], v[76:77] op_sel:[1,0,0] op_sel_hi:[1,1,1] neg_lo:[1,0,0] neg_hi:[1,0,0]
    v_pk_fma_f32 v[172:173], v[32:33], v[74:75], v[172:173] op_sel:[1,0,0] op_sel_hi:[1,1,1]
    v_pk_fma_f32 v[76:77], v[32:33], v[74:75], v[76:77] op_sel:[0,0,0] op_sel_hi:[0,1,1]
    v_pk_fma_f32 v[172:173], v[32:33], v[170:171], v[172:173] op_sel:[0,0,0] op_sel_hi:[0,1,1]
    v_pk_fma_f32 v[78:79], v[32:33], v[172:173], v[78:79] op_sel:[1,0,0] op_sel_hi:[1,1,1] neg_lo:[1,0,0] neg_hi:[1,0,0]
    v_pk_fma_f32 v[174:175], v[32:33], v[76:77], v[174:175] op_sel:[1,0,0] op_sel_hi:[1,1,1]
    v_pk_fma_f32 v[78:79], v[32:33], v[76:77], v[78:79] op_sel:[0,0,0] op_sel_hi:[0,1,1]
    v_pk_fma_f32 v[174:175], v[32:33], v[172:173], v[174:175] op_sel:[0,0,0] op_sel_hi:[0,1,1]
    v_cvt_pk_bf16_f32 v195, v76, v78
    v_cvt_pk_bf16_f32 v211, -v172, -v174
    v_cvt_pk_bf16_f32 v203, v77, v79
    v_cvt_pk_bf16_f32 v219, -v173, -v175
    ds_write_b128 v133, v[192:195] offset:0
    ds_write_b128 v133, v[200:203] offset:32
    ds_write_b128 v133, v[208:211] offset:4608
    ds_write_b128 v133, v[216:219] offset:4640
    v_pk_fma_f32 v[96:97], v[32:33], v[174:175], v[96:97] op_sel:[1,0,0] op_sel_hi:[1,1,1] neg_lo:[1,0,0] neg_hi:[1,0,0]
    v_pk_fma_f32 v[176:177], v[32:33], v[78:79], v[176:177] op_sel:[1,0,0] op_sel_hi:[1,1,1]
    v_pk_fma_f32 v[96:97], v[32:33], v[78:79], v[96:97] op_sel:[0,0,0] op_sel_hi:[0,1,1]
    v_pk_fma_f32 v[176:177], v[32:33], v[174:175], v[176:177] op_sel:[0,0,0] op_sel_hi:[0,1,1]
    v_pk_fma_f32 v[98:99], v[32:33], v[176:177], v[98:99] op_sel:[1,0,0] op_sel_hi:[1,1,1] neg_lo:[1,0,0] neg_hi:[1,0,0]
    v_pk_fma_f32 v[178:179], v[32:33], v[96:97], v[178:179] op_sel:[1,0,0] op_sel_hi:[1,1,1]
    v_pk_fma_f32 v[98:99], v[32:33], v[96:97], v[98:99] op_sel:[0,0,0] op_sel_hi:[0,1,1]
    v_pk_fma_f32 v[178:179], v[32:33], v[176:177], v[178:179] op_sel:[0,0,0] op_sel_hi:[0,1,1]
    v_cvt_pk_bf16_f32 v196, v96, v98
    v_cvt_pk_bf16_f32 v212, -v176, -v178
    v_cvt_pk_bf16_f32 v204, v97, v99
    v_cvt_pk_bf16_f32 v220, -v177, -v179
    v_pk_fma_f32 v[100:101], v[32:33], v[178:179], v[100:101] op_sel:[1,0,0] op_sel_hi:[1,1,1] neg_lo:[1,0,0] neg_hi:[1,0,0]
    v_pk_fma_f32 v[180:181], v[32:33], v[98:99], v[180:181] op_sel:[1,0,0] op_sel_hi:[1,1,1]
    v_pk_fma_f32 v[100:101], v[32:33], v[98:99], v[100:101] op_sel:[0,0,0] op_sel_hi:[0,1,1]
    v_pk_fma_f32 v[180:181], v[32:33], v[178:179], v[180:181] op_sel:[0,0,0] op_sel_hi:[0,1,1]
    v_pk_fma_f32 v[102:103], v[32:33], v[180:181], v[102:103] op_sel:[1,0,0] op_sel_hi:[1,1,1] neg_lo:[1,0,0] neg_hi:[1,0,0]
    v_pk_fma_f32 v[182:183], v[32:33], v[100:101], v[182:183] op_sel:[1,0,0] op_sel_hi:[1,1,1]
    v_pk_fma_f32 v[102:103], v[32:33], v[100:101], v[102:103] op_sel:[0,0,0] op_sel_hi:[0,1,1]
    v_pk_fma_f32 v[182:183], v[32:33], v[180:181], v[182:183] op_sel:[0,0,0] op_sel_hi:[0,1,1]
    v_cvt_pk_bf16_f32 v197, v100, v102
    v_cvt_pk_bf16_f32 v213, -v180, -v182
    v_cvt_pk_bf16_f32 v205, v101, v103
    v_cvt_pk_bf16_f32 v221, -v181, -v183
    v_pk_fma_f32 v[104:105], v[32:33], v[182:183], v[104:105] op_sel:[1,0,0] op_sel_hi:[1,1,1] neg_lo:[1,0,0] neg_hi:[1,0,0]
    v_pk_fma_f32 v[184:185], v[32:33], v[102:103], v[184:185] op_sel:[1,0,0] op_sel_hi:[1,1,1]
    v_pk_fma_f32 v[104:105], v[32:33], v[102:103], v[104:105] op_sel:[0,0,0] op_sel_hi:[0,1,1]
    v_pk_fma_f32 v[184:185], v[32:33], v[182:183], v[184:185] op_sel:[0,0,0] op_sel_hi:[0,1,1]
    v_pk_fma_f32 v[106:107], v[32:33], v[184:185], v[106:107] op_sel:[1,0,0] op_sel_hi:[1,1,1] neg_lo:[1,0,0] neg_hi:[1,0,0]
    v_pk_fma_f32 v[186:187], v[32:33], v[104:105], v[186:187] op_sel:[1,0,0] op_sel_hi:[1,1,1]
    v_pk_fma_f32 v[106:107], v[32:33], v[104:105], v[106:107] op_sel:[0,0,0] op_sel_hi:[0,1,1]
    v_pk_fma_f32 v[186:187], v[32:33], v[184:185], v[186:187] op_sel:[0,0,0] op_sel_hi:[0,1,1]
    v_cvt_pk_bf16_f32 v198, v104, v106
    v_cvt_pk_bf16_f32 v214, -v184, -v186
    v_cvt_pk_bf16_f32 v206, v105, v107
    v_cvt_pk_bf16_f32 v222, -v185, -v187
    v_pk_fma_f32 v[108:109], v[32:33], v[186:187], v[108:109] op_sel:[1,0,0] op_sel_hi:[1,1,1] neg_lo:[1,0,0] neg_hi:[1,0,0]
    v_pk_fma_f32 v[188:189], v[32:33], v[106:107], v[188:189] op_sel:[1,0,0] op_sel_hi:[1,1,1]
    v_pk_fma_f32 v[108:109], v[32:33], v[106:107], v[108:109] op_sel:[0,0,0] op_sel_hi:[0,1,1]
    v_pk_fma_f32 v[188:189], v[32:33], v[186:187], v[188:189] op_sel:[0,0,0] op_sel_hi:[0,1,1]
    v_pk_fma_f32 v[110:111], v[32:33], v[188:189], v[110:111] op_sel:[1,0,0] op_sel_hi:[1,1,1] neg_lo:[1,0,0] neg_hi:[1,0,0]
    v_pk_fma_f32 v[190:191], v[32:33], v[108:109], v[190:191] op_sel:[1,0,0] op_sel_hi:[1,1,1]
    v_pk_fma_f32 v[110:111], v[32:33], v[108:109], v[110:111] op_sel:[0,0,0] op_sel_hi:[0,1,1]
    v_pk_fma_f32 v[190:191], v[32:33], v[188:189], v[190:191] op_sel:[0,0,0] op_sel_hi:[0,1,1]
    v_cvt_pk_bf16_f32 v199, v108, v110
    v_cvt_pk_bf16_f32 v215, -v188, -v190
    v_cvt_pk_bf16_f32 v207, v109, v111
    v_cvt_pk_bf16_f32 v223, -v189, -v191
    ds_write_b128 v133, v[196:199] offset:16
    ds_write_b128 v133, v[204:207] offset:48
    ds_write_b128 v133, v[212:215] offset:4624
    ds_write_b128 v133, v[220:223] offset:4656
    s_waitcnt lgkmcnt(0)
    s_lshl_b32 s38, s16, 19
    s_lshl_b32 s39, s17, 15
    s_add_u32 s38, s38, s39
    s_lshl_b32 s39, s20, 11
    s_add_u32 s38, s38, s39
    s_lshl_b32 s39, s19, 14
    s_add_u32 s38, s38, s39
    ds_read_b64_tr_b16 v[64:65], v134 offset:0
    ds_read_b64_tr_b16 v[66:67], v134 offset:576
    ds_read_b64_tr_b16 v[68:69], v134 offset:2304
    ds_read_b64_tr_b16 v[70:71], v134 offset:2880
    ds_read_b64_tr_b16 v[72:73], v134 offset:64
    ds_read_b64_tr_b16 v[74:75], v134 offset:640
    ds_read_b64_tr_b16 v[76:77], v134 offset:2368
    ds_read_b64_tr_b16 v[78:79], v134 offset:2944
    ds_read_b64_tr_b16 v[80:81], v134 offset:4608
    ds_read_b64_tr_b16 v[82:83], v134 offset:5184
    ds_read_b64_tr_b16 v[84:85], v134 offset:6912
    ds_read_b64_tr_b16 v[86:87], v134 offset:7488
    ds_read_b64_tr_b16 v[88:89], v134 offset:4672
    ds_read_b64_tr_b16 v[90:91], v134 offset:5248
    ds_read_b64_tr_b16 v[92:93], v134 offset:6976
    ds_read_b64_tr_b16 v[94:95], v134 offset:7552
    s_add_u32 s39, s38, 0
    s_waitcnt lgkmcnt(14)
    buffer_store_dwordx4 v[64:67], v135, s[12:15], s39 offen offset:0
    s_waitcnt lgkmcnt(12)
    buffer_store_dwordx4 v[68:71], v135, s[12:15], s39 offen offset:1024
    s_add_u32 s39, s38, 8192
    s_waitcnt lgkmcnt(10)
    buffer_store_dwordx4 v[72:75], v135, s[12:15], s39 offen offset:0
    s_waitcnt lgkmcnt(8)
    buffer_store_dwordx4 v[76:79], v135, s[12:15], s39 offen offset:1024
    s_add_u32 s39, s38, 4096
    s_waitcnt lgkmcnt(6)
    buffer_store_dwordx4 v[80:83], v135, s[12:15], s39 offen offset:0
    s_waitcnt lgkmcnt(4)
    buffer_store_dwordx4 v[84:87], v135, s[12:15], s39 offen offset:1024
    s_add_u32 s39, s38, 12288
    s_waitcnt lgkmcnt(2)
    buffer_store_dwordx4 v[88:91], v135, s[12:15], s39 offen offset:0
    s_waitcnt lgkmcnt(0)
    buffer_store_dwordx4 v[92:95], v135, s[12:15], s39 offen offset:1024
    s_endpgm
L_k1_side:
    s_load_dwordx2 s[28:29], s[0:1], 0
    s_load_dwordx2 s[30:31], s[0:1], 80
    s_load_dwordx4 s[32:35], s[0:1], 88
    s_load_dwordx2 s[36:37], s[0:1], 112
    s_load_dwordx4 s[40:43], s[0:1], 128
    v_lshrrev_b32 v1, 6, v0
    v_and_b32 v2, 63, v0
    v_readfirstlane_b32 s18, v1
    s_sub_u32 s19, s2, 256
    s_and_b32 s3, s19, 7
    s_lshl_b32 s3, s3, 8
    s_lshr_b32 s38, s19, 3
    s_lshl_b32 s38, s38, 3
    s_add_u32 s3, s3, s38
    s_lshl_b32 s38, s18, 1
    s_add_u32 s16, s3, s38
    s_lshl_b32 s17, s16, 11
    v_lshlrev_b32 v3, 4, v2
    s_waitcnt lgkmcnt(0)
    s_mov_b32 s4, s28
    s_mov_b32 s5, s29
    s_mov_b32 s6, 4194304
    s_mov_b32 s7, 0x20000
    s_mov_b32 s12, s42
    s_mov_b32 s13, s43
    s_mov_b32 s14, 16777216
    s_mov_b32 s15, 0x20000
    buffer_load_dwordx4 v[8:11], v3, s[4:7], s17 offen offset:0
    buffer_load_dwordx4 v[12:15], v3, s[4:7], s17 offen offset:1024
    buffer_load_dwordx4 v[16:19], v3, s[4:7], s17 offen offset:2048
    buffer_load_dwordx4 v[20:23], v3, s[4:7], s17 offen offset:3072
    global_load_dwordx4 v[24:27], v3, s[30:31] offset:0
    global_load_dwordx4 v[32:35], v3, s[36:37] offset:0
    global_load_dwordx4 v[28:31], v3, s[30:31] offset:1024
    global_load_dwordx4 v[36:39], v3, s[36:37] offset:1024
    s_mov_b32 s20, 0xffff0000
    s_mov_b32 s21, 0x3f803f80
    v_mov_b32 v40, 0
    v_mov_b32 v41, 0
    v_mov_b32 v42, 0
    v_mov_b32 v43, 0
    s_waitcnt vmcnt(0)
    v_lshlrev_b32 v44, 16, v32
    v_and_b32 v45, s20, v32
    v_dot2c_f32_bf16 v40, v8, v24
    v_lshlrev_b32 v46, 16, v8
    v_and_b32 v47, s20, v8
    v_mul_f32 v46, v46, v44
    v_mul_f32 v47, v47, v45
    v_cvt_pk_bf16_f32 v46, v46, v47
    v_lshlrev_b32 v47, 16, v46
    v_and_b32 v46, s20, v46
    v_add_f32 v42, v42, v47
    v_add_f32 v42, v42, v46
    v_dot2c_f32_bf16 v41, v16, v24
    v_lshlrev_b32 v46, 16, v16
    v_and_b32 v47, s20, v16
    v_mul_f32 v46, v46, v44
    v_mul_f32 v47, v47, v45
    v_cvt_pk_bf16_f32 v46, v46, v47
    v_lshlrev_b32 v47, 16, v46
    v_and_b32 v46, s20, v46
    v_add_f32 v43, v43, v47
    v_add_f32 v43, v43, v46
    v_lshlrev_b32 v44, 16, v33
    v_and_b32 v45, s20, v33
    v_dot2c_f32_bf16 v40, v9, v25
    v_lshlrev_b32 v46, 16, v9
    v_and_b32 v47, s20, v9
    v_mul_f32 v46, v46, v44
    v_mul_f32 v47, v47, v45
    v_cvt_pk_bf16_f32 v46, v46, v47
    v_lshlrev_b32 v47, 16, v46
    v_and_b32 v46, s20, v46
    v_add_f32 v42, v42, v47
    v_add_f32 v42, v42, v46
    v_dot2c_f32_bf16 v41, v17, v25
    v_lshlrev_b32 v46, 16, v17
    v_and_b32 v47, s20, v17
    v_mul_f32 v46, v46, v44
    v_mul_f32 v47, v47, v45
    v_cvt_pk_bf16_f32 v46, v46, v47
    v_lshlrev_b32 v47, 16, v46
    v_and_b32 v46, s20, v46
    v_add_f32 v43, v43, v47
    v_add_f32 v43, v43, v46
    v_lshlrev_b32 v44, 16, v34
    v_and_b32 v45, s20, v34
    v_dot2c_f32_bf16 v40, v10, v26
    v_lshlrev_b32 v46, 16, v10
    v_and_b32 v47, s20, v10
    v_mul_f32 v46, v46, v44
    v_mul_f32 v47, v47, v45
    v_cvt_pk_bf16_f32 v46, v46, v47
    v_lshlrev_b32 v47, 16, v46
    v_and_b32 v46, s20, v46
    v_add_f32 v42, v42, v47
    v_add_f32 v42, v42, v46
    v_dot2c_f32_bf16 v41, v18, v26
    v_lshlrev_b32 v46, 16, v18
    v_and_b32 v47, s20, v18
    v_mul_f32 v46, v46, v44
    v_mul_f32 v47, v47, v45
    v_cvt_pk_bf16_f32 v46, v46, v47
    v_lshlrev_b32 v47, 16, v46
    v_and_b32 v46, s20, v46
    v_add_f32 v43, v43, v47
    v_add_f32 v43, v43, v46
    v_lshlrev_b32 v44, 16, v35
    v_and_b32 v45, s20, v35
    v_dot2c_f32_bf16 v40, v11, v27
    v_lshlrev_b32 v46, 16, v11
    v_and_b32 v47, s20, v11
    v_mul_f32 v46, v46, v44
    v_mul_f32 v47, v47, v45
    v_cvt_pk_bf16_f32 v46, v46, v47
    v_lshlrev_b32 v47, 16, v46
    v_and_b32 v46, s20, v46
    v_add_f32 v42, v42, v47
    v_add_f32 v42, v42, v46
    v_dot2c_f32_bf16 v41, v19, v27
    v_lshlrev_b32 v46, 16, v19
    v_and_b32 v47, s20, v19
    v_mul_f32 v46, v46, v44
    v_mul_f32 v47, v47, v45
    v_cvt_pk_bf16_f32 v46, v46, v47
    v_lshlrev_b32 v47, 16, v46
    v_and_b32 v46, s20, v46
    v_add_f32 v43, v43, v47
    v_add_f32 v43, v43, v46
    v_lshlrev_b32 v44, 16, v36
    v_and_b32 v45, s20, v36
    v_dot2c_f32_bf16 v40, v12, v28
    v_lshlrev_b32 v46, 16, v12
    v_and_b32 v47, s20, v12
    v_mul_f32 v46, v46, v44
    v_mul_f32 v47, v47, v45
    v_cvt_pk_bf16_f32 v46, v46, v47
    v_lshlrev_b32 v47, 16, v46
    v_and_b32 v46, s20, v46
    v_add_f32 v42, v42, v47
    v_add_f32 v42, v42, v46
    v_dot2c_f32_bf16 v41, v20, v28
    v_lshlrev_b32 v46, 16, v20
    v_and_b32 v47, s20, v20
    v_mul_f32 v46, v46, v44
    v_mul_f32 v47, v47, v45
    v_cvt_pk_bf16_f32 v46, v46, v47
    v_lshlrev_b32 v47, 16, v46
    v_and_b32 v46, s20, v46
    v_add_f32 v43, v43, v47
    v_add_f32 v43, v43, v46
    v_lshlrev_b32 v44, 16, v37
    v_and_b32 v45, s20, v37
    v_dot2c_f32_bf16 v40, v13, v29
    v_lshlrev_b32 v46, 16, v13
    v_and_b32 v47, s20, v13
    v_mul_f32 v46, v46, v44
    v_mul_f32 v47, v47, v45
    v_cvt_pk_bf16_f32 v46, v46, v47
    v_lshlrev_b32 v47, 16, v46
    v_and_b32 v46, s20, v46
    v_add_f32 v42, v42, v47
    v_add_f32 v42, v42, v46
    v_dot2c_f32_bf16 v41, v21, v29
    v_lshlrev_b32 v46, 16, v21
    v_and_b32 v47, s20, v21
    v_mul_f32 v46, v46, v44
    v_mul_f32 v47, v47, v45
    v_cvt_pk_bf16_f32 v46, v46, v47
    v_lshlrev_b32 v47, 16, v46
    v_and_b32 v46, s20, v46
    v_add_f32 v43, v43, v47
    v_add_f32 v43, v43, v46
    v_lshlrev_b32 v44, 16, v38
    v_and_b32 v45, s20, v38
    v_dot2c_f32_bf16 v40, v14, v30
    v_lshlrev_b32 v46, 16, v14
    v_and_b32 v47, s20, v14
    v_mul_f32 v46, v46, v44
    v_mul_f32 v47, v47, v45
    v_cvt_pk_bf16_f32 v46, v46, v47
    v_lshlrev_b32 v47, 16, v46
    v_and_b32 v46, s20, v46
    v_add_f32 v42, v42, v47
    v_add_f32 v42, v42, v46
    v_dot2c_f32_bf16 v41, v22, v30
    v_lshlrev_b32 v46, 16, v22
    v_and_b32 v47, s20, v22
    v_mul_f32 v46, v46, v44
    v_mul_f32 v47, v47, v45
    v_cvt_pk_bf16_f32 v46, v46, v47
    v_lshlrev_b32 v47, 16, v46
    v_and_b32 v46, s20, v46
    v_add_f32 v43, v43, v47
    v_add_f32 v43, v43, v46
    v_lshlrev_b32 v44, 16, v39
    v_and_b32 v45, s20, v39
    v_dot2c_f32_bf16 v40, v15, v31
    v_lshlrev_b32 v46, 16, v15
    v_and_b32 v47, s20, v15
    v_mul_f32 v46, v46, v44
    v_mul_f32 v47, v47, v45
    v_cvt_pk_bf16_f32 v46, v46, v47
    v_lshlrev_b32 v47, 16, v46
    v_and_b32 v46, s20, v46
    v_add_f32 v42, v42, v47
    v_add_f32 v42, v42, v46
    v_dot2c_f32_bf16 v41, v23, v31
    v_lshlrev_b32 v46, 16, v23
    v_and_b32 v47, s20, v23
    v_mul_f32 v46, v46, v44
    v_mul_f32 v47, v47, v45
    v_cvt_pk_bf16_f32 v46, v46, v47
    v_lshlrev_b32 v47, 16, v46
    v_and_b32 v46, s20, v46
    v_add_f32 v43, v43, v47
    v_add_f32 v43, v43, v46
    s_nop 3
    v_add_f32_dpp v40, v40, v40 row_ror:8 row_mask:0xf bank_mask:0xf
    v_add_f32_dpp v41, v41, v41 row_ror:8 row_mask:0xf bank_mask:0xf
    v_add_f32_dpp v42, v42, v42 row_ror:8 row_mask:0xf bank_mask:0xf
    v_add_f32_dpp v43, v43, v43 row_ror:8 row_mask:0xf bank_mask:0xf
    v_add_f32_dpp v40, v40, v40 row_ror:4 row_mask:0xf bank_mask:0xf
    v_add_f32_dpp v41, v41, v41 row_ror:4 row_mask:0xf bank_mask:0xf
    v_add_f32_dpp v42, v42, v42 row_ror:4 row_mask:0xf bank_mask:0xf
    v_add_f32_dpp v43, v43, v43 row_ror:4 row_mask:0xf bank_mask:0xf
    v_add_f32_dpp v40, v40, v40 row_ror:2 row_mask:0xf bank_mask:0xf
    v_add_f32_dpp v41, v41, v41 row_ror:2 row_mask:0xf bank_mask:0xf
    v_add_f32_dpp v42, v42, v42 row_ror:2 row_mask:0xf bank_mask:0xf
    v_add_f32_dpp v43, v43, v43 row_ror:2 row_mask:0xf bank_mask:0xf
    v_add_f32_dpp v40, v40, v40 row_ror:1 row_mask:0xf bank_mask:0xf
    v_add_f32_dpp v41, v41, v41 row_ror:1 row_mask:0xf bank_mask:0xf
    v_add_f32_dpp v42, v42, v42 row_ror:1 row_mask:0xf bank_mask:0xf
    v_add_f32_dpp v43, v43, v43 row_ror:1 row_mask:0xf bank_mask:0xf
    v_mov_b32 v44, v40
    v_mov_b32 v45, v41
    v_mov_b32 v46, v42
    v_mov_b32 v47, v43
    s_nop 1
    v_permlane16_swap_b32 v40, v44
    v_permlane16_swap_b32 v41, v45
    v_permlane16_swap_b32 v42, v46
    v_permlane16_swap_b32 v43, v47
    s_nop 1
    v_add_f32 v40, v40, v44
    v_add_f32 v41, v41, v45
    v_add_f32 v42, v42, v46
    v_add_f32 v43, v43, v47
    v_mov_b32 v44, v40
    v_mov_b32 v45, v41
    v_mov_b32 v46, v42
    v_mov_b32 v47, v43
    s_nop 1
    v_permlane32_swap_b32 v40, v44
    v_permlane32_swap_b32 v41, v45
    v_permlane32_swap_b32 v42, v46
    v_permlane32_swap_b32 v43, v47
    s_nop 1
    v_add_f32 v40, v40, v44
    v_add_f32 v41, v41, v45
    v_add_f32 v42, v42, v46
    v_add_f32 v43, v43, v47
    v_cvt_pk_bf16_f32 v44, v40, v40
    v_lshlrev_b32 v44, 16, v44
    v_ashrrev_i32 v46, 31, v44
    v_or_b32 v46, 0x80000000, v46
    v_xor_b32 v44, v44, v46
    v_and_b32 v44, s20, v44
    s_sub_u32 s38, 2047, s16
    v_or_b32 v44, s38, v44
    v_cvt_pk_bf16_f32 v45, v41, v41
    v_lshlrev_b32 v45, 16, v45
    v_ashrrev_i32 v46, 31, v45
    v_or_b32 v46, 0x80000000, v46
    v_xor_b32 v45, v45, v46
    v_and_b32 v45, s20, v45
    s_sub_u32 s38, 2046, s16
    v_or_b32 v45, s38, v45
    v_cvt_pk_bf16_f32 v46, v42, v42
    v_lshlrev_b32 v46, 16, v46
    v_mul_f32 v48, 0xbfb8aa3b, v46
    v_exp_f32 v48, v48
    s_nop 0
    v_add_f32 v48, 1.0, v48
    v_rcp_f32 v48, v48
    s_nop 0
    v_cvt_pk_bf16_f32 v48, v48, v48
    v_lshlrev_b32 v48, 16, v48
    v_cvt_pk_bf16_f32 v46, v43, v43
    v_lshlrev_b32 v46, 16, v46
    v_mul_f32 v49, 0xbfb8aa3b, v46
    v_exp_f32 v49, v49
    s_nop 0
    v_add_f32 v49, 1.0, v49
    v_rcp_f32 v49, v49
    s_nop 0
    v_cvt_pk_bf16_f32 v49, v49, v49
    v_lshlrev_b32 v49, 16, v49
    s_lshl_b32 s38, s16, 2
    s_add_u32 s38, s38, 9437184
    v_mov_b32 v4, 0
    s_mov_b64 exec, 1
    buffer_store_dwordx2 v[44:45], v4, s[12:15], s38 offen sc1
    s_add_u32 s38, s38, 8192
    buffer_store_dwordx2 v[48:49], v4, s[12:15], s38 offen
    s_mov_b64 exec, -1
    s_waitcnt vmcnt(0)
    s_barrier
    s_cmp_lg_u32 s18, 0
    s_cbranch_scc1 L_k1s_nosig
    s_and_b32 s38, s19, 15
    s_lshl_b32 s38, s38, 2
    s_add_u32 s38, s38, 128
    v_mov_b32 v4, s38
    v_mov_b32 v5, 1
    s_mov_b64 exec, 1
    global_atomic_add v4, v5, s[40:41] sc1
    s_mov_b64 exec, -1
L_k1s_nosig:
    s_cmp_ge_u32 s19, 224
    s_cbranch_scc1 L_k1s_end
    s_mul_hi_u32 s23, s19, 76695845
    s_mul_i32 s38, s23, 56
    s_sub_u32 s22, s19, s38
    s_cmp_lt_u32 s18, 2
    s_cselect_b32 s8, s32, s34
    s_cselect_b32 s9, s33, s35
    s_mov_b32 s10, 7340032
    s_mov_b32 s11, 0x20000
    v_lshrrev_b32 v4, 3, v2
    v_and_b32 v5, 7, v2
    v_and_b32 v6, 3, v4
    v_lshlrev_b32 v6, 1, v6
    v_xor_b32 v5, v5, v6
    v_mul_u32_u24 v4, 7168, v4
    v_lshl_add_u32 v4, v5, 4, v4
    s_and_b32 s38, s18, 1
    s_lshl_b32 s38, s38, 7
    s_lshl_b32 s39, s23, 8
    s_add_u32 s38, s38, s39
    s_mul_i32 s38, s38, 7168
    s_lshl_b32 s39, s22, 7
    s_add_u32 s38, s38, s39
    s_lshl_b32 s39, s18, 14
    s_add_u32 m0, s39, 0
    s_nop 0
    buffer_load_dwordx4 v4, s[8:11], s38 offen lds
    s_add_u32 s38, s38, 57344
    s_add_u32 m0, s39, 1024
    s_nop 0
    buffer_load_dwordx4 v4, s[8:11], s38 offen lds
    s_add_u32 s38, s38, 57344
    s_add_u32 m0, s39, 2048
    s_nop 0
    buffer_load_dwordx4 v4, s[8:11], s38 offen lds
    s_add_u32 s38, s38, 57344
    s_add_u32 m0, s39, 3072
    s_nop 0
    buffer_load_dwordx4 v4, s[8:11], s38 offen lds
    s_add_u32 s38, s38, 57344
    s_add_u32 m0, s39, 4096
    s_nop 0
    buffer_load_dwordx4 v4, s[8:11], s38 offen lds
    s_add_u32 s38, s38, 57344
    s_add_u32 m0, s39, 5120
    s_nop 0
    buffer_load_dwordx4 v4, s[8:11], s38 offen lds
    s_add_u32 s38, s38, 57344
    s_add_u32 m0, s39, 6144
    s_nop 0
    buffer_load_dwordx4 v4, s[8:11], s38 offen lds
    s_add_u32 s38, s38, 57344
    s_add_u32 m0, s39, 7168
    s_nop 0
    buffer_load_dwordx4 v4, s[8:11], s38 offen lds
    s_add_u32 s38, s38, 57344
    s_add_u32 m0, s39, 8192
    s_nop 0
    buffer_load_dwordx4 v4, s[8:11], s38 offen lds
    s_add_u32 s38, s38, 57344
    s_add_u32 m0, s39, 9216
    s_nop 0
    buffer_load_dwordx4 v4, s[8:11], s38 offen lds
    s_add_u32 s38, s38, 57344
    s_add_u32 m0, s39, 10240
    s_nop 0
    buffer_load_dwordx4 v4, s[8:11], s38 offen lds
    s_add_u32 s38, s38, 57344
    s_add_u32 m0, s39, 11264
    s_nop 0
    buffer_load_dwordx4 v4, s[8:11], s38 offen lds
    s_add_u32 s38, s38, 57344
    s_add_u32 m0, s39, 12288
    s_nop 0
    buffer_load_dwordx4 v4, s[8:11], s38 offen lds
    s_add_u32 s38, s38, 57344
    s_add_u32 m0, s39, 13312
    s_nop 0
    buffer_load_dwordx4 v4, s[8:11], s38 offen lds
    s_add_u32 s38, s38, 57344
    s_add_u32 m0, s39, 14336
    s_nop 0
    buffer_load_dwordx4 v4, s[8:11], s38 offen lds
    s_add_u32 s38, s38, 57344
    s_add_u32 m0, s39, 15360
    s_nop 0
    buffer_load_dwordx4 v4, s[8:11], s38 offen lds
    s_add_u32 s38, s38, 57344
    v_and_b32 v5, 15, v2
    v_lshlrev_b32 v5, 2, v5
L_k1s_poll:
    global_load_dword v6, v5, s[40:41] offset:128 sc1
    s_waitcnt vmcnt(0)
    v_cmp_ne_u32 vcc, 16, v6
    s_nop 1
    s_cmp_eq_u64 vcc, 0
    s_cbranch_scc1 L_k1s_go
    s_sleep 4
    s_branch L_k1s_poll
L_k1s_go:
    s_mov_b32 s38, 9437184
    buffer_load_dwordx4 v[64:67], v3, s[12:15], s38 offen offset:0 sc1
    buffer_load_dwordx4 v[68:71], v3, s[12:15], s38 offen offset:1024 sc1
    buffer_load_dwordx4 v[72:75], v3, s[12:15], s38 offen offset:2048 sc1
    buffer_load_dwordx4 v[76:79], v3, s[12:15], s38 offen offset:3072 sc1
    s_mov_b32 s38, 9441280
    buffer_load_dwordx4 v[80:83], v3, s[12:15], s38 offen offset:0 sc1
    buffer_load_dwordx4 v[84:87], v3, s[12:15], s38 offen offset:1024 sc1
    buffer_load_dwordx4 v[88:91], v3, s[12:15], s38 offen offset:2048 sc1
    buffer_load_dwordx4 v[92:95], v3, s[12:15], s38 offen offset:3072 sc1
    v_and_b32 v7, 7, v2
    v_mov_b32 v8, 0
    s_mov_b32 s24, -1
    s_mov_b32 s25, 0
    s_waitcnt vmcnt(0)
L_k1s_top:
    v_sub_u32 v100, s24, v64
    v_sub_u32 v101, s24, v65
    v_sub_u32 v102, s24, v66
    v_sub_u32 v103, s24, v67
    v_sub_u32 v104, s24, v68
    v_sub_u32 v105, s24, v69
    v_sub_u32 v106, s24, v70
    v_sub_u32 v107, s24, v71
    v_sub_u32 v108, s24, v72
    v_sub_u32 v109, s24, v73
    v_sub_u32 v110, s24, v74
    v_sub_u32 v111, s24, v75
    v_sub_u32 v112, s24, v76
    v_sub_u32 v113, s24, v77
    v_sub_u32 v114, s24, v78
    v_sub_u32 v115, s24, v79
    v_sub_u32 v116, s24, v80
    v_sub_u32 v117, s24, v81
    v_sub_u32 v118, s24, v82
    v_sub_u32 v119, s24, v83
    v_sub_u32 v120, s24, v84
    v_sub_u32 v121, s24, v85
    v_sub_u32 v122, s24, v86
    v_sub_u32 v123, s24, v87
    v_sub_u32 v124, s24, v88
    v_sub_u32 v125, s24, v89
    v_sub_u32 v126, s24, v90
    v_sub_u32 v127, s24, v91
    v_sub_u32 v128, s24, v92
    v_sub_u32 v129, s24, v93
    v_sub_u32 v130, s24, v94
    v_sub_u32 v131, s24, v95
    v_min3_u32 v9, v100, v101, v102
    v_min3_u32 v9, v9, v103, v104
    v_min3_u32 v9, v9, v105, v106
    v_min3_u32 v9, v9, v107, v108
    v_min3_u32 v9, v9, v109, v110
    v_min3_u32 v9, v9, v111, v112
    v_min3_u32 v9, v9, v113, v114
    v_min3_u32 v9, v9, v115, v116
    v_min3_u32 v9, v9, v117, v118
    v_min3_u32 v9, v9, v119, v120
    v_min3_u32 v9, v9, v121, v122
    v_min3_u32 v9, v9, v123, v124
    v_min3_u32 v9, v9, v125, v126
    v_min3_u32 v9, v9, v127, v128
    v_min3_u32 v9, v9, v129, v130
    v_min_u32 v9, v9, v131
    s_nop 1
    v_min_u32_dpp v9, v9, v9 row_ror:8 row_mask:0xf bank_mask:0xf
    s_nop 1
    v_min_u32_dpp v9, v9, v9 row_ror:4 row_mask:0xf bank_mask:0xf
    s_nop 1
    v_min_u32_dpp v9, v9, v9 row_ror:2 row_mask:0xf bank_mask:0xf
    s_nop 1
    v_min_u32_dpp v9, v9, v9 row_ror:1 row_mask:0xf bank_mask:0xf
    s_nop 0
    v_readlane_b32 s44, v9, 0
    v_readlane_b32 s45, v9, 16
    v_readlane_b32 s46, v9, 32
    v_readlane_b32 s47, v9, 48
    v_cmp_eq_u32 vcc, s25, v7
    s_min_u32 s44, s44, s45
    s_min_u32 s46, s46, s47
    s_min_u32 s44, s44, s46
    s_sub_u32 s24, s24, s44
    v_mov_b32 v10, s24
    v_cndmask_b32 v8, v8, v10, vcc
    s_sub_u32 s24, s24, 1
    s_add_u32 s25, s25, 1
    s_cmp_lt_u32 s25, 8
    s_cbranch_scc1 L_k1s_top
    s_or_b32 s38, s19, s18
    s_cbranch_scc1 L_k1s_notop
    v_lshlrev_b32 v9, 2, v2
    s_mov_b32 s38, 9453568
    s_mov_b64 exec, 0xff
    buffer_store_dword v8, v9, s[12:15], s38 offen
    s_mov_b64 exec, -1
L_k1s_notop:
    v_and_b32 v9, 0x7ff, v8
    v_sub_u32 v9, 2047, v9
    v_lshlrev_b32 v9, 11, v9
    v_lshrrev_b32 v10, 4, v2
    v_lshl_add_u32 v9, v10, 4, v9
    s_lshl_b32 s38, s23, 9
    buffer_load_dwordx4 v[64:67], v9, s[4:7], s38 offen offset:0
    buffer_load_dwordx4 v[68:71], v9, s[4:7], s38 offen offset:64
    buffer_load_dwordx4 v[72:75], v9, s[4:7], s38 offen offset:128
    buffer_load_dwordx4 v[76:79], v9, s[4:7], s38 offen offset:192
    buffer_load_dwordx4 v[80:83], v9, s[4:7], s38 offen offset:256
    buffer_load_dwordx4 v[84:87], v9, s[4:7], s38 offen offset:320
    buffer_load_dwordx4 v[88:91], v9, s[4:7], s38 offen offset:384
    buffer_load_dwordx4 v[92:95], v9, s[4:7], s38 offen offset:448
    v_bfe_u32 v11, v2, 2, 2
    v_lshl_add_u32 v12, v10, 3, v11
    v_lshlrev_b32 v12, 7, v12
    v_xor_b32 v11, s18, v11
    v_lshl_add_u32 v12, v11, 5, v12
    v_and_b32 v11, 3, v2
    v_lshl_add_u32 v12, v11, 3, v12
    s_waitcnt vmcnt(0)
    s_barrier
    ds_read_b64_tr_b16 v[100:101], v12 offset:0
    ds_read_b64_tr_b16 v[102:103], v12 offset:512
    ds_read_b64_tr_b16 v[104:105], v12 offset:4096
    ds_read_b64_tr_b16 v[106:107], v12 offset:4608
    ds_read_b64_tr_b16 v[108:109], v12 offset:8192
    ds_read_b64_tr_b16 v[110:111], v12 offset:8704
    ds_read_b64_tr_b16 v[112:113], v12 offset:12288
    ds_read_b64_tr_b16 v[114:115], v12 offset:12800
    ds_read_b64_tr_b16 v[116:117], v12 offset:16384
    ds_read_b64_tr_b16 v[118:119], v12 offset:16896
    ds_read_b64_tr_b16 v[120:121], v12 offset:20480
    ds_read_b64_tr_b16 v[122:123], v12 offset:20992
    ds_read_b64_tr_b16 v[124:125], v12 offset:24576
    ds_read_b64_tr_b16 v[126:127], v12 offset:25088
    ds_read_b64_tr_b16 v[128:129], v12 offset:28672
    ds_read_b64_tr_b16 v[130:131], v12 offset:29184
    s_waitcnt lgkmcnt(0)
    v_mfma_f32_16x16x32_bf16 v[16:19], v[100:103], v[64:67], 0
    v_mfma_f32_16x16x32_bf16 v[16:19], v[104:107], v[68:71], v[16:19]
    v_mfma_f32_16x16x32_bf16 v[16:19], v[108:111], v[72:75], v[16:19]
    v_mfma_f32_16x16x32_bf16 v[16:19], v[112:115], v[76:79], v[16:19]
    v_mfma_f32_16x16x32_bf16 v[16:19], v[116:119], v[80:83], v[16:19]
    v_mfma_f32_16x16x32_bf16 v[16:19], v[120:123], v[84:87], v[16:19]
    v_mfma_f32_16x16x32_bf16 v[16:19], v[124:127], v[88:91], v[16:19]
    v_mfma_f32_16x16x32_bf16 v[16:19], v[128:131], v[92:95], v[16:19]
    ds_read_b64_tr_b16 v[132:133], v12 offset:32768
    ds_read_b64_tr_b16 v[134:135], v12 offset:33280
    ds_read_b64_tr_b16 v[136:137], v12 offset:36864
    ds_read_b64_tr_b16 v[138:139], v12 offset:37376
    ds_read_b64_tr_b16 v[140:141], v12 offset:40960
    ds_read_b64_tr_b16 v[142:143], v12 offset:41472
    ds_read_b64_tr_b16 v[144:145], v12 offset:45056
    ds_read_b64_tr_b16 v[146:147], v12 offset:45568
    ds_read_b64_tr_b16 v[148:149], v12 offset:49152
    ds_read_b64_tr_b16 v[150:151], v12 offset:49664
    ds_read_b64_tr_b16 v[152:153], v12 offset:53248
    ds_read_b64_tr_b16 v[154:155], v12 offset:53760
    ds_read_b64_tr_b16 v[156:157], v12 offset:57344
    ds_read_b64_tr_b16 v[158:159], v12 offset:57856
    ds_read_b64_tr_b16 v[160:161], v12 offset:61440
    ds_read_b64_tr_b16 v[162:163], v12 offset:61952
    s_waitcnt lgkmcnt(0)
    v_mfma_f32_16x16x32_bf16 v[20:23], v[132:135], v[64:67], 0
    v_mfma_f32_16x16x32_bf16 v[20:23], v[136:139], v[68:71], v[20:23]
    v_mfma_f32_16x16x32_bf16 v[20:23], v[140:143], v[72:75], v[20:23]
    v_mfma_f32_16x16x32_bf16 v[20:23], v[144:147], v[76:79], v[20:23]
    v_mfma_f32_16x16x32_bf16 v[20:23], v[148:151], v[80:83], v[20:23]
    v_mfma_f32_16x16x32_bf16 v[20:23], v[152:155], v[84:87], v[20:23]
    v_mfma_f32_16x16x32_bf16 v[20:23], v[156:159], v[88:91], v[20:23]
    v_mfma_f32_16x16x32_bf16 v[20:23], v[160:163], v[92:95], v[20:23]
    v_and_b32 v11, 15, v2
    v_mul_u32_u24 v13, 14336, v11
    v_lshl_add_u32 v13, v10, 4, v13
    s_mul_i32 s38, s23, 229376
    s_lshl_b32 s39, s22, 8
    s_add_u32 s38, s38, s39
    s_lshl_b32 s39, s18, 6
    s_add_u32 s38, s38, s39
    s_add_u32 s38, s38, 10485760
    s_add_u32 s39, s38, 114688
    v_cmp_gt_u32 vcc, 8, v11
    s_nop 4
    s_mov_b64 exec, vcc
    buffer_store_dwordx4 v[16:19], v13, s[12:15], s38 offen
    buffer_store_dwordx4 v[20:23], v13, s[12:15], s39 offen
L_k1s_end:
    s_endpgm
.globl k2_kernel
.p2align 8
.type k2_kernel,@function
k2_kernel:
    s_cmp_ge_u32 s2, 256
    s_cbranch_scc1 L_k2_side
L_k2_gemm:
    s_load_dwordx2 s[28:29], s[0:1], 0
    s_load_dwordx4 s[32:35], s[0:1], 40
    s_load_dwordx2 s[36:37], s[0:1], 64
    s_load_dwordx2 s[30:31], s[0:1], 120
    s_load_dwordx4 s[40:43], s[0:1], 128
    v_lshrrev_b32 v26, 6, v0
    v_and_b32 v22, 63, v0
    v_readfirstlane_b32 s18, v26
    s_and_b32 s3, s2, 7
    s_lshr_b32 s38, s2, 3
    s_lshr_b32 s16, s3, 1
    s_lshl_b32 s16, s16, 2
    s_and_b32 s39, s38, 3
    s_add_u32 s16, s16, s39
    s_and_b32 s17, s3, 1
    s_lshl_b32 s17, s17, 3
    s_mul_i32 s19, s3, 8
    s_lshr_b32 s39, s38, 2
    s_add_u32 s17, s17, s39
    s_mul_i32 s39, s16, 0
    s_add_u32 s19, s19, s39
    s_mul_i32 s39, s17, 0
    s_add_u32 s19, s19, s39
    v_lshrrev_b32 v23, 5, v22
    v_lshrrev_b32 v26, 3, v22
    v_and_b32 v27, 7, v22
    v_lshrrev_b32 v28, 1, v26
    v_xor_b32 v27, v27, v28
    v_lshlrev_b32 v27, 4, v27
    s_lshl_b32 s38, s17, 6
    s_and_b32 s39, s18, 1
    s_lshl_b32 s39, s39, 5
    s_add_u32 s38, s38, s39
    v_add_u32 v28, s38, v26
    v_lshl_add_u32 v28, v28, 11, v27
    v_add_u32 v8, 3072, v28
    v_xor_b32 v29, 64, v28
    v_add_u32 v9, 18432, v29
    v_add_u32 v10, 33792, v28
    v_xor_b32 v29, 64, v28
    v_add_u32 v11, 49152, v29
    v_lshlrev_b32 v20, 4, v22
    v_add_u32 v21, 4096, v20
    s_lshl_b32 s20, s16, 19
    s_lshl_b32 s38, s18, 13
    s_add_u32 s20, s20, s38
    s_lshl_b32 s44, s18, 12
    s_waitcnt lgkmcnt(0)
    s_cmp_lt_u32 s18, 2
    s_cselect_b32 s4, s32, s34
    s_cselect_b32 s5, s33, s35
    s_sub_u32 s4, s4, 3072
    s_subb_u32 s5, s5, 0
    s_mov_b32 s6, 2100224
    s_mov_b32 s7, 0x20000
    s_mov_b32 s12, s42
    s_mov_b32 s13, s43
    s_mov_b32 s14, 16777216
    s_mov_b32 s15, 0x20000
    s_mov_b32 s8, s28
    s_mov_b32 s9, s29
    s_mov_b32 s10, 4194304
    s_mov_b32 s11, 0x20000
    s_mov_b32 s24, s30
    s_mov_b32 s25, s31
    s_mov_b32 s26, 8388608
    s_mov_b32 s27, 0x20000
    s_add_u32 s46, s42, 9453568
    s_addc_u32 s47, s43, 0
    s_load_dwordx8 s[48:55], s[46:47], 0
    s_add_u32 m0, s44, 0
    s_add_u32 s21, s19, 0
    s_and_b32 s21, s21, 15
    s_lshl_b32 s21, s21, 7
    buffer_load_dwordx4 v8, s[4:7], s21 offen offset:0 lds
    buffer_load_dwordx4 v9, s[4:7], s21 offen offset:1024 lds
    buffer_load_dwordx4 v10, s[4:7], s21 offen offset:2048 lds
    buffer_load_dwordx4 v11, s[4:7], s21 offen offset:3072 lds
    s_add_u32 s22, s19, 0
    s_and_b32 s22, s22, 15
    s_lshl_b32 s22, s22, 15
    s_add_u32 s22, s22, s20
    buffer_load_dwordx4 v[160:163], v20, s[12:15], s22 offen offset:0
    buffer_load_dwordx4 v[164:167], v20, s[12:15], s22 offen offset:1024
    buffer_load_dwordx4 v[168:171], v20, s[12:15], s22 offen offset:2048
    buffer_load_dwordx4 v[172:175], v20, s[12:15], s22 offen offset:3072
    buffer_load_dwordx4 v[176:179], v21, s[12:15], s22 offen offset:0
    buffer_load_dwordx4 v[180:183], v21, s[12:15], s22 offen offset:1024
    buffer_load_dwordx4 v[184:187], v21, s[12:15], s22 offen offset:2048
    buffer_load_dwordx4 v[188:191], v21, s[12:15], s22 offen offset:3072
    s_add_u32 m0, s44, 16384
    s_add_u32 s21, s19, 1
    s_and_b32 s21, s21, 15
    s_lshl_b32 s21, s21, 7
    buffer_load_dwordx4 v8, s[4:7], s21 offen offset:0 lds
    buffer_load_dwordx4 v9, s[4:7], s21 offen offset:1024 lds
    buffer_load_dwordx4 v10, s[4:7], s21 offen offset:2048 lds
    buffer_load_dwordx4 v11, s[4:7], s21 offen offset:3072 lds
    s_add_u32 s22, s19, 1
    s_and_b32 s22, s22, 15
    s_lshl_b32 s22, s22, 15
    s_add_u32 s22, s22, s20
    buffer_load_dwordx4 v[192:195], v20, s[12:15], s22 offen offset:0
    buffer_load_dwordx4 v[196:199], v20, s[12:15], s22 offen offset:1024
    buffer_load_dwordx4 v[200:203], v20, s[12:15], s22 offen offset:2048
    buffer_load_dwordx4 v[204:207], v20, s[12:15], s22 offen offset:3072
    buffer_load_dwordx4 v[208:211], v21, s[12:15], s22 offen offset:0
    buffer_load_dwordx4 v[212:215], v21, s[12:15], s22 offen offset:1024
    buffer_load_dwordx4 v[216:219], v21, s[12:15], s22 offen offset:2048
    buffer_load_dwordx4 v[220:223], v21, s[12:15], s22 offen offset:3072
    v_lshrrev_b32 v28, 4, v22
    v_and_b32 v29, 15, v22
    v_lshlrev_b32 v30, 11, v28
    v_lshl_add_u32 v30, v29, 3, v30
    v_lshlrev_b32 v31, 2, v28
    s_lshl_b32 s45, s16, 7
    s_lshl_b32 s38, s18, 5
    s_add_u32 s45, s45, s38
    s_lshl_b32 s38, s45, 11
    s_lshl_b32 s39, s17, 7
    s_add_u32 s38, s38, s39
    buffer_load_dwordx2 v[40:41], v30, s[8:11], s38 offen
    s_add_u32 s38, s38, 8192
    buffer_load_dwordx2 v[42:43], v30, s[8:11], s38 offen
    s_add_u32 s38, s38, 8192
    buffer_load_dwordx2 v[44:45], v30, s[8:11], s38 offen
    s_add_u32 s38, s38, 8192
    buffer_load_dwordx2 v[46:47], v30, s[8:11], s38 offen
    s_add_u32 s38, s38, 8192
    buffer_load_dwordx2 v[48:49], v30, s[8:11], s38 offen
    s_add_u32 s38, s38, 8192
    buffer_load_dwordx2 v[50:51], v30, s[8:11], s38 offen
    s_add_u32 s38, s38, 8192
    buffer_load_dwordx2 v[52:53], v30, s[8:11], s38 offen
    s_add_u32 s38, s38, 8192
    buffer_load_dwordx2 v[54:55], v30, s[8:11], s38 offen
    s_add_u32 s38, s38, 8192
    s_lshl_b32 s38, s45, 2
    s_add_u32 s38, s38, 9445376
    buffer_load_dword v56, v31, s[12:15], s38 offen offset:0
    buffer_load_dword v57, v31, s[12:15], s38 offen offset:16
    buffer_load_dword v58, v31, s[12:15], s38 offen offset:32
    buffer_load_dword v59, v31, s[12:15], s38 offen offset:48
    buffer_load_dword v60, v31, s[12:15], s38 offen offset:64
    buffer_load_dword v61, v31, s[12:15], s38 offen offset:80
    buffer_load_dword v62, v31, s[12:15], s38 offen offset:96
    buffer_load_dword v63, v31, s[12:15], s38 offen offset:112
    v_and_b32 v32, 31, v22
    v_lshlrev_b32 v32, 2, v32
    buffer_load_dword v24, v32, s[12:15], s38 offen
    v_lshl_add_u32 v32, v29, 3, s39
    global_load_dwordx2 v[156:157], v32, s[36:37]
    s_add_u32 m0, s44, 32768
    s_add_u32 s21, s19, 2
    s_and_b32 s21, s21, 15
    s_lshl_b32 s21, s21, 7
    buffer_load_dwordx4 v8, s[4:7], s21 offen offset:0 lds
    buffer_load_dwordx4 v9, s[4:7], s21 offen offset:1024 lds
    buffer_load_dwordx4 v10, s[4:7], s21 offen offset:2048 lds
    buffer_load_dwordx4 v11, s[4:7], s21 offen offset:3072 lds
    s_add_u32 s22, s19, 2
    s_and_b32 s22, s22, 15
    s_lshl_b32 s22, s22, 15
    s_add_u32 s22, s22, s20
    buffer_load_dwordx4 v[224:227], v20, s[12:15], s22 offen offset:0
    buffer_load_dwordx4 v[228:231], v20, s[12:15], s22 offen offset:1024
    buffer_load_dwordx4 v[232:235], v20, s[12:15], s22 offen offset:2048
    buffer_load_dwordx4 v[236:239], v20, s[12:15], s22 offen offset:3072
    buffer_load_dwordx4 v[240:243], v21, s[12:15], s22 offen offset:0
    buffer_load_dwordx4 v[244:247], v21, s[12:15], s22 offen offset:1024
    buffer_load_dwordx4 v[248:251], v21, s[12:15], s22 offen offset:2048
    buffer_load_dwordx4 v[252:255], v21, s[12:15], s22 offen offset:3072
    s_add_u32 m0, s44, 49152
    s_add_u32 s21, s19, 3
    s_and_b32 s21, s21, 15
    s_lshl_b32 s21, s21, 7
    buffer_load_dwordx4 v8, s[4:7], s21 offen offset:0 lds
    buffer_load_dwordx4 v9, s[4:7], s21 offen offset:1024 lds
    buffer_load_dwordx4 v10, s[4:7], s21 offen offset:2048 lds
    buffer_load_dwordx4 v11, s[4:7], s21 offen offset:3072 lds
    v_and_b32 v28, 31, v22
    v_bfe_u32 v29, v22, 1, 3
    v_xor_b32 v29, v29, v23
    v_lshlrev_b32 v29, 4, v29
    v_lshl_add_u32 v29, v28, 7, v29
    v_xor_b32 v12, 0, v29
    v_add_u32 v16, 0x10000, v12
    v_xor_b32 v13, 32, v29
    v_add_u32 v17, 0x10000, v13
    v_xor_b32 v14, 64, v29
    v_add_u32 v18, 0x10000, v14
    v_xor_b32 v15, 96, v29
    v_add_u32 v19, 0x10000, v15
    s_mov_b32 s23, 0xffff0000
    s_waitcnt vmcnt(54) lgkmcnt(0)
    s_barrier
    ds_read_b128 v[96:99], v12 offset:0
    ds_read_b128 v[100:103], v12 offset:4096
    ds_read_b128 v[104:107], v13 offset:0
    ds_read_b128 v[108:111], v13 offset:4096
    ds_read_b128 v[112:115], v14 offset:0
    ds_read_b128 v[116:119], v14 offset:4096
    s_waitcnt vmcnt(53) lgkmcnt(4)
    v_mfma_f32_32x32x16_bf16 v[64:79], v[96:99], v[160:163], 0
    v_mfma_f32_32x32x16_bf16 v[80:95], v[100:103], v[160:163], 0
    s_add_u32 s22, s19, 3
    s_and_b32 s22, s22, 15
    s_lshl_b32 s22, s22, 15
    s_add_u32 s22, s22, s20
    buffer_load_dwordx4 v[160:163], v20, s[12:15], s22 offen offset:0
    s_add_u32 m0, s44, 65536
    s_add_u32 s21, s19, 4
    s_and_b32 s21, s21, 15
    s_lshl_b32 s21, s21, 7
    buffer_load_dwordx4 v8, s[4:7], s21 offen offset:0 lds
    buffer_load_dwordx4 v9, s[4:7], s21 offen offset:1024 lds
    ds_read_b128 v[96:99], v15 offset:0
    ds_read_b128 v[100:103], v15 offset:4096
    s_waitcnt vmcnt(55) lgkmcnt(4)
    v_mfma_f32_32x32x16_bf16 v[64:79], v[104:107], v[164:167], v[64:79]
    v_mfma_f32_32x32x16_bf16 v[80:95], v[108:111], v[164:167], v[80:95]
    buffer_load_dwordx4 v[164:167], v20, s[12:15], s22 offen offset:1024
    ds_read_b128 v[104:107], v12 offset:8192
    ds_read_b128 v[108:111], v12 offset:12288
    s_waitcnt vmcnt(55) lgkmcnt(4)
    v_mfma_f32_32x32x16_bf16 v[64:79], v[112:115], v[168:171], v[64:79]
    v_mfma_f32_32x32x16_bf16 v[80:95], v[116:119], v[168:171], v[80:95]
    buffer_load_dwordx4 v[168:171], v20, s[12:15], s22 offen offset:2048
    buffer_load_dwordx4 v10, s[4:7], s21 offen offset:2048 lds
    ds_read_b128 v[112:115], v13 offset:8192
    ds_read_b128 v[116:119], v13 offset:12288
    s_waitcnt vmcnt(56) lgkmcnt(4)
    v_mfma_f32_32x32x16_bf16 v[64:79], v[96:99], v[172:175], v[64:79]
    v_mfma_f32_32x32x16_bf16 v[80:95], v[100:103], v[172:175], v[80:95]
    buffer_load_dwordx4 v[172:175], v20, s[12:15], s22 offen offset:3072
    ds_read_b128 v[96:99], v14 offset:8192
    ds_read_b128 v[100:103], v14 offset:12288
    s_waitcnt vmcnt(56) lgkmcnt(4)
    v_mfma_f32_32x32x16_bf16 v[64:79], v[104:107], v[176:179], v[64:79]
    v_mfma_f32_32x32x16_bf16 v[80:95], v[108:111], v[176:179], v[80:95]
    buffer_load_dwordx4 v[176:179], v21, s[12:15], s22 offen offset:0
    buffer_load_dwordx4 v11, s[4:7], s21 offen offset:3072 lds
    ds_read_b128 v[104:107], v15 offset:8192
    ds_read_b128 v[108:111], v15 offset:12288
    s_waitcnt vmcnt(57) lgkmcnt(4)
    v_mfma_f32_32x32x16_bf16 v[64:79], v[112:115], v[180:183], v[64:79]
    v_mfma_f32_32x32x16_bf16 v[80:95], v[116:119], v[180:183], v[80:95]
    buffer_load_dwordx4 v[180:183], v21, s[12:15], s22 offen offset:1024
    s_waitcnt vmcnt(52) lgkmcnt(0)
    s_barrier
    ds_read_b128 v[112:115], v12 offset:16384
    ds_read_b128 v[116:119], v12 offset:20480
    s_waitcnt vmcnt(57) lgkmcnt(4)
    v_mfma_f32_32x32x16_bf16 v[64:79], v[96:99], v[184:187], v[64:79]
    v_mfma_f32_32x32x16_bf16 v[80:95], v[100:103], v[184:187], v[80:95]
    buffer_load_dwordx4 v[184:187], v21, s[12:15], s22 offen offset:2048
    s_add_u32 m0, s44, 0
    s_add_u32 s21, s19, 5
    s_and_b32 s21, s21, 15
    s_lshl_b32 s21, s21, 7
    buffer_load_dwordx4 v8, s[4:7], s21 offen offset:0 lds
    ds_read_b128 v[96:99], v13 offset:16384
    ds_read_b128 v[100:103], v13 offset:20480
    s_waitcnt vmcnt(58) lgkmcnt(4)
    v_mfma_f32_32x32x16_bf16 v[64:79], v[104:107], v[188:191], v[64:79]
    v_mfma_f32_32x32x16_bf16 v[80:95], v[108:111], v[188:191], v[80:95]
    buffer_load_dwordx4 v[188:191], v21, s[12:15], s22 offen offset:3072
    ds_read_b128 v[104:107], v14 offset:16384
    ds_read_b128 v[108:111], v14 offset:20480
    s_waitcnt vmcnt(54) lgkmcnt(4)
    v_mfma_f32_32x32x16_bf16 v[64:79], v[112:115], v[192:195], v[64:79]
    v_mfma_f32_32x32x16_bf16 v[80:95], v[116:119], v[192:195], v[80:95]
    s_add_u32 s22, s19, 4
    s_and_b32 s22, s22, 15
    s_lshl_b32 s22, s22, 15
    s_add_u32 s22, s22, s20
    buffer_load_dwordx4 v[192:195], v20, s[12:15], s22 offen offset:0
    buffer_load_dwordx4 v9, s[4:7], s21 offen offset:1024 lds
    ds_read_b128 v[112:115], v15 offset:16384
    ds_read_b128 v[116:119], v15 offset:20480
    s_waitcnt vmcnt(55) lgkmcnt(4)
    v_mfma_f32_32x32x16_bf16 v[64:79], v[96:99], v[196:199], v[64:79]
    v_mfma_f32_32x32x16_bf16 v[80:95], v[100:103], v[196:199], v[80:95]
    buffer_load_dwordx4 v[196:199], v20, s[12:15], s22 offen offset:1024
    ds_read_b128 v[96:99], v12 offset:24576
    ds_read_b128 v[100:103], v12 offset:28672
    s_waitcnt vmcnt(55) lgkmcnt(4)
    v_mfma_f32_32x32x16_bf16 v[64:79], v[104:107], v[200:203], v[64:79]
    v_mfma_f32_32x32x16_bf16 v[80:95], v[108:111], v[200:203], v[80:95]
    buffer_load_dwordx4 v[200:203], v20, s[12:15], s22 offen offset:2048
    buffer_load_dwordx4 v10, s[4:7], s21 offen offset:2048 lds
    ds_read_b128 v[104:107], v13 offset:24576
    ds_read_b128 v[108:111], v13 offset:28672
    s_waitcnt vmcnt(56) lgkmcnt(4)
    v_mfma_f32_32x32x16_bf16 v[64:79], v[112:115], v[204:207], v[64:79]
    v_mfma_f32_32x32x16_bf16 v[80:95], v[116:119], v[204:207], v[80:95]
    buffer_load_dwordx4 v[204:207], v20, s[12:15], s22 offen offset:3072
    ds_read_b128 v[112:115], v14 offset:24576
    ds_read_b128 v[116:119], v14 offset:28672
    s_waitcnt vmcnt(56) lgkmcnt(4)
    v_mfma_f32_32x32x16_bf16 v[64:79], v[96:99], v[208:211], v[64:79]
    v_mfma_f32_32x32x16_bf16 v[80:95], v[100:103], v[208:211], v[80:95]
    buffer_load_dwordx4 v[208:211], v21, s[12:15], s22 offen offset:0
    buffer_load_dwordx4 v11, s[4:7], s21 offen offset:3072 lds
    ds_read_b128 v[96:99], v15 offset:24576
    ds_read_b128 v[100:103], v15 offset:28672
    s_waitcnt vmcnt(57) lgkmcnt(4)
    v_mfma_f32_32x32x16_bf16 v[64:79], v[104:107], v[212:215], v[64:79]
    v_mfma_f32_32x32x16_bf16 v[80:95], v[108:111], v[212:215], v[80:95]
    buffer_load_dwordx4 v[212:215], v21, s[12:15], s22 offen offset:1024
    s_waitcnt vmcnt(34) lgkmcnt(0)
    s_barrier
    ds_read_b128 v[104:107], v12 offset:32768
    ds_read_b128 v[108:111], v12 offset:36864
    s_waitcnt vmcnt(57) lgkmcnt(4)
    v_mfma_f32_32x32x16_bf16 v[64:79], v[112:115], v[216:219], v[64:79]
    v_mfma_f32_32x32x16_bf16 v[80:95], v[116:119], v[216:219], v[80:95]
    buffer_load_dwordx4 v[216:219], v21, s[12:15], s22 offen offset:2048
    s_add_u32 m0, s44, 16384
    s_add_u32 s21, s19, 6
    s_and_b32 s21, s21, 15
    s_lshl_b32 s21, s21, 7
    buffer_load_dwordx4 v8, s[4:7], s21 offen offset:0 lds
    ds_read_b128 v[112:115], v13 offset:32768
    ds_read_b128 v[116:119], v13 offset:36864
    s_waitcnt vmcnt(58) lgkmcnt(4)
    v_mfma_f32_32x32x16_bf16 v[64:79], v[96:99], v[220:223], v[64:79]
    v_mfma_f32_32x32x16_bf16 v[80:95], v[100:103], v[220:223], v[80:95]
    buffer_load_dwordx4 v[220:223], v21, s[12:15], s22 offen offset:3072
    ds_read_b128 v[96:99], v14 offset:32768
    ds_read_b128 v[100:103], v14 offset:36864
    s_waitcnt vmcnt(36) lgkmcnt(4)
    v_mfma_f32_32x32x16_bf16 v[64:79], v[104:107], v[224:227], v[64:79]
    v_mfma_f32_32x32x16_bf16 v[80:95], v[108:111], v[224:227], v[80:95]
    s_add_u32 s22, s19, 5
    s_and_b32 s22, s22, 15
    s_lshl_b32 s22, s22, 15
    s_add_u32 s22, s22, s20
    buffer_load_dwordx4 v[224:227], v20, s[12:15], s22 offen offset:0
    buffer_load_dwordx4 v9, s[4:7], s21 offen offset:1024 lds
    ds_read_b128 v[104:107], v15 offset:32768
    ds_read_b128 v[108:111], v15 offset:36864
    s_waitcnt vmcnt(37) lgkmcnt(4)
    v_mfma_f32_32x32x16_bf16 v[64:79], v[112:115], v[228:231], v[64:79]
    v_mfma_f32_32x32x16_bf16 v[80:95], v[116:119], v[228:231], v[80:95]
    buffer_load_dwordx4 v[228:231], v20, s[12:15], s22 offen offset:1024
    ds_read_b128 v[112:115], v12 offset:40960
    ds_read_b128 v[116:119], v12 offset:45056
    s_waitcnt vmcnt(37) lgkmcnt(4)
    v_mfma_f32_32x32x16_bf16 v[64:79], v[96:99], v[232:235], v[64:79]
    v_mfma_f32_32x32x16_bf16 v[80:95], v[100:103], v[232:235], v[80:95]
    buffer_load_dwordx4 v[232:235], v20, s[12:15], s22 offen offset:2048
    buffer_load_dwordx4 v10, s[4:7], s21 offen offset:2048 lds
    ds_read_b128 v[96:99], v13 offset:40960
    ds_read_b128 v[100:103], v13 offset:45056
    s_waitcnt vmcnt(38) lgkmcnt(4)
    v_mfma_f32_32x32x16_bf16 v[64:79], v[104:107], v[236:239], v[64:79]
    v_mfma_f32_32x32x16_bf16 v[80:95], v[108:111], v[236:239], v[80:95]
    buffer_load_dwordx4 v[236:239], v20, s[12:15], s22 offen offset:3072
    ds_read_b128 v[104:107], v14 offset:40960
    ds_read_b128 v[108:111], v14 offset:45056
    s_waitcnt vmcnt(38) lgkmcnt(4)
    v_mfma_f32_32x32x16_bf16 v[64:79], v[112:115], v[240:243], v[64:79]
    v_mfma_f32_32x32x16_bf16 v[80:95], v[116:119], v[240:243], v[80:95]
    buffer_load_dwordx4 v[240:243], v21, s[12:15], s22 offen offset:0
    buffer_load_dwordx4 v11, s[4:7], s21 offen offset:3072 lds
    ds_read_b128 v[112:115], v15 offset:40960
    ds_read_b128 v[116:119], v15 offset:45056
    s_waitcnt vmcnt(39) lgkmcnt(4)
    v_mfma_f32_32x32x16_bf16 v[64:79], v[96:99], v[244:247], v[64:79]
    v_mfma_f32_32x32x16_bf16 v[80:95], v[100:103], v[244:247], v[80:95]
    buffer_load_dwordx4 v[244:247], v21, s[12:15], s22 offen offset:1024
    s_waitcnt vmcnt(34) lgkmcnt(0)
    s_barrier
    ds_read_b128 v[96:99], v12 offset:49152
    ds_read_b128 v[100:103], v12 offset:53248
    s_waitcnt vmcnt(39) lgkmcnt(4)
    v_mfma_f32_32x32x16_bf16 v[64:79], v[104:107], v[248:251], v[64:79]
    v_mfma_f32_32x32x16_bf16 v[80:95], v[108:111], v[248:251], v[80:95]
    buffer_load_dwordx4 v[248:251], v21, s[12:15], s22 offen offset:2048
    s_add_u32 m0, s44, 32768
    s_add_u32 s21, s19, 7
    s_and_b32 s21, s21, 15
    s_lshl_b32 s21, s21, 7
    buffer_load_dwordx4 v8, s[4:7], s21 offen offset:0 lds
    ds_read_b128 v[104:107], v13 offset:49152
    ds_read_b128 v[108:111], v13 offset:53248
    s_waitcnt vmcnt(40) lgkmcnt(4)
    v_mfma_f32_32x32x16_bf16 v[64:79], v[112:115], v[252:255], v[64:79]
    v_mfma_f32_32x32x16_bf16 v[80:95], v[116:119], v[252:255], v[80:95]
    buffer_load_dwordx4 v[252:255], v21, s[12:15], s22 offen offset:3072
    ds_read_b128 v[112:115], v14 offset:49152
    ds_read_b128 v[116:119], v14 offset:53248
    s_waitcnt vmcnt(36) lgkmcnt(4)
    v_mfma_f32_32x32x16_bf16 v[64:79], v[96:99], v[160:163], v[64:79]
    v_mfma_f32_32x32x16_bf16 v[80:95], v[100:103], v[160:163], v[80:95]
    s_add_u32 s22, s19, 6
    s_and_b32 s22, s22, 15
    s_lshl_b32 s22, s22, 15
    s_add_u32 s22, s22, s20
    buffer_load_dwordx4 v[160:163], v20, s[12:15], s22 offen offset:0
    buffer_load_dwordx4 v9, s[4:7], s21 offen offset:1024 lds
    ds_read_b128 v[96:99], v15 offset:49152
    ds_read_b128 v[100:103], v15 offset:53248
    s_waitcnt vmcnt(35) lgkmcnt(4)
    v_mfma_f32_32x32x16_bf16 v[64:79], v[104:107], v[164:167], v[64:79]
    v_mfma_f32_32x32x16_bf16 v[80:95], v[108:111], v[164:167], v[80:95]
    buffer_load_dwordx4 v[164:167], v20, s[12:15], s22 offen offset:1024
    ds_read_b128 v[104:107], v12 offset:57344
    ds_read_b128 v[108:111], v12 offset:61440
    s_waitcnt vmcnt(35) lgkmcnt(4)
    v_mfma_f32_32x32x16_bf16 v[64:79], v[112:115], v[168:171], v[64:79]
    v_mfma_f32_32x32x16_bf16 v[80:95], v[116:119], v[168:171], v[80:95]
    buffer_load_dwordx4 v[168:171], v20, s[12:15], s22 offen offset:2048
    buffer_load_dwordx4 v10, s[4:7], s21 offen offset:2048 lds
    ds_read_b128 v[112:115], v13 offset:57344
    ds_read_b128 v[116:119], v13 offset:61440
    s_waitcnt vmcnt(35) lgkmcnt(4)
    v_mfma_f32_32x32x16_bf16 v[64:79], v[96:99], v[172:175], v[64:79]
    v_mfma_f32_32x32x16_bf16 v[80:95], v[100:103], v[172:175], v[80:95]
    buffer_load_dwordx4 v[172:175], v20, s[12:15], s22 offen offset:3072
    ds_read_b128 v[96:99], v14 offset:57344
    ds_read_b128 v[100:103], v14 offset:61440
    s_waitcnt vmcnt(35) lgkmcnt(4)
    v_mfma_f32_32x32x16_bf16 v[64:79], v[104:107], v[176:179], v[64:79]
    v_mfma_f32_32x32x16_bf16 v[80:95], v[108:111], v[176:179], v[80:95]
    buffer_load_dwordx4 v[176:179], v21, s[12:15], s22 offen offset:0
    buffer_load_dwordx4 v11, s[4:7], s21 offen offset:3072 lds
    ds_read_b128 v[104:107], v15 offset:57344
    ds_read_b128 v[108:111], v15 offset:61440
    s_waitcnt vmcnt(35) lgkmcnt(4)
    v_mfma_f32_32x32x16_bf16 v[64:79], v[112:115], v[180:183], v[64:79]
    v_mfma_f32_32x32x16_bf16 v[80:95], v[116:119], v[180:183], v[80:95]
    buffer_load_dwordx4 v[180:183], v21, s[12:15], s22 offen offset:1024
    s_waitcnt vmcnt(37) lgkmcnt(0)
    s_barrier
    ds_read_b128 v[112:115], v16 offset:0
    ds_read_b128 v[116:119], v16 offset:4096
    s_waitcnt vmcnt(35) lgkmcnt(4)
    v_mfma_f32_32x32x16_bf16 v[64:79], v[96:99], v[184:187], v[64:79]
    v_mfma_f32_32x32x16_bf16 v[80:95], v[100:103], v[184:187], v[80:95]
    buffer_load_dwordx4 v[184:187], v21, s[12:15], s22 offen offset:2048
    s_add_u32 m0, s44, 49152
    s_add_u32 s21, s19, 8
    s_and_b32 s21, s21, 15
    s_lshl_b32 s21, s21, 7
    buffer_load_dwordx4 v8, s[4:7], s21 offen offset:0 lds
    ds_read_b128 v[96:99], v17 offset:0
    ds_read_b128 v[100:103], v17 offset:4096
    s_waitcnt vmcnt(35) lgkmcnt(4)
    v_mfma_f32_32x32x16_bf16 v[64:79], v[104:107], v[188:191], v[64:79]
    v_mfma_f32_32x32x16_bf16 v[80:95], v[108:111], v[188:191], v[80:95]
    buffer_load_dwordx4 v[188:191], v21, s[12:15], s22 offen offset:3072
    ds_read_b128 v[104:107], v18 offset:0
    ds_read_b128 v[108:111], v18 offset:4096
    s_waitcnt vmcnt(35) lgkmcnt(4)
    v_mfma_f32_32x32x16_bf16 v[64:79], v[112:115], v[192:195], v[64:79]
    v_mfma_f32_32x32x16_bf16 v[80:95], v[116:119], v[192:195], v[80:95]
    s_add_u32 s22, s19, 7
    s_and_b32 s22, s22, 15
    s_lshl_b32 s22, s22, 15
    s_add_u32 s22, s22, s20
    buffer_load_dwordx4 v[192:195], v20, s[12:15], s22 offen offset:0
    buffer_load_dwordx4 v9, s[4:7], s21 offen offset:1024 lds
    ds_read_b128 v[112:115], v19 offset:0
    ds_read_b128 v[116:119], v19 offset:4096
    s_waitcnt vmcnt(35) lgkmcnt(4)
    v_mfma_f32_32x32x16_bf16 v[64:79], v[96:99], v[196:199], v[64:79]
    v_mfma_f32_32x32x16_bf16 v[80:95], v[100:103], v[196:199], v[80:95]
    buffer_load_dwordx4 v[196:199], v20, s[12:15], s22 offen offset:1024
    ds_read_b128 v[96:99], v16 offset:8192
    ds_read_b128 v[100:103], v16 offset:12288
    s_waitcnt vmcnt(35) lgkmcnt(4)
    v_mfma_f32_32x32x16_bf16 v[64:79], v[104:107], v[200:203], v[64:79]
    v_mfma_f32_32x32x16_bf16 v[80:95], v[108:111], v[200:203], v[80:95]
    buffer_load_dwordx4 v[200:203], v20, s[12:15], s22 offen offset:2048
    buffer_load_dwordx4 v10, s[4:7], s21 offen offset:2048 lds
    ds_read_b128 v[104:107], v17 offset:8192
    ds_read_b128 v[108:111], v17 offset:12288
    s_waitcnt vmcnt(35) lgkmcnt(4)
    v_mfma_f32_32x32x16_bf16 v[64:79], v[112:115], v[204:207], v[64:79]
    v_mfma_f32_32x32x16_bf16 v[80:95], v[116:119], v[204:207], v[80:95]
    buffer_load_dwordx4 v[204:207], v20, s[12:15], s22 offen offset:3072
    ds_read_b128 v[112:115], v18 offset:8192
    ds_read_b128 v[116:119], v18 offset:12288
    s_waitcnt vmcnt(35) lgkmcnt(4)
    v_mfma_f32_32x32x16_bf16 v[64:79], v[96:99], v[208:211], v[64:79]
    v_mfma_f32_32x32x16_bf16 v[80:95], v[100:103], v[208:211], v[80:95]
    buffer_load_dwordx4 v[208:211], v21, s[12:15], s22 offen offset:0
    buffer_load_dwordx4 v11, s[4:7], s21 offen offset:3072 lds
    ds_read_b128 v[96:99], v19 offset:8192
    ds_read_b128 v[100:103], v19 offset:12288
    s_waitcnt vmcnt(35) lgkmcnt(4)
    v_mfma_f32_32x32x16_bf16 v[64:79], v[104:107], v[212:215], v[64:79]
    v_mfma_f32_32x32x16_bf16 v[80:95], v[108:111], v[212:215], v[80:95]
    buffer_load_dwordx4 v[212:215], v21, s[12:15], s22 offen offset:1024
    s_waitcnt vmcnt(37) lgkmcnt(0)
    s_barrier
    ds_read_b128 v[104:107], v12 offset:0
    ds_read_b128 v[108:111], v12 offset:4096
    s_waitcnt vmcnt(35) lgkmcnt(4)
    v_mfma_f32_32x32x16_bf16 v[64:79], v[112:115], v[216:219], v[64:79]
    v_mfma_f32_32x32x16_bf16 v[80:95], v[116:119], v[216:219], v[80:95]
    buffer_load_dwordx4 v[216:219], v21, s[12:15], s22 offen offset:2048
    s_add_u32 m0, s44, 65536
    s_add_u32 s21, s19, 9
    s_and_b32 s21, s21, 15
    s_lshl_b32 s21, s21, 7
    buffer_load_dwordx4 v8, s[4:7], s21 offen offset:0 lds
    ds_read_b128 v[112:115], v13 offset:0
    ds_read_b128 v[116:119], v13 offset:4096
    s_waitcnt vmcnt(35) lgkmcnt(4)
    v_mfma_f32_32x32x16_bf16 v[64:79], v[96:99], v[220:223], v[64:79]
    v_mfma_f32_32x32x16_bf16 v[80:95], v[100:103], v[220:223], v[80:95]
    buffer_load_dwordx4 v[220:223], v21, s[12:15], s22 offen offset:3072
    ds_read_b128 v[96:99], v14 offset:0
    ds_read_b128 v[100:103], v14 offset:4096
    s_waitcnt vmcnt(35) lgkmcnt(4)
    v_mfma_f32_32x32x16_bf16 v[64:79], v[104:107], v[224:227], v[64:79]
    v_mfma_f32_32x32x16_bf16 v[80:95], v[108:111], v[224:227], v[80:95]
    s_add_u32 s22, s19, 8
    s_and_b32 s22, s22, 15
    s_lshl_b32 s22, s22, 15
    s_add_u32 s22, s22, s20
    buffer_load_dwordx4 v[224:227], v20, s[12:15], s22 offen offset:0
    buffer_load_dwordx4 v9, s[4:7], s21 offen offset:1024 lds
    v_lshlrev_b32 v152, 16, v156
    v_and_b32 v153, s23, v156
    v_lshlrev_b32 v154, 16, v157
    v_and_b32 v155, s23, v157
    ds_read_b128 v[104:107], v15 offset:0
    ds_read_b128 v[108:111], v15 offset:4096
    s_waitcnt vmcnt(35) lgkmcnt(4)
    v_mfma_f32_32x32x16_bf16 v[64:79], v[112:115], v[228:231], v[64:79]
    v_mfma_f32_32x32x16_bf16 v[80:95], v[116:119], v[228:231], v[80:95]
    buffer_load_dwordx4 v[228:231], v20, s[12:15], s22 offen offset:1024
    v_sub_f32 v30, 1.0, v56
    v_cvt_pk_bf16_f32 v30, v30, v30
    v_lshlrev_b32 v30, 16, v30
    v_lshlrev_b32 v26, 16, v40
    ds_read_b128 v[112:115], v12 offset:8192
    ds_read_b128 v[116:119], v12 offset:12288
    s_waitcnt vmcnt(35) lgkmcnt(4)
    v_mfma_f32_32x32x16_bf16 v[64:79], v[96:99], v[232:235], v[64:79]
    v_mfma_f32_32x32x16_bf16 v[80:95], v[100:103], v[232:235], v[80:95]
    buffer_load_dwordx4 v[232:235], v20, s[12:15], s22 offen offset:2048
    buffer_load_dwordx4 v10, s[4:7], s21 offen offset:2048 lds
    v_and_b32 v27, s23, v40
    v_mul_f32 v28, v26, v152
    v_mul_f32 v29, v27, v153
    v_cvt_pk_bf16_f32 v28, v28, v29
    ds_read_b128 v[96:99], v13 offset:8192
    ds_read_b128 v[100:103], v13 offset:12288
    s_waitcnt vmcnt(35) lgkmcnt(4)
    v_mfma_f32_32x32x16_bf16 v[64:79], v[104:107], v[236:239], v[64:79]
    v_mfma_f32_32x32x16_bf16 v[80:95], v[108:111], v[236:239], v[80:95]
    buffer_load_dwordx4 v[236:239], v20, s[12:15], s22 offen offset:3072
    v_mul_f32 v26, v26, v30
    v_mul_f32 v27, v27, v30
    v_cvt_pk_bf16_f32 v26, v26, v27
    v_and_b32 v29, s23, v28
    ds_read_b128 v[104:107], v14 offset:8192
    ds_read_b128 v[108:111], v14 offset:12288
    s_waitcnt vmcnt(35) lgkmcnt(4)
    v_mfma_f32_32x32x16_bf16 v[64:79], v[112:115], v[240:243], v[64:79]
    v_mfma_f32_32x32x16_bf16 v[80:95], v[116:119], v[240:243], v[80:95]
    buffer_load_dwordx4 v[240:243], v21, s[12:15], s22 offen offset:0
    buffer_load_dwordx4 v11, s[4:7], s21 offen offset:3072 lds
    v_lshlrev_b32 v28, 16, v28
    v_and_b32 v27, s23, v26
    v_lshlrev_b32 v26, 16, v26
    v_fma_f32 v120, v56, v28, v26
    ds_read_b128 v[112:115], v15 offset:8192
    ds_read_b128 v[116:119], v15 offset:12288
    s_waitcnt vmcnt(35) lgkmcnt(4)
    v_mfma_f32_32x32x16_bf16 v[64:79], v[96:99], v[244:247], v[64:79]
    v_mfma_f32_32x32x16_bf16 v[80:95], v[100:103], v[244:247], v[80:95]
    buffer_load_dwordx4 v[244:247], v21, s[12:15], s22 offen offset:1024
    v_fma_f32 v121, v56, v29, v27
    v_lshlrev_b32 v26, 16, v41
    v_and_b32 v27, s23, v41
    v_mul_f32 v28, v26, v154
    s_waitcnt vmcnt(37) lgkmcnt(0)
    s_barrier
    ds_read_b128 v[96:99], v12 offset:16384
    ds_read_b128 v[100:103], v12 offset:20480
    s_waitcnt vmcnt(35) lgkmcnt(4)
    v_mfma_f32_32x32x16_bf16 v[64:79], v[104:107], v[248:251], v[64:79]
    v_mfma_f32_32x32x16_bf16 v[80:95], v[108:111], v[248:251], v[80:95]
    buffer_load_dwordx4 v[248:251], v21, s[12:15], s22 offen offset:2048
    s_add_u32 m0, s44, 0
    s_add_u32 s21, s19, 10
    s_and_b32 s21, s21, 15
    s_lshl_b32 s21, s21, 7
    buffer_load_dwordx4 v8, s[4:7], s21 offen offset:0 lds
    v_mul_f32 v29, v27, v155
    v_cvt_pk_bf16_f32 v28, v28, v29
    v_mul_f32 v26, v26, v30
    v_mul_f32 v27, v27, v30
    ds_read_b128 v[104:107], v13 offset:16384
    ds_read_b128 v[108:111], v13 offset:20480
    s_waitcnt vmcnt(35) lgkmcnt(4)
    v_mfma_f32_32x32x16_bf16 v[64:79], v[112:115], v[252:255], v[64:79]
    v_mfma_f32_32x32x16_bf16 v[80:95], v[116:119], v[252:255], v[80:95]
    buffer_load_dwordx4 v[252:255], v21, s[12:15], s22 offen offset:3072
    v_cvt_pk_bf16_f32 v26, v26, v27
    v_and_b32 v29, s23, v28
    v_lshlrev_b32 v28, 16, v28
    v_and_b32 v27, s23, v26
    ds_read_b128 v[112:115], v14 offset:16384
    ds_read_b128 v[116:119], v14 offset:20480
    s_waitcnt vmcnt(35) lgkmcnt(4)
    v_mfma_f32_32x32x16_bf16 v[64:79], v[96:99], v[160:163], v[64:79]
    v_mfma_f32_32x32x16_bf16 v[80:95], v[100:103], v[160:163], v[80:95]
    s_add_u32 s22, s19, 9
    s_and_b32 s22, s22, 15
    s_lshl_b32 s22, s22, 15
    s_add_u32 s22, s22, s20
    buffer_load_dwordx4 v[160:163], v20, s[12:15], s22 offen offset:0
    buffer_load_dwordx4 v9, s[4:7], s21 offen offset:1024 lds
    v_lshlrev_b32 v26, 16, v26
    v_fma_f32 v122, v56, v28, v26
    v_fma_f32 v123, v56, v29, v27
    v_sub_f32 v30, 1.0, v57
    ds_read_b128 v[96:99], v15 offset:16384
    ds_read_b128 v[100:103], v15 offset:20480
    s_waitcnt vmcnt(35) lgkmcnt(4)
    v_mfma_f32_32x32x16_bf16 v[64:79], v[104:107], v[164:167], v[64:79]
    v_mfma_f32_32x32x16_bf16 v[80:95], v[108:111], v[164:167], v[80:95]
    buffer_load_dwordx4 v[164:167], v20, s[12:15], s22 offen offset:1024
    v_cvt_pk_bf16_f32 v30, v30, v30
    v_lshlrev_b32 v30, 16, v30
    v_lshlrev_b32 v26, 16, v42
    v_and_b32 v27, s23, v42
    ds_read_b128 v[104:107], v12 offset:24576
    ds_read_b128 v[108:111], v12 offset:28672
    s_waitcnt vmcnt(35) lgkmcnt(4)
    v_mfma_f32_32x32x16_bf16 v[64:79], v[112:115], v[168:171], v[64:79]
    v_mfma_f32_32x32x16_bf16 v[80:95], v[116:119], v[168:171], v[80:95]
    buffer_load_dwordx4 v[168:171], v20, s[12:15], s22 offen offset:2048
    buffer_load_dwordx4 v10, s[4:7], s21 offen offset:2048 lds
    v_mul_f32 v28, v26, v152
    v_mul_f32 v29, v27, v153
    v_cvt_pk_bf16_f32 v28, v28, v29
    v_mul_f32 v26, v26, v30
    ds_read_b128 v[112:115], v13 offset:24576
    ds_read_b128 v[116:119], v13 offset:28672
    s_waitcnt vmcnt(35) lgkmcnt(4)
    v_mfma_f32_32x32x16_bf16 v[64:79], v[96:99], v[172:175], v[64:79]
    v_mfma_f32_32x32x16_bf16 v[80:95], v[100:103], v[172:175], v[80:95]
    buffer_load_dwordx4 v[172:175], v20, s[12:15], s22 offen offset:3072
    v_mul_f32 v27, v27, v30
    v_cvt_pk_bf16_f32 v26, v26, v27
    v_and_b32 v29, s23, v28
    v_lshlrev_b32 v28, 16, v28
    ds_read_b128 v[96:99], v14 offset:24576
    ds_read_b128 v[100:103], v14 offset:28672
    s_waitcnt vmcnt(35) lgkmcnt(4)
    v_mfma_f32_32x32x16_bf16 v[64:79], v[104:107], v[176:179], v[64:79]
    v_mfma_f32_32x32x16_bf16 v[80:95], v[108:111], v[176:179], v[80:95]
    buffer_load_dwordx4 v[176:179], v21, s[12:15], s22 offen offset:0
    buffer_load_dwordx4 v11, s[4:7], s21 offen offset:3072 lds
    v_and_b32 v27, s23, v26
    v_lshlrev_b32 v26, 16, v26
    v_fma_f32 v124, v57, v28, v26
    v_fma_f32 v125, v57, v29, v27
    ds_read_b128 v[104:107], v15 offset:24576
    ds_read_b128 v[108:111], v15 offset:28672
    s_waitcnt vmcnt(35) lgkmcnt(4)
    v_mfma_f32_32x32x16_bf16 v[64:79], v[112:115], v[180:183], v[64:79]
    v_mfma_f32_32x32x16_bf16 v[80:95], v[116:119], v[180:183], v[80:95]
    buffer_load_dwordx4 v[180:183], v21, s[12:15], s22 offen offset:1024
    v_lshlrev_b32 v26, 16, v43
    v_and_b32 v27, s23, v43
    v_mul_f32 v28, v26, v154
    v_mul_f32 v29, v27, v155
    s_waitcnt vmcnt(37) lgkmcnt(0)
    s_barrier
    ds_read_b128 v[112:115], v12 offset:32768
    ds_read_b128 v[116:119], v12 offset:36864
    s_waitcnt vmcnt(35) lgkmcnt(4)
    v_mfma_f32_32x32x16_bf16 v[64:79], v[96:99], v[184:187], v[64:79]
    v_mfma_f32_32x32x16_bf16 v[80:95], v[100:103], v[184:187], v[80:95]
    buffer_load_dwordx4 v[184:187], v21, s[12:15], s22 offen offset:2048
    s_add_u32 m0, s44, 16384
    s_add_u32 s21, s19, 11
    s_and_b32 s21, s21, 15
    s_lshl_b32 s21, s21, 7
    buffer_load_dwordx4 v8, s[4:7], s21 offen offset:0 lds
    v_cvt_pk_bf16_f32 v28, v28, v29
    v_mul_f32 v26, v26, v30
    v_mul_f32 v27, v27, v30
    v_cvt_pk_bf16_f32 v26, v26, v27
    ds_read_b128 v[96:99], v13 offset:32768
    ds_read_b128 v[100:103], v13 offset:36864
    s_waitcnt vmcnt(35) lgkmcnt(4)
    v_mfma_f32_32x32x16_bf16 v[64:79], v[104:107], v[188:191], v[64:79]
    v_mfma_f32_32x32x16_bf16 v[80:95], v[108:111], v[188:191], v[80:95]
    buffer_load_dwordx4 v[188:191], v21, s[12:15], s22 offen offset:3072
    v_and_b32 v29, s23, v28
    v_lshlrev_b32 v28, 16, v28
    v_and_b32 v27, s23, v26
    v_lshlrev_b32 v26, 16, v26
    ds_read_b128 v[104:107], v14 offset:32768
    ds_read_b128 v[108:111], v14 offset:36864
    s_waitcnt vmcnt(35) lgkmcnt(4)
    v_mfma_f32_32x32x16_bf16 v[64:79], v[112:115], v[192:195], v[64:79]
    v_mfma_f32_32x32x16_bf16 v[80:95], v[116:119], v[192:195], v[80:95]
    s_add_u32 s22, s19, 10
    s_and_b32 s22, s22, 15
    s_lshl_b32 s22, s22, 15
    s_add_u32 s22, s22, s20
    buffer_load_dwordx4 v[192:195], v20, s[12:15], s22 offen offset:0
    buffer_load_dwordx4 v9, s[4:7], s21 offen offset:1024 lds
    v_fma_f32 v126, v57, v28, v26
    v_fma_f32 v127, v57, v29, v27
    v_sub_f32 v30, 1.0, v58
    v_cvt_pk_bf16_f32 v30, v30, v30
    ds_read_b128 v[112:115], v15 offset:32768
    ds_read_b128 v[116:119], v15 offset:36864
    s_waitcnt vmcnt(35) lgkmcnt(4)
    v_mfma_f32_32x32x16_bf16 v[64:79], v[96:99], v[196:199], v[64:79]
    v_mfma_f32_32x32x16_bf16 v[80:95], v[100:103], v[196:199], v[80:95]
    buffer_load_dwordx4 v[196:199], v20, s[12:15], s22 offen offset:1024
    v_lshlrev_b32 v30, 16, v30
    v_lshlrev_b32 v26, 16, v44
    v_and_b32 v27, s23, v44
    v_mul_f32 v28, v26, v152
    ds_read_b128 v[96:99], v12 offset:40960
    ds_read_b128 v[100:103], v12 offset:45056
    s_waitcnt vmcnt(35) lgkmcnt(4)
    v_mfma_f32_32x32x16_bf16 v[64:79], v[104:107], v[200:203], v[64:79]
    v_mfma_f32_32x32x16_bf16 v[80:95], v[108:111], v[200:203], v[80:95]
    buffer_load_dwordx4 v[200:203], v20, s[12:15], s22 offen offset:2048
    buffer_load_dwordx4 v10, s[4:7], s21 offen offset:2048 lds
    v_mul_f32 v29, v27, v153
    v_cvt_pk_bf16_f32 v28, v28, v29
    v_mul_f32 v26, v26, v30
    v_mul_f32 v27, v27, v30
    ds_read_b128 v[104:107], v13 offset:40960
    ds_read_b128 v[108:111], v13 offset:45056
    s_waitcnt vmcnt(35) lgkmcnt(4)
    v_mfma_f32_32x32x16_bf16 v[64:79], v[112:115], v[204:207], v[64:79]
    v_mfma_f32_32x32x16_bf16 v[80:95], v[116:119], v[204:207], v[80:95]
    buffer_load_dwordx4 v[204:207], v20, s[12:15], s22 offen offset:3072
    v_cvt_pk_bf16_f32 v26, v26, v27
    v_and_b32 v29, s23, v28
    v_lshlrev_b32 v28, 16, v28
    v_and_b32 v27, s23, v26
    ds_read_b128 v[112:115], v14 offset:40960
    ds_read_b128 v[116:119], v14 offset:45056
    s_waitcnt vmcnt(35) lgkmcnt(4)
    v_mfma_f32_32x32x16_bf16 v[64:79], v[96:99], v[208:211], v[64:79]
    v_mfma_f32_32x32x16_bf16 v[80:95], v[100:103], v[208:211], v[80:95]
    buffer_load_dwordx4 v[208:211], v21, s[12:15], s22 offen offset:0
    buffer_load_dwordx4 v11, s[4:7], s21 offen offset:3072 lds
    v_lshlrev_b32 v26, 16, v26
    v_fma_f32 v128, v58, v28, v26
    v_fma_f32 v129, v58, v29, v27
    v_lshlrev_b32 v26, 16, v45
    ds_read_b128 v[96:99], v15 offset:40960
    ds_read_b128 v[100:103], v15 offset:45056
    s_waitcnt vmcnt(35) lgkmcnt(4)
    v_mfma_f32_32x32x16_bf16 v[64:79], v[104:107], v[212:215], v[64:79]
    v_mfma_f32_32x32x16_bf16 v[80:95], v[108:111], v[212:215], v[80:95]
    buffer_load_dwordx4 v[212:215], v21, s[12:15], s22 offen offset:1024
    v_and_b32 v27, s23, v45
    v_mul_f32 v28, v26, v154
    v_mul_f32 v29, v27, v155
    v_cvt_pk_bf16_f32 v28, v28, v29
    s_waitcnt vmcnt(37) lgkmcnt(0)
    s_barrier
    ds_read_b128 v[104:107], v12 offset:49152
    ds_read_b128 v[108:111], v12 offset:53248
    s_waitcnt vmcnt(35) lgkmcnt(4)
    v_mfma_f32_32x32x16_bf16 v[64:79], v[112:115], v[216:219], v[64:79]
    v_mfma_f32_32x32x16_bf16 v[80:95], v[116:119], v[216:219], v[80:95]
    buffer_load_dwordx4 v[216:219], v21, s[12:15], s22 offen offset:2048
    s_add_u32 m0, s44, 32768
    s_add_u32 s21, s19, 12
    s_and_b32 s21, s21, 15
    s_lshl_b32 s21, s21, 7
    buffer_load_dwordx4 v8, s[4:7], s21 offen offset:0 lds
    v_mul_f32 v26, v26, v30
    v_mul_f32 v27, v27, v30
    v_cvt_pk_bf16_f32 v26, v26, v27
    v_and_b32 v29, s23, v28
    ds_read_b128 v[112:115], v13 offset:49152
    ds_read_b128 v[116:119], v13 offset:53248
    s_waitcnt vmcnt(35) lgkmcnt(4)
    v_mfma_f32_32x32x16_bf16 v[64:79], v[96:99], v[220:223], v[64:79]
    v_mfma_f32_32x32x16_bf16 v[80:95], v[100:103], v[220:223], v[80:95]
    buffer_load_dwordx4 v[220:223], v21, s[12:15], s22 offen offset:3072
    v_lshlrev_b32 v28, 16, v28
    v_and_b32 v27, s23, v26
    v_lshlrev_b32 v26, 16, v26
    v_fma_f32 v130, v58, v28, v26
    ds_read_b128 v[96:99], v14 offset:49152
    ds_read_b128 v[100:103], v14 offset:53248
    s_waitcnt vmcnt(35) lgkmcnt(4)
    v_mfma_f32_32x32x16_bf16 v[64:79], v[104:107], v[224:227], v[64:79]
    v_mfma_f32_32x32x16_bf16 v[80:95], v[108:111], v[224:227], v[80:95]
    s_add_u32 s22, s19, 11
    s_and_b32 s22, s22, 15
    s_lshl_b32 s22, s22, 15
    s_add_u32 s22, s22, s20
    buffer_load_dwordx4 v[224:227], v20, s[12:15], s22 offen offset:0
    buffer_load_dwordx4 v9, s[4:7], s21 offen offset:1024 lds
    v_fma_f32 v131, v58, v29, v27
    v_sub_f32 v30, 1.0, v59
    v_cvt_pk_bf16_f32 v30, v30, v30
    v_lshlrev_b32 v30, 16, v30
    ds_read_b128 v[104:107], v15 offset:49152
    ds_read_b128 v[108:111], v15 offset:53248
    s_waitcnt vmcnt(35) lgkmcnt(4)
    v_mfma_f32_32x32x16_bf16 v[64:79], v[112:115], v[228:231], v[64:79]
    v_mfma_f32_32x32x16_bf16 v[80:95], v[116:119], v[228:231], v[80:95]
    buffer_load_dwordx4 v[228:231], v20, s[12:15], s22 offen offset:1024
    v_lshlrev_b32 v26, 16, v46
    v_and_b32 v27, s23, v46
    v_mul_f32 v28, v26, v152
    v_mul_f32 v29, v27, v153
    ds_read_b128 v[112:115], v12 offset:57344
    ds_read_b128 v[116:119], v12 offset:61440
    s_waitcnt vmcnt(35) lgkmcnt(4)
    v_mfma_f32_32x32x16_bf16 v[64:79], v[96:99], v[232:235], v[64:79]
    v_mfma_f32_32x32x16_bf16 v[80:95], v[100:103], v[232:235], v[80:95]
    buffer_load_dwordx4 v[232:235], v20, s[12:15], s22 offen offset:2048
    buffer_load_dwordx4 v10, s[4:7], s21 offen offset:2048 lds
    v_cvt_pk_bf16_f32 v28, v28, v29
    v_mul_f32 v26, v26, v30
    v_mul_f32 v27, v27, v30
    v_cvt_pk_bf16_f32 v26, v26, v27
    ds_read_b128 v[96:99], v13 offset:57344
    ds_read_b128 v[100:103], v13 offset:61440
    s_waitcnt vmcnt(35) lgkmcnt(4)
    v_mfma_f32_32x32x16_bf16 v[64:79], v[104:107], v[236:239], v[64:79]
    v_mfma_f32_32x32x16_bf16 v[80:95], v[108:111], v[236:239], v[80:95]
    buffer_load_dwordx4 v[236:239], v20, s[12:15], s22 offen offset:3072
    v_and_b32 v29, s23, v28
    v_lshlrev_b32 v28, 16, v28
    v_and_b32 v27, s23, v26
    v_lshlrev_b32 v26, 16, v26
    ds_read_b128 v[104:107], v14 offset:57344
    ds_read_b128 v[108:111], v14 offset:61440
    s_waitcnt vmcnt(35) lgkmcnt(4)
    v_mfma_f32_32x32x16_bf16 v[64:79], v[112:115], v[240:243], v[64:79]
    v_mfma_f32_32x32x16_bf16 v[80:95], v[116:119], v[240:243], v[80:95]
    buffer_load_dwordx4 v[240:243], v21, s[12:15], s22 offen offset:0
    buffer_load_dwordx4 v11, s[4:7], s21 offen offset:3072 lds
    v_fma_f32 v132, v59, v28, v26
    v_fma_f32 v133, v59, v29, v27
    v_lshlrev_b32 v26, 16, v47
    v_and_b32 v27, s23, v47
    ds_read_b128 v[112:115], v15 offset:57344
    ds_read_b128 v[116:119], v15 offset:61440
    s_waitcnt vmcnt(35) lgkmcnt(4)
    v_mfma_f32_32x32x16_bf16 v[64:79], v[96:99], v[244:247], v[64:79]
    v_mfma_f32_32x32x16_bf16 v[80:95], v[100:103], v[244:247], v[80:95]
    buffer_load_dwordx4 v[244:247], v21, s[12:15], s22 offen offset:1024
    v_mul_f32 v28, v26, v154
    v_mul_f32 v29, v27, v155
    v_cvt_pk_bf16_f32 v28, v28, v29
    v_mul_f32 v26, v26, v30
    s_waitcnt vmcnt(37) lgkmcnt(0)
    s_barrier
    ds_read_b128 v[96:99], v16 offset:0
    ds_read_b128 v[100:103], v16 offset:4096
    s_waitcnt vmcnt(35) lgkmcnt(4)
    v_mfma_f32_32x32x16_bf16 v[64:79], v[104:107], v[248:251], v[64:79]
    v_mfma_f32_32x32x16_bf16 v[80:95], v[108:111], v[248:251], v[80:95]
    buffer_load_dwordx4 v[248:251], v21, s[12:15], s22 offen offset:2048
    s_add_u32 m0, s44, 49152
    s_add_u32 s21, s19, 13
    s_and_b32 s21, s21, 15
    s_lshl_b32 s21, s21, 7
    buffer_load_dwordx4 v8, s[4:7], s21 offen offset:0 lds
    v_mul_f32 v27, v27, v30
    v_cvt_pk_bf16_f32 v26, v26, v27
    v_and_b32 v29, s23, v28
    v_lshlrev_b32 v28, 16, v28
    ds_read_b128 v[104:107], v17 offset:0
    ds_read_b128 v[108:111], v17 offset:4096
    s_waitcnt vmcnt(35) lgkmcnt(4)
    v_mfma_f32_32x32x16_bf16 v[64:79], v[112:115], v[252:255], v[64:79]
    v_mfma_f32_32x32x16_bf16 v[80:95], v[116:119], v[252:255], v[80:95]
    buffer_load_dwordx4 v[252:255], v21, s[12:15], s22 offen offset:3072
    v_and_b32 v27, s23, v26
    v_lshlrev_b32 v26, 16, v26
    v_fma_f32 v134, v59, v28, v26
    v_fma_f32 v135, v59, v29, v27
    ds_read_b128 v[112:115], v18 offset:0
    ds_read_b128 v[116:119], v18 offset:4096
    s_waitcnt vmcnt(35) lgkmcnt(4)
    v_mfma_f32_32x32x16_bf16 v[64:79], v[96:99], v[160:163], v[64:79]
    v_mfma_f32_32x32x16_bf16 v[80:95], v[100:103], v[160:163], v[80:95]
    s_add_u32 s22, s19, 12
    s_and_b32 s22, s22, 15
    s_lshl_b32 s22, s22, 15
    s_add_u32 s22, s22, s20
    buffer_load_dwordx4 v[160:163], v20, s[12:15], s22 offen offset:0
    buffer_load_dwordx4 v9, s[4:7], s21 offen offset:1024 lds
    v_sub_f32 v30, 1.0, v60
    v_cvt_pk_bf16_f32 v30, v30, v30
    v_lshlrev_b32 v30, 16, v30
    v_lshlrev_b32 v26, 16, v48
    ds_read_b128 v[96:99], v19 offset:0
    ds_read_b128 v[100:103], v19 offset:4096
    s_waitcnt vmcnt(35) lgkmcnt(4)
    v_mfma_f32_32x32x16_bf16 v[64:79], v[104:107], v[164:167], v[64:79]
    v_mfma_f32_32x32x16_bf16 v[80:95], v[108:111], v[164:167], v[80:95]
    buffer_load_dwordx4 v[164:167], v20, s[12:15], s22 offen offset:1024
    v_and_b32 v27, s23, v48
    v_mul_f32 v28, v26, v152
    v_mul_f32 v29, v27, v153
    v_cvt_pk_bf16_f32 v28, v28, v29
    ds_read_b128 v[104:107], v16 offset:8192
    ds_read_b128 v[108:111], v16 offset:12288
    s_waitcnt vmcnt(35) lgkmcnt(4)
    v_mfma_f32_32x32x16_bf16 v[64:79], v[112:115], v[168:171], v[64:79]
    v_mfma_f32_32x32x16_bf16 v[80:95], v[116:119], v[168:171], v[80:95]
    buffer_load_dwordx4 v[168:171], v20, s[12:15], s22 offen offset:2048
    buffer_load_dwordx4 v10, s[4:7], s21 offen offset:2048 lds
    v_mul_f32 v26, v26, v30
    v_mul_f32 v27, v27, v30
    v_cvt_pk_bf16_f32 v26, v26, v27
    v_and_b32 v29, s23, v28
    ds_read_b128 v[112:115], v17 offset:8192
    ds_read_b128 v[116:119], v17 offset:12288
    s_waitcnt vmcnt(35) lgkmcnt(4)
    v_mfma_f32_32x32x16_bf16 v[64:79], v[96:99], v[172:175], v[64:79]
    v_mfma_f32_32x32x16_bf16 v[80:95], v[100:103], v[172:175], v[80:95]
    buffer_load_dwordx4 v[172:175], v20, s[12:15], s22 offen offset:3072
    v_lshlrev_b32 v28, 16, v28
    v_and_b32 v27, s23, v26
    v_lshlrev_b32 v26, 16, v26
    v_fma_f32 v136, v60, v28, v26
    ds_read_b128 v[96:99], v18 offset:8192
    ds_read_b128 v[100:103], v18 offset:12288
    s_waitcnt vmcnt(35) lgkmcnt(4)
    v_mfma_f32_32x32x16_bf16 v[64:79], v[104:107], v[176:179], v[64:79]
    v_mfma_f32_32x32x16_bf16 v[80:95], v[108:111], v[176:179], v[80:95]
    buffer_load_dwordx4 v[176:179], v21, s[12:15], s22 offen offset:0
    buffer_load_dwordx4 v11, s[4:7], s21 offen offset:3072 lds
    v_fma_f32 v137, v60, v29, v27
    v_lshlrev_b32 v26, 16, v49
    v_and_b32 v27, s23, v49
    v_mul_f32 v28, v26, v154
    ds_read_b128 v[104:107], v19 offset:8192
    ds_read_b128 v[108:111], v19 offset:12288
    s_waitcnt vmcnt(35) lgkmcnt(4)
    v_mfma_f32_32x32x16_bf16 v[64:79], v[112:115], v[180:183], v[64:79]
    v_mfma_f32_32x32x16_bf16 v[80:95], v[116:119], v[180:183], v[80:95]
    buffer_load_dwordx4 v[180:183], v21, s[12:15], s22 offen offset:1024
    v_mul_f32 v29, v27, v155
    v_cvt_pk_bf16_f32 v28, v28, v29
    v_mul_f32 v26, v26, v30
    v_mul_f32 v27, v27, v30
    s_waitcnt vmcnt(37) lgkmcnt(0)
    s_barrier
    ds_read_b128 v[112:115], v12 offset:0
    ds_read_b128 v[116:119], v12 offset:4096
    s_waitcnt vmcnt(35) lgkmcnt(4)
    v_mfma_f32_32x32x16_bf16 v[64:79], v[96:99], v[184:187], v[64:79]
    v_mfma_f32_32x32x16_bf16 v[80:95], v[100:103], v[184:187], v[80:95]
    buffer_load_dwordx4 v[184:187], v21, s[12:15], s22 offen offset:2048
    s_add_u32 m0, s44, 65536
    s_add_u32 s21, s19, 14
    s_and_b32 s21, s21, 15
    s_lshl_b32 s21, s21, 7
    buffer_load_dwordx4 v8, s[4:7], s21 offen offset:0 lds
    v_cvt_pk_bf16_f32 v26, v26, v27
    v_and_b32 v29, s23, v28
    v_lshlrev_b32 v28, 16, v28
    v_and_b32 v27, s23, v26
    ds_read_b128 v[96:99], v13 offset:0
    ds_read_b128 v[100:103], v13 offset:4096
    s_waitcnt vmcnt(35) lgkmcnt(4)
    v_mfma_f32_32x32x16_bf16 v[64:79], v[104:107], v[188:191], v[64:79]
    v_mfma_f32_32x32x16_bf16 v[80:95], v[108:111], v[188:191], v[80:95]
    buffer_load_dwordx4 v[188:191], v21, s[12:15], s22 offen offset:3072
    v_lshlrev_b32 v26, 16, v26
    v_fma_f32 v138, v60, v28, v26
    v_fma_f32 v139, v60, v29, v27
    v_sub_f32 v30, 1.0, v61
    ds_read_b128 v[104:107], v14 offset:0
    ds_read_b128 v[108:111], v14 offset:4096
    s_waitcnt vmcnt(35) lgkmcnt(4)
    v_mfma_f32_32x32x16_bf16 v[64:79], v[112:115], v[192:195], v[64:79]
    v_mfma_f32_32x32x16_bf16 v[80:95], v[116:119], v[192:195], v[80:95]
    s_add_u32 s22, s19, 13
    s_and_b32 s22, s22, 15
    s_lshl_b32 s22, s22, 15
    s_add_u32 s22, s22, s20
    buffer_load_dwordx4 v[192:195], v20, s[12:15], s22 offen offset:0
    buffer_load_dwordx4 v9, s[4:7], s21 offen offset:1024 lds
    v_cvt_pk_bf16_f32 v30, v30, v30
    v_lshlrev_b32 v30, 16, v30
    v_lshlrev_b32 v26, 16, v50
    v_and_b32 v27, s23, v50
    ds_read_b128 v[112:115], v15 offset:0
    ds_read_b128 v[116:119], v15 offset:4096
    s_waitcnt vmcnt(35) lgkmcnt(4)
    v_mfma_f32_32x32x16_bf16 v[64:79], v[96:99], v[196:199], v[64:79]
    v_mfma_f32_32x32x16_bf16 v[80:95], v[100:103], v[196:199], v[80:95]
    buffer_load_dwordx4 v[196:199], v20, s[12:15], s22 offen offset:1024
    v_mul_f32 v28, v26, v152
    v_mul_f32 v29, v27, v153
    v_cvt_pk_bf16_f32 v28, v28, v29
    v_mul_f32 v26, v26, v30
    ds_read_b128 v[96:99], v12 offset:8192
    ds_read_b128 v[100:103], v12 offset:12288
    s_waitcnt vmcnt(35) lgkmcnt(4)
    v_mfma_f32_32x32x16_bf16 v[64:79], v[104:107], v[200:203], v[64:79]
    v_mfma_f32_32x32x16_bf16 v[80:95], v[108:111], v[200:203], v[80:95]
    buffer_load_dwordx4 v[200:203], v20, s[12:15], s22 offen offset:2048
    buffer_load_dwordx4 v10, s[4:7], s21 offen offset:2048 lds
    v_mul_f32 v27, v27, v30
    v_cvt_pk_bf16_f32 v26, v26, v27
    v_and_b32 v29, s23, v28
    v_lshlrev_b32 v28, 16, v28
    ds_read_b128 v[104:107], v13 offset:8192
    ds_read_b128 v[108:111], v13 offset:12288
    s_waitcnt vmcnt(35) lgkmcnt(4)
    v_mfma_f32_32x32x16_bf16 v[64:79], v[112:115], v[204:207], v[64:79]
    v_mfma_f32_32x32x16_bf16 v[80:95], v[116:119], v[204:207], v[80:95]
    buffer_load_dwordx4 v[204:207], v20, s[12:15], s22 offen offset:3072
    v_and_b32 v27, s23, v26
    v_lshlrev_b32 v26, 16, v26
    v_fma_f32 v140, v61, v28, v26
    v_fma_f32 v141, v61, v29, v27
    ds_read_b128 v[112:115], v14 offset:8192
    ds_read_b128 v[116:119], v14 offset:12288
    s_waitcnt vmcnt(35) lgkmcnt(4)
    v_mfma_f32_32x32x16_bf16 v[64:79], v[96:99], v[208:211], v[64:79]
    v_mfma_f32_32x32x16_bf16 v[80:95], v[100:103], v[208:211], v[80:95]
    buffer_load_dwordx4 v[208:211], v21, s[12:15], s22 offen offset:0
    buffer_load_dwordx4 v11, s[4:7], s21 offen offset:3072 lds
    v_lshlrev_b32 v26, 16, v51
    v_and_b32 v27, s23, v51
    v_mul_f32 v28, v26, v154
    v_mul_f32 v29, v27, v155
    ds_read_b128 v[96:99], v15 offset:8192
    ds_read_b128 v[100:103], v15 offset:12288
    s_waitcnt vmcnt(35) lgkmcnt(4)
    v_mfma_f32_32x32x16_bf16 v[64:79], v[104:107], v[212:215], v[64:79]
    v_mfma_f32_32x32x16_bf16 v[80:95], v[108:111], v[212:215], v[80:95]
    buffer_load_dwordx4 v[212:215], v21, s[12:15], s22 offen offset:1024
    v_cvt_pk_bf16_f32 v28, v28, v29
    v_mul_f32 v26, v26, v30
    v_mul_f32 v27, v27, v30
    v_cvt_pk_bf16_f32 v26, v26, v27
    s_waitcnt vmcnt(37) lgkmcnt(0)
    s_barrier
    ds_read_b128 v[104:107], v12 offset:16384
    ds_read_b128 v[108:111], v12 offset:20480
    s_waitcnt vmcnt(35) lgkmcnt(4)
    v_mfma_f32_32x32x16_bf16 v[64:79], v[112:115], v[216:219], v[64:79]
    v_mfma_f32_32x32x16_bf16 v[80:95], v[116:119], v[216:219], v[80:95]
    buffer_load_dwordx4 v[216:219], v21, s[12:15], s22 offen offset:2048
    s_add_u32 m0, s44, 0
    s_add_u32 s21, s19, 15
    s_and_b32 s21, s21, 15
    s_lshl_b32 s21, s21, 7
    buffer_load_dwordx4 v8, s[4:7], s21 offen offset:0 lds
    v_and_b32 v29, s23, v28
    v_lshlrev_b32 v28, 16, v28
    v_and_b32 v27, s23, v26
    v_lshlrev_b32 v26, 16, v26
    ds_read_b128 v[112:115], v13 offset:16384
    ds_read_b128 v[116:119], v13 offset:20480
    s_waitcnt vmcnt(35) lgkmcnt(4)
    v_mfma_f32_32x32x16_bf16 v[64:79], v[96:99], v[220:223], v[64:79]
    v_mfma_f32_32x32x16_bf16 v[80:95], v[100:103], v[220:223], v[80:95]
    buffer_load_dwordx4 v[220:223], v21, s[12:15], s22 offen offset:3072
    v_fma_f32 v142, v61, v28, v26
    v_fma_f32 v143, v61, v29, v27
    v_sub_f32 v30, 1.0, v62
    v_cvt_pk_bf16_f32 v30, v30, v30
    ds_read_b128 v[96:99], v14 offset:16384
    ds_read_b128 v[100:103], v14 offset:20480
    s_waitcnt vmcnt(35) lgkmcnt(4)
    v_mfma_f32_32x32x16_bf16 v[64:79], v[104:107], v[224:227], v[64:79]
    v_mfma_f32_32x32x16_bf16 v[80:95], v[108:111], v[224:227], v[80:95]
    s_add_u32 s22, s19, 14
    s_and_b32 s22, s22, 15
    s_lshl_b32 s22, s22, 15
    s_add_u32 s22, s22, s20
    buffer_load_dwordx4 v[224:227], v20, s[12:15], s22 offen offset:0
    buffer_load_dwordx4 v9, s[4:7], s21 offen offset:1024 lds
    v_lshlrev_b32 v30, 16, v30
    v_lshlrev_b32 v26, 16, v52
    v_and_b32 v27, s23, v52
    v_mul_f32 v28, v26, v152
    ds_read_b128 v[104:107], v15 offset:16384
    ds_read_b128 v[108:111], v15 offset:20480
    s_waitcnt vmcnt(35) lgkmcnt(4)
    v_mfma_f32_32x32x16_bf16 v[64:79], v[112:115], v[228:231], v[64:79]
    v_mfma_f32_32x32x16_bf16 v[80:95], v[116:119], v[228:231], v[80:95]
    buffer_load_dwordx4 v[228:231], v20, s[12:15], s22 offen offset:1024
    v_mul_f32 v29, v27, v153
    v_cvt_pk_bf16_f32 v28, v28, v29
    v_mul_f32 v26, v26, v30
    v_mul_f32 v27, v27, v30
    ds_read_b128 v[112:115], v12 offset:24576
    ds_read_b128 v[116:119], v12 offset:28672
    s_waitcnt vmcnt(35) lgkmcnt(4)
    v_mfma_f32_32x32x16_bf16 v[64:79], v[96:99], v[232:235], v[64:79]
    v_mfma_f32_32x32x16_bf16 v[80:95], v[100:103], v[232:235], v[80:95]
    buffer_load_dwordx4 v[232:235], v20, s[12:15], s22 offen offset:2048
    buffer_load_dwordx4 v10, s[4:7], s21 offen offset:2048 lds
    v_cvt_pk_bf16_f32 v26, v26, v27
    v_and_b32 v29, s23, v28
    v_lshlrev_b32 v28, 16, v28
    v_and_b32 v27, s23, v26
    ds_read_b128 v[96:99], v13 offset:24576
    ds_read_b128 v[100:103], v13 offset:28672
    s_waitcnt vmcnt(35) lgkmcnt(4)
    v_mfma_f32_32x32x16_bf16 v[64:79], v[104:107], v[236:239], v[64:79]
    v_mfma_f32_32x32x16_bf16 v[80:95], v[108:111], v[236:239], v[80:95]
    buffer_load_dwordx4 v[236:239], v20, s[12:15], s22 offen offset:3072
    v_lshlrev_b32 v26, 16, v26
    v_fma_f32 v144, v62, v28, v26
    v_fma_f32 v145, v62, v29, v27
    v_lshlrev_b32 v26, 16, v53
    ds_read_b128 v[104:107], v14 offset:24576
    ds_read_b128 v[108:111], v14 offset:28672
    s_waitcnt vmcnt(35) lgkmcnt(4)
    v_mfma_f32_32x32x16_bf16 v[64:79], v[112:115], v[240:243], v[64:79]
    v_mfma_f32_32x32x16_bf16 v[80:95], v[116:119], v[240:243], v[80:95]
    buffer_load_dwordx4 v[240:243], v21, s[12:15], s22 offen offset:0
    buffer_load_dwordx4 v11, s[4:7], s21 offen offset:3072 lds
    v_and_b32 v27, s23, v53
    v_mul_f32 v28, v26, v154
    v_mul_f32 v29, v27, v155
    v_cvt_pk_bf16_f32 v28, v28, v29
    ds_read_b128 v[112:115], v15 offset:24576
    ds_read_b128 v[116:119], v15 offset:28672
    s_waitcnt vmcnt(35) lgkmcnt(4)
    v_mfma_f32_32x32x16_bf16 v[64:79], v[96:99], v[244:247], v[64:79]
    v_mfma_f32_32x32x16_bf16 v[80:95], v[100:103], v[244:247], v[80:95]
    buffer_load_dwordx4 v[244:247], v21, s[12:15], s22 offen offset:1024
    v_mul_f32 v26, v26, v30
    v_mul_f32 v27, v27, v30
    v_cvt_pk_bf16_f32 v26, v26, v27
    v_and_b32 v29, s23, v28
    s_waitcnt vmcnt(37) lgkmcnt(0)
    s_barrier
    ds_read_b128 v[96:99], v12 offset:32768
    ds_read_b128 v[100:103], v12 offset:36864
    s_waitcnt vmcnt(35) lgkmcnt(4)
    v_mfma_f32_32x32x16_bf16 v[64:79], v[104:107], v[248:251], v[64:79]
    v_mfma_f32_32x32x16_bf16 v[80:95], v[108:111], v[248:251], v[80:95]
    buffer_load_dwordx4 v[248:251], v21, s[12:15], s22 offen offset:2048
    v_lshlrev_b32 v28, 16, v28
    v_and_b32 v27, s23, v26
    v_lshlrev_b32 v26, 16, v26
    v_fma_f32 v146, v62, v28, v26
    ds_read_b128 v[104:107], v13 offset:32768
    ds_read_b128 v[108:111], v13 offset:36864
    s_waitcnt vmcnt(34) lgkmcnt(4)
    v_mfma_f32_32x32x16_bf16 v[64:79], v[112:115], v[252:255], v[64:79]
    v_mfma_f32_32x32x16_bf16 v[80:95], v[116:119], v[252:255], v[80:95]
    buffer_load_dwordx4 v[252:255], v21, s[12:15], s22 offen offset:3072
    v_fma_f32 v147, v62, v29, v27
    v_sub_f32 v30, 1.0, v63
    v_cvt_pk_bf16_f32 v30, v30, v30
    v_lshlrev_b32 v30, 16, v30
    ds_read_b128 v[112:115], v14 offset:32768
    ds_read_b128 v[116:119], v14 offset:36864
    s_waitcnt vmcnt(34) lgkmcnt(4)
    v_mfma_f32_32x32x16_bf16 v[64:79], v[96:99], v[160:163], v[64:79]
    v_mfma_f32_32x32x16_bf16 v[80:95], v[100:103], v[160:163], v[80:95]
    s_add_u32 s22, s19, 15
    s_and_b32 s22, s22, 15
    s_lshl_b32 s22, s22, 15
    s_add_u32 s22, s22, s20
    buffer_load_dwordx4 v[160:163], v20, s[12:15], s22 offen offset:0
    v_lshlrev_b32 v26, 16, v54
    v_and_b32 v27, s23, v54
    v_mul_f32 v28, v26, v152
    v_mul_f32 v29, v27, v153
    ds_read_b128 v[96:99], v15 offset:32768
    ds_read_b128 v[100:103], v15 offset:36864
    s_waitcnt vmcnt(33) lgkmcnt(4)
    v_mfma_f32_32x32x16_bf16 v[64:79], v[104:107], v[164:167], v[64:79]
    v_mfma_f32_32x32x16_bf16 v[80:95], v[108:111], v[164:167], v[80:95]
    buffer_load_dwordx4 v[164:167], v20, s[12:15], s22 offen offset:1024
    v_cvt_pk_bf16_f32 v28, v28, v29
    v_mul_f32 v26, v26, v30
    v_mul_f32 v27, v27, v30
    v_cvt_pk_bf16_f32 v26, v26, v27
    ds_read_b128 v[104:107], v12 offset:40960
    ds_read_b128 v[108:111], v12 offset:45056
    s_waitcnt vmcnt(33) lgkmcnt(4)
    v_mfma_f32_32x32x16_bf16 v[64:79], v[112:115], v[168:171], v[64:79]
    v_mfma_f32_32x32x16_bf16 v[80:95], v[116:119], v[168:171], v[80:95]
    buffer_load_dwordx4 v[168:171], v20, s[12:15], s22 offen offset:2048
    v_and_b32 v29, s23, v28
    v_lshlrev_b32 v28, 16, v28
    v_and_b32 v27, s23, v26
    v_lshlrev_b32 v26, 16, v26
    ds_read_b128 v[112:115], v13 offset:40960
    ds_read_b128 v[116:119], v13 offset:45056
    s_waitcnt vmcnt(32) lgkmcnt(4)
    v_mfma_f32_32x32x16_bf16 v[64:79], v[96:99], v[172:175], v[64:79]
    v_mfma_f32_32x32x16_bf16 v[80:95], v[100:103], v[172:175], v[80:95]
    buffer_load_dwordx4 v[172:175], v20, s[12:15], s22 offen offset:3072
    v_fma_f32 v148, v63, v28, v26
    v_fma_f32 v149, v63, v29, v27
    v_lshlrev_b32 v26, 16, v55
    v_and_b32 v27, s23, v55
    ds_read_b128 v[96:99], v14 offset:40960
    ds_read_b128 v[100:103], v14 offset:45056
    s_waitcnt vmcnt(32) lgkmcnt(4)
    v_mfma_f32_32x32x16_bf16 v[64:79], v[104:107], v[176:179], v[64:79]
    v_mfma_f32_32x32x16_bf16 v[80:95], v[108:111], v[176:179], v[80:95]
    buffer_load_dwordx4 v[176:179], v21, s[12:15], s22 offen offset:0
    v_mul_f32 v28, v26, v154
    v_mul_f32 v29, v27, v155
    v_cvt_pk_bf16_f32 v28, v28, v29
    v_mul_f32 v26, v26, v30
    ds_read_b128 v[104:107], v15 offset:40960
    ds_read_b128 v[108:111], v15 offset:45056
    s_waitcnt vmcnt(31) lgkmcnt(4)
    v_mfma_f32_32x32x16_bf16 v[64:79], v[112:115], v[180:183], v[64:79]
    v_mfma_f32_32x32x16_bf16 v[80:95], v[116:119], v[180:183], v[80:95]
    buffer_load_dwordx4 v[180:183], v21, s[12:15], s22 offen offset:1024
    v_mul_f32 v27, v27, v30
    v_cvt_pk_bf16_f32 v26, v26, v27
    v_and_b32 v29, s23, v28
    v_lshlrev_b32 v28, 16, v28
    s_waitcnt vmcnt(33) lgkmcnt(0)
    s_barrier
    ds_read_b128 v[112:115], v12 offset:49152
    ds_read_b128 v[116:119], v12 offset:53248
    s_waitcnt vmcnt(31) lgkmcnt(4)
    v_mfma_f32_32x32x16_bf16 v[64:79], v[96:99], v[184:187], v[64:79]
    v_mfma_f32_32x32x16_bf16 v[80:95], v[100:103], v[184:187], v[80:95]
    buffer_load_dwordx4 v[184:187], v21, s[12:15], s22 offen offset:2048
    v_and_b32 v27, s23, v26
    v_lshlrev_b32 v26, 16, v26
    v_fma_f32 v150, v63, v28, v26
    v_fma_f32 v151, v63, v29, v27
    ds_read_b128 v[96:99], v13 offset:49152
    ds_read_b128 v[100:103], v13 offset:53248
    s_waitcnt vmcnt(30) lgkmcnt(4)
    v_mfma_f32_32x32x16_bf16 v[64:79], v[104:107], v[188:191], v[64:79]
    v_mfma_f32_32x32x16_bf16 v[80:95], v[108:111], v[188:191], v[80:95]
    buffer_load_dwordx4 v[188:191], v21, s[12:15], s22 offen offset:3072
    ds_read_b128 v[104:107], v14 offset:49152
    ds_read_b128 v[108:111], v14 offset:53248
    s_waitcnt vmcnt(30) lgkmcnt(4)
    v_mfma_f32_32x32x16_bf16 v[64:79], v[112:115], v[192:195], v[64:79]
    v_mfma_f32_32x32x16_bf16 v[80:95], v[116:119], v[192:195], v[80:95]
    ds_read_b128 v[112:115], v15 offset:49152
    ds_read_b128 v[116:119], v15 offset:53248
    s_waitcnt vmcnt(28) lgkmcnt(4)
    v_mfma_f32_32x32x16_bf16 v[64:79], v[96:99], v[196:199], v[64:79]
    v_mfma_f32_32x32x16_bf16 v[80:95], v[100:103], v[196:199], v[80:95]
    ds_read_b128 v[96:99], v12 offset:57344
    ds_read_b128 v[100:103], v12 offset:61440
    s_waitcnt vmcnt(27) lgkmcnt(4)
    v_mfma_f32_32x32x16_bf16 v[64:79], v[104:107], v[200:203], v[64:79]
    v_mfma_f32_32x32x16_bf16 v[80:95], v[108:111], v[200:203], v[80:95]
    ds_read_b128 v[104:107], v13 offset:57344
    ds_read_b128 v[108:111], v13 offset:61440
    s_waitcnt vmcnt(25) lgkmcnt(4)
    v_mfma_f32_32x32x16_bf16 v[64:79], v[112:115], v[204:207], v[64:79]
    v_mfma_f32_32x32x16_bf16 v[80:95], v[116:119], v[204:207], v[80:95]
    ds_read_b128 v[112:115], v14 offset:57344
    ds_read_b128 v[116:119], v14 offset:61440
    s_waitcnt vmcnt(24) lgkmcnt(4)
    v_mfma_f32_32x32x16_bf16 v[64:79], v[96:99], v[208:211], v[64:79]
    v_mfma_f32_32x32x16_bf16 v[80:95], v[100:103], v[208:211], v[80:95]
    ds_read_b128 v[96:99], v15 offset:57344
    ds_read_b128 v[100:103], v15 offset:61440
    s_waitcnt vmcnt(22) lgkmcnt(4)
    v_mfma_f32_32x32x16_bf16 v[64:79], v[104:107], v[212:215], v[64:79]
    v_mfma_f32_32x32x16_bf16 v[80:95], v[108:111], v[212:215], v[80:95]
    s_waitcnt vmcnt(23) lgkmcnt(0)
    s_barrier
    ds_read_b128 v[104:107], v16 offset:0
    ds_read_b128 v[108:111], v16 offset:4096
    s_waitcnt vmcnt(21) lgkmcnt(4)
    v_mfma_f32_32x32x16_bf16 v[64:79], v[112:115], v[216:219], v[64:79]
    v_mfma_f32_32x32x16_bf16 v[80:95], v[116:119], v[216:219], v[80:95]
    ds_read_b128 v[112:115], v17 offset:0
    ds_read_b128 v[116:119], v17 offset:4096
    s_waitcnt vmcnt(19) lgkmcnt(4)
    v_mfma_f32_32x32x16_bf16 v[64:79], v[96:99], v[220:223], v[64:79]
    v_mfma_f32_32x32x16_bf16 v[80:95], v[100:103], v[220:223], v[80:95]
    ds_read_b128 v[96:99], v18 offset:0
    ds_read_b128 v[100:103], v18 offset:4096
    s_waitcnt vmcnt(18) lgkmcnt(4)
    v_mfma_f32_32x32x16_bf16 v[64:79], v[104:107], v[224:227], v[64:79]
    v_mfma_f32_32x32x16_bf16 v[80:95], v[108:111], v[224:227], v[80:95]
    ds_read_b128 v[104:107], v19 offset:0
    ds_read_b128 v[108:111], v19 offset:4096
    s_waitcnt vmcnt(16) lgkmcnt(4)
    v_mfma_f32_32x32x16_bf16 v[64:79], v[112:115], v[228:231], v[64:79]
    v_mfma_f32_32x32x16_bf16 v[80:95], v[116:119], v[228:231], v[80:95]
    ds_read_b128 v[112:115], v16 offset:8192
    ds_read_b128 v[116:119], v16 offset:12288
    s_waitcnt vmcnt(15) lgkmcnt(4)
    v_mfma_f32_32x32x16_bf16 v[64:79], v[96:99], v[232:235], v[64:79]
    v_mfma_f32_32x32x16_bf16 v[80:95], v[100:103], v[232:235], v[80:95]
    ds_read_b128 v[96:99], v17 offset:8192
    ds_read_b128 v[100:103], v17 offset:12288
    s_waitcnt vmcnt(13) lgkmcnt(4)
    v_mfma_f32_32x32x16_bf16 v[64:79], v[104:107], v[236:239], v[64:79]
    v_mfma_f32_32x32x16_bf16 v[80:95], v[108:111], v[236:239], v[80:95]
    ds_read_b128 v[104:107], v18 offset:8192
    ds_read_b128 v[108:111], v18 offset:12288
    s_waitcnt vmcnt(12) lgkmcnt(4)
    v_mfma_f32_32x32x16_bf16 v[64:79], v[112:115], v[240:243], v[64:79]
    v_mfma_f32_32x32x16_bf16 v[80:95], v[116:119], v[240:243], v[80:95]
    ds_read_b128 v[112:115], v19 offset:8192
    ds_read_b128 v[116:119], v19 offset:12288
    s_waitcnt vmcnt(10) lgkmcnt(4)
    v_mfma_f32_32x32x16_bf16 v[64:79], v[96:99], v[244:247], v[64:79]
    v_mfma_f32_32x32x16_bf16 v[80:95], v[100:103], v[244:247], v[80:95]
    s_waitcnt vmcnt(11) lgkmcnt(0)
    s_barrier
    ds_read_b128 v[96:99], v12 offset:0
    ds_read_b128 v[100:103], v12 offset:4096
    s_waitcnt vmcnt(9) lgkmcnt(4)
    v_mfma_f32_32x32x16_bf16 v[64:79], v[104:107], v[248:251], v[64:79]
    v_mfma_f32_32x32x16_bf16 v[80:95], v[108:111], v[248:251], v[80:95]
    ds_read_b128 v[104:107], v13 offset:0
    ds_read_b128 v[108:111], v13 offset:4096
    s_waitcnt vmcnt(8) lgkmcnt(4)
    v_mfma_f32_32x32x16_bf16 v[64:79], v[112:115], v[252:255], v[64:79]
    v_mfma_f32_32x32x16_bf16 v[80:95], v[116:119], v[252:255], v[80:95]
    ds_read_b128 v[112:115], v14 offset:0
    ds_read_b128 v[116:119], v14 offset:4096
    s_waitcnt vmcnt(7) lgkmcnt(4)
    v_mfma_f32_32x32x16_bf16 v[64:79], v[96:99], v[160:163], v[64:79]
    v_mfma_f32_32x32x16_bf16 v[80:95], v[100:103], v[160:163], v[80:95]
    ds_read_b128 v[96:99], v15 offset:0
    ds_read_b128 v[100:103], v15 offset:4096
    s_waitcnt vmcnt(6) lgkmcnt(4)
    v_mfma_f32_32x32x16_bf16 v[64:79], v[104:107], v[164:167], v[64:79]
    v_mfma_f32_32x32x16_bf16 v[80:95], v[108:111], v[164:167], v[80:95]
    ds_read_b128 v[104:107], v12 offset:8192
    ds_read_b128 v[108:111], v12 offset:12288
    s_waitcnt vmcnt(5) lgkmcnt(4)
    v_mfma_f32_32x32x16_bf16 v[64:79], v[112:115], v[168:171], v[64:79]
    v_mfma_f32_32x32x16_bf16 v[80:95], v[116:119], v[168:171], v[80:95]
    ds_read_b128 v[112:115], v13 offset:8192
    ds_read_b128 v[116:119], v13 offset:12288
    s_waitcnt vmcnt(4) lgkmcnt(4)
    v_mfma_f32_32x32x16_bf16 v[64:79], v[96:99], v[172:175], v[64:79]
    v_mfma_f32_32x32x16_bf16 v[80:95], v[100:103], v[172:175], v[80:95]
    ds_read_b128 v[96:99], v14 offset:8192
    ds_read_b128 v[100:103], v14 offset:12288
    s_waitcnt vmcnt(3) lgkmcnt(4)
    v_mfma_f32_32x32x16_bf16 v[64:79], v[104:107], v[176:179], v[64:79]
    v_mfma_f32_32x32x16_bf16 v[80:95], v[108:111], v[176:179], v[80:95]
    ds_read_b128 v[104:107], v15 offset:8192
    ds_read_b128 v[108:111], v15 offset:12288
    s_waitcnt vmcnt(2) lgkmcnt(4)
    v_mfma_f32_32x32x16_bf16 v[64:79], v[112:115], v[180:183], v[64:79]
    v_mfma_f32_32x32x16_bf16 v[80:95], v[116:119], v[180:183], v[80:95]
    s_waitcnt vmcnt(1) lgkmcnt(2)
    v_mfma_f32_32x32x16_bf16 v[64:79], v[96:99], v[184:187], v[64:79]
    v_mfma_f32_32x32x16_bf16 v[80:95], v[100:103], v[184:187], v[80:95]
    s_waitcnt vmcnt(0) lgkmcnt(0)
    v_mfma_f32_32x32x16_bf16 v[64:79], v[104:107], v[188:191], v[64:79]
    v_mfma_f32_32x32x16_bf16 v[80:95], v[108:111], v[188:191], v[80:95]
    s_mul_i32 s38, s18, 8704
    s_add_u32 s56, s38, 16384
    v_and_b32 v30, 31, v22
    v_mul_u32_u24 v26, 272, v30
    v_lshl_add_u32 v26, v23, 4, v26
    v_add_u32 v26, s56, v26
    v_lshrrev_b32 v31, 4, v22
    v_and_b32 v32, 15, v22
    v_mul_u32_u24 v27, 272, v31
    v_lshl_add_u32 v27, v32, 4, v27
    v_add_u32 v27, s56, v27
    v_lshlrev_b32 v28, 12, v31
    v_lshl_add_u32 v28, v32, 4, v28
    v_mul_f32 v64, v64, v24
    v_mul_f32 v65, v65, v24
    v_mul_f32 v66, v66, v24
    v_mul_f32 v67, v67, v24
    ds_write_b128 v26, v[64:67] offset:0
    v_mul_f32 v68, v68, v24
    v_mul_f32 v69, v69, v24
    v_mul_f32 v70, v70, v24
    v_mul_f32 v71, v71, v24
    ds_write_b128 v26, v[68:71] offset:32
    v_mul_f32 v72, v72, v24
    v_mul_f32 v73, v73, v24
    v_mul_f32 v74, v74, v24
    v_mul_f32 v75, v75, v24
    ds_write_b128 v26, v[72:75] offset:64
    v_mul_f32 v76, v76, v24
    v_mul_f32 v77, v77, v24
    v_mul_f32 v78, v78, v24
    v_mul_f32 v79, v79, v24
    ds_write_b128 v26, v[76:79] offset:96
    v_mul_f32 v80, v80, v24
    v_mul_f32 v81, v81, v24
    v_mul_f32 v82, v82, v24
    v_mul_f32 v83, v83, v24
    ds_write_b128 v26, v[80:83] offset:128
    v_mul_f32 v84, v84, v24
    v_mul_f32 v85, v85, v24
    v_mul_f32 v86, v86, v24
    v_mul_f32 v87, v87, v24
    ds_write_b128 v26, v[84:87] offset:160
    v_mul_f32 v88, v88, v24
    v_mul_f32 v89, v89, v24
    v_mul_f32 v90, v90, v24
    v_mul_f32 v91, v91, v24
    ds_write_b128 v26, v[88:91] offset:192
    v_mul_f32 v92, v92, v24
    v_mul_f32 v93, v93, v24
    v_mul_f32 v94, v94, v24
    v_mul_f32 v95, v95, v24
    ds_write_b128 v26, v[92:95] offset:224
    s_mov_b32 s57, 0
L_k2_fix:
    s_mov_b32 m0, s57
    s_nop 0
    s_movrels_b32 s58, s48
    s_and_b32 s59, s58, 0x7ff
    s_sub_u32 s59, 2047, s59
    s_sub_u32 s38, s59, s45
    s_cmp_ge_u32 s38, 32
    s_cbranch_scc1 L_k2_fixnext
    s_lshr_b32 s39, s17, 2
    s_lshl_b32 s39, s39, 2
    v_mov_b32 v220, s39
L_k2_ypoll:
    global_load_dword v221, v220, s[40:41] sc1
    s_waitcnt vmcnt(0)
    v_readfirstlane_b32 s39, v221
    s_nop 1
    s_cmp_ge_u32 s39, 56
    s_cbranch_scc1 L_k2_ygo
    s_sleep 2
    s_branch L_k2_ypoll
L_k2_ygo:
    s_mul_i32 s39, s57, 229376
    s_lshl_b32 s3, s17, 8
    s_add_u32 s39, s39, s3
    s_add_u32 s39, s39, 13631488
    buffer_load_dwordx4 v[160:163], v28, s[12:15], s39 offen sc1
    s_add_u32 s39, s39, 16384
    buffer_load_dwordx4 v[164:167], v28, s[12:15], s39 offen sc1
    s_add_u32 s39, s39, 16384
    buffer_load_dwordx4 v[168:171], v28, s[12:15], s39 offen sc1
    s_add_u32 s39, s39, 16384
    buffer_load_dwordx4 v[172:175], v28, s[12:15], s39 offen sc1
    s_add_u32 s39, s39, 16384
    buffer_load_dwordx4 v[176:179], v28, s[12:15], s39 offen sc1
    s_add_u32 s39, s39, 16384
    buffer_load_dwordx4 v[180:183], v28, s[12:15], s39 offen sc1
    s_add_u32 s39, s39, 16384
    buffer_load_dwordx4 v[184:187], v28, s[12:15], s39 offen sc1
    s_add_u32 s39, s39, 16384
    buffer_load_dwordx4 v[188:191], v28, s[12:15], s39 offen sc1
    s_add_u32 s39, s39, 16384
    buffer_load_dwordx4 v[192:195], v28, s[12:15], s39 offen sc1
    s_add_u32 s39, s39, 16384
    buffer_load_dwordx4 v[196:199], v28, s[12:15], s39 offen sc1
    s_add_u32 s39, s39, 16384
    buffer_load_dwordx4 v[200:203], v28, s[12:15], s39 offen sc1
    s_add_u32 s39, s39, 16384
    buffer_load_dwordx4 v[204:207], v28, s[12:15], s39 offen sc1
    s_add_u32 s39, s39, 16384
    buffer_load_dwordx4 v[208:211], v28, s[12:15], s39 offen sc1
    s_add_u32 s39, s39, 16384
    buffer_load_dwordx4 v[212:215], v28, s[12:15], s39 offen sc1
    s_add_u32 s39, s39, 16384
    s_lshl_b32 s39, s59, 11
    s_lshl_b32 s3, s17, 7
    s_add_u32 s39, s39, s3
    v_lshlrev_b32 v220, 3, v32
    buffer_load_dwordx2 v[216:217], v220, s[8:11], s39 offen
    s_lshl_b32 s39, s59, 2
    s_add_u32 s39, s39, 9445376
    v_mov_b32 v220, 0
    buffer_load_dword v218, v220, s[12:15], s39 offen
    s_ashr_i32 s39, s58, 31
    s_not_b32 s39, s39
    s_or_b32 s39, s39, 0x80000000
    s_xor_b32 s39, s58, s39
    s_and_b32 s39, s39, 0xffff0000
    v_mov_b32 v222, s39
    v_mul_f32 v219, 0xbfb8aa3b, v222
    v_exp_f32 v219, v219
    s_nop 0
    v_add_f32 v219, 1.0, v219
    v_rcp_f32 v219, v219
    s_nop 0
    v_cvt_pk_bf16_f32 v219, v219, v219
    v_lshlrev_b32 v219, 16, v219
    s_mul_i32 s39, s38, 272
    s_add_u32 s39, s39, s56
    v_lshl_add_u32 v220, v32, 4, s39
    s_waitcnt lgkmcnt(0)
    ds_read_b128 v[224:227], v220
    s_waitcnt vmcnt(0)
    v_add_f32 v160, v160, v164
    v_add_f32 v161, v161, v165
    v_add_f32 v162, v162, v166
    v_add_f32 v163, v163, v167
    v_add_f32 v160, v160, v168
    v_add_f32 v161, v161, v169
    v_add_f32 v162, v162, v170
    v_add_f32 v163, v163, v171
    v_add_f32 v160, v160, v172
    v_add_f32 v161, v161, v173
    v_add_f32 v162, v162, v174
    v_add_f32 v163, v163, v175
    v_add_f32 v160, v160, v176
    v_add_f32 v161, v161, v177
    v_add_f32 v162, v162, v178
    v_add_f32 v163, v163, v179
    v_add_f32 v160, v160, v180
    v_add_f32 v161, v161, v181
    v_add_f32 v162, v162, v182
    v_add_f32 v163, v163, v183
    v_add_f32 v160, v160, v184
    v_add_f32 v161, v161, v185
    v_add_f32 v162, v162, v186
    v_add_f32 v163, v163, v187
    v_add_f32 v160, v160, v188
    v_add_f32 v161, v161, v189
    v_add_f32 v162, v162, v190
    v_add_f32 v163, v163, v191
    v_add_f32 v160, v160, v192
    v_add_f32 v161, v161, v193
    v_add_f32 v162, v162, v194
    v_add_f32 v163, v163, v195
    v_add_f32 v160, v160, v196
    v_add_f32 v161, v161, v197
    v_add_f32 v162, v162, v198
    v_add_f32 v163, v163, v199
    v_add_f32 v160, v160, v200
    v_add_f32 v161, v161, v201
    v_add_f32 v162, v162, v202
    v_add_f32 v163, v163, v203
    v_add_f32 v160, v160, v204
    v_add_f32 v161, v161, v205
    v_add_f32 v162, v162, v206
    v_add_f32 v163, v163, v207
    v_add_f32 v160, v160, v208
    v_add_f32 v161, v161, v209
    v_add_f32 v162, v162, v210
    v_add_f32 v163, v163, v211
    v_add_f32 v160, v160, v212
    v_add_f32 v161, v161, v213
    v_add_f32 v162, v162, v214
    v_add_f32 v163, v163, v215
    v_mov_b32 v164, v160
    v_mov_b32 v165, v161
    v_mov_b32 v166, v162
    v_mov_b32 v167, v163
    s_nop 1
    v_permlane16_swap_b32 v160, v164
    v_permlane16_swap_b32 v161, v165
    v_permlane16_swap_b32 v162, v166
    v_permlane16_swap_b32 v163, v167
    s_nop 1
    v_add_f32 v160, v160, v164
    v_add_f32 v161, v161, v165
    v_add_f32 v162, v162, v166
    v_add_f32 v163, v163, v167
    v_mov_b32 v164, v160
    v_mov_b32 v165, v161
    v_mov_b32 v166, v162
    v_mov_b32 v167, v163
    s_nop 1
    v_permlane32_swap_b32 v160, v164
    v_permlane32_swap_b32 v161, v165
    v_permlane32_swap_b32 v162, v166
    v_permlane32_swap_b32 v163, v167
    s_nop 1
    v_add_f32 v160, v160, v164
    v_add_f32 v161, v161, v165
    v_add_f32 v162, v162, v166
    v_add_f32 v163, v163, v167
    v_sub_f32 v218, 1.0, v218
    v_cvt_pk_bf16_f32 v218, v218, v218
    v_lshlrev_b32 v218, 16, v218
    v_lshlrev_b32 v168, 16, v216
    v_and_b32 v169, s23, v216
    v_lshlrev_b32 v170, 16, v217
    v_and_b32 v171, s23, v217
    s_waitcnt lgkmcnt(0)
    v_cvt_pk_bf16_f32 v160, v160, v160
    v_lshlrev_b32 v160, 16, v160
    v_mul_f32 v160, v160, v219
    v_cvt_pk_bf16_f32 v160, v160, v160
    v_lshlrev_b32 v160, 16, v160
    v_add_f32 v160, v160, v168
    v_cvt_pk_bf16_f32 v160, v160, v160
    v_lshlrev_b32 v160, 16, v160
    v_mul_f32 v160, v160, v218
    v_cvt_pk_bf16_f32 v160, v160, v160
    v_lshlrev_b32 v160, 16, v160
    v_mul_f32 v168, v168, v218
    v_cvt_pk_bf16_f32 v168, v168, v168
    v_lshlrev_b32 v168, 16, v168
    v_sub_f32 v160, v160, v168
    v_add_f32 v224, v224, v160
    v_cvt_pk_bf16_f32 v161, v161, v161
    v_lshlrev_b32 v161, 16, v161
    v_mul_f32 v161, v161, v219
    v_cvt_pk_bf16_f32 v161, v161, v161
    v_lshlrev_b32 v161, 16, v161
    v_add_f32 v161, v161, v169
    v_cvt_pk_bf16_f32 v161, v161, v161
    v_lshlrev_b32 v161, 16, v161
    v_mul_f32 v161, v161, v218
    v_cvt_pk_bf16_f32 v161, v161, v161
    v_lshlrev_b32 v161, 16, v161
    v_mul_f32 v169, v169, v218
    v_cvt_pk_bf16_f32 v169, v169, v169
    v_lshlrev_b32 v169, 16, v169
    v_sub_f32 v161, v161, v169
    v_add_f32 v225, v225, v161
    v_cvt_pk_bf16_f32 v162, v162, v162
    v_lshlrev_b32 v162, 16, v162
    v_mul_f32 v162, v162, v219
    v_cvt_pk_bf16_f32 v162, v162, v162
    v_lshlrev_b32 v162, 16, v162
    v_add_f32 v162, v162, v170
    v_cvt_pk_bf16_f32 v162, v162, v162
    v_lshlrev_b32 v162, 16, v162
    v_mul_f32 v162, v162, v218
    v_cvt_pk_bf16_f32 v162, v162, v162
    v_lshlrev_b32 v162, 16, v162
    v_mul_f32 v170, v170, v218
    v_cvt_pk_bf16_f32 v170, v170, v170
    v_lshlrev_b32 v170, 16, v170
    v_sub_f32 v162, v162, v170
    v_add_f32 v226, v226, v162
    v_cvt_pk_bf16_f32 v163, v163, v163
    v_lshlrev_b32 v163, 16, v163
    v_mul_f32 v163, v163, v219
    v_cvt_pk_bf16_f32 v163, v163, v163
    v_lshlrev_b32 v163, 16, v163
    v_add_f32 v163, v163, v171
    v_cvt_pk_bf16_f32 v163, v163, v163
    v_lshlrev_b32 v163, 16, v163
    v_mul_f32 v163, v163, v218
    v_cvt_pk_bf16_f32 v163, v163, v163
    v_lshlrev_b32 v163, 16, v163
    v_mul_f32 v171, v171, v218
    v_cvt_pk_bf16_f32 v171, v171, v171
    v_lshlrev_b32 v171, 16, v171
    v_sub_f32 v163, v163, v171
    v_add_f32 v227, v227, v163
    ds_write_b128 v220, v[224:227]
L_k2_fixnext:
    s_add_u32 s57, s57, 1
    s_cmp_lt_u32 s57, 8
    s_cbranch_scc1 L_k2_fix
    s_waitcnt lgkmcnt(0)
    ds_read_b128 v[64:67], v27 offset:0
    ds_read_b128 v[68:71], v27 offset:1088
    ds_read_b128 v[72:75], v27 offset:2176
    ds_read_b128 v[76:79], v27 offset:3264
    ds_read_b128 v[80:83], v27 offset:4352
    ds_read_b128 v[84:87], v27 offset:5440
    ds_read_b128 v[88:91], v27 offset:6528
    ds_read_b128 v[92:95], v27 offset:7616
    s_lshl_b32 s38, s45, 12
    s_lshl_b32 s39, s17, 8
    s_add_u32 s38, s38, s39
    s_waitcnt lgkmcnt(7)
    v_add_f32 v64, v64, v120
    v_add_f32 v65, v65, v121
    v_add_f32 v66, v66, v122
    v_add_f32 v67, v67, v123
    buffer_store_dwordx4 v[64:67], v28, s[24:27], s38 offen
    s_add_u32 s38, s38, 16384
    s_waitcnt lgkmcnt(6)
    v_add_f32 v68, v68, v124
    v_add_f32 v69, v69, v125
    v_add_f32 v70, v70, v126
    v_add_f32 v71, v71, v127
    buffer_store_dwordx4 v[68:71], v28, s[24:27], s38 offen
    s_add_u32 s38, s38, 16384
    s_waitcnt lgkmcnt(5)
    v_add_f32 v72, v72, v128
    v_add_f32 v73, v73, v129
    v_add_f32 v74, v74, v130
    v_add_f32 v75, v75, v131
    buffer_store_dwordx4 v[72:75], v28, s[24:27], s38 offen
    s_add_u32 s38, s38, 16384
    s_waitcnt lgkmcnt(4)
    v_add_f32 v76, v76, v132
    v_add_f32 v77, v77, v133
    v_add_f32 v78, v78, v134
    v_add_f32 v79, v79, v135
    buffer_store_dwordx4 v[76:79], v28, s[24:27], s38 offen
    s_add_u32 s38, s38, 16384
    s_waitcnt lgkmcnt(3)
    v_add_f32 v80, v80, v136
    v_add_f32 v81, v81, v137
    v_add_f32 v82, v82, v138
    v_add_f32 v83, v83, v139
    buffer_store_dwordx4 v[80:83], v28, s[24:27], s38 offen
    s_add_u32 s38, s38, 16384
    s_waitcnt lgkmcnt(2)
    v_add_f32 v84, v84, v140
    v_add_f32 v85, v85, v141
    v_add_f32 v86, v86, v142
    v_add_f32 v87, v87, v143
    buffer_store_dwordx4 v[84:87], v28, s[24:27], s38 offen
    s_add_u32 s38, s38, 16384
    s_waitcnt lgkmcnt(1)
    v_add_f32 v88, v88, v144
    v_add_f32 v89, v89, v145
    v_add_f32 v90, v90, v146
    v_add_f32 v91, v91, v147
    buffer_store_dwordx4 v[88:91], v28, s[24:27], s38 offen
    s_add_u32 s38, s38, 16384
    s_waitcnt lgkmcnt(0)
    v_add_f32 v92, v92, v148
    v_add_f32 v93, v93, v149
    v_add_f32 v94, v94, v150
    v_add_f32 v95, v95, v151
    buffer_store_dwordx4 v[92:95], v28, s[24:27], s38 offen
    s_add_u32 s38, s38, 16384
    s_endpgm
L_k2_side:
    s_sub_u32 s19, s2, 256
    s_cmp_ge_u32 s19, 224
    s_cbranch_scc1 L_k2s_end
    s_load_dwordx2 s[28:29], s[0:1], 104
    s_load_dwordx4 s[40:43], s[0:1], 128
    v_lshrrev_b32 v1, 6, v0
    v_and_b32 v2, 63, v0
    v_readfirstlane_b32 s18, v1
    s_lshr_b32 s22, s19, 2
    s_and_b32 s23, s19, 3
    v_lshrrev_b32 v3, 5, v0
    v_and_b32 v4, 31, v0
    v_mul_u32_u24 v5, 14336, v3
    v_lshl_add_u32 v5, v4, 3, v5
    v_lshrrev_b32 v6, 3, v2
    v_and_b32 v7, 7, v2
    v_and_b32 v8, 3, v6
    v_lshlrev_b32 v8, 1, v8
    v_xor_b32 v7, v7, v8
    v_lshlrev_b32 v6, 11, v6
    v_lshl_add_u32 v6, v7, 4, v6
    s_waitcnt lgkmcnt(0)
    s_mov_b32 s12, s42
    s_mov_b32 s13, s43
    s_mov_b32 s14, 16777216
    s_mov_b32 s15, 0x20000
    s_mov_b32 s8, s28
    s_mov_b32 s9, s29
    s_mov_b32 s10, 7340032
    s_mov_b32 s11, 0x20000
    s_lshl_b32 s38, s22, 8
    s_add_u32 s38, s38, 10485760
    buffer_load_dwordx2 v[16:17], v5, s[12:15], s38 offen
    s_add_u32 s38, s38, 114688
    buffer_load_dwordx2 v[18:19], v5, s[12:15], s38 offen
    s_add_u32 s38, s38, 114688
    buffer_load_dwordx2 v[20:21], v5, s[12:15], s38 offen
    s_add_u32 s38, s38, 114688
    buffer_load_dwordx2 v[22:23], v5, s[12:15], s38 offen
    s_add_u32 s38, s38, 114688
    buffer_load_dwordx2 v[24:25], v5, s[12:15], s38 offen
    s_add_u32 s38, s38, 114688
    buffer_load_dwordx2 v[26:27], v5, s[12:15], s38 offen
    s_add_u32 s38, s38, 114688
    buffer_load_dwordx2 v[28:29], v5, s[12:15], s38 offen
    s_add_u32 s38, s38, 114688
    buffer_load_dwordx2 v[30:31], v5, s[12:15], s38 offen
    s_add_u32 s38, s38, 114688
    s_lshl_b32 s38, s22, 17
    s_lshl_b32 s39, s23, 9
    s_add_u32 s38, s38, s39
    s_lshl_b32 s39, s18, 7
    s_add_u32 s38, s38, s39
    s_lshl_b32 s39, s18, 13
    s_add_u32 m0, s39, 0
    s_nop 0
    buffer_load_dwordx4 v6, s[8:11], s38 offen lds
    s_add_u32 s38, s38, 16384
    s_add_u32 m0, s39, 1024
    s_nop 0
    buffer_load_dwordx4 v6, s[8:11], s38 offen lds
    s_add_u32 s38, s38, 16384
    s_add_u32 m0, s39, 2048
    s_nop 0
    buffer_load_dwordx4 v6, s[8:11], s38 offen lds
    s_add_u32 s38, s38, 16384
    s_add_u32 m0, s39, 3072
    s_nop 0
    buffer_load_dwordx4 v6, s[8:11], s38 offen lds
    s_add_u32 s38, s38, 16384
    s_add_u32 m0, s39, 4096
    s_nop 0
    buffer_load_dwordx4 v6, s[8:11], s38 offen lds
    s_add_u32 s38, s38, 16384
    s_add_u32 m0, s39, 5120
    s_nop 0
    buffer_load_dwordx4 v6, s[8:11], s38 offen lds
    s_add_u32 s38, s38, 16384
    s_add_u32 m0, s39, 6144
    s_nop 0
    buffer_load_dwordx4 v6, s[8:11], s38 offen lds
    s_add_u32 s38, s38, 16384
    s_add_u32 m0, s39, 7168
    s_nop 0
    buffer_load_dwordx4 v6, s[8:11], s38 offen lds
    s_add_u32 s38, s38, 16384
    s_waitcnt vmcnt(8)
    v_add_f32 v16, v16, v20
    v_add_f32 v24, v24, v28
    v_add_f32 v16, v16, v24
    v_cvt_pk_bf16_f32 v16, v16, v16
    v_lshlrev_b32 v16, 16, v16
    v_add_f32 v17, v17, v21
    v_add_f32 v25, v25, v29
    v_add_f32 v17, v17, v25
    v_cvt_pk_bf16_f32 v17, v17, v17
    v_lshlrev_b32 v17, 16, v17
    v_add_f32 v18, v18, v22
    v_add_f32 v26, v26, v30
    v_add_f32 v18, v18, v26
    v_cvt_pk_bf16_f32 v18, v18, v18
    v_lshlrev_b32 v18, 16, v18
    v_add_f32 v19, v19, v23
    v_add_f32 v27, v27, v31
    v_add_f32 v19, v19, v27
    v_cvt_pk_bf16_f32 v19, v19, v19
    v_lshlrev_b32 v19, 16, v19
    v_mul_f32 v32, 0xbfb8aa3b, v16
    v_exp_f32 v32, v32
    s_nop 0
    v_add_f32 v32, 1.0, v32
    v_rcp_f32 v32, v32
    s_nop 0
    v_mul_f32 v32, v32, v16
    v_cvt_pk_bf16_f32 v32, v32, v32
    v_lshlrev_b32 v32, 16, v32
    v_mul_f32 v32, v32, v18
    v_mul_f32 v33, 0xbfb8aa3b, v17
    v_exp_f32 v33, v33
    s_nop 0
    v_add_f32 v33, 1.0, v33
    v_rcp_f32 v33, v33
    s_nop 0
    v_mul_f32 v33, v33, v17
    v_cvt_pk_bf16_f32 v33, v33, v33
    v_lshlrev_b32 v33, 16, v33
    v_mul_f32 v33, v33, v19
    v_cvt_pk_bf16_f32 v32, v32, v33
    v_mul_u32_u24 v9, 144, v3
    v_lshl_add_u32 v9, v4, 2, v9
    ds_write_b32 v9, v32 offset:32768
    v_and_b32 v10, 7, v2
    v_mul_u32_u24 v10, 144, v10
    v_lshrrev_b32 v11, 4, v2
    v_lshl_add_u32 v10, v11, 4, v10
    v_bfe_u32 v12, v2, 2, 2
    v_lshl_add_u32 v13, v11, 3, v12
    v_lshlrev_b32 v13, 7, v13
    v_and_b32 v14, 3, v2
    v_lshl_add_u32 v13, v14, 3, v13
    v_add_u32 v13, s39, v13
    v_xor_b32 v14, 0, v12
    v_lshl_add_u32 v36, v14, 5, v13
    v_xor_b32 v14, 1, v12
    v_lshl_add_u32 v37, v14, 5, v13
    v_xor_b32 v14, 2, v12
    v_lshl_add_u32 v38, v14, 5, v13
    v_xor_b32 v14, 3, v12
    v_lshl_add_u32 v39, v14, 5, v13
    s_waitcnt vmcnt(0) lgkmcnt(0)
    s_barrier
    ds_read_b128 v[40:43], v10 offset:32768
    ds_read_b128 v[44:47], v10 offset:32832
    ds_read_b64_tr_b16 v[64:65], v36 offset:0
    ds_read_b64_tr_b16 v[66:67], v36 offset:512
    ds_read_b64_tr_b16 v[68:69], v36 offset:4096
    ds_read_b64_tr_b16 v[70:71], v36 offset:4608
    ds_read_b64_tr_b16 v[72:73], v37 offset:0
    ds_read_b64_tr_b16 v[74:75], v37 offset:512
    ds_read_b64_tr_b16 v[76:77], v37 offset:4096
    ds_read_b64_tr_b16 v[78:79], v37 offset:4608
    ds_read_b64_tr_b16 v[80:81], v38 offset:0
    ds_read_b64_tr_b16 v[82:83], v38 offset:512
    ds_read_b64_tr_b16 v[84:85], v38 offset:4096
    ds_read_b64_tr_b16 v[86:87], v38 offset:4608
    ds_read_b64_tr_b16 v[88:89], v39 offset:0
    ds_read_b64_tr_b16 v[90:91], v39 offset:512
    ds_read_b64_tr_b16 v[92:93], v39 offset:4096
    ds_read_b64_tr_b16 v[94:95], v39 offset:4608
    s_waitcnt lgkmcnt(0)
    v_mfma_f32_16x16x32_bf16 v[48:51], v[64:67], v[40:43], 0
    v_mfma_f32_16x16x32_bf16 v[52:55], v[72:75], v[40:43], 0
    v_mfma_f32_16x16x32_bf16 v[56:59], v[80:83], v[40:43], 0
    v_mfma_f32_16x16x32_bf16 v[60:63], v[88:91], v[40:43], 0
    v_mfma_f32_16x16x32_bf16 v[48:51], v[68:71], v[44:47], v[48:51]
    v_mfma_f32_16x16x32_bf16 v[52:55], v[76:79], v[44:47], v[52:55]
    v_mfma_f32_16x16x32_bf16 v[56:59], v[84:87], v[44:47], v[56:59]
    v_mfma_f32_16x16x32_bf16 v[60:63], v[92:95], v[44:47], v[60:63]
    v_and_b32 v14, 15, v2
    s_mov_b32 s38, 229376
    v_mul_lo_u32 v15, v14, s38
    v_lshl_add_u32 v15, v11, 4, v15
    s_lshl_b32 s38, s22, 12
    s_lshl_b32 s39, s23, 10
    s_add_u32 s38, s38, s39
    s_lshl_b32 s39, s18, 8
    s_add_u32 s38, s38, s39
    s_add_u32 s38, s38, 13631488
    v_cmp_gt_u32 vcc, 8, v14
    s_nop 4
    s_mov_b64 exec, vcc
    buffer_store_dwordx4 v[48:51], v15, s[12:15], s38 offen offset:0 sc1
    buffer_store_dwordx4 v[52:55], v15, s[12:15], s38 offen offset:64 sc1
    buffer_store_dwordx4 v[56:59], v15, s[12:15], s38 offen offset:128 sc1
    buffer_store_dwordx4 v[60:63], v15, s[12:15], s38 offen offset:192 sc1
    s_mov_b64 exec, -1
    s_waitcnt vmcnt(0)
    s_barrier
    s_cmp_lg_u32 s18, 0
    s_cbranch_scc1 L_k2s_end
    s_lshl_b32 s38, s23, 2
    v_mov_b32 v4, s38
    v_mov_b32 v5, 1
    s_mov_b64 exec, 1
    global_atomic_add v4, v5, s[40:41] sc1
L_k2s_end:
    s_endpgm
.section .rodata,"a"
.p2align 6
.amdhsa_kernel k1_kernel
  .amdhsa_next_free_vgpr 256
  .amdhsa_next_free_sgpr 96
  .amdhsa_accum_offset 256
  .amdhsa_group_segment_fixed_size 0
  .amdhsa_kernarg_size 144
  .amdhsa_user_sgpr_count 2
  .amdhsa_user_sgpr_kernarg_segment_ptr 1
  .amdhsa_system_sgpr_workgroup_id_x 1
  .amdhsa_float_denorm_mode_32 3
.end_amdhsa_kernel
.p2align 6
.amdhsa_kernel k2_kernel
  .amdhsa_next_free_vgpr 256
  .amdhsa_next_free_sgpr 96
  .amdhsa_accum_offset 256
  .amdhsa_group_segment_fixed_size 0
  .amdhsa_kernarg_size 144
  .amdhsa_user_sgpr_count 2
  .amdhsa_user_sgpr_kernarg_segment_ptr 1
  .amdhsa_system_sgpr_workgroup_id_x 1
  .amdhsa_float_denorm_mode_32 3
.end_amdhsa_kernel
```

```asm
; @launch kernel=k1_kernel grid=(256,1,1) block=(512,1,1) lds=163840
; @launch kernel=k2_kernel grid=(256,1,1) block=(512,1,1) lds=118784
.amdgcn_target "amdgcn-amd-amdhsa--gfx950"
.text
.globl k1_kernel
.p2align 8
.type k1_kernel,@function
k1_kernel:
    v_lshrrev_b32 v1, 6, v0
    s_cmp_ge_u32 s2, 256
    s_cbranch_scc1 L_k1_exit
    v_readfirstlane_b32 s18, v1
    s_nop 1
    s_cmp_ge_u32 s18, 4
    s_cbranch_scc0 L_k1_gemm
    s_branch L_k1_side
L_k1_exit:
    s_endpgm
L_k1_gemm:
    s_load_dwordx2 s[4:5], s[0:1], 0
    s_load_dwordx4 s[28:31], s[0:1], 8
    s_load_dwordx4 s[32:35], s[0:1], 24
    s_load_dwordx2 s[36:37], s[0:1], 56
    s_load_dwordx4 s[40:43], s[0:1], 128
    s_load_dwordx4 s[48:51], s[0:1], 40
    v_lshrrev_b32 v48, 6, v0
    v_and_b32 v46, 63, v0
    v_readfirstlane_b32 s18, v48
    s_and_b32 s3, s2, 7
    s_lshr_b32 s38, s2, 3
    s_lshr_b32 s16, s3, 1
    s_lshl_b32 s16, s16, 2
    s_and_b32 s39, s38, 3
    s_add_u32 s16, s16, s39
    s_and_b32 s17, s3, 1
    s_lshl_b32 s17, s17, 3
    s_lshr_b32 s39, s38, 2
    s_add_u32 s17, s17, s39
    s_and_b32 s19, s18, 1
    s_lshr_b32 s20, s18, 1
    v_lshrrev_b32 v47, 5, v46
    v_lshrrev_b32 v48, 3, v46
    v_and_b32 v49, 7, v46
    v_lshrrev_b32 v50, 1, v48
    v_xor_b32 v49, v49, v50
    v_lshlrev_b32 v49, 4, v49
    v_lshrrev_b32 v50, 2, v48
    v_lshlrev_b32 v50, 5, v50
    v_and_b32 v51, 1, v48
    v_lshl_add_u32 v50, v51, 4, v50
    v_bfe_u32 v51, v48, 1, 1
    v_add_u32 v50, v50, v51
    s_lshl_b32 s38, s20, 6
    s_lshl_b32 s39, s19, 3
    s_add_u32 s38, s38, s39
    s_lshl_b32 s39, s16, 7
    s_add_u32 s38, s38, s39
    v_add_u32 v50, s38, v50
    v_lshl_add_u32 v50, v50, 11, v49
    v_add_u32 v8, 3072, v50
    v_xor_b32 v51, 64, v50
    v_add_u32 v9, 6144, v51
    v_add_u32 v10, 9216, v50
    v_xor_b32 v51, 64, v50
    v_add_u32 v11, 12288, v51
    s_lshl_b32 s38, s17, 6
    s_lshl_b32 s39, s20, 5
    s_add_u32 s38, s38, s39
    v_add_u32 v50, s38, v48
    v_lshl_add_u32 v50, v50, 11, v49
    v_add_u32 v12, 3072, v50
    v_xor_b32 v51, 64, v50
    v_add_u32 v13, 18432, v51
    v_add_u32 v14, 33792, v50
    v_xor_b32 v51, 64, v50
    v_add_u32 v15, 49152, v51
    s_waitcnt lgkmcnt(0)
    s_sub_u32 s4, s4, 3072
    s_subb_u32 s5, s5, 0
    s_mov_b32 s6, 4197376
    s_mov_b32 s7, 0x20000
    s_cmp_eq_u32 s19, 0
    s_cselect_b32 s8, s32, s34
    s_cselect_b32 s9, s33, s35
    s_sub_u32 s8, s8, 3072
    s_subb_u32 s9, s9, 0
    s_mov_b32 s10, 2100224
    s_mov_b32 s11, 0x20000
    s_mov_b32 s12, s42
    s_mov_b32 s13, s43
    s_mov_b32 s14, 16777216
    s_mov_b32 s15, 0x20000
    s_add_u32 s94, s42, 9469952
    s_addc_u32 s95, s43, 0
    s_load_dword s93, s[94:95], 0
    s_lshl_b32 s38, s17, 14
    s_add_u32 s38, s38, 8388608
    s_add_u32 s24, s42, s38
    s_addc_u32 s25, s43, 0
    s_mov_b32 s26, 16384
    s_mov_b32 s27, 0x20000
    s_mov_b32 s22, s40
    s_mov_b32 s23, s41
    s_lshl_b32 s44, s18, 12
    s_and_b32 s45, s2, 7
    s_mul_i32 s45, s45, 128
    s_mul_i32 s38, s16, 0
    s_add_u32 s45, s45, s38
    s_mul_i32 s38, s17, 1024
    s_add_u32 s45, s45, s38
    v_and_b32 v50, 31, v46
    v_lshlrev_b32 v56, 4, v50
    s_sub_u32 s38, 15, s16
    s_lshl_b32 s38, s38, 10
    s_lshl_b32 s39, s20, 9
    s_add_u32 s38, s38, s39
    v_add_u32 v56, s38, v56
    s_add_u32 m0, s44, 0
    s_add_u32 s21, s45, 0
    s_and_b32 s21, s21, 2047
    buffer_load_dwordx4 v8, s[4:7], s21 offen offset:0 lds
    buffer_load_dwordx4 v9, s[4:7], s21 offen offset:1024 lds
    buffer_load_dwordx4 v10, s[4:7], s21 offen offset:2048 lds
    buffer_load_dwordx4 v11, s[4:7], s21 offen offset:3072 lds
    s_add_u32 m0, s44, 16384
    s_add_u32 s21, s45, 0
    s_and_b32 s21, s21, 2047
    buffer_load_dwordx4 v12, s[8:11], s21 offen offset:0 lds
    buffer_load_dwordx4 v13, s[8:11], s21 offen offset:1024 lds
    buffer_load_dwordx4 v14, s[8:11], s21 offen offset:2048 lds
    buffer_load_dwordx4 v15, s[8:11], s21 offen offset:3072 lds
    s_add_u32 m0, s44, 32768
    s_add_u32 s21, s45, 128
    s_and_b32 s21, s21, 2047
    buffer_load_dwordx4 v8, s[4:7], s21 offen offset:0 lds
    buffer_load_dwordx4 v9, s[4:7], s21 offen offset:1024 lds
    buffer_load_dwordx4 v10, s[4:7], s21 offen offset:2048 lds
    buffer_load_dwordx4 v11, s[4:7], s21 offen offset:3072 lds
    s_add_u32 m0, s44, 49152
    s_add_u32 s21, s45, 128
    s_and_b32 s21, s21, 2047
    buffer_load_dwordx4 v12, s[8:11], s21 offen offset:0 lds
    buffer_load_dwordx4 v13, s[8:11], s21 offen offset:1024 lds
    buffer_load_dwordx4 v14, s[8:11], s21 offen offset:2048 lds
    buffer_load_dwordx4 v15, s[8:11], s21 offen offset:3072 lds
    s_add_u32 m0, s44, 65536
    s_add_u32 s21, s45, 256
    s_and_b32 s21, s21, 2047
    buffer_load_dwordx4 v8, s[4:7], s21 offen offset:0 lds
    buffer_load_dwordx4 v9, s[4:7], s21 offen offset:1024 lds
    buffer_load_dwordx4 v10, s[4:7], s21 offen offset:2048 lds
    buffer_load_dwordx4 v11, s[4:7], s21 offen offset:3072 lds
    s_add_u32 m0, s44, 81920
    s_add_u32 s21, s45, 256
    s_and_b32 s21, s21, 2047
    buffer_load_dwordx4 v12, s[8:11], s21 offen offset:0 lds
    buffer_load_dwordx4 v13, s[8:11], s21 offen offset:1024 lds
    buffer_load_dwordx4 v14, s[8:11], s21 offen offset:2048 lds
    buffer_load_dwordx4 v15, s[8:11], s21 offen offset:3072 lds
    s_lshl_b32 s38, s17, 6
    s_lshl_b32 s39, s20, 5
    s_add_u32 s38, s38, s39
    v_add_lshl_u32 v51, s38, v50, 1
    global_load_ushort v60, v51, s[28:29]
    global_load_ushort v61, v51, s[30:31]
    global_load_ushort v62, v51, s[36:37]
    v_bfe_u32 v51, v46, 1, 3
    v_xor_b32 v51, v51, v47
    v_lshlrev_b32 v51, 4, v51
    v_lshl_add_u32 v51, v50, 7, v51
    s_lshl_b32 s38, s19, 13
    s_lshl_b32 s39, s20, 13
    v_xor_b32 v48, 0, v51
    v_add_u32 v16, s38, v48
    v_add_u32 v20, s39, v48
    v_add_u32 v24, 0x10000, v16
    v_add_u32 v28, 0x10000, v20
    v_xor_b32 v48, 32, v51
    v_add_u32 v17, s38, v48
    v_add_u32 v21, s39, v48
    v_add_u32 v25, 0x10000, v17
    v_add_u32 v29, 0x10000, v21
    v_xor_b32 v48, 64, v51
    v_add_u32 v18, s38, v48
    v_add_u32 v22, s39, v48
    v_add_u32 v26, 0x10000, v18
    v_add_u32 v30, 0x10000, v22
    v_xor_b32 v48, 96, v51
    v_add_u32 v19, s38, v48
    v_add_u32 v23, s39, v48
    v_add_u32 v27, 0x10000, v19
    v_add_u32 v31, 0x10000, v23
    s_waitcnt vmcnt(19) lgkmcnt(0)
    s_barrier
    s_mul_i32 s93, s93, 1664525
    s_add_u32 s93, s93, 1013904223
    ds_read_b128 v[128:131], v16 offset:0
    ds_read_b128 v[132:135], v16 offset:4096
    ds_read_b128 v[136:139], v20 offset:16384
    ds_read_b128 v[140:143], v20 offset:20480
    ds_read_b128 v[144:147], v17 offset:0
    ds_read_b128 v[148:151], v17 offset:4096
    ds_read_b128 v[152:155], v21 offset:16384
    ds_read_b128 v[156:159], v21 offset:20480
    s_waitcnt lgkmcnt(4)
    v_mfma_f32_32x32x16_bf16 v[64:79], v[128:131], v[136:139], 0
    v_mfma_f32_32x32x16_bf16 v[80:95], v[128:131], v[140:143], 0
    v_mfma_f32_32x32x16_bf16 v[96:111], v[132:135], v[136:139], 0
    v_mfma_f32_32x32x16_bf16 v[112:127], v[132:135], v[140:143], 0
    ds_read_b128 v[128:131], v18 offset:0
    ds_read_b128 v[132:135], v18 offset:4096
    ds_read_b128 v[136:139], v22 offset:16384
    ds_read_b128 v[140:143], v22 offset:20480
    s_waitcnt lgkmcnt(4)
    v_mfma_f32_32x32x16_bf16 v[64:79], v[144:147], v[152:155], v[64:79]
    v_mfma_f32_32x32x16_bf16 v[80:95], v[144:147], v[156:159], v[80:95]
    v_mfma_f32_32x32x16_bf16 v[96:111], v[148:151], v[152:155], v[96:111]
    v_mfma_f32_32x32x16_bf16 v[112:127], v[148:151], v[156:159], v[112:127]
    ds_read_b128 v[144:147], v19 offset:0
    ds_read_b128 v[148:151], v19 offset:4096
    ds_read_b128 v[152:155], v23 offset:16384
    ds_read_b128 v[156:159], v23 offset:20480
    s_waitcnt lgkmcnt(4)
    v_mfma_f32_32x32x16_bf16 v[64:79], v[128:131], v[136:139], v[64:79]
    v_mfma_f32_32x32x16_bf16 v[80:95], v[128:131], v[140:143], v[80:95]
    v_mfma_f32_32x32x16_bf16 v[96:111], v[132:135], v[136:139], v[96:111]
    v_mfma_f32_32x32x16_bf16 v[112:127], v[132:135], v[140:143], v[112:127]
    s_waitcnt vmcnt(11) lgkmcnt(0)
    s_barrier
    ds_read_b128 v[128:131], v16 offset:32768
    ds_read_b128 v[132:135], v16 offset:36864
    ds_read_b128 v[136:139], v20 offset:49152
    ds_read_b128 v[140:143], v20 offset:53248
    v_mfma_f32_32x32x16_bf16 v[64:79], v[144:147], v[152:155], v[64:79]
    s_add_u32 m0, s44, 0
    s_add_u32 s21, s45, 384
    s_and_b32 s21, s21, 2047
    buffer_load_dwordx4 v8, s[4:7], s21 offen offset:0 lds
    v_mfma_f32_32x32x16_bf16 v[80:95], v[144:147], v[156:159], v[80:95]
    v_mfma_f32_32x32x16_bf16 v[96:111], v[148:151], v[152:155], v[96:111]
    buffer_load_dwordx4 v9, s[4:7], s21 offen offset:1024 lds
    v_mfma_f32_32x32x16_bf16 v[112:127], v[148:151], v[156:159], v[112:127]
    ds_read_b128 v[144:147], v17 offset:32768
    ds_read_b128 v[148:151], v17 offset:36864
    ds_read_b128 v[152:155], v21 offset:49152
    ds_read_b128 v[156:159], v21 offset:53248
    s_waitcnt lgkmcnt(4)
    v_mfma_f32_32x32x16_bf16 v[64:79], v[128:131], v[136:139], v[64:79]
    buffer_load_dwordx4 v10, s[4:7], s21 offen offset:2048 lds
    v_mfma_f32_32x32x16_bf16 v[80:95], v[128:131], v[140:143], v[80:95]
    v_mfma_f32_32x32x16_bf16 v[96:111], v[132:135], v[136:139], v[96:111]
    buffer_load_dwordx4 v11, s[4:7], s21 offen offset:3072 lds
    v_mfma_f32_32x32x16_bf16 v[112:127], v[132:135], v[140:143], v[112:127]
    ds_read_b128 v[128:131], v18 offset:32768
    ds_read_b128 v[132:135], v18 offset:36864
    ds_read_b128 v[136:139], v22 offset:49152
    ds_read_b128 v[140:143], v22 offset:53248
    s_waitcnt lgkmcnt(4)
    v_mfma_f32_32x32x16_bf16 v[64:79], v[144:147], v[152:155], v[64:79]
    s_add_u32 m0, s44, 16384
    s_add_u32 s21, s45, 384
    s_and_b32 s21, s21, 2047
    buffer_load_dwordx4 v12, s[8:11], s21 offen offset:0 lds
    v_mfma_f32_32x32x16_bf16 v[80:95], v[144:147], v[156:159], v[80:95]
    v_mfma_f32_32x32x16_bf16 v[96:111], v[148:151], v[152:155], v[96:111]
    buffer_load_dwordx4 v13, s[8:11], s21 offen offset:1024 lds
    v_mfma_f32_32x32x16_bf16 v[112:127], v[148:151], v[156:159], v[112:127]
    ds_read_b128 v[144:147], v19 offset:32768
    ds_read_b128 v[148:151], v19 offset:36864
    ds_read_b128 v[152:155], v23 offset:49152
    ds_read_b128 v[156:159], v23 offset:53248
    s_waitcnt lgkmcnt(4)
    v_mfma_f32_32x32x16_bf16 v[64:79], v[128:131], v[136:139], v[64:79]
    buffer_load_dwordx4 v14, s[8:11], s21 offen offset:2048 lds
    v_mfma_f32_32x32x16_bf16 v[80:95], v[128:131], v[140:143], v[80:95]
    v_mfma_f32_32x32x16_bf16 v[96:111], v[132:135], v[136:139], v[96:111]
    buffer_load_dwordx4 v15, s[8:11], s21 offen offset:3072 lds
    v_mfma_f32_32x32x16_bf16 v[112:127], v[132:135], v[140:143], v[112:127]
    s_waitcnt vmcnt(11) lgkmcnt(0)
    s_barrier
    ds_read_b128 v[128:131], v24 offset:0
    ds_read_b128 v[132:135], v24 offset:4096
    ds_read_b128 v[136:139], v28 offset:16384
    ds_read_b128 v[140:143], v28 offset:20480
    v_mfma_f32_32x32x16_bf16 v[64:79], v[144:147], v[152:155], v[64:79]
    s_add_u32 m0, s44, 32768
    s_add_u32 s21, s45, 512
    s_and_b32 s21, s21, 2047
    buffer_load_dwordx4 v8, s[4:7], s21 offen offset:0 lds
    v_mfma_f32_32x32x16_bf16 v[80:95], v[144:147], v[156:159], v[80:95]
    v_mfma_f32_32x32x16_bf16 v[96:111], v[148:151], v[152:155], v[96:111]
    buffer_load_dwordx4 v9, s[4:7], s21 offen offset:1024 lds
    v_mfma_f32_32x32x16_bf16 v[112:127], v[148:151], v[156:159], v[112:127]
    ds_read_b128 v[144:147], v25 offset:0
    ds_read_b128 v[148:151], v25 offset:4096
    ds_read_b128 v[152:155], v29 offset:16384
    ds_read_b128 v[156:159], v29 offset:20480
    s_waitcnt lgkmcnt(4)
    v_mfma_f32_32x32x16_bf16 v[64:79], v[128:131], v[136:139], v[64:79]
    buffer_load_dwordx4 v10, s[4:7], s21 offen offset:2048 lds
    v_mfma_f32_32x32x16_bf16 v[80:95], v[128:131], v[140:143], v[80:95]
    v_mfma_f32_32x32x16_bf16 v[96:111], v[132:135], v[136:139], v[96:111]
    buffer_load_dwordx4 v11, s[4:7], s21 offen offset:3072 lds
    v_mfma_f32_32x32x16_bf16 v[112:127], v[132:135], v[140:143], v[112:127]
    ds_read_b128 v[128:131], v26 offset:0
    ds_read_b128 v[132:135], v26 offset:4096
    ds_read_b128 v[136:139], v30 offset:16384
    ds_read_b128 v[140:143], v30 offset:20480
    s_waitcnt lgkmcnt(4)
    v_mfma_f32_32x32x16_bf16 v[64:79], v[144:147], v[152:155], v[64:79]
    s_add_u32 m0, s44, 49152
    s_add_u32 s21, s45, 512
    s_and_b32 s21, s21, 2047
    buffer_load_dwordx4 v12, s[8:11], s21 offen offset:0 lds
    v_mfma_f32_32x32x16_bf16 v[80:95], v[144:147], v[156:159], v[80:95]
    v_mfma_f32_32x32x16_bf16 v[96:111], v[148:151], v[152:155], v[96:111]
    buffer_load_dwordx4 v13, s[8:11], s21 offen offset:1024 lds
    v_mfma_f32_32x32x16_bf16 v[112:127], v[148:151], v[156:159], v[112:127]
    ds_read_b128 v[144:147], v27 offset:0
    ds_read_b128 v[148:151], v27 offset:4096
    ds_read_b128 v[152:155], v31 offset:16384
    ds_read_b128 v[156:159], v31 offset:20480
    s_waitcnt lgkmcnt(4)
    v_mfma_f32_32x32x16_bf16 v[64:79], v[128:131], v[136:139], v[64:79]
    buffer_load_dwordx4 v14, s[8:11], s21 offen offset:2048 lds
    v_mfma_f32_32x32x16_bf16 v[80:95], v[128:131], v[140:143], v[80:95]
    v_mfma_f32_32x32x16_bf16 v[96:111], v[132:135], v[136:139], v[96:111]
    buffer_load_dwordx4 v15, s[8:11], s21 offen offset:3072 lds
    v_mfma_f32_32x32x16_bf16 v[112:127], v[132:135], v[140:143], v[112:127]
    s_waitcnt vmcnt(8) lgkmcnt(0)
    s_barrier
    ds_read_b128 v[128:131], v16 offset:0
    ds_read_b128 v[132:135], v16 offset:4096
    ds_read_b128 v[136:139], v20 offset:16384
    ds_read_b128 v[140:143], v20 offset:20480
    v_mfma_f32_32x32x16_bf16 v[64:79], v[144:147], v[152:155], v[64:79]
    s_add_u32 m0, s44, 65536
    s_add_u32 s21, s45, 640
    s_and_b32 s21, s21, 2047
    buffer_load_dwordx4 v8, s[4:7], s21 offen offset:0 lds
    v_mfma_f32_32x32x16_bf16 v[80:95], v[144:147], v[156:159], v[80:95]
    v_mfma_f32_32x32x16_bf16 v[96:111], v[148:151], v[152:155], v[96:111]
    buffer_load_dwordx4 v9, s[4:7], s21 offen offset:1024 lds
    v_mfma_f32_32x32x16_bf16 v[112:127], v[148:151], v[156:159], v[112:127]
    ds_read_b128 v[144:147], v17 offset:0
    ds_read_b128 v[148:151], v17 offset:4096
    ds_read_b128 v[152:155], v21 offset:16384
    ds_read_b128 v[156:159], v21 offset:20480
    s_waitcnt lgkmcnt(4)
    v_mfma_f32_32x32x16_bf16 v[64:79], v[128:131], v[136:139], v[64:79]
    buffer_load_dwordx4 v10, s[4:7], s21 offen offset:2048 lds
    v_mfma_f32_32x32x16_bf16 v[80:95], v[128:131], v[140:143], v[80:95]
    v_mfma_f32_32x32x16_bf16 v[96:111], v[132:135], v[136:139], v[96:111]
    buffer_load_dwordx4 v11, s[4:7], s21 offen offset:3072 lds
    v_mfma_f32_32x32x16_bf16 v[112:127], v[132:135], v[140:143], v[112:127]
    ds_read_b128 v[128:131], v18 offset:0
    ds_read_b128 v[132:135], v18 offset:4096
    ds_read_b128 v[136:139], v22 offset:16384
    ds_read_b128 v[140:143], v22 offset:20480
    s_waitcnt lgkmcnt(4)
    v_mfma_f32_32x32x16_bf16 v[64:79], v[144:147], v[152:155], v[64:79]
    s_add_u32 m0, s44, 81920
    s_add_u32 s21, s45, 640
    s_and_b32 s21, s21, 2047
    buffer_load_dwordx4 v12, s[8:11], s21 offen offset:0 lds
    v_mfma_f32_32x32x16_bf16 v[80:95], v[144:147], v[156:159], v[80:95]
    v_mfma_f32_32x32x16_bf16 v[96:111], v[148:151], v[152:155], v[96:111]
    buffer_load_dwordx4 v13, s[8:11], s21 offen offset:1024 lds
    v_mfma_f32_32x32x16_bf16 v[112:127], v[148:151], v[156:159], v[112:127]
    ds_read_b128 v[144:147], v19 offset:0
    ds_read_b128 v[148:151], v19 offset:4096
    ds_read_b128 v[152:155], v23 offset:16384
    ds_read_b128 v[156:159], v23 offset:20480
    s_waitcnt lgkmcnt(4)
    v_mfma_f32_32x32x16_bf16 v[64:79], v[128:131], v[136:139], v[64:79]
    buffer_load_dwordx4 v14, s[8:11], s21 offen offset:2048 lds
    v_mfma_f32_32x32x16_bf16 v[80:95], v[128:131], v[140:143], v[80:95]
    v_mfma_f32_32x32x16_bf16 v[96:111], v[132:135], v[136:139], v[96:111]
    buffer_load_dwordx4 v15, s[8:11], s21 offen offset:3072 lds
    v_mfma_f32_32x32x16_bf16 v[112:127], v[132:135], v[140:143], v[112:127]
    s_waitcnt vmcnt(8) lgkmcnt(0)
    s_barrier
    ds_read_b128 v[128:131], v16 offset:32768
    ds_read_b128 v[132:135], v16 offset:36864
    ds_read_b128 v[136:139], v20 offset:49152
    ds_read_b128 v[140:143], v20 offset:53248
    v_mfma_f32_32x32x16_bf16 v[64:79], v[144:147], v[152:155], v[64:79]
    s_add_u32 m0, s44, 0
    s_add_u32 s21, s45, 768
    s_and_b32 s21, s21, 2047
    buffer_load_dwordx4 v8, s[4:7], s21 offen offset:0 lds
    v_lshlrev_b32 v60, 16, v60
    v_lshlrev_b32 v61, 16, v61
    v_lshlrev_b32 v62, 16, v62
    v_mul_f32 v48, 1069066811, v62
    v_exp_f32 v48, v48
    s_nop 0
    v_mfma_f32_32x32x16_bf16 v[80:95], v[144:147], v[156:159], v[80:95]
    v_cvt_pk_bf16_f32 v48, v48, v48
    v_lshlrev_b32 v48, 16, v48
    v_mul_f32 v49, v48, v60
    v_mul_f32 v50, v48, v61
    v_mul_f32 v49, 1069066811, v49
    v_exp_f32 v49, v49
    v_mfma_f32_32x32x16_bf16 v[96:111], v[148:151], v[152:155], v[96:111]
    buffer_load_dwordx4 v9, s[4:7], s21 offen offset:1024 lds
    v_mul_f32 v50, 1042479491, v50
    v_rndne_f32 v51, v50
    v_sub_f32 v50, v50, v51
    v_cos_f32 v51, v50
    v_sin_f32 v52, v50
    v_mul_f32 v53, v60, v60
    v_mfma_f32_32x32x16_bf16 v[112:127], v[148:151], v[156:159], v[112:127]
    v_mul_f32 v32, v49, v51
    v_mul_f32 v33, v49, v52
    v_fma_f32 v53, v61, v61, v53
    v_rcp_f32 v53, v53
    v_add_f32 v48, -1.0, v32
    v_add_f32 v53, v53, v53
    ds_read_b128 v[144:147], v17 offset:32768
    ds_read_b128 v[148:151], v17 offset:36864
    ds_read_b128 v[152:155], v21 offset:49152
    ds_read_b128 v[156:159], v21 offset:53248
    s_waitcnt lgkmcnt(4)
    v_mfma_f32_32x32x16_bf16 v[64:79], v[128:131], v[136:139], v[64:79]
    buffer_load_dwordx4 v10, s[4:7], s21 offen offset:2048 lds
    v_mul_f32 v49, v48, v60
    v_fma_f32 v49, v33, v61, v49
    v_mul_f32 v50, v33, v60
    v_fma_f32 v50, -v48, v61, v50
    v_mul_f32 v34, v49, v53
    v_mul_f32 v35, v50, v53
    v_mfma_f32_32x32x16_bf16 v[80:95], v[128:131], v[140:143], v[80:95]
    v_mul_f32 v48, v33, v33
    v_fma_f32 v48, v32, v32, -v48
    v_mul_f32 v49, v32, v33
    v_add_f32 v49, v49, v49
    v_mul_f32 v50, v49, v49
    v_fma_f32 v50, v48, v48, -v50
    v_mfma_f32_32x32x16_bf16 v[96:111], v[132:135], v[136:139], v[96:111]
    buffer_load_dwordx4 v11, s[4:7], s21 offen offset:3072 lds
    v_mul_f32 v51, v48, v49
    v_add_f32 v51, v51, v51
    v_mul_f32 v48, v51, v51
    v_fma_f32 v48, v50, v50, -v48
    v_mul_f32 v49, v50, v51
    v_add_f32 v49, v49, v49
    v_mfma_f32_32x32x16_bf16 v[112:127], v[132:135], v[140:143], v[112:127]
    v_mul_f32 v36, v49, v49
    v_fma_f32 v36, v48, v48, -v36
    v_mul_f32 v37, v48, v49
    v_add_f32 v37, v37, v37
    v_mul_f32 v48, v37, v37
    v_fma_f32 v48, v36, v36, -v48
    ds_read_b128 v[128:131], v18 offset:32768
    ds_read_b128 v[132:135], v18 offset:36864
    ds_read_b128 v[136:139], v22 offset:49152
    ds_read_b128 v[140:143], v22 offset:53248
    s_waitcnt lgkmcnt(4)
    v_mfma_f32_32x32x16_bf16 v[64:79], v[144:147], v[152:155], v[64:79]
    s_add_u32 m0, s44, 16384
    s_add_u32 s21, s45, 768
    s_and_b32 s21, s21, 2047
    buffer_load_dwordx4 v12, s[8:11], s21 offen offset:0 lds
    v_mul_f32 v49, v36, v37
    v_add_f32 v49, v49, v49
    v_mul_f32 v50, v49, v49
    v_fma_f32 v50, v48, v48, -v50
    v_mul_f32 v51, v48, v49
    v_add_f32 v51, v51, v51
    v_mfma_f32_32x32x16_bf16 v[80:95], v[144:147], v[156:159], v[80:95]
    v_mul_f32 v38, v51, v51
    v_fma_f32 v38, v50, v50, -v38
    v_mul_f32 v39, v50, v51
    v_add_f32 v39, v39, v39
    v_mul_f32 v40, v39, v39
    v_fma_f32 v40, v38, v38, -v40
    v_mfma_f32_32x32x16_bf16 v[96:111], v[148:151], v[152:155], v[96:111]
    buffer_load_dwordx4 v13, s[8:11], s21 offen offset:1024 lds
    v_mul_f32 v41, v38, v39
    v_add_f32 v41, v41, v41
    v_cmp_eq_u32 vcc, 1, v47
    s_cmp_eq_u32 s19, 1
    s_cselect_b64 s[38:39], -1, 0
    v_cndmask_b32 v48, 1.0, v48, vcc
    v_mfma_f32_32x32x16_bf16 v[112:127], v[148:151], v[156:159], v[112:127]
    v_cndmask_b32 v49, 0, v49, vcc
    v_cndmask_b32 v50, 1.0, v50, s[38:39]
    v_cndmask_b32 v51, 0, v51, s[38:39]
    v_mul_f32 v42, v48, v50
    v_mul_f32 v44, v48, v51
    v_fma_f32 v42, -v49, v51, v42
    ds_read_b128 v[144:147], v19 offset:32768
    ds_read_b128 v[148:151], v19 offset:36864
    ds_read_b128 v[152:155], v23 offset:49152
    ds_read_b128 v[156:159], v23 offset:53248
    s_waitcnt lgkmcnt(4)
    v_mfma_f32_32x32x16_bf16 v[64:79], v[128:131], v[136:139], v[64:79]
    buffer_load_dwordx4 v14, s[8:11], s21 offen offset:2048 lds
    v_fma_f32 v44, v49, v50, v44
    v_mul_f32 v43, v42, v36
    v_mul_f32 v45, v42, v37
    v_fma_f32 v43, -v44, v37, v43
    v_fma_f32 v45, v44, v36, v45
    v_mfma_f32_32x32x16_bf16 v[80:95], v[128:131], v[140:143], v[80:95]
    v_mfma_f32_32x32x16_bf16 v[96:111], v[132:135], v[136:139], v[96:111]
    buffer_load_dwordx4 v15, s[8:11], s21 offen offset:3072 lds
    v_mfma_f32_32x32x16_bf16 v[112:127], v[132:135], v[140:143], v[112:127]
    s_waitcnt vmcnt(8) lgkmcnt(0)
    s_barrier
    ds_read_b128 v[128:131], v24 offset:0
    ds_read_b128 v[132:135], v24 offset:4096
    ds_read_b128 v[136:139], v28 offset:16384
    ds_read_b128 v[140:143], v28 offset:20480
    v_mfma_f32_32x32x16_bf16 v[64:79], v[144:147], v[152:155], v[64:79]
    s_add_u32 m0, s44, 32768
    s_add_u32 s21, s45, 896
    s_and_b32 s21, s21, 2047
    buffer_load_dwordx4 v8, s[4:7], s21 offen offset:0 lds
    v_mfma_f32_32x32x16_bf16 v[80:95], v[144:147], v[156:159], v[80:95]
    v_mfma_f32_32x32x16_bf16 v[96:111], v[148:151], v[152:155], v[96:111]
    buffer_load_dwordx4 v9, s[4:7], s21 offen offset:1024 lds
    v_mfma_f32_32x32x16_bf16 v[112:127], v[148:151], v[156:159], v[112:127]
    ds_read_b128 v[144:147], v25 offset:0
    ds_read_b128 v[148:151], v25 offset:4096
    ds_read_b128 v[152:155], v29 offset:16384
    ds_read_b128 v[156:159], v29 offset:20480
    s_waitcnt lgkmcnt(4)
    v_mfma_f32_32x32x16_bf16 v[64:79], v[128:131], v[136:139], v[64:79]
    buffer_load_dwordx4 v10, s[4:7], s21 offen offset:2048 lds
    v_mfma_f32_32x32x16_bf16 v[80:95], v[128:131], v[140:143], v[80:95]
    v_mfma_f32_32x32x16_bf16 v[96:111], v[132:135], v[136:139], v[96:111]
    buffer_load_dwordx4 v11, s[4:7], s21 offen offset:3072 lds
    v_mfma_f32_32x32x16_bf16 v[112:127], v[132:135], v[140:143], v[112:127]
    ds_read_b128 v[128:131], v26 offset:0
    ds_read_b128 v[132:135], v26 offset:4096
    ds_read_b128 v[136:139], v30 offset:16384
    ds_read_b128 v[140:143], v30 offset:20480
    s_waitcnt lgkmcnt(4)
    v_mfma_f32_32x32x16_bf16 v[64:79], v[144:147], v[152:155], v[64:79]
    s_add_u32 m0, s44, 49152
    s_add_u32 s21, s45, 896
    s_and_b32 s21, s21, 2047
    buffer_load_dwordx4 v12, s[8:11], s21 offen offset:0 lds
    v_mfma_f32_32x32x16_bf16 v[80:95], v[144:147], v[156:159], v[80:95]
    v_mfma_f32_32x32x16_bf16 v[96:111], v[148:151], v[152:155], v[96:111]
    buffer_load_dwordx4 v13, s[8:11], s21 offen offset:1024 lds
    v_mfma_f32_32x32x16_bf16 v[112:127], v[148:151], v[156:159], v[112:127]
    ds_read_b128 v[144:147], v27 offset:0
    ds_read_b128 v[148:151], v27 offset:4096
    ds_read_b128 v[152:155], v31 offset:16384
    ds_read_b128 v[156:159], v31 offset:20480
    s_waitcnt lgkmcnt(4)
    v_mfma_f32_32x32x16_bf16 v[64:79], v[128:131], v[136:139], v[64:79]
    buffer_load_dwordx4 v14, s[8:11], s21 offen offset:2048 lds
    v_mfma_f32_32x32x16_bf16 v[80:95], v[128:131], v[140:143], v[80:95]
    v_mfma_f32_32x32x16_bf16 v[96:111], v[132:135], v[136:139], v[96:111]
    buffer_load_dwordx4 v15, s[8:11], s21 offen offset:3072 lds
    v_mfma_f32_32x32x16_bf16 v[112:127], v[132:135], v[140:143], v[112:127]
    s_waitcnt vmcnt(8) lgkmcnt(0)
    s_barrier
    ds_read_b128 v[128:131], v16 offset:0
    ds_read_b128 v[132:135], v16 offset:4096
    ds_read_b128 v[136:139], v20 offset:16384
    ds_read_b128 v[140:143], v20 offset:20480
    v_mfma_f32_32x32x16_bf16 v[64:79], v[144:147], v[152:155], v[64:79]
    s_add_u32 m0, s44, 65536
    s_add_u32 s21, s45, 1024
    s_and_b32 s21, s21, 2047
    buffer_load_dwordx4 v8, s[4:7], s21 offen offset:0 lds
    v_mfma_f32_32x32x16_bf16 v[80:95], v[144:147], v[156:159], v[80:95]
    v_mfma_f32_32x32x16_bf16 v[96:111], v[148:151], v[152:155], v[96:111]
    buffer_load_dwordx4 v9, s[4:7], s21 offen offset:1024 lds
    v_mfma_f32_32x32x16_bf16 v[112:127], v[148:151], v[156:159], v[112:127]
    ds_read_b128 v[144:147], v17 offset:0
    ds_read_b128 v[148:151], v17 offset:4096
    ds_read_b128 v[152:155], v21 offset:16384
    ds_read_b128 v[156:159], v21 offset:20480
    s_waitcnt lgkmcnt(4)
    v_mfma_f32_32x32x16_bf16 v[64:79], v[128:131], v[136:139], v[64:79]
    buffer_load_dwordx4 v10, s[4:7], s21 offen offset:2048 lds
    v_mfma_f32_32x32x16_bf16 v[80:95], v[128:131], v[140:143], v[80:95]
    v_mfma_f32_32x32x16_bf16 v[96:111], v[132:135], v[136:139], v[96:111]
    buffer_load_dwordx4 v11, s[4:7], s21 offen offset:3072 lds
    v_mfma_f32_32x32x16_bf16 v[112:127], v[132:135], v[140:143], v[112:127]
    ds_read_b128 v[128:131], v18 offset:0
    ds_read_b128 v[132:135], v18 offset:4096
    ds_read_b128 v[136:139], v22 offset:16384
    ds_read_b128 v[140:143], v22 offset:20480
    s_waitcnt lgkmcnt(4)
    v_mfma_f32_32x32x16_bf16 v[64:79], v[144:147], v[152:155], v[64:79]
    s_add_u32 m0, s44, 81920
    s_add_u32 s21, s45, 1024
    s_and_b32 s21, s21, 2047
    buffer_load_dwordx4 v12, s[8:11], s21 offen offset:0 lds
    v_mfma_f32_32x32x16_bf16 v[80:95], v[144:147], v[156:159], v[80:95]
    v_mfma_f32_32x32x16_bf16 v[96:111], v[148:151], v[152:155], v[96:111]
    buffer_load_dwordx4 v13, s[8:11], s21 offen offset:1024 lds
    v_mfma_f32_32x32x16_bf16 v[112:127], v[148:151], v[156:159], v[112:127]
    ds_read_b128 v[144:147], v19 offset:0
    ds_read_b128 v[148:151], v19 offset:4096
    ds_read_b128 v[152:155], v23 offset:16384
    ds_read_b128 v[156:159], v23 offset:20480
    s_waitcnt lgkmcnt(4)
    v_mfma_f32_32x32x16_bf16 v[64:79], v[128:131], v[136:139], v[64:79]
    buffer_load_dwordx4 v14, s[8:11], s21 offen offset:2048 lds
    v_mfma_f32_32x32x16_bf16 v[80:95], v[128:131], v[140:143], v[80:95]
    v_mfma_f32_32x32x16_bf16 v[96:111], v[132:135], v[136:139], v[96:111]
    buffer_load_dwordx4 v15, s[8:11], s21 offen offset:3072 lds
    v_mfma_f32_32x32x16_bf16 v[112:127], v[132:135], v[140:143], v[112:127]
    s_waitcnt vmcnt(8) lgkmcnt(0)
    s_barrier
    ds_read_b128 v[128:131], v16 offset:32768
    ds_read_b128 v[132:135], v16 offset:36864
    ds_read_b128 v[136:139], v20 offset:49152
    ds_read_b128 v[140:143], v20 offset:53248
    v_mfma_f32_32x32x16_bf16 v[64:79], v[144:147], v[152:155], v[64:79]
    s_add_u32 m0, s44, 0
    s_add_u32 s21, s45, 1152
    s_and_b32 s21, s21, 2047
    buffer_load_dwordx4 v8, s[4:7], s21 offen offset:0 lds
    v_mfma_f32_32x32x16_bf16 v[80:95], v[144:147], v[156:159], v[80:95]
    v_mfma_f32_32x32x16_bf16 v[96:111], v[148:151], v[152:155], v[96:111]
    buffer_load_dwordx4 v9, s[4:7], s21 offen offset:1024 lds
    v_mfma_f32_32x32x16_bf16 v[112:127], v[148:151], v[156:159], v[112:127]
    ds_read_b128 v[144:147], v17 offset:32768
    ds_read_b128 v[148:151], v17 offset:36864
    ds_read_b128 v[152:155], v21 offset:49152
    ds_read_b128 v[156:159], v21 offset:53248
    s_waitcnt lgkmcnt(4)
    v_mfma_f32_32x32x16_bf16 v[64:79], v[128:131], v[136:139], v[64:79]
    buffer_load_dwordx4 v10, s[4:7], s21 offen offset:2048 lds
    v_mfma_f32_32x32x16_bf16 v[80:95], v[128:131], v[140:143], v[80:95]
    v_mfma_f32_32x32x16_bf16 v[96:111], v[132:135], v[136:139], v[96:111]
    buffer_load_dwordx4 v11, s[4:7], s21 offen offset:3072 lds
    v_mfma_f32_32x32x16_bf16 v[112:127], v[132:135], v[140:143], v[112:127]
    ds_read_b128 v[128:131], v18 offset:32768
    ds_read_b128 v[132:135], v18 offset:36864
    ds_read_b128 v[136:139], v22 offset:49152
    ds_read_b128 v[140:143], v22 offset:53248
    s_waitcnt lgkmcnt(4)
    v_mfma_f32_32x32x16_bf16 v[64:79], v[144:147], v[152:155], v[64:79]
    s_add_u32 m0, s44, 16384
    s_add_u32 s21, s45, 1152
    s_and_b32 s21, s21, 2047
    buffer_load_dwordx4 v12, s[8:11], s21 offen offset:0 lds
    v_mfma_f32_32x32x16_bf16 v[80:95], v[144:147], v[156:159], v[80:95]
    v_mfma_f32_32x32x16_bf16 v[96:111], v[148:151], v[152:155], v[96:111]
    buffer_load_dwordx4 v13, s[8:11], s21 offen offset:1024 lds
    v_mfma_f32_32x32x16_bf16 v[112:127], v[148:151], v[156:159], v[112:127]
    ds_read_b128 v[144:147], v19 offset:32768
    ds_read_b128 v[148:151], v19 offset:36864
    ds_read_b128 v[152:155], v23 offset:49152
    ds_read_b128 v[156:159], v23 offset:53248
    s_waitcnt lgkmcnt(4)
    v_mfma_f32_32x32x16_bf16 v[64:79], v[128:131], v[136:139], v[64:79]
    buffer_load_dwordx4 v14, s[8:11], s21 offen offset:2048 lds
    v_mfma_f32_32x32x16_bf16 v[80:95], v[128:131], v[140:143], v[80:95]
    v_mfma_f32_32x32x16_bf16 v[96:111], v[132:135], v[136:139], v[96:111]
    buffer_load_dwordx4 v15, s[8:11], s21 offen offset:3072 lds
    v_mfma_f32_32x32x16_bf16 v[112:127], v[132:135], v[140:143], v[112:127]
    s_waitcnt vmcnt(8) lgkmcnt(0)
    s_barrier
    ds_read_b128 v[128:131], v24 offset:0
    ds_read_b128 v[132:135], v24 offset:4096
    ds_read_b128 v[136:139], v28 offset:16384
    ds_read_b128 v[140:143], v28 offset:20480
    v_mfma_f32_32x32x16_bf16 v[64:79], v[144:147], v[152:155], v[64:79]
    s_add_u32 m0, s44, 32768
    s_add_u32 s21, s45, 1280
    s_and_b32 s21, s21, 2047
    buffer_load_dwordx4 v8, s[4:7], s21 offen offset:0 lds
    v_mfma_f32_32x32x16_bf16 v[80:95], v[144:147], v[156:159], v[80:95]
    v_mfma_f32_32x32x16_bf16 v[96:111], v[148:151], v[152:155], v[96:111]
    buffer_load_dwordx4 v9, s[4:7], s21 offen offset:1024 lds
    v_mfma_f32_32x32x16_bf16 v[112:127], v[148:151], v[156:159], v[112:127]
    ds_read_b128 v[144:147], v25 offset:0
    ds_read_b128 v[148:151], v25 offset:4096
    ds_read_b128 v[152:155], v29 offset:16384
    ds_read_b128 v[156:159], v29 offset:20480
    s_waitcnt lgkmcnt(4)
    v_mfma_f32_32x32x16_bf16 v[64:79], v[128:131], v[136:139], v[64:79]
    buffer_load_dwordx4 v10, s[4:7], s21 offen offset:2048 lds
    v_mfma_f32_32x32x16_bf16 v[80:95], v[128:131], v[140:143], v[80:95]
    v_mfma_f32_32x32x16_bf16 v[96:111], v[132:135], v[136:139], v[96:111]
    buffer_load_dwordx4 v11, s[4:7], s21 offen offset:3072 lds
    v_mfma_f32_32x32x16_bf16 v[112:127], v[132:135], v[140:143], v[112:127]
    ds_read_b128 v[128:131], v26 offset:0
    ds_read_b128 v[132:135], v26 offset:4096
    ds_read_b128 v[136:139], v30 offset:16384
    ds_read_b128 v[140:143], v30 offset:20480
    s_waitcnt lgkmcnt(4)
    v_mfma_f32_32x32x16_bf16 v[64:79], v[144:147], v[152:155], v[64:79]
    s_add_u32 m0, s44, 49152
    s_add_u32 s21, s45, 1280
    s_and_b32 s21, s21, 2047
    buffer_load_dwordx4 v12, s[8:11], s21 offen offset:0 lds
    v_mfma_f32_32x32x16_bf16 v[80:95], v[144:147], v[156:159], v[80:95]
    v_mfma_f32_32x32x16_bf16 v[96:111], v[148:151], v[152:155], v[96:111]
    buffer_load_dwordx4 v13, s[8:11], s21 offen offset:1024 lds
    v_mfma_f32_32x32x16_bf16 v[112:127], v[148:151], v[156:159], v[112:127]
    ds_read_b128 v[144:147], v27 offset:0
    ds_read_b128 v[148:151], v27 offset:4096
    ds_read_b128 v[152:155], v31 offset:16384
    ds_read_b128 v[156:159], v31 offset:20480
    s_waitcnt lgkmcnt(4)
    v_mfma_f32_32x32x16_bf16 v[64:79], v[128:131], v[136:139], v[64:79]
    buffer_load_dwordx4 v14, s[8:11], s21 offen offset:2048 lds
    v_mfma_f32_32x32x16_bf16 v[80:95], v[128:131], v[140:143], v[80:95]
    v_mfma_f32_32x32x16_bf16 v[96:111], v[132:135], v[136:139], v[96:111]
    buffer_load_dwordx4 v15, s[8:11], s21 offen offset:3072 lds
    v_mfma_f32_32x32x16_bf16 v[112:127], v[132:135], v[140:143], v[112:127]
    s_waitcnt vmcnt(8) lgkmcnt(0)
    s_barrier
    ds_read_b128 v[128:131], v16 offset:0
    ds_read_b128 v[132:135], v16 offset:4096
    ds_read_b128 v[136:139], v20 offset:16384
    ds_read_b128 v[140:143], v20 offset:20480
    v_mfma_f32_32x32x16_bf16 v[64:79], v[144:147], v[152:155], v[64:79]
    s_add_u32 m0, s44, 65536
    s_add_u32 s21, s45, 1408
    s_and_b32 s21, s21, 2047
    buffer_load_dwordx4 v8, s[4:7], s21 offen offset:0 lds
    v_mfma_f32_32x32x16_bf16 v[80:95], v[144:147], v[156:159], v[80:95]
    v_mfma_f32_32x32x16_bf16 v[96:111], v[148:151], v[152:155], v[96:111]
    buffer_load_dwordx4 v9, s[4:7], s21 offen offset:1024 lds
    v_mfma_f32_32x32x16_bf16 v[112:127], v[148:151], v[156:159], v[112:127]
    ds_read_b128 v[144:147], v17 offset:0
    ds_read_b128 v[148:151], v17 offset:4096
    ds_read_b128 v[152:155], v21 offset:16384
    ds_read_b128 v[156:159], v21 offset:20480
    s_waitcnt lgkmcnt(4)
    v_mfma_f32_32x32x16_bf16 v[64:79], v[128:131], v[136:139], v[64:79]
    buffer_load_dwordx4 v10, s[4:7], s21 offen offset:2048 lds
    v_mfma_f32_32x32x16_bf16 v[80:95], v[128:131], v[140:143], v[80:95]
    v_mfma_f32_32x32x16_bf16 v[96:111], v[132:135], v[136:139], v[96:111]
    buffer_load_dwordx4 v11, s[4:7], s21 offen offset:3072 lds
    v_mfma_f32_32x32x16_bf16 v[112:127], v[132:135], v[140:143], v[112:127]
    ds_read_b128 v[128:131], v18 offset:0
    ds_read_b128 v[132:135], v18 offset:4096
    ds_read_b128 v[136:139], v22 offset:16384
    ds_read_b128 v[140:143], v22 offset:20480
    s_waitcnt lgkmcnt(4)
    v_mfma_f32_32x32x16_bf16 v[64:79], v[144:147], v[152:155], v[64:79]
    s_add_u32 m0, s44, 81920
    s_add_u32 s21, s45, 1408
    s_and_b32 s21, s21, 2047
    buffer_load_dwordx4 v12, s[8:11], s21 offen offset:0 lds
    v_mfma_f32_32x32x16_bf16 v[80:95], v[144:147], v[156:159], v[80:95]
    v_mfma_f32_32x32x16_bf16 v[96:111], v[148:151], v[152:155], v[96:111]
    buffer_load_dwordx4 v13, s[8:11], s21 offen offset:1024 lds
    v_mfma_f32_32x32x16_bf16 v[112:127], v[148:151], v[156:159], v[112:127]
    ds_read_b128 v[144:147], v19 offset:0
    ds_read_b128 v[148:151], v19 offset:4096
    ds_read_b128 v[152:155], v23 offset:16384
    ds_read_b128 v[156:159], v23 offset:20480
    s_waitcnt lgkmcnt(4)
    v_mfma_f32_32x32x16_bf16 v[64:79], v[128:131], v[136:139], v[64:79]
    buffer_load_dwordx4 v14, s[8:11], s21 offen offset:2048 lds
    v_mfma_f32_32x32x16_bf16 v[80:95], v[128:131], v[140:143], v[80:95]
    v_mfma_f32_32x32x16_bf16 v[96:111], v[132:135], v[136:139], v[96:111]
    buffer_load_dwordx4 v15, s[8:11], s21 offen offset:3072 lds
    v_mfma_f32_32x32x16_bf16 v[112:127], v[132:135], v[140:143], v[112:127]
    s_waitcnt vmcnt(8) lgkmcnt(0)
    s_barrier
    ds_read_b128 v[128:131], v16 offset:32768
    ds_read_b128 v[132:135], v16 offset:36864
    ds_read_b128 v[136:139], v20 offset:49152
    ds_read_b128 v[140:143], v20 offset:53248
    v_mfma_f32_32x32x16_bf16 v[64:79], v[144:147], v[152:155], v[64:79]
    s_add_u32 m0, s44, 0
    s_add_u32 s21, s45, 1536
    s_and_b32 s21, s21, 2047
    buffer_load_dwordx4 v8, s[4:7], s21 offen offset:0 lds
    v_mfma_f32_32x32x16_bf16 v[80:95], v[144:147], v[156:159], v[80:95]
    v_mfma_f32_32x32x16_bf16 v[96:111], v[148:151], v[152:155], v[96:111]
    buffer_load_dwordx4 v9, s[4:7], s21 offen offset:1024 lds
    v_mfma_f32_32x32x16_bf16 v[112:127], v[148:151], v[156:159], v[112:127]
    ds_read_b128 v[144:147], v17 offset:32768
    ds_read_b128 v[148:151], v17 offset:36864
    ds_read_b128 v[152:155], v21 offset:49152
    ds_read_b128 v[156:159], v21 offset:53248
    s_waitcnt lgkmcnt(4)
    v_mfma_f32_32x32x16_bf16 v[64:79], v[128:131], v[136:139], v[64:79]
    buffer_load_dwordx4 v10, s[4:7], s21 offen offset:2048 lds
    v_mfma_f32_32x32x16_bf16 v[80:95], v[128:131], v[140:143], v[80:95]
    v_mfma_f32_32x32x16_bf16 v[96:111], v[132:135], v[136:139], v[96:111]
    buffer_load_dwordx4 v11, s[4:7], s21 offen offset:3072 lds
    v_mfma_f32_32x32x16_bf16 v[112:127], v[132:135], v[140:143], v[112:127]
    ds_read_b128 v[128:131], v18 offset:32768
    ds_read_b128 v[132:135], v18 offset:36864
    ds_read_b128 v[136:139], v22 offset:49152
    ds_read_b128 v[140:143], v22 offset:53248
    s_waitcnt lgkmcnt(4)
    v_mfma_f32_32x32x16_bf16 v[64:79], v[144:147], v[152:155], v[64:79]
    s_add_u32 m0, s44, 16384
    s_add_u32 s21, s45, 1536
    s_and_b32 s21, s21, 2047
    buffer_load_dwordx4 v12, s[8:11], s21 offen offset:0 lds
    v_mfma_f32_32x32x16_bf16 v[80:95], v[144:147], v[156:159], v[80:95]
    v_mfma_f32_32x32x16_bf16 v[96:111], v[148:151], v[152:155], v[96:111]
    buffer_load_dwordx4 v13, s[8:11], s21 offen offset:1024 lds
    v_mfma_f32_32x32x16_bf16 v[112:127], v[148:151], v[156:159], v[112:127]
    ds_read_b128 v[144:147], v19 offset:32768
    ds_read_b128 v[148:151], v19 offset:36864
    ds_read_b128 v[152:155], v23 offset:49152
    ds_read_b128 v[156:159], v23 offset:53248
    s_waitcnt lgkmcnt(4)
    v_mfma_f32_32x32x16_bf16 v[64:79], v[128:131], v[136:139], v[64:79]
    buffer_load_dwordx4 v14, s[8:11], s21 offen offset:2048 lds
    v_mfma_f32_32x32x16_bf16 v[80:95], v[128:131], v[140:143], v[80:95]
    v_mfma_f32_32x32x16_bf16 v[96:111], v[132:135], v[136:139], v[96:111]
    buffer_load_dwordx4 v15, s[8:11], s21 offen offset:3072 lds
    v_mfma_f32_32x32x16_bf16 v[112:127], v[132:135], v[140:143], v[112:127]
    s_waitcnt vmcnt(8) lgkmcnt(0)
    s_barrier
    ds_read_b128 v[128:131], v24 offset:0
    ds_read_b128 v[132:135], v24 offset:4096
    ds_read_b128 v[136:139], v28 offset:16384
    ds_read_b128 v[140:143], v28 offset:20480
    v_mfma_f32_32x32x16_bf16 v[64:79], v[144:147], v[152:155], v[64:79]
    s_add_u32 m0, s44, 32768
    s_add_u32 s21, s45, 1664
    s_and_b32 s21, s21, 2047
    buffer_load_dwordx4 v8, s[4:7], s21 offen offset:0 lds
    v_mfma_f32_32x32x16_bf16 v[80:95], v[144:147], v[156:159], v[80:95]
    v_mfma_f32_32x32x16_bf16 v[96:111], v[148:151], v[152:155], v[96:111]
    buffer_load_dwordx4 v9, s[4:7], s21 offen offset:1024 lds
    v_mfma_f32_32x32x16_bf16 v[112:127], v[148:151], v[156:159], v[112:127]
    ds_read_b128 v[144:147], v25 offset:0
    ds_read_b128 v[148:151], v25 offset:4096
    ds_read_b128 v[152:155], v29 offset:16384
    ds_read_b128 v[156:159], v29 offset:20480
    s_waitcnt lgkmcnt(4)
    v_mfma_f32_32x32x16_bf16 v[64:79], v[128:131], v[136:139], v[64:79]
    buffer_load_dwordx4 v10, s[4:7], s21 offen offset:2048 lds
    v_mfma_f32_32x32x16_bf16 v[80:95], v[128:131], v[140:143], v[80:95]
    v_mfma_f32_32x32x16_bf16 v[96:111], v[132:135], v[136:139], v[96:111]
    buffer_load_dwordx4 v11, s[4:7], s21 offen offset:3072 lds
    v_mfma_f32_32x32x16_bf16 v[112:127], v[132:135], v[140:143], v[112:127]
    ds_read_b128 v[128:131], v26 offset:0
    ds_read_b128 v[132:135], v26 offset:4096
    ds_read_b128 v[136:139], v30 offset:16384
    ds_read_b128 v[140:143], v30 offset:20480
    s_waitcnt lgkmcnt(4)
    v_mfma_f32_32x32x16_bf16 v[64:79], v[144:147], v[152:155], v[64:79]
    s_add_u32 m0, s44, 49152
    s_add_u32 s21, s45, 1664
    s_and_b32 s21, s21, 2047
    buffer_load_dwordx4 v12, s[8:11], s21 offen offset:0 lds
    v_mfma_f32_32x32x16_bf16 v[80:95], v[144:147], v[156:159], v[80:95]
    v_mfma_f32_32x32x16_bf16 v[96:111], v[148:151], v[152:155], v[96:111]
    buffer_load_dwordx4 v13, s[8:11], s21 offen offset:1024 lds
    v_mfma_f32_32x32x16_bf16 v[112:127], v[148:151], v[156:159], v[112:127]
    ds_read_b128 v[144:147], v27 offset:0
    ds_read_b128 v[148:151], v27 offset:4096
    ds_read_b128 v[152:155], v31 offset:16384
    ds_read_b128 v[156:159], v31 offset:20480
    s_waitcnt lgkmcnt(4)
    v_mfma_f32_32x32x16_bf16 v[64:79], v[128:131], v[136:139], v[64:79]
    buffer_load_dwordx4 v14, s[8:11], s21 offen offset:2048 lds
    v_mfma_f32_32x32x16_bf16 v[80:95], v[128:131], v[140:143], v[80:95]
    v_mfma_f32_32x32x16_bf16 v[96:111], v[132:135], v[136:139], v[96:111]
    buffer_load_dwordx4 v15, s[8:11], s21 offen offset:3072 lds
    v_mfma_f32_32x32x16_bf16 v[112:127], v[132:135], v[140:143], v[112:127]
    s_waitcnt vmcnt(8) lgkmcnt(0)
    s_barrier
    ds_read_b128 v[128:131], v16 offset:0
    ds_read_b128 v[132:135], v16 offset:4096
    ds_read_b128 v[136:139], v20 offset:16384
    ds_read_b128 v[140:143], v20 offset:20480
    v_mfma_f32_32x32x16_bf16 v[64:79], v[144:147], v[152:155], v[64:79]
    s_add_u32 m0, s44, 65536
    s_add_u32 s21, s45, 1792
    s_and_b32 s21, s21, 2047
    buffer_load_dwordx4 v8, s[4:7], s21 offen offset:0 lds
    v_mfma_f32_32x32x16_bf16 v[80:95], v[144:147], v[156:159], v[80:95]
    v_mfma_f32_32x32x16_bf16 v[96:111], v[148:151], v[152:155], v[96:111]
    buffer_load_dwordx4 v9, s[4:7], s21 offen offset:1024 lds
    v_mfma_f32_32x32x16_bf16 v[112:127], v[148:151], v[156:159], v[112:127]
    ds_read_b128 v[144:147], v17 offset:0
    ds_read_b128 v[148:151], v17 offset:4096
    ds_read_b128 v[152:155], v21 offset:16384
    ds_read_b128 v[156:159], v21 offset:20480
    s_waitcnt lgkmcnt(4)
    v_mfma_f32_32x32x16_bf16 v[64:79], v[128:131], v[136:139], v[64:79]
    buffer_load_dwordx4 v10, s[4:7], s21 offen offset:2048 lds
    v_mfma_f32_32x32x16_bf16 v[80:95], v[128:131], v[140:143], v[80:95]
    v_mfma_f32_32x32x16_bf16 v[96:111], v[132:135], v[136:139], v[96:111]
    buffer_load_dwordx4 v11, s[4:7], s21 offen offset:3072 lds
    v_mfma_f32_32x32x16_bf16 v[112:127], v[132:135], v[140:143], v[112:127]
    ds_read_b128 v[128:131], v18 offset:0
    ds_read_b128 v[132:135], v18 offset:4096
    ds_read_b128 v[136:139], v22 offset:16384
    ds_read_b128 v[140:143], v22 offset:20480
    s_waitcnt lgkmcnt(4)
    v_mfma_f32_32x32x16_bf16 v[64:79], v[144:147], v[152:155], v[64:79]
    s_add_u32 m0, s44, 81920
    s_add_u32 s21, s45, 1792
    s_and_b32 s21, s21, 2047
    buffer_load_dwordx4 v12, s[8:11], s21 offen offset:0 lds
    v_mfma_f32_32x32x16_bf16 v[80:95], v[144:147], v[156:159], v[80:95]
    v_mfma_f32_32x32x16_bf16 v[96:111], v[148:151], v[152:155], v[96:111]
    buffer_load_dwordx4 v13, s[8:11], s21 offen offset:1024 lds
    v_mfma_f32_32x32x16_bf16 v[112:127], v[148:151], v[156:159], v[112:127]
    ds_read_b128 v[144:147], v19 offset:0
    ds_read_b128 v[148:151], v19 offset:4096
    ds_read_b128 v[152:155], v23 offset:16384
    ds_read_b128 v[156:159], v23 offset:20480
    s_waitcnt lgkmcnt(4)
    v_mfma_f32_32x32x16_bf16 v[64:79], v[128:131], v[136:139], v[64:79]
    buffer_load_dwordx4 v14, s[8:11], s21 offen offset:2048 lds
    v_mfma_f32_32x32x16_bf16 v[80:95], v[128:131], v[140:143], v[80:95]
    v_mfma_f32_32x32x16_bf16 v[96:111], v[132:135], v[136:139], v[96:111]
    buffer_load_dwordx4 v15, s[8:11], s21 offen offset:3072 lds
    v_mfma_f32_32x32x16_bf16 v[112:127], v[132:135], v[140:143], v[112:127]
    s_waitcnt vmcnt(8) lgkmcnt(0)
    s_barrier
    ds_read_b128 v[128:131], v16 offset:32768
    ds_read_b128 v[132:135], v16 offset:36864
    ds_read_b128 v[136:139], v20 offset:49152
    ds_read_b128 v[140:143], v20 offset:53248
    v_mfma_f32_32x32x16_bf16 v[64:79], v[144:147], v[152:155], v[64:79]
    s_add_u32 m0, s44, 0
    s_add_u32 s21, s45, 1920
    s_and_b32 s21, s21, 2047
    buffer_load_dwordx4 v8, s[4:7], s21 offen offset:0 lds
    v_mfma_f32_32x32x16_bf16 v[80:95], v[144:147], v[156:159], v[80:95]
    v_mfma_f32_32x32x16_bf16 v[96:111], v[148:151], v[152:155], v[96:111]
    buffer_load_dwordx4 v9, s[4:7], s21 offen offset:1024 lds
    v_mfma_f32_32x32x16_bf16 v[112:127], v[148:151], v[156:159], v[112:127]
    ds_read_b128 v[144:147], v17 offset:32768
    ds_read_b128 v[148:151], v17 offset:36864
    ds_read_b128 v[152:155], v21 offset:49152
    ds_read_b128 v[156:159], v21 offset:53248
    s_waitcnt lgkmcnt(4)
    v_mfma_f32_32x32x16_bf16 v[64:79], v[128:131], v[136:139], v[64:79]
    buffer_load_dwordx4 v10, s[4:7], s21 offen offset:2048 lds
    v_mfma_f32_32x32x16_bf16 v[80:95], v[128:131], v[140:143], v[80:95]
    v_mfma_f32_32x32x16_bf16 v[96:111], v[132:135], v[136:139], v[96:111]
    buffer_load_dwordx4 v11, s[4:7], s21 offen offset:3072 lds
    v_mfma_f32_32x32x16_bf16 v[112:127], v[132:135], v[140:143], v[112:127]
    ds_read_b128 v[128:131], v18 offset:32768
    ds_read_b128 v[132:135], v18 offset:36864
    ds_read_b128 v[136:139], v22 offset:49152
    ds_read_b128 v[140:143], v22 offset:53248
    s_waitcnt lgkmcnt(4)
    v_mfma_f32_32x32x16_bf16 v[64:79], v[144:147], v[152:155], v[64:79]
    s_add_u32 m0, s44, 16384
    s_add_u32 s21, s45, 1920
    s_and_b32 s21, s21, 2047
    buffer_load_dwordx4 v12, s[8:11], s21 offen offset:0 lds
    v_mfma_f32_32x32x16_bf16 v[80:95], v[144:147], v[156:159], v[80:95]
    v_mfma_f32_32x32x16_bf16 v[96:111], v[148:151], v[152:155], v[96:111]
    buffer_load_dwordx4 v13, s[8:11], s21 offen offset:1024 lds
    v_mfma_f32_32x32x16_bf16 v[112:127], v[148:151], v[156:159], v[112:127]
    ds_read_b128 v[144:147], v19 offset:32768
    ds_read_b128 v[148:151], v19 offset:36864
    ds_read_b128 v[152:155], v23 offset:49152
    ds_read_b128 v[156:159], v23 offset:53248
    s_waitcnt lgkmcnt(4)
    v_mfma_f32_32x32x16_bf16 v[64:79], v[128:131], v[136:139], v[64:79]
    buffer_load_dwordx4 v14, s[8:11], s21 offen offset:2048 lds
    v_mfma_f32_32x32x16_bf16 v[80:95], v[128:131], v[140:143], v[80:95]
    v_mfma_f32_32x32x16_bf16 v[96:111], v[132:135], v[136:139], v[96:111]
    buffer_load_dwordx4 v15, s[8:11], s21 offen offset:3072 lds
    v_mfma_f32_32x32x16_bf16 v[112:127], v[132:135], v[140:143], v[112:127]
    s_waitcnt vmcnt(8) lgkmcnt(0)
    s_barrier
    ds_read_b128 v[128:131], v24 offset:0
    ds_read_b128 v[132:135], v24 offset:4096
    ds_read_b128 v[136:139], v28 offset:16384
    ds_read_b128 v[140:143], v28 offset:20480
    v_mfma_f32_32x32x16_bf16 v[64:79], v[144:147], v[152:155], v[64:79]
    v_mfma_f32_32x32x16_bf16 v[80:95], v[144:147], v[156:159], v[80:95]
    v_mfma_f32_32x32x16_bf16 v[96:111], v[148:151], v[152:155], v[96:111]
    v_mfma_f32_32x32x16_bf16 v[112:127], v[148:151], v[156:159], v[112:127]
    ds_read_b128 v[144:147], v25 offset:0
    ds_read_b128 v[148:151], v25 offset:4096
    ds_read_b128 v[152:155], v29 offset:16384
    ds_read_b128 v[156:159], v29 offset:20480
    s_waitcnt lgkmcnt(4)
    v_mfma_f32_32x32x16_bf16 v[64:79], v[128:131], v[136:139], v[64:79]
    v_mfma_f32_32x32x16_bf16 v[80:95], v[128:131], v[140:143], v[80:95]
    v_mfma_f32_32x32x16_bf16 v[96:111], v[132:135], v[136:139], v[96:111]
    v_mfma_f32_32x32x16_bf16 v[112:127], v[132:135], v[140:143], v[112:127]
    ds_read_b128 v[128:131], v26 offset:0
    ds_read_b128 v[132:135], v26 offset:4096
    ds_read_b128 v[136:139], v30 offset:16384
    ds_read_b128 v[140:143], v30 offset:20480
    s_waitcnt lgkmcnt(4)
    v_mfma_f32_32x32x16_bf16 v[64:79], v[144:147], v[152:155], v[64:79]
    v_mfma_f32_32x32x16_bf16 v[80:95], v[144:147], v[156:159], v[80:95]
    v_mfma_f32_32x32x16_bf16 v[96:111], v[148:151], v[152:155], v[96:111]
    v_mfma_f32_32x32x16_bf16 v[112:127], v[148:151], v[156:159], v[112:127]
    ds_read_b128 v[144:147], v27 offset:0
    ds_read_b128 v[148:151], v27 offset:4096
    ds_read_b128 v[152:155], v31 offset:16384
    ds_read_b128 v[156:159], v31 offset:20480
    s_waitcnt lgkmcnt(4)
    v_mfma_f32_32x32x16_bf16 v[64:79], v[128:131], v[136:139], v[64:79]
    v_mfma_f32_32x32x16_bf16 v[80:95], v[128:131], v[140:143], v[80:95]
    v_mfma_f32_32x32x16_bf16 v[96:111], v[132:135], v[136:139], v[96:111]
    v_mfma_f32_32x32x16_bf16 v[112:127], v[132:135], v[140:143], v[112:127]
    s_waitcnt vmcnt(0) lgkmcnt(0)
    s_barrier
    ds_read_b128 v[128:131], v16 offset:0
    ds_read_b128 v[132:135], v16 offset:4096
    ds_read_b128 v[136:139], v20 offset:16384
    ds_read_b128 v[140:143], v20 offset:20480
    v_mfma_f32_32x32x16_bf16 v[64:79], v[144:147], v[152:155], v[64:79]
    v_mfma_f32_32x32x16_bf16 v[80:95], v[144:147], v[156:159], v[80:95]
    v_mfma_f32_32x32x16_bf16 v[96:111], v[148:151], v[152:155], v[96:111]
    v_mfma_f32_32x32x16_bf16 v[112:127], v[148:151], v[156:159], v[112:127]
    ds_read_b128 v[144:147], v17 offset:0
    ds_read_b128 v[148:151], v17 offset:4096
    ds_read_b128 v[152:155], v21 offset:16384
    ds_read_b128 v[156:159], v21 offset:20480
    s_waitcnt lgkmcnt(4)
    v_mfma_f32_32x32x16_bf16 v[64:79], v[128:131], v[136:139], v[64:79]
    v_mfma_f32_32x32x16_bf16 v[80:95], v[128:131], v[140:143], v[80:95]
    v_mfma_f32_32x32x16_bf16 v[96:111], v[132:135], v[136:139], v[96:111]
    v_mfma_f32_32x32x16_bf16 v[112:127], v[132:135], v[140:143], v[112:127]
    ds_read_b128 v[128:131], v18 offset:0
    ds_read_b128 v[132:135], v18 offset:4096
    ds_read_b128 v[136:139], v22 offset:16384
    ds_read_b128 v[140:143], v22 offset:20480
    s_waitcnt lgkmcnt(4)
    v_mfma_f32_32x32x16_bf16 v[64:79], v[144:147], v[152:155], v[64:79]
    v_mfma_f32_32x32x16_bf16 v[80:95], v[144:147], v[156:159], v[80:95]
    v_mfma_f32_32x32x16_bf16 v[96:111], v[148:151], v[152:155], v[96:111]
    v_mfma_f32_32x32x16_bf16 v[112:127], v[148:151], v[156:159], v[112:127]
    ds_read_b128 v[144:147], v19 offset:0
    ds_read_b128 v[148:151], v19 offset:4096
    ds_read_b128 v[152:155], v23 offset:16384
    ds_read_b128 v[156:159], v23 offset:20480
    s_waitcnt lgkmcnt(4)
    v_mfma_f32_32x32x16_bf16 v[64:79], v[128:131], v[136:139], v[64:79]
    v_mfma_f32_32x32x16_bf16 v[80:95], v[128:131], v[140:143], v[80:95]
    v_mfma_f32_32x32x16_bf16 v[96:111], v[132:135], v[136:139], v[96:111]
    v_mfma_f32_32x32x16_bf16 v[112:127], v[132:135], v[140:143], v[112:127]
    s_waitcnt lgkmcnt(0)
    v_mfma_f32_32x32x16_bf16 v[64:79], v[144:147], v[152:155], v[64:79]
    v_mfma_f32_32x32x16_bf16 v[80:95], v[144:147], v[156:159], v[80:95]
    v_mfma_f32_32x32x16_bf16 v[96:111], v[148:151], v[152:155], v[96:111]
    v_mfma_f32_32x32x16_bf16 v[112:127], v[148:151], v[156:159], v[112:127]
    v_and_b32 v128, 31, v46
    s_lshl_b32 s38, s20, 8
    s_add_u32 s38, s38, 32768
    v_lshl_add_u32 v130, v128, 3, s38
    s_lshl_b32 s39, s19, 11
    v_lshl_add_u32 v129, v47, 10, v130
    v_add_u32 v129, s39, v129
    v_lshl_add_u32 v131, v47, 10, v56
    v_add_u32 v131, 1024, v131
    v_sub_u32 v132, s16, v47
    s_mul_i32 s38, s18, 9216
    s_add_u32 s38, s38, 36864
    v_mul_u32_u24 v133, 144, v128
    v_lshl_add_u32 v133, v47, 6, v133
    v_add_u32 v133, s38, v133
    v_bfe_u32 v134, v46, 2, 2
    v_lshl_add_u32 v134, v47, 3, v134
    v_mul_u32_u24 v134, 144, v134
    v_bfe_u32 v136, v46, 4, 1
    v_lshl_add_u32 v134, v136, 5, v134
    v_and_b32 v136, 3, v46
    v_lshl_add_u32 v134, v136, 3, v134
    v_add_u32 v134, s38, v134
    v_lshlrev_b32 v135, 4, v46
    v_pk_fma_f32 v[52:53], v[32:33], v[80:81], v[66:67] op_sel:[1,0,0] op_sel_hi:[1,1,1] neg_lo:[1,0,0] neg_hi:[1,0,0]
    v_pk_fma_f32 v[54:55], v[32:33], v[64:65], v[82:83] op_sel:[1,0,0] op_sel_hi:[1,1,1]
    v_pk_fma_f32 v[48:49], v[32:33], v[64:65], v[52:53] op_sel:[0,0,0] op_sel_hi:[0,1,1]
    v_pk_fma_f32 v[50:51], v[32:33], v[80:81], v[54:55] op_sel:[0,0,0] op_sel_hi:[0,1,1]
    v_pk_fma_f32 v[52:53], v[32:33], v[50:51], v[68:69] op_sel:[1,0,0] op_sel_hi:[1,1,1] neg_lo:[1,0,0] neg_hi:[1,0,0]
    v_pk_fma_f32 v[54:55], v[32:33], v[48:49], v[84:85] op_sel:[1,0,0] op_sel_hi:[1,1,1]
    v_pk_fma_f32 v[48:49], v[32:33], v[48:49], v[52:53] op_sel:[0,0,0] op_sel_hi:[0,1,1]
    v_pk_fma_f32 v[50:51], v[32:33], v[50:51], v[54:55] op_sel:[0,0,0] op_sel_hi:[0,1,1]
    v_pk_fma_f32 v[52:53], v[32:33], v[50:51], v[70:71] op_sel:[1,0,0] op_sel_hi:[1,1,1] neg_lo:[1,0,0] neg_hi:[1,0,0]
    v_pk_fma_f32 v[54:55], v[32:33], v[48:49], v[86:87] op_sel:[1,0,0] op_sel_hi:[1,1,1]
    v_pk_fma_f32 v[48:49], v[32:33], v[48:49], v[52:53] op_sel:[0,0,0] op_sel_hi:[0,1,1]
    v_pk_fma_f32 v[50:51], v[32:33], v[50:51], v[54:55] op_sel:[0,0,0] op_sel_hi:[0,1,1]
    v_pk_fma_f32 v[52:53], v[32:33], v[50:51], v[72:73] op_sel:[1,0,0] op_sel_hi:[1,1,1] neg_lo:[1,0,0] neg_hi:[1,0,0]
    v_pk_fma_f32 v[54:55], v[32:33], v[48:49], v[88:89] op_sel:[1,0,0] op_sel_hi:[1,1,1]
    v_pk_fma_f32 v[48:49], v[32:33], v[48:49], v[52:53] op_sel:[0,0,0] op_sel_hi:[0,1,1]
    v_pk_fma_f32 v[50:51], v[32:33], v[50:51], v[54:55] op_sel:[0,0,0] op_sel_hi:[0,1,1]
    v_pk_fma_f32 v[52:53], v[32:33], v[50:51], v[74:75] op_sel:[1,0,0] op_sel_hi:[1,1,1] neg_lo:[1,0,0] neg_hi:[1,0,0]
    v_pk_fma_f32 v[54:55], v[32:33], v[48:49], v[90:91] op_sel:[1,0,0] op_sel_hi:[1,1,1]
    v_pk_fma_f32 v[48:49], v[32:33], v[48:49], v[52:53] op_sel:[0,0,0] op_sel_hi:[0,1,1]
    v_pk_fma_f32 v[50:51], v[32:33], v[50:51], v[54:55] op_sel:[0,0,0] op_sel_hi:[0,1,1]
    v_pk_fma_f32 v[52:53], v[32:33], v[50:51], v[76:77] op_sel:[1,0,0] op_sel_hi:[1,1,1] neg_lo:[1,0,0] neg_hi:[1,0,0]
    v_pk_fma_f32 v[54:55], v[32:33], v[48:49], v[92:93] op_sel:[1,0,0] op_sel_hi:[1,1,1]
    v_pk_fma_f32 v[48:49], v[32:33], v[48:49], v[52:53] op_sel:[0,0,0] op_sel_hi:[0,1,1]
    v_pk_fma_f32 v[50:51], v[32:33], v[50:51], v[54:55] op_sel:[0,0,0] op_sel_hi:[0,1,1]
    v_pk_fma_f32 v[52:53], v[32:33], v[50:51], v[78:79] op_sel:[1,0,0] op_sel_hi:[1,1,1] neg_lo:[1,0,0] neg_hi:[1,0,0]
    v_pk_fma_f32 v[54:55], v[32:33], v[48:49], v[94:95] op_sel:[1,0,0] op_sel_hi:[1,1,1]
    v_pk_fma_f32 v[48:49], v[32:33], v[48:49], v[52:53] op_sel:[0,0,0] op_sel_hi:[0,1,1]
    v_pk_fma_f32 v[50:51], v[32:33], v[50:51], v[54:55] op_sel:[0,0,0] op_sel_hi:[0,1,1]
    v_pk_fma_f32 v[52:53], v[32:33], v[50:51], v[96:97] op_sel:[1,0,0] op_sel_hi:[1,1,1] neg_lo:[1,0,0] neg_hi:[1,0,0]
    v_pk_fma_f32 v[54:55], v[32:33], v[48:49], v[112:113] op_sel:[1,0,0] op_sel_hi:[1,1,1]
    v_pk_fma_f32 v[48:49], v[32:33], v[48:49], v[52:53] op_sel:[0,0,0] op_sel_hi:[0,1,1]
    v_pk_fma_f32 v[50:51], v[32:33], v[50:51], v[54:55] op_sel:[0,0,0] op_sel_hi:[0,1,1]
    v_pk_fma_f32 v[52:53], v[32:33], v[50:51], v[98:99] op_sel:[1,0,0] op_sel_hi:[1,1,1] neg_lo:[1,0,0] neg_hi:[1,0,0]
    v_pk_fma_f32 v[54:55], v[32:33], v[48:49], v[114:115] op_sel:[1,0,0] op_sel_hi:[1,1,1]
    v_pk_fma_f32 v[48:49], v[32:33], v[48:49], v[52:53] op_sel:[0,0,0] op_sel_hi:[0,1,1]
    v_pk_fma_f32 v[50:51], v[32:33], v[50:51], v[54:55] op_sel:[0,0,0] op_sel_hi:[0,1,1]
    v_pk_fma_f32 v[52:53], v[32:33], v[50:51], v[100:101] op_sel:[1,0,0] op_sel_hi:[1,1,1] neg_lo:[1,0,0] neg_hi:[1,0,0]
    v_pk_fma_f32 v[54:55], v[32:33], v[48:49], v[116:117] op_sel:[1,0,0] op_sel_hi:[1,1,1]
    v_pk_fma_f32 v[48:49], v[32:33], v[48:49], v[52:53] op_sel:[0,0,0] op_sel_hi:[0,1,1]
    v_pk_fma_f32 v[50:51], v[32:33], v[50:51], v[54:55] op_sel:[0,0,0] op_sel_hi:[0,1,1]
    v_pk_fma_f32 v[52:53], v[32:33], v[50:51], v[102:103] op_sel:[1,0,0] op_sel_hi:[1,1,1] neg_lo:[1,0,0] neg_hi:[1,0,0]
    v_pk_fma_f32 v[54:55], v[32:33], v[48:49], v[118:119] op_sel:[1,0,0] op_sel_hi:[1,1,1]
    v_pk_fma_f32 v[48:49], v[32:33], v[48:49], v[52:53] op_sel:[0,0,0] op_sel_hi:[0,1,1]
    v_pk_fma_f32 v[50:51], v[32:33], v[50:51], v[54:55] op_sel:[0,0,0] op_sel_hi:[0,1,1]
    v_pk_fma_f32 v[52:53], v[32:33], v[50:51], v[104:105] op_sel:[1,0,0] op_sel_hi:[1,1,1] neg_lo:[1,0,0] neg_hi:[1,0,0]
    v_pk_fma_f32 v[54:55], v[32:33], v[48:49], v[120:121] op_sel:[1,0,0] op_sel_hi:[1,1,1]
    v_pk_fma_f32 v[48:49], v[32:33], v[48:49], v[52:53] op_sel:[0,0,0] op_sel_hi:[0,1,1]
    v_pk_fma_f32 v[50:51], v[32:33], v[50:51], v[54:55] op_sel:[0,0,0] op_sel_hi:[0,1,1]
    v_pk_fma_f32 v[52:53], v[32:33], v[50:51], v[106:107] op_sel:[1,0,0] op_sel_hi:[1,1,1] neg_lo:[1,0,0] neg_hi:[1,0,0]
    v_pk_fma_f32 v[54:55], v[32:33], v[48:49], v[122:123] op_sel:[1,0,0] op_sel_hi:[1,1,1]
    v_pk_fma_f32 v[48:49], v[32:33], v[48:49], v[52:53] op_sel:[0,0,0] op_sel_hi:[0,1,1]
    v_pk_fma_f32 v[50:51], v[32:33], v[50:51], v[54:55] op_sel:[0,0,0] op_sel_hi:[0,1,1]
    v_pk_fma_f32 v[52:53], v[32:33], v[50:51], v[108:109] op_sel:[1,0,0] op_sel_hi:[1,1,1] neg_lo:[1,0,0] neg_hi:[1,0,0]
    v_pk_fma_f32 v[54:55], v[32:33], v[48:49], v[124:125] op_sel:[1,0,0] op_sel_hi:[1,1,1]
    v_pk_fma_f32 v[48:49], v[32:33], v[48:49], v[52:53] op_sel:[0,0,0] op_sel_hi:[0,1,1]
    v_pk_fma_f32 v[50:51], v[32:33], v[50:51], v[54:55] op_sel:[0,0,0] op_sel_hi:[0,1,1]
    v_pk_fma_f32 v[52:53], v[32:33], v[50:51], v[110:111] op_sel:[1,0,0] op_sel_hi:[1,1,1] neg_lo:[1,0,0] neg_hi:[1,0,0]
    v_pk_fma_f32 v[54:55], v[32:33], v[48:49], v[126:127] op_sel:[1,0,0] op_sel_hi:[1,1,1]
    v_pk_fma_f32 v[48:49], v[32:33], v[48:49], v[52:53] op_sel:[0,0,0] op_sel_hi:[0,1,1]
    v_pk_fma_f32 v[50:51], v[32:33], v[50:51], v[54:55] op_sel:[0,0,0] op_sel_hi:[0,1,1]
    ds_write_b64 v129, v[48:49]
    ds_write_b64 v129, v[50:51] offset:512
    s_waitcnt lgkmcnt(0)
    s_barrier
    ds_read_b64 v[208:209], v130 offset:0
    ds_read_b64 v[210:211], v130 offset:512
    ds_read_b64 v[212:213], v130 offset:1024
    ds_read_b64 v[214:215], v130 offset:1536
    ds_read_b64 v[216:217], v130 offset:2048
    ds_read_b64 v[218:219], v130 offset:2560
    ds_read_b64 v[220:221], v130 offset:3072
    ds_read_b64 v[222:223], v130 offset:3584
    s_waitcnt lgkmcnt(0)
    v_fma_f32 v228, -v37, v210, v209
    v_fma_f32 v229, v37, v208, v211
    v_fma_f32 v228, v36, v208, v228
    v_fma_f32 v229, v36, v210, v229
    v_fma_f32 v230, -v37, v229, v212
    v_fma_f32 v231, v37, v228, v214
    v_fma_f32 v230, v36, v228, v230
    v_fma_f32 v231, v36, v229, v231
    v_fma_f32 v232, -v37, v231, v213
    v_fma_f32 v233, v37, v230, v215
    v_fma_f32 v232, v36, v230, v232
    v_fma_f32 v233, v36, v231, v233
    v_fma_f32 v234, -v37, v233, v216
    v_fma_f32 v235, v37, v232, v218
    v_fma_f32 v234, v36, v232, v234
    v_fma_f32 v235, v36, v233, v235
    v_fma_f32 v236, -v37, v235, v217
    v_fma_f32 v237, v37, v234, v219
    v_fma_f32 v236, v36, v234, v236
    v_fma_f32 v237, v36, v235, v237
    v_fma_f32 v238, -v37, v237, v220
    v_fma_f32 v239, v37, v236, v222
    v_fma_f32 v238, v36, v236, v238
    v_fma_f32 v239, v36, v237, v239
    v_fma_f32 v240, -v37, v239, v221
    v_fma_f32 v241, v37, v238, v223
    v_fma_f32 v240, v36, v238, v240
    v_fma_f32 v241, v36, v239, v241
    v_mov_b32 v140, v240
    v_mov_b32 v141, s93
    v_mov_b32 v142, v241
    v_mov_b32 v143, s93
    s_cmp_lg_u32 s19, 0
    s_cbranch_scc1 L_k1_nopub
    s_mov_b32 exec_hi, 0
    buffer_store_dwordx4 v[140:143], v56, s[24:27], 0 offen sc1
    s_mov_b32 exec_hi, -1
L_k1_nopub:
    s_mov_b32 s46, 0
    s_mov_b32 s47, 4096
    s_mov_b32 s48, 8192
    s_mov_b32 s49, 12288
    buffer_load_dwordx4 v[0:3], v131, s[24:27], s46 offen offset:0 sc1
    buffer_load_dwordx4 v[4:7], v131, s[24:27], s46 offen offset:2048 sc1
    buffer_load_dwordx4 v[8:11], v131, s[24:27], s47 offen offset:0 sc1
    buffer_load_dwordx4 v[12:15], v131, s[24:27], s47 offen offset:2048 sc1
    buffer_load_dwordx4 v[16:19], v131, s[24:27], s48 offen offset:0 sc1
    buffer_load_dwordx4 v[20:23], v131, s[24:27], s48 offen offset:2048 sc1
    buffer_load_dwordx4 v[24:27], v131, s[24:27], s49 offen offset:0 sc1
    buffer_load_dwordx4 v[28:31], v131, s[24:27], s49 offen offset:2048 sc1
    v_cmp_lt_i32 vcc, 0, v132
    s_nop 1
    v_cndmask_b32 v144, 0, v141, vcc
    v_cmp_lt_i32 vcc, 2, v132
    s_nop 1
    v_cndmask_b32 v145, 0, v141, vcc
    v_cmp_lt_i32 vcc, 4, v132
    s_nop 1
    v_cndmask_b32 v146, 0, v141, vcc
    v_cmp_lt_i32 vcc, 6, v132
    s_nop 1
    v_cndmask_b32 v147, 0, v141, vcc
    v_cmp_lt_i32 vcc, 8, v132
    s_nop 1
    v_cndmask_b32 v148, 0, v141, vcc
    v_cmp_lt_i32 vcc, 10, v132
    s_nop 1
    v_cndmask_b32 v149, 0, v141, vcc
    v_cmp_lt_i32 vcc, 12, v132
    s_nop 1
    v_cndmask_b32 v150, 0, v141, vcc
    v_cmp_lt_i32 vcc, 14, v132
    s_nop 1
    v_cndmask_b32 v151, 0, v141, vcc
    v_cmp_eq_u32 vcc, 1, v47
    s_cmp_eq_u32 s19, 1
    s_cselect_b64 s[38:39], -1, 0
    v_cndmask_b32 v48, 0, v228, vcc
    v_cndmask_b32 v136, v232, v236, vcc
    v_cndmask_b32 v48, v48, v136, s[38:39]
    v_cndmask_b32 v50, 0, v229, vcc
    v_cndmask_b32 v136, v233, v237, vcc
    v_cndmask_b32 v50, v50, v136, s[38:39]
    v_cndmask_b32 v49, v208, v230, vcc
    v_cndmask_b32 v136, v234, v238, vcc
    v_cndmask_b32 v49, v49, v136, s[38:39]
    v_cndmask_b32 v51, v210, v231, vcc
    v_cndmask_b32 v136, v235, v239, vcc
    v_cndmask_b32 v51, v51, v136, s[38:39]
    v_pk_mul_f32 v[160:161], v[34:35], v[80:81] op_sel:[0,0] op_sel_hi:[0,1]
    v_pk_fma_f32 v[160:161], v[34:35], v[64:65], v[160:161] op_sel:[1,0,0] op_sel_hi:[1,1,1]
    v_pk_mul_f32 v[64:65], v[34:35], v[64:65] op_sel:[0,0] op_sel_hi:[0,1]
    v_pk_fma_f32 v[64:65], v[34:35], v[80:81], v[64:65] op_sel:[1,0,0] op_sel_hi:[1,1,1] neg_lo:[1,0,0] neg_hi:[1,0,0]
    v_pk_mul_f32 v[162:163], v[34:35], v[82:83] op_sel:[0,0] op_sel_hi:[0,1]
    v_pk_fma_f32 v[162:163], v[34:35], v[66:67], v[162:163] op_sel:[1,0,0] op_sel_hi:[1,1,1]
    v_pk_mul_f32 v[66:67], v[34:35], v[66:67] op_sel:[0,0] op_sel_hi:[0,1]
    v_pk_fma_f32 v[66:67], v[34:35], v[82:83], v[66:67] op_sel:[1,0,0] op_sel_hi:[1,1,1] neg_lo:[1,0,0] neg_hi:[1,0,0]
    v_pk_mul_f32 v[164:165], v[34:35], v[84:85] op_sel:[0,0] op_sel_hi:[0,1]
    v_pk_fma_f32 v[164:165], v[34:35], v[68:69], v[164:165] op_sel:[1,0,0] op_sel_hi:[1,1,1]
    v_pk_mul_f32 v[68:69], v[34:35], v[68:69] op_sel:[0,0] op_sel_hi:[0,1]
    v_pk_fma_f32 v[68:69], v[34:35], v[84:85], v[68:69] op_sel:[1,0,0] op_sel_hi:[1,1,1] neg_lo:[1,0,0] neg_hi:[1,0,0]
    v_pk_mul_f32 v[166:167], v[34:35], v[86:87] op_sel:[0,0] op_sel_hi:[0,1]
    v_pk_fma_f32 v[166:167], v[34:35], v[70:71], v[166:167] op_sel:[1,0,0] op_sel_hi:[1,1,1]
    v_pk_mul_f32 v[70:71], v[34:35], v[70:71] op_sel:[0,0] op_sel_hi:[0,1]
    v_pk_fma_f32 v[70:71], v[34:35], v[86:87], v[70:71] op_sel:[1,0,0] op_sel_hi:[1,1,1] neg_lo:[1,0,0] neg_hi:[1,0,0]
    v_pk_mul_f32 v[168:169], v[34:35], v[88:89] op_sel:[0,0] op_sel_hi:[0,1]
    v_pk_fma_f32 v[168:169], v[34:35], v[72:73], v[168:169] op_sel:[1,0,0] op_sel_hi:[1,1,1]
    v_pk_mul_f32 v[72:73], v[34:35], v[72:73] op_sel:[0,0] op_sel_hi:[0,1]
    v_pk_fma_f32 v[72:73], v[34:35], v[88:89], v[72:73] op_sel:[1,0,0] op_sel_hi:[1,1,1] neg_lo:[1,0,0] neg_hi:[1,0,0]
    v_pk_mul_f32 v[170:171], v[34:35], v[90:91] op_sel:[0,0] op_sel_hi:[0,1]
    v_pk_fma_f32 v[170:171], v[34:35], v[74:75], v[170:171] op_sel:[1,0,0] op_sel_hi:[1,1,1]
    v_pk_mul_f32 v[74:75], v[34:35], v[74:75] op_sel:[0,0] op_sel_hi:[0,1]
    v_pk_fma_f32 v[74:75], v[34:35], v[90:91], v[74:75] op_sel:[1,0,0] op_sel_hi:[1,1,1] neg_lo:[1,0,0] neg_hi:[1,0,0]
    v_pk_mul_f32 v[172:173], v[34:35], v[92:93] op_sel:[0,0] op_sel_hi:[0,1]
    v_pk_fma_f32 v[172:173], v[34:35], v[76:77], v[172:173] op_sel:[1,0,0] op_sel_hi:[1,1,1]
    v_pk_mul_f32 v[76:77], v[34:35], v[76:77] op_sel:[0,0] op_sel_hi:[0,1]
    v_pk_fma_f32 v[76:77], v[34:35], v[92:93], v[76:77] op_sel:[1,0,0] op_sel_hi:[1,1,1] neg_lo:[1,0,0] neg_hi:[1,0,0]
    v_pk_mul_f32 v[174:175], v[34:35], v[94:95] op_sel:[0,0] op_sel_hi:[0,1]
    v_pk_fma_f32 v[174:175], v[34:35], v[78:79], v[174:175] op_sel:[1,0,0] op_sel_hi:[1,1,1]
    v_pk_mul_f32 v[78:79], v[34:35], v[78:79] op_sel:[0,0] op_sel_hi:[0,1]
    v_pk_fma_f32 v[78:79], v[34:35], v[94:95], v[78:79] op_sel:[1,0,0] op_sel_hi:[1,1,1] neg_lo:[1,0,0] neg_hi:[1,0,0]
    v_pk_mul_f32 v[176:177], v[34:35], v[112:113] op_sel:[0,0] op_sel_hi:[0,1]
    v_pk_fma_f32 v[176:177], v[34:35], v[96:97], v[176:177] op_sel:[1,0,0] op_sel_hi:[1,1,1]
    v_pk_mul_f32 v[96:97], v[34:35], v[96:97] op_sel:[0,0] op_sel_hi:[0,1]
    v_pk_fma_f32 v[96:97], v[34:35], v[112:113], v[96:97] op_sel:[1,0,0] op_sel_hi:[1,1,1] neg_lo:[1,0,0] neg_hi:[1,0,0]
    v_pk_mul_f32 v[178:179], v[34:35], v[114:115] op_sel:[0,0] op_sel_hi:[0,1]
    v_pk_fma_f32 v[178:179], v[34:35], v[98:99], v[178:179] op_sel:[1,0,0] op_sel_hi:[1,1,1]
    v_pk_mul_f32 v[98:99], v[34:35], v[98:99] op_sel:[0,0] op_sel_hi:[0,1]
    v_pk_fma_f32 v[98:99], v[34:35], v[114:115], v[98:99] op_sel:[1,0,0] op_sel_hi:[1,1,1] neg_lo:[1,0,0] neg_hi:[1,0,0]
    v_pk_mul_f32 v[180:181], v[34:35], v[116:117] op_sel:[0,0] op_sel_hi:[0,1]
    v_pk_fma_f32 v[180:181], v[34:35], v[100:101], v[180:181] op_sel:[1,0,0] op_sel_hi:[1,1,1]
    v_pk_mul_f32 v[100:101], v[34:35], v[100:101] op_sel:[0,0] op_sel_hi:[0,1]
    v_pk_fma_f32 v[100:101], v[34:35], v[116:117], v[100:101] op_sel:[1,0,0] op_sel_hi:[1,1,1] neg_lo:[1,0,0] neg_hi:[1,0,0]
    v_pk_mul_f32 v[182:183], v[34:35], v[118:119] op_sel:[0,0] op_sel_hi:[0,1]
    v_pk_fma_f32 v[182:183], v[34:35], v[102:103], v[182:183] op_sel:[1,0,0] op_sel_hi:[1,1,1]
    v_pk_mul_f32 v[102:103], v[34:35], v[102:103] op_sel:[0,0] op_sel_hi:[0,1]
    v_pk_fma_f32 v[102:103], v[34:35], v[118:119], v[102:103] op_sel:[1,0,0] op_sel_hi:[1,1,1] neg_lo:[1,0,0] neg_hi:[1,0,0]
    v_pk_mul_f32 v[184:185], v[34:35], v[120:121] op_sel:[0,0] op_sel_hi:[0,1]
    v_pk_fma_f32 v[184:185], v[34:35], v[104:105], v[184:185] op_sel:[1,0,0] op_sel_hi:[1,1,1]
    v_pk_mul_f32 v[104:105], v[34:35], v[104:105] op_sel:[0,0] op_sel_hi:[0,1]
    v_pk_fma_f32 v[104:105], v[34:35], v[120:121], v[104:105] op_sel:[1,0,0] op_sel_hi:[1,1,1] neg_lo:[1,0,0] neg_hi:[1,0,0]
    v_pk_mul_f32 v[186:187], v[34:35], v[122:123] op_sel:[0,0] op_sel_hi:[0,1]
    v_pk_fma_f32 v[186:187], v[34:35], v[106:107], v[186:187] op_sel:[1,0,0] op_sel_hi:[1,1,1]
    v_pk_mul_f32 v[106:107], v[34:35], v[106:107] op_sel:[0,0] op_sel_hi:[0,1]
    v_pk_fma_f32 v[106:107], v[34:35], v[122:123], v[106:107] op_sel:[1,0,0] op_sel_hi:[1,1,1] neg_lo:[1,0,0] neg_hi:[1,0,0]
    v_pk_mul_f32 v[188:189], v[34:35], v[124:125] op_sel:[0,0] op_sel_hi:[0,1]
    v_pk_fma_f32 v[188:189], v[34:35], v[108:109], v[188:189] op_sel:[1,0,0] op_sel_hi:[1,1,1]
    v_pk_mul_f32 v[108:109], v[34:35], v[108:109] op_sel:[0,0] op_sel_hi:[0,1]
    v_pk_fma_f32 v[108:109], v[34:35], v[124:125], v[108:109] op_sel:[1,0,0] op_sel_hi:[1,1,1] neg_lo:[1,0,0] neg_hi:[1,0,0]
    v_pk_mul_f32 v[190:191], v[34:35], v[126:127] op_sel:[0,0] op_sel_hi:[0,1]
    v_pk_fma_f32 v[190:191], v[34:35], v[110:111], v[190:191] op_sel:[1,0,0] op_sel_hi:[1,1,1]
    v_pk_mul_f32 v[110:111], v[34:35], v[110:111] op_sel:[0,0] op_sel_hi:[0,1]
    v_pk_fma_f32 v[110:111], v[34:35], v[126:127], v[110:111] op_sel:[1,0,0] op_sel_hi:[1,1,1] neg_lo:[1,0,0] neg_hi:[1,0,0]
L_k1_poll:
    s_waitcnt vmcnt(0)
    v_xor_b32 v1, v1, v144
    v_xor_b32 v3, v3, v144
    v_xor_b32 v5, v5, v145
    v_xor_b32 v7, v7, v145
    v_xor_b32 v9, v9, v146
    v_xor_b32 v11, v11, v146
    v_xor_b32 v13, v13, v147
    v_xor_b32 v15, v15, v147
    v_xor_b32 v17, v17, v148
    v_xor_b32 v19, v19, v148
    v_xor_b32 v21, v21, v149
    v_xor_b32 v23, v23, v149
    v_xor_b32 v25, v25, v150
    v_xor_b32 v27, v27, v150
    v_xor_b32 v29, v29, v151
    v_xor_b32 v31, v31, v151
    v_or3_b32 v136, v1, v3, v5
    v_or3_b32 v136, v136, v7, v9
    v_or3_b32 v136, v136, v11, v13
    v_or3_b32 v136, v136, v15, v17
    v_or3_b32 v136, v136, v19, v21
    v_or3_b32 v136, v136, v23, v25
    v_or3_b32 v136, v136, v27, v29
    v_or_b32 v136, v136, v31
    v_cmp_ne_u32 vcc, 0, v136
    s_nop 1
    s_cmp_eq_u64 vcc, 0
    s_cbranch_scc1 L_k1_got
    s_sleep 3
    buffer_load_dwordx4 v[0:3], v131, s[24:27], s46 offen offset:0 sc1
    buffer_load_dwordx4 v[4:7], v131, s[24:27], s46 offen offset:2048 sc1
    buffer_load_dwordx4 v[8:11], v131, s[24:27], s47 offen offset:0 sc1
    buffer_load_dwordx4 v[12:15], v131, s[24:27], s47 offen offset:2048 sc1
    buffer_load_dwordx4 v[16:19], v131, s[24:27], s48 offen offset:0 sc1
    buffer_load_dwordx4 v[20:23], v131, s[24:27], s48 offen offset:2048 sc1
    buffer_load_dwordx4 v[24:27], v131, s[24:27], s49 offen offset:0 sc1
    buffer_load_dwordx4 v[28:31], v131, s[24:27], s49 offen offset:2048 sc1
    s_branch L_k1_poll
L_k1_got:
    v_fma_f32 v24, -v41, v30, v24
    v_fma_f32 v26, v41, v28, v26
    v_fma_f32 v24, v40, v28, v24
    v_fma_f32 v26, v40, v30, v26
    v_fma_f32 v20, -v41, v26, v20
    v_fma_f32 v22, v41, v24, v22
    v_fma_f32 v20, v40, v24, v20
    v_fma_f32 v22, v40, v26, v22
    v_fma_f32 v16, -v41, v22, v16
    v_fma_f32 v18, v41, v20, v18
    v_fma_f32 v16, v40, v20, v16
    v_fma_f32 v18, v40, v22, v18
    v_fma_f32 v12, -v41, v18, v12
    v_fma_f32 v14, v41, v16, v14
    v_fma_f32 v12, v40, v16, v12
    v_fma_f32 v14, v40, v18, v14
    v_fma_f32 v8, -v41, v14, v8
    v_fma_f32 v10, v41, v12, v10
    v_fma_f32 v8, v40, v12, v8
    v_fma_f32 v10, v40, v14, v10
    v_fma_f32 v4, -v41, v10, v4
    v_fma_f32 v6, v41, v8, v6
    v_fma_f32 v4, v40, v8, v4
    v_fma_f32 v6, v40, v10, v6
    v_fma_f32 v0, -v41, v6, v0
    v_fma_f32 v2, v41, v4, v2
    v_fma_f32 v192, v40, v4, v0
    v_fma_f32 v193, v40, v6, v2
    v_mov_b32 v194, v192
    v_mov_b32 v195, v193
    s_nop 1
    v_permlane32_swap_b32 v192, v194
    v_permlane32_swap_b32 v193, v195
    s_nop 0
    v_fma_f32 v192, -v39, v195, v192
    v_fma_f32 v193, v39, v194, v193
    v_fma_f32 v192, v38, v194, v192
    v_fma_f32 v193, v38, v195, v193
    v_pk_fma_f32 v[48:49], v[192:193], v[42:43], v[48:49] op_sel:[0,0,0] op_sel_hi:[0,1,1]
    v_pk_fma_f32 v[50:51], v[192:193], v[44:45], v[50:51] op_sel:[0,0,0] op_sel_hi:[0,1,1]
    v_pk_fma_f32 v[48:49], v[192:193], v[44:45], v[48:49] op_sel:[1,0,0] op_sel_hi:[1,1,1] neg_lo:[1,0,0] neg_hi:[1,0,0]
    v_pk_fma_f32 v[50:51], v[192:193], v[42:43], v[50:51] op_sel:[1,0,0] op_sel_hi:[1,1,1]
    v_pk_mul_f32 v[52:53], v[34:35], v[48:49] op_sel:[0,0] op_sel_hi:[0,1]
    v_pk_mul_f32 v[54:55], v[34:35], v[50:51] op_sel:[0,0] op_sel_hi:[0,1]
    v_pk_fma_f32 v[52:53], v[34:35], v[50:51], v[52:53] op_sel:[1,0,0] op_sel_hi:[1,1,1] neg_lo:[1,0,0] neg_hi:[1,0,0]
    v_pk_fma_f32 v[54:55], v[34:35], v[48:49], v[54:55] op_sel:[1,0,0] op_sel_hi:[1,1,1]
    v_pk_fma_f32 v[64:65], v[32:33], v[54:55], v[64:65] op_sel:[1,0,0] op_sel_hi:[1,1,1] neg_lo:[1,0,0] neg_hi:[1,0,0]
    v_pk_fma_f32 v[160:161], v[32:33], v[52:53], v[160:161] op_sel:[1,0,0] op_sel_hi:[1,1,1]
    v_pk_fma_f32 v[64:65], v[32:33], v[52:53], v[64:65] op_sel:[0,0,0] op_sel_hi:[0,1,1]
    v_pk_fma_f32 v[160:161], v[32:33], v[54:55], v[160:161] op_sel:[0,0,0] op_sel_hi:[0,1,1]
    v_pk_fma_f32 v[66:67], v[32:33], v[160:161], v[66:67] op_sel:[1,0,0] op_sel_hi:[1,1,1] neg_lo:[1,0,0] neg_hi:[1,0,0]
    v_pk_fma_f32 v[162:163], v[32:33], v[64:65], v[162:163] op_sel:[1,0,0] op_sel_hi:[1,1,1]
    v_pk_fma_f32 v[66:67], v[32:33], v[64:65], v[66:67] op_sel:[0,0,0] op_sel_hi:[0,1,1]
    v_pk_fma_f32 v[162:163], v[32:33], v[160:161], v[162:163] op_sel:[0,0,0] op_sel_hi:[0,1,1]
    v_cvt_pk_bf16_f32 v192, v64, v66
    v_cvt_pk_bf16_f32 v208, -v160, -v162
    v_cvt_pk_bf16_f32 v200, v65, v67
    v_cvt_pk_bf16_f32 v216, -v161, -v163
    v_pk_fma_f32 v[68:69], v[32:33], v[162:163], v[68:69] op_sel:[1,0,0] op_sel_hi:[1,1,1] neg_lo:[1,0,0] neg_hi:[1,0,0]
    v_pk_fma_f32 v[164:165], v[32:33], v[66:67], v[164:165] op_sel:[1,0,0] op_sel_hi:[1,1,1]
    v_pk_fma_f32 v[68:69], v[32:33], v[66:67], v[68:69] op_sel:[0,0,0] op_sel_hi:[0,1,1]
    v_pk_fma_f32 v[164:165], v[32:33], v[162:163], v[164:165] op_sel:[0,0,0] op_sel_hi:[0,1,1]
    v_pk_fma_f32 v[70:71], v[32:33], v[164:165], v[70:71] op_sel:[1,0,0] op_sel_hi:[1,1,1] neg_lo:[1,0,0] neg_hi:[1,0,0]
    v_pk_fma_f32 v[166:167], v[32:33], v[68:69], v[166:167] op_sel:[1,0,0] op_sel_hi:[1,1,1]
    v_pk_fma_f32 v[70:71], v[32:33], v[68:69], v[70:71] op_sel:[0,0,0] op_sel_hi:[0,1,1]
    v_pk_fma_f32 v[166:167], v[32:33], v[164:165], v[166:167] op_sel:[0,0,0] op_sel_hi:[0,1,1]
    v_cvt_pk_bf16_f32 v193, v68, v70
    v_cvt_pk_bf16_f32 v209, -v164, -v166
    v_cvt_pk_bf16_f32 v201, v69, v71
    v_cvt_pk_bf16_f32 v217, -v165, -v167
    v_pk_fma_f32 v[72:73], v[32:33], v[166:167], v[72:73] op_sel:[1,0,0] op_sel_hi:[1,1,1] neg_lo:[1,0,0] neg_hi:[1,0,0]
    v_pk_fma_f32 v[168:169], v[32:33], v[70:71], v[168:169] op_sel:[1,0,0] op_sel_hi:[1,1,1]
    v_pk_fma_f32 v[72:73], v[32:33], v[70:71], v[72:73] op_sel:[0,0,0] op_sel_hi:[0,1,1]
    v_pk_fma_f32 v[168:169], v[32:33], v[166:167], v[168:169] op_sel:[0,0,0] op_sel_hi:[0,1,1]
    v_pk_fma_f32 v[74:75], v[32:33], v[168:169], v[74:75] op_sel:[1,0,0] op_sel_hi:[1,1,1] neg_lo:[1,0,0] neg_hi:[1,0,0]
    v_pk_fma_f32 v[170:171], v[32:33], v[72:73], v[170:171] op_sel:[1,0,0] op_sel_hi:[1,1,1]
    v_pk_fma_f32 v[74:75], v[32:33], v[72:73], v[74:75] op_sel:[0,0,0] op_sel_hi:[0,1,1]
    v_pk_fma_f32 v[170:171], v[32:33], v[168:169], v[170:171] op_sel:[0,0,0] op_sel_hi:[0,1,1]
    v_cvt_pk_bf16_f32 v194, v72, v74
    v_cvt_pk_bf16_f32 v210, -v168, -v170
    v_cvt_pk_bf16_f32 v202, v73, v75
    v_cvt_pk_bf16_f32 v218, -v169, -v171
    v_pk_fma_f32 v[76:77], v[32:33], v[170:171], v[76:77] op_sel:[1,0,0] op_sel_hi:[1,1,1] neg_lo:[1,0,0] neg_hi:[1,0,0]
    v_pk_fma_f32 v[172:173], v[32:33], v[74:75], v[172:173] op_sel:[1,0,0] op_sel_hi:[1,1,1]
    v_pk_fma_f32 v[76:77], v[32:33], v[74:75], v[76:77] op_sel:[0,0,0] op_sel_hi:[0,1,1]
    v_pk_fma_f32 v[172:173], v[32:33], v[170:171], v[172:173] op_sel:[0,0,0] op_sel_hi:[0,1,1]
    v_pk_fma_f32 v[78:79], v[32:33], v[172:173], v[78:79] op_sel:[1,0,0] op_sel_hi:[1,1,1] neg_lo:[1,0,0] neg_hi:[1,0,0]
    v_pk_fma_f32 v[174:175], v[32:33], v[76:77], v[174:175] op_sel:[1,0,0] op_sel_hi:[1,1,1]
    v_pk_fma_f32 v[78:79], v[32:33], v[76:77], v[78:79] op_sel:[0,0,0] op_sel_hi:[0,1,1]
    v_pk_fma_f32 v[174:175], v[32:33], v[172:173], v[174:175] op_sel:[0,0,0] op_sel_hi:[0,1,1]
    v_cvt_pk_bf16_f32 v195, v76, v78
    v_cvt_pk_bf16_f32 v211, -v172, -v174
    v_cvt_pk_bf16_f32 v203, v77, v79
    v_cvt_pk_bf16_f32 v219, -v173, -v175
    ds_write_b128 v133, v[192:195] offset:0
    ds_write_b128 v133, v[200:203] offset:32
    ds_write_b128 v133, v[208:211] offset:4608
    ds_write_b128 v133, v[216:219] offset:4640
    v_pk_fma_f32 v[96:97], v[32:33], v[174:175], v[96:97] op_sel:[1,0,0] op_sel_hi:[1,1,1] neg_lo:[1,0,0] neg_hi:[1,0,0]
    v_pk_fma_f32 v[176:177], v[32:33], v[78:79], v[176:177] op_sel:[1,0,0] op_sel_hi:[1,1,1]
    v_pk_fma_f32 v[96:97], v[32:33], v[78:79], v[96:97] op_sel:[0,0,0] op_sel_hi:[0,1,1]
    v_pk_fma_f32 v[176:177], v[32:33], v[174:175], v[176:177] op_sel:[0,0,0] op_sel_hi:[0,1,1]
    v_pk_fma_f32 v[98:99], v[32:33], v[176:177], v[98:99] op_sel:[1,0,0] op_sel_hi:[1,1,1] neg_lo:[1,0,0] neg_hi:[1,0,0]
    v_pk_fma_f32 v[178:179], v[32:33], v[96:97], v[178:179] op_sel:[1,0,0] op_sel_hi:[1,1,1]
    v_pk_fma_f32 v[98:99], v[32:33], v[96:97], v[98:99] op_sel:[0,0,0] op_sel_hi:[0,1,1]
    v_pk_fma_f32 v[178:179], v[32:33], v[176:177], v[178:179] op_sel:[0,0,0] op_sel_hi:[0,1,1]
    v_cvt_pk_bf16_f32 v196, v96, v98
    v_cvt_pk_bf16_f32 v212, -v176, -v178
    v_cvt_pk_bf16_f32 v204, v97, v99
    v_cvt_pk_bf16_f32 v220, -v177, -v179
    v_pk_fma_f32 v[100:101], v[32:33], v[178:179], v[100:101] op_sel:[1,0,0] op_sel_hi:[1,1,1] neg_lo:[1,0,0] neg_hi:[1,0,0]
    v_pk_fma_f32 v[180:181], v[32:33], v[98:99], v[180:181] op_sel:[1,0,0] op_sel_hi:[1,1,1]
    v_pk_fma_f32 v[100:101], v[32:33], v[98:99], v[100:101] op_sel:[0,0,0] op_sel_hi:[0,1,1]
    v_pk_fma_f32 v[180:181], v[32:33], v[178:179], v[180:181] op_sel:[0,0,0] op_sel_hi:[0,1,1]
    v_pk_fma_f32 v[102:103], v[32:33], v[180:181], v[102:103] op_sel:[1,0,0] op_sel_hi:[1,1,1] neg_lo:[1,0,0] neg_hi:[1,0,0]
    v_pk_fma_f32 v[182:183], v[32:33], v[100:101], v[182:183] op_sel:[1,0,0] op_sel_hi:[1,1,1]
    v_pk_fma_f32 v[102:103], v[32:33], v[100:101], v[102:103] op_sel:[0,0,0] op_sel_hi:[0,1,1]
    v_pk_fma_f32 v[182:183], v[32:33], v[180:181], v[182:183] op_sel:[0,0,0] op_sel_hi:[0,1,1]
    v_cvt_pk_bf16_f32 v197, v100, v102
    v_cvt_pk_bf16_f32 v213, -v180, -v182
    v_cvt_pk_bf16_f32 v205, v101, v103
    v_cvt_pk_bf16_f32 v221, -v181, -v183
    v_pk_fma_f32 v[104:105], v[32:33], v[182:183], v[104:105] op_sel:[1,0,0] op_sel_hi:[1,1,1] neg_lo:[1,0,0] neg_hi:[1,0,0]
    v_pk_fma_f32 v[184:185], v[32:33], v[102:103], v[184:185] op_sel:[1,0,0] op_sel_hi:[1,1,1]
    v_pk_fma_f32 v[104:105], v[32:33], v[102:103], v[104:105] op_sel:[0,0,0] op_sel_hi:[0,1,1]
    v_pk_fma_f32 v[184:185], v[32:33], v[182:183], v[184:185] op_sel:[0,0,0] op_sel_hi:[0,1,1]
    v_pk_fma_f32 v[106:107], v[32:33], v[184:185], v[106:107] op_sel:[1,0,0] op_sel_hi:[1,1,1] neg_lo:[1,0,0] neg_hi:[1,0,0]
    v_pk_fma_f32 v[186:187], v[32:33], v[104:105], v[186:187] op_sel:[1,0,0] op_sel_hi:[1,1,1]
    v_pk_fma_f32 v[106:107], v[32:33], v[104:105], v[106:107] op_sel:[0,0,0] op_sel_hi:[0,1,1]
    v_pk_fma_f32 v[186:187], v[32:33], v[184:185], v[186:187] op_sel:[0,0,0] op_sel_hi:[0,1,1]
    v_cvt_pk_bf16_f32 v198, v104, v106
    v_cvt_pk_bf16_f32 v214, -v184, -v186
    v_cvt_pk_bf16_f32 v206, v105, v107
    v_cvt_pk_bf16_f32 v222, -v185, -v187
    v_pk_fma_f32 v[108:109], v[32:33], v[186:187], v[108:109] op_sel:[1,0,0] op_sel_hi:[1,1,1] neg_lo:[1,0,0] neg_hi:[1,0,0]
    v_pk_fma_f32 v[188:189], v[32:33], v[106:107], v[188:189] op_sel:[1,0,0] op_sel_hi:[1,1,1]
    v_pk_fma_f32 v[108:109], v[32:33], v[106:107], v[108:109] op_sel:[0,0,0] op_sel_hi:[0,1,1]
    v_pk_fma_f32 v[188:189], v[32:33], v[186:187], v[188:189] op_sel:[0,0,0] op_sel_hi:[0,1,1]
    v_pk_fma_f32 v[110:111], v[32:33], v[188:189], v[110:111] op_sel:[1,0,0] op_sel_hi:[1,1,1] neg_lo:[1,0,0] neg_hi:[1,0,0]
    v_pk_fma_f32 v[190:191], v[32:33], v[108:109], v[190:191] op_sel:[1,0,0] op_sel_hi:[1,1,1]
    v_pk_fma_f32 v[110:111], v[32:33], v[108:109], v[110:111] op_sel:[0,0,0] op_sel_hi:[0,1,1]
    v_pk_fma_f32 v[190:191], v[32:33], v[188:189], v[190:191] op_sel:[0,0,0] op_sel_hi:[0,1,1]
    v_cvt_pk_bf16_f32 v199, v108, v110
    v_cvt_pk_bf16_f32 v215, -v188, -v190
    v_cvt_pk_bf16_f32 v207, v109, v111
    v_cvt_pk_bf16_f32 v223, -v189, -v191
    ds_write_b128 v133, v[196:199] offset:16
    ds_write_b128 v133, v[204:207] offset:48
    ds_write_b128 v133, v[212:215] offset:4624
    ds_write_b128 v133, v[220:223] offset:4656
    s_waitcnt lgkmcnt(0)
    s_lshl_b32 s38, s16, 19
    s_lshl_b32 s39, s17, 15
    s_add_u32 s38, s38, s39
    s_lshl_b32 s39, s20, 11
    s_add_u32 s38, s38, s39
    s_lshl_b32 s39, s19, 14
    s_add_u32 s38, s38, s39
    ds_read_b64_tr_b16 v[64:65], v134 offset:0
    ds_read_b64_tr_b16 v[66:67], v134 offset:576
    ds_read_b64_tr_b16 v[68:69], v134 offset:2304
    ds_read_b64_tr_b16 v[70:71], v134 offset:2880
    ds_read_b64_tr_b16 v[72:73], v134 offset:64
    ds_read_b64_tr_b16 v[74:75], v134 offset:640
    ds_read_b64_tr_b16 v[76:77], v134 offset:2368
    ds_read_b64_tr_b16 v[78:79], v134 offset:2944
    ds_read_b64_tr_b16 v[80:81], v134 offset:4608
    ds_read_b64_tr_b16 v[82:83], v134 offset:5184
    ds_read_b64_tr_b16 v[84:85], v134 offset:6912
    ds_read_b64_tr_b16 v[86:87], v134 offset:7488
    ds_read_b64_tr_b16 v[88:89], v134 offset:4672
    ds_read_b64_tr_b16 v[90:91], v134 offset:5248
    ds_read_b64_tr_b16 v[92:93], v134 offset:6976
    ds_read_b64_tr_b16 v[94:95], v134 offset:7552
    s_add_u32 s39, s38, 0
    s_waitcnt lgkmcnt(14)
    buffer_store_dwordx4 v[64:67], v135, s[12:15], s39 offen offset:0
    s_waitcnt lgkmcnt(12)
    buffer_store_dwordx4 v[68:71], v135, s[12:15], s39 offen offset:1024
    s_add_u32 s39, s38, 8192
    s_waitcnt lgkmcnt(10)
    buffer_store_dwordx4 v[72:75], v135, s[12:15], s39 offen offset:0
    s_waitcnt lgkmcnt(8)
    buffer_store_dwordx4 v[76:79], v135, s[12:15], s39 offen offset:1024
    s_add_u32 s39, s38, 4096
    s_waitcnt lgkmcnt(6)
    buffer_store_dwordx4 v[80:83], v135, s[12:15], s39 offen offset:0
    s_waitcnt lgkmcnt(4)
    buffer_store_dwordx4 v[84:87], v135, s[12:15], s39 offen offset:1024
    s_add_u32 s39, s38, 12288
    s_waitcnt lgkmcnt(2)
    buffer_store_dwordx4 v[88:91], v135, s[12:15], s39 offen offset:0
    s_waitcnt lgkmcnt(0)
    buffer_store_dwordx4 v[92:95], v135, s[12:15], s39 offen offset:1024
    s_endpgm
L_k1_side:
    s_load_dwordx2 s[28:29], s[0:1], 0
    s_load_dwordx2 s[30:31], s[0:1], 80
    s_load_dwordx4 s[32:35], s[0:1], 88
    s_load_dwordx2 s[36:37], s[0:1], 112
    s_load_dwordx4 s[40:43], s[0:1], 128
    s_load_dwordx4 s[48:51], s[0:1], 40
    s_load_dwordx2 s[52:53], s[0:1], 104
    s_sub_u32 s18, s18, 4
    v_and_b32 v2, 63, v0
    s_and_b32 s3, s2, 7
    s_lshl_b32 s3, s3, 8
    s_lshr_b32 s38, s2, 3
    s_lshl_b32 s38, s38, 3
    s_add_u32 s3, s3, s38
    s_lshl_b32 s38, s18, 1
    s_add_u32 s16, s3, s38
    s_lshl_b32 s17, s16, 11
    v_lshlrev_b32 v3, 4, v2
    s_waitcnt lgkmcnt(0)
    s_mov_b32 s4, s28
    s_mov_b32 s5, s29
    s_mov_b32 s6, 4194304
    s_mov_b32 s7, 0x20000
    s_mov_b32 s12, s42
    s_mov_b32 s13, s43
    s_mov_b32 s14, 16777216
    s_mov_b32 s15, 0x20000
    s_mov_b32 s8, s32
    s_mov_b32 s9, s33
    s_mov_b32 s10, 7340032
    s_mov_b32 s11, 0x20000
    s_mov_b32 s24, s34
    s_mov_b32 s25, s35
    s_mov_b32 s26, 7340032
    s_mov_b32 s27, 0x20000
    s_add_u32 s94, s42, 9469952
    s_addc_u32 s95, s43, 0
    s_load_dword s93, s[94:95], 0
    buffer_load_dwordx4 v[8:11], v3, s[4:7], s17 offen offset:0
    buffer_load_dwordx4 v[12:15], v3, s[4:7], s17 offen offset:1024
    buffer_load_dwordx4 v[16:19], v3, s[4:7], s17 offen offset:2048
    buffer_load_dwordx4 v[20:23], v3, s[4:7], s17 offen offset:3072
    global_load_dwordx4 v[24:27], v3, s[30:31] offset:0
    global_load_dwordx4 v[32:35], v3, s[36:37] offset:0
    global_load_dwordx4 v[28:31], v3, s[30:31] offset:1024
    global_load_dwordx4 v[36:39], v3, s[36:37] offset:1024
    s_mov_b32 s20, 0xffff0000
    v_mov_b32 v40, 0
    v_mov_b32 v41, 0
    v_mov_b32 v42, 0
    v_mov_b32 v43, 0
    s_barrier
    s_waitcnt vmcnt(0) lgkmcnt(0)
    s_mul_i32 s93, s93, 1664525
    s_add_u32 s93, s93, 1013904223
    v_lshlrev_b32 v44, 16, v32
    v_and_b32 v45, s20, v32
    v_dot2c_f32_bf16 v40, v8, v24
    v_lshlrev_b32 v46, 16, v8
    v_and_b32 v47, s20, v8
    v_mul_f32 v46, v46, v44
    v_mul_f32 v47, v47, v45
    v_cvt_pk_bf16_f32 v46, v46, v47
    v_lshlrev_b32 v47, 16, v46
    v_and_b32 v46, s20, v46
    v_add_f32 v42, v42, v47
    v_add_f32 v42, v42, v46
    v_dot2c_f32_bf16 v41, v16, v24
    v_lshlrev_b32 v46, 16, v16
    v_and_b32 v47, s20, v16
    v_mul_f32 v46, v46, v44
    v_mul_f32 v47, v47, v45
    v_cvt_pk_bf16_f32 v46, v46, v47
    v_lshlrev_b32 v47, 16, v46
    v_and_b32 v46, s20, v46
    v_add_f32 v43, v43, v47
    v_add_f32 v43, v43, v46
    v_lshlrev_b32 v44, 16, v33
    v_and_b32 v45, s20, v33
    v_dot2c_f32_bf16 v40, v9, v25
    v_lshlrev_b32 v46, 16, v9
    v_and_b32 v47, s20, v9
    v_mul_f32 v46, v46, v44
    v_mul_f32 v47, v47, v45
    v_cvt_pk_bf16_f32 v46, v46, v47
    v_lshlrev_b32 v47, 16, v46
    v_and_b32 v46, s20, v46
    v_add_f32 v42, v42, v47
    v_add_f32 v42, v42, v46
    v_dot2c_f32_bf16 v41, v17, v25
    v_lshlrev_b32 v46, 16, v17
    v_and_b32 v47, s20, v17
    v_mul_f32 v46, v46, v44
    v_mul_f32 v47, v47, v45
    v_cvt_pk_bf16_f32 v46, v46, v47
    v_lshlrev_b32 v47, 16, v46
    v_and_b32 v46, s20, v46
    v_add_f32 v43, v43, v47
    v_add_f32 v43, v43, v46
    v_lshlrev_b32 v44, 16, v34
    v_and_b32 v45, s20, v34
    v_dot2c_f32_bf16 v40, v10, v26
    v_lshlrev_b32 v46, 16, v10
    v_and_b32 v47, s20, v10
    v_mul_f32 v46, v46, v44
    v_mul_f32 v47, v47, v45
    v_cvt_pk_bf16_f32 v46, v46, v47
    v_lshlrev_b32 v47, 16, v46
    v_and_b32 v46, s20, v46
    v_add_f32 v42, v42, v47
    v_add_f32 v42, v42, v46
    v_dot2c_f32_bf16 v41, v18, v26
    v_lshlrev_b32 v46, 16, v18
    v_and_b32 v47, s20, v18
    v_mul_f32 v46, v46, v44
    v_mul_f32 v47, v47, v45
    v_cvt_pk_bf16_f32 v46, v46, v47
    v_lshlrev_b32 v47, 16, v46
    v_and_b32 v46, s20, v46
    v_add_f32 v43, v43, v47
    v_add_f32 v43, v43, v46
    v_lshlrev_b32 v44, 16, v35
    v_and_b32 v45, s20, v35
    v_dot2c_f32_bf16 v40, v11, v27
    v_lshlrev_b32 v46, 16, v11
    v_and_b32 v47, s20, v11
    v_mul_f32 v46, v46, v44
    v_mul_f32 v47, v47, v45
    v_cvt_pk_bf16_f32 v46, v46, v47
    v_lshlrev_b32 v47, 16, v46
    v_and_b32 v46, s20, v46
    v_add_f32 v42, v42, v47
    v_add_f32 v42, v42, v46
    v_dot2c_f32_bf16 v41, v19, v27
    v_lshlrev_b32 v46, 16, v19
    v_and_b32 v47, s20, v19
    v_mul_f32 v46, v46, v44
    v_mul_f32 v47, v47, v45
    v_cvt_pk_bf16_f32 v46, v46, v47
    v_lshlrev_b32 v47, 16, v46
    v_and_b32 v46, s20, v46
    v_add_f32 v43, v43, v47
    v_add_f32 v43, v43, v46
    v_lshlrev_b32 v44, 16, v36
    v_and_b32 v45, s20, v36
    v_dot2c_f32_bf16 v40, v12, v28
    v_lshlrev_b32 v46, 16, v12
    v_and_b32 v47, s20, v12
    v_mul_f32 v46, v46, v44
    v_mul_f32 v47, v47, v45
    v_cvt_pk_bf16_f32 v46, v46, v47
    v_lshlrev_b32 v47, 16, v46
    v_and_b32 v46, s20, v46
    v_add_f32 v42, v42, v47
    v_add_f32 v42, v42, v46
    v_dot2c_f32_bf16 v41, v20, v28
    v_lshlrev_b32 v46, 16, v20
    v_and_b32 v47, s20, v20
    v_mul_f32 v46, v46, v44
    v_mul_f32 v47, v47, v45
    v_cvt_pk_bf16_f32 v46, v46, v47
    v_lshlrev_b32 v47, 16, v46
    v_and_b32 v46, s20, v46
    v_add_f32 v43, v43, v47
    v_add_f32 v43, v43, v46
    v_lshlrev_b32 v44, 16, v37
    v_and_b32 v45, s20, v37
    v_dot2c_f32_bf16 v40, v13, v29
    v_lshlrev_b32 v46, 16, v13
    v_and_b32 v47, s20, v13
    v_mul_f32 v46, v46, v44
    v_mul_f32 v47, v47, v45
    v_cvt_pk_bf16_f32 v46, v46, v47
    v_lshlrev_b32 v47, 16, v46
    v_and_b32 v46, s20, v46
    v_add_f32 v42, v42, v47
    v_add_f32 v42, v42, v46
    v_dot2c_f32_bf16 v41, v21, v29
    v_lshlrev_b32 v46, 16, v21
    v_and_b32 v47, s20, v21
    v_mul_f32 v46, v46, v44
    v_mul_f32 v47, v47, v45
    v_cvt_pk_bf16_f32 v46, v46, v47
    v_lshlrev_b32 v47, 16, v46
    v_and_b32 v46, s20, v46
    v_add_f32 v43, v43, v47
    v_add_f32 v43, v43, v46
    v_lshlrev_b32 v44, 16, v38
    v_and_b32 v45, s20, v38
    v_dot2c_f32_bf16 v40, v14, v30
    v_lshlrev_b32 v46, 16, v14
    v_and_b32 v47, s20, v14
    v_mul_f32 v46, v46, v44
    v_mul_f32 v47, v47, v45
    v_cvt_pk_bf16_f32 v46, v46, v47
    v_lshlrev_b32 v47, 16, v46
    v_and_b32 v46, s20, v46
    v_add_f32 v42, v42, v47
    v_add_f32 v42, v42, v46
    v_dot2c_f32_bf16 v41, v22, v30
    v_lshlrev_b32 v46, 16, v22
    v_and_b32 v47, s20, v22
    v_mul_f32 v46, v46, v44
    v_mul_f32 v47, v47, v45
    v_cvt_pk_bf16_f32 v46, v46, v47
    v_lshlrev_b32 v47, 16, v46
    v_and_b32 v46, s20, v46
    v_add_f32 v43, v43, v47
    v_add_f32 v43, v43, v46
    v_lshlrev_b32 v44, 16, v39
    v_and_b32 v45, s20, v39
    v_dot2c_f32_bf16 v40, v15, v31
    v_lshlrev_b32 v46, 16, v15
    v_and_b32 v47, s20, v15
    v_mul_f32 v46, v46, v44
    v_mul_f32 v47, v47, v45
    v_cvt_pk_bf16_f32 v46, v46, v47
    v_lshlrev_b32 v47, 16, v46
    v_and_b32 v46, s20, v46
    v_add_f32 v42, v42, v47
    v_add_f32 v42, v42, v46
    v_dot2c_f32_bf16 v41, v23, v31
    v_lshlrev_b32 v46, 16, v23
    v_and_b32 v47, s20, v23
    v_mul_f32 v46, v46, v44
    v_mul_f32 v47, v47, v45
    v_cvt_pk_bf16_f32 v46, v46, v47
    v_lshlrev_b32 v47, 16, v46
    v_and_b32 v46, s20, v46
    v_add_f32 v43, v43, v47
    v_add_f32 v43, v43, v46
    s_nop 3
    v_add_f32_dpp v40, v40, v40 row_ror:8 row_mask:0xf bank_mask:0xf
    v_add_f32_dpp v41, v41, v41 row_ror:8 row_mask:0xf bank_mask:0xf
    v_add_f32_dpp v42, v42, v42 row_ror:8 row_mask:0xf bank_mask:0xf
    v_add_f32_dpp v43, v43, v43 row_ror:8 row_mask:0xf bank_mask:0xf
    v_add_f32_dpp v40, v40, v40 row_ror:4 row_mask:0xf bank_mask:0xf
    v_add_f32_dpp v41, v41, v41 row_ror:4 row_mask:0xf bank_mask:0xf
    v_add_f32_dpp v42, v42, v42 row_ror:4 row_mask:0xf bank_mask:0xf
    v_add_f32_dpp v43, v43, v43 row_ror:4 row_mask:0xf bank_mask:0xf
    v_add_f32_dpp v40, v40, v40 row_ror:2 row_mask:0xf bank_mask:0xf
    v_add_f32_dpp v41, v41, v41 row_ror:2 row_mask:0xf bank_mask:0xf
    v_add_f32_dpp v42, v42, v42 row_ror:2 row_mask:0xf bank_mask:0xf
    v_add_f32_dpp v43, v43, v43 row_ror:2 row_mask:0xf bank_mask:0xf
    v_add_f32_dpp v40, v40, v40 row_ror:1 row_mask:0xf bank_mask:0xf
    v_add_f32_dpp v41, v41, v41 row_ror:1 row_mask:0xf bank_mask:0xf
    v_add_f32_dpp v42, v42, v42 row_ror:1 row_mask:0xf bank_mask:0xf
    v_add_f32_dpp v43, v43, v43 row_ror:1 row_mask:0xf bank_mask:0xf
    v_mov_b32 v44, v40
    v_mov_b32 v45, v41
    v_mov_b32 v46, v42
    v_mov_b32 v47, v43
    s_nop 1
    v_permlane16_swap_b32 v40, v44
    v_permlane16_swap_b32 v41, v45
    v_permlane16_swap_b32 v42, v46
    v_permlane16_swap_b32 v43, v47
    s_nop 1
    v_add_f32 v40, v40, v44
    v_add_f32 v41, v41, v45
    v_add_f32 v42, v42, v46
    v_add_f32 v43, v43, v47
    v_mov_b32 v44, v40
    v_mov_b32 v45, v41
    v_mov_b32 v46, v42
    v_mov_b32 v47, v43
    s_nop 1
    v_permlane32_swap_b32 v40, v44
    v_permlane32_swap_b32 v41, v45
    v_permlane32_swap_b32 v42, v46
    v_permlane32_swap_b32 v43, v47
    s_nop 1
    v_add_f32 v40, v40, v44
    v_add_f32 v41, v41, v45
    v_add_f32 v42, v42, v46
    v_add_f32 v43, v43, v47
    v_cvt_pk_bf16_f32 v44, v40, v40
    v_lshlrev_b32 v44, 16, v44
    v_ashrrev_i32 v46, 31, v44
    v_or_b32 v46, 0x80000000, v46
    v_xor_b32 v44, v44, v46
    v_and_b32 v44, s20, v44
    s_sub_u32 s38, 2047, s16
    v_or_b32 v44, s38, v44
    v_cvt_pk_bf16_f32 v45, v41, v41
    v_lshlrev_b32 v45, 16, v45
    v_ashrrev_i32 v46, 31, v45
    v_or_b32 v46, 0x80000000, v46
    v_xor_b32 v45, v45, v46
    v_and_b32 v45, s20, v45
    s_sub_u32 s38, 2046, s16
    v_or_b32 v45, s38, v45
    v_cvt_pk_bf16_f32 v46, v42, v42
    v_lshlrev_b32 v46, 16, v46
    v_mul_f32 v48, 0xbfb8aa3b, v46
    v_exp_f32 v48, v48
    s_nop 0
    v_add_f32 v48, 1.0, v48
    v_rcp_f32 v48, v48
    s_nop 0
    v_cvt_pk_bf16_f32 v48, v48, v48
    v_lshlrev_b32 v48, 16, v48
    v_cvt_pk_bf16_f32 v46, v43, v43
    v_lshlrev_b32 v46, 16, v46
    v_mul_f32 v49, 0xbfb8aa3b, v46
    v_exp_f32 v49, v49
    s_nop 0
    v_add_f32 v49, 1.0, v49
    v_rcp_f32 v49, v49
    s_nop 0
    v_cvt_pk_bf16_f32 v49, v49, v49
    v_lshlrev_b32 v49, 16, v49
    v_mov_b32 v46, v45
    v_mov_b32 v45, s93
    v_mov_b32 v47, s93
    s_lshl_b32 s38, s16, 3
    s_add_u32 s38, s38, 9437184
    s_lshl_b32 s39, s16, 2
    s_add_u32 s39, s39, 9453568
    v_mov_b32 v4, 0
    s_mov_b64 exec, 1
    buffer_store_dwordx4 v[44:47], v4, s[12:15], s38 offen sc1
    buffer_store_dwordx2 v[48:49], v4, s[12:15], s39 offen
    s_mov_b64 exec, -1
    s_cmp_ge_u32 s2, 224
    s_cbranch_scc1 L_k1s_noffn
    s_mul_hi_u32 s23, s2, 76695845
    s_mul_i32 s38, s23, 56
    s_sub_u32 s22, s2, s38
    v_lshrrev_b32 v4, 3, v2
    v_and_b32 v5, 7, v2
    v_and_b32 v6, 3, v4
    v_lshlrev_b32 v6, 1, v6
    v_xor_b32 v5, v5, v6
    v_mul_u32_u24 v4, 7168, v4
    v_lshl_add_u32 v4, v5, 4, v4
    s_lshl_b32 s38, s18, 6
    s_lshl_b32 s39, s23, 8
    s_add_u32 s54, s38, s39
    s_mul_i32 s55, s54, 7168
    s_lshl_b32 s39, s22, 7
    s_add_u32 s55, s55, s39
    s_lshl_b32 s56, s18, 14
    s_add_u32 s56, s56, 98304
    s_barrier
    s_barrier
    s_barrier
    s_barrier
    s_barrier
    s_barrier
    s_barrier
    s_barrier
    s_barrier
    s_lshl_b32 s58, s18, 12
    s_add_u32 s58, s58, 9437184
    buffer_load_dwordx4 v[80:83], v3, s[12:15], s58 offen offset:0 sc1
    buffer_load_dwordx4 v[84:87], v3, s[12:15], s58 offen offset:1024 sc1
    buffer_load_dwordx4 v[88:91], v3, s[12:15], s58 offen offset:2048 sc1
    buffer_load_dwordx4 v[92:95], v3, s[12:15], s58 offen offset:3072 sc1
    v_mov_b32 v8, 0
    s_mov_b32 s57, -1
    s_barrier
    s_barrier
L_k1s_poll:
    s_waitcnt vmcnt(0)
    v_xor_b32 v81, s93, v81
    v_mov_b32 v64, v80
    v_xor_b32 v83, s93, v83
    v_mov_b32 v65, v82
    v_xor_b32 v85, s93, v85
    v_mov_b32 v66, v84
    v_xor_b32 v87, s93, v87
    v_mov_b32 v67, v86
    v_xor_b32 v89, s93, v89
    v_mov_b32 v68, v88
    v_xor_b32 v91, s93, v91
    v_mov_b32 v69, v90
    v_xor_b32 v93, s93, v93
    v_mov_b32 v70, v92
    v_xor_b32 v95, s93, v95
    v_mov_b32 v71, v94
    v_or3_b32 v9, v81, v83, v85
    v_or3_b32 v9, v9, v87, v89
    v_or3_b32 v9, v9, v91, v93
    v_or_b32 v9, v9, v95
    v_cmp_ne_u32 vcc, 0, v9
    s_nop 1
    s_cmp_eq_u64 vcc, 0
    s_cbranch_scc1 L_k1s_go
    s_sleep 8
    buffer_load_dwordx4 v[80:83], v3, s[12:15], s58 offen offset:0 sc1
    buffer_load_dwordx4 v[84:87], v3, s[12:15], s58 offen offset:1024 sc1
    buffer_load_dwordx4 v[88:91], v3, s[12:15], s58 offen offset:2048 sc1
    buffer_load_dwordx4 v[92:95], v3, s[12:15], s58 offen offset:3072 sc1
    s_branch L_k1s_poll
L_k1s_go:
    v_sub_u32 v72, s57, v64
    v_sub_u32 v73, s57, v65
    v_sub_u32 v74, s57, v66
    v_sub_u32 v75, s57, v67
    v_sub_u32 v76, s57, v68
    v_sub_u32 v77, s57, v69
    v_sub_u32 v78, s57, v70
    v_sub_u32 v79, s57, v71
    v_min3_u32 v9, v72, v73, v74
    v_min3_u32 v10, v75, v76, v77
    v_min3_u32 v9, v9, v78, v79
    v_min_u32 v9, v9, v10
    s_nop 1
    v_min_u32_dpp v9, v9, v9 row_ror:8 row_mask:0xf bank_mask:0xf
    s_nop 1
    v_min_u32_dpp v9, v9, v9 row_ror:4 row_mask:0xf bank_mask:0xf
    s_nop 1
    v_min_u32_dpp v9, v9, v9 row_ror:2 row_mask:0xf bank_mask:0xf
    s_nop 1
    v_min_u32_dpp v9, v9, v9 row_ror:1 row_mask:0xf bank_mask:0xf
    s_nop 0
    v_readlane_b32 s44, v9, 0
    v_readlane_b32 s45, v9, 16
    v_readlane_b32 s46, v9, 32
    v_readlane_b32 s47, v9, 48
    s_nop 0
    s_min_u32 s44, s44, s45
    s_min_u32 s46, s46, s47
    s_min_u32 s44, s44, s46
    s_sub_u32 s57, s57, s44
    v_writelane_b32 v8, s57, 0
    s_sub_u32 s57, s57, 1
    v_sub_u32 v72, s57, v64
    v_sub_u32 v73, s57, v65
    v_sub_u32 v74, s57, v66
    v_sub_u32 v75, s57, v67
    v_sub_u32 v76, s57, v68
    v_sub_u32 v77, s57, v69
    v_sub_u32 v78, s57, v70
    v_sub_u32 v79, s57, v71
    v_min3_u32 v9, v72, v73, v74
    v_min3_u32 v10, v75, v76, v77
    v_min3_u32 v9, v9, v78, v79
    v_min_u32 v9, v9, v10
    s_nop 1
    v_min_u32_dpp v9, v9, v9 row_ror:8 row_mask:0xf bank_mask:0xf
    s_nop 1
    v_min_u32_dpp v9, v9, v9 row_ror:4 row_mask:0xf bank_mask:0xf
    s_nop 1
    v_min_u32_dpp v9, v9, v9 row_ror:2 row_mask:0xf bank_mask:0xf
    s_nop 1
    v_min_u32_dpp v9, v9, v9 row_ror:1 row_mask:0xf bank_mask:0xf
    s_nop 0
    v_readlane_b32 s44, v9, 0
    v_readlane_b32 s45, v9, 16
    v_readlane_b32 s46, v9, 32
    v_readlane_b32 s47, v9, 48
    s_nop 0
    s_min_u32 s44, s44, s45
    s_min_u32 s46, s46, s47
    s_min_u32 s44, s44, s46
    s_sub_u32 s57, s57, s44
    v_writelane_b32 v8, s57, 1
    s_sub_u32 s57, s57, 1
    v_sub_u32 v72, s57, v64
    v_sub_u32 v73, s57, v65
    v_sub_u32 v74, s57, v66
    v_sub_u32 v75, s57, v67
    v_sub_u32 v76, s57, v68
    v_sub_u32 v77, s57, v69
    v_sub_u32 v78, s57, v70
    v_sub_u32 v79, s57, v71
    v_min3_u32 v9, v72, v73, v74
    v_min3_u32 v10, v75, v76, v77
    v_min3_u32 v9, v9, v78, v79
    v_min_u32 v9, v9, v10
    s_nop 1
    v_min_u32_dpp v9, v9, v9 row_ror:8 row_mask:0xf bank_mask:0xf
    s_nop 1
    v_min_u32_dpp v9, v9, v9 row_ror:4 row_mask:0xf bank_mask:0xf
    s_nop 1
    v_min_u32_dpp v9, v9, v9 row_ror:2 row_mask:0xf bank_mask:0xf
    s_nop 1
    v_min_u32_dpp v9, v9, v9 row_ror:1 row_mask:0xf bank_mask:0xf
    s_nop 0
    v_readlane_b32 s44, v9, 0
    v_readlane_b32 s45, v9, 16
    v_readlane_b32 s46, v9, 32
    v_readlane_b32 s47, v9, 48
    s_nop 0
    s_min_u32 s44, s44, s45
    s_min_u32 s46, s46, s47
    s_min_u32 s44, s44, s46
    s_sub_u32 s57, s57, s44
    v_writelane_b32 v8, s57, 2
    s_sub_u32 s57, s57, 1
    v_sub_u32 v72, s57, v64
    v_sub_u32 v73, s57, v65
    v_sub_u32 v74, s57, v66
    v_sub_u32 v75, s57, v67
    v_sub_u32 v76, s57, v68
    v_sub_u32 v77, s57, v69
    v_sub_u32 v78, s57, v70
    v_sub_u32 v79, s57, v71
    v_min3_u32 v9, v72, v73, v74
    v_min3_u32 v10, v75, v76, v77
    v_min3_u32 v9, v9, v78, v79
    v_min_u32 v9, v9, v10
    s_nop 1
    v_min_u32_dpp v9, v9, v9 row_ror:8 row_mask:0xf bank_mask:0xf
    s_nop 1
    v_min_u32_dpp v9, v9, v9 row_ror:4 row_mask:0xf bank_mask:0xf
    s_nop 1
    v_min_u32_dpp v9, v9, v9 row_ror:2 row_mask:0xf bank_mask:0xf
    s_nop 1
    v_min_u32_dpp v9, v9, v9 row_ror:1 row_mask:0xf bank_mask:0xf
    s_nop 0
    v_readlane_b32 s44, v9, 0
    v_readlane_b32 s45, v9, 16
    v_readlane_b32 s46, v9, 32
    v_readlane_b32 s47, v9, 48
    s_nop 0
    s_min_u32 s44, s44, s45
    s_min_u32 s46, s46, s47
    s_min_u32 s44, s44, s46
    s_sub_u32 s57, s57, s44
    v_writelane_b32 v8, s57, 3
    s_sub_u32 s57, s57, 1
    s_barrier
    v_sub_u32 v72, s57, v64
    v_sub_u32 v73, s57, v65
    v_sub_u32 v74, s57, v66
    v_sub_u32 v75, s57, v67
    v_sub_u32 v76, s57, v68
    v_sub_u32 v77, s57, v69
    v_sub_u32 v78, s57, v70
    v_sub_u32 v79, s57, v71
    v_min3_u32 v9, v72, v73, v74
    v_min3_u32 v10, v75, v76, v77
    v_min3_u32 v9, v9, v78, v79
    v_min_u32 v9, v9, v10
    s_nop 1
    v_min_u32_dpp v9, v9, v9 row_ror:8 row_mask:0xf bank_mask:0xf
    s_nop 1
    v_min_u32_dpp v9, v9, v9 row_ror:4 row_mask:0xf bank_mask:0xf
    s_nop 1
    v_min_u32_dpp v9, v9, v9 row_ror:2 row_mask:0xf bank_mask:0xf
    s_nop 1
    v_min_u32_dpp v9, v9, v9 row_ror:1 row_mask:0xf bank_mask:0xf
    s_nop 0
    v_readlane_b32 s44, v9, 0
    v_readlane_b32 s45, v9, 16
    v_readlane_b32 s46, v9, 32
    v_readlane_b32 s47, v9, 48
    s_nop 0
    s_min_u32 s44, s44, s45
    s_min_u32 s46, s46, s47
    s_min_u32 s44, s44, s46
    s_sub_u32 s57, s57, s44
    v_writelane_b32 v8, s57, 4
    s_sub_u32 s57, s57, 1
    v_sub_u32 v72, s57, v64
    v_sub_u32 v73, s57, v65
    v_sub_u32 v74, s57, v66
    v_sub_u32 v75, s57, v67
    v_sub_u32 v76, s57, v68
    v_sub_u32 v77, s57, v69
    v_sub_u32 v78, s57, v70
    v_sub_u32 v79, s57, v71
    v_min3_u32 v9, v72, v73, v74
    v_min3_u32 v10, v75, v76, v77
    v_min3_u32 v9, v9, v78, v79
    v_min_u32 v9, v9, v10
    s_nop 1
    v_min_u32_dpp v9, v9, v9 row_ror:8 row_mask:0xf bank_mask:0xf
    s_nop 1
    v_min_u32_dpp v9, v9, v9 row_ror:4 row_mask:0xf bank_mask:0xf
    s_nop 1
    v_min_u32_dpp v9, v9, v9 row_ror:2 row_mask:0xf bank_mask:0xf
    s_nop 1
    v_min_u32_dpp v9, v9, v9 row_ror:1 row_mask:0xf bank_mask:0xf
    s_nop 0
    v_readlane_b32 s44, v9, 0
    v_readlane_b32 s45, v9, 16
    v_readlane_b32 s46, v9, 32
    v_readlane_b32 s47, v9, 48
    s_nop 0
    s_min_u32 s44, s44, s45
    s_min_u32 s46, s46, s47
    s_min_u32 s44, s44, s46
    s_sub_u32 s57, s57, s44
    v_writelane_b32 v8, s57, 5
    s_sub_u32 s57, s57, 1
    v_sub_u32 v72, s57, v64
    v_sub_u32 v73, s57, v65
    v_sub_u32 v74, s57, v66
    v_sub_u32 v75, s57, v67
    v_sub_u32 v76, s57, v68
    v_sub_u32 v77, s57, v69
    v_sub_u32 v78, s57, v70
    v_sub_u32 v79, s57, v71
    v_min3_u32 v9, v72, v73, v74
    v_min3_u32 v10, v75, v76, v77
    v_min3_u32 v9, v9, v78, v79
    v_min_u32 v9, v9, v10
    s_nop 1
    v_min_u32_dpp v9, v9, v9 row_ror:8 row_mask:0xf bank_mask:0xf
    s_nop 1
    v_min_u32_dpp v9, v9, v9 row_ror:4 row_mask:0xf bank_mask:0xf
    s_nop 1
    v_min_u32_dpp v9, v9, v9 row_ror:2 row_mask:0xf bank_mask:0xf
    s_nop 1
    v_min_u32_dpp v9, v9, v9 row_ror:1 row_mask:0xf bank_mask:0xf
    s_nop 0
    v_readlane_b32 s44, v9, 0
    v_readlane_b32 s45, v9, 16
    v_readlane_b32 s46, v9, 32
    v_readlane_b32 s47, v9, 48
    s_nop 0
    s_min_u32 s44, s44, s45
    s_min_u32 s46, s46, s47
    s_min_u32 s44, s44, s46
    s_sub_u32 s57, s57, s44
    v_writelane_b32 v8, s57, 6
    s_sub_u32 s57, s57, 1
    v_sub_u32 v72, s57, v64
    v_sub_u32 v73, s57, v65
    v_sub_u32 v74, s57, v66
    v_sub_u32 v75, s57, v67
    v_sub_u32 v76, s57, v68
    v_sub_u32 v77, s57, v69
    v_sub_u32 v78, s57, v70
    v_sub_u32 v79, s57, v71
    v_min3_u32 v9, v72, v73, v74
    v_min3_u32 v10, v75, v76, v77
    v_min3_u32 v9, v9, v78, v79
    v_min_u32 v9, v9, v10
    s_nop 1
    v_min_u32_dpp v9, v9, v9 row_ror:8 row_mask:0xf bank_mask:0xf
    s_nop 1
    v_min_u32_dpp v9, v9, v9 row_ror:4 row_mask:0xf bank_mask:0xf
    s_nop 1
    v_min_u32_dpp v9, v9, v9 row_ror:2 row_mask:0xf bank_mask:0xf
    s_nop 1
    v_min_u32_dpp v9, v9, v9 row_ror:1 row_mask:0xf bank_mask:0xf
    s_nop 0
    v_readlane_b32 s44, v9, 0
    v_readlane_b32 s45, v9, 16
    v_readlane_b32 s46, v9, 32
    v_readlane_b32 s47, v9, 48
    s_nop 0
    s_min_u32 s44, s44, s45
    s_min_u32 s46, s46, s47
    s_min_u32 s44, s44, s46
    s_sub_u32 s57, s57, s44
    v_writelane_b32 v8, s57, 7
    s_sub_u32 s57, s57, 1
    s_lshl_b32 s38, s18, 5
    s_add_u32 s38, s38, 163584
    v_lshl_add_u32 v9, v2, 2, s38
    s_mov_b64 exec, 0xff
    ds_write_b32 v9, v8
    s_mov_b64 exec, -1
    s_waitcnt lgkmcnt(0)
    s_barrier
    v_and_b32 v9, 31, v2
    v_lshlrev_b32 v9, 2, v9
    v_add_u32 v9, 163584, v9
    v_mov_b32 v10, 163584
    ds_read_b32 v11, v9
    ds_read_b128 v[64:67], v10 offset:0
    ds_read_b128 v[68:71], v10 offset:16
    ds_read_b128 v[72:75], v10 offset:32
    ds_read_b128 v[76:79], v10 offset:48
    ds_read_b128 v[80:83], v10 offset:64
    ds_read_b128 v[84:87], v10 offset:80
    ds_read_b128 v[88:91], v10 offset:96
    ds_read_b128 v[92:95], v10 offset:112
    v_mov_b32 v12, 0
    s_waitcnt lgkmcnt(0)
    v_cmp_gt_u32 s[82:83], v64, v11
    v_cmp_gt_u32 s[84:85], v65, v11
    v_cmp_gt_u32 s[86:87], v66, v11
    v_cmp_gt_u32 s[88:89], v67, v11
    v_addc_co_u32 v12, vcc, 0, v12, s[82:83]
    v_addc_co_u32 v12, vcc, 0, v12, s[84:85]
    v_addc_co_u32 v12, vcc, 0, v12, s[86:87]
    v_addc_co_u32 v12, vcc, 0, v12, s[88:89]
    v_cmp_gt_u32 s[82:83], v68, v11
    v_cmp_gt_u32 s[84:85], v69, v11
    v_cmp_gt_u32 s[86:87], v70, v11
    v_cmp_gt_u32 s[88:89], v71, v11
    v_addc_co_u32 v12, vcc, 0, v12, s[82:83]
    v_addc_co_u32 v12, vcc, 0, v12, s[84:85]
    v_addc_co_u32 v12, vcc, 0, v12, s[86:87]
    v_addc_co_u32 v12, vcc, 0, v12, s[88:89]
    v_cmp_gt_u32 s[82:83], v72, v11
    v_cmp_gt_u32 s[84:85], v73, v11
    v_cmp_gt_u32 s[86:87], v74, v11
    v_cmp_gt_u32 s[88:89], v75, v11
    v_addc_co_u32 v12, vcc, 0, v12, s[82:83]
    v_addc_co_u32 v12, vcc, 0, v12, s[84:85]
    v_addc_co_u32 v12, vcc, 0, v12, s[86:87]
    v_addc_co_u32 v12, vcc, 0, v12, s[88:89]
    v_cmp_gt_u32 s[82:83], v76, v11
    v_cmp_gt_u32 s[84:85], v77, v11
    v_cmp_gt_u32 s[86:87], v78, v11
    v_cmp_gt_u32 s[88:89], v79, v11
    v_addc_co_u32 v12, vcc, 0, v12, s[82:83]
    v_addc_co_u32 v12, vcc, 0, v12, s[84:85]
    v_addc_co_u32 v12, vcc, 0, v12, s[86:87]
    v_addc_co_u32 v12, vcc, 0, v12, s[88:89]
    v_cmp_gt_u32 s[82:83], v80, v11
    v_cmp_gt_u32 s[84:85], v81, v11
    v_cmp_gt_u32 s[86:87], v82, v11
    v_cmp_gt_u32 s[88:89], v83, v11
    v_addc_co_u32 v12, vcc, 0, v12, s[82:83]
    v_addc_co_u32 v12, vcc, 0, v12, s[84:85]
    v_addc_co_u32 v12, vcc, 0, v12, s[86:87]
    v_addc_co_u32 v12, vcc, 0, v12, s[88:89]
    v_cmp_gt_u32 s[82:83], v84, v11
    v_cmp_gt_u32 s[84:85], v85, v11
    v_cmp_gt_u32 s[86:87], v86, v11
    v_cmp_gt_u32 s[88:89], v87, v11
    v_addc_co_u32 v12, vcc, 0, v12, s[82:83]
    v_addc_co_u32 v12, vcc, 0, v12, s[84:85]
    v_addc_co_u32 v12, vcc, 0, v12, s[86:87]
    v_addc_co_u32 v12, vcc, 0, v12, s[88:89]
    v_cmp_gt_u32 s[82:83], v88, v11
    v_cmp_gt_u32 s[84:85], v89, v11
    v_cmp_gt_u32 s[86:87], v90, v11
    v_cmp_gt_u32 s[88:89], v91, v11
    v_addc_co_u32 v12, vcc, 0, v12, s[82:83]
    v_addc_co_u32 v12, vcc, 0, v12, s[84:85]
    v_addc_co_u32 v12, vcc, 0, v12, s[86:87]
    v_addc_co_u32 v12, vcc, 0, v12, s[88:89]
    v_cmp_gt_u32 s[82:83], v92, v11
    v_cmp_gt_u32 s[84:85], v93, v11
    v_cmp_gt_u32 s[86:87], v94, v11
    v_cmp_gt_u32 s[88:89], v95, v11
    v_addc_co_u32 v12, vcc, 0, v12, s[82:83]
    v_addc_co_u32 v12, vcc, 0, v12, s[84:85]
    v_addc_co_u32 v12, vcc, 0, v12, s[86:87]
    v_addc_co_u32 v12, vcc, 0, v12, s[88:89]
    v_lshlrev_b32 v12, 2, v12
    s_mov_b32 exec_hi, 0
    ds_permute_b32 v13, v12, v11
    s_mov_b64 exec, -1
    v_and_b32 v12, 7, v2
    v_lshlrev_b32 v12, 2, v12
    s_waitcnt lgkmcnt(0)
    ds_bpermute_b32 v8, v12, v13
    s_waitcnt lgkmcnt(0)
    s_or_b32 s38, s2, s18
    s_cbranch_scc1 L_k1s_notop
    v_lshlrev_b32 v9, 2, v2
    s_mov_b32 s38, 9461760
    s_mov_b64 exec, 0xff
    buffer_store_dword v8, v9, s[12:15], s38 offen
    s_mov_b64 exec, 1
    s_mov_b32 s38, 9469952
    v_mov_b32 v13, s93
    buffer_store_dword v13, v9, s[12:15], s38 offen
    s_mov_b64 exec, -1
L_k1s_notop:
    v_and_b32 v9, 0x7ff, v8
    v_sub_u32 v9, 2047, v9
    v_lshlrev_b32 v9, 11, v9
    v_lshrrev_b32 v10, 4, v2
    v_lshl_add_u32 v9, v10, 4, v9
    s_lshl_b32 s38, s54, 1
    buffer_load_dwordx4 v[64:67], v9, s[4:7], s38 offen offset:0
    buffer_load_dwordx4 v[68:71], v9, s[4:7], s38 offen offset:64
    v_bfe_u32 v11, v2, 2, 2
    v_lshl_add_u32 v12, v10, 3, v11
    v_lshlrev_b32 v12, 7, v12
    v_and_b32 v13, 3, v2
    v_lshl_add_u32 v12, v13, 3, v12
    v_add_u32 v12, s56, v12
    v_xor_b32 v13, 0, v11
    v_lshl_add_u32 v16, v13, 5, v12
    v_xor_b32 v13, 1, v11
    v_lshl_add_u32 v17, v13, 5, v12
    v_xor_b32 v13, 2, v11
    v_lshl_add_u32 v18, v13, 5, v12
    v_xor_b32 v13, 3, v11
    v_lshl_add_u32 v19, v13, 5, v12
    s_barrier
    s_add_u32 m0, s56, 0
    s_add_u32 s38, s55, 0
    buffer_load_dwordx4 v4, s[8:11], s38 offen lds
    s_add_u32 m0, s56, 1024
    s_add_u32 s38, s55, 57344
    buffer_load_dwordx4 v4, s[8:11], s38 offen lds
    s_add_u32 m0, s56, 2048
    s_add_u32 s38, s55, 114688
    buffer_load_dwordx4 v4, s[8:11], s38 offen lds
    s_add_u32 m0, s56, 3072
    s_add_u32 s38, s55, 172032
    buffer_load_dwordx4 v4, s[8:11], s38 offen lds
    s_barrier
    s_add_u32 m0, s56, 4096
    s_add_u32 s38, s55, 229376
    buffer_load_dwordx4 v4, s[8:11], s38 offen lds
    s_add_u32 m0, s56, 5120
    s_add_u32 s38, s55, 286720
    buffer_load_dwordx4 v4, s[8:11], s38 offen lds
    s_add_u32 m0, s56, 6144
    s_add_u32 s38, s55, 344064
    buffer_load_dwordx4 v4, s[8:11], s38 offen lds
    s_add_u32 m0, s56, 7168
    s_add_u32 s38, s55, 401408
    buffer_load_dwordx4 v4, s[8:11], s38 offen lds
    s_cmp_lg_u32 s18, 0
    s_cbranch_scc1 L_k1s_nocz
    v_mov_b32 v13, 73728
    v_mov_b32 v14, 0
    ds_write_b32 v13, v14
    s_waitcnt lgkmcnt(0)
L_k1s_nocz:
    s_barrier
    s_waitcnt vmcnt(3)
    s_add_u32 m0, s56, 8192
    s_add_u32 s38, s55, 0
    buffer_load_dwordx4 v4, s[24:27], s38 offen lds
    s_waitcnt vmcnt(3)
    s_add_u32 m0, s56, 9216
    s_add_u32 s38, s55, 57344
    buffer_load_dwordx4 v4, s[24:27], s38 offen lds
    s_waitcnt vmcnt(3)
    s_add_u32 m0, s56, 10240
    s_add_u32 s38, s55, 114688
    buffer_load_dwordx4 v4, s[24:27], s38 offen lds
    s_waitcnt vmcnt(3)
    s_add_u32 m0, s56, 11264
    s_add_u32 s38, s55, 172032
    buffer_load_dwordx4 v4, s[24:27], s38 offen lds
    s_waitcnt vmcnt(3)
    s_add_u32 m0, s56, 12288
    s_add_u32 s38, s55, 229376
    buffer_load_dwordx4 v4, s[24:27], s38 offen lds
    s_waitcnt vmcnt(3)
    s_add_u32 m0, s56, 13312
    s_add_u32 s38, s55, 286720
    buffer_load_dwordx4 v4, s[24:27], s38 offen lds
    s_waitcnt vmcnt(3)
    s_add_u32 m0, s56, 14336
    s_add_u32 s38, s55, 344064
    buffer_load_dwordx4 v4, s[24:27], s38 offen lds
    s_waitcnt vmcnt(3)
    s_add_u32 m0, s56, 15360
    s_add_u32 s38, s55, 401408
    buffer_load_dwordx4 v4, s[24:27], s38 offen lds
    s_waitcnt vmcnt(0)
    s_and_b32 s38, s2, 1
    s_lshl_b32 s38, s38, 9
    s_lshr_b32 s39, s2, 3
    s_lshl_b32 s39, s39, 4
    s_add_u32 s38, s38, s39
    s_lshl_b32 s39, s18, 2
    s_add_u32 s38, s38, s39
    s_lshl_b32 s38, s38, 11
    v_lshl_add_u32 v60, v2, 7, s38
    global_load_dword v61, v60, s[48:49]
    global_load_dword v62, v60, s[50:51]
    ds_read_b64_tr_b16 v[100:101], v16 offset:0
    ds_read_b64_tr_b16 v[102:103], v16 offset:512
    ds_read_b64_tr_b16 v[104:105], v16 offset:4096
    ds_read_b64_tr_b16 v[106:107], v16 offset:4608
    ds_read_b64_tr_b16 v[108:109], v17 offset:0
    ds_read_b64_tr_b16 v[110:111], v17 offset:512
    ds_read_b64_tr_b16 v[112:113], v17 offset:4096
    ds_read_b64_tr_b16 v[114:115], v17 offset:4608
    ds_read_b64_tr_b16 v[116:117], v18 offset:0
    ds_read_b64_tr_b16 v[118:119], v18 offset:512
    ds_read_b64_tr_b16 v[120:121], v18 offset:4096
    ds_read_b64_tr_b16 v[122:123], v18 offset:4608
    ds_read_b64_tr_b16 v[124:125], v19 offset:0
    ds_read_b64_tr_b16 v[126:127], v19 offset:512
    ds_read_b64_tr_b16 v[128:129], v19 offset:4096
    ds_read_b64_tr_b16 v[130:131], v19 offset:4608
    s_waitcnt lgkmcnt(0)
    ds_read_b64_tr_b16 v[132:133], v16 offset:8192
    ds_read_b64_tr_b16 v[134:135], v16 offset:8704
    ds_read_b64_tr_b16 v[136:137], v16 offset:12288
    ds_read_b64_tr_b16 v[138:139], v16 offset:12800
    ds_read_b64_tr_b16 v[140:141], v17 offset:8192
    ds_read_b64_tr_b16 v[142:143], v17 offset:8704
    ds_read_b64_tr_b16 v[144:145], v17 offset:12288
    ds_read_b64_tr_b16 v[146:147], v17 offset:12800
    ds_read_b64_tr_b16 v[148:149], v18 offset:8192
    ds_read_b64_tr_b16 v[150:151], v18 offset:8704
    ds_read_b64_tr_b16 v[152:153], v18 offset:12288
    ds_read_b64_tr_b16 v[154:155], v18 offset:12800
    ds_read_b64_tr_b16 v[156:157], v19 offset:8192
    ds_read_b64_tr_b16 v[158:159], v19 offset:8704
    ds_read_b64_tr_b16 v[160:161], v19 offset:12288
    ds_read_b64_tr_b16 v[162:163], v19 offset:12800
    s_waitcnt lgkmcnt(0)
    v_mfma_f32_16x16x32_bf16 v[24:27], v[100:103], v[64:67], 0
    v_mfma_f32_16x16x32_bf16 v[28:31], v[108:111], v[64:67], 0
    v_mfma_f32_16x16x32_bf16 v[32:35], v[116:119], v[64:67], 0
    v_mfma_f32_16x16x32_bf16 v[36:39], v[124:127], v[64:67], 0
    v_mfma_f32_16x16x32_bf16 v[40:43], v[132:135], v[64:67], 0
    v_mfma_f32_16x16x32_bf16 v[44:47], v[140:143], v[64:67], 0
    v_mfma_f32_16x16x32_bf16 v[48:51], v[148:151], v[64:67], 0
    v_mfma_f32_16x16x32_bf16 v[52:55], v[156:159], v[64:67], 0
    v_mfma_f32_16x16x32_bf16 v[24:27], v[104:107], v[68:71], v[24:27]
    v_mfma_f32_16x16x32_bf16 v[28:31], v[112:115], v[68:71], v[28:31]
    v_mfma_f32_16x16x32_bf16 v[32:35], v[120:123], v[68:71], v[32:35]
    v_mfma_f32_16x16x32_bf16 v[36:39], v[128:131], v[68:71], v[36:39]
    v_mfma_f32_16x16x32_bf16 v[40:43], v[136:139], v[68:71], v[40:43]
    v_mfma_f32_16x16x32_bf16 v[44:47], v[144:147], v[68:71], v[44:47]
    v_mfma_f32_16x16x32_bf16 v[48:51], v[152:155], v[68:71], v[48:51]
    v_mfma_f32_16x16x32_bf16 v[52:55], v[160:163], v[68:71], v[52:55]
    v_add_u32 v13, s56, v3
    v_mov_b32 v14, 73728
    v_mov_b32 v15, 1
    s_nop 7
    ds_write_b128 v13, v[24:27] offset:0
    ds_write_b128 v13, v[28:31] offset:1024
    ds_write_b128 v13, v[32:35] offset:2048
    ds_write_b128 v13, v[36:39] offset:3072
    ds_write_b128 v13, v[40:43] offset:4096
    ds_write_b128 v13, v[44:47] offset:5120
    ds_write_b128 v13, v[48:51] offset:6144
    ds_write_b128 v13, v[52:55] offset:7168
    s_waitcnt lgkmcnt(0)
    s_mov_b64 exec, 1
    ds_add_rtn_u32 v15, v14, v15
    s_mov_b64 exec, -1
    s_waitcnt lgkmcnt(0)
    v_readfirstlane_b32 s38, v15
    s_nop 1
    s_cmp_lg_u32 s38, 3
    s_cbranch_scc1 L_k1s_end
    v_add_u32 v13, 98304, v3
    ds_read_b128 v[100:103], v13 offset:0
    ds_read_b128 v[104:107], v13 offset:1024
    ds_read_b128 v[108:111], v13 offset:2048
    ds_read_b128 v[112:115], v13 offset:3072
    ds_read_b128 v[116:119], v13 offset:4096
    ds_read_b128 v[120:123], v13 offset:5120
    ds_read_b128 v[124:127], v13 offset:6144
    ds_read_b128 v[128:131], v13 offset:7168
    ds_read_b128 v[132:135], v13 offset:16384
    ds_read_b128 v[136:139], v13 offset:17408
    ds_read_b128 v[140:143], v13 offset:18432
    ds_read_b128 v[144:147], v13 offset:19456
    ds_read_b128 v[148:151], v13 offset:20480
    ds_read_b128 v[152:155], v13 offset:21504
    ds_read_b128 v[156:159], v13 offset:22528
    ds_read_b128 v[160:163], v13 offset:23552
    s_waitcnt lgkmcnt(0)
    ds_read_b128 v[164:167], v13 offset:32768
    ds_read_b128 v[168:171], v13 offset:33792
    ds_read_b128 v[172:175], v13 offset:34816
    ds_read_b128 v[176:179], v13 offset:35840
    ds_read_b128 v[180:183], v13 offset:36864
    ds_read_b128 v[184:187], v13 offset:37888
    ds_read_b128 v[188:191], v13 offset:38912
    ds_read_b128 v[192:195], v13 offset:39936
    ds_read_b128 v[196:199], v13 offset:49152
    ds_read_b128 v[200:203], v13 offset:50176
    ds_read_b128 v[204:207], v13 offset:51200
    ds_read_b128 v[208:211], v13 offset:52224
    ds_read_b128 v[212:215], v13 offset:53248
    ds_read_b128 v[216:219], v13 offset:54272
    ds_read_b128 v[220:223], v13 offset:55296
    ds_read_b128 v[224:227], v13 offset:56320
    s_waitcnt lgkmcnt(0)
    v_add_f32 v100, v100, v132
    v_add_f32 v164, v164, v196
    v_add_f32 v100, v100, v164
    v_add_f32 v101, v101, v133
    v_add_f32 v165, v165, v197
    v_add_f32 v101, v101, v165
    v_add_f32 v102, v102, v134
    v_add_f32 v166, v166, v198
    v_add_f32 v102, v102, v166
    v_add_f32 v103, v103, v135
    v_add_f32 v167, v167, v199
    v_add_f32 v103, v103, v167
    v_add_f32 v104, v104, v136
    v_add_f32 v168, v168, v200
    v_add_f32 v104, v104, v168
    v_add_f32 v105, v105, v137
    v_add_f32 v169, v169, v201
    v_add_f32 v105, v105, v169
    v_add_f32 v106, v106, v138
    v_add_f32 v170, v170, v202
    v_add_f32 v106, v106, v170
    v_add_f32 v107, v107, v139
    v_add_f32 v171, v171, v203
    v_add_f32 v107, v107, v171
    v_add_f32 v108, v108, v140
    v_add_f32 v172, v172, v204
    v_add_f32 v108, v108, v172
    v_add_f32 v109, v109, v141
    v_add_f32 v173, v173, v205
    v_add_f32 v109, v109, v173
    v_add_f32 v110, v110, v142
    v_add_f32 v174, v174, v206
    v_add_f32 v110, v110, v174
    v_add_f32 v111, v111, v143
    v_add_f32 v175, v175, v207
    v_add_f32 v111, v111, v175
    v_add_f32 v112, v112, v144
    v_add_f32 v176, v176, v208
    v_add_f32 v112, v112, v176
    v_add_f32 v113, v113, v145
    v_add_f32 v177, v177, v209
    v_add_f32 v113, v113, v177
    v_add_f32 v114, v114, v146
    v_add_f32 v178, v178, v210
    v_add_f32 v114, v114, v178
    v_add_f32 v115, v115, v147
    v_add_f32 v179, v179, v211
    v_add_f32 v115, v115, v179
    v_add_f32 v116, v116, v148
    v_add_f32 v180, v180, v212
    v_add_f32 v116, v116, v180
    v_add_f32 v117, v117, v149
    v_add_f32 v181, v181, v213
    v_add_f32 v117, v117, v181
    v_add_f32 v118, v118, v150
    v_add_f32 v182, v182, v214
    v_add_f32 v118, v118, v182
    v_add_f32 v119, v119, v151
    v_add_f32 v183, v183, v215
    v_add_f32 v119, v119, v183
    v_add_f32 v120, v120, v152
    v_add_f32 v184, v184, v216
    v_add_f32 v120, v120, v184
    v_add_f32 v121, v121, v153
    v_add_f32 v185, v185, v217
    v_add_f32 v121, v121, v185
    v_add_f32 v122, v122, v154
    v_add_f32 v186, v186, v218
    v_add_f32 v122, v122, v186
    v_add_f32 v123, v123, v155
    v_add_f32 v187, v187, v219
    v_add_f32 v123, v123, v187
    v_add_f32 v124, v124, v156
    v_add_f32 v188, v188, v220
    v_add_f32 v124, v124, v188
    v_add_f32 v125, v125, v157
    v_add_f32 v189, v189, v221
    v_add_f32 v125, v125, v189
    v_add_f32 v126, v126, v158
    v_add_f32 v190, v190, v222
    v_add_f32 v126, v126, v190
    v_add_f32 v127, v127, v159
    v_add_f32 v191, v191, v223
    v_add_f32 v127, v127, v191
    v_add_f32 v128, v128, v160
    v_add_f32 v192, v192, v224
    v_add_f32 v128, v128, v192
    v_add_f32 v129, v129, v161
    v_add_f32 v193, v193, v225
    v_add_f32 v129, v129, v193
    v_add_f32 v130, v130, v162
    v_add_f32 v194, v194, v226
    v_add_f32 v130, v130, v194
    v_add_f32 v131, v131, v163
    v_add_f32 v195, v195, v227
    v_add_f32 v131, v131, v195
    v_and_b32 v11, 15, v2
    v_mul_u32_u24 v13, 14336, v11
    v_lshl_add_u32 v13, v10, 4, v13
    s_mul_i32 s38, s23, 229376
    s_lshl_b32 s39, s22, 8
    s_add_u32 s38, s38, s39
    s_add_u32 s38, s38, 10485760
    s_add_u32 s39, s38, 114688
    v_cmp_gt_u32 vcc, 8, v11
    s_nop 1
    s_mov_b64 exec, vcc
    buffer_store_dwordx4 v[100:103], v13, s[12:15], s38 offen offset:0
    buffer_store_dwordx4 v[104:107], v13, s[12:15], s38 offen offset:64
    buffer_store_dwordx4 v[108:111], v13, s[12:15], s38 offen offset:128
    buffer_store_dwordx4 v[112:115], v13, s[12:15], s38 offen offset:192
    buffer_store_dwordx4 v[116:119], v13, s[12:15], s39 offen offset:0
    buffer_store_dwordx4 v[120:123], v13, s[12:15], s39 offen offset:64
    buffer_store_dwordx4 v[124:127], v13, s[12:15], s39 offen offset:128
    buffer_store_dwordx4 v[128:131], v13, s[12:15], s39 offen offset:192
    s_branch L_k1s_end
L_k1s_noffn:
    s_barrier
    s_barrier
    s_barrier
    s_barrier
    s_barrier
    s_barrier
    s_barrier
    s_barrier
    s_barrier
    s_barrier
    s_barrier
    s_barrier
    s_barrier
    s_barrier
    s_and_b32 s38, s2, 1
    s_lshl_b32 s38, s38, 9
    s_lshr_b32 s39, s2, 3
    s_lshl_b32 s39, s39, 4
    s_add_u32 s38, s38, s39
    s_lshl_b32 s39, s18, 2
    s_add_u32 s38, s38, s39
    s_lshl_b32 s38, s38, 11
    v_lshl_add_u32 v60, v2, 7, s38
    global_load_dword v61, v60, s[48:49]
    global_load_dword v62, v60, s[50:51]
L_k1s_end:
    s_endpgm
.globl k2_kernel
.p2align 8
.type k2_kernel,@function
k2_kernel:
    v_lshrrev_b32 v1, 6, v0
    s_cmp_ge_u32 s2, 256
    s_cbranch_scc1 L_k2_exit
    v_readfirstlane_b32 s18, v1
    s_nop 1
    s_cmp_ge_u32 s18, 4
    s_cbranch_scc0 L_k2_gemm
    s_branch L_k2_side
L_k2_exit:
    s_endpgm
L_k2_gemm:
    s_load_dwordx2 s[28:29], s[0:1], 0
    s_load_dwordx4 s[32:35], s[0:1], 40
    s_load_dwordx2 s[36:37], s[0:1], 64
    s_load_dwordx2 s[30:31], s[0:1], 120
    s_load_dwordx4 s[40:43], s[0:1], 128
    v_lshrrev_b32 v26, 6, v0
    v_and_b32 v22, 63, v0
    v_readfirstlane_b32 s18, v26
    s_and_b32 s3, s2, 7
    s_lshr_b32 s38, s2, 3
    s_lshr_b32 s16, s3, 1
    s_lshl_b32 s16, s16, 2
    s_and_b32 s39, s38, 3
    s_add_u32 s16, s16, s39
    s_and_b32 s17, s3, 1
    s_lshl_b32 s17, s17, 3
    s_mul_i32 s19, s3, 8
    s_lshr_b32 s39, s38, 2
    s_add_u32 s17, s17, s39
    s_mul_i32 s39, s16, 0
    s_add_u32 s19, s19, s39
    s_mul_i32 s39, s17, 0
    s_add_u32 s19, s19, s39
    v_lshrrev_b32 v23, 5, v22
    v_lshrrev_b32 v26, 3, v22
    v_and_b32 v27, 7, v22
    v_lshrrev_b32 v28, 1, v26
    v_xor_b32 v27, v27, v28
    v_lshlrev_b32 v27, 4, v27
    s_lshl_b32 s38, s17, 6
    s_and_b32 s39, s18, 1
    s_lshl_b32 s39, s39, 5
    s_add_u32 s38, s38, s39
    v_add_u32 v28, s38, v26
    v_lshl_add_u32 v28, v28, 11, v27
    v_add_u32 v8, 3072, v28
    v_xor_b32 v29, 64, v28
    v_add_u32 v9, 18432, v29
    v_add_u32 v10, 33792, v28
    v_xor_b32 v29, 64, v28
    v_add_u32 v11, 49152, v29
    v_lshlrev_b32 v20, 4, v22
    v_add_u32 v21, 4096, v20
    s_lshl_b32 s20, s16, 19
    s_lshl_b32 s38, s18, 13
    s_add_u32 s20, s20, s38
    s_lshl_b32 s44, s18, 12
    s_waitcnt lgkmcnt(0)
    s_cmp_lt_u32 s18, 2
    s_cselect_b32 s4, s32, s34
    s_cselect_b32 s5, s33, s35
    s_sub_u32 s4, s4, 3072
    s_subb_u32 s5, s5, 0
    s_mov_b32 s6, 2100224
    s_mov_b32 s7, 0x20000
    s_mov_b32 s12, s42
    s_mov_b32 s13, s43
    s_mov_b32 s14, 16777216
    s_mov_b32 s15, 0x20000
    s_mov_b32 s8, s28
    s_mov_b32 s9, s29
    s_mov_b32 s10, 4194304
    s_mov_b32 s11, 0x20000
    s_mov_b32 s24, s30
    s_mov_b32 s25, s31
    s_mov_b32 s26, 8388608
    s_mov_b32 s27, 0x20000
    s_add_u32 s46, s42, 9461760
    s_addc_u32 s47, s43, 0
    s_load_dwordx8 s[48:55], s[46:47], 0
    s_add_u32 m0, s44, 0
    s_add_u32 s21, s19, 0
    s_and_b32 s21, s21, 15
    s_lshl_b32 s21, s21, 7
    buffer_load_dwordx4 v8, s[4:7], s21 offen offset:0 lds
    buffer_load_dwordx4 v9, s[4:7], s21 offen offset:1024 lds
    buffer_load_dwordx4 v10, s[4:7], s21 offen offset:2048 lds
    buffer_load_dwordx4 v11, s[4:7], s21 offen offset:3072 lds
    s_add_u32 s22, s19, 0
    s_and_b32 s22, s22, 15
    s_lshl_b32 s22, s22, 15
    s_add_u32 s22, s22, s20
    buffer_load_dwordx4 v[160:163], v20, s[12:15], s22 offen offset:0
    buffer_load_dwordx4 v[164:167], v20, s[12:15], s22 offen offset:1024
    buffer_load_dwordx4 v[168:171], v20, s[12:15], s22 offen offset:2048
    buffer_load_dwordx4 v[172:175], v20, s[12:15], s22 offen offset:3072
    buffer_load_dwordx4 v[176:179], v21, s[12:15], s22 offen offset:0
    buffer_load_dwordx4 v[180:183], v21, s[12:15], s22 offen offset:1024
    buffer_load_dwordx4 v[184:187], v21, s[12:15], s22 offen offset:2048
    buffer_load_dwordx4 v[188:191], v21, s[12:15], s22 offen offset:3072
    s_add_u32 m0, s44, 16384
    s_add_u32 s21, s19, 1
    s_and_b32 s21, s21, 15
    s_lshl_b32 s21, s21, 7
    buffer_load_dwordx4 v8, s[4:7], s21 offen offset:0 lds
    buffer_load_dwordx4 v9, s[4:7], s21 offen offset:1024 lds
    buffer_load_dwordx4 v10, s[4:7], s21 offen offset:2048 lds
    buffer_load_dwordx4 v11, s[4:7], s21 offen offset:3072 lds
    s_add_u32 s22, s19, 1
    s_and_b32 s22, s22, 15
    s_lshl_b32 s22, s22, 15
    s_add_u32 s22, s22, s20
    buffer_load_dwordx4 v[192:195], v20, s[12:15], s22 offen offset:0
    buffer_load_dwordx4 v[196:199], v20, s[12:15], s22 offen offset:1024
    buffer_load_dwordx4 v[200:203], v20, s[12:15], s22 offen offset:2048
    buffer_load_dwordx4 v[204:207], v20, s[12:15], s22 offen offset:3072
    buffer_load_dwordx4 v[208:211], v21, s[12:15], s22 offen offset:0
    buffer_load_dwordx4 v[212:215], v21, s[12:15], s22 offen offset:1024
    buffer_load_dwordx4 v[216:219], v21, s[12:15], s22 offen offset:2048
    buffer_load_dwordx4 v[220:223], v21, s[12:15], s22 offen offset:3072
    v_lshrrev_b32 v28, 4, v22
    v_and_b32 v29, 15, v22
    v_lshlrev_b32 v30, 11, v28
    v_lshl_add_u32 v30, v29, 3, v30
    v_lshlrev_b32 v31, 2, v28
    s_lshl_b32 s45, s16, 7
    s_lshl_b32 s38, s18, 5
    s_add_u32 s45, s45, s38
    s_lshl_b32 s38, s45, 11
    s_lshl_b32 s39, s17, 7
    s_add_u32 s38, s38, s39
    buffer_load_dwordx2 v[40:41], v30, s[8:11], s38 offen
    s_add_u32 s38, s38, 8192
    buffer_load_dwordx2 v[42:43], v30, s[8:11], s38 offen
    s_add_u32 s38, s38, 8192
    buffer_load_dwordx2 v[44:45], v30, s[8:11], s38 offen
    s_add_u32 s38, s38, 8192
    buffer_load_dwordx2 v[46:47], v30, s[8:11], s38 offen
    s_add_u32 s38, s38, 8192
    buffer_load_dwordx2 v[48:49], v30, s[8:11], s38 offen
    s_add_u32 s38, s38, 8192
    buffer_load_dwordx2 v[50:51], v30, s[8:11], s38 offen
    s_add_u32 s38, s38, 8192
    buffer_load_dwordx2 v[52:53], v30, s[8:11], s38 offen
    s_add_u32 s38, s38, 8192
    buffer_load_dwordx2 v[54:55], v30, s[8:11], s38 offen
    s_add_u32 s38, s38, 8192
    s_lshl_b32 s38, s45, 2
    s_add_u32 s38, s38, 9453568
    buffer_load_dword v56, v31, s[12:15], s38 offen offset:0
    buffer_load_dword v57, v31, s[12:15], s38 offen offset:16
    buffer_load_dword v58, v31, s[12:15], s38 offen offset:32
    buffer_load_dword v59, v31, s[12:15], s38 offen offset:48
    buffer_load_dword v60, v31, s[12:15], s38 offen offset:64
    buffer_load_dword v61, v31, s[12:15], s38 offen offset:80
    buffer_load_dword v62, v31, s[12:15], s38 offen offset:96
    buffer_load_dword v63, v31, s[12:15], s38 offen offset:112
    v_and_b32 v32, 31, v22
    v_lshlrev_b32 v32, 2, v32
    buffer_load_dword v24, v32, s[12:15], s38 offen
    v_lshl_add_u32 v32, v29, 3, s39
    global_load_dwordx2 v[156:157], v32, s[36:37]
    s_add_u32 m0, s44, 32768
    s_add_u32 s21, s19, 2
    s_and_b32 s21, s21, 15
    s_lshl_b32 s21, s21, 7
    buffer_load_dwordx4 v8, s[4:7], s21 offen offset:0 lds
    buffer_load_dwordx4 v9, s[4:7], s21 offen offset:1024 lds
    buffer_load_dwordx4 v10, s[4:7], s21 offen offset:2048 lds
    buffer_load_dwordx4 v11, s[4:7], s21 offen offset:3072 lds
    s_add_u32 m0, s44, 49152
    s_add_u32 s21, s19, 3
    s_and_b32 s21, s21, 15
    s_lshl_b32 s21, s21, 7
    buffer_load_dwordx4 v8, s[4:7], s21 offen offset:0 lds
    buffer_load_dwordx4 v9, s[4:7], s21 offen offset:1024 lds
    buffer_load_dwordx4 v10, s[4:7], s21 offen offset:2048 lds
    buffer_load_dwordx4 v11, s[4:7], s21 offen offset:3072 lds
    v_and_b32 v28, 31, v22
    v_bfe_u32 v29, v22, 1, 3
    v_xor_b32 v29, v29, v23
    v_lshlrev_b32 v29, 4, v29
    v_lshl_add_u32 v29, v28, 7, v29
    v_xor_b32 v12, 0, v29
    v_add_u32 v16, 0x10000, v12
    v_xor_b32 v13, 32, v29
    v_add_u32 v17, 0x10000, v13
    v_xor_b32 v14, 64, v29
    v_add_u32 v18, 0x10000, v14
    v_xor_b32 v15, 96, v29
    v_add_u32 v19, 0x10000, v15
    s_mov_b32 s23, 0xffff0000
    s_waitcnt vmcnt(46) lgkmcnt(0)
    s_barrier
    ds_read_b128 v[96:99], v12 offset:0
    ds_read_b128 v[100:103], v12 offset:4096
    ds_read_b128 v[104:107], v13 offset:0
    ds_read_b128 v[108:111], v13 offset:4096
    ds_read_b128 v[112:115], v14 offset:0
    ds_read_b128 v[116:119], v14 offset:4096
    s_waitcnt vmcnt(45) lgkmcnt(4)
    v_mfma_f32_32x32x16_bf16 v[64:79], v[96:99], v[160:163], 0
    v_mfma_f32_32x32x16_bf16 v[80:95], v[100:103], v[160:163], 0
    s_add_u32 s22, s19, 2
    s_and_b32 s22, s22, 15
    s_lshl_b32 s22, s22, 15
    s_add_u32 s22, s22, s20
    buffer_load_dwordx4 v[160:163], v20, s[12:15], s22 offen offset:0
    s_add_u32 m0, s44, 65536
    s_add_u32 s21, s19, 4
    s_and_b32 s21, s21, 15
    s_lshl_b32 s21, s21, 7
    buffer_load_dwordx4 v8, s[4:7], s21 offen offset:0 lds
    buffer_load_dwordx4 v9, s[4:7], s21 offen offset:1024 lds
    ds_read_b128 v[96:99], v15 offset:0
    ds_read_b128 v[100:103], v15 offset:4096
    s_waitcnt vmcnt(47) lgkmcnt(4)
    v_mfma_f32_32x32x16_bf16 v[64:79], v[104:107], v[164:167], v[64:79]
    v_mfma_f32_32x32x16_bf16 v[80:95], v[108:111], v[164:167], v[80:95]
    buffer_load_dwordx4 v[164:167], v20, s[12:15], s22 offen offset:1024
    ds_read_b128 v[104:107], v12 offset:8192
    ds_read_b128 v[108:111], v12 offset:12288
    s_waitcnt vmcnt(47) lgkmcnt(4)
    v_mfma_f32_32x32x16_bf16 v[64:79], v[112:115], v[168:171], v[64:79]
    v_mfma_f32_32x32x16_bf16 v[80:95], v[116:119], v[168:171], v[80:95]
    buffer_load_dwordx4 v[168:171], v20, s[12:15], s22 offen offset:2048
    buffer_load_dwordx4 v10, s[4:7], s21 offen offset:2048 lds
    ds_read_b128 v[112:115], v13 offset:8192
    ds_read_b128 v[116:119], v13 offset:12288
    s_waitcnt vmcnt(48) lgkmcnt(4)
    v_mfma_f32_32x32x16_bf16 v[64:79], v[96:99], v[172:175], v[64:79]
    v_mfma_f32_32x32x16_bf16 v[80:95], v[100:103], v[172:175], v[80:95]
    buffer_load_dwordx4 v[172:175], v20, s[12:15], s22 offen offset:3072
    ds_read_b128 v[96:99], v14 offset:8192
    ds_read_b128 v[100:103], v14 offset:12288
    s_waitcnt vmcnt(48) lgkmcnt(4)
    v_mfma_f32_32x32x16_bf16 v[64:79], v[104:107], v[176:179], v[64:79]
    v_mfma_f32_32x32x16_bf16 v[80:95], v[108:111], v[176:179], v[80:95]
    buffer_load_dwordx4 v[176:179], v21, s[12:15], s22 offen offset:0
    buffer_load_dwordx4 v11, s[4:7], s21 offen offset:3072 lds
    ds_read_b128 v[104:107], v15 offset:8192
    ds_read_b128 v[108:111], v15 offset:12288
    s_waitcnt vmcnt(49) lgkmcnt(4)
    v_mfma_f32_32x32x16_bf16 v[64:79], v[112:115], v[180:183], v[64:79]
    v_mfma_f32_32x32x16_bf16 v[80:95], v[116:119], v[180:183], v[80:95]
    buffer_load_dwordx4 v[180:183], v21, s[12:15], s22 offen offset:1024
    s_waitcnt vmcnt(44) lgkmcnt(0)
    s_barrier
    ds_read_b128 v[112:115], v12 offset:16384
    ds_read_b128 v[116:119], v12 offset:20480
    s_waitcnt vmcnt(49) lgkmcnt(4)
    v_mfma_f32_32x32x16_bf16 v[64:79], v[96:99], v[184:187], v[64:79]
    v_mfma_f32_32x32x16_bf16 v[80:95], v[100:103], v[184:187], v[80:95]
    buffer_load_dwordx4 v[184:187], v21, s[12:15], s22 offen offset:2048
    s_add_u32 m0, s44, 0
    s_add_u32 s21, s19, 5
    s_and_b32 s21, s21, 15
    s_lshl_b32 s21, s21, 7
    buffer_load_dwordx4 v8, s[4:7], s21 offen offset:0 lds
    ds_read_b128 v[96:99], v13 offset:16384
    ds_read_b128 v[100:103], v13 offset:20480
    s_waitcnt vmcnt(50) lgkmcnt(4)
    v_mfma_f32_32x32x16_bf16 v[64:79], v[104:107], v[188:191], v[64:79]
    v_mfma_f32_32x32x16_bf16 v[80:95], v[108:111], v[188:191], v[80:95]
    buffer_load_dwordx4 v[188:191], v21, s[12:15], s22 offen offset:3072
    ds_read_b128 v[104:107], v14 offset:16384
    ds_read_b128 v[108:111], v14 offset:20480
    s_waitcnt vmcnt(46) lgkmcnt(4)
    v_mfma_f32_32x32x16_bf16 v[64:79], v[112:115], v[192:195], v[64:79]
    v_mfma_f32_32x32x16_bf16 v[80:95], v[116:119], v[192:195], v[80:95]
    s_add_u32 s22, s19, 3
    s_and_b32 s22, s22, 15
    s_lshl_b32 s22, s22, 15
    s_add_u32 s22, s22, s20
    buffer_load_dwordx4 v[192:195], v20, s[12:15], s22 offen offset:0
    buffer_load_dwordx4 v9, s[4:7], s21 offen offset:1024 lds
    ds_read_b128 v[112:115], v15 offset:16384
    ds_read_b128 v[116:119], v15 offset:20480
    s_waitcnt vmcnt(47) lgkmcnt(4)
    v_mfma_f32_32x32x16_bf16 v[64:79], v[96:99], v[196:199], v[64:79]
    v_mfma_f32_32x32x16_bf16 v[80:95], v[100:103], v[196:199], v[80:95]
    buffer_load_dwordx4 v[196:199], v20, s[12:15], s22 offen offset:1024
    ds_read_b128 v[96:99], v12 offset:24576
    ds_read_b128 v[100:103], v12 offset:28672
    s_waitcnt vmcnt(47) lgkmcnt(4)
    v_mfma_f32_32x32x16_bf16 v[64:79], v[104:107], v[200:203], v[64:79]
    v_mfma_f32_32x32x16_bf16 v[80:95], v[108:111], v[200:203], v[80:95]
    buffer_load_dwordx4 v[200:203], v20, s[12:15], s22 offen offset:2048
    buffer_load_dwordx4 v10, s[4:7], s21 offen offset:2048 lds
    ds_read_b128 v[104:107], v13 offset:24576
    ds_read_b128 v[108:111], v13 offset:28672
    s_waitcnt vmcnt(48) lgkmcnt(4)
    v_mfma_f32_32x32x16_bf16 v[64:79], v[112:115], v[204:207], v[64:79]
    v_mfma_f32_32x32x16_bf16 v[80:95], v[116:119], v[204:207], v[80:95]
    buffer_load_dwordx4 v[204:207], v20, s[12:15], s22 offen offset:3072
    ds_read_b128 v[112:115], v14 offset:24576
    ds_read_b128 v[116:119], v14 offset:28672
    s_waitcnt vmcnt(48) lgkmcnt(4)
    v_mfma_f32_32x32x16_bf16 v[64:79], v[96:99], v[208:211], v[64:79]
    v_mfma_f32_32x32x16_bf16 v[80:95], v[100:103], v[208:211], v[80:95]
    buffer_load_dwordx4 v[208:211], v21, s[12:15], s22 offen offset:0
    buffer_load_dwordx4 v11, s[4:7], s21 offen offset:3072 lds
    ds_read_b128 v[96:99], v15 offset:24576
    ds_read_b128 v[100:103], v15 offset:28672
    s_waitcnt vmcnt(49) lgkmcnt(4)
    v_mfma_f32_32x32x16_bf16 v[64:79], v[104:107], v[212:215], v[64:79]
    v_mfma_f32_32x32x16_bf16 v[80:95], v[108:111], v[212:215], v[80:95]
    buffer_load_dwordx4 v[212:215], v21, s[12:15], s22 offen offset:1024
    s_waitcnt vmcnt(26) lgkmcnt(0)
    s_barrier
    ds_read_b128 v[104:107], v12 offset:32768
    ds_read_b128 v[108:111], v12 offset:36864
    s_waitcnt vmcnt(49) lgkmcnt(4)
    v_mfma_f32_32x32x16_bf16 v[64:79], v[112:115], v[216:219], v[64:79]
    v_mfma_f32_32x32x16_bf16 v[80:95], v[116:119], v[216:219], v[80:95]
    buffer_load_dwordx4 v[216:219], v21, s[12:15], s22 offen offset:2048
    s_add_u32 m0, s44, 16384
    s_add_u32 s21, s19, 6
    s_and_b32 s21, s21, 15
    s_lshl_b32 s21, s21, 7
    buffer_load_dwordx4 v8, s[4:7], s21 offen offset:0 lds
    ds_read_b128 v[112:115], v13 offset:32768
    ds_read_b128 v[116:119], v13 offset:36864
    s_waitcnt vmcnt(50) lgkmcnt(4)
    v_mfma_f32_32x32x16_bf16 v[64:79], v[96:99], v[220:223], v[64:79]
    v_mfma_f32_32x32x16_bf16 v[80:95], v[100:103], v[220:223], v[80:95]
    buffer_load_dwordx4 v[220:223], v21, s[12:15], s22 offen offset:3072
    ds_read_b128 v[96:99], v14 offset:32768
    ds_read_b128 v[100:103], v14 offset:36864
    s_waitcnt vmcnt(24) lgkmcnt(4)
    v_mfma_f32_32x32x16_bf16 v[64:79], v[104:107], v[160:163], v[64:79]
    v_mfma_f32_32x32x16_bf16 v[80:95], v[108:111], v[160:163], v[80:95]
    s_add_u32 s22, s19, 4
    s_and_b32 s22, s22, 15
    s_lshl_b32 s22, s22, 15
    s_add_u32 s22, s22, s20
    buffer_load_dwordx4 v[160:163], v20, s[12:15], s22 offen offset:0
    buffer_load_dwordx4 v9, s[4:7], s21 offen offset:1024 lds
    ds_read_b128 v[104:107], v15 offset:32768
    ds_read_b128 v[108:111], v15 offset:36864
    s_waitcnt vmcnt(23) lgkmcnt(4)
    v_mfma_f32_32x32x16_bf16 v[64:79], v[112:115], v[164:167], v[64:79]
    v_mfma_f32_32x32x16_bf16 v[80:95], v[116:119], v[164:167], v[80:95]
    buffer_load_dwordx4 v[164:167], v20, s[12:15], s22 offen offset:1024
    ds_read_b128 v[112:115], v12 offset:40960
    ds_read_b128 v[116:119], v12 offset:45056
    s_waitcnt vmcnt(23) lgkmcnt(4)
    v_mfma_f32_32x32x16_bf16 v[64:79], v[96:99], v[168:171], v[64:79]
    v_mfma_f32_32x32x16_bf16 v[80:95], v[100:103], v[168:171], v[80:95]
    buffer_load_dwordx4 v[168:171], v20, s[12:15], s22 offen offset:2048
    buffer_load_dwordx4 v10, s[4:7], s21 offen offset:2048 lds
    ds_read_b128 v[96:99], v13 offset:40960
    ds_read_b128 v[100:103], v13 offset:45056
    s_waitcnt vmcnt(23) lgkmcnt(4)
    v_mfma_f32_32x32x16_bf16 v[64:79], v[104:107], v[172:175], v[64:79]
    v_mfma_f32_32x32x16_bf16 v[80:95], v[108:111], v[172:175], v[80:95]
    buffer_load_dwordx4 v[172:175], v20, s[12:15], s22 offen offset:3072
    ds_read_b128 v[104:107], v14 offset:40960
    ds_read_b128 v[108:111], v14 offset:45056
    s_waitcnt vmcnt(23) lgkmcnt(4)
    v_mfma_f32_32x32x16_bf16 v[64:79], v[112:115], v[176:179], v[64:79]
    v_mfma_f32_32x32x16_bf16 v[80:95], v[116:119], v[176:179], v[80:95]
    buffer_load_dwordx4 v[176:179], v21, s[12:15], s22 offen offset:0
    buffer_load_dwordx4 v11, s[4:7], s21 offen offset:3072 lds
    ds_read_b128 v[112:115], v15 offset:40960
    ds_read_b128 v[116:119], v15 offset:45056
    s_waitcnt vmcnt(23) lgkmcnt(4)
    v_mfma_f32_32x32x16_bf16 v[64:79], v[96:99], v[180:183], v[64:79]
    v_mfma_f32_32x32x16_bf16 v[80:95], v[100:103], v[180:183], v[80:95]
    buffer_load_dwordx4 v[180:183], v21, s[12:15], s22 offen offset:1024
    s_waitcnt vmcnt(34) lgkmcnt(0)
    s_barrier
    ds_read_b128 v[96:99], v12 offset:49152
    ds_read_b128 v[100:103], v12 offset:53248
    s_waitcnt vmcnt(23) lgkmcnt(4)
    v_mfma_f32_32x32x16_bf16 v[64:79], v[104:107], v[184:187], v[64:79]
    v_mfma_f32_32x32x16_bf16 v[80:95], v[108:111], v[184:187], v[80:95]
    buffer_load_dwordx4 v[184:187], v21, s[12:15], s22 offen offset:2048
    s_add_u32 m0, s44, 32768
    s_add_u32 s21, s19, 7
    s_and_b32 s21, s21, 15
    s_lshl_b32 s21, s21, 7
    buffer_load_dwordx4 v8, s[4:7], s21 offen offset:0 lds
    ds_read_b128 v[104:107], v13 offset:49152
    ds_read_b128 v[108:111], v13 offset:53248
    s_waitcnt vmcnt(23) lgkmcnt(4)
    v_mfma_f32_32x32x16_bf16 v[64:79], v[112:115], v[188:191], v[64:79]
    v_mfma_f32_32x32x16_bf16 v[80:95], v[116:119], v[188:191], v[80:95]
    buffer_load_dwordx4 v[188:191], v21, s[12:15], s22 offen offset:3072
    ds_read_b128 v[112:115], v14 offset:49152
    ds_read_b128 v[116:119], v14 offset:53248
    s_waitcnt vmcnt(23) lgkmcnt(4)
    v_mfma_f32_32x32x16_bf16 v[64:79], v[96:99], v[192:195], v[64:79]
    v_mfma_f32_32x32x16_bf16 v[80:95], v[100:103], v[192:195], v[80:95]
    s_add_u32 s22, s19, 5
    s_and_b32 s22, s22, 15
    s_lshl_b32 s22, s22, 15
    s_add_u32 s22, s22, s20
    buffer_load_dwordx4 v[192:195], v20, s[12:15], s22 offen offset:0
    buffer_load_dwordx4 v9, s[4:7], s21 offen offset:1024 lds
    ds_read_b128 v[96:99], v15 offset:49152
    ds_read_b128 v[100:103], v15 offset:53248
    s_waitcnt vmcnt(23) lgkmcnt(4)
    v_mfma_f32_32x32x16_bf16 v[64:79], v[104:107], v[196:199], v[64:79]
    v_mfma_f32_32x32x16_bf16 v[80:95], v[108:111], v[196:199], v[80:95]
    buffer_load_dwordx4 v[196:199], v20, s[12:15], s22 offen offset:1024
    ds_read_b128 v[104:107], v12 offset:57344
    ds_read_b128 v[108:111], v12 offset:61440
    s_waitcnt vmcnt(23) lgkmcnt(4)
    v_mfma_f32_32x32x16_bf16 v[64:79], v[112:115], v[200:203], v[64:79]
    v_mfma_f32_32x32x16_bf16 v[80:95], v[116:119], v[200:203], v[80:95]
    buffer_load_dwordx4 v[200:203], v20, s[12:15], s22 offen offset:2048
    buffer_load_dwordx4 v10, s[4:7], s21 offen offset:2048 lds
    ds_read_b128 v[112:115], v13 offset:57344
    ds_read_b128 v[116:119], v13 offset:61440
    s_waitcnt vmcnt(23) lgkmcnt(4)
    v_mfma_f32_32x32x16_bf16 v[64:79], v[96:99], v[204:207], v[64:79]
    v_mfma_f32_32x32x16_bf16 v[80:95], v[100:103], v[204:207], v[80:95]
    buffer_load_dwordx4 v[204:207], v20, s[12:15], s22 offen offset:3072
    ds_read_b128 v[96:99], v14 offset:57344
    ds_read_b128 v[100:103], v14 offset:61440
    s_waitcnt vmcnt(23) lgkmcnt(4)
    v_mfma_f32_32x32x16_bf16 v[64:79], v[104:107], v[208:211], v[64:79]
    v_mfma_f32_32x32x16_bf16 v[80:95], v[108:111], v[208:211], v[80:95]
    buffer_load_dwordx4 v[208:211], v21, s[12:15], s22 offen offset:0
    buffer_load_dwordx4 v11, s[4:7], s21 offen offset:3072 lds
    ds_read_b128 v[104:107], v15 offset:57344
    ds_read_b128 v[108:111], v15 offset:61440
    s_waitcnt vmcnt(23) lgkmcnt(4)
    v_mfma_f32_32x32x16_bf16 v[64:79], v[112:115], v[212:215], v[64:79]
    v_mfma_f32_32x32x16_bf16 v[80:95], v[116:119], v[212:215], v[80:95]
    buffer_load_dwordx4 v[212:215], v21, s[12:15], s22 offen offset:1024
    s_waitcnt vmcnt(37) lgkmcnt(0)
    s_barrier
    ds_read_b128 v[112:115], v16 offset:0
    ds_read_b128 v[116:119], v16 offset:4096
    s_waitcnt vmcnt(23) lgkmcnt(4)
    v_mfma_f32_32x32x16_bf16 v[64:79], v[96:99], v[216:219], v[64:79]
    v_mfma_f32_32x32x16_bf16 v[80:95], v[100:103], v[216:219], v[80:95]
    buffer_load_dwordx4 v[216:219], v21, s[12:15], s22 offen offset:2048
    s_add_u32 m0, s44, 49152
    s_add_u32 s21, s19, 8
    s_and_b32 s21, s21, 15
    s_lshl_b32 s21, s21, 7
    buffer_load_dwordx4 v8, s[4:7], s21 offen offset:0 lds
    ds_read_b128 v[96:99], v17 offset:0
    ds_read_b128 v[100:103], v17 offset:4096
    s_waitcnt vmcnt(23) lgkmcnt(4)
    v_mfma_f32_32x32x16_bf16 v[64:79], v[104:107], v[220:223], v[64:79]
    v_mfma_f32_32x32x16_bf16 v[80:95], v[108:111], v[220:223], v[80:95]
    buffer_load_dwordx4 v[220:223], v21, s[12:15], s22 offen offset:3072
    ds_read_b128 v[104:107], v18 offset:0
    ds_read_b128 v[108:111], v18 offset:4096
    s_waitcnt vmcnt(23) lgkmcnt(4)
    v_mfma_f32_32x32x16_bf16 v[64:79], v[112:115], v[160:163], v[64:79]
    v_mfma_f32_32x32x16_bf16 v[80:95], v[116:119], v[160:163], v[80:95]
    s_add_u32 s22, s19, 6
    s_and_b32 s22, s22, 15
    s_lshl_b32 s22, s22, 15
    s_add_u32 s22, s22, s20
    buffer_load_dwordx4 v[160:163], v20, s[12:15], s22 offen offset:0
    buffer_load_dwordx4 v9, s[4:7], s21 offen offset:1024 lds
    ds_read_b128 v[112:115], v19 offset:0
    ds_read_b128 v[116:119], v19 offset:4096
    s_waitcnt vmcnt(23) lgkmcnt(4)
    v_mfma_f32_32x32x16_bf16 v[64:79], v[96:99], v[164:167], v[64:79]
    v_mfma_f32_32x32x16_bf16 v[80:95], v[100:103], v[164:167], v[80:95]
    buffer_load_dwordx4 v[164:167], v20, s[12:15], s22 offen offset:1024
    ds_read_b128 v[96:99], v16 offset:8192
    ds_read_b128 v[100:103], v16 offset:12288
    s_waitcnt vmcnt(23) lgkmcnt(4)
    v_mfma_f32_32x32x16_bf16 v[64:79], v[104:107], v[168:171], v[64:79]
    v_mfma_f32_32x32x16_bf16 v[80:95], v[108:111], v[168:171], v[80:95]
    buffer_load_dwordx4 v[168:171], v20, s[12:15], s22 offen offset:2048
    buffer_load_dwordx4 v10, s[4:7], s21 offen offset:2048 lds
    ds_read_b128 v[104:107], v17 offset:8192
    ds_read_b128 v[108:111], v17 offset:12288
    s_waitcnt vmcnt(23) lgkmcnt(4)
    v_mfma_f32_32x32x16_bf16 v[64:79], v[112:115], v[172:175], v[64:79]
    v_mfma_f32_32x32x16_bf16 v[80:95], v[116:119], v[172:175], v[80:95]
    buffer_load_dwordx4 v[172:175], v20, s[12:15], s22 offen offset:3072
    ds_read_b128 v[112:115], v18 offset:8192
    ds_read_b128 v[116:119], v18 offset:12288
    s_waitcnt vmcnt(23) lgkmcnt(4)
    v_mfma_f32_32x32x16_bf16 v[64:79], v[96:99], v[176:179], v[64:79]
    v_mfma_f32_32x32x16_bf16 v[80:95], v[100:103], v[176:179], v[80:95]
    buffer_load_dwordx4 v[176:179], v21, s[12:15], s22 offen offset:0
    buffer_load_dwordx4 v11, s[4:7], s21 offen offset:3072 lds
    ds_read_b128 v[96:99], v19 offset:8192
    ds_read_b128 v[100:103], v19 offset:12288
    s_waitcnt vmcnt(23) lgkmcnt(4)
    v_mfma_f32_32x32x16_bf16 v[64:79], v[104:107], v[180:183], v[64:79]
    v_mfma_f32_32x32x16_bf16 v[80:95], v[108:111], v[180:183], v[80:95]
    buffer_load_dwordx4 v[180:183], v21, s[12:15], s22 offen offset:1024
    s_waitcnt vmcnt(37) lgkmcnt(0)
    s_barrier
    ds_read_b128 v[104:107], v12 offset:0
    ds_read_b128 v[108:111], v12 offset:4096
    s_waitcnt vmcnt(23) lgkmcnt(4)
    v_mfma_f32_32x32x16_bf16 v[64:79], v[112:115], v[184:187], v[64:79]
    v_mfma_f32_32x32x16_bf16 v[80:95], v[116:119], v[184:187], v[80:95]
    buffer_load_dwordx4 v[184:187], v21, s[12:15], s22 offen offset:2048
    s_add_u32 m0, s44, 65536
    s_add_u32 s21, s19, 9
    s_and_b32 s21, s21, 15
    s_lshl_b32 s21, s21, 7
    buffer_load_dwordx4 v8, s[4:7], s21 offen offset:0 lds
    ds_read_b128 v[112:115], v13 offset:0
    ds_read_b128 v[116:119], v13 offset:4096
    s_waitcnt vmcnt(23) lgkmcnt(4)
    v_mfma_f32_32x32x16_bf16 v[64:79], v[96:99], v[188:191], v[64:79]
    v_mfma_f32_32x32x16_bf16 v[80:95], v[100:103], v[188:191], v[80:95]
    buffer_load_dwordx4 v[188:191], v21, s[12:15], s22 offen offset:3072
    ds_read_b128 v[96:99], v14 offset:0
    ds_read_b128 v[100:103], v14 offset:4096
    s_waitcnt vmcnt(23) lgkmcnt(4)
    v_mfma_f32_32x32x16_bf16 v[64:79], v[104:107], v[192:195], v[64:79]
    v_mfma_f32_32x32x16_bf16 v[80:95], v[108:111], v[192:195], v[80:95]
    s_add_u32 s22, s19, 7
    s_and_b32 s22, s22, 15
    s_lshl_b32 s22, s22, 15
    s_add_u32 s22, s22, s20
    buffer_load_dwordx4 v[192:195], v20, s[12:15], s22 offen offset:0
    buffer_load_dwordx4 v9, s[4:7], s21 offen offset:1024 lds
    v_lshlrev_b32 v152, 16, v156
    v_and_b32 v153, s23, v156
    v_lshlrev_b32 v154, 16, v157
    v_and_b32 v155, s23, v157
    ds_read_b128 v[104:107], v15 offset:0
    ds_read_b128 v[108:111], v15 offset:4096
    s_waitcnt vmcnt(23) lgkmcnt(4)
    v_mfma_f32_32x32x16_bf16 v[64:79], v[112:115], v[196:199], v[64:79]
    v_mfma_f32_32x32x16_bf16 v[80:95], v[116:119], v[196:199], v[80:95]
    buffer_load_dwordx4 v[196:199], v20, s[12:15], s22 offen offset:1024
    v_sub_f32 v30, 1.0, v56
    v_cvt_pk_bf16_f32 v30, v30, v30
    v_lshlrev_b32 v30, 16, v30
    v_lshlrev_b32 v26, 16, v40
    ds_read_b128 v[112:115], v12 offset:8192
    ds_read_b128 v[116:119], v12 offset:12288
    s_waitcnt vmcnt(23) lgkmcnt(4)
    v_mfma_f32_32x32x16_bf16 v[64:79], v[96:99], v[200:203], v[64:79]
    v_mfma_f32_32x32x16_bf16 v[80:95], v[100:103], v[200:203], v[80:95]
    buffer_load_dwordx4 v[200:203], v20, s[12:15], s22 offen offset:2048
    buffer_load_dwordx4 v10, s[4:7], s21 offen offset:2048 lds
    v_and_b32 v27, s23, v40
    v_mul_f32 v28, v26, v152
    v_mul_f32 v29, v27, v153
    v_cvt_pk_bf16_f32 v28, v28, v29
    ds_read_b128 v[96:99], v13 offset:8192
    ds_read_b128 v[100:103], v13 offset:12288
    s_waitcnt vmcnt(23) lgkmcnt(4)
    v_mfma_f32_32x32x16_bf16 v[64:79], v[104:107], v[204:207], v[64:79]
    v_mfma_f32_32x32x16_bf16 v[80:95], v[108:111], v[204:207], v[80:95]
    buffer_load_dwordx4 v[204:207], v20, s[12:15], s22 offen offset:3072
    v_mul_f32 v26, v26, v30
    v_mul_f32 v27, v27, v30
    v_cvt_pk_bf16_f32 v26, v26, v27
    v_and_b32 v29, s23, v28
    ds_read_b128 v[104:107], v14 offset:8192
    ds_read_b128 v[108:111], v14 offset:12288
    s_waitcnt vmcnt(23) lgkmcnt(4)
    v_mfma_f32_32x32x16_bf16 v[64:79], v[112:115], v[208:211], v[64:79]
    v_mfma_f32_32x32x16_bf16 v[80:95], v[116:119], v[208:211], v[80:95]
    buffer_load_dwordx4 v[208:211], v21, s[12:15], s22 offen offset:0
    buffer_load_dwordx4 v11, s[4:7], s21 offen offset:3072 lds
    v_lshlrev_b32 v28, 16, v28
    v_and_b32 v27, s23, v26
    v_lshlrev_b32 v26, 16, v26
    v_fma_f32 v120, v56, v28, v26
    ds_read_b128 v[112:115], v15 offset:8192
    ds_read_b128 v[116:119], v15 offset:12288
    s_waitcnt vmcnt(23) lgkmcnt(4)
    v_mfma_f32_32x32x16_bf16 v[64:79], v[96:99], v[212:215], v[64:79]
    v_mfma_f32_32x32x16_bf16 v[80:95], v[100:103], v[212:215], v[80:95]
    buffer_load_dwordx4 v[212:215], v21, s[12:15], s22 offen offset:1024
    v_fma_f32 v121, v56, v29, v27
    v_lshlrev_b32 v26, 16, v41
    v_and_b32 v27, s23, v41
    v_mul_f32 v28, v26, v154
    s_waitcnt vmcnt(37) lgkmcnt(0)
    s_barrier
    ds_read_b128 v[96:99], v12 offset:16384
    ds_read_b128 v[100:103], v12 offset:20480
    s_waitcnt vmcnt(23) lgkmcnt(4)
    v_mfma_f32_32x32x16_bf16 v[64:79], v[104:107], v[216:219], v[64:79]
    v_mfma_f32_32x32x16_bf16 v[80:95], v[108:111], v[216:219], v[80:95]
    buffer_load_dwordx4 v[216:219], v21, s[12:15], s22 offen offset:2048
    s_add_u32 m0, s44, 0
    s_add_u32 s21, s19, 10
    s_and_b32 s21, s21, 15
    s_lshl_b32 s21, s21, 7
    buffer_load_dwordx4 v8, s[4:7], s21 offen offset:0 lds
    v_mul_f32 v29, v27, v155
    v_cvt_pk_bf16_f32 v28, v28, v29
    v_mul_f32 v26, v26, v30
    v_mul_f32 v27, v27, v30
    ds_read_b128 v[104:107], v13 offset:16384
    ds_read_b128 v[108:111], v13 offset:20480
    s_waitcnt vmcnt(23) lgkmcnt(4)
    v_mfma_f32_32x32x16_bf16 v[64:79], v[112:115], v[220:223], v[64:79]
    v_mfma_f32_32x32x16_bf16 v[80:95], v[116:119], v[220:223], v[80:95]
    buffer_load_dwordx4 v[220:223], v21, s[12:15], s22 offen offset:3072
    v_cvt_pk_bf16_f32 v26, v26, v27
    v_and_b32 v29, s23, v28
    v_lshlrev_b32 v28, 16, v28
    v_and_b32 v27, s23, v26
    ds_read_b128 v[112:115], v14 offset:16384
    ds_read_b128 v[116:119], v14 offset:20480
    s_waitcnt vmcnt(23) lgkmcnt(4)
    v_mfma_f32_32x32x16_bf16 v[64:79], v[96:99], v[160:163], v[64:79]
    v_mfma_f32_32x32x16_bf16 v[80:95], v[100:103], v[160:163], v[80:95]
    s_add_u32 s22, s19, 8
    s_and_b32 s22, s22, 15
    s_lshl_b32 s22, s22, 15
    s_add_u32 s22, s22, s20
    buffer_load_dwordx4 v[160:163], v20, s[12:15], s22 offen offset:0
    buffer_load_dwordx4 v9, s[4:7], s21 offen offset:1024 lds
    v_lshlrev_b32 v26, 16, v26
    v_fma_f32 v122, v56, v28, v26
    v_fma_f32 v123, v56, v29, v27
    v_sub_f32 v30, 1.0, v57
    ds_read_b128 v[96:99], v15 offset:16384
    ds_read_b128 v[100:103], v15 offset:20480
    s_waitcnt vmcnt(23) lgkmcnt(4)
    v_mfma_f32_32x32x16_bf16 v[64:79], v[104:107], v[164:167], v[64:79]
    v_mfma_f32_32x32x16_bf16 v[80:95], v[108:111], v[164:167], v[80:95]
    buffer_load_dwordx4 v[164:167], v20, s[12:15], s22 offen offset:1024
    v_cvt_pk_bf16_f32 v30, v30, v30
    v_lshlrev_b32 v30, 16, v30
    v_lshlrev_b32 v26, 16, v42
    v_and_b32 v27, s23, v42
    ds_read_b128 v[104:107], v12 offset:24576
    ds_read_b128 v[108:111], v12 offset:28672
    s_waitcnt vmcnt(23) lgkmcnt(4)
    v_mfma_f32_32x32x16_bf16 v[64:79], v[112:115], v[168:171], v[64:79]
    v_mfma_f32_32x32x16_bf16 v[80:95], v[116:119], v[168:171], v[80:95]
    buffer_load_dwordx4 v[168:171], v20, s[12:15], s22 offen offset:2048
    buffer_load_dwordx4 v10, s[4:7], s21 offen offset:2048 lds
    v_mul_f32 v28, v26, v152
    v_mul_f32 v29, v27, v153
    v_cvt_pk_bf16_f32 v28, v28, v29
    v_mul_f32 v26, v26, v30
    ds_read_b128 v[112:115], v13 offset:24576
    ds_read_b128 v[116:119], v13 offset:28672
    s_waitcnt vmcnt(23) lgkmcnt(4)
    v_mfma_f32_32x32x16_bf16 v[64:79], v[96:99], v[172:175], v[64:79]
    v_mfma_f32_32x32x16_bf16 v[80:95], v[100:103], v[172:175], v[80:95]
    buffer_load_dwordx4 v[172:175], v20, s[12:15], s22 offen offset:3072
    v_mul_f32 v27, v27, v30
    v_cvt_pk_bf16_f32 v26, v26, v27
    v_and_b32 v29, s23, v28
    v_lshlrev_b32 v28, 16, v28
    ds_read_b128 v[96:99], v14 offset:24576
    ds_read_b128 v[100:103], v14 offset:28672
    s_waitcnt vmcnt(23) lgkmcnt(4)
    v_mfma_f32_32x32x16_bf16 v[64:79], v[104:107], v[176:179], v[64:79]
    v_mfma_f32_32x32x16_bf16 v[80:95], v[108:111], v[176:179], v[80:95]
    buffer_load_dwordx4 v[176:179], v21, s[12:15], s22 offen offset:0
    buffer_load_dwordx4 v11, s[4:7], s21 offen offset:3072 lds
    v_and_b32 v27, s23, v26
    v_lshlrev_b32 v26, 16, v26
    v_fma_f32 v124, v57, v28, v26
    v_fma_f32 v125, v57, v29, v27
    ds_read_b128 v[104:107], v15 offset:24576
    ds_read_b128 v[108:111], v15 offset:28672
    s_waitcnt vmcnt(23) lgkmcnt(4)
    v_mfma_f32_32x32x16_bf16 v[64:79], v[112:115], v[180:183], v[64:79]
    v_mfma_f32_32x32x16_bf16 v[80:95], v[116:119], v[180:183], v[80:95]
    buffer_load_dwordx4 v[180:183], v21, s[12:15], s22 offen offset:1024
    v_lshlrev_b32 v26, 16, v43
    v_and_b32 v27, s23, v43
    v_mul_f32 v28, v26, v154
    v_mul_f32 v29, v27, v155
    s_waitcnt vmcnt(37) lgkmcnt(0)
    s_barrier
    ds_read_b128 v[112:115], v12 offset:32768
    ds_read_b128 v[116:119], v12 offset:36864
    s_waitcnt vmcnt(23) lgkmcnt(4)
    v_mfma_f32_32x32x16_bf16 v[64:79], v[96:99], v[184:187], v[64:79]
    v_mfma_f32_32x32x16_bf16 v[80:95], v[100:103], v[184:187], v[80:95]
    buffer_load_dwordx4 v[184:187], v21, s[12:15], s22 offen offset:2048
    s_add_u32 m0, s44, 16384
    s_add_u32 s21, s19, 11
    s_and_b32 s21, s21, 15
    s_lshl_b32 s21, s21, 7
    buffer_load_dwordx4 v8, s[4:7], s21 offen offset:0 lds
    v_cvt_pk_bf16_f32 v28, v28, v29
    v_mul_f32 v26, v26, v30
    v_mul_f32 v27, v27, v30
    v_cvt_pk_bf16_f32 v26, v26, v27
    ds_read_b128 v[96:99], v13 offset:32768
    ds_read_b128 v[100:103], v13 offset:36864
    s_waitcnt vmcnt(23) lgkmcnt(4)
    v_mfma_f32_32x32x16_bf16 v[64:79], v[104:107], v[188:191], v[64:79]
    v_mfma_f32_32x32x16_bf16 v[80:95], v[108:111], v[188:191], v[80:95]
    buffer_load_dwordx4 v[188:191], v21, s[12:15], s22 offen offset:3072
    v_and_b32 v29, s23, v28
    v_lshlrev_b32 v28, 16, v28
    v_and_b32 v27, s23, v26
    v_lshlrev_b32 v26, 16, v26
    ds_read_b128 v[104:107], v14 offset:32768
    ds_read_b128 v[108:111], v14 offset:36864
    s_waitcnt vmcnt(23) lgkmcnt(4)
    v_mfma_f32_32x32x16_bf16 v[64:79], v[112:115], v[192:195], v[64:79]
    v_mfma_f32_32x32x16_bf16 v[80:95], v[116:119], v[192:195], v[80:95]
    s_add_u32 s22, s19, 9
    s_and_b32 s22, s22, 15
    s_lshl_b32 s22, s22, 15
    s_add_u32 s22, s22, s20
    buffer_load_dwordx4 v[192:195], v20, s[12:15], s22 offen offset:0
    buffer_load_dwordx4 v9, s[4:7], s21 offen offset:1024 lds
    v_fma_f32 v126, v57, v28, v26
    v_fma_f32 v127, v57, v29, v27
    v_sub_f32 v30, 1.0, v58
    v_cvt_pk_bf16_f32 v30, v30, v30
    ds_read_b128 v[112:115], v15 offset:32768
    ds_read_b128 v[116:119], v15 offset:36864
    s_waitcnt vmcnt(23) lgkmcnt(4)
    v_mfma_f32_32x32x16_bf16 v[64:79], v[96:99], v[196:199], v[64:79]
    v_mfma_f32_32x32x16_bf16 v[80:95], v[100:103], v[196:199], v[80:95]
    buffer_load_dwordx4 v[196:199], v20, s[12:15], s22 offen offset:1024
    v_lshlrev_b32 v30, 16, v30
    v_lshlrev_b32 v26, 16, v44
    v_and_b32 v27, s23, v44
    v_mul_f32 v28, v26, v152
    ds_read_b128 v[96:99], v12 offset:40960
    ds_read_b128 v[100:103], v12 offset:45056
    s_waitcnt vmcnt(23) lgkmcnt(4)
    v_mfma_f32_32x32x16_bf16 v[64:79], v[104:107], v[200:203], v[64:79]
    v_mfma_f32_32x32x16_bf16 v[80:95], v[108:111], v[200:203], v[80:95]
    buffer_load_dwordx4 v[200:203], v20, s[12:15], s22 offen offset:2048
    buffer_load_dwordx4 v10, s[4:7], s21 offen offset:2048 lds
    v_mul_f32 v29, v27, v153
    v_cvt_pk_bf16_f32 v28, v28, v29
    v_mul_f32 v26, v26, v30
    v_mul_f32 v27, v27, v30
    ds_read_b128 v[104:107], v13 offset:40960
    ds_read_b128 v[108:111], v13 offset:45056
    s_waitcnt vmcnt(23) lgkmcnt(4)
    v_mfma_f32_32x32x16_bf16 v[64:79], v[112:115], v[204:207], v[64:79]
    v_mfma_f32_32x32x16_bf16 v[80:95], v[116:119], v[204:207], v[80:95]
    buffer_load_dwordx4 v[204:207], v20, s[12:15], s22 offen offset:3072
    v_cvt_pk_bf16_f32 v26, v26, v27
    v_and_b32 v29, s23, v28
    v_lshlrev_b32 v28, 16, v28
    v_and_b32 v27, s23, v26
    ds_read_b128 v[112:115], v14 offset:40960
    ds_read_b128 v[116:119], v14 offset:45056
    s_waitcnt vmcnt(23) lgkmcnt(4)
    v_mfma_f32_32x32x16_bf16 v[64:79], v[96:99], v[208:211], v[64:79]
    v_mfma_f32_32x32x16_bf16 v[80:95], v[100:103], v[208:211], v[80:95]
    buffer_load_dwordx4 v[208:211], v21, s[12:15], s22 offen offset:0
    buffer_load_dwordx4 v11, s[4:7], s21 offen offset:3072 lds
    v_lshlrev_b32 v26, 16, v26
    v_fma_f32 v128, v58, v28, v26
    v_fma_f32 v129, v58, v29, v27
    v_lshlrev_b32 v26, 16, v45
    ds_read_b128 v[96:99], v15 offset:40960
    ds_read_b128 v[100:103], v15 offset:45056
    s_waitcnt vmcnt(23) lgkmcnt(4)
    v_mfma_f32_32x32x16_bf16 v[64:79], v[104:107], v[212:215], v[64:79]
    v_mfma_f32_32x32x16_bf16 v[80:95], v[108:111], v[212:215], v[80:95]
    buffer_load_dwordx4 v[212:215], v21, s[12:15], s22 offen offset:1024
    v_and_b32 v27, s23, v45
    v_mul_f32 v28, v26, v154
    v_mul_f32 v29, v27, v155
    v_cvt_pk_bf16_f32 v28, v28, v29
    s_waitcnt vmcnt(37) lgkmcnt(0)
    s_barrier
    ds_read_b128 v[104:107], v12 offset:49152
    ds_read_b128 v[108:111], v12 offset:53248
    s_waitcnt vmcnt(23) lgkmcnt(4)
    v_mfma_f32_32x32x16_bf16 v[64:79], v[112:115], v[216:219], v[64:79]
    v_mfma_f32_32x32x16_bf16 v[80:95], v[116:119], v[216:219], v[80:95]
    buffer_load_dwordx4 v[216:219], v21, s[12:15], s22 offen offset:2048
    s_add_u32 m0, s44, 32768
    s_add_u32 s21, s19, 12
    s_and_b32 s21, s21, 15
    s_lshl_b32 s21, s21, 7
    buffer_load_dwordx4 v8, s[4:7], s21 offen offset:0 lds
    v_mul_f32 v26, v26, v30
    v_mul_f32 v27, v27, v30
    v_cvt_pk_bf16_f32 v26, v26, v27
    v_and_b32 v29, s23, v28
    ds_read_b128 v[112:115], v13 offset:49152
    ds_read_b128 v[116:119], v13 offset:53248
    s_waitcnt vmcnt(23) lgkmcnt(4)
    v_mfma_f32_32x32x16_bf16 v[64:79], v[96:99], v[220:223], v[64:79]
    v_mfma_f32_32x32x16_bf16 v[80:95], v[100:103], v[220:223], v[80:95]
    buffer_load_dwordx4 v[220:223], v21, s[12:15], s22 offen offset:3072
    v_lshlrev_b32 v28, 16, v28
    v_and_b32 v27, s23, v26
    v_lshlrev_b32 v26, 16, v26
    v_fma_f32 v130, v58, v28, v26
    ds_read_b128 v[96:99], v14 offset:49152
    ds_read_b128 v[100:103], v14 offset:53248
    s_waitcnt vmcnt(23) lgkmcnt(4)
    v_mfma_f32_32x32x16_bf16 v[64:79], v[104:107], v[160:163], v[64:79]
    v_mfma_f32_32x32x16_bf16 v[80:95], v[108:111], v[160:163], v[80:95]
    s_add_u32 s22, s19, 10
    s_and_b32 s22, s22, 15
    s_lshl_b32 s22, s22, 15
    s_add_u32 s22, s22, s20
    buffer_load_dwordx4 v[160:163], v20, s[12:15], s22 offen offset:0
    buffer_load_dwordx4 v9, s[4:7], s21 offen offset:1024 lds
    v_fma_f32 v131, v58, v29, v27
    v_sub_f32 v30, 1.0, v59
    v_cvt_pk_bf16_f32 v30, v30, v30
    v_lshlrev_b32 v30, 16, v30
    ds_read_b128 v[104:107], v15 offset:49152
    ds_read_b128 v[108:111], v15 offset:53248
    s_waitcnt vmcnt(23) lgkmcnt(4)
    v_mfma_f32_32x32x16_bf16 v[64:79], v[112:115], v[164:167], v[64:79]
    v_mfma_f32_32x32x16_bf16 v[80:95], v[116:119], v[164:167], v[80:95]
    buffer_load_dwordx4 v[164:167], v20, s[12:15], s22 offen offset:1024
    v_lshlrev_b32 v26, 16, v46
    v_and_b32 v27, s23, v46
    v_mul_f32 v28, v26, v152
    v_mul_f32 v29, v27, v153
    ds_read_b128 v[112:115], v12 offset:57344
    ds_read_b128 v[116:119], v12 offset:61440
    s_waitcnt vmcnt(23) lgkmcnt(4)
    v_mfma_f32_32x32x16_bf16 v[64:79], v[96:99], v[168:171], v[64:79]
    v_mfma_f32_32x32x16_bf16 v[80:95], v[100:103], v[168:171], v[80:95]
    buffer_load_dwordx4 v[168:171], v20, s[12:15], s22 offen offset:2048
    buffer_load_dwordx4 v10, s[4:7], s21 offen offset:2048 lds
    v_cvt_pk_bf16_f32 v28, v28, v29
    v_mul_f32 v26, v26, v30
    v_mul_f32 v27, v27, v30
    v_cvt_pk_bf16_f32 v26, v26, v27
    ds_read_b128 v[96:99], v13 offset:57344
    ds_read_b128 v[100:103], v13 offset:61440
    s_waitcnt vmcnt(23) lgkmcnt(4)
    v_mfma_f32_32x32x16_bf16 v[64:79], v[104:107], v[172:175], v[64:79]
    v_mfma_f32_32x32x16_bf16 v[80:95], v[108:111], v[172:175], v[80:95]
    buffer_load_dwordx4 v[172:175], v20, s[12:15], s22 offen offset:3072
    v_and_b32 v29, s23, v28
    v_lshlrev_b32 v28, 16, v28
    v_and_b32 v27, s23, v26
    v_lshlrev_b32 v26, 16, v26
    ds_read_b128 v[104:107], v14 offset:57344
    ds_read_b128 v[108:111], v14 offset:61440
    s_waitcnt vmcnt(23) lgkmcnt(4)
    v_mfma_f32_32x32x16_bf16 v[64:79], v[112:115], v[176:179], v[64:79]
    v_mfma_f32_32x32x16_bf16 v[80:95], v[116:119], v[176:179], v[80:95]
    buffer_load_dwordx4 v[176:179], v21, s[12:15], s22 offen offset:0
    buffer_load_dwordx4 v11, s[4:7], s21 offen offset:3072 lds
    v_fma_f32 v132, v59, v28, v26
    v_fma_f32 v133, v59, v29, v27
    v_lshlrev_b32 v26, 16, v47
    v_and_b32 v27, s23, v47
    ds_read_b128 v[112:115], v15 offset:57344
    ds_read_b128 v[116:119], v15 offset:61440
    s_waitcnt vmcnt(23) lgkmcnt(4)
    v_mfma_f32_32x32x16_bf16 v[64:79], v[96:99], v[180:183], v[64:79]
    v_mfma_f32_32x32x16_bf16 v[80:95], v[100:103], v[180:183], v[80:95]
    buffer_load_dwordx4 v[180:183], v21, s[12:15], s22 offen offset:1024
    v_mul_f32 v28, v26, v154
    v_mul_f32 v29, v27, v155
    v_cvt_pk_bf16_f32 v28, v28, v29
    v_mul_f32 v26, v26, v30
    s_waitcnt vmcnt(37) lgkmcnt(0)
    s_barrier
    ds_read_b128 v[96:99], v16 offset:0
    ds_read_b128 v[100:103], v16 offset:4096
    s_waitcnt vmcnt(23) lgkmcnt(4)
    v_mfma_f32_32x32x16_bf16 v[64:79], v[104:107], v[184:187], v[64:79]
    v_mfma_f32_32x32x16_bf16 v[80:95], v[108:111], v[184:187], v[80:95]
    buffer_load_dwordx4 v[184:187], v21, s[12:15], s22 offen offset:2048
    s_add_u32 m0, s44, 49152
    s_add_u32 s21, s19, 13
    s_and_b32 s21, s21, 15
    s_lshl_b32 s21, s21, 7
    buffer_load_dwordx4 v8, s[4:7], s21 offen offset:0 lds
    v_mul_f32 v27, v27, v30
    v_cvt_pk_bf16_f32 v26, v26, v27
    v_and_b32 v29, s23, v28
    v_lshlrev_b32 v28, 16, v28
    ds_read_b128 v[104:107], v17 offset:0
    ds_read_b128 v[108:111], v17 offset:4096
    s_waitcnt vmcnt(23) lgkmcnt(4)
    v_mfma_f32_32x32x16_bf16 v[64:79], v[112:115], v[188:191], v[64:79]
    v_mfma_f32_32x32x16_bf16 v[80:95], v[116:119], v[188:191], v[80:95]
    buffer_load_dwordx4 v[188:191], v21, s[12:15], s22 offen offset:3072
    v_and_b32 v27, s23, v26
    v_lshlrev_b32 v26, 16, v26
    v_fma_f32 v134, v59, v28, v26
    v_fma_f32 v135, v59, v29, v27
    ds_read_b128 v[112:115], v18 offset:0
    ds_read_b128 v[116:119], v18 offset:4096
    s_waitcnt vmcnt(23) lgkmcnt(4)
    v_mfma_f32_32x32x16_bf16 v[64:79], v[96:99], v[192:195], v[64:79]
    v_mfma_f32_32x32x16_bf16 v[80:95], v[100:103], v[192:195], v[80:95]
    s_add_u32 s22, s19, 11
    s_and_b32 s22, s22, 15
    s_lshl_b32 s22, s22, 15
    s_add_u32 s22, s22, s20
    buffer_load_dwordx4 v[192:195], v20, s[12:15], s22 offen offset:0
    buffer_load_dwordx4 v9, s[4:7], s21 offen offset:1024 lds
    v_sub_f32 v30, 1.0, v60
    v_cvt_pk_bf16_f32 v30, v30, v30
    v_lshlrev_b32 v30, 16, v30
    v_lshlrev_b32 v26, 16, v48
    ds_read_b128 v[96:99], v19 offset:0
    ds_read_b128 v[100:103], v19 offset:4096
    s_waitcnt vmcnt(23) lgkmcnt(4)
    v_mfma_f32_32x32x16_bf16 v[64:79], v[104:107], v[196:199], v[64:79]
    v_mfma_f32_32x32x16_bf16 v[80:95], v[108:111], v[196:199], v[80:95]
    buffer_load_dwordx4 v[196:199], v20, s[12:15], s22 offen offset:1024
    v_and_b32 v27, s23, v48
    v_mul_f32 v28, v26, v152
    v_mul_f32 v29, v27, v153
    v_cvt_pk_bf16_f32 v28, v28, v29
    ds_read_b128 v[104:107], v16 offset:8192
    ds_read_b128 v[108:111], v16 offset:12288
    s_waitcnt vmcnt(23) lgkmcnt(4)
    v_mfma_f32_32x32x16_bf16 v[64:79], v[112:115], v[200:203], v[64:79]
    v_mfma_f32_32x32x16_bf16 v[80:95], v[116:119], v[200:203], v[80:95]
    buffer_load_dwordx4 v[200:203], v20, s[12:15], s22 offen offset:2048
    buffer_load_dwordx4 v10, s[4:7], s21 offen offset:2048 lds
    v_mul_f32 v26, v26, v30
    v_mul_f32 v27, v27, v30
    v_cvt_pk_bf16_f32 v26, v26, v27
    v_and_b32 v29, s23, v28
    ds_read_b128 v[112:115], v17 offset:8192
    ds_read_b128 v[116:119], v17 offset:12288
    s_waitcnt vmcnt(23) lgkmcnt(4)
    v_mfma_f32_32x32x16_bf16 v[64:79], v[96:99], v[204:207], v[64:79]
    v_mfma_f32_32x32x16_bf16 v[80:95], v[100:103], v[204:207], v[80:95]
    buffer_load_dwordx4 v[204:207], v20, s[12:15], s22 offen offset:3072
    v_lshlrev_b32 v28, 16, v28
    v_and_b32 v27, s23, v26
    v_lshlrev_b32 v26, 16, v26
    v_fma_f32 v136, v60, v28, v26
    ds_read_b128 v[96:99], v18 offset:8192
    ds_read_b128 v[100:103], v18 offset:12288
    s_waitcnt vmcnt(23) lgkmcnt(4)
    v_mfma_f32_32x32x16_bf16 v[64:79], v[104:107], v[208:211], v[64:79]
    v_mfma_f32_32x32x16_bf16 v[80:95], v[108:111], v[208:211], v[80:95]
    buffer_load_dwordx4 v[208:211], v21, s[12:15], s22 offen offset:0
    buffer_load_dwordx4 v11, s[4:7], s21 offen offset:3072 lds
    v_fma_f32 v137, v60, v29, v27
    v_lshlrev_b32 v26, 16, v49
    v_and_b32 v27, s23, v49
    v_mul_f32 v28, v26, v154
    ds_read_b128 v[104:107], v19 offset:8192
    ds_read_b128 v[108:111], v19 offset:12288
    s_waitcnt vmcnt(23) lgkmcnt(4)
    v_mfma_f32_32x32x16_bf16 v[64:79], v[112:115], v[212:215], v[64:79]
    v_mfma_f32_32x32x16_bf16 v[80:95], v[116:119], v[212:215], v[80:95]
    buffer_load_dwordx4 v[212:215], v21, s[12:15], s22 offen offset:1024
    v_mul_f32 v29, v27, v155
    v_cvt_pk_bf16_f32 v28, v28, v29
    v_mul_f32 v26, v26, v30
    v_mul_f32 v27, v27, v30
    s_waitcnt vmcnt(37) lgkmcnt(0)
    s_barrier
    ds_read_b128 v[112:115], v12 offset:0
    ds_read_b128 v[116:119], v12 offset:4096
    s_waitcnt vmcnt(23) lgkmcnt(4)
    v_mfma_f32_32x32x16_bf16 v[64:79], v[96:99], v[216:219], v[64:79]
    v_mfma_f32_32x32x16_bf16 v[80:95], v[100:103], v[216:219], v[80:95]
    buffer_load_dwordx4 v[216:219], v21, s[12:15], s22 offen offset:2048
    s_add_u32 m0, s44, 65536
    s_add_u32 s21, s19, 14
    s_and_b32 s21, s21, 15
    s_lshl_b32 s21, s21, 7
    buffer_load_dwordx4 v8, s[4:7], s21 offen offset:0 lds
    v_cvt_pk_bf16_f32 v26, v26, v27
    v_and_b32 v29, s23, v28
    v_lshlrev_b32 v28, 16, v28
    v_and_b32 v27, s23, v26
    ds_read_b128 v[96:99], v13 offset:0
    ds_read_b128 v[100:103], v13 offset:4096
    s_waitcnt vmcnt(23) lgkmcnt(4)
    v_mfma_f32_32x32x16_bf16 v[64:79], v[104:107], v[220:223], v[64:79]
    v_mfma_f32_32x32x16_bf16 v[80:95], v[108:111], v[220:223], v[80:95]
    buffer_load_dwordx4 v[220:223], v21, s[12:15], s22 offen offset:3072
    v_lshlrev_b32 v26, 16, v26
    v_fma_f32 v138, v60, v28, v26
    v_fma_f32 v139, v60, v29, v27
    v_sub_f32 v30, 1.0, v61
    ds_read_b128 v[104:107], v14 offset:0
    ds_read_b128 v[108:111], v14 offset:4096
    s_waitcnt vmcnt(23) lgkmcnt(4)
    v_mfma_f32_32x32x16_bf16 v[64:79], v[112:115], v[160:163], v[64:79]
    v_mfma_f32_32x32x16_bf16 v[80:95], v[116:119], v[160:163], v[80:95]
    s_add_u32 s22, s19, 12
    s_and_b32 s22, s22, 15
    s_lshl_b32 s22, s22, 15
    s_add_u32 s22, s22, s20
    buffer_load_dwordx4 v[160:163], v20, s[12:15], s22 offen offset:0
    buffer_load_dwordx4 v9, s[4:7], s21 offen offset:1024 lds
    v_cvt_pk_bf16_f32 v30, v30, v30
    v_lshlrev_b32 v30, 16, v30
    v_lshlrev_b32 v26, 16, v50
    v_and_b32 v27, s23, v50
    ds_read_b128 v[112:115], v15 offset:0
    ds_read_b128 v[116:119], v15 offset:4096
    s_waitcnt vmcnt(23) lgkmcnt(4)
    v_mfma_f32_32x32x16_bf16 v[64:79], v[96:99], v[164:167], v[64:79]
    v_mfma_f32_32x32x16_bf16 v[80:95], v[100:103], v[164:167], v[80:95]
    buffer_load_dwordx4 v[164:167], v20, s[12:15], s22 offen offset:1024
    v_mul_f32 v28, v26, v152
    v_mul_f32 v29, v27, v153
    v_cvt_pk_bf16_f32 v28, v28, v29
    v_mul_f32 v26, v26, v30
    ds_read_b128 v[96:99], v12 offset:8192
    ds_read_b128 v[100:103], v12 offset:12288
    s_waitcnt vmcnt(23) lgkmcnt(4)
    v_mfma_f32_32x32x16_bf16 v[64:79], v[104:107], v[168:171], v[64:79]
    v_mfma_f32_32x32x16_bf16 v[80:95], v[108:111], v[168:171], v[80:95]
    buffer_load_dwordx4 v[168:171], v20, s[12:15], s22 offen offset:2048
    buffer_load_dwordx4 v10, s[4:7], s21 offen offset:2048 lds
    v_mul_f32 v27, v27, v30
    v_cvt_pk_bf16_f32 v26, v26, v27
    v_and_b32 v29, s23, v28
    v_lshlrev_b32 v28, 16, v28
    ds_read_b128 v[104:107], v13 offset:8192
    ds_read_b128 v[108:111], v13 offset:12288
    s_waitcnt vmcnt(23) lgkmcnt(4)
    v_mfma_f32_32x32x16_bf16 v[64:79], v[112:115], v[172:175], v[64:79]
    v_mfma_f32_32x32x16_bf16 v[80:95], v[116:119], v[172:175], v[80:95]
    buffer_load_dwordx4 v[172:175], v20, s[12:15], s22 offen offset:3072
    v_and_b32 v27, s23, v26
    v_lshlrev_b32 v26, 16, v26
    v_fma_f32 v140, v61, v28, v26
    v_fma_f32 v141, v61, v29, v27
    ds_read_b128 v[112:115], v14 offset:8192
    ds_read_b128 v[116:119], v14 offset:12288
    s_waitcnt vmcnt(23) lgkmcnt(4)
    v_mfma_f32_32x32x16_bf16 v[64:79], v[96:99], v[176:179], v[64:79]
    v_mfma_f32_32x32x16_bf16 v[80:95], v[100:103], v[176:179], v[80:95]
    buffer_load_dwordx4 v[176:179], v21, s[12:15], s22 offen offset:0
    buffer_load_dwordx4 v11, s[4:7], s21 offen offset:3072 lds
    v_lshlrev_b32 v26, 16, v51
    v_and_b32 v27, s23, v51
    v_mul_f32 v28, v26, v154
    v_mul_f32 v29, v27, v155
    ds_read_b128 v[96:99], v15 offset:8192
    ds_read_b128 v[100:103], v15 offset:12288
    s_waitcnt vmcnt(23) lgkmcnt(4)
    v_mfma_f32_32x32x16_bf16 v[64:79], v[104:107], v[180:183], v[64:79]
    v_mfma_f32_32x32x16_bf16 v[80:95], v[108:111], v[180:183], v[80:95]
    buffer_load_dwordx4 v[180:183], v21, s[12:15], s22 offen offset:1024
    v_cvt_pk_bf16_f32 v28, v28, v29
    v_mul_f32 v26, v26, v30
    v_mul_f32 v27, v27, v30
    v_cvt_pk_bf16_f32 v26, v26, v27
    s_waitcnt vmcnt(37) lgkmcnt(0)
    s_barrier
    ds_read_b128 v[104:107], v12 offset:16384
    ds_read_b128 v[108:111], v12 offset:20480
    s_waitcnt vmcnt(23) lgkmcnt(4)
    v_mfma_f32_32x32x16_bf16 v[64:79], v[112:115], v[184:187], v[64:79]
    v_mfma_f32_32x32x16_bf16 v[80:95], v[116:119], v[184:187], v[80:95]
    buffer_load_dwordx4 v[184:187], v21, s[12:15], s22 offen offset:2048
    s_add_u32 m0, s44, 0
    s_add_u32 s21, s19, 15
    s_and_b32 s21, s21, 15
    s_lshl_b32 s21, s21, 7
    buffer_load_dwordx4 v8, s[4:7], s21 offen offset:0 lds
    v_and_b32 v29, s23, v28
    v_lshlrev_b32 v28, 16, v28
    v_and_b32 v27, s23, v26
    v_lshlrev_b32 v26, 16, v26
    ds_read_b128 v[112:115], v13 offset:16384
    ds_read_b128 v[116:119], v13 offset:20480
    s_waitcnt vmcnt(23) lgkmcnt(4)
    v_mfma_f32_32x32x16_bf16 v[64:79], v[96:99], v[188:191], v[64:79]
    v_mfma_f32_32x32x16_bf16 v[80:95], v[100:103], v[188:191], v[80:95]
    buffer_load_dwordx4 v[188:191], v21, s[12:15], s22 offen offset:3072
    v_fma_f32 v142, v61, v28, v26
    v_fma_f32 v143, v61, v29, v27
    v_sub_f32 v30, 1.0, v62
    v_cvt_pk_bf16_f32 v30, v30, v30
    ds_read_b128 v[96:99], v14 offset:16384
    ds_read_b128 v[100:103], v14 offset:20480
    s_waitcnt vmcnt(23) lgkmcnt(4)
    v_mfma_f32_32x32x16_bf16 v[64:79], v[104:107], v[192:195], v[64:79]
    v_mfma_f32_32x32x16_bf16 v[80:95], v[108:111], v[192:195], v[80:95]
    s_add_u32 s22, s19, 13
    s_and_b32 s22, s22, 15
    s_lshl_b32 s22, s22, 15
    s_add_u32 s22, s22, s20
    buffer_load_dwordx4 v[192:195], v20, s[12:15], s22 offen offset:0
    buffer_load_dwordx4 v9, s[4:7], s21 offen offset:1024 lds
    v_lshlrev_b32 v30, 16, v30
    v_lshlrev_b32 v26, 16, v52
    v_and_b32 v27, s23, v52
    v_mul_f32 v28, v26, v152
    ds_read_b128 v[104:107], v15 offset:16384
    ds_read_b128 v[108:111], v15 offset:20480
    s_waitcnt vmcnt(23) lgkmcnt(4)
    v_mfma_f32_32x32x16_bf16 v[64:79], v[112:115], v[196:199], v[64:79]
    v_mfma_f32_32x32x16_bf16 v[80:95], v[116:119], v[196:199], v[80:95]
    buffer_load_dwordx4 v[196:199], v20, s[12:15], s22 offen offset:1024
    v_mul_f32 v29, v27, v153
    v_cvt_pk_bf16_f32 v28, v28, v29
    v_mul_f32 v26, v26, v30
    v_mul_f32 v27, v27, v30
    ds_read_b128 v[112:115], v12 offset:24576
    ds_read_b128 v[116:119], v12 offset:28672
    s_waitcnt vmcnt(23) lgkmcnt(4)
    v_mfma_f32_32x32x16_bf16 v[64:79], v[96:99], v[200:203], v[64:79]
    v_mfma_f32_32x32x16_bf16 v[80:95], v[100:103], v[200:203], v[80:95]
    buffer_load_dwordx4 v[200:203], v20, s[12:15], s22 offen offset:2048
    buffer_load_dwordx4 v10, s[4:7], s21 offen offset:2048 lds
    v_cvt_pk_bf16_f32 v26, v26, v27
    v_and_b32 v29, s23, v28
    v_lshlrev_b32 v28, 16, v28
    v_and_b32 v27, s23, v26
    ds_read_b128 v[96:99], v13 offset:24576
    ds_read_b128 v[100:103], v13 offset:28672
    s_waitcnt vmcnt(23) lgkmcnt(4)
    v_mfma_f32_32x32x16_bf16 v[64:79], v[104:107], v[204:207], v[64:79]
    v_mfma_f32_32x32x16_bf16 v[80:95], v[108:111], v[204:207], v[80:95]
    buffer_load_dwordx4 v[204:207], v20, s[12:15], s22 offen offset:3072
    v_lshlrev_b32 v26, 16, v26
    v_fma_f32 v144, v62, v28, v26
    v_fma_f32 v145, v62, v29, v27
    v_lshlrev_b32 v26, 16, v53
    ds_read_b128 v[104:107], v14 offset:24576
    ds_read_b128 v[108:111], v14 offset:28672
    s_waitcnt vmcnt(23) lgkmcnt(4)
    v_mfma_f32_32x32x16_bf16 v[64:79], v[112:115], v[208:211], v[64:79]
    v_mfma_f32_32x32x16_bf16 v[80:95], v[116:119], v[208:211], v[80:95]
    buffer_load_dwordx4 v[208:211], v21, s[12:15], s22 offen offset:0
    buffer_load_dwordx4 v11, s[4:7], s21 offen offset:3072 lds
    v_and_b32 v27, s23, v53
    v_mul_f32 v28, v26, v154
    v_mul_f32 v29, v27, v155
    v_cvt_pk_bf16_f32 v28, v28, v29
    ds_read_b128 v[112:115], v15 offset:24576
    ds_read_b128 v[116:119], v15 offset:28672
    s_waitcnt vmcnt(23) lgkmcnt(4)
    v_mfma_f32_32x32x16_bf16 v[64:79], v[96:99], v[212:215], v[64:79]
    v_mfma_f32_32x32x16_bf16 v[80:95], v[100:103], v[212:215], v[80:95]
    buffer_load_dwordx4 v[212:215], v21, s[12:15], s22 offen offset:1024
    v_mul_f32 v26, v26, v30
    v_mul_f32 v27, v27, v30
    v_cvt_pk_bf16_f32 v26, v26, v27
    v_and_b32 v29, s23, v28
    s_waitcnt vmcnt(37) lgkmcnt(0)
    s_barrier
    ds_read_b128 v[96:99], v12 offset:32768
    ds_read_b128 v[100:103], v12 offset:36864
    s_waitcnt vmcnt(23) lgkmcnt(4)
    v_mfma_f32_32x32x16_bf16 v[64:79], v[104:107], v[216:219], v[64:79]
    v_mfma_f32_32x32x16_bf16 v[80:95], v[108:111], v[216:219], v[80:95]
    buffer_load_dwordx4 v[216:219], v21, s[12:15], s22 offen offset:2048
    v_lshlrev_b32 v28, 16, v28
    v_and_b32 v27, s23, v26
    v_lshlrev_b32 v26, 16, v26
    v_fma_f32 v146, v62, v28, v26
    ds_read_b128 v[104:107], v13 offset:32768
    ds_read_b128 v[108:111], v13 offset:36864
    s_waitcnt vmcnt(22) lgkmcnt(4)
    v_mfma_f32_32x32x16_bf16 v[64:79], v[112:115], v[220:223], v[64:79]
    v_mfma_f32_32x32x16_bf16 v[80:95], v[116:119], v[220:223], v[80:95]
    buffer_load_dwordx4 v[220:223], v21, s[12:15], s22 offen offset:3072
    v_fma_f32 v147, v62, v29, v27
    v_sub_f32 v30, 1.0, v63
    v_cvt_pk_bf16_f32 v30, v30, v30
    v_lshlrev_b32 v30, 16, v30
    ds_read_b128 v[112:115], v14 offset:32768
    ds_read_b128 v[116:119], v14 offset:36864
    s_waitcnt vmcnt(22) lgkmcnt(4)
    v_mfma_f32_32x32x16_bf16 v[64:79], v[96:99], v[160:163], v[64:79]
    v_mfma_f32_32x32x16_bf16 v[80:95], v[100:103], v[160:163], v[80:95]
    s_add_u32 s22, s19, 14
    s_and_b32 s22, s22, 15
    s_lshl_b32 s22, s22, 15
    s_add_u32 s22, s22, s20
    buffer_load_dwordx4 v[160:163], v20, s[12:15], s22 offen offset:0
    v_lshlrev_b32 v26, 16, v54
    v_and_b32 v27, s23, v54
    v_mul_f32 v28, v26, v152
    v_mul_f32 v29, v27, v153
    ds_read_b128 v[96:99], v15 offset:32768
    ds_read_b128 v[100:103], v15 offset:36864
    s_waitcnt vmcnt(21) lgkmcnt(4)
    v_mfma_f32_32x32x16_bf16 v[64:79], v[104:107], v[164:167], v[64:79]
    v_mfma_f32_32x32x16_bf16 v[80:95], v[108:111], v[164:167], v[80:95]
    buffer_load_dwordx4 v[164:167], v20, s[12:15], s22 offen offset:1024
    v_cvt_pk_bf16_f32 v28, v28, v29
    v_mul_f32 v26, v26, v30
    v_mul_f32 v27, v27, v30
    v_cvt_pk_bf16_f32 v26, v26, v27
    ds_read_b128 v[104:107], v12 offset:40960
    ds_read_b128 v[108:111], v12 offset:45056
    s_waitcnt vmcnt(21) lgkmcnt(4)
    v_mfma_f32_32x32x16_bf16 v[64:79], v[112:115], v[168:171], v[64:79]
    v_mfma_f32_32x32x16_bf16 v[80:95], v[116:119], v[168:171], v[80:95]
    buffer_load_dwordx4 v[168:171], v20, s[12:15], s22 offen offset:2048
    v_and_b32 v29, s23, v28
    v_lshlrev_b32 v28, 16, v28
    v_and_b32 v27, s23, v26
    v_lshlrev_b32 v26, 16, v26
    ds_read_b128 v[112:115], v13 offset:40960
    ds_read_b128 v[116:119], v13 offset:45056
    s_waitcnt vmcnt(20) lgkmcnt(4)
    v_mfma_f32_32x32x16_bf16 v[64:79], v[96:99], v[172:175], v[64:79]
    v_mfma_f32_32x32x16_bf16 v[80:95], v[100:103], v[172:175], v[80:95]
    buffer_load_dwordx4 v[172:175], v20, s[12:15], s22 offen offset:3072
    v_fma_f32 v148, v63, v28, v26
    v_fma_f32 v149, v63, v29, v27
    v_lshlrev_b32 v26, 16, v55
    v_and_b32 v27, s23, v55
    ds_read_b128 v[96:99], v14 offset:40960
    ds_read_b128 v[100:103], v14 offset:45056
    s_waitcnt vmcnt(20) lgkmcnt(4)
    v_mfma_f32_32x32x16_bf16 v[64:79], v[104:107], v[176:179], v[64:79]
    v_mfma_f32_32x32x16_bf16 v[80:95], v[108:111], v[176:179], v[80:95]
    buffer_load_dwordx4 v[176:179], v21, s[12:15], s22 offen offset:0
    v_mul_f32 v28, v26, v154
    v_mul_f32 v29, v27, v155
    v_cvt_pk_bf16_f32 v28, v28, v29
    v_mul_f32 v26, v26, v30
    ds_read_b128 v[104:107], v15 offset:40960
    ds_read_b128 v[108:111], v15 offset:45056
    s_waitcnt vmcnt(19) lgkmcnt(4)
    v_mfma_f32_32x32x16_bf16 v[64:79], v[112:115], v[180:183], v[64:79]
    v_mfma_f32_32x32x16_bf16 v[80:95], v[116:119], v[180:183], v[80:95]
    buffer_load_dwordx4 v[180:183], v21, s[12:15], s22 offen offset:1024
    v_mul_f32 v27, v27, v30
    v_cvt_pk_bf16_f32 v26, v26, v27
    v_and_b32 v29, s23, v28
    v_lshlrev_b32 v28, 16, v28
    s_waitcnt vmcnt(33) lgkmcnt(0)
    s_barrier
    ds_read_b128 v[112:115], v12 offset:49152
    ds_read_b128 v[116:119], v12 offset:53248
    s_waitcnt vmcnt(19) lgkmcnt(4)
    v_mfma_f32_32x32x16_bf16 v[64:79], v[96:99], v[184:187], v[64:79]
    v_mfma_f32_32x32x16_bf16 v[80:95], v[100:103], v[184:187], v[80:95]
    buffer_load_dwordx4 v[184:187], v21, s[12:15], s22 offen offset:2048
    v_and_b32 v27, s23, v26
    v_lshlrev_b32 v26, 16, v26
    v_fma_f32 v150, v63, v28, v26
    v_fma_f32 v151, v63, v29, v27
    ds_read_b128 v[96:99], v13 offset:49152
    ds_read_b128 v[100:103], v13 offset:53248
    s_waitcnt vmcnt(18) lgkmcnt(4)
    v_mfma_f32_32x32x16_bf16 v[64:79], v[104:107], v[188:191], v[64:79]
    v_mfma_f32_32x32x16_bf16 v[80:95], v[108:111], v[188:191], v[80:95]
    buffer_load_dwordx4 v[188:191], v21, s[12:15], s22 offen offset:3072
    ds_read_b128 v[104:107], v14 offset:49152
    ds_read_b128 v[108:111], v14 offset:53248
    s_waitcnt vmcnt(18) lgkmcnt(4)
    v_mfma_f32_32x32x16_bf16 v[64:79], v[112:115], v[192:195], v[64:79]
    v_mfma_f32_32x32x16_bf16 v[80:95], v[116:119], v[192:195], v[80:95]
    s_add_u32 s22, s19, 15
    s_and_b32 s22, s22, 15
    s_lshl_b32 s22, s22, 15
    s_add_u32 s22, s22, s20
    buffer_load_dwordx4 v[192:195], v20, s[12:15], s22 offen offset:0
    ds_read_b128 v[112:115], v15 offset:49152
    ds_read_b128 v[116:119], v15 offset:53248
    s_waitcnt vmcnt(17) lgkmcnt(4)
    v_mfma_f32_32x32x16_bf16 v[64:79], v[96:99], v[196:199], v[64:79]
    v_mfma_f32_32x32x16_bf16 v[80:95], v[100:103], v[196:199], v[80:95]
    buffer_load_dwordx4 v[196:199], v20, s[12:15], s22 offen offset:1024
    ds_read_b128 v[96:99], v12 offset:57344
    ds_read_b128 v[100:103], v12 offset:61440
    s_waitcnt vmcnt(17) lgkmcnt(4)
    v_mfma_f32_32x32x16_bf16 v[64:79], v[104:107], v[200:203], v[64:79]
    v_mfma_f32_32x32x16_bf16 v[80:95], v[108:111], v[200:203], v[80:95]
    buffer_load_dwordx4 v[200:203], v20, s[12:15], s22 offen offset:2048
    ds_read_b128 v[104:107], v13 offset:57344
    ds_read_b128 v[108:111], v13 offset:61440
    s_waitcnt vmcnt(16) lgkmcnt(4)
    v_mfma_f32_32x32x16_bf16 v[64:79], v[112:115], v[204:207], v[64:79]
    v_mfma_f32_32x32x16_bf16 v[80:95], v[116:119], v[204:207], v[80:95]
    buffer_load_dwordx4 v[204:207], v20, s[12:15], s22 offen offset:3072
    ds_read_b128 v[112:115], v14 offset:57344
    ds_read_b128 v[116:119], v14 offset:61440
    s_waitcnt vmcnt(16) lgkmcnt(4)
    v_mfma_f32_32x32x16_bf16 v[64:79], v[96:99], v[208:211], v[64:79]
    v_mfma_f32_32x32x16_bf16 v[80:95], v[100:103], v[208:211], v[80:95]
    buffer_load_dwordx4 v[208:211], v21, s[12:15], s22 offen offset:0
    ds_read_b128 v[96:99], v15 offset:57344
    ds_read_b128 v[100:103], v15 offset:61440
    s_waitcnt vmcnt(15) lgkmcnt(4)
    v_mfma_f32_32x32x16_bf16 v[64:79], v[104:107], v[212:215], v[64:79]
    v_mfma_f32_32x32x16_bf16 v[80:95], v[108:111], v[212:215], v[80:95]
    buffer_load_dwordx4 v[212:215], v21, s[12:15], s22 offen offset:1024
    s_waitcnt vmcnt(29) lgkmcnt(0)
    s_barrier
    ds_read_b128 v[104:107], v16 offset:0
    ds_read_b128 v[108:111], v16 offset:4096
    s_waitcnt vmcnt(15) lgkmcnt(4)
    v_mfma_f32_32x32x16_bf16 v[64:79], v[112:115], v[216:219], v[64:79]
    v_mfma_f32_32x32x16_bf16 v[80:95], v[116:119], v[216:219], v[80:95]
    buffer_load_dwordx4 v[216:219], v21, s[12:15], s22 offen offset:2048
    ds_read_b128 v[112:115], v17 offset:0
    ds_read_b128 v[116:119], v17 offset:4096
    s_waitcnt vmcnt(15) lgkmcnt(4)
    v_mfma_f32_32x32x16_bf16 v[64:79], v[96:99], v[220:223], v[64:79]
    v_mfma_f32_32x32x16_bf16 v[80:95], v[100:103], v[220:223], v[80:95]
    buffer_load_dwordx4 v[220:223], v21, s[12:15], s22 offen offset:3072
    ds_read_b128 v[96:99], v18 offset:0
    ds_read_b128 v[100:103], v18 offset:4096
    s_waitcnt vmcnt(15) lgkmcnt(4)
    v_mfma_f32_32x32x16_bf16 v[64:79], v[104:107], v[160:163], v[64:79]
    v_mfma_f32_32x32x16_bf16 v[80:95], v[108:111], v[160:163], v[80:95]
    ds_read_b128 v[104:107], v19 offset:0
    ds_read_b128 v[108:111], v19 offset:4096
    s_waitcnt vmcnt(14) lgkmcnt(4)
    v_mfma_f32_32x32x16_bf16 v[64:79], v[112:115], v[164:167], v[64:79]
    v_mfma_f32_32x32x16_bf16 v[80:95], v[116:119], v[164:167], v[80:95]
    ds_read_b128 v[112:115], v16 offset:8192
    ds_read_b128 v[116:119], v16 offset:12288
    s_waitcnt vmcnt(13) lgkmcnt(4)
    v_mfma_f32_32x32x16_bf16 v[64:79], v[96:99], v[168:171], v[64:79]
    v_mfma_f32_32x32x16_bf16 v[80:95], v[100:103], v[168:171], v[80:95]
    ds_read_b128 v[96:99], v17 offset:8192
    ds_read_b128 v[100:103], v17 offset:12288
    s_waitcnt vmcnt(12) lgkmcnt(4)
    v_mfma_f32_32x32x16_bf16 v[64:79], v[104:107], v[172:175], v[64:79]
    v_mfma_f32_32x32x16_bf16 v[80:95], v[108:111], v[172:175], v[80:95]
    ds_read_b128 v[104:107], v18 offset:8192
    ds_read_b128 v[108:111], v18 offset:12288
    s_waitcnt vmcnt(11) lgkmcnt(4)
    v_mfma_f32_32x32x16_bf16 v[64:79], v[112:115], v[176:179], v[64:79]
    v_mfma_f32_32x32x16_bf16 v[80:95], v[116:119], v[176:179], v[80:95]
    ds_read_b128 v[112:115], v19 offset:8192
    ds_read_b128 v[116:119], v19 offset:12288
    s_waitcnt vmcnt(10) lgkmcnt(4)
    v_mfma_f32_32x32x16_bf16 v[64:79], v[96:99], v[180:183], v[64:79]
    v_mfma_f32_32x32x16_bf16 v[80:95], v[100:103], v[180:183], v[80:95]
    s_waitcnt vmcnt(19) lgkmcnt(0)
    s_barrier
    ds_read_b128 v[96:99], v12 offset:0
    ds_read_b128 v[100:103], v12 offset:4096
    s_waitcnt vmcnt(9) lgkmcnt(4)
    v_mfma_f32_32x32x16_bf16 v[64:79], v[104:107], v[184:187], v[64:79]
    v_mfma_f32_32x32x16_bf16 v[80:95], v[108:111], v[184:187], v[80:95]
    ds_read_b128 v[104:107], v13 offset:0
    ds_read_b128 v[108:111], v13 offset:4096
    s_waitcnt vmcnt(8) lgkmcnt(4)
    v_mfma_f32_32x32x16_bf16 v[64:79], v[112:115], v[188:191], v[64:79]
    v_mfma_f32_32x32x16_bf16 v[80:95], v[116:119], v[188:191], v[80:95]
    ds_read_b128 v[112:115], v14 offset:0
    ds_read_b128 v[116:119], v14 offset:4096
    s_waitcnt vmcnt(7) lgkmcnt(4)
    v_mfma_f32_32x32x16_bf16 v[64:79], v[96:99], v[192:195], v[64:79]
    v_mfma_f32_32x32x16_bf16 v[80:95], v[100:103], v[192:195], v[80:95]
    ds_read_b128 v[96:99], v15 offset:0
    ds_read_b128 v[100:103], v15 offset:4096
    s_waitcnt vmcnt(6) lgkmcnt(4)
    v_mfma_f32_32x32x16_bf16 v[64:79], v[104:107], v[196:199], v[64:79]
    v_mfma_f32_32x32x16_bf16 v[80:95], v[108:111], v[196:199], v[80:95]
    ds_read_b128 v[104:107], v12 offset:8192
    ds_read_b128 v[108:111], v12 offset:12288
    s_waitcnt vmcnt(5) lgkmcnt(4)
    v_mfma_f32_32x32x16_bf16 v[64:79], v[112:115], v[200:203], v[64:79]
    v_mfma_f32_32x32x16_bf16 v[80:95], v[116:119], v[200:203], v[80:95]
    ds_read_b128 v[112:115], v13 offset:8192
    ds_read_b128 v[116:119], v13 offset:12288
    s_waitcnt vmcnt(4) lgkmcnt(4)
    v_mfma_f32_32x32x16_bf16 v[64:79], v[96:99], v[204:207], v[64:79]
    v_mfma_f32_32x32x16_bf16 v[80:95], v[100:103], v[204:207], v[80:95]
    ds_read_b128 v[96:99], v14 offset:8192
    ds_read_b128 v[100:103], v14 offset:12288
    s_waitcnt vmcnt(3) lgkmcnt(4)
    v_mfma_f32_32x32x16_bf16 v[64:79], v[104:107], v[208:211], v[64:79]
    v_mfma_f32_32x32x16_bf16 v[80:95], v[108:111], v[208:211], v[80:95]
    ds_read_b128 v[104:107], v15 offset:8192
    ds_read_b128 v[108:111], v15 offset:12288
    s_waitcnt vmcnt(2) lgkmcnt(4)
    v_mfma_f32_32x32x16_bf16 v[64:79], v[112:115], v[212:215], v[64:79]
    v_mfma_f32_32x32x16_bf16 v[80:95], v[116:119], v[212:215], v[80:95]
    s_waitcnt vmcnt(1) lgkmcnt(2)
    v_mfma_f32_32x32x16_bf16 v[64:79], v[96:99], v[216:219], v[64:79]
    v_mfma_f32_32x32x16_bf16 v[80:95], v[100:103], v[216:219], v[80:95]
    s_waitcnt vmcnt(0) lgkmcnt(0)
    v_mfma_f32_32x32x16_bf16 v[64:79], v[104:107], v[220:223], v[64:79]
    v_mfma_f32_32x32x16_bf16 v[80:95], v[108:111], v[220:223], v[80:95]
    s_mul_i32 s38, s18, 8704
    s_add_u32 s56, s38, 16384
    v_and_b32 v30, 31, v22
    v_mul_u32_u24 v26, 272, v30
    v_lshl_add_u32 v26, v23, 4, v26
    v_add_u32 v26, s56, v26
    v_lshrrev_b32 v31, 4, v22
    v_and_b32 v32, 15, v22
    v_mul_u32_u24 v27, 272, v31
    v_lshl_add_u32 v27, v32, 4, v27
    v_add_u32 v27, s56, v27
    v_lshlrev_b32 v28, 12, v31
    v_lshl_add_u32 v28, v32, 4, v28
    v_mul_f32 v64, v64, v24
    v_mul_f32 v65, v65, v24
    v_mul_f32 v66, v66, v24
    v_mul_f32 v67, v67, v24
    ds_write_b128 v26, v[64:67] offset:0
    v_mul_f32 v68, v68, v24
    v_mul_f32 v69, v69, v24
    v_mul_f32 v70, v70, v24
    v_mul_f32 v71, v71, v24
    ds_write_b128 v26, v[68:71] offset:32
    v_mul_f32 v72, v72, v24
    v_mul_f32 v73, v73, v24
    v_mul_f32 v74, v74, v24
    v_mul_f32 v75, v75, v24
    ds_write_b128 v26, v[72:75] offset:64
    v_mul_f32 v76, v76, v24
    v_mul_f32 v77, v77, v24
    v_mul_f32 v78, v78, v24
    v_mul_f32 v79, v79, v24
    ds_write_b128 v26, v[76:79] offset:96
    v_mul_f32 v80, v80, v24
    v_mul_f32 v81, v81, v24
    v_mul_f32 v82, v82, v24
    v_mul_f32 v83, v83, v24
    ds_write_b128 v26, v[80:83] offset:128
    v_mul_f32 v84, v84, v24
    v_mul_f32 v85, v85, v24
    v_mul_f32 v86, v86, v24
    v_mul_f32 v87, v87, v24
    ds_write_b128 v26, v[84:87] offset:160
    v_mul_f32 v88, v88, v24
    v_mul_f32 v89, v89, v24
    v_mul_f32 v90, v90, v24
    v_mul_f32 v91, v91, v24
    ds_write_b128 v26, v[88:91] offset:192
    v_mul_f32 v92, v92, v24
    v_mul_f32 v93, v93, v24
    v_mul_f32 v94, v94, v24
    v_mul_f32 v95, v95, v24
    ds_write_b128 v26, v[92:95] offset:224
    s_waitcnt lgkmcnt(0)
    s_barrier
    s_and_b32 s59, s48, 0x7ff
    s_sub_u32 s59, 2047, s59
    s_sub_u32 s38, s59, s45
    s_cmp_ge_u32 s38, 32
    s_cbranch_scc1 L_k2_fx0
    s_mul_i32 s39, s38, 272
    s_add_u32 s39, s39, s56
    v_lshl_add_u32 v168, v32, 4, s39
    s_mov_b32 s39, 116736
    v_lshl_add_u32 v169, v32, 4, s39
    ds_read_b128 v[160:163], v168
    ds_read_b128 v[164:167], v169
    s_waitcnt lgkmcnt(0)
    v_add_f32 v160, v160, v164
    v_add_f32 v161, v161, v165
    v_add_f32 v162, v162, v166
    v_add_f32 v163, v163, v167
    ds_write_b128 v168, v[160:163]
L_k2_fx0:
    s_and_b32 s59, s49, 0x7ff
    s_sub_u32 s59, 2047, s59
    s_sub_u32 s38, s59, s45
    s_cmp_ge_u32 s38, 32
    s_cbranch_scc1 L_k2_fx1
    s_mul_i32 s39, s38, 272
    s_add_u32 s39, s39, s56
    v_lshl_add_u32 v168, v32, 4, s39
    s_mov_b32 s39, 116992
    v_lshl_add_u32 v169, v32, 4, s39
    ds_read_b128 v[160:163], v168
    ds_read_b128 v[164:167], v169
    s_waitcnt lgkmcnt(0)
    v_add_f32 v160, v160, v164
    v_add_f32 v161, v161, v165
    v_add_f32 v162, v162, v166
    v_add_f32 v163, v163, v167
    ds_write_b128 v168, v[160:163]
L_k2_fx1:
    s_and_b32 s59, s50, 0x7ff
    s_sub_u32 s59, 2047, s59
    s_sub_u32 s38, s59, s45
    s_cmp_ge_u32 s38, 32
    s_cbranch_scc1 L_k2_fx2
    s_mul_i32 s39, s38, 272
    s_add_u32 s39, s39, s56
    v_lshl_add_u32 v168, v32, 4, s39
    s_mov_b32 s39, 117248
    v_lshl_add_u32 v169, v32, 4, s39
    ds_read_b128 v[160:163], v168
    ds_read_b128 v[164:167], v169
    s_waitcnt lgkmcnt(0)
    v_add_f32 v160, v160, v164
    v_add_f32 v161, v161, v165
    v_add_f32 v162, v162, v166
    v_add_f32 v163, v163, v167
    ds_write_b128 v168, v[160:163]
L_k2_fx2:
    s_and_b32 s59, s51, 0x7ff
    s_sub_u32 s59, 2047, s59
    s_sub_u32 s38, s59, s45
    s_cmp_ge_u32 s38, 32
    s_cbranch_scc1 L_k2_fx3
    s_mul_i32 s39, s38, 272
    s_add_u32 s39, s39, s56
    v_lshl_add_u32 v168, v32, 4, s39
    s_mov_b32 s39, 117504
    v_lshl_add_u32 v169, v32, 4, s39
    ds_read_b128 v[160:163], v168
    ds_read_b128 v[164:167], v169
    s_waitcnt lgkmcnt(0)
    v_add_f32 v160, v160, v164
    v_add_f32 v161, v161, v165
    v_add_f32 v162, v162, v166
    v_add_f32 v163, v163, v167
    ds_write_b128 v168, v[160:163]
L_k2_fx3:
    s_and_b32 s59, s52, 0x7ff
    s_sub_u32 s59, 2047, s59
    s_sub_u32 s38, s59, s45
    s_cmp_ge_u32 s38, 32
    s_cbranch_scc1 L_k2_fx4
    s_mul_i32 s39, s38, 272
    s_add_u32 s39, s39, s56
    v_lshl_add_u32 v168, v32, 4, s39
    s_mov_b32 s39, 117760
    v_lshl_add_u32 v169, v32, 4, s39
    ds_read_b128 v[160:163], v168
    ds_read_b128 v[164:167], v169
    s_waitcnt lgkmcnt(0)
    v_add_f32 v160, v160, v164
    v_add_f32 v161, v161, v165
    v_add_f32 v162, v162, v166
    v_add_f32 v163, v163, v167
    ds_write_b128 v168, v[160:163]
L_k2_fx4:
    s_and_b32 s59, s53, 0x7ff
    s_sub_u32 s59, 2047, s59
    s_sub_u32 s38, s59, s45
    s_cmp_ge_u32 s38, 32
    s_cbranch_scc1 L_k2_fx5
    s_mul_i32 s39, s38, 272
    s_add_u32 s39, s39, s56
    v_lshl_add_u32 v168, v32, 4, s39
    s_mov_b32 s39, 118016
    v_lshl_add_u32 v169, v32, 4, s39
    ds_read_b128 v[160:163], v168
    ds_read_b128 v[164:167], v169
    s_waitcnt lgkmcnt(0)
    v_add_f32 v160, v160, v164
    v_add_f32 v161, v161, v165
    v_add_f32 v162, v162, v166
    v_add_f32 v163, v163, v167
    ds_write_b128 v168, v[160:163]
L_k2_fx5:
    s_and_b32 s59, s54, 0x7ff
    s_sub_u32 s59, 2047, s59
    s_sub_u32 s38, s59, s45
    s_cmp_ge_u32 s38, 32
    s_cbranch_scc1 L_k2_fx6
    s_mul_i32 s39, s38, 272
    s_add_u32 s39, s39, s56
    v_lshl_add_u32 v168, v32, 4, s39
    s_mov_b32 s39, 118272
    v_lshl_add_u32 v169, v32, 4, s39
    ds_read_b128 v[160:163], v168
    ds_read_b128 v[164:167], v169
    s_waitcnt lgkmcnt(0)
    v_add_f32 v160, v160, v164
    v_add_f32 v161, v161, v165
    v_add_f32 v162, v162, v166
    v_add_f32 v163, v163, v167
    ds_write_b128 v168, v[160:163]
L_k2_fx6:
    s_and_b32 s59, s55, 0x7ff
    s_sub_u32 s59, 2047, s59
    s_sub_u32 s38, s59, s45
    s_cmp_ge_u32 s38, 32
    s_cbranch_scc1 L_k2_fx7
    s_mul_i32 s39, s38, 272
    s_add_u32 s39, s39, s56
    v_lshl_add_u32 v168, v32, 4, s39
    s_mov_b32 s39, 118528
    v_lshl_add_u32 v169, v32, 4, s39
    ds_read_b128 v[160:163], v168
    ds_read_b128 v[164:167], v169
    s_waitcnt lgkmcnt(0)
    v_add_f32 v160, v160, v164
    v_add_f32 v161, v161, v165
    v_add_f32 v162, v162, v166
    v_add_f32 v163, v163, v167
    ds_write_b128 v168, v[160:163]
L_k2_fx7:
    s_waitcnt lgkmcnt(0)
    ds_read_b128 v[64:67], v27 offset:0
    ds_read_b128 v[68:71], v27 offset:1088
    ds_read_b128 v[72:75], v27 offset:2176
    ds_read_b128 v[76:79], v27 offset:3264
    ds_read_b128 v[80:83], v27 offset:4352
    ds_read_b128 v[84:87], v27 offset:5440
    ds_read_b128 v[88:91], v27 offset:6528
    ds_read_b128 v[92:95], v27 offset:7616
    s_lshl_b32 s38, s45, 12
    s_lshl_b32 s39, s17, 8
    s_add_u32 s38, s38, s39
    s_waitcnt lgkmcnt(7)
    v_add_f32 v64, v64, v120
    v_add_f32 v65, v65, v121
    v_add_f32 v66, v66, v122
    v_add_f32 v67, v67, v123
    buffer_store_dwordx4 v[64:67], v28, s[24:27], s38 offen
    s_add_u32 s38, s38, 16384
    s_waitcnt lgkmcnt(6)
    v_add_f32 v68, v68, v124
    v_add_f32 v69, v69, v125
    v_add_f32 v70, v70, v126
    v_add_f32 v71, v71, v127
    buffer_store_dwordx4 v[68:71], v28, s[24:27], s38 offen
    s_add_u32 s38, s38, 16384
    s_waitcnt lgkmcnt(5)
    v_add_f32 v72, v72, v128
    v_add_f32 v73, v73, v129
    v_add_f32 v74, v74, v130
    v_add_f32 v75, v75, v131
    buffer_store_dwordx4 v[72:75], v28, s[24:27], s38 offen
    s_add_u32 s38, s38, 16384
    s_waitcnt lgkmcnt(4)
    v_add_f32 v76, v76, v132
    v_add_f32 v77, v77, v133
    v_add_f32 v78, v78, v134
    v_add_f32 v79, v79, v135
    buffer_store_dwordx4 v[76:79], v28, s[24:27], s38 offen
    s_add_u32 s38, s38, 16384
    s_waitcnt lgkmcnt(3)
    v_add_f32 v80, v80, v136
    v_add_f32 v81, v81, v137
    v_add_f32 v82, v82, v138
    v_add_f32 v83, v83, v139
    buffer_store_dwordx4 v[80:83], v28, s[24:27], s38 offen
    s_add_u32 s38, s38, 16384
    s_waitcnt lgkmcnt(2)
    v_add_f32 v84, v84, v140
    v_add_f32 v85, v85, v141
    v_add_f32 v86, v86, v142
    v_add_f32 v87, v87, v143
    buffer_store_dwordx4 v[84:87], v28, s[24:27], s38 offen
    s_add_u32 s38, s38, 16384
    s_waitcnt lgkmcnt(1)
    v_add_f32 v88, v88, v144
    v_add_f32 v89, v89, v145
    v_add_f32 v90, v90, v146
    v_add_f32 v91, v91, v147
    buffer_store_dwordx4 v[88:91], v28, s[24:27], s38 offen
    s_add_u32 s38, s38, 16384
    s_waitcnt lgkmcnt(0)
    v_add_f32 v92, v92, v148
    v_add_f32 v93, v93, v149
    v_add_f32 v94, v94, v150
    v_add_f32 v95, v95, v151
    buffer_store_dwordx4 v[92:95], v28, s[24:27], s38 offen
    s_add_u32 s38, s38, 16384
    s_endpgm
L_k2_side:
    s_load_dwordx2 s[28:29], s[0:1], 104
    s_load_dwordx2 s[30:31], s[0:1], 0
    s_load_dwordx4 s[40:43], s[0:1], 128
    s_sub_u32 s18, s18, 4
    v_and_b32 v2, 63, v0
    v_and_b32 v1, 255, v0
    s_lshr_b32 s22, s2, 2
    s_and_b32 s23, s2, 3
    s_and_b32 s3, s2, 7
    s_lshr_b32 s38, s2, 3
    s_lshr_b32 s16, s3, 1
    s_lshl_b32 s16, s16, 2
    s_and_b32 s39, s38, 3
    s_add_u32 s16, s16, s39
    s_and_b32 s17, s3, 1
    s_lshl_b32 s17, s17, 3
    s_lshr_b32 s39, s38, 2
    s_add_u32 s17, s17, s39
    s_and_b32 s58, s38, 3
    s_add_u32 s58, s58, 1
    v_lshrrev_b32 v3, 5, v1
    v_and_b32 v4, 31, v1
    v_mul_u32_u24 v5, 14336, v3
    v_lshl_add_u32 v5, v4, 3, v5
    v_lshrrev_b32 v6, 3, v2
    v_and_b32 v7, 7, v2
    v_and_b32 v8, 3, v6
    v_lshlrev_b32 v8, 1, v8
    v_xor_b32 v7, v7, v8
    v_lshlrev_b32 v6, 11, v6
    v_lshl_add_u32 v6, v7, 4, v6
    s_waitcnt lgkmcnt(0)
    s_mov_b32 s12, s42
    s_mov_b32 s13, s43
    s_mov_b32 s14, 16777216
    s_mov_b32 s15, 0x20000
    s_mov_b32 s8, s28
    s_mov_b32 s9, s29
    s_mov_b32 s10, 7340032
    s_mov_b32 s11, 0x20000
    s_mov_b32 s4, s30
    s_mov_b32 s5, s31
    s_mov_b32 s6, 4194304
    s_mov_b32 s7, 0x20000
    s_add_u32 s46, s42, 9461760
    s_addc_u32 s47, s43, 0
    s_load_dwordx8 s[48:55], s[46:47], 0
    s_mov_b32 s59, 13
    s_cmp_ge_u32 s2, 224
    s_cbranch_scc1 L_k2s_cons
    s_sub_u32 s59, s59, s58
    s_sub_u32 s59, s59, 6
L_k2s_prel:
    s_cmp_eq_u32 s58, 0
    s_cbranch_scc1 L_k2s_pred
    s_barrier
    s_sub_u32 s58, s58, 1
    s_branch L_k2s_prel
L_k2s_pred:
    s_lshl_b32 s38, s22, 8
    s_add_u32 s38, s38, 10485760
    buffer_load_dwordx2 v[16:17], v5, s[12:15], s38 offen
    s_add_u32 s38, s38, 114688
    buffer_load_dwordx2 v[18:19], v5, s[12:15], s38 offen
    s_add_u32 s38, s38, 114688
    buffer_load_dwordx2 v[20:21], v5, s[12:15], s38 offen
    s_add_u32 s38, s38, 114688
    buffer_load_dwordx2 v[22:23], v5, s[12:15], s38 offen
    s_add_u32 s38, s38, 114688
    buffer_load_dwordx2 v[24:25], v5, s[12:15], s38 offen
    s_add_u32 s38, s38, 114688
    buffer_load_dwordx2 v[26:27], v5, s[12:15], s38 offen
    s_add_u32 s38, s38, 114688
    buffer_load_dwordx2 v[28:29], v5, s[12:15], s38 offen
    s_add_u32 s38, s38, 114688
    buffer_load_dwordx2 v[30:31], v5, s[12:15], s38 offen
    s_add_u32 s38, s38, 114688
    s_lshl_b32 s38, s22, 17
    s_lshl_b32 s39, s23, 9
    s_add_u32 s38, s38, s39
    s_lshl_b32 s39, s18, 7
    s_add_u32 s38, s38, s39
    s_lshl_b32 s39, s18, 13
    s_add_u32 s39, s39, 81920
    s_add_u32 m0, s39, 0
    s_nop 0
    buffer_load_dwordx4 v6, s[8:11], s38 offen lds
    s_add_u32 s38, s38, 16384
    s_add_u32 m0, s39, 1024
    s_nop 0
    buffer_load_dwordx4 v6, s[8:11], s38 offen lds
    s_add_u32 s38, s38, 16384
    s_add_u32 m0, s39, 2048
    s_nop 0
    buffer_load_dwordx4 v6, s[8:11], s38 offen lds
    s_add_u32 s38, s38, 16384
    s_add_u32 m0, s39, 3072
    s_nop 0
    buffer_load_dwordx4 v6, s[8:11], s38 offen lds
    s_add_u32 s38, s38, 16384
    s_add_u32 m0, s39, 4096
    s_nop 0
    buffer_load_dwordx4 v6, s[8:11], s38 offen lds
    s_add_u32 s38, s38, 16384
    s_add_u32 m0, s39, 5120
    s_nop 0
    buffer_load_dwordx4 v6, s[8:11], s38 offen lds
    s_add_u32 s38, s38, 16384
    s_add_u32 m0, s39, 6144
    s_nop 0
    buffer_load_dwordx4 v6, s[8:11], s38 offen lds
    s_add_u32 s38, s38, 16384
    s_add_u32 m0, s39, 7168
    s_nop 0
    buffer_load_dwordx4 v6, s[8:11], s38 offen lds
    s_add_u32 s38, s38, 16384
    s_barrier
    s_barrier
    s_waitcnt vmcnt(8)
    v_add_f32 v16, v16, v20
    v_add_f32 v24, v24, v28
    v_add_f32 v16, v16, v24
    v_cvt_pk_bf16_f32 v16, v16, v16
    v_lshlrev_b32 v16, 16, v16
    v_add_f32 v17, v17, v21
    v_add_f32 v25, v25, v29
    v_add_f32 v17, v17, v25
    v_cvt_pk_bf16_f32 v17, v17, v17
    v_lshlrev_b32 v17, 16, v17
    v_add_f32 v18, v18, v22
    v_add_f32 v26, v26, v30
    v_add_f32 v18, v18, v26
    v_cvt_pk_bf16_f32 v18, v18, v18
    v_lshlrev_b32 v18, 16, v18
    v_add_f32 v19, v19, v23
    v_add_f32 v27, v27, v31
    v_add_f32 v19, v19, v27
    v_cvt_pk_bf16_f32 v19, v19, v19
    v_lshlrev_b32 v19, 16, v19
    v_mul_f32 v32, 0xbfb8aa3b, v16
    v_exp_f32 v32, v32
    s_nop 0
    v_add_f32 v32, 1.0, v32
    v_rcp_f32 v32, v32
    s_nop 0
    v_mul_f32 v32, v32, v16
    v_cvt_pk_bf16_f32 v32, v32, v32
    v_lshlrev_b32 v32, 16, v32
    v_mul_f32 v32, v32, v18
    v_mul_f32 v33, 0xbfb8aa3b, v17
    v_exp_f32 v33, v33
    s_nop 0
    v_add_f32 v33, 1.0, v33
    v_rcp_f32 v33, v33
    s_nop 0
    v_mul_f32 v33, v33, v17
    v_cvt_pk_bf16_f32 v33, v33, v33
    v_lshlrev_b32 v33, 16, v33
    v_mul_f32 v33, v33, v19
    v_cvt_pk_bf16_f32 v32, v32, v33
    v_mul_u32_u24 v9, 144, v3
    v_lshl_add_u32 v9, v4, 2, v9
    v_add_u32 v9, 114688, v9
    ds_write_b32 v9, v32
    v_and_b32 v10, 7, v2
    v_mul_u32_u24 v10, 144, v10
    v_lshrrev_b32 v11, 4, v2
    v_lshl_add_u32 v10, v11, 4, v10
    v_add_u32 v10, 114688, v10
    v_bfe_u32 v12, v2, 2, 2
    v_lshl_add_u32 v13, v11, 3, v12
    v_lshlrev_b32 v13, 7, v13
    v_and_b32 v14, 3, v2
    v_lshl_add_u32 v13, v14, 3, v13
    v_add_u32 v13, s39, v13
    v_xor_b32 v14, 0, v12
    v_lshl_add_u32 v36, v14, 5, v13
    v_xor_b32 v14, 1, v12
    v_lshl_add_u32 v37, v14, 5, v13
    v_xor_b32 v14, 2, v12
    v_lshl_add_u32 v38, v14, 5, v13
    v_xor_b32 v14, 3, v12
    v_lshl_add_u32 v39, v14, 5, v13
    s_waitcnt lgkmcnt(0)
    s_barrier
    s_waitcnt vmcnt(0)
    ds_read_b128 v[40:43], v10
    ds_read_b128 v[44:47], v10 offset:64
    ds_read_b64_tr_b16 v[64:65], v36 offset:0
    ds_read_b64_tr_b16 v[66:67], v36 offset:512
    ds_read_b64_tr_b16 v[68:69], v36 offset:4096
    ds_read_b64_tr_b16 v[70:71], v36 offset:4608
    ds_read_b64_tr_b16 v[72:73], v37 offset:0
    ds_read_b64_tr_b16 v[74:75], v37 offset:512
    ds_read_b64_tr_b16 v[76:77], v37 offset:4096
    ds_read_b64_tr_b16 v[78:79], v37 offset:4608
    ds_read_b64_tr_b16 v[80:81], v38 offset:0
    ds_read_b64_tr_b16 v[82:83], v38 offset:512
    ds_read_b64_tr_b16 v[84:85], v38 offset:4096
    ds_read_b64_tr_b16 v[86:87], v38 offset:4608
    ds_read_b64_tr_b16 v[88:89], v39 offset:0
    ds_read_b64_tr_b16 v[90:91], v39 offset:512
    ds_read_b64_tr_b16 v[92:93], v39 offset:4096
    ds_read_b64_tr_b16 v[94:95], v39 offset:4608
    s_waitcnt lgkmcnt(0)
    v_mfma_f32_16x16x32_bf16 v[48:51], v[64:67], v[40:43], 0
    v_mfma_f32_16x16x32_bf16 v[52:55], v[72:75], v[40:43], 0
    v_mfma_f32_16x16x32_bf16 v[56:59], v[80:83], v[40:43], 0
    v_mfma_f32_16x16x32_bf16 v[60:63], v[88:91], v[40:43], 0
    v_mfma_f32_16x16x32_bf16 v[48:51], v[68:71], v[44:47], v[48:51]
    v_mfma_f32_16x16x32_bf16 v[52:55], v[76:79], v[44:47], v[52:55]
    v_mfma_f32_16x16x32_bf16 v[56:59], v[84:87], v[44:47], v[56:59]
    v_mfma_f32_16x16x32_bf16 v[60:63], v[92:95], v[44:47], v[60:63]
    v_and_b32 v14, 15, v2
    s_mov_b32 s38, 229376
    v_mul_lo_u32 v15, v14, s38
    v_lshl_add_u32 v15, v11, 4, v15
    s_lshl_b32 s38, s22, 12
    s_lshl_b32 s39, s23, 10
    s_add_u32 s38, s38, s39
    s_lshl_b32 s39, s18, 8
    s_add_u32 s38, s38, s39
    s_add_u32 s38, s38, 13631488
    v_cmp_gt_u32 vcc, 8, v14
    s_nop 4
    s_mov_b64 exec, vcc
    buffer_store_dwordx4 v[48:51], v15, s[12:15], s38 offen offset:0 sc1
    buffer_store_dwordx4 v[52:55], v15, s[12:15], s38 offen offset:64 sc1
    buffer_store_dwordx4 v[56:59], v15, s[12:15], s38 offen offset:128 sc1
    buffer_store_dwordx4 v[60:63], v15, s[12:15], s38 offen offset:192 sc1
    s_mov_b64 exec, -1
    s_barrier
    s_barrier
    s_waitcnt vmcnt(0)
    s_barrier
    s_cmp_lg_u32 s18, 0
    s_cbranch_scc1 L_k2s_cons
    s_lshl_b32 s38, s23, 2
    v_mov_b32 v4, s38
    v_mov_b32 v5, 1
    s_mov_b64 exec, 1
    global_atomic_add v4, v5, s[40:41] sc1
    s_mov_b64 exec, -1
L_k2s_cons:
    s_waitcnt lgkmcnt(0)
    s_mov_b32 m0, s18
    s_lshl_b32 s45, s16, 7
    s_movrels_b32 s24, s48
    s_movrels_b32 s25, s52
    s_and_b32 s26, s24, 0x7ff
    s_sub_u32 s26, 2047, s26
    s_sub_u32 s56, s26, s45
    s_and_b32 s27, s25, 0x7ff
    s_sub_u32 s27, 2047, s27
    s_sub_u32 s57, s27, s45
    s_min_u32 s38, s56, s57
    s_cmp_ge_u32 s38, 128
    s_cbranch_scc1 L_k2s_end
L_k2s_cl:
    s_cmp_eq_u32 s59, 0
    s_cbranch_scc1 L_k2s_cd
    s_barrier
    s_sub_u32 s59, s59, 1
    s_branch L_k2s_cl
L_k2s_cd:
    s_lshr_b32 s39, s17, 2
    s_lshl_b32 s39, s39, 2
    v_mov_b32 v4, s39
    global_load_dword v5, v4, s[40:41] sc1
    v_lshrrev_b32 v6, 4, v2
    v_and_b32 v7, 15, v2
    v_lshlrev_b32 v8, 12, v6
    v_lshl_add_u32 v8, v7, 4, v8
    v_lshlrev_b32 v9, 3, v7
    v_mov_b32 v10, 0
    s_mov_b32 s23, 0xffff0000
    s_barrier
L_k2s_poll:
    s_waitcnt vmcnt(0)
    v_readfirstlane_b32 s39, v5
    s_nop 1
    s_cmp_ge_u32 s39, 56
    s_cbranch_scc1 L_k2s_go
    s_sleep 4
    global_load_dword v5, v4, s[40:41] sc1
    s_branch L_k2s_poll
L_k2s_go:
    s_cmp_ge_u32 s56, 128
    s_cbranch_scc1 L_k2s_sk0
    s_add_u32 s39, s18, 0
    s_mul_i32 s39, s39, 229376
    s_lshl_b32 s3, s17, 8
    s_add_u32 s39, s39, s3
    s_add_u32 s39, s39, 13631488
    buffer_load_dwordx4 v[16:19], v8, s[12:15], s39 offen sc1
    s_add_u32 s39, s39, 16384
    buffer_load_dwordx4 v[20:23], v8, s[12:15], s39 offen sc1
    s_add_u32 s39, s39, 16384
    buffer_load_dwordx4 v[24:27], v8, s[12:15], s39 offen sc1
    s_add_u32 s39, s39, 16384
    buffer_load_dwordx4 v[28:31], v8, s[12:15], s39 offen sc1
    s_add_u32 s39, s39, 16384
    buffer_load_dwordx4 v[32:35], v8, s[12:15], s39 offen sc1
    s_add_u32 s39, s39, 16384
    buffer_load_dwordx4 v[36:39], v8, s[12:15], s39 offen sc1
    s_add_u32 s39, s39, 16384
    buffer_load_dwordx4 v[40:43], v8, s[12:15], s39 offen sc1
    s_add_u32 s39, s39, 16384
    buffer_load_dwordx4 v[44:47], v8, s[12:15], s39 offen sc1
    s_add_u32 s39, s39, 16384
    buffer_load_dwordx4 v[48:51], v8, s[12:15], s39 offen sc1
    s_add_u32 s39, s39, 16384
    buffer_load_dwordx4 v[52:55], v8, s[12:15], s39 offen sc1
    s_add_u32 s39, s39, 16384
    buffer_load_dwordx4 v[56:59], v8, s[12:15], s39 offen sc1
    s_add_u32 s39, s39, 16384
    buffer_load_dwordx4 v[60:63], v8, s[12:15], s39 offen sc1
    s_add_u32 s39, s39, 16384
    buffer_load_dwordx4 v[64:67], v8, s[12:15], s39 offen sc1
    s_add_u32 s39, s39, 16384
    buffer_load_dwordx4 v[68:71], v8, s[12:15], s39 offen sc1
    s_add_u32 s39, s39, 16384
    s_lshl_b32 s39, s26, 11
    s_lshl_b32 s3, s17, 7
    s_add_u32 s39, s39, s3
    buffer_load_dwordx2 v[72:73], v9, s[4:7], s39 offen
    s_lshl_b32 s39, s26, 2
    s_add_u32 s39, s39, 9453568
    buffer_load_dword v74, v10, s[12:15], s39 offen
L_k2s_sk0:
    s_cmp_ge_u32 s57, 128
    s_cbranch_scc1 L_k2s_sk1
    s_add_u32 s39, s18, 4
    s_mul_i32 s39, s39, 229376
    s_lshl_b32 s3, s17, 8
    s_add_u32 s39, s39, s3
    s_add_u32 s39, s39, 13631488
    buffer_load_dwordx4 v[80:83], v8, s[12:15], s39 offen sc1
    s_add_u32 s39, s39, 16384
    buffer_load_dwordx4 v[84:87], v8, s[12:15], s39 offen sc1
    s_add_u32 s39, s39, 16384
    buffer_load_dwordx4 v[88:91], v8, s[12:15], s39 offen sc1
    s_add_u32 s39, s39, 16384
    buffer_load_dwordx4 v[92:95], v8, s[12:15], s39 offen sc1
    s_add_u32 s39, s39, 16384
    buffer_load_dwordx4 v[96:99], v8, s[12:15], s39 offen sc1
    s_add_u32 s39, s39, 16384
    buffer_load_dwordx4 v[100:103], v8, s[12:15], s39 offen sc1
    s_add_u32 s39, s39, 16384
    buffer_load_dwordx4 v[104:107], v8, s[12:15], s39 offen sc1
    s_add_u32 s39, s39, 16384
    buffer_load_dwordx4 v[108:111], v8, s[12:15], s39 offen sc1
    s_add_u32 s39, s39, 16384
    buffer_load_dwordx4 v[112:115], v8, s[12:15], s39 offen sc1
    s_add_u32 s39, s39, 16384
    buffer_load_dwordx4 v[116:119], v8, s[12:15], s39 offen sc1
    s_add_u32 s39, s39, 16384
    buffer_load_dwordx4 v[120:123], v8, s[12:15], s39 offen sc1
    s_add_u32 s39, s39, 16384
    buffer_load_dwordx4 v[124:127], v8, s[12:15], s39 offen sc1
    s_add_u32 s39, s39, 16384
    buffer_load_dwordx4 v[128:131], v8, s[12:15], s39 offen sc1
    s_add_u32 s39, s39, 16384
    buffer_load_dwordx4 v[132:135], v8, s[12:15], s39 offen sc1
    s_add_u32 s39, s39, 16384
    s_lshl_b32 s39, s27, 11
    s_lshl_b32 s3, s17, 7
    s_add_u32 s39, s39, s3
    buffer_load_dwordx2 v[136:137], v9, s[4:7], s39 offen
    s_lshl_b32 s39, s27, 2
    s_add_u32 s39, s39, 9453568
    buffer_load_dword v138, v10, s[12:15], s39 offen
L_k2s_sk1:
    s_barrier
    s_barrier
    s_waitcnt vmcnt(0)
    s_cmp_ge_u32 s56, 128
    s_cbranch_scc1 L_k2s_sc0
    s_ashr_i32 s39, s24, 31
    s_not_b32 s39, s39
    s_or_b32 s39, s39, 0x80000000
    s_xor_b32 s39, s24, s39
    s_and_b32 s39, s39, 0xffff0000
    v_mov_b32 v78, s39
    v_mul_f32 v75, 0xbfb8aa3b, v78
    v_exp_f32 v75, v75
    s_nop 0
    v_add_f32 v75, 1.0, v75
    v_rcp_f32 v75, v75
    s_nop 0
    v_cvt_pk_bf16_f32 v75, v75, v75
    v_lshlrev_b32 v75, 16, v75
    v_add_f32 v16, v16, v20
    v_add_f32 v17, v17, v21
    v_add_f32 v18, v18, v22
    v_add_f32 v19, v19, v23
    v_add_f32 v16, v16, v24
    v_add_f32 v17, v17, v25
    v_add_f32 v18, v18, v26
    v_add_f32 v19, v19, v27
    v_add_f32 v16, v16, v28
    v_add_f32 v17, v17, v29
    v_add_f32 v18, v18, v30
    v_add_f32 v19, v19, v31
    v_add_f32 v16, v16, v32
    v_add_f32 v17, v17, v33
    v_add_f32 v18, v18, v34
    v_add_f32 v19, v19, v35
    v_add_f32 v16, v16, v36
    v_add_f32 v17, v17, v37
    v_add_f32 v18, v18, v38
    v_add_f32 v19, v19, v39
    v_add_f32 v16, v16, v40
    v_add_f32 v17, v17, v41
    v_add_f32 v18, v18, v42
    v_add_f32 v19, v19, v43
    v_add_f32 v16, v16, v44
    v_add_f32 v17, v17, v45
    v_add_f32 v18, v18, v46
    v_add_f32 v19, v19, v47
    v_add_f32 v16, v16, v48
    v_add_f32 v17, v17, v49
    v_add_f32 v18, v18, v50
    v_add_f32 v19, v19, v51
    v_add_f32 v16, v16, v52
    v_add_f32 v17, v17, v53
    v_add_f32 v18, v18, v54
    v_add_f32 v19, v19, v55
    v_add_f32 v16, v16, v56
    v_add_f32 v17, v17, v57
    v_add_f32 v18, v18, v58
    v_add_f32 v19, v19, v59
    v_add_f32 v16, v16, v60
    v_add_f32 v17, v17, v61
    v_add_f32 v18, v18, v62
    v_add_f32 v19, v19, v63
    v_add_f32 v16, v16, v64
    v_add_f32 v17, v17, v65
    v_add_f32 v18, v18, v66
    v_add_f32 v19, v19, v67
    v_add_f32 v16, v16, v68
    v_add_f32 v17, v17, v69
    v_add_f32 v18, v18, v70
    v_add_f32 v19, v19, v71
    v_mov_b32 v20, v16
    v_mov_b32 v21, v17
    v_mov_b32 v22, v18
    v_mov_b32 v23, v19
    s_nop 1
    v_permlane16_swap_b32 v16, v20
    v_permlane16_swap_b32 v17, v21
    v_permlane16_swap_b32 v18, v22
    v_permlane16_swap_b32 v19, v23
    s_nop 1
    v_add_f32 v16, v16, v20
    v_add_f32 v17, v17, v21
    v_add_f32 v18, v18, v22
    v_add_f32 v19, v19, v23
    v_mov_b32 v20, v16
    v_mov_b32 v21, v17
    v_mov_b32 v22, v18
    v_mov_b32 v23, v19
    s_nop 1
    v_permlane32_swap_b32 v16, v20
    v_permlane32_swap_b32 v17, v21
    v_permlane32_swap_b32 v18, v22
    v_permlane32_swap_b32 v19, v23
    s_nop 1
    v_add_f32 v16, v16, v20
    v_add_f32 v17, v17, v21
    v_add_f32 v18, v18, v22
    v_add_f32 v19, v19, v23
    v_sub_f32 v74, 1.0, v74
    v_cvt_pk_bf16_f32 v74, v74, v74
    v_lshlrev_b32 v74, 16, v74
    v_lshlrev_b32 v24, 16, v72
    v_and_b32 v25, s23, v72
    v_lshlrev_b32 v26, 16, v73
    v_and_b32 v27, s23, v73
    v_cvt_pk_bf16_f32 v16, v16, v16
    v_lshlrev_b32 v16, 16, v16
    v_mul_f32 v16, v16, v75
    v_cvt_pk_bf16_f32 v16, v16, v16
    v_lshlrev_b32 v16, 16, v16
    v_add_f32 v16, v16, v24
    v_cvt_pk_bf16_f32 v16, v16, v16
    v_lshlrev_b32 v16, 16, v16
    v_mul_f32 v16, v16, v74
    v_cvt_pk_bf16_f32 v16, v16, v16
    v_lshlrev_b32 v16, 16, v16
    v_mul_f32 v24, v24, v74
    v_cvt_pk_bf16_f32 v24, v24, v24
    v_lshlrev_b32 v24, 16, v24
    v_sub_f32 v16, v16, v24
    v_cvt_pk_bf16_f32 v17, v17, v17
    v_lshlrev_b32 v17, 16, v17
    v_mul_f32 v17, v17, v75
    v_cvt_pk_bf16_f32 v17, v17, v17
    v_lshlrev_b32 v17, 16, v17
    v_add_f32 v17, v17, v25
    v_cvt_pk_bf16_f32 v17, v17, v17
    v_lshlrev_b32 v17, 16, v17
    v_mul_f32 v17, v17, v74
    v_cvt_pk_bf16_f32 v17, v17, v17
    v_lshlrev_b32 v17, 16, v17
    v_mul_f32 v25, v25, v74
    v_cvt_pk_bf16_f32 v25, v25, v25
    v_lshlrev_b32 v25, 16, v25
    v_sub_f32 v17, v17, v25
    v_cvt_pk_bf16_f32 v18, v18, v18
    v_lshlrev_b32 v18, 16, v18
    v_mul_f32 v18, v18, v75
    v_cvt_pk_bf16_f32 v18, v18, v18
    v_lshlrev_b32 v18, 16, v18
    v_add_f32 v18, v18, v26
    v_cvt_pk_bf16_f32 v18, v18, v18
    v_lshlrev_b32 v18, 16, v18
    v_mul_f32 v18, v18, v74
    v_cvt_pk_bf16_f32 v18, v18, v18
    v_lshlrev_b32 v18, 16, v18
    v_mul_f32 v26, v26, v74
    v_cvt_pk_bf16_f32 v26, v26, v26
    v_lshlrev_b32 v26, 16, v26
    v_sub_f32 v18, v18, v26
    v_cvt_pk_bf16_f32 v19, v19, v19
    v_lshlrev_b32 v19, 16, v19
    v_mul_f32 v19, v19, v75
    v_cvt_pk_bf16_f32 v19, v19, v19
    v_lshlrev_b32 v19, 16, v19
    v_add_f32 v19, v19, v27
    v_cvt_pk_bf16_f32 v19, v19, v19
    v_lshlrev_b32 v19, 16, v19
    v_mul_f32 v19, v19, v74
    v_cvt_pk_bf16_f32 v19, v19, v19
    v_lshlrev_b32 v19, 16, v19
    v_mul_f32 v27, v27, v74
    v_cvt_pk_bf16_f32 v27, v27, v27
    v_lshlrev_b32 v27, 16, v27
    v_sub_f32 v19, v19, v27
    s_lshl_b32 s39, s18, 8
    s_add_u32 s39, s39, 116736
    v_lshl_add_u32 v76, v7, 4, s39
    ds_write_b128 v76, v[16:19]
L_k2s_sc0:
    s_cmp_ge_u32 s57, 128
    s_cbranch_scc1 L_k2s_sc1
    s_ashr_i32 s39, s25, 31
    s_not_b32 s39, s39
    s_or_b32 s39, s39, 0x80000000
    s_xor_b32 s39, s25, s39
    s_and_b32 s39, s39, 0xffff0000
    v_mov_b32 v142, s39
    v_mul_f32 v139, 0xbfb8aa3b, v142
    v_exp_f32 v139, v139
    s_nop 0
    v_add_f32 v139, 1.0, v139
    v_rcp_f32 v139, v139
    s_nop 0
    v_cvt_pk_bf16_f32 v139, v139, v139
    v_lshlrev_b32 v139, 16, v139
    v_add_f32 v80, v80, v84
    v_add_f32 v81, v81, v85
    v_add_f32 v82, v82, v86
    v_add_f32 v83, v83, v87
    v_add_f32 v80, v80, v88
    v_add_f32 v81, v81, v89
    v_add_f32 v82, v82, v90
    v_add_f32 v83, v83, v91
    v_add_f32 v80, v80, v92
    v_add_f32 v81, v81, v93
    v_add_f32 v82, v82, v94
    v_add_f32 v83, v83, v95
    v_add_f32 v80, v80, v96
    v_add_f32 v81, v81, v97
    v_add_f32 v82, v82, v98
    v_add_f32 v83, v83, v99
    v_add_f32 v80, v80, v100
    v_add_f32 v81, v81, v101
    v_add_f32 v82, v82, v102
    v_add_f32 v83, v83, v103
    v_add_f32 v80, v80, v104
    v_add_f32 v81, v81, v105
    v_add_f32 v82, v82, v106
    v_add_f32 v83, v83, v107
    v_add_f32 v80, v80, v108
    v_add_f32 v81, v81, v109
    v_add_f32 v82, v82, v110
    v_add_f32 v83, v83, v111
    v_add_f32 v80, v80, v112
    v_add_f32 v81, v81, v113
    v_add_f32 v82, v82, v114
    v_add_f32 v83, v83, v115
    v_add_f32 v80, v80, v116
    v_add_f32 v81, v81, v117
    v_add_f32 v82, v82, v118
    v_add_f32 v83, v83, v119
    v_add_f32 v80, v80, v120
    v_add_f32 v81, v81, v121
    v_add_f32 v82, v82, v122
    v_add_f32 v83, v83, v123
    v_add_f32 v80, v80, v124
    v_add_f32 v81, v81, v125
    v_add_f32 v82, v82, v126
    v_add_f32 v83, v83, v127
    v_add_f32 v80, v80, v128
    v_add_f32 v81, v81, v129
    v_add_f32 v82, v82, v130
    v_add_f32 v83, v83, v131
    v_add_f32 v80, v80, v132
    v_add_f32 v81, v81, v133
    v_add_f32 v82, v82, v134
    v_add_f32 v83, v83, v135
    v_mov_b32 v84, v80
    v_mov_b32 v85, v81
    v_mov_b32 v86, v82
    v_mov_b32 v87, v83
    s_nop 1
    v_permlane16_swap_b32 v80, v84
    v_permlane16_swap_b32 v81, v85
    v_permlane16_swap_b32 v82, v86
    v_permlane16_swap_b32 v83, v87
    s_nop 1
    v_add_f32 v80, v80, v84
    v_add_f32 v81, v81, v85
    v_add_f32 v82, v82, v86
    v_add_f32 v83, v83, v87
    v_mov_b32 v84, v80
    v_mov_b32 v85, v81
    v_mov_b32 v86, v82
    v_mov_b32 v87, v83
    s_nop 1
    v_permlane32_swap_b32 v80, v84
    v_permlane32_swap_b32 v81, v85
    v_permlane32_swap_b32 v82, v86
    v_permlane32_swap_b32 v83, v87
    s_nop 1
    v_add_f32 v80, v80, v84
    v_add_f32 v81, v81, v85
    v_add_f32 v82, v82, v86
    v_add_f32 v83, v83, v87
    v_sub_f32 v138, 1.0, v138
    v_cvt_pk_bf16_f32 v138, v138, v138
    v_lshlrev_b32 v138, 16, v138
    v_lshlrev_b32 v88, 16, v136
    v_and_b32 v89, s23, v136
    v_lshlrev_b32 v90, 16, v137
    v_and_b32 v91, s23, v137
    v_cvt_pk_bf16_f32 v80, v80, v80
    v_lshlrev_b32 v80, 16, v80
    v_mul_f32 v80, v80, v139
    v_cvt_pk_bf16_f32 v80, v80, v80
    v_lshlrev_b32 v80, 16, v80
    v_add_f32 v80, v80, v88
    v_cvt_pk_bf16_f32 v80, v80, v80
    v_lshlrev_b32 v80, 16, v80
    v_mul_f32 v80, v80, v138
    v_cvt_pk_bf16_f32 v80, v80, v80
    v_lshlrev_b32 v80, 16, v80
    v_mul_f32 v88, v88, v138
    v_cvt_pk_bf16_f32 v88, v88, v88
    v_lshlrev_b32 v88, 16, v88
    v_sub_f32 v80, v80, v88
    v_cvt_pk_bf16_f32 v81, v81, v81
    v_lshlrev_b32 v81, 16, v81
    v_mul_f32 v81, v81, v139
    v_cvt_pk_bf16_f32 v81, v81, v81
    v_lshlrev_b32 v81, 16, v81
    v_add_f32 v81, v81, v89
    v_cvt_pk_bf16_f32 v81, v81, v81
    v_lshlrev_b32 v81, 16, v81
    v_mul_f32 v81, v81, v138
    v_cvt_pk_bf16_f32 v81, v81, v81
    v_lshlrev_b32 v81, 16, v81
    v_mul_f32 v89, v89, v138
    v_cvt_pk_bf16_f32 v89, v89, v89
    v_lshlrev_b32 v89, 16, v89
    v_sub_f32 v81, v81, v89
    v_cvt_pk_bf16_f32 v82, v82, v82
    v_lshlrev_b32 v82, 16, v82
    v_mul_f32 v82, v82, v139
    v_cvt_pk_bf16_f32 v82, v82, v82
    v_lshlrev_b32 v82, 16, v82
    v_add_f32 v82, v82, v90
    v_cvt_pk_bf16_f32 v82, v82, v82
    v_lshlrev_b32 v82, 16, v82
    v_mul_f32 v82, v82, v138
    v_cvt_pk_bf16_f32 v82, v82, v82
    v_lshlrev_b32 v82, 16, v82
    v_mul_f32 v90, v90, v138
    v_cvt_pk_bf16_f32 v90, v90, v90
    v_lshlrev_b32 v90, 16, v90
    v_sub_f32 v82, v82, v90
    v_cvt_pk_bf16_f32 v83, v83, v83
    v_lshlrev_b32 v83, 16, v83
    v_mul_f32 v83, v83, v139
    v_cvt_pk_bf16_f32 v83, v83, v83
    v_lshlrev_b32 v83, 16, v83
    v_add_f32 v83, v83, v91
    v_cvt_pk_bf16_f32 v83, v83, v83
    v_lshlrev_b32 v83, 16, v83
    v_mul_f32 v83, v83, v138
    v_cvt_pk_bf16_f32 v83, v83, v83
    v_lshlrev_b32 v83, 16, v83
    v_mul_f32 v91, v91, v138
    v_cvt_pk_bf16_f32 v91, v91, v91
    v_lshlrev_b32 v91, 16, v91
    v_sub_f32 v83, v83, v91
    s_lshl_b32 s39, s18, 8
    s_add_u32 s39, s39, 117760
    v_lshl_add_u32 v140, v7, 4, s39
    ds_write_b128 v140, v[80:83]
L_k2s_sc1:
    s_waitcnt lgkmcnt(0)
    s_barrier
L_k2s_end:
    s_endpgm
.section .rodata,"a"
.p2align 6
.amdhsa_kernel k1_kernel
  .amdhsa_next_free_vgpr 256
  .amdhsa_next_free_sgpr 96
  .amdhsa_accum_offset 256
  .amdhsa_group_segment_fixed_size 0
  .amdhsa_kernarg_size 144
  .amdhsa_user_sgpr_count 2
  .amdhsa_user_sgpr_kernarg_segment_ptr 1
  .amdhsa_system_sgpr_workgroup_id_x 1
  .amdhsa_float_denorm_mode_32 3
.end_amdhsa_kernel
.p2align 6
.amdhsa_kernel k2_kernel
  .amdhsa_next_free_vgpr 256
  .amdhsa_next_free_sgpr 96
  .amdhsa_accum_offset 256
  .amdhsa_group_segment_fixed_size 0
  .amdhsa_kernarg_size 144
  .amdhsa_user_sgpr_count 2
  .amdhsa_user_sgpr_kernarg_segment_ptr 1
  .amdhsa_system_sgpr_workgroup_id_x 1
  .amdhsa_float_denorm_mode_32 3
.end_amdhsa_kernel
```

```asm
; @launch grid=(256,1,1) block=(512,1,1) lds=163840
.amdgcn_target "amdgcn-amd-amdhsa--gfx950"
.text
.globl gated_mix__ssm_conv_s5__moe_arch_mod__prompt_kernel
.p2align 8
.type gated_mix__ssm_conv_s5__moe_arch_mod__prompt_kernel,@function
gated_mix__ssm_conv_s5__moe_arch_mod__prompt_kernel:
L_code_start:
    v_lshrrev_b32 v1, 6, v0
    s_cmp_ge_u32 s2, 256
    s_cbranch_scc1 L_exit
    v_readfirstlane_b32 s18, v1
    s_mov_b32 s96, 1048576
    s_nop 0
    s_cmp_ge_u32 s18, 4
    s_cbranch_scc1 L_side
L_gemm:
    s_load_dwordx2 s[40:41], s[0:1], 0
    s_load_dwordx8 s[44:51], s[0:1], 8
    s_load_dwordx8 s[52:59], s[0:1], 40
    s_load_dwordx2 s[42:43], s[0:1], 136
    s_load_dwordx2 s[36:37], s[0:1], 120
    s_setprio 1
    v_and_b32 v24, 63, v0
    s_and_b32 s3, s2, 7
    s_sub_u32 s39, 11, s3
    s_cmp_lt_u32 s3, 4
    s_cselect_b32 s3, s3, s39
    s_lshr_b32 s38, s2, 3
    s_lshl_b32 s16, s3, 1
    s_and_b32 s39, s38, 1
    s_add_u32 s16, s16, s39
    s_lshr_b32 s17, s38, 1
    s_and_b32 s19, s18, 1
    s_lshr_b32 s20, s18, 1
    s_mul_i32 s22, s3, 2
    s_mul_i32 s38, s16, 0
    s_add_u32 s22, s22, s38
    s_mul_i32 s38, s17, 1
    s_add_u32 s22, s22, s38
    s_lshl_b32 s22, s22, 7
    s_lshl_b32 s23, s18, 12
    v_lshrrev_b32 v25, 4, v24
    v_and_b32 v26, 15, v24
    v_lshrrev_b32 v56, 3, v24
    v_and_b32 v57, 7, v24
    v_lshrrev_b32 v58, 1, v56
    v_xor_b32 v57, v57, v58
    v_lshlrev_b32 v57, 4, v57
    v_lshrrev_b32 v58, 2, v56
    v_lshlrev_b32 v58, 4, v58
    v_and_b32 v59, 1, v56
    v_lshl_add_u32 v58, v59, 3, v58
    v_bfe_u32 v59, v56, 1, 1
    v_add_u32 v58, v58, v59
    s_lshl_b32 s38, s20, 6
    s_lshl_b32 s39, s19, 2
    s_add_u32 s38, s38, s39
    s_lshl_b32 s39, s16, 7
    s_add_u32 s38, s38, s39
    v_add_u32 v58, s38, v58
    v_lshl_add_u32 v58, v58, 11, v57
    v_xor_b32 v59, 64, v58
    v_add_u32 v8, 3072, v58
    v_add_u32 v9, 67584, v59
    v_add_u32 v10, 5120, v58
    v_add_u32 v11, 69632, v59
    s_lshl_b32 s38, s17, 6
    s_lshl_b32 s39, s20, 5
    s_add_u32 s38, s38, s39
    v_add_u32 v58, s38, v56
    v_lshl_add_u32 v58, v58, 11, v57
    v_xor_b32 v59, 64, v58
    v_add_u32 v12, 3072, v58
    v_add_u32 v13, 18432, v59
    v_add_u32 v14, 33792, v58
    v_add_u32 v15, 49152, v59
    v_add_lshl_u32 v255, s38, v26, 1
    s_waitcnt lgkmcnt(0)
    s_sub_u32 s4, s40, 3072
    s_subb_u32 s5, s41, 0
    s_mov_b32 s6, 4197376
    s_mov_b32 s7, 0x20000
    s_cmp_eq_u32 s19, 0
    s_cselect_b32 s8, s48, s50
    s_cselect_b32 s9, s49, s51
    s_sub_u32 s8, s8, 3072
    s_subb_u32 s9, s9, 0
    s_mov_b32 s10, 2100224
    s_mov_b32 s11, 0x20000
    s_add_u32 m0, s23, 0
    s_add_u32 s21, s22, 0
    s_and_b32 s21, s21, 2047
    buffer_load_dwordx4 v8, s[4:7], s21 offen offset:0 lds
    buffer_load_dwordx4 v9, s[4:7], s21 offen offset:1024 lds
    buffer_load_dwordx4 v10, s[4:7], s21 offen offset:2048 lds
    buffer_load_dwordx4 v11, s[4:7], s21 offen offset:3072 lds
    s_add_u32 m0, s23, 16384
    s_nop 0
    buffer_load_dwordx4 v12, s[8:11], s21 offen offset:0 lds
    buffer_load_dwordx4 v13, s[8:11], s21 offen offset:1024 lds
    buffer_load_dwordx4 v14, s[8:11], s21 offen offset:2048 lds
    buffer_load_dwordx4 v15, s[8:11], s21 offen offset:3072 lds
    s_add_u32 m0, s23, 32768
    s_add_u32 s21, s22, 128
    s_and_b32 s21, s21, 2047
    buffer_load_dwordx4 v8, s[4:7], s21 offen offset:0 lds
    buffer_load_dwordx4 v9, s[4:7], s21 offen offset:1024 lds
    buffer_load_dwordx4 v10, s[4:7], s21 offen offset:2048 lds
    buffer_load_dwordx4 v11, s[4:7], s21 offen offset:3072 lds
    s_add_u32 m0, s23, 49152
    s_nop 0
    buffer_load_dwordx4 v12, s[8:11], s21 offen offset:0 lds
    buffer_load_dwordx4 v13, s[8:11], s21 offen offset:1024 lds
    buffer_load_dwordx4 v14, s[8:11], s21 offen offset:2048 lds
    buffer_load_dwordx4 v15, s[8:11], s21 offen offset:3072 lds
    s_mov_b32 s12, s42
    s_mov_b32 s13, s43
    s_mov_b32 s14, 16777216
    s_mov_b32 s15, 0x20000
    s_add_u32 s94, s42, 9469952
    s_addc_u32 s95, s43, 0
    s_load_dword s93, s[94:95], 0
    s_lshl_b32 s38, s17, 14
    s_add_u32 s38, s38, 8388608
    s_add_u32 s24, s42, s38
    s_addc_u32 s25, s43, 0
    s_mov_b32 s26, 16384
    s_mov_b32 s27, 0x20000
    s_cmp_lt_u32 s18, 2
    s_cselect_b32 s28, s52, s54
    s_cselect_b32 s29, s53, s55
    s_sub_u32 s28, s28, 3072
    s_subb_u32 s29, s29, 0
    s_mov_b32 s30, 2100224
    s_mov_b32 s31, 0x20000
    s_mov_b32 s32, s36
    s_mov_b32 s33, s37
    s_mov_b32 s34, 8388608
    s_mov_b32 s35, 0x20000
    global_load_ushort v224, v255, s[44:45] offset:0
    global_load_ushort v226, v255, s[46:47] offset:0
    global_load_ushort v228, v255, s[56:57] offset:0
    global_load_ushort v225, v255, s[44:45] offset:32
    global_load_ushort v227, v255, s[46:47] offset:32
    global_load_ushort v229, v255, s[56:57] offset:32
    s_add_u32 m0, s23, 65536
    s_add_u32 s21, s22, 256
    s_and_b32 s21, s21, 2047
    buffer_load_dwordx4 v8, s[4:7], s21 offen offset:0 lds
    buffer_load_dwordx4 v9, s[4:7], s21 offen offset:1024 lds
    buffer_load_dwordx4 v10, s[4:7], s21 offen offset:2048 lds
    buffer_load_dwordx4 v11, s[4:7], s21 offen offset:3072 lds
    s_add_u32 m0, s23, 81920
    s_nop 0
    buffer_load_dwordx4 v12, s[8:11], s21 offen offset:0 lds
    buffer_load_dwordx4 v13, s[8:11], s21 offen offset:1024 lds
    buffer_load_dwordx4 v14, s[8:11], s21 offen offset:2048 lds
    buffer_load_dwordx4 v15, s[8:11], s21 offen offset:3072 lds
    v_bfe_u32 v59, v24, 1, 3
    v_xor_b32 v59, v59, v25
    v_lshlrev_b32 v59, 4, v59
    v_lshl_add_u32 v59, v26, 7, v59
    s_lshl_b32 s38, s19, 13
    s_lshl_b32 s39, s20, 13
    v_xor_b32 v58, 0, v59
    v_add_u32 v16, s38, v58
    v_add_u32 v18, s39, v58
    v_add_u32 v20, 0x10000, v16
    v_add_u32 v22, 0x10000, v18
    v_xor_b32 v58, 64, v59
    v_add_u32 v17, s38, v58
    v_add_u32 v19, s39, v58
    v_add_u32 v21, 0x10000, v17
    v_add_u32 v23, 0x10000, v19
    v_and_b32 v58, 31, v24
    v_lshlrev_b32 v27, 4, v58
    s_sub_u32 s38, 15, s16
    s_lshl_b32 s38, s38, 10
    s_lshl_b32 s39, s20, 9
    s_add_u32 s92, s38, s39
    v_add_u32 v27, s92, v27
    s_cmp_eq_u32 s19, 1
    s_cselect_b64 s[82:83], -1, 0
    s_waitcnt vmcnt(22) lgkmcnt(0)
    s_barrier
    s_mul_i32 s93, s93, 1664525
    s_add_u32 s93, s93, 1013904223
    ds_read_b128 v[128:131], v16 offset:0
    ds_read_b128 v[144:147], v18 offset:16384
    ds_read_b128 v[148:151], v18 offset:18432
    ds_read_b128 v[152:155], v18 offset:20480
    ds_read_b128 v[156:159], v18 offset:22528
    ds_read_b128 v[132:135], v16 offset:2048
    ds_read_b128 v[136:139], v16 offset:4096
    ds_read_b128 v[140:143], v16 offset:6144
    s_lshl_b32 s38, s20, 8
    s_add_u32 s38, s38, 32768
    v_lshl_add_u32 v193, v26, 4, s38
    s_lshl_b32 s39, s19, 11
    v_lshl_add_u32 v192, v25, 9, v193
    v_add_u32 v192, s39, v192
    v_lshlrev_b32 v194, 10, v25
    v_lshl_add_u32 v194, v26, 4, v194
    s_add_u32 s38, s92, 1024
    v_add_u32 v194, s38, v194
    v_sub_u32 v58, s16, v25
    v_mov_b32 v59, s93
    v_cmp_lt_i32 vcc, 0, v58
    s_nop 1
    v_cndmask_b32 v198, 0, v59, vcc
    v_cmp_lt_i32 vcc, 4, v58
    s_nop 1
    v_cndmask_b32 v199, 0, v59, vcc
    v_cmp_lt_i32 vcc, 8, v58
    s_nop 1
    v_cndmask_b32 v200, 0, v59, vcc
    v_cmp_lt_i32 vcc, 12, v58
    s_nop 1
    v_cndmask_b32 v201, 0, v59, vcc
    s_mul_i32 s38, s18, 9216
    s_add_u32 s38, s38, 36864
    v_mul_u32_u24 v195, 144, v26
    v_lshl_add_u32 v195, v25, 5, v195
    v_add_u32 v195, s38, v195
    v_bfe_u32 v196, v24, 2, 2
    v_lshl_add_u32 v196, v25, 3, v196
    v_mul_u32_u24 v196, 144, v196
    v_and_b32 v58, 3, v24
    v_lshl_add_u32 v196, v58, 3, v196
    v_add_u32 v196, s38, v196
    v_lshlrev_b32 v197, 4, v24
    s_lshl_b32 s38, s17, 6
    s_lshl_b32 s39, s19, 5
    s_add_u32 s38, s38, s39
    v_add_u32 v58, s38, v56
    v_lshl_add_u32 v58, v58, 11, v57
    v_xor_b32 v59, 64, v58
    v_add_u32 v202, 3072, v58
    v_add_u32 v203, 18432, v59
    v_add_u32 v204, 33792, v58
    v_add_u32 v205, 49152, v59
    s_mul_i32 s55, s3, 2
    s_mul_i32 s38, s16, 0
    s_add_u32 s55, s55, s38
    s_mul_i32 s38, s17, 0
    s_add_u32 s55, s55, s38
    s_lshl_b32 s48, s16, 19
    s_lshl_b32 s39, s17, 15
    s_add_u32 s53, s48, s39
    s_lshl_b32 s39, s20, 11
    s_add_u32 s53, s53, s39
    s_lshl_b32 s39, s19, 14
    s_add_u32 s53, s53, s39
    s_getreg_b32 s97, hwreg(HW_REG_XCC_ID, 0, 4)
    s_xor_b32 s97, s97, s93
    s_lshl_b32 s52, s16, 12
    s_add_u32 s52, s52, 9699328
    s_lshl_b32 s38, s17, 8
    s_add_u32 s38, s38, s52
    v_mov_b32 v58, s97
    v_lshlrev_b32 v59, 2, v24
    v_lshlrev_b32 v1, 8, v26
    s_cmp_lg_u32 s18, 0
    s_cbranch_scc1 L_noxc
    s_mov_b32 exec_hi, 0
    buffer_store_dword v58, v59, s[12:15], s38 offen sc1
    s_mov_b32 exec_hi, -1
L_noxc:
    s_waitcnt lgkmcnt(0)
    v_mfma_f32_16x16x32_bf16 v[64:67], v[128:131], v[144:147], 0
    ds_read_b128 v[160:163], v17 offset:0
    v_mfma_f32_16x16x32_bf16 v[68:71], v[128:131], v[148:151], 0
    ds_read_b128 v[176:179], v19 offset:16384
    v_mfma_f32_16x16x32_bf16 v[72:75], v[128:131], v[152:155], 0
    ds_read_b128 v[180:183], v19 offset:18432
    v_mfma_f32_16x16x32_bf16 v[76:79], v[128:131], v[156:159], 0
    ds_read_b128 v[184:187], v19 offset:20480
    v_mfma_f32_16x16x32_bf16 v[80:83], v[132:135], v[144:147], 0
    ds_read_b128 v[188:191], v19 offset:22528
    v_mfma_f32_16x16x32_bf16 v[84:87], v[132:135], v[148:151], 0
    ds_read_b128 v[164:167], v17 offset:2048
    v_mfma_f32_16x16x32_bf16 v[88:91], v[132:135], v[152:155], 0
    ds_read_b128 v[168:171], v17 offset:4096
    v_mfma_f32_16x16x32_bf16 v[92:95], v[132:135], v[156:159], 0
    ds_read_b128 v[172:175], v17 offset:6144
    v_mfma_f32_16x16x32_bf16 v[96:99], v[136:139], v[144:147], 0
    v_mfma_f32_16x16x32_bf16 v[100:103], v[136:139], v[148:151], 0
    v_mfma_f32_16x16x32_bf16 v[104:107], v[136:139], v[152:155], 0
    v_mfma_f32_16x16x32_bf16 v[108:111], v[136:139], v[156:159], 0
    v_mfma_f32_16x16x32_bf16 v[112:115], v[140:143], v[144:147], 0
    v_mfma_f32_16x16x32_bf16 v[116:119], v[140:143], v[148:151], 0
    v_mfma_f32_16x16x32_bf16 v[120:123], v[140:143], v[152:155], 0
    v_mfma_f32_16x16x32_bf16 v[124:127], v[140:143], v[156:159], 0
    s_waitcnt vmcnt(14) lgkmcnt(0)
    s_barrier
    v_mfma_f32_16x16x32_bf16 v[64:67], v[160:163], v[176:179], v[64:67]
    ds_read_b128 v[128:131], v16 offset:32768
    v_mfma_f32_16x16x32_bf16 v[68:71], v[160:163], v[180:183], v[68:71]
    ds_read_b128 v[144:147], v18 offset:49152
    v_mfma_f32_16x16x32_bf16 v[72:75], v[160:163], v[184:187], v[72:75]
    ds_read_b128 v[148:151], v18 offset:51200
    v_mfma_f32_16x16x32_bf16 v[76:79], v[160:163], v[188:191], v[76:79]
    ds_read_b128 v[152:155], v18 offset:53248
    v_mfma_f32_16x16x32_bf16 v[80:83], v[164:167], v[176:179], v[80:83]
    ds_read_b128 v[156:159], v18 offset:55296
    v_mfma_f32_16x16x32_bf16 v[84:87], v[164:167], v[180:183], v[84:87]
    ds_read_b128 v[132:135], v16 offset:34816
    v_mfma_f32_16x16x32_bf16 v[88:91], v[164:167], v[184:187], v[88:91]
    ds_read_b128 v[136:139], v16 offset:36864
    v_mfma_f32_16x16x32_bf16 v[92:95], v[164:167], v[188:191], v[92:95]
    ds_read_b128 v[140:143], v16 offset:38912
    v_mfma_f32_16x16x32_bf16 v[96:99], v[168:171], v[176:179], v[96:99]
    s_add_u32 m0, s23, 0
    s_add_u32 s21, s22, 384
    s_and_b32 s21, s21, 2047
    buffer_load_dwordx4 v8, s[4:7], s21 offen offset:0 lds
    v_mfma_f32_16x16x32_bf16 v[100:103], v[168:171], v[180:183], v[100:103]
    v_mfma_f32_16x16x32_bf16 v[104:107], v[168:171], v[184:187], v[104:107]
    buffer_load_dwordx4 v9, s[4:7], s21 offen offset:1024 lds
    v_mfma_f32_16x16x32_bf16 v[108:111], v[168:171], v[188:191], v[108:111]
    v_mfma_f32_16x16x32_bf16 v[112:115], v[172:175], v[176:179], v[112:115]
    buffer_load_dwordx4 v10, s[4:7], s21 offen offset:2048 lds
    v_mfma_f32_16x16x32_bf16 v[116:119], v[172:175], v[180:183], v[116:119]
    v_mfma_f32_16x16x32_bf16 v[120:123], v[172:175], v[184:187], v[120:123]
    buffer_load_dwordx4 v11, s[4:7], s21 offen offset:3072 lds
    v_mfma_f32_16x16x32_bf16 v[124:127], v[172:175], v[188:191], v[124:127]
    s_waitcnt lgkmcnt(0)
    v_mfma_f32_16x16x32_bf16 v[64:67], v[128:131], v[144:147], v[64:67]
    ds_read_b128 v[160:163], v17 offset:32768
    v_mfma_f32_16x16x32_bf16 v[68:71], v[128:131], v[148:151], v[68:71]
    ds_read_b128 v[176:179], v19 offset:49152
    v_mfma_f32_16x16x32_bf16 v[72:75], v[128:131], v[152:155], v[72:75]
    ds_read_b128 v[180:183], v19 offset:51200
    v_mfma_f32_16x16x32_bf16 v[76:79], v[128:131], v[156:159], v[76:79]
    ds_read_b128 v[184:187], v19 offset:53248
    v_mfma_f32_16x16x32_bf16 v[80:83], v[132:135], v[144:147], v[80:83]
    ds_read_b128 v[188:191], v19 offset:55296
    v_mfma_f32_16x16x32_bf16 v[84:87], v[132:135], v[148:151], v[84:87]
    ds_read_b128 v[164:167], v17 offset:34816
    v_mfma_f32_16x16x32_bf16 v[88:91], v[132:135], v[152:155], v[88:91]
    ds_read_b128 v[168:171], v17 offset:36864
    v_mfma_f32_16x16x32_bf16 v[92:95], v[132:135], v[156:159], v[92:95]
    ds_read_b128 v[172:175], v17 offset:38912
    v_mfma_f32_16x16x32_bf16 v[96:99], v[136:139], v[144:147], v[96:99]
    s_add_u32 m0, s23, 16384
    s_nop 0
    buffer_load_dwordx4 v12, s[8:11], s21 offen offset:0 lds
    v_mfma_f32_16x16x32_bf16 v[100:103], v[136:139], v[148:151], v[100:103]
    v_mfma_f32_16x16x32_bf16 v[104:107], v[136:139], v[152:155], v[104:107]
    buffer_load_dwordx4 v13, s[8:11], s21 offen offset:1024 lds
    v_mfma_f32_16x16x32_bf16 v[108:111], v[136:139], v[156:159], v[108:111]
    v_mfma_f32_16x16x32_bf16 v[112:115], v[140:143], v[144:147], v[112:115]
    buffer_load_dwordx4 v14, s[8:11], s21 offen offset:2048 lds
    v_mfma_f32_16x16x32_bf16 v[116:119], v[140:143], v[148:151], v[116:119]
    v_mfma_f32_16x16x32_bf16 v[120:123], v[140:143], v[152:155], v[120:123]
    buffer_load_dwordx4 v15, s[8:11], s21 offen offset:3072 lds
    v_mfma_f32_16x16x32_bf16 v[124:127], v[140:143], v[156:159], v[124:127]
    s_waitcnt vmcnt(8) lgkmcnt(0)
    s_barrier
    v_mfma_f32_16x16x32_bf16 v[64:67], v[160:163], v[176:179], v[64:67]
    ds_read_b128 v[128:131], v20 offset:0
    v_mfma_f32_16x16x32_bf16 v[68:71], v[160:163], v[180:183], v[68:71]
    ds_read_b128 v[144:147], v22 offset:16384
    v_mfma_f32_16x16x32_bf16 v[72:75], v[160:163], v[184:187], v[72:75]
    ds_read_b128 v[148:151], v22 offset:18432
    v_mfma_f32_16x16x32_bf16 v[76:79], v[160:163], v[188:191], v[76:79]
    ds_read_b128 v[152:155], v22 offset:20480
    v_mfma_f32_16x16x32_bf16 v[80:83], v[164:167], v[176:179], v[80:83]
    ds_read_b128 v[156:159], v22 offset:22528
    v_mfma_f32_16x16x32_bf16 v[84:87], v[164:167], v[180:183], v[84:87]
    ds_read_b128 v[132:135], v20 offset:2048
    v_mfma_f32_16x16x32_bf16 v[88:91], v[164:167], v[184:187], v[88:91]
    ds_read_b128 v[136:139], v20 offset:4096
    v_mfma_f32_16x16x32_bf16 v[92:95], v[164:167], v[188:191], v[92:95]
    ds_read_b128 v[140:143], v20 offset:6144
    v_mfma_f32_16x16x32_bf16 v[96:99], v[168:171], v[176:179], v[96:99]
    s_add_u32 m0, s23, 32768
    s_add_u32 s21, s22, 512
    s_and_b32 s21, s21, 2047
    buffer_load_dwordx4 v8, s[4:7], s21 offen offset:0 lds
    v_mfma_f32_16x16x32_bf16 v[100:103], v[168:171], v[180:183], v[100:103]
    v_mfma_f32_16x16x32_bf16 v[104:107], v[168:171], v[184:187], v[104:107]
    buffer_load_dwordx4 v9, s[4:7], s21 offen offset:1024 lds
    v_mfma_f32_16x16x32_bf16 v[108:111], v[168:171], v[188:191], v[108:111]
    v_mfma_f32_16x16x32_bf16 v[112:115], v[172:175], v[176:179], v[112:115]
    buffer_load_dwordx4 v10, s[4:7], s21 offen offset:2048 lds
    v_mfma_f32_16x16x32_bf16 v[116:119], v[172:175], v[180:183], v[116:119]
    v_mfma_f32_16x16x32_bf16 v[120:123], v[172:175], v[184:187], v[120:123]
    buffer_load_dwordx4 v11, s[4:7], s21 offen offset:3072 lds
    v_mfma_f32_16x16x32_bf16 v[124:127], v[172:175], v[188:191], v[124:127]
    s_waitcnt lgkmcnt(0)
    v_mfma_f32_16x16x32_bf16 v[64:67], v[128:131], v[144:147], v[64:67]
    ds_read_b128 v[160:163], v21 offset:0
    v_mfma_f32_16x16x32_bf16 v[68:71], v[128:131], v[148:151], v[68:71]
    ds_read_b128 v[176:179], v23 offset:16384
    v_mfma_f32_16x16x32_bf16 v[72:75], v[128:131], v[152:155], v[72:75]
    ds_read_b128 v[180:183], v23 offset:18432
    v_mfma_f32_16x16x32_bf16 v[76:79], v[128:131], v[156:159], v[76:79]
    ds_read_b128 v[184:187], v23 offset:20480
    v_mfma_f32_16x16x32_bf16 v[80:83], v[132:135], v[144:147], v[80:83]
    ds_read_b128 v[188:191], v23 offset:22528
    v_mfma_f32_16x16x32_bf16 v[84:87], v[132:135], v[148:151], v[84:87]
    ds_read_b128 v[164:167], v21 offset:2048
    v_mfma_f32_16x16x32_bf16 v[88:91], v[132:135], v[152:155], v[88:91]
    ds_read_b128 v[168:171], v21 offset:4096
    v_mfma_f32_16x16x32_bf16 v[92:95], v[132:135], v[156:159], v[92:95]
    ds_read_b128 v[172:175], v21 offset:6144
    v_mfma_f32_16x16x32_bf16 v[96:99], v[136:139], v[144:147], v[96:99]
    s_add_u32 m0, s23, 49152
    s_nop 0
    buffer_load_dwordx4 v12, s[8:11], s21 offen offset:0 lds
    v_mfma_f32_16x16x32_bf16 v[100:103], v[136:139], v[148:151], v[100:103]
    v_mfma_f32_16x16x32_bf16 v[104:107], v[136:139], v[152:155], v[104:107]
    buffer_load_dwordx4 v13, s[8:11], s21 offen offset:1024 lds
    v_mfma_f32_16x16x32_bf16 v[108:111], v[136:139], v[156:159], v[108:111]
    v_mfma_f32_16x16x32_bf16 v[112:115], v[140:143], v[144:147], v[112:115]
    buffer_load_dwordx4 v14, s[8:11], s21 offen offset:2048 lds
    v_mfma_f32_16x16x32_bf16 v[116:119], v[140:143], v[148:151], v[116:119]
    v_mfma_f32_16x16x32_bf16 v[120:123], v[140:143], v[152:155], v[120:123]
    buffer_load_dwordx4 v15, s[8:11], s21 offen offset:3072 lds
    v_mfma_f32_16x16x32_bf16 v[124:127], v[140:143], v[156:159], v[124:127]
    s_waitcnt vmcnt(8) lgkmcnt(0)
    s_barrier
    v_mfma_f32_16x16x32_bf16 v[64:67], v[160:163], v[176:179], v[64:67]
    ds_read_b128 v[128:131], v16 offset:0
    v_mfma_f32_16x16x32_bf16 v[68:71], v[160:163], v[180:183], v[68:71]
    ds_read_b128 v[144:147], v18 offset:16384
    v_mfma_f32_16x16x32_bf16 v[72:75], v[160:163], v[184:187], v[72:75]
    ds_read_b128 v[148:151], v18 offset:18432
    v_mfma_f32_16x16x32_bf16 v[76:79], v[160:163], v[188:191], v[76:79]
    ds_read_b128 v[152:155], v18 offset:20480
    v_mfma_f32_16x16x32_bf16 v[80:83], v[164:167], v[176:179], v[80:83]
    ds_read_b128 v[156:159], v18 offset:22528
    v_mfma_f32_16x16x32_bf16 v[84:87], v[164:167], v[180:183], v[84:87]
    ds_read_b128 v[132:135], v16 offset:2048
    v_mfma_f32_16x16x32_bf16 v[88:91], v[164:167], v[184:187], v[88:91]
    ds_read_b128 v[136:139], v16 offset:4096
    v_mfma_f32_16x16x32_bf16 v[92:95], v[164:167], v[188:191], v[92:95]
    ds_read_b128 v[140:143], v16 offset:6144
    v_mfma_f32_16x16x32_bf16 v[96:99], v[168:171], v[176:179], v[96:99]
    s_add_u32 m0, s23, 65536
    s_add_u32 s21, s22, 640
    s_and_b32 s21, s21, 2047
    buffer_load_dwordx4 v8, s[4:7], s21 offen offset:0 lds
    v_mfma_f32_16x16x32_bf16 v[100:103], v[168:171], v[180:183], v[100:103]
    v_lshlrev_b32 v224, 16, v224
    v_mfma_f32_16x16x32_bf16 v[104:107], v[168:171], v[184:187], v[104:107]
    buffer_load_dwordx4 v9, s[4:7], s21 offen offset:1024 lds
    v_mfma_f32_16x16x32_bf16 v[108:111], v[168:171], v[188:191], v[108:111]
    v_lshlrev_b32 v225, 16, v225
    v_mfma_f32_16x16x32_bf16 v[112:115], v[172:175], v[176:179], v[112:115]
    buffer_load_dwordx4 v10, s[4:7], s21 offen offset:2048 lds
    v_mfma_f32_16x16x32_bf16 v[116:119], v[172:175], v[180:183], v[116:119]
    v_lshlrev_b32 v226, 16, v226
    v_mfma_f32_16x16x32_bf16 v[120:123], v[172:175], v[184:187], v[120:123]
    buffer_load_dwordx4 v11, s[4:7], s21 offen offset:3072 lds
    v_mfma_f32_16x16x32_bf16 v[124:127], v[172:175], v[188:191], v[124:127]
    v_lshlrev_b32 v227, 16, v227
    s_waitcnt lgkmcnt(0)
    v_mfma_f32_16x16x32_bf16 v[64:67], v[128:131], v[144:147], v[64:67]
    ds_read_b128 v[160:163], v17 offset:0
    v_mfma_f32_16x16x32_bf16 v[68:71], v[128:131], v[148:151], v[68:71]
    ds_read_b128 v[176:179], v19 offset:16384
    v_mfma_f32_16x16x32_bf16 v[72:75], v[128:131], v[152:155], v[72:75]
    ds_read_b128 v[180:183], v19 offset:18432
    v_mfma_f32_16x16x32_bf16 v[76:79], v[128:131], v[156:159], v[76:79]
    ds_read_b128 v[184:187], v19 offset:20480
    v_mfma_f32_16x16x32_bf16 v[80:83], v[132:135], v[144:147], v[80:83]
    ds_read_b128 v[188:191], v19 offset:22528
    v_mfma_f32_16x16x32_bf16 v[84:87], v[132:135], v[148:151], v[84:87]
    ds_read_b128 v[164:167], v17 offset:2048
    v_mfma_f32_16x16x32_bf16 v[88:91], v[132:135], v[152:155], v[88:91]
    ds_read_b128 v[168:171], v17 offset:4096
    v_mfma_f32_16x16x32_bf16 v[92:95], v[132:135], v[156:159], v[92:95]
    ds_read_b128 v[172:175], v17 offset:6144
    v_mfma_f32_16x16x32_bf16 v[96:99], v[136:139], v[144:147], v[96:99]
    s_add_u32 m0, s23, 81920
    s_nop 0
    buffer_load_dwordx4 v12, s[8:11], s21 offen offset:0 lds
    v_mfma_f32_16x16x32_bf16 v[100:103], v[136:139], v[148:151], v[100:103]
    v_lshlrev_b32 v228, 16, v228
    v_mfma_f32_16x16x32_bf16 v[104:107], v[136:139], v[152:155], v[104:107]
    buffer_load_dwordx4 v13, s[8:11], s21 offen offset:1024 lds
    v_mfma_f32_16x16x32_bf16 v[108:111], v[136:139], v[156:159], v[108:111]
    v_lshlrev_b32 v229, 16, v229
    v_mfma_f32_16x16x32_bf16 v[112:115], v[140:143], v[144:147], v[112:115]
    buffer_load_dwordx4 v14, s[8:11], s21 offen offset:2048 lds
    v_mfma_f32_16x16x32_bf16 v[116:119], v[140:143], v[148:151], v[116:119]
    v_mul_f32 v230, 1069066811, v228
    v_mfma_f32_16x16x32_bf16 v[120:123], v[140:143], v[152:155], v[120:123]
    buffer_load_dwordx4 v15, s[8:11], s21 offen offset:3072 lds
    v_mul_f32 v231, 1069066811, v229
    v_mfma_f32_16x16x32_bf16 v[124:127], v[140:143], v[156:159], v[124:127]
    v_exp_f32 v230, v230
    v_exp_f32 v231, v231
    s_waitcnt vmcnt(8) lgkmcnt(0)
    s_barrier
    v_mfma_f32_16x16x32_bf16 v[64:67], v[160:163], v[176:179], v[64:67]
    ds_read_b128 v[128:131], v16 offset:32768
    v_mfma_f32_16x16x32_bf16 v[68:71], v[160:163], v[180:183], v[68:71]
    ds_read_b128 v[144:147], v18 offset:49152
    v_mfma_f32_16x16x32_bf16 v[72:75], v[160:163], v[184:187], v[72:75]
    ds_read_b128 v[148:151], v18 offset:51200
    v_mfma_f32_16x16x32_bf16 v[76:79], v[160:163], v[188:191], v[76:79]
    ds_read_b128 v[152:155], v18 offset:53248
    v_mfma_f32_16x16x32_bf16 v[80:83], v[164:167], v[176:179], v[80:83]
    ds_read_b128 v[156:159], v18 offset:55296
    v_mfma_f32_16x16x32_bf16 v[84:87], v[164:167], v[180:183], v[84:87]
    ds_read_b128 v[132:135], v16 offset:34816
    v_mfma_f32_16x16x32_bf16 v[88:91], v[164:167], v[184:187], v[88:91]
    ds_read_b128 v[136:139], v16 offset:36864
    v_mfma_f32_16x16x32_bf16 v[92:95], v[164:167], v[188:191], v[92:95]
    ds_read_b128 v[140:143], v16 offset:38912
    v_mfma_f32_16x16x32_bf16 v[96:99], v[168:171], v[176:179], v[96:99]
    s_add_u32 m0, s23, 0
    s_add_u32 s21, s22, 768
    s_and_b32 s21, s21, 2047
    buffer_load_dwordx4 v8, s[4:7], s21 offen offset:0 lds
    v_mfma_f32_16x16x32_bf16 v[100:103], v[168:171], v[180:183], v[100:103]
    s_nop 0
    v_mfma_f32_16x16x32_bf16 v[104:107], v[168:171], v[184:187], v[104:107]
    buffer_load_dwordx4 v9, s[4:7], s21 offen offset:1024 lds
    v_mfma_f32_16x16x32_bf16 v[108:111], v[168:171], v[188:191], v[108:111]
    v_cvt_pk_bf16_f32 v230, v230, v230
    v_mfma_f32_16x16x32_bf16 v[112:115], v[172:175], v[176:179], v[112:115]
    buffer_load_dwordx4 v10, s[4:7], s21 offen offset:2048 lds
    v_mfma_f32_16x16x32_bf16 v[116:119], v[172:175], v[180:183], v[116:119]
    v_lshlrev_b32 v230, 16, v230
    v_mfma_f32_16x16x32_bf16 v[120:123], v[172:175], v[184:187], v[120:123]
    buffer_load_dwordx4 v11, s[4:7], s21 offen offset:3072 lds
    v_mfma_f32_16x16x32_bf16 v[124:127], v[172:175], v[188:191], v[124:127]
    v_cvt_pk_bf16_f32 v231, v231, v231
    s_waitcnt lgkmcnt(0)
    v_mfma_f32_16x16x32_bf16 v[64:67], v[128:131], v[144:147], v[64:67]
    ds_read_b128 v[160:163], v17 offset:32768
    v_mfma_f32_16x16x32_bf16 v[68:71], v[128:131], v[148:151], v[68:71]
    ds_read_b128 v[176:179], v19 offset:49152
    v_mfma_f32_16x16x32_bf16 v[72:75], v[128:131], v[152:155], v[72:75]
    ds_read_b128 v[180:183], v19 offset:51200
    v_mfma_f32_16x16x32_bf16 v[76:79], v[128:131], v[156:159], v[76:79]
    ds_read_b128 v[184:187], v19 offset:53248
    v_mfma_f32_16x16x32_bf16 v[80:83], v[132:135], v[144:147], v[80:83]
    ds_read_b128 v[188:191], v19 offset:55296
    v_mfma_f32_16x16x32_bf16 v[84:87], v[132:135], v[148:151], v[84:87]
    ds_read_b128 v[164:167], v17 offset:34816
    v_mfma_f32_16x16x32_bf16 v[88:91], v[132:135], v[152:155], v[88:91]
    ds_read_b128 v[168:171], v17 offset:36864
    v_mfma_f32_16x16x32_bf16 v[92:95], v[132:135], v[156:159], v[92:95]
    ds_read_b128 v[172:175], v17 offset:38912
    v_mfma_f32_16x16x32_bf16 v[96:99], v[136:139], v[144:147], v[96:99]
    s_add_u32 m0, s23, 16384
    s_nop 0
    buffer_load_dwordx4 v12, s[8:11], s21 offen offset:0 lds
    v_mfma_f32_16x16x32_bf16 v[100:103], v[136:139], v[148:151], v[100:103]
    v_lshlrev_b32 v231, 16, v231
    v_mfma_f32_16x16x32_bf16 v[104:107], v[136:139], v[152:155], v[104:107]
    buffer_load_dwordx4 v13, s[8:11], s21 offen offset:1024 lds
    v_mfma_f32_16x16x32_bf16 v[108:111], v[136:139], v[156:159], v[108:111]
    v_pk_mul_f32 v[232:233], v[230:231], v[224:225] op_sel:[0,0] op_sel_hi:[1,1]
    v_mfma_f32_16x16x32_bf16 v[112:115], v[140:143], v[144:147], v[112:115]
    buffer_load_dwordx4 v14, s[8:11], s21 offen offset:2048 lds
    v_mfma_f32_16x16x32_bf16 v[116:119], v[140:143], v[148:151], v[116:119]
    v_pk_mul_f32 v[234:235], v[230:231], v[226:227] op_sel:[0,0] op_sel_hi:[1,1]
    v_mfma_f32_16x16x32_bf16 v[120:123], v[140:143], v[152:155], v[120:123]
    buffer_load_dwordx4 v15, s[8:11], s21 offen offset:3072 lds
    v_mul_f32 v232, 1069066811, v232
    v_mfma_f32_16x16x32_bf16 v[124:127], v[140:143], v[156:159], v[124:127]
    v_mul_f32 v234, 1042479491, v234
    v_mul_f32 v233, 1069066811, v233
    s_waitcnt vmcnt(8) lgkmcnt(0)
    s_barrier
    v_mfma_f32_16x16x32_bf16 v[64:67], v[160:163], v[176:179], v[64:67]
    ds_read_b128 v[128:131], v20 offset:0
    v_mfma_f32_16x16x32_bf16 v[68:71], v[160:163], v[180:183], v[68:71]
    ds_read_b128 v[144:147], v22 offset:16384
    v_mfma_f32_16x16x32_bf16 v[72:75], v[160:163], v[184:187], v[72:75]
    ds_read_b128 v[148:151], v22 offset:18432
    v_mfma_f32_16x16x32_bf16 v[76:79], v[160:163], v[188:191], v[76:79]
    ds_read_b128 v[152:155], v22 offset:20480
    v_mfma_f32_16x16x32_bf16 v[80:83], v[164:167], v[176:179], v[80:83]
    ds_read_b128 v[156:159], v22 offset:22528
    v_mfma_f32_16x16x32_bf16 v[84:87], v[164:167], v[180:183], v[84:87]
    ds_read_b128 v[132:135], v20 offset:2048
    v_mfma_f32_16x16x32_bf16 v[88:91], v[164:167], v[184:187], v[88:91]
    ds_read_b128 v[136:139], v20 offset:4096
    v_mfma_f32_16x16x32_bf16 v[92:95], v[164:167], v[188:191], v[92:95]
    ds_read_b128 v[140:143], v20 offset:6144
    v_mfma_f32_16x16x32_bf16 v[96:99], v[168:171], v[176:179], v[96:99]
    s_add_u32 m0, s23, 32768
    s_add_u32 s21, s22, 896
    s_and_b32 s21, s21, 2047
    buffer_load_dwordx4 v8, s[4:7], s21 offen offset:0 lds
    v_mfma_f32_16x16x32_bf16 v[100:103], v[168:171], v[180:183], v[100:103]
    v_mul_f32 v235, 1042479491, v235
    v_mfma_f32_16x16x32_bf16 v[104:107], v[168:171], v[184:187], v[104:107]
    buffer_load_dwordx4 v9, s[4:7], s21 offen offset:1024 lds
    v_mfma_f32_16x16x32_bf16 v[108:111], v[168:171], v[188:191], v[108:111]
    v_exp_f32 v232, v232
    v_mfma_f32_16x16x32_bf16 v[112:115], v[172:175], v[176:179], v[112:115]
    buffer_load_dwordx4 v10, s[4:7], s21 offen offset:2048 lds
    v_mfma_f32_16x16x32_bf16 v[116:119], v[172:175], v[180:183], v[116:119]
    v_rndne_f32 v236, v234
    v_mfma_f32_16x16x32_bf16 v[120:123], v[172:175], v[184:187], v[120:123]
    buffer_load_dwordx4 v11, s[4:7], s21 offen offset:3072 lds
    v_mfma_f32_16x16x32_bf16 v[124:127], v[172:175], v[188:191], v[124:127]
    v_exp_f32 v233, v233
    s_waitcnt lgkmcnt(0)
    v_mfma_f32_16x16x32_bf16 v[64:67], v[128:131], v[144:147], v[64:67]
    ds_read_b128 v[160:163], v21 offset:0
    v_mfma_f32_16x16x32_bf16 v[68:71], v[128:131], v[148:151], v[68:71]
    ds_read_b128 v[176:179], v23 offset:16384
    v_mfma_f32_16x16x32_bf16 v[72:75], v[128:131], v[152:155], v[72:75]
    ds_read_b128 v[180:183], v23 offset:18432
    v_mfma_f32_16x16x32_bf16 v[76:79], v[128:131], v[156:159], v[76:79]
    ds_read_b128 v[184:187], v23 offset:20480
    v_mfma_f32_16x16x32_bf16 v[80:83], v[132:135], v[144:147], v[80:83]
    ds_read_b128 v[188:191], v23 offset:22528
    v_mfma_f32_16x16x32_bf16 v[84:87], v[132:135], v[148:151], v[84:87]
    ds_read_b128 v[164:167], v21 offset:2048
    v_mfma_f32_16x16x32_bf16 v[88:91], v[132:135], v[152:155], v[88:91]
    ds_read_b128 v[168:171], v21 offset:4096
    v_mfma_f32_16x16x32_bf16 v[92:95], v[132:135], v[156:159], v[92:95]
    ds_read_b128 v[172:175], v21 offset:6144
    v_mfma_f32_16x16x32_bf16 v[96:99], v[136:139], v[144:147], v[96:99]
    s_add_u32 m0, s23, 49152
    s_nop 0
    buffer_load_dwordx4 v12, s[8:11], s21 offen offset:0 lds
    v_mfma_f32_16x16x32_bf16 v[100:103], v[136:139], v[148:151], v[100:103]
    v_rndne_f32 v237, v235
    v_mfma_f32_16x16x32_bf16 v[104:107], v[136:139], v[152:155], v[104:107]
    buffer_load_dwordx4 v13, s[8:11], s21 offen offset:1024 lds
    v_mfma_f32_16x16x32_bf16 v[108:111], v[136:139], v[156:159], v[108:111]
    v_sub_f32 v234, v234, v236
    v_mfma_f32_16x16x32_bf16 v[112:115], v[140:143], v[144:147], v[112:115]
    buffer_load_dwordx4 v14, s[8:11], s21 offen offset:2048 lds
    v_mfma_f32_16x16x32_bf16 v[116:119], v[140:143], v[148:151], v[116:119]
    v_sub_f32 v235, v235, v237
    v_mfma_f32_16x16x32_bf16 v[120:123], v[140:143], v[152:155], v[120:123]
    buffer_load_dwordx4 v15, s[8:11], s21 offen offset:3072 lds
    v_cos_f32 v236, v234
    v_mfma_f32_16x16x32_bf16 v[124:127], v[140:143], v[156:159], v[124:127]
    v_sin_f32 v238, v234
    v_cos_f32 v237, v235
    s_waitcnt vmcnt(8) lgkmcnt(0)
    s_barrier
    v_mfma_f32_16x16x32_bf16 v[64:67], v[160:163], v[176:179], v[64:67]
    ds_read_b128 v[128:131], v16 offset:0
    v_mfma_f32_16x16x32_bf16 v[68:71], v[160:163], v[180:183], v[68:71]
    ds_read_b128 v[144:147], v18 offset:16384
    v_mfma_f32_16x16x32_bf16 v[72:75], v[160:163], v[184:187], v[72:75]
    ds_read_b128 v[148:151], v18 offset:18432
    v_mfma_f32_16x16x32_bf16 v[76:79], v[160:163], v[188:191], v[76:79]
    ds_read_b128 v[152:155], v18 offset:20480
    v_mfma_f32_16x16x32_bf16 v[80:83], v[164:167], v[176:179], v[80:83]
    ds_read_b128 v[156:159], v18 offset:22528
    v_mfma_f32_16x16x32_bf16 v[84:87], v[164:167], v[180:183], v[84:87]
    ds_read_b128 v[132:135], v16 offset:2048
    v_mfma_f32_16x16x32_bf16 v[88:91], v[164:167], v[184:187], v[88:91]
    ds_read_b128 v[136:139], v16 offset:4096
    v_mfma_f32_16x16x32_bf16 v[92:95], v[164:167], v[188:191], v[92:95]
    ds_read_b128 v[140:143], v16 offset:6144
    v_mfma_f32_16x16x32_bf16 v[96:99], v[168:171], v[176:179], v[96:99]
    s_add_u32 m0, s23, 65536
    s_add_u32 s21, s22, 1024
    s_and_b32 s21, s21, 2047
    buffer_load_dwordx4 v8, s[4:7], s21 offen offset:0 lds
    v_mfma_f32_16x16x32_bf16 v[100:103], v[168:171], v[180:183], v[100:103]
    v_sin_f32 v239, v235
    v_mfma_f32_16x16x32_bf16 v[104:107], v[168:171], v[184:187], v[104:107]
    buffer_load_dwordx4 v9, s[4:7], s21 offen offset:1024 lds
    v_mfma_f32_16x16x32_bf16 v[108:111], v[168:171], v[188:191], v[108:111]
    v_pk_mul_f32 v[240:241], v[224:225], v[224:225] op_sel:[0,0] op_sel_hi:[1,1]
    v_mfma_f32_16x16x32_bf16 v[112:115], v[172:175], v[176:179], v[112:115]
    buffer_load_dwordx4 v10, s[4:7], s21 offen offset:2048 lds
    v_mfma_f32_16x16x32_bf16 v[116:119], v[172:175], v[180:183], v[116:119]
    v_pk_fma_f32 v[240:241], v[226:227], v[226:227], v[240:241] op_sel:[0,0,0] op_sel_hi:[1,1,1]
    v_mfma_f32_16x16x32_bf16 v[120:123], v[172:175], v[184:187], v[120:123]
    buffer_load_dwordx4 v11, s[4:7], s21 offen offset:3072 lds
    v_mfma_f32_16x16x32_bf16 v[124:127], v[172:175], v[188:191], v[124:127]
    v_pk_mul_f32 v[28:29], v[232:233], v[236:237] op_sel:[0,0] op_sel_hi:[1,1]
    s_waitcnt lgkmcnt(0)
    v_mfma_f32_16x16x32_bf16 v[64:67], v[128:131], v[144:147], v[64:67]
    ds_read_b128 v[160:163], v17 offset:0
    v_mfma_f32_16x16x32_bf16 v[68:71], v[128:131], v[148:151], v[68:71]
    ds_read_b128 v[176:179], v19 offset:16384
    v_mfma_f32_16x16x32_bf16 v[72:75], v[128:131], v[152:155], v[72:75]
    ds_read_b128 v[180:183], v19 offset:18432
    v_mfma_f32_16x16x32_bf16 v[76:79], v[128:131], v[156:159], v[76:79]
    ds_read_b128 v[184:187], v19 offset:20480
    v_mfma_f32_16x16x32_bf16 v[80:83], v[132:135], v[144:147], v[80:83]
    ds_read_b128 v[188:191], v19 offset:22528
    v_mfma_f32_16x16x32_bf16 v[84:87], v[132:135], v[148:151], v[84:87]
    ds_read_b128 v[164:167], v17 offset:2048
    v_mfma_f32_16x16x32_bf16 v[88:91], v[132:135], v[152:155], v[88:91]
    ds_read_b128 v[168:171], v17 offset:4096
    v_mfma_f32_16x16x32_bf16 v[92:95], v[132:135], v[156:159], v[92:95]
    ds_read_b128 v[172:175], v17 offset:6144
    v_mfma_f32_16x16x32_bf16 v[96:99], v[136:139], v[144:147], v[96:99]
    s_add_u32 m0, s23, 81920
    s_nop 0
    buffer_load_dwordx4 v12, s[8:11], s21 offen offset:0 lds
    v_mfma_f32_16x16x32_bf16 v[100:103], v[136:139], v[148:151], v[100:103]
    v_pk_mul_f32 v[30:31], v[232:233], v[238:239] op_sel:[0,0] op_sel_hi:[1,1]
    v_mfma_f32_16x16x32_bf16 v[104:107], v[136:139], v[152:155], v[104:107]
    buffer_load_dwordx4 v13, s[8:11], s21 offen offset:1024 lds
    v_mfma_f32_16x16x32_bf16 v[108:111], v[136:139], v[156:159], v[108:111]
    v_rcp_f32 v240, v240
    v_mfma_f32_16x16x32_bf16 v[112:115], v[140:143], v[144:147], v[112:115]
    buffer_load_dwordx4 v14, s[8:11], s21 offen offset:2048 lds
    v_mfma_f32_16x16x32_bf16 v[116:119], v[140:143], v[148:151], v[116:119]
    v_rcp_f32 v241, v241
    v_mfma_f32_16x16x32_bf16 v[120:123], v[140:143], v[152:155], v[120:123]
    buffer_load_dwordx4 v15, s[8:11], s21 offen offset:3072 lds
    v_add_f32 v230, -1.0, v28
    v_mfma_f32_16x16x32_bf16 v[124:127], v[140:143], v[156:159], v[124:127]
    v_add_f32 v231, -1.0, v29
    v_pk_add_f32 v[240:241], v[240:241], v[240:241]
    s_waitcnt vmcnt(8) lgkmcnt(0)
    s_barrier
    v_mfma_f32_16x16x32_bf16 v[64:67], v[160:163], v[176:179], v[64:67]
    ds_read_b128 v[128:131], v16 offset:32768
    v_mfma_f32_16x16x32_bf16 v[68:71], v[160:163], v[180:183], v[68:71]
    ds_read_b128 v[144:147], v18 offset:49152
    v_mfma_f32_16x16x32_bf16 v[72:75], v[160:163], v[184:187], v[72:75]
    ds_read_b128 v[148:151], v18 offset:51200
    v_mfma_f32_16x16x32_bf16 v[76:79], v[160:163], v[188:191], v[76:79]
    ds_read_b128 v[152:155], v18 offset:53248
    v_mfma_f32_16x16x32_bf16 v[80:83], v[164:167], v[176:179], v[80:83]
    ds_read_b128 v[156:159], v18 offset:55296
    v_mfma_f32_16x16x32_bf16 v[84:87], v[164:167], v[180:183], v[84:87]
    ds_read_b128 v[132:135], v16 offset:34816
    v_mfma_f32_16x16x32_bf16 v[88:91], v[164:167], v[184:187], v[88:91]
    ds_read_b128 v[136:139], v16 offset:36864
    v_mfma_f32_16x16x32_bf16 v[92:95], v[164:167], v[188:191], v[92:95]
    ds_read_b128 v[140:143], v16 offset:38912
    v_mfma_f32_16x16x32_bf16 v[96:99], v[168:171], v[176:179], v[96:99]
    s_add_u32 m0, s23, 0
    s_add_u32 s21, s22, 1152
    s_and_b32 s21, s21, 2047
    buffer_load_dwordx4 v8, s[4:7], s21 offen offset:0 lds
    v_mfma_f32_16x16x32_bf16 v[100:103], v[168:171], v[180:183], v[100:103]
    v_pk_mul_f32 v[232:233], v[230:231], v[224:225] op_sel:[0,0] op_sel_hi:[1,1]
    v_mfma_f32_16x16x32_bf16 v[104:107], v[168:171], v[184:187], v[104:107]
    buffer_load_dwordx4 v9, s[4:7], s21 offen offset:1024 lds
    v_mfma_f32_16x16x32_bf16 v[108:111], v[168:171], v[188:191], v[108:111]
    v_pk_fma_f32 v[232:233], v[30:31], v[226:227], v[232:233] op_sel:[0,0,0] op_sel_hi:[1,1,1]
    v_mfma_f32_16x16x32_bf16 v[112:115], v[172:175], v[176:179], v[112:115]
    buffer_load_dwordx4 v10, s[4:7], s21 offen offset:2048 lds
    v_mfma_f32_16x16x32_bf16 v[116:119], v[172:175], v[180:183], v[116:119]
    v_pk_mul_f32 v[234:235], v[30:31], v[224:225] op_sel:[0,0] op_sel_hi:[1,1]
    v_mfma_f32_16x16x32_bf16 v[120:123], v[172:175], v[184:187], v[120:123]
    buffer_load_dwordx4 v11, s[4:7], s21 offen offset:3072 lds
    v_mfma_f32_16x16x32_bf16 v[124:127], v[172:175], v[188:191], v[124:127]
    v_pk_fma_f32 v[234:235], v[230:231], v[226:227], v[234:235] op_sel:[0,0,0] op_sel_hi:[1,1,1] neg_lo:[1,0,0] neg_hi:[1,0,0]
    s_waitcnt lgkmcnt(0)
    v_mfma_f32_16x16x32_bf16 v[64:67], v[128:131], v[144:147], v[64:67]
    ds_read_b128 v[160:163], v17 offset:32768
    v_mfma_f32_16x16x32_bf16 v[68:71], v[128:131], v[148:151], v[68:71]
    ds_read_b128 v[176:179], v19 offset:49152
    v_mfma_f32_16x16x32_bf16 v[72:75], v[128:131], v[152:155], v[72:75]
    ds_read_b128 v[180:183], v19 offset:51200
    v_mfma_f32_16x16x32_bf16 v[76:79], v[128:131], v[156:159], v[76:79]
    ds_read_b128 v[184:187], v19 offset:53248
    v_mfma_f32_16x16x32_bf16 v[80:83], v[132:135], v[144:147], v[80:83]
    ds_read_b128 v[188:191], v19 offset:55296
    v_mfma_f32_16x16x32_bf16 v[84:87], v[132:135], v[148:151], v[84:87]
    ds_read_b128 v[164:167], v17 offset:34816
    v_mfma_f32_16x16x32_bf16 v[88:91], v[132:135], v[152:155], v[88:91]
    ds_read_b128 v[168:171], v17 offset:36864
    v_mfma_f32_16x16x32_bf16 v[92:95], v[132:135], v[156:159], v[92:95]
    ds_read_b128 v[172:175], v17 offset:38912
    v_mfma_f32_16x16x32_bf16 v[96:99], v[136:139], v[144:147], v[96:99]
    s_add_u32 m0, s23, 16384
    s_nop 0
    buffer_load_dwordx4 v12, s[8:11], s21 offen offset:0 lds
    v_mfma_f32_16x16x32_bf16 v[100:103], v[136:139], v[148:151], v[100:103]
    v_pk_mul_f32 v[32:33], v[232:233], v[240:241] op_sel:[0,0] op_sel_hi:[1,1]
    v_mfma_f32_16x16x32_bf16 v[104:107], v[136:139], v[152:155], v[104:107]
    buffer_load_dwordx4 v13, s[8:11], s21 offen offset:1024 lds
    v_mfma_f32_16x16x32_bf16 v[108:111], v[136:139], v[156:159], v[108:111]
    v_pk_mul_f32 v[34:35], v[234:235], v[240:241] op_sel:[0,0] op_sel_hi:[1,1]
    v_mfma_f32_16x16x32_bf16 v[112:115], v[140:143], v[144:147], v[112:115]
    buffer_load_dwordx4 v14, s[8:11], s21 offen offset:2048 lds
    v_mfma_f32_16x16x32_bf16 v[116:119], v[140:143], v[148:151], v[116:119]
    v_pk_mul_f32 v[224:225], v[28:29], v[28:29] op_sel:[0,0] op_sel_hi:[1,1]
    v_mfma_f32_16x16x32_bf16 v[120:123], v[140:143], v[152:155], v[120:123]
    buffer_load_dwordx4 v15, s[8:11], s21 offen offset:3072 lds
    v_pk_mul_f32 v[226:227], v[28:29], v[30:31] op_sel:[0,0] op_sel_hi:[1,1]
    v_mfma_f32_16x16x32_bf16 v[124:127], v[140:143], v[156:159], v[124:127]
    v_pk_fma_f32 v[224:225], v[30:31], v[30:31], v[224:225] op_sel:[0,0,0] op_sel_hi:[1,1,1] neg_lo:[1,0,0] neg_hi:[1,0,0]
    v_pk_add_f32 v[226:227], v[226:227], v[226:227]
    s_waitcnt vmcnt(8) lgkmcnt(0)
    s_barrier
    v_mfma_f32_16x16x32_bf16 v[64:67], v[160:163], v[176:179], v[64:67]
    ds_read_b128 v[128:131], v20 offset:0
    v_mfma_f32_16x16x32_bf16 v[68:71], v[160:163], v[180:183], v[68:71]
    ds_read_b128 v[144:147], v22 offset:16384
    v_mfma_f32_16x16x32_bf16 v[72:75], v[160:163], v[184:187], v[72:75]
    ds_read_b128 v[148:151], v22 offset:18432
    v_mfma_f32_16x16x32_bf16 v[76:79], v[160:163], v[188:191], v[76:79]
    ds_read_b128 v[152:155], v22 offset:20480
    v_mfma_f32_16x16x32_bf16 v[80:83], v[164:167], v[176:179], v[80:83]
    ds_read_b128 v[156:159], v22 offset:22528
    v_mfma_f32_16x16x32_bf16 v[84:87], v[164:167], v[180:183], v[84:87]
    ds_read_b128 v[132:135], v20 offset:2048
    v_mfma_f32_16x16x32_bf16 v[88:91], v[164:167], v[184:187], v[88:91]
    ds_read_b128 v[136:139], v20 offset:4096
    v_mfma_f32_16x16x32_bf16 v[92:95], v[164:167], v[188:191], v[92:95]
    ds_read_b128 v[140:143], v20 offset:6144
    v_mfma_f32_16x16x32_bf16 v[96:99], v[168:171], v[176:179], v[96:99]
    s_add_u32 m0, s23, 32768
    s_add_u32 s21, s22, 1280
    s_and_b32 s21, s21, 2047
    buffer_load_dwordx4 v8, s[4:7], s21 offen offset:0 lds
    v_mfma_f32_16x16x32_bf16 v[100:103], v[168:171], v[180:183], v[100:103]
    v_pk_mul_f32 v[228:229], v[224:225], v[224:225] op_sel:[0,0] op_sel_hi:[1,1]
    v_mfma_f32_16x16x32_bf16 v[104:107], v[168:171], v[184:187], v[104:107]
    buffer_load_dwordx4 v9, s[4:7], s21 offen offset:1024 lds
    v_mfma_f32_16x16x32_bf16 v[108:111], v[168:171], v[188:191], v[108:111]
    v_pk_mul_f32 v[230:231], v[224:225], v[226:227] op_sel:[0,0] op_sel_hi:[1,1]
    v_mfma_f32_16x16x32_bf16 v[112:115], v[172:175], v[176:179], v[112:115]
    buffer_load_dwordx4 v10, s[4:7], s21 offen offset:2048 lds
    v_mfma_f32_16x16x32_bf16 v[116:119], v[172:175], v[180:183], v[116:119]
    v_pk_fma_f32 v[228:229], v[226:227], v[226:227], v[228:229] op_sel:[0,0,0] op_sel_hi:[1,1,1] neg_lo:[1,0,0] neg_hi:[1,0,0]
    v_mfma_f32_16x16x32_bf16 v[120:123], v[172:175], v[184:187], v[120:123]
    buffer_load_dwordx4 v11, s[4:7], s21 offen offset:3072 lds
    v_mfma_f32_16x16x32_bf16 v[124:127], v[172:175], v[188:191], v[124:127]
    v_pk_add_f32 v[230:231], v[230:231], v[230:231]
    s_waitcnt lgkmcnt(0)
    v_mfma_f32_16x16x32_bf16 v[64:67], v[128:131], v[144:147], v[64:67]
    ds_read_b128 v[160:163], v21 offset:0
    v_mfma_f32_16x16x32_bf16 v[68:71], v[128:131], v[148:151], v[68:71]
    ds_read_b128 v[176:179], v23 offset:16384
    v_mfma_f32_16x16x32_bf16 v[72:75], v[128:131], v[152:155], v[72:75]
    ds_read_b128 v[180:183], v23 offset:18432
    v_mfma_f32_16x16x32_bf16 v[76:79], v[128:131], v[156:159], v[76:79]
    ds_read_b128 v[184:187], v23 offset:20480
    v_mfma_f32_16x16x32_bf16 v[80:83], v[132:135], v[144:147], v[80:83]
    ds_read_b128 v[188:191], v23 offset:22528
    v_mfma_f32_16x16x32_bf16 v[84:87], v[132:135], v[148:151], v[84:87]
    ds_read_b128 v[164:167], v21 offset:2048
    v_mfma_f32_16x16x32_bf16 v[88:91], v[132:135], v[152:155], v[88:91]
    ds_read_b128 v[168:171], v21 offset:4096
    v_mfma_f32_16x16x32_bf16 v[92:95], v[132:135], v[156:159], v[92:95]
    ds_read_b128 v[172:175], v21 offset:6144
    v_mfma_f32_16x16x32_bf16 v[96:99], v[136:139], v[144:147], v[96:99]
    s_add_u32 m0, s23, 49152
    s_nop 0
    buffer_load_dwordx4 v12, s[8:11], s21 offen offset:0 lds
    v_mfma_f32_16x16x32_bf16 v[100:103], v[136:139], v[148:151], v[100:103]
    v_pk_mul_f32 v[36:37], v[228:229], v[228:229] op_sel:[0,0] op_sel_hi:[1,1]
    v_mfma_f32_16x16x32_bf16 v[104:107], v[136:139], v[152:155], v[104:107]
    buffer_load_dwordx4 v13, s[8:11], s21 offen offset:1024 lds
    v_mfma_f32_16x16x32_bf16 v[108:111], v[136:139], v[156:159], v[108:111]
    v_pk_mul_f32 v[38:39], v[228:229], v[230:231] op_sel:[0,0] op_sel_hi:[1,1]
    v_mfma_f32_16x16x32_bf16 v[112:115], v[140:143], v[144:147], v[112:115]
    buffer_load_dwordx4 v14, s[8:11], s21 offen offset:2048 lds
    v_mfma_f32_16x16x32_bf16 v[116:119], v[140:143], v[148:151], v[116:119]
    v_pk_fma_f32 v[36:37], v[230:231], v[230:231], v[36:37] op_sel:[0,0,0] op_sel_hi:[1,1,1] neg_lo:[1,0,0] neg_hi:[1,0,0]
    v_mfma_f32_16x16x32_bf16 v[120:123], v[140:143], v[152:155], v[120:123]
    buffer_load_dwordx4 v15, s[8:11], s21 offen offset:3072 lds
    v_pk_add_f32 v[38:39], v[38:39], v[38:39]
    v_mfma_f32_16x16x32_bf16 v[124:127], v[140:143], v[156:159], v[124:127]
    v_pk_mul_f32 v[40:41], v[36:37], v[36:37] op_sel:[0,0] op_sel_hi:[1,1]
    v_pk_mul_f32 v[42:43], v[36:37], v[38:39] op_sel:[0,0] op_sel_hi:[1,1]
    s_waitcnt vmcnt(8) lgkmcnt(0)
    s_barrier
    v_mfma_f32_16x16x32_bf16 v[64:67], v[160:163], v[176:179], v[64:67]
    ds_read_b128 v[128:131], v16 offset:0
    v_mfma_f32_16x16x32_bf16 v[68:71], v[160:163], v[180:183], v[68:71]
    ds_read_b128 v[144:147], v18 offset:16384
    v_mfma_f32_16x16x32_bf16 v[72:75], v[160:163], v[184:187], v[72:75]
    ds_read_b128 v[148:151], v18 offset:18432
    v_mfma_f32_16x16x32_bf16 v[76:79], v[160:163], v[188:191], v[76:79]
    ds_read_b128 v[152:155], v18 offset:20480
    v_mfma_f32_16x16x32_bf16 v[80:83], v[164:167], v[176:179], v[80:83]
    ds_read_b128 v[156:159], v18 offset:22528
    v_mfma_f32_16x16x32_bf16 v[84:87], v[164:167], v[180:183], v[84:87]
    ds_read_b128 v[132:135], v16 offset:2048
    v_mfma_f32_16x16x32_bf16 v[88:91], v[164:167], v[184:187], v[88:91]
    ds_read_b128 v[136:139], v16 offset:4096
    v_mfma_f32_16x16x32_bf16 v[92:95], v[164:167], v[188:191], v[92:95]
    ds_read_b128 v[140:143], v16 offset:6144
    v_mfma_f32_16x16x32_bf16 v[96:99], v[168:171], v[176:179], v[96:99]
    s_add_u32 m0, s23, 65536
    s_add_u32 s21, s22, 1408
    s_and_b32 s21, s21, 2047
    buffer_load_dwordx4 v8, s[4:7], s21 offen offset:0 lds
    v_mfma_f32_16x16x32_bf16 v[100:103], v[168:171], v[180:183], v[100:103]
    v_pk_fma_f32 v[40:41], v[38:39], v[38:39], v[40:41] op_sel:[0,0,0] op_sel_hi:[1,1,1] neg_lo:[1,0,0] neg_hi:[1,0,0]
    v_mfma_f32_16x16x32_bf16 v[104:107], v[168:171], v[184:187], v[104:107]
    buffer_load_dwordx4 v9, s[4:7], s21 offen offset:1024 lds
    v_mfma_f32_16x16x32_bf16 v[108:111], v[168:171], v[188:191], v[108:111]
    v_pk_add_f32 v[42:43], v[42:43], v[42:43]
    v_mfma_f32_16x16x32_bf16 v[112:115], v[172:175], v[176:179], v[112:115]
    buffer_load_dwordx4 v10, s[4:7], s21 offen offset:2048 lds
    v_mfma_f32_16x16x32_bf16 v[116:119], v[172:175], v[180:183], v[116:119]
    v_pk_mul_f32 v[224:225], v[40:41], v[40:41] op_sel:[0,0] op_sel_hi:[1,1]
    v_mfma_f32_16x16x32_bf16 v[120:123], v[172:175], v[184:187], v[120:123]
    buffer_load_dwordx4 v11, s[4:7], s21 offen offset:3072 lds
    v_mfma_f32_16x16x32_bf16 v[124:127], v[172:175], v[188:191], v[124:127]
    v_pk_mul_f32 v[226:227], v[40:41], v[42:43] op_sel:[0,0] op_sel_hi:[1,1]
    s_waitcnt lgkmcnt(0)
    v_mfma_f32_16x16x32_bf16 v[64:67], v[128:131], v[144:147], v[64:67]
    ds_read_b128 v[160:163], v17 offset:0
    v_mfma_f32_16x16x32_bf16 v[68:71], v[128:131], v[148:151], v[68:71]
    ds_read_b128 v[176:179], v19 offset:16384
    v_mfma_f32_16x16x32_bf16 v[72:75], v[128:131], v[152:155], v[72:75]
    ds_read_b128 v[180:183], v19 offset:18432
    v_mfma_f32_16x16x32_bf16 v[76:79], v[128:131], v[156:159], v[76:79]
    ds_read_b128 v[184:187], v19 offset:20480
    v_mfma_f32_16x16x32_bf16 v[80:83], v[132:135], v[144:147], v[80:83]
    ds_read_b128 v[188:191], v19 offset:22528
    v_mfma_f32_16x16x32_bf16 v[84:87], v[132:135], v[148:151], v[84:87]
    ds_read_b128 v[164:167], v17 offset:2048
    v_mfma_f32_16x16x32_bf16 v[88:91], v[132:135], v[152:155], v[88:91]
    ds_read_b128 v[168:171], v17 offset:4096
    v_mfma_f32_16x16x32_bf16 v[92:95], v[132:135], v[156:159], v[92:95]
    ds_read_b128 v[172:175], v17 offset:6144
    v_mfma_f32_16x16x32_bf16 v[96:99], v[136:139], v[144:147], v[96:99]
    s_add_u32 m0, s23, 81920
    s_nop 0
    buffer_load_dwordx4 v12, s[8:11], s21 offen offset:0 lds
    v_mfma_f32_16x16x32_bf16 v[100:103], v[136:139], v[148:151], v[100:103]
    v_pk_fma_f32 v[224:225], v[42:43], v[42:43], v[224:225] op_sel:[0,0,0] op_sel_hi:[1,1,1] neg_lo:[1,0,0] neg_hi:[1,0,0]
    v_mfma_f32_16x16x32_bf16 v[104:107], v[136:139], v[152:155], v[104:107]
    buffer_load_dwordx4 v13, s[8:11], s21 offen offset:1024 lds
    v_mfma_f32_16x16x32_bf16 v[108:111], v[136:139], v[156:159], v[108:111]
    v_pk_add_f32 v[226:227], v[226:227], v[226:227]
    v_mfma_f32_16x16x32_bf16 v[112:115], v[140:143], v[144:147], v[112:115]
    buffer_load_dwordx4 v14, s[8:11], s21 offen offset:2048 lds
    v_mfma_f32_16x16x32_bf16 v[116:119], v[140:143], v[148:151], v[116:119]
    v_pk_mul_f32 v[228:229], v[224:225], v[224:225] op_sel:[0,0] op_sel_hi:[1,1]
    v_mfma_f32_16x16x32_bf16 v[120:123], v[140:143], v[152:155], v[120:123]
    buffer_load_dwordx4 v15, s[8:11], s21 offen offset:3072 lds
    v_pk_mul_f32 v[230:231], v[224:225], v[226:227] op_sel:[0,0] op_sel_hi:[1,1]
    v_mfma_f32_16x16x32_bf16 v[124:127], v[140:143], v[156:159], v[124:127]
    v_pk_fma_f32 v[228:229], v[226:227], v[226:227], v[228:229] op_sel:[0,0,0] op_sel_hi:[1,1,1] neg_lo:[1,0,0] neg_hi:[1,0,0]
    v_pk_add_f32 v[230:231], v[230:231], v[230:231]
    s_waitcnt vmcnt(8) lgkmcnt(0)
    s_barrier
    v_mfma_f32_16x16x32_bf16 v[64:67], v[160:163], v[176:179], v[64:67]
    ds_read_b128 v[128:131], v16 offset:32768
    v_mfma_f32_16x16x32_bf16 v[68:71], v[160:163], v[180:183], v[68:71]
    ds_read_b128 v[144:147], v18 offset:49152
    v_mfma_f32_16x16x32_bf16 v[72:75], v[160:163], v[184:187], v[72:75]
    ds_read_b128 v[148:151], v18 offset:51200
    v_mfma_f32_16x16x32_bf16 v[76:79], v[160:163], v[188:191], v[76:79]
    ds_read_b128 v[152:155], v18 offset:53248
    v_mfma_f32_16x16x32_bf16 v[80:83], v[164:167], v[176:179], v[80:83]
    ds_read_b128 v[156:159], v18 offset:55296
    v_mfma_f32_16x16x32_bf16 v[84:87], v[164:167], v[180:183], v[84:87]
    ds_read_b128 v[132:135], v16 offset:34816
    v_mfma_f32_16x16x32_bf16 v[88:91], v[164:167], v[184:187], v[88:91]
    ds_read_b128 v[136:139], v16 offset:36864
    v_mfma_f32_16x16x32_bf16 v[92:95], v[164:167], v[188:191], v[92:95]
    ds_read_b128 v[140:143], v16 offset:38912
    v_mfma_f32_16x16x32_bf16 v[96:99], v[168:171], v[176:179], v[96:99]
    s_add_u32 m0, s23, 0
    s_add_u32 s21, s22, 1536
    s_and_b32 s21, s21, 2047
    buffer_load_dwordx4 v8, s[4:7], s21 offen offset:0 lds
    v_mfma_f32_16x16x32_bf16 v[100:103], v[168:171], v[180:183], v[100:103]
    v_and_b32 v240, 1, v25
    v_mfma_f32_16x16x32_bf16 v[104:107], v[168:171], v[184:187], v[104:107]
    buffer_load_dwordx4 v9, s[4:7], s21 offen offset:1024 lds
    v_mfma_f32_16x16x32_bf16 v[108:111], v[168:171], v[188:191], v[108:111]
    v_cmp_eq_u32 s[84:85], 1, v240
    v_mfma_f32_16x16x32_bf16 v[112:115], v[172:175], v[176:179], v[112:115]
    buffer_load_dwordx4 v10, s[4:7], s21 offen offset:2048 lds
    v_mfma_f32_16x16x32_bf16 v[116:119], v[172:175], v[180:183], v[116:119]
    v_cmp_lt_u32 s[86:87], 1, v25
    v_mfma_f32_16x16x32_bf16 v[120:123], v[172:175], v[184:187], v[120:123]
    buffer_load_dwordx4 v11, s[4:7], s21 offen offset:3072 lds
    v_mfma_f32_16x16x32_bf16 v[124:127], v[172:175], v[188:191], v[124:127]
    v_cndmask_b32 v232, 1.0, v40, s[84:85]
    s_waitcnt lgkmcnt(0)
    v_mfma_f32_16x16x32_bf16 v[64:67], v[128:131], v[144:147], v[64:67]
    ds_read_b128 v[160:163], v17 offset:32768
    v_mfma_f32_16x16x32_bf16 v[68:71], v[128:131], v[148:151], v[68:71]
    ds_read_b128 v[176:179], v19 offset:49152
    v_mfma_f32_16x16x32_bf16 v[72:75], v[128:131], v[152:155], v[72:75]
    ds_read_b128 v[180:183], v19 offset:51200
    v_mfma_f32_16x16x32_bf16 v[76:79], v[128:131], v[156:159], v[76:79]
    ds_read_b128 v[184:187], v19 offset:53248
    v_mfma_f32_16x16x32_bf16 v[80:83], v[132:135], v[144:147], v[80:83]
    ds_read_b128 v[188:191], v19 offset:55296
    v_mfma_f32_16x16x32_bf16 v[84:87], v[132:135], v[148:151], v[84:87]
    ds_read_b128 v[164:167], v17 offset:34816
    v_mfma_f32_16x16x32_bf16 v[88:91], v[132:135], v[152:155], v[88:91]
    ds_read_b128 v[168:171], v17 offset:36864
    v_mfma_f32_16x16x32_bf16 v[92:95], v[132:135], v[156:159], v[92:95]
    ds_read_b128 v[172:175], v17 offset:38912
    v_mfma_f32_16x16x32_bf16 v[96:99], v[136:139], v[144:147], v[96:99]
    s_add_u32 m0, s23, 16384
    s_nop 0
    buffer_load_dwordx4 v12, s[8:11], s21 offen offset:0 lds
    v_mfma_f32_16x16x32_bf16 v[100:103], v[136:139], v[148:151], v[100:103]
    v_cndmask_b32 v234, 0, v42, s[84:85]
    v_mfma_f32_16x16x32_bf16 v[104:107], v[136:139], v[152:155], v[104:107]
    buffer_load_dwordx4 v13, s[8:11], s21 offen offset:1024 lds
    v_mfma_f32_16x16x32_bf16 v[108:111], v[136:139], v[156:159], v[108:111]
    v_cndmask_b32 v233, 1.0, v41, s[84:85]
    v_mfma_f32_16x16x32_bf16 v[112:115], v[140:143], v[144:147], v[112:115]
    buffer_load_dwordx4 v14, s[8:11], s21 offen offset:2048 lds
    v_mfma_f32_16x16x32_bf16 v[116:119], v[140:143], v[148:151], v[116:119]
    v_cndmask_b32 v235, 0, v43, s[84:85]
    v_mfma_f32_16x16x32_bf16 v[120:123], v[140:143], v[152:155], v[120:123]
    buffer_load_dwordx4 v15, s[8:11], s21 offen offset:3072 lds
    v_cndmask_b32 v236, 1.0, v224, s[86:87]
    v_mfma_f32_16x16x32_bf16 v[124:127], v[140:143], v[156:159], v[124:127]
    v_cndmask_b32 v238, 0, v226, s[86:87]
    v_cndmask_b32 v237, 1.0, v225, s[86:87]
    s_waitcnt vmcnt(8) lgkmcnt(0)
    s_barrier
    v_mfma_f32_16x16x32_bf16 v[64:67], v[160:163], v[176:179], v[64:67]
    ds_read_b128 v[128:131], v20 offset:0
    v_mfma_f32_16x16x32_bf16 v[68:71], v[160:163], v[180:183], v[68:71]
    ds_read_b128 v[144:147], v22 offset:16384
    v_mfma_f32_16x16x32_bf16 v[72:75], v[160:163], v[184:187], v[72:75]
    ds_read_b128 v[148:151], v22 offset:18432
    v_mfma_f32_16x16x32_bf16 v[76:79], v[160:163], v[188:191], v[76:79]
    ds_read_b128 v[152:155], v22 offset:20480
    v_mfma_f32_16x16x32_bf16 v[80:83], v[164:167], v[176:179], v[80:83]
    ds_read_b128 v[156:159], v22 offset:22528
    v_mfma_f32_16x16x32_bf16 v[84:87], v[164:167], v[180:183], v[84:87]
    ds_read_b128 v[132:135], v20 offset:2048
    v_mfma_f32_16x16x32_bf16 v[88:91], v[164:167], v[184:187], v[88:91]
    ds_read_b128 v[136:139], v20 offset:4096
    v_mfma_f32_16x16x32_bf16 v[92:95], v[164:167], v[188:191], v[92:95]
    ds_read_b128 v[140:143], v20 offset:6144
    v_mfma_f32_16x16x32_bf16 v[96:99], v[168:171], v[176:179], v[96:99]
    s_add_u32 m0, s23, 32768
    s_add_u32 s21, s22, 1664
    s_and_b32 s21, s21, 2047
    buffer_load_dwordx4 v8, s[4:7], s21 offen offset:0 lds
    v_mfma_f32_16x16x32_bf16 v[100:103], v[168:171], v[180:183], v[100:103]
    v_cndmask_b32 v239, 0, v227, s[86:87]
    v_mfma_f32_16x16x32_bf16 v[104:107], v[168:171], v[184:187], v[104:107]
    buffer_load_dwordx4 v9, s[4:7], s21 offen offset:1024 lds
    v_mfma_f32_16x16x32_bf16 v[108:111], v[168:171], v[188:191], v[108:111]
    v_pk_mul_f32 v[242:243], v[232:233], v[236:237] op_sel:[0,0] op_sel_hi:[1,1]
    v_mfma_f32_16x16x32_bf16 v[112:115], v[172:175], v[176:179], v[112:115]
    buffer_load_dwordx4 v10, s[4:7], s21 offen offset:2048 lds
    v_mfma_f32_16x16x32_bf16 v[116:119], v[172:175], v[180:183], v[116:119]
    v_pk_mul_f32 v[244:245], v[232:233], v[238:239] op_sel:[0,0] op_sel_hi:[1,1]
    v_mfma_f32_16x16x32_bf16 v[120:123], v[172:175], v[184:187], v[120:123]
    buffer_load_dwordx4 v11, s[4:7], s21 offen offset:3072 lds
    v_mfma_f32_16x16x32_bf16 v[124:127], v[172:175], v[188:191], v[124:127]
    v_pk_fma_f32 v[242:243], v[234:235], v[238:239], v[242:243] op_sel:[0,0,0] op_sel_hi:[1,1,1] neg_lo:[1,0,0] neg_hi:[1,0,0]
    s_waitcnt lgkmcnt(0)
    v_mfma_f32_16x16x32_bf16 v[64:67], v[128:131], v[144:147], v[64:67]
    ds_read_b128 v[160:163], v21 offset:0
    v_mfma_f32_16x16x32_bf16 v[68:71], v[128:131], v[148:151], v[68:71]
    ds_read_b128 v[176:179], v23 offset:16384
    v_mfma_f32_16x16x32_bf16 v[72:75], v[128:131], v[152:155], v[72:75]
    ds_read_b128 v[180:183], v23 offset:18432
    v_mfma_f32_16x16x32_bf16 v[76:79], v[128:131], v[156:159], v[76:79]
    ds_read_b128 v[184:187], v23 offset:20480
    v_mfma_f32_16x16x32_bf16 v[80:83], v[132:135], v[144:147], v[80:83]
    ds_read_b128 v[188:191], v23 offset:22528
    v_mfma_f32_16x16x32_bf16 v[84:87], v[132:135], v[148:151], v[84:87]
    ds_read_b128 v[164:167], v21 offset:2048
    v_mfma_f32_16x16x32_bf16 v[88:91], v[132:135], v[152:155], v[88:91]
    ds_read_b128 v[168:171], v21 offset:4096
    v_mfma_f32_16x16x32_bf16 v[92:95], v[132:135], v[156:159], v[92:95]
    ds_read_b128 v[172:175], v21 offset:6144
    v_mfma_f32_16x16x32_bf16 v[96:99], v[136:139], v[144:147], v[96:99]
    s_add_u32 m0, s23, 49152
    s_nop 0
    buffer_load_dwordx4 v12, s[8:11], s21 offen offset:0 lds
    v_mfma_f32_16x16x32_bf16 v[100:103], v[136:139], v[148:151], v[100:103]
    v_pk_fma_f32 v[244:245], v[234:235], v[236:237], v[244:245] op_sel:[0,0,0] op_sel_hi:[1,1,1]
    v_mfma_f32_16x16x32_bf16 v[104:107], v[136:139], v[152:155], v[104:107]
    buffer_load_dwordx4 v13, s[8:11], s21 offen offset:1024 lds
    v_mfma_f32_16x16x32_bf16 v[108:111], v[136:139], v[156:159], v[108:111]
    v_cndmask_b32 v232, 1.0, v228, s[82:83]
    v_mfma_f32_16x16x32_bf16 v[112:115], v[140:143], v[144:147], v[112:115]
    buffer_load_dwordx4 v14, s[8:11], s21 offen offset:2048 lds
    v_mfma_f32_16x16x32_bf16 v[116:119], v[140:143], v[148:151], v[116:119]
    v_cndmask_b32 v234, 0, v230, s[82:83]
    v_mfma_f32_16x16x32_bf16 v[120:123], v[140:143], v[152:155], v[120:123]
    buffer_load_dwordx4 v15, s[8:11], s21 offen offset:3072 lds
    v_cndmask_b32 v233, 1.0, v229, s[82:83]
    v_mfma_f32_16x16x32_bf16 v[124:127], v[140:143], v[156:159], v[124:127]
    v_cndmask_b32 v235, 0, v231, s[82:83]
    v_pk_mul_f32 v[52:53], v[242:243], v[232:233] op_sel:[0,0] op_sel_hi:[1,1]
    s_waitcnt vmcnt(8) lgkmcnt(0)
    s_barrier
    v_mfma_f32_16x16x32_bf16 v[64:67], v[160:163], v[176:179], v[64:67]
    ds_read_b128 v[128:131], v16 offset:0
    v_mfma_f32_16x16x32_bf16 v[68:71], v[160:163], v[180:183], v[68:71]
    ds_read_b128 v[144:147], v18 offset:16384
    v_mfma_f32_16x16x32_bf16 v[72:75], v[160:163], v[184:187], v[72:75]
    ds_read_b128 v[148:151], v18 offset:18432
    v_mfma_f32_16x16x32_bf16 v[76:79], v[160:163], v[188:191], v[76:79]
    ds_read_b128 v[152:155], v18 offset:20480
    v_mfma_f32_16x16x32_bf16 v[80:83], v[164:167], v[176:179], v[80:83]
    ds_read_b128 v[156:159], v18 offset:22528
    v_mfma_f32_16x16x32_bf16 v[84:87], v[164:167], v[180:183], v[84:87]
    ds_read_b128 v[132:135], v16 offset:2048
    v_mfma_f32_16x16x32_bf16 v[88:91], v[164:167], v[184:187], v[88:91]
    ds_read_b128 v[136:139], v16 offset:4096
    v_mfma_f32_16x16x32_bf16 v[92:95], v[164:167], v[188:191], v[92:95]
    ds_read_b128 v[140:143], v16 offset:6144
    v_mfma_f32_16x16x32_bf16 v[96:99], v[168:171], v[176:179], v[96:99]
    s_add_u32 m0, s23, 65536
    s_add_u32 s21, s22, 1792
    s_and_b32 s21, s21, 2047
    buffer_load_dwordx4 v8, s[4:7], s21 offen offset:0 lds
    v_mfma_f32_16x16x32_bf16 v[100:103], v[168:171], v[180:183], v[100:103]
    v_pk_mul_f32 v[54:55], v[242:243], v[234:235] op_sel:[0,0] op_sel_hi:[1,1]
    v_mfma_f32_16x16x32_bf16 v[104:107], v[168:171], v[184:187], v[104:107]
    buffer_load_dwordx4 v9, s[4:7], s21 offen offset:1024 lds
    v_mfma_f32_16x16x32_bf16 v[108:111], v[168:171], v[188:191], v[108:111]
    v_pk_fma_f32 v[52:53], v[244:245], v[234:235], v[52:53] op_sel:[0,0,0] op_sel_hi:[1,1,1] neg_lo:[1,0,0] neg_hi:[1,0,0]
    v_mfma_f32_16x16x32_bf16 v[112:115], v[172:175], v[176:179], v[112:115]
    buffer_load_dwordx4 v10, s[4:7], s21 offen offset:2048 lds
    v_mfma_f32_16x16x32_bf16 v[116:119], v[172:175], v[180:183], v[116:119]
    v_pk_fma_f32 v[54:55], v[244:245], v[232:233], v[54:55] op_sel:[0,0,0] op_sel_hi:[1,1,1]
    v_mfma_f32_16x16x32_bf16 v[120:123], v[172:175], v[184:187], v[120:123]
    buffer_load_dwordx4 v11, s[4:7], s21 offen offset:3072 lds
    v_mfma_f32_16x16x32_bf16 v[124:127], v[172:175], v[188:191], v[124:127]
    v_pk_mul_f32 v[224:225], v[228:229], v[228:229] op_sel:[0,0] op_sel_hi:[1,1]
    s_waitcnt lgkmcnt(0)
    v_mfma_f32_16x16x32_bf16 v[64:67], v[128:131], v[144:147], v[64:67]
    ds_read_b128 v[160:163], v17 offset:0
    v_mfma_f32_16x16x32_bf16 v[68:71], v[128:131], v[148:151], v[68:71]
    ds_read_b128 v[176:179], v19 offset:16384
    v_mfma_f32_16x16x32_bf16 v[72:75], v[128:131], v[152:155], v[72:75]
    ds_read_b128 v[180:183], v19 offset:18432
    v_mfma_f32_16x16x32_bf16 v[76:79], v[128:131], v[156:159], v[76:79]
    ds_read_b128 v[184:187], v19 offset:20480
    v_mfma_f32_16x16x32_bf16 v[80:83], v[132:135], v[144:147], v[80:83]
    ds_read_b128 v[188:191], v19 offset:22528
    v_mfma_f32_16x16x32_bf16 v[84:87], v[132:135], v[148:151], v[84:87]
    ds_read_b128 v[164:167], v17 offset:2048
    v_mfma_f32_16x16x32_bf16 v[88:91], v[132:135], v[152:155], v[88:91]
    ds_read_b128 v[168:171], v17 offset:4096
    v_mfma_f32_16x16x32_bf16 v[92:95], v[132:135], v[156:159], v[92:95]
    ds_read_b128 v[172:175], v17 offset:6144
    v_mfma_f32_16x16x32_bf16 v[96:99], v[136:139], v[144:147], v[96:99]
    s_add_u32 m0, s23, 81920
    s_nop 0
    buffer_load_dwordx4 v12, s[8:11], s21 offen offset:0 lds
    v_mfma_f32_16x16x32_bf16 v[100:103], v[136:139], v[148:151], v[100:103]
    v_pk_mul_f32 v[226:227], v[228:229], v[230:231] op_sel:[0,0] op_sel_hi:[1,1]
    v_mfma_f32_16x16x32_bf16 v[104:107], v[136:139], v[152:155], v[104:107]
    buffer_load_dwordx4 v13, s[8:11], s21 offen offset:1024 lds
    v_mfma_f32_16x16x32_bf16 v[108:111], v[136:139], v[156:159], v[108:111]
    v_pk_fma_f32 v[224:225], v[230:231], v[230:231], v[224:225] op_sel:[0,0,0] op_sel_hi:[1,1,1] neg_lo:[1,0,0] neg_hi:[1,0,0]
    v_mfma_f32_16x16x32_bf16 v[112:115], v[140:143], v[144:147], v[112:115]
    buffer_load_dwordx4 v14, s[8:11], s21 offen offset:2048 lds
    v_mfma_f32_16x16x32_bf16 v[116:119], v[140:143], v[148:151], v[116:119]
    v_pk_add_f32 v[226:227], v[226:227], v[226:227]
    v_mfma_f32_16x16x32_bf16 v[120:123], v[140:143], v[152:155], v[120:123]
    buffer_load_dwordx4 v15, s[8:11], s21 offen offset:3072 lds
    v_pk_mul_f32 v[228:229], v[224:225], v[224:225] op_sel:[0,0] op_sel_hi:[1,1]
    v_mfma_f32_16x16x32_bf16 v[124:127], v[140:143], v[156:159], v[124:127]
    v_pk_mul_f32 v[230:231], v[224:225], v[226:227] op_sel:[0,0] op_sel_hi:[1,1]
    v_pk_fma_f32 v[228:229], v[226:227], v[226:227], v[228:229] op_sel:[0,0,0] op_sel_hi:[1,1,1] neg_lo:[1,0,0] neg_hi:[1,0,0]
    buffer_load_dword v2, v1, s[12:15], s52 offen sc1
    s_waitcnt vmcnt(9) lgkmcnt(0)
    s_barrier
    v_mfma_f32_16x16x32_bf16 v[64:67], v[160:163], v[176:179], v[64:67]
    ds_read_b128 v[128:131], v16 offset:32768
    v_mfma_f32_16x16x32_bf16 v[68:71], v[160:163], v[180:183], v[68:71]
    ds_read_b128 v[144:147], v18 offset:49152
    v_mfma_f32_16x16x32_bf16 v[72:75], v[160:163], v[184:187], v[72:75]
    ds_read_b128 v[148:151], v18 offset:51200
    v_mfma_f32_16x16x32_bf16 v[76:79], v[160:163], v[188:191], v[76:79]
    ds_read_b128 v[152:155], v18 offset:53248
    v_mfma_f32_16x16x32_bf16 v[80:83], v[164:167], v[176:179], v[80:83]
    ds_read_b128 v[156:159], v18 offset:55296
    v_mfma_f32_16x16x32_bf16 v[84:87], v[164:167], v[180:183], v[84:87]
    ds_read_b128 v[132:135], v16 offset:34816
    v_mfma_f32_16x16x32_bf16 v[88:91], v[164:167], v[184:187], v[88:91]
    ds_read_b128 v[136:139], v16 offset:36864
    v_mfma_f32_16x16x32_bf16 v[92:95], v[164:167], v[188:191], v[92:95]
    ds_read_b128 v[140:143], v16 offset:38912
    v_mfma_f32_16x16x32_bf16 v[96:99], v[168:171], v[176:179], v[96:99]
    s_add_u32 m0, s23, 0
    s_add_u32 s21, s22, 1920
    s_and_b32 s21, s21, 2047
    buffer_load_dwordx4 v8, s[4:7], s21 offen offset:0 lds
    v_mfma_f32_16x16x32_bf16 v[100:103], v[168:171], v[180:183], v[100:103]
    v_pk_add_f32 v[230:231], v[230:231], v[230:231]
    v_mfma_f32_16x16x32_bf16 v[104:107], v[168:171], v[184:187], v[104:107]
    buffer_load_dwordx4 v9, s[4:7], s21 offen offset:1024 lds
    v_mfma_f32_16x16x32_bf16 v[108:111], v[168:171], v[188:191], v[108:111]
    v_pk_mul_f32 v[44:45], v[228:229], v[228:229] op_sel:[0,0] op_sel_hi:[1,1]
    v_mfma_f32_16x16x32_bf16 v[112:115], v[172:175], v[176:179], v[112:115]
    buffer_load_dwordx4 v10, s[4:7], s21 offen offset:2048 lds
    v_mfma_f32_16x16x32_bf16 v[116:119], v[172:175], v[180:183], v[116:119]
    v_pk_mul_f32 v[46:47], v[228:229], v[230:231] op_sel:[0,0] op_sel_hi:[1,1]
    v_mfma_f32_16x16x32_bf16 v[120:123], v[172:175], v[184:187], v[120:123]
    buffer_load_dwordx4 v11, s[4:7], s21 offen offset:3072 lds
    v_mfma_f32_16x16x32_bf16 v[124:127], v[172:175], v[188:191], v[124:127]
    v_pk_fma_f32 v[44:45], v[230:231], v[230:231], v[44:45] op_sel:[0,0,0] op_sel_hi:[1,1,1] neg_lo:[1,0,0] neg_hi:[1,0,0]
    s_waitcnt lgkmcnt(0)
    v_mfma_f32_16x16x32_bf16 v[64:67], v[128:131], v[144:147], v[64:67]
    ds_read_b128 v[160:163], v17 offset:32768
    v_mfma_f32_16x16x32_bf16 v[68:71], v[128:131], v[148:151], v[68:71]
    ds_read_b128 v[176:179], v19 offset:49152
    v_mfma_f32_16x16x32_bf16 v[72:75], v[128:131], v[152:155], v[72:75]
    ds_read_b128 v[180:183], v19 offset:51200
    v_mfma_f32_16x16x32_bf16 v[76:79], v[128:131], v[156:159], v[76:79]
    ds_read_b128 v[184:187], v19 offset:53248
    v_mfma_f32_16x16x32_bf16 v[80:83], v[132:135], v[144:147], v[80:83]
    ds_read_b128 v[188:191], v19 offset:55296
    v_mfma_f32_16x16x32_bf16 v[84:87], v[132:135], v[148:151], v[84:87]
    ds_read_b128 v[164:167], v17 offset:34816
    v_mfma_f32_16x16x32_bf16 v[88:91], v[132:135], v[152:155], v[88:91]
    ds_read_b128 v[168:171], v17 offset:36864
    v_mfma_f32_16x16x32_bf16 v[92:95], v[132:135], v[156:159], v[92:95]
    ds_read_b128 v[172:175], v17 offset:38912
    v_mfma_f32_16x16x32_bf16 v[96:99], v[136:139], v[144:147], v[96:99]
    s_add_u32 m0, s23, 16384
    s_nop 0
    buffer_load_dwordx4 v12, s[8:11], s21 offen offset:0 lds
    v_mfma_f32_16x16x32_bf16 v[100:103], v[136:139], v[148:151], v[100:103]
    v_pk_add_f32 v[46:47], v[46:47], v[46:47]
    v_mfma_f32_16x16x32_bf16 v[104:107], v[136:139], v[152:155], v[104:107]
    buffer_load_dwordx4 v13, s[8:11], s21 offen offset:1024 lds
    v_mfma_f32_16x16x32_bf16 v[108:111], v[136:139], v[156:159], v[108:111]
    v_cndmask_b32 v232, 1.0, v224, s[84:85]
    v_mfma_f32_16x16x32_bf16 v[112:115], v[140:143], v[144:147], v[112:115]
    buffer_load_dwordx4 v14, s[8:11], s21 offen offset:2048 lds
    v_mfma_f32_16x16x32_bf16 v[116:119], v[140:143], v[148:151], v[116:119]
    v_cndmask_b32 v234, 0, v226, s[84:85]
    v_mfma_f32_16x16x32_bf16 v[120:123], v[140:143], v[152:155], v[120:123]
    buffer_load_dwordx4 v15, s[8:11], s21 offen offset:3072 lds
    v_cndmask_b32 v233, 1.0, v225, s[84:85]
    v_mfma_f32_16x16x32_bf16 v[124:127], v[140:143], v[156:159], v[124:127]
    v_cndmask_b32 v235, 0, v227, s[84:85]
    v_cndmask_b32 v236, 1.0, v228, s[86:87]
    s_waitcnt vmcnt(9) lgkmcnt(0)
    s_barrier
    v_mfma_f32_16x16x32_bf16 v[64:67], v[160:163], v[176:179], v[64:67]
    ds_read_b128 v[128:131], v20 offset:0
    v_mfma_f32_16x16x32_bf16 v[68:71], v[160:163], v[180:183], v[68:71]
    ds_read_b128 v[144:147], v22 offset:16384
    v_mfma_f32_16x16x32_bf16 v[72:75], v[160:163], v[184:187], v[72:75]
    ds_read_b128 v[148:151], v22 offset:18432
    v_mfma_f32_16x16x32_bf16 v[76:79], v[160:163], v[188:191], v[76:79]
    ds_read_b128 v[152:155], v22 offset:20480
    v_mfma_f32_16x16x32_bf16 v[80:83], v[164:167], v[176:179], v[80:83]
    ds_read_b128 v[156:159], v22 offset:22528
    v_mfma_f32_16x16x32_bf16 v[84:87], v[164:167], v[180:183], v[84:87]
    ds_read_b128 v[132:135], v20 offset:2048
    v_mfma_f32_16x16x32_bf16 v[88:91], v[164:167], v[184:187], v[88:91]
    ds_read_b128 v[136:139], v20 offset:4096
    v_mfma_f32_16x16x32_bf16 v[92:95], v[164:167], v[188:191], v[92:95]
    ds_read_b128 v[140:143], v20 offset:6144
    v_mfma_f32_16x16x32_bf16 v[96:99], v[168:171], v[176:179], v[96:99]
    v_cndmask_b32 v238, 0, v230, s[86:87]
    v_cndmask_b32 v237, 1.0, v229, s[86:87]
    v_mfma_f32_16x16x32_bf16 v[100:103], v[168:171], v[180:183], v[100:103]
    v_cndmask_b32 v239, 0, v231, s[86:87]
    v_pk_mul_f32 v[48:49], v[232:233], v[236:237] op_sel:[0,0] op_sel_hi:[1,1]
    v_mfma_f32_16x16x32_bf16 v[104:107], v[168:171], v[184:187], v[104:107]
    v_pk_mul_f32 v[50:51], v[232:233], v[238:239] op_sel:[0,0] op_sel_hi:[1,1]
    v_pk_fma_f32 v[48:49], v[234:235], v[238:239], v[48:49] op_sel:[0,0,0] op_sel_hi:[1,1,1] neg_lo:[1,0,0] neg_hi:[1,0,0]
    v_mfma_f32_16x16x32_bf16 v[108:111], v[168:171], v[188:191], v[108:111]
    v_pk_fma_f32 v[50:51], v[234:235], v[236:237], v[50:51] op_sel:[0,0,0] op_sel_hi:[1,1,1]
    v_mov_b32 v224, v52
    v_mfma_f32_16x16x32_bf16 v[112:115], v[172:175], v[176:179], v[112:115]
    v_mov_b32 v226, v54
    v_mul_f32 v225, v36, v52
    v_mfma_f32_16x16x32_bf16 v[116:119], v[172:175], v[180:183], v[116:119]
    v_mul_f32 v227, v36, v54
    v_fma_f32 v225, -v38, v54, v225
    v_mfma_f32_16x16x32_bf16 v[120:123], v[172:175], v[184:187], v[120:123]
    v_fma_f32 v227, v38, v52, v227
    v_pk_mul_f32 v[206:207], v[32:33], v[224:225] op_sel:[0,0] op_sel_hi:[0,1]
    v_mfma_f32_16x16x32_bf16 v[124:127], v[172:175], v[188:191], v[124:127]
    v_pk_mul_f32 v[208:209], v[32:33], v[226:227] op_sel:[0,0] op_sel_hi:[0,1]
    v_pk_fma_f32 v[206:207], v[34:35], v[226:227], v[206:207] op_sel:[0,0,0] op_sel_hi:[0,1,1] neg_lo:[1,0,0] neg_hi:[1,0,0]
    s_waitcnt lgkmcnt(0)
    v_mfma_f32_16x16x32_bf16 v[64:67], v[128:131], v[144:147], v[64:67]
    ds_read_b128 v[160:163], v21 offset:0
    v_mfma_f32_16x16x32_bf16 v[68:71], v[128:131], v[148:151], v[68:71]
    ds_read_b128 v[176:179], v23 offset:16384
    v_mfma_f32_16x16x32_bf16 v[72:75], v[128:131], v[152:155], v[72:75]
    ds_read_b128 v[180:183], v23 offset:18432
    v_mfma_f32_16x16x32_bf16 v[76:79], v[128:131], v[156:159], v[76:79]
    ds_read_b128 v[184:187], v23 offset:20480
    v_mfma_f32_16x16x32_bf16 v[80:83], v[132:135], v[144:147], v[80:83]
    ds_read_b128 v[188:191], v23 offset:22528
    v_mfma_f32_16x16x32_bf16 v[84:87], v[132:135], v[148:151], v[84:87]
    ds_read_b128 v[164:167], v21 offset:2048
    v_mfma_f32_16x16x32_bf16 v[88:91], v[132:135], v[152:155], v[88:91]
    ds_read_b128 v[168:171], v21 offset:4096
    v_mfma_f32_16x16x32_bf16 v[92:95], v[132:135], v[156:159], v[92:95]
    ds_read_b128 v[172:175], v21 offset:6144
    v_mfma_f32_16x16x32_bf16 v[96:99], v[136:139], v[144:147], v[96:99]
    v_pk_fma_f32 v[208:209], v[34:35], v[224:225], v[208:209] op_sel:[0,0,0] op_sel_hi:[0,1,1]
    v_mov_b32 v224, v53
    v_mfma_f32_16x16x32_bf16 v[100:103], v[136:139], v[148:151], v[100:103]
    v_mov_b32 v226, v55
    v_mul_f32 v225, v37, v53
    v_mfma_f32_16x16x32_bf16 v[104:107], v[136:139], v[152:155], v[104:107]
    v_mul_f32 v227, v37, v55
    v_fma_f32 v225, -v39, v55, v225
    v_mfma_f32_16x16x32_bf16 v[108:111], v[136:139], v[156:159], v[108:111]
    v_fma_f32 v227, v39, v53, v227
    v_pk_mul_f32 v[210:211], v[32:33], v[224:225] op_sel:[1,0] op_sel_hi:[1,1]
    v_mfma_f32_16x16x32_bf16 v[112:115], v[140:143], v[144:147], v[112:115]
    v_pk_mul_f32 v[212:213], v[32:33], v[226:227] op_sel:[1,0] op_sel_hi:[1,1]
    v_pk_fma_f32 v[210:211], v[34:35], v[226:227], v[210:211] op_sel:[1,0,0] op_sel_hi:[1,1,1] neg_lo:[1,0,0] neg_hi:[1,0,0]
    v_mfma_f32_16x16x32_bf16 v[116:119], v[140:143], v[148:151], v[116:119]
    v_pk_fma_f32 v[212:213], v[34:35], v[224:225], v[212:213] op_sel:[1,0,0] op_sel_hi:[1,1,1]
    v_mfma_f32_16x16x32_bf16 v[120:123], v[140:143], v[152:155], v[120:123]
    v_mfma_f32_16x16x32_bf16 v[124:127], v[140:143], v[156:159], v[124:127]
    s_waitcnt vmcnt(0) lgkmcnt(0)
    s_barrier
    v_mfma_f32_16x16x32_bf16 v[64:67], v[160:163], v[176:179], v[64:67]
    ds_read_b128 v[128:131], v16 offset:0
    v_mfma_f32_16x16x32_bf16 v[68:71], v[160:163], v[180:183], v[68:71]
    ds_read_b128 v[144:147], v18 offset:16384
    v_mfma_f32_16x16x32_bf16 v[72:75], v[160:163], v[184:187], v[72:75]
    ds_read_b128 v[148:151], v18 offset:18432
    v_mfma_f32_16x16x32_bf16 v[76:79], v[160:163], v[188:191], v[76:79]
    ds_read_b128 v[152:155], v18 offset:20480
    v_mfma_f32_16x16x32_bf16 v[80:83], v[164:167], v[176:179], v[80:83]
    ds_read_b128 v[156:159], v18 offset:22528
    v_mfma_f32_16x16x32_bf16 v[84:87], v[164:167], v[180:183], v[84:87]
    ds_read_b128 v[132:135], v16 offset:2048
    v_mfma_f32_16x16x32_bf16 v[88:91], v[164:167], v[184:187], v[88:91]
    ds_read_b128 v[136:139], v16 offset:4096
    v_mfma_f32_16x16x32_bf16 v[92:95], v[164:167], v[188:191], v[92:95]
    ds_read_b128 v[140:143], v16 offset:6144
    v_mfma_f32_16x16x32_bf16 v[96:99], v[168:171], v[176:179], v[96:99]
    v_mfma_f32_16x16x32_bf16 v[100:103], v[168:171], v[180:183], v[100:103]
    v_mfma_f32_16x16x32_bf16 v[104:107], v[168:171], v[184:187], v[104:107]
    v_mfma_f32_16x16x32_bf16 v[108:111], v[168:171], v[188:191], v[108:111]
    v_mfma_f32_16x16x32_bf16 v[112:115], v[172:175], v[176:179], v[112:115]
    v_mfma_f32_16x16x32_bf16 v[116:119], v[172:175], v[180:183], v[116:119]
    v_mfma_f32_16x16x32_bf16 v[120:123], v[172:175], v[184:187], v[120:123]
    v_mfma_f32_16x16x32_bf16 v[124:127], v[172:175], v[188:191], v[124:127]
    s_waitcnt lgkmcnt(0)
    v_mfma_f32_16x16x32_bf16 v[64:67], v[128:131], v[144:147], v[64:67]
    ds_read_b128 v[160:163], v17 offset:0
    v_mfma_f32_16x16x32_bf16 v[68:71], v[128:131], v[148:151], v[68:71]
    ds_read_b128 v[176:179], v19 offset:16384
    v_mfma_f32_16x16x32_bf16 v[72:75], v[128:131], v[152:155], v[72:75]
    ds_read_b128 v[180:183], v19 offset:18432
    v_mfma_f32_16x16x32_bf16 v[76:79], v[128:131], v[156:159], v[76:79]
    ds_read_b128 v[184:187], v19 offset:20480
    v_mfma_f32_16x16x32_bf16 v[80:83], v[132:135], v[144:147], v[80:83]
    ds_read_b128 v[188:191], v19 offset:22528
    v_mfma_f32_16x16x32_bf16 v[84:87], v[132:135], v[148:151], v[84:87]
    ds_read_b128 v[164:167], v17 offset:2048
    v_mfma_f32_16x16x32_bf16 v[88:91], v[132:135], v[152:155], v[88:91]
    ds_read_b128 v[168:171], v17 offset:4096
    v_mfma_f32_16x16x32_bf16 v[92:95], v[132:135], v[156:159], v[92:95]
    ds_read_b128 v[172:175], v17 offset:6144
    v_mfma_f32_16x16x32_bf16 v[96:99], v[136:139], v[144:147], v[96:99]
    v_mfma_f32_16x16x32_bf16 v[100:103], v[136:139], v[148:151], v[100:103]
    v_mfma_f32_16x16x32_bf16 v[104:107], v[136:139], v[152:155], v[104:107]
    v_mfma_f32_16x16x32_bf16 v[108:111], v[136:139], v[156:159], v[108:111]
    v_mfma_f32_16x16x32_bf16 v[112:115], v[140:143], v[144:147], v[112:115]
    v_mfma_f32_16x16x32_bf16 v[116:119], v[140:143], v[148:151], v[116:119]
    v_mfma_f32_16x16x32_bf16 v[120:123], v[140:143], v[152:155], v[120:123]
    v_mfma_f32_16x16x32_bf16 v[124:127], v[140:143], v[156:159], v[124:127]
    s_waitcnt lgkmcnt(0)
    v_mfma_f32_16x16x32_bf16 v[64:67], v[160:163], v[176:179], v[64:67]
    v_mfma_f32_16x16x32_bf16 v[68:71], v[160:163], v[180:183], v[68:71]
    v_mfma_f32_16x16x32_bf16 v[72:75], v[160:163], v[184:187], v[72:75]
    v_mfma_f32_16x16x32_bf16 v[76:79], v[160:163], v[188:191], v[76:79]
    v_mfma_f32_16x16x32_bf16 v[80:83], v[164:167], v[176:179], v[80:83]
    v_mfma_f32_16x16x32_bf16 v[84:87], v[164:167], v[180:183], v[84:87]
    v_mfma_f32_16x16x32_bf16 v[88:91], v[164:167], v[184:187], v[88:91]
    v_mfma_f32_16x16x32_bf16 v[92:95], v[164:167], v[188:191], v[92:95]
    v_mfma_f32_16x16x32_bf16 v[96:99], v[168:171], v[176:179], v[96:99]
    v_mfma_f32_16x16x32_bf16 v[100:103], v[168:171], v[180:183], v[100:103]
    v_mfma_f32_16x16x32_bf16 v[104:107], v[168:171], v[184:187], v[104:107]
    v_mfma_f32_16x16x32_bf16 v[108:111], v[168:171], v[188:191], v[108:111]
    v_mfma_f32_16x16x32_bf16 v[112:115], v[172:175], v[176:179], v[112:115]
    v_mfma_f32_16x16x32_bf16 v[116:119], v[172:175], v[180:183], v[116:119]
    v_mfma_f32_16x16x32_bf16 v[120:123], v[172:175], v[184:187], v[120:123]
    v_mfma_f32_16x16x32_bf16 v[124:127], v[172:175], v[188:191], v[124:127]
    s_mov_b32 s44, 0
    s_mov_b32 s45, 4096
    s_mov_b32 s46, 8192
    s_mov_b32 s47, 12288
    v_mov_b32 v61, s93
    v_mov_b32 v63, s93
    v_mov_b32 v216, 73728
    v_mov_b32 v218, 0
    v_mov_b32 v219, 0
    ds_write_b64 v216, v[218:219]
    ds_write_b64 v216, v[218:219] offset:8
    v_pk_fma_f32 v[16:17], v[30:31], v[72:73], v[66:67] op_sel:[0,0,0] op_sel_hi:[0,1,1] neg_lo:[1,0,0] neg_hi:[1,0,0]
    v_pk_fma_f32 v[18:19], v[30:31], v[64:65], v[74:75] op_sel:[0,0,0] op_sel_hi:[0,1,1]
    v_pk_fma_f32 v[8:9], v[28:29], v[64:65], v[16:17] op_sel:[0,0,0] op_sel_hi:[0,1,1]
    v_pk_fma_f32 v[10:11], v[28:29], v[72:73], v[18:19] op_sel:[0,0,0] op_sel_hi:[0,1,1]
    v_pk_fma_f32 v[20:21], v[30:31], v[76:77], v[70:71] op_sel:[1,0,0] op_sel_hi:[1,1,1] neg_lo:[1,0,0] neg_hi:[1,0,0]
    v_pk_fma_f32 v[22:23], v[30:31], v[68:69], v[78:79] op_sel:[1,0,0] op_sel_hi:[1,1,1]
    v_pk_fma_f32 v[12:13], v[28:29], v[68:69], v[20:21] op_sel:[1,0,0] op_sel_hi:[1,1,1]
    v_pk_fma_f32 v[14:15], v[28:29], v[76:77], v[22:23] op_sel:[1,0,0] op_sel_hi:[1,1,1]
    v_pk_fma_f32 v[16:17], v[30:31], v[10:11], v[80:81] op_sel:[0,0,0] op_sel_hi:[0,1,1] neg_lo:[1,0,0] neg_hi:[1,0,0]
    v_pk_fma_f32 v[18:19], v[30:31], v[8:9], v[88:89] op_sel:[0,0,0] op_sel_hi:[0,1,1]
    v_pk_fma_f32 v[8:9], v[28:29], v[8:9], v[16:17] op_sel:[0,0,0] op_sel_hi:[0,1,1]
    v_pk_fma_f32 v[10:11], v[28:29], v[10:11], v[18:19] op_sel:[0,0,0] op_sel_hi:[0,1,1]
    v_pk_fma_f32 v[20:21], v[30:31], v[14:15], v[84:85] op_sel:[1,0,0] op_sel_hi:[1,1,1] neg_lo:[1,0,0] neg_hi:[1,0,0]
    v_pk_fma_f32 v[22:23], v[30:31], v[12:13], v[92:93] op_sel:[1,0,0] op_sel_hi:[1,1,1]
    v_pk_fma_f32 v[12:13], v[28:29], v[12:13], v[20:21] op_sel:[1,0,0] op_sel_hi:[1,1,1]
    v_pk_fma_f32 v[14:15], v[28:29], v[14:15], v[22:23] op_sel:[1,0,0] op_sel_hi:[1,1,1]
    v_pk_fma_f32 v[16:17], v[30:31], v[10:11], v[82:83] op_sel:[0,0,0] op_sel_hi:[0,1,1] neg_lo:[1,0,0] neg_hi:[1,0,0]
    v_pk_fma_f32 v[18:19], v[30:31], v[8:9], v[90:91] op_sel:[0,0,0] op_sel_hi:[0,1,1]
    v_pk_fma_f32 v[8:9], v[28:29], v[8:9], v[16:17] op_sel:[0,0,0] op_sel_hi:[0,1,1]
    v_pk_fma_f32 v[10:11], v[28:29], v[10:11], v[18:19] op_sel:[0,0,0] op_sel_hi:[0,1,1]
    v_pk_fma_f32 v[20:21], v[30:31], v[14:15], v[86:87] op_sel:[1,0,0] op_sel_hi:[1,1,1] neg_lo:[1,0,0] neg_hi:[1,0,0]
    v_pk_fma_f32 v[22:23], v[30:31], v[12:13], v[94:95] op_sel:[1,0,0] op_sel_hi:[1,1,1]
    v_pk_fma_f32 v[12:13], v[28:29], v[12:13], v[20:21] op_sel:[1,0,0] op_sel_hi:[1,1,1]
    v_pk_fma_f32 v[14:15], v[28:29], v[14:15], v[22:23] op_sel:[1,0,0] op_sel_hi:[1,1,1]
    v_pk_fma_f32 v[16:17], v[30:31], v[10:11], v[96:97] op_sel:[0,0,0] op_sel_hi:[0,1,1] neg_lo:[1,0,0] neg_hi:[1,0,0]
    v_pk_fma_f32 v[18:19], v[30:31], v[8:9], v[104:105] op_sel:[0,0,0] op_sel_hi:[0,1,1]
    v_pk_fma_f32 v[8:9], v[28:29], v[8:9], v[16:17] op_sel:[0,0,0] op_sel_hi:[0,1,1]
    v_pk_fma_f32 v[10:11], v[28:29], v[10:11], v[18:19] op_sel:[0,0,0] op_sel_hi:[0,1,1]
    v_pk_fma_f32 v[20:21], v[30:31], v[14:15], v[100:101] op_sel:[1,0,0] op_sel_hi:[1,1,1] neg_lo:[1,0,0] neg_hi:[1,0,0]
    v_pk_fma_f32 v[22:23], v[30:31], v[12:13], v[108:109] op_sel:[1,0,0] op_sel_hi:[1,1,1]
    v_pk_fma_f32 v[12:13], v[28:29], v[12:13], v[20:21] op_sel:[1,0,0] op_sel_hi:[1,1,1]
    v_pk_fma_f32 v[14:15], v[28:29], v[14:15], v[22:23] op_sel:[1,0,0] op_sel_hi:[1,1,1]
    v_pk_fma_f32 v[16:17], v[30:31], v[10:11], v[98:99] op_sel:[0,0,0] op_sel_hi:[0,1,1] neg_lo:[1,0,0] neg_hi:[1,0,0]
    v_pk_fma_f32 v[18:19], v[30:31], v[8:9], v[106:107] op_sel:[0,0,0] op_sel_hi:[0,1,1]
    v_pk_fma_f32 v[8:9], v[28:29], v[8:9], v[16:17] op_sel:[0,0,0] op_sel_hi:[0,1,1]
    v_pk_fma_f32 v[10:11], v[28:29], v[10:11], v[18:19] op_sel:[0,0,0] op_sel_hi:[0,1,1]
    v_pk_fma_f32 v[20:21], v[30:31], v[14:15], v[102:103] op_sel:[1,0,0] op_sel_hi:[1,1,1] neg_lo:[1,0,0] neg_hi:[1,0,0]
    v_pk_fma_f32 v[22:23], v[30:31], v[12:13], v[110:111] op_sel:[1,0,0] op_sel_hi:[1,1,1]
    v_pk_fma_f32 v[12:13], v[28:29], v[12:13], v[20:21] op_sel:[1,0,0] op_sel_hi:[1,1,1]
    v_pk_fma_f32 v[14:15], v[28:29], v[14:15], v[22:23] op_sel:[1,0,0] op_sel_hi:[1,1,1]
    v_pk_fma_f32 v[16:17], v[30:31], v[10:11], v[112:113] op_sel:[0,0,0] op_sel_hi:[0,1,1] neg_lo:[1,0,0] neg_hi:[1,0,0]
    v_pk_fma_f32 v[18:19], v[30:31], v[8:9], v[120:121] op_sel:[0,0,0] op_sel_hi:[0,1,1]
    v_pk_fma_f32 v[8:9], v[28:29], v[8:9], v[16:17] op_sel:[0,0,0] op_sel_hi:[0,1,1]
    v_pk_fma_f32 v[10:11], v[28:29], v[10:11], v[18:19] op_sel:[0,0,0] op_sel_hi:[0,1,1]
    v_pk_fma_f32 v[20:21], v[30:31], v[14:15], v[116:117] op_sel:[1,0,0] op_sel_hi:[1,1,1] neg_lo:[1,0,0] neg_hi:[1,0,0]
    v_pk_fma_f32 v[22:23], v[30:31], v[12:13], v[124:125] op_sel:[1,0,0] op_sel_hi:[1,1,1]
    v_pk_fma_f32 v[12:13], v[28:29], v[12:13], v[20:21] op_sel:[1,0,0] op_sel_hi:[1,1,1]
    v_pk_fma_f32 v[14:15], v[28:29], v[14:15], v[22:23] op_sel:[1,0,0] op_sel_hi:[1,1,1]
    v_pk_fma_f32 v[16:17], v[30:31], v[10:11], v[114:115] op_sel:[0,0,0] op_sel_hi:[0,1,1] neg_lo:[1,0,0] neg_hi:[1,0,0]
    v_pk_fma_f32 v[18:19], v[30:31], v[8:9], v[122:123] op_sel:[0,0,0] op_sel_hi:[0,1,1]
    v_pk_fma_f32 v[8:9], v[28:29], v[8:9], v[16:17] op_sel:[0,0,0] op_sel_hi:[0,1,1]
    v_pk_fma_f32 v[10:11], v[28:29], v[10:11], v[18:19] op_sel:[0,0,0] op_sel_hi:[0,1,1]
    v_pk_fma_f32 v[20:21], v[30:31], v[14:15], v[118:119] op_sel:[1,0,0] op_sel_hi:[1,1,1] neg_lo:[1,0,0] neg_hi:[1,0,0]
    v_pk_fma_f32 v[22:23], v[30:31], v[12:13], v[126:127] op_sel:[1,0,0] op_sel_hi:[1,1,1]
    v_pk_fma_f32 v[12:13], v[28:29], v[12:13], v[20:21] op_sel:[1,0,0] op_sel_hi:[1,1,1]
    v_pk_fma_f32 v[14:15], v[28:29], v[14:15], v[22:23] op_sel:[1,0,0] op_sel_hi:[1,1,1]
    v_fma_f32 v56, -v38, v10, v9
    v_fma_f32 v58, v38, v8, v11
    v_fma_f32 v57, -v39, v14, v13
    v_fma_f32 v59, v39, v12, v15
    v_fma_f32 v56, v36, v8, v56
    v_fma_f32 v58, v36, v10, v58
    v_fma_f32 v57, v37, v12, v57
    v_fma_f32 v59, v37, v14, v59
    ds_write_b128 v192, v[56:59]
    s_waitcnt lgkmcnt(0)
    s_barrier
    ds_read_b128 v[160:163], v193 offset:0
    ds_read_b128 v[164:167], v193 offset:512
    ds_read_b128 v[168:171], v193 offset:1024
    ds_read_b128 v[172:175], v193 offset:1536
    ds_read_b128 v[176:179], v193 offset:2048
    ds_read_b128 v[180:183], v193 offset:2560
    ds_read_b128 v[184:187], v193 offset:3072
    ds_read_b128 v[188:191], v193 offset:3584
    s_waitcnt lgkmcnt(6)
    v_pk_fma_f32 v[164:165], v[42:43], v[162:163], v[164:165] op_sel:[0,0,0] op_sel_hi:[1,1,1] neg_lo:[1,0,0] neg_hi:[1,0,0]
    v_pk_fma_f32 v[166:167], v[42:43], v[160:161], v[166:167] op_sel:[0,0,0] op_sel_hi:[1,1,1]
    v_pk_fma_f32 v[164:165], v[40:41], v[160:161], v[164:165] op_sel:[0,0,0] op_sel_hi:[1,1,1]
    v_pk_fma_f32 v[166:167], v[40:41], v[162:163], v[166:167] op_sel:[0,0,0] op_sel_hi:[1,1,1]
    s_waitcnt lgkmcnt(5)
    v_pk_fma_f32 v[168:169], v[42:43], v[166:167], v[168:169] op_sel:[0,0,0] op_sel_hi:[1,1,1] neg_lo:[1,0,0] neg_hi:[1,0,0]
    v_pk_fma_f32 v[170:171], v[42:43], v[164:165], v[170:171] op_sel:[0,0,0] op_sel_hi:[1,1,1]
    v_pk_fma_f32 v[168:169], v[40:41], v[164:165], v[168:169] op_sel:[0,0,0] op_sel_hi:[1,1,1]
    v_pk_fma_f32 v[170:171], v[40:41], v[166:167], v[170:171] op_sel:[0,0,0] op_sel_hi:[1,1,1]
    s_waitcnt lgkmcnt(4)
    v_pk_fma_f32 v[172:173], v[42:43], v[170:171], v[172:173] op_sel:[0,0,0] op_sel_hi:[1,1,1] neg_lo:[1,0,0] neg_hi:[1,0,0]
    v_pk_fma_f32 v[174:175], v[42:43], v[168:169], v[174:175] op_sel:[0,0,0] op_sel_hi:[1,1,1]
    v_pk_fma_f32 v[172:173], v[40:41], v[168:169], v[172:173] op_sel:[0,0,0] op_sel_hi:[1,1,1]
    v_pk_fma_f32 v[174:175], v[40:41], v[170:171], v[174:175] op_sel:[0,0,0] op_sel_hi:[1,1,1]
    s_waitcnt lgkmcnt(3)
    v_pk_fma_f32 v[176:177], v[42:43], v[174:175], v[176:177] op_sel:[0,0,0] op_sel_hi:[1,1,1] neg_lo:[1,0,0] neg_hi:[1,0,0]
    v_pk_fma_f32 v[178:179], v[42:43], v[172:173], v[178:179] op_sel:[0,0,0] op_sel_hi:[1,1,1]
    v_pk_fma_f32 v[176:177], v[40:41], v[172:173], v[176:177] op_sel:[0,0,0] op_sel_hi:[1,1,1]
    v_pk_fma_f32 v[178:179], v[40:41], v[174:175], v[178:179] op_sel:[0,0,0] op_sel_hi:[1,1,1]
    s_waitcnt lgkmcnt(2)
    v_pk_fma_f32 v[180:181], v[42:43], v[178:179], v[180:181] op_sel:[0,0,0] op_sel_hi:[1,1,1] neg_lo:[1,0,0] neg_hi:[1,0,0]
    v_pk_fma_f32 v[182:183], v[42:43], v[176:177], v[182:183] op_sel:[0,0,0] op_sel_hi:[1,1,1]
    v_pk_fma_f32 v[180:181], v[40:41], v[176:177], v[180:181] op_sel:[0,0,0] op_sel_hi:[1,1,1]
    v_pk_fma_f32 v[182:183], v[40:41], v[178:179], v[182:183] op_sel:[0,0,0] op_sel_hi:[1,1,1]
    s_waitcnt lgkmcnt(1)
    v_pk_fma_f32 v[184:185], v[42:43], v[182:183], v[184:185] op_sel:[0,0,0] op_sel_hi:[1,1,1] neg_lo:[1,0,0] neg_hi:[1,0,0]
    v_pk_fma_f32 v[186:187], v[42:43], v[180:181], v[186:187] op_sel:[0,0,0] op_sel_hi:[1,1,1]
    v_pk_fma_f32 v[184:185], v[40:41], v[180:181], v[184:185] op_sel:[0,0,0] op_sel_hi:[1,1,1]
    v_pk_fma_f32 v[186:187], v[40:41], v[182:183], v[186:187] op_sel:[0,0,0] op_sel_hi:[1,1,1]
    s_waitcnt lgkmcnt(0)
    v_pk_fma_f32 v[188:189], v[42:43], v[186:187], v[188:189] op_sel:[0,0,0] op_sel_hi:[1,1,1] neg_lo:[1,0,0] neg_hi:[1,0,0]
    v_pk_fma_f32 v[190:191], v[42:43], v[184:185], v[190:191] op_sel:[0,0,0] op_sel_hi:[1,1,1]
    v_pk_fma_f32 v[188:189], v[40:41], v[184:185], v[188:189] op_sel:[0,0,0] op_sel_hi:[1,1,1]
    v_pk_fma_f32 v[190:191], v[40:41], v[186:187], v[190:191] op_sel:[0,0,0] op_sel_hi:[1,1,1]
    v_cndmask_b32 v60, v188, v189, s[84:85]
    v_cndmask_b32 v62, v190, v191, s[84:85]
    s_cmp_lg_u32 s19, 0
    s_cbranch_scc1 L_nopub
    s_mov_b32 exec_hi, 0
    buffer_store_dwordx4 v[60:63], v27, s[24:27], 0 offen sc1
    s_mov_b32 exec_hi, -1
L_nopub:
    v_cndmask_b32 v16, 0, v172, s[82:83]
    v_cndmask_b32 v17, v160, v176, s[82:83]
    v_cndmask_b32 v18, v164, v180, s[82:83]
    v_cndmask_b32 v19, v168, v184, s[82:83]
    v_cndmask_b32 v16, v16, v17, s[84:85]
    v_cndmask_b32 v18, v18, v19, s[84:85]
    v_cndmask_b32 v216, v16, v18, s[86:87]
    v_cndmask_b32 v16, 0, v173, s[82:83]
    v_cndmask_b32 v17, v161, v177, s[82:83]
    v_cndmask_b32 v18, v165, v181, s[82:83]
    v_cndmask_b32 v19, v169, v185, s[82:83]
    v_cndmask_b32 v16, v16, v17, s[84:85]
    v_cndmask_b32 v18, v18, v19, s[84:85]
    v_cndmask_b32 v217, v16, v18, s[86:87]
    v_cndmask_b32 v16, 0, v174, s[82:83]
    v_cndmask_b32 v17, v162, v178, s[82:83]
    v_cndmask_b32 v18, v166, v182, s[82:83]
    v_cndmask_b32 v19, v170, v186, s[82:83]
    v_cndmask_b32 v16, v16, v17, s[84:85]
    v_cndmask_b32 v18, v18, v19, s[84:85]
    v_cndmask_b32 v218, v16, v18, s[86:87]
    v_cndmask_b32 v16, 0, v175, s[82:83]
    v_cndmask_b32 v17, v163, v179, s[82:83]
    v_cndmask_b32 v18, v167, v183, s[82:83]
    v_cndmask_b32 v19, v171, v187, s[82:83]
    v_cndmask_b32 v16, v16, v17, s[84:85]
    v_cndmask_b32 v18, v18, v19, s[84:85]
    v_cndmask_b32 v219, v16, v18, s[86:87]
    v_mov_b32 v176, v216
    v_mov_b32 v178, v218
    v_fma_f32 v177, -v38, v218, v8
    v_fma_f32 v179, v38, v216, v10
    v_fma_f32 v177, v36, v216, v177
    v_fma_f32 v179, v36, v218, v179
    v_pk_mul_f32 v[160:161], v[32:33], v[176:177] op_sel:[0,0] op_sel_hi:[0,1]
    v_pk_mul_f32 v[162:163], v[32:33], v[178:179] op_sel:[0,0] op_sel_hi:[0,1]
    v_pk_fma_f32 v[160:161], v[34:35], v[178:179], v[160:161] op_sel:[0,0,0] op_sel_hi:[0,1,1] neg_lo:[1,0,0] neg_hi:[1,0,0]
    v_pk_fma_f32 v[162:163], v[34:35], v[176:177], v[162:163] op_sel:[0,0,0] op_sel_hi:[0,1,1]
    v_mov_b32 v176, v217
    v_mov_b32 v178, v219
    v_fma_f32 v177, -v39, v219, v12
    v_fma_f32 v179, v39, v217, v14
    v_fma_f32 v177, v37, v217, v177
    v_fma_f32 v179, v37, v219, v179
    v_pk_mul_f32 v[164:165], v[32:33], v[176:177] op_sel:[1,0] op_sel_hi:[1,1]
    v_pk_mul_f32 v[166:167], v[32:33], v[178:179] op_sel:[1,0] op_sel_hi:[1,1]
    v_pk_fma_f32 v[164:165], v[34:35], v[178:179], v[164:165] op_sel:[1,0,0] op_sel_hi:[1,1,1] neg_lo:[1,0,0] neg_hi:[1,0,0]
    v_pk_fma_f32 v[166:167], v[34:35], v[176:177], v[166:167] op_sel:[1,0,0] op_sel_hi:[1,1,1]
    v_pk_mul_f32 v[128:129], v[32:33], v[72:73] op_sel:[0,0] op_sel_hi:[0,1]
    v_pk_fma_f32 v[128:129], v[34:35], v[64:65], v[128:129] op_sel:[0,0,0] op_sel_hi:[0,1,1]
    v_pk_mul_f32 v[64:65], v[32:33], v[64:65] op_sel:[0,0] op_sel_hi:[0,1]
    v_pk_fma_f32 v[64:65], v[34:35], v[72:73], v[64:65] op_sel:[0,0,0] op_sel_hi:[0,1,1] neg_lo:[1,0,0] neg_hi:[1,0,0]
    v_pk_mul_f32 v[144:145], v[32:33], v[76:77] op_sel:[1,0] op_sel_hi:[1,1]
    v_pk_fma_f32 v[144:145], v[34:35], v[68:69], v[144:145] op_sel:[1,0,0] op_sel_hi:[1,1,1]
    v_pk_mul_f32 v[68:69], v[32:33], v[68:69] op_sel:[1,0] op_sel_hi:[1,1]
    v_pk_fma_f32 v[68:69], v[34:35], v[76:77], v[68:69] op_sel:[1,0,0] op_sel_hi:[1,1,1] neg_lo:[1,0,0] neg_hi:[1,0,0]
    v_pk_mul_f32 v[130:131], v[32:33], v[74:75] op_sel:[0,0] op_sel_hi:[0,1]
    v_pk_fma_f32 v[130:131], v[34:35], v[66:67], v[130:131] op_sel:[0,0,0] op_sel_hi:[0,1,1]
    v_pk_mul_f32 v[66:67], v[32:33], v[66:67] op_sel:[0,0] op_sel_hi:[0,1]
    v_pk_fma_f32 v[66:67], v[34:35], v[74:75], v[66:67] op_sel:[0,0,0] op_sel_hi:[0,1,1] neg_lo:[1,0,0] neg_hi:[1,0,0]
    buffer_load_dwordx4 v[224:227], v194, s[24:27], s44 offen offset:0 sc1
    buffer_load_dwordx4 v[228:231], v194, s[24:27], s45 offen offset:0 sc1
    buffer_load_dwordx4 v[232:235], v194, s[24:27], s46 offen offset:0 sc1
    buffer_load_dwordx4 v[236:239], v194, s[24:27], s47 offen offset:0 sc1
    buffer_load_dwordx4 v[240:243], v194, s[24:27], s44 offen offset:256 sc1
    buffer_load_dwordx4 v[244:247], v194, s[24:27], s45 offen offset:256 sc1
    buffer_load_dwordx4 v[248:251], v194, s[24:27], s46 offen offset:256 sc1
    buffer_load_dwordx4 v[252:255], v194, s[24:27], s47 offen offset:256 sc1
    v_pk_mul_f32 v[146:147], v[32:33], v[78:79] op_sel:[1,0] op_sel_hi:[1,1]
    v_pk_fma_f32 v[146:147], v[34:35], v[70:71], v[146:147] op_sel:[1,0,0] op_sel_hi:[1,1,1]
    v_pk_mul_f32 v[70:71], v[32:33], v[70:71] op_sel:[1,0] op_sel_hi:[1,1]
    v_pk_fma_f32 v[70:71], v[34:35], v[78:79], v[70:71] op_sel:[1,0,0] op_sel_hi:[1,1,1] neg_lo:[1,0,0] neg_hi:[1,0,0]
    v_pk_mul_f32 v[132:133], v[32:33], v[88:89] op_sel:[0,0] op_sel_hi:[0,1]
    v_pk_fma_f32 v[132:133], v[34:35], v[80:81], v[132:133] op_sel:[0,0,0] op_sel_hi:[0,1,1]
    v_pk_mul_f32 v[80:81], v[32:33], v[80:81] op_sel:[0,0] op_sel_hi:[0,1]
    v_pk_fma_f32 v[80:81], v[34:35], v[88:89], v[80:81] op_sel:[0,0,0] op_sel_hi:[0,1,1] neg_lo:[1,0,0] neg_hi:[1,0,0]
    v_pk_mul_f32 v[148:149], v[32:33], v[92:93] op_sel:[1,0] op_sel_hi:[1,1]
    v_pk_fma_f32 v[148:149], v[34:35], v[84:85], v[148:149] op_sel:[1,0,0] op_sel_hi:[1,1,1]
    v_pk_mul_f32 v[84:85], v[32:33], v[84:85] op_sel:[1,0] op_sel_hi:[1,1]
    v_pk_fma_f32 v[84:85], v[34:35], v[92:93], v[84:85] op_sel:[1,0,0] op_sel_hi:[1,1,1] neg_lo:[1,0,0] neg_hi:[1,0,0]
    v_pk_mul_f32 v[134:135], v[32:33], v[90:91] op_sel:[0,0] op_sel_hi:[0,1]
    v_pk_fma_f32 v[134:135], v[34:35], v[82:83], v[134:135] op_sel:[0,0,0] op_sel_hi:[0,1,1]
    v_pk_mul_f32 v[82:83], v[32:33], v[82:83] op_sel:[0,0] op_sel_hi:[0,1]
    v_pk_fma_f32 v[82:83], v[34:35], v[90:91], v[82:83] op_sel:[0,0,0] op_sel_hi:[0,1,1] neg_lo:[1,0,0] neg_hi:[1,0,0]
    v_pk_mul_f32 v[150:151], v[32:33], v[94:95] op_sel:[1,0] op_sel_hi:[1,1]
    v_pk_fma_f32 v[150:151], v[34:35], v[86:87], v[150:151] op_sel:[1,0,0] op_sel_hi:[1,1,1]
    v_pk_mul_f32 v[86:87], v[32:33], v[86:87] op_sel:[1,0] op_sel_hi:[1,1]
    v_pk_fma_f32 v[86:87], v[34:35], v[94:95], v[86:87] op_sel:[1,0,0] op_sel_hi:[1,1,1] neg_lo:[1,0,0] neg_hi:[1,0,0]
    v_pk_mul_f32 v[136:137], v[32:33], v[104:105] op_sel:[0,0] op_sel_hi:[0,1]
    v_pk_fma_f32 v[136:137], v[34:35], v[96:97], v[136:137] op_sel:[0,0,0] op_sel_hi:[0,1,1]
    v_pk_mul_f32 v[96:97], v[32:33], v[96:97] op_sel:[0,0] op_sel_hi:[0,1]
    v_pk_fma_f32 v[96:97], v[34:35], v[104:105], v[96:97] op_sel:[0,0,0] op_sel_hi:[0,1,1] neg_lo:[1,0,0] neg_hi:[1,0,0]
    v_pk_mul_f32 v[152:153], v[32:33], v[108:109] op_sel:[1,0] op_sel_hi:[1,1]
    v_pk_fma_f32 v[152:153], v[34:35], v[100:101], v[152:153] op_sel:[1,0,0] op_sel_hi:[1,1,1]
    v_pk_mul_f32 v[100:101], v[32:33], v[100:101] op_sel:[1,0] op_sel_hi:[1,1]
    v_pk_fma_f32 v[100:101], v[34:35], v[108:109], v[100:101] op_sel:[1,0,0] op_sel_hi:[1,1,1] neg_lo:[1,0,0] neg_hi:[1,0,0]
    v_pk_mul_f32 v[138:139], v[32:33], v[106:107] op_sel:[0,0] op_sel_hi:[0,1]
    v_pk_fma_f32 v[138:139], v[34:35], v[98:99], v[138:139] op_sel:[0,0,0] op_sel_hi:[0,1,1]
    v_pk_mul_f32 v[98:99], v[32:33], v[98:99] op_sel:[0,0] op_sel_hi:[0,1]
    v_pk_fma_f32 v[98:99], v[34:35], v[106:107], v[98:99] op_sel:[0,0,0] op_sel_hi:[0,1,1] neg_lo:[1,0,0] neg_hi:[1,0,0]
    v_pk_mul_f32 v[154:155], v[32:33], v[110:111] op_sel:[1,0] op_sel_hi:[1,1]
    v_pk_fma_f32 v[154:155], v[34:35], v[102:103], v[154:155] op_sel:[1,0,0] op_sel_hi:[1,1,1]
    v_pk_mul_f32 v[102:103], v[32:33], v[102:103] op_sel:[1,0] op_sel_hi:[1,1]
    v_pk_fma_f32 v[102:103], v[34:35], v[110:111], v[102:103] op_sel:[1,0,0] op_sel_hi:[1,1,1] neg_lo:[1,0,0] neg_hi:[1,0,0]
    v_pk_mul_f32 v[140:141], v[32:33], v[120:121] op_sel:[0,0] op_sel_hi:[0,1]
    v_pk_fma_f32 v[140:141], v[34:35], v[112:113], v[140:141] op_sel:[0,0,0] op_sel_hi:[0,1,1]
    v_pk_mul_f32 v[112:113], v[32:33], v[112:113] op_sel:[0,0] op_sel_hi:[0,1]
    v_pk_fma_f32 v[112:113], v[34:35], v[120:121], v[112:113] op_sel:[0,0,0] op_sel_hi:[0,1,1] neg_lo:[1,0,0] neg_hi:[1,0,0]
    v_pk_mul_f32 v[156:157], v[32:33], v[124:125] op_sel:[1,0] op_sel_hi:[1,1]
    v_pk_fma_f32 v[156:157], v[34:35], v[116:117], v[156:157] op_sel:[1,0,0] op_sel_hi:[1,1,1]
    v_pk_mul_f32 v[116:117], v[32:33], v[116:117] op_sel:[1,0] op_sel_hi:[1,1]
    v_pk_fma_f32 v[116:117], v[34:35], v[124:125], v[116:117] op_sel:[1,0,0] op_sel_hi:[1,1,1] neg_lo:[1,0,0] neg_hi:[1,0,0]
    v_pk_mul_f32 v[142:143], v[32:33], v[122:123] op_sel:[0,0] op_sel_hi:[0,1]
    v_pk_fma_f32 v[142:143], v[34:35], v[114:115], v[142:143] op_sel:[0,0,0] op_sel_hi:[0,1,1]
    v_pk_mul_f32 v[114:115], v[32:33], v[114:115] op_sel:[0,0] op_sel_hi:[0,1]
    v_pk_fma_f32 v[114:115], v[34:35], v[122:123], v[114:115] op_sel:[0,0,0] op_sel_hi:[0,1,1] neg_lo:[1,0,0] neg_hi:[1,0,0]
    v_pk_mul_f32 v[158:159], v[32:33], v[126:127] op_sel:[1,0] op_sel_hi:[1,1]
    v_pk_fma_f32 v[158:159], v[34:35], v[118:119], v[158:159] op_sel:[1,0,0] op_sel_hi:[1,1,1]
    v_pk_mul_f32 v[118:119], v[32:33], v[118:119] op_sel:[1,0] op_sel_hi:[1,1]
    v_pk_fma_f32 v[118:119], v[34:35], v[126:127], v[118:119] op_sel:[1,0,0] op_sel_hi:[1,1,1] neg_lo:[1,0,0] neg_hi:[1,0,0]
L_poll:
    s_waitcnt vmcnt(0)
    v_xor_b32 v225, v225, v198
    v_xor_b32 v227, v227, v198
    v_xor_b32 v229, v229, v199
    v_xor_b32 v231, v231, v199
    v_xor_b32 v233, v233, v200
    v_xor_b32 v235, v235, v200
    v_xor_b32 v237, v237, v201
    v_xor_b32 v239, v239, v201
    v_xor_b32 v241, v241, v198
    v_xor_b32 v243, v243, v198
    v_xor_b32 v245, v245, v199
    v_xor_b32 v247, v247, v199
    v_xor_b32 v249, v249, v200
    v_xor_b32 v251, v251, v200
    v_xor_b32 v253, v253, v201
    v_xor_b32 v255, v255, v201
    v_or3_b32 v214, v225, v227, v229
    v_or3_b32 v214, v214, v231, v233
    v_or3_b32 v214, v214, v235, v237
    v_or3_b32 v214, v214, v239, v241
    v_or3_b32 v214, v214, v243, v245
    v_or3_b32 v214, v214, v247, v249
    v_or3_b32 v214, v214, v251, v253
    v_or_b32 v214, v214, v255
    v_cmp_ne_u32 vcc, 0, v214
    s_nop 1
    s_cmp_eq_u64 vcc, 0
    s_cbranch_scc1 L_got
    s_sub_u32 s96, s96, 1
    s_cbranch_scc1 L_got
    s_sleep 2
    buffer_load_dwordx4 v[224:227], v194, s[24:27], s44 offen offset:0 sc1
    buffer_load_dwordx4 v[228:231], v194, s[24:27], s45 offen offset:0 sc1
    buffer_load_dwordx4 v[232:235], v194, s[24:27], s46 offen offset:0 sc1
    buffer_load_dwordx4 v[236:239], v194, s[24:27], s47 offen offset:0 sc1
    buffer_load_dwordx4 v[240:243], v194, s[24:27], s44 offen offset:256 sc1
    buffer_load_dwordx4 v[244:247], v194, s[24:27], s45 offen offset:256 sc1
    buffer_load_dwordx4 v[248:251], v194, s[24:27], s46 offen offset:256 sc1
    buffer_load_dwordx4 v[252:255], v194, s[24:27], s47 offen offset:256 sc1
    s_branch L_poll
L_got:
    s_add_u32 m0, s23, 81920
    s_add_u32 s21, s55, 0
    s_and_b32 s21, s21, 15
    s_lshl_b32 s21, s21, 7
    buffer_load_dwordx4 v202, s[28:31], s21 offen offset:0  lds
    buffer_load_dwordx4 v203, s[28:31], s21 offen offset:1024  lds
    buffer_load_dwordx4 v204, s[28:31], s21 offen offset:2048  lds
    buffer_load_dwordx4 v205, s[28:31], s21 offen offset:3072  lds
    s_add_u32 m0, s23, 0
    s_add_u32 s21, s55, 1
    s_and_b32 s21, s21, 15
    s_lshl_b32 s21, s21, 7
    buffer_load_dwordx4 v202, s[28:31], s21 offen offset:0  lds
    buffer_load_dwordx4 v203, s[28:31], s21 offen offset:1024  lds
    buffer_load_dwordx4 v204, s[28:31], s21 offen offset:2048  lds
    buffer_load_dwordx4 v205, s[28:31], s21 offen offset:3072  lds
    s_add_u32 m0, s23, 16384
    s_add_u32 s21, s55, 2
    s_and_b32 s21, s21, 15
    s_lshl_b32 s21, s21, 7
    buffer_load_dwordx4 v202, s[28:31], s21 offen offset:0  lds
    buffer_load_dwordx4 v203, s[28:31], s21 offen offset:1024  lds
    buffer_load_dwordx4 v204, s[28:31], s21 offen offset:2048  lds
    buffer_load_dwordx4 v205, s[28:31], s21 offen offset:3072  lds
    v_fma_f32 v232, -v46, v238, v232
    v_fma_f32 v234, v46, v236, v234
    v_fma_f32 v232, v44, v236, v232
    v_fma_f32 v234, v44, v238, v234
    v_fma_f32 v248, -v47, v254, v248
    v_fma_f32 v250, v47, v252, v250
    v_fma_f32 v248, v45, v252, v248
    v_fma_f32 v250, v45, v254, v250
    v_fma_f32 v228, -v46, v234, v228
    v_fma_f32 v230, v46, v232, v230
    v_fma_f32 v228, v44, v232, v228
    v_fma_f32 v230, v44, v234, v230
    v_fma_f32 v244, -v47, v250, v244
    v_fma_f32 v246, v47, v248, v246
    v_fma_f32 v244, v45, v248, v244
    v_fma_f32 v246, v45, v250, v246
    v_fma_f32 v224, -v46, v230, v224
    v_fma_f32 v226, v46, v228, v226
    v_fma_f32 v224, v44, v228, v224
    v_fma_f32 v226, v44, v230, v226
    v_fma_f32 v240, -v47, v246, v240
    v_fma_f32 v242, v47, v244, v242
    v_fma_f32 v240, v45, v244, v240
    v_fma_f32 v242, v45, v246, v242
    v_mul_f32 v16, v48, v224
    v_mul_f32 v17, v48, v226
    v_fma_f32 v16, -v50, v226, v16
    v_fma_f32 v17, v50, v224, v17
    v_mul_f32 v18, v49, v240
    v_mul_f32 v19, v49, v242
    v_fma_f32 v18, -v51, v242, v18
    v_fma_f32 v19, v51, v240, v19
    v_mov_b32 v20, v16
    v_mov_b32 v21, v17
    v_mov_b32 v22, v18
    v_mov_b32 v23, v19
    s_nop 1
    v_permlane16_swap_b32 v16, v20
    v_permlane16_swap_b32 v17, v21
    v_permlane16_swap_b32 v18, v22
    v_permlane16_swap_b32 v19, v23
    s_nop 1
    v_add_f32 v16, v16, v20
    v_add_f32 v17, v17, v21
    v_add_f32 v18, v18, v22
    v_add_f32 v19, v19, v23
    v_mov_b32 v20, v16
    v_mov_b32 v21, v17
    v_mov_b32 v22, v18
    v_mov_b32 v23, v19
    s_nop 1
    v_permlane32_swap_b32 v16, v20
    v_permlane32_swap_b32 v17, v21
    v_permlane32_swap_b32 v18, v22
    v_permlane32_swap_b32 v19, v23
    s_nop 1
    v_add_f32 v16, v16, v20
    v_add_f32 v17, v17, v21
    v_add_f32 v18, v18, v22
    v_add_f32 v19, v19, v23
    v_pk_fma_f32 v[160:161], v[16:17], v[206:207], v[160:161] op_sel:[0,0,0] op_sel_hi:[0,1,1]
    v_pk_fma_f32 v[162:163], v[16:17], v[208:209], v[162:163] op_sel:[0,0,0] op_sel_hi:[0,1,1]
    v_pk_fma_f32 v[160:161], v[16:17], v[208:209], v[160:161] op_sel:[1,0,0] op_sel_hi:[1,1,1] neg_lo:[1,0,0] neg_hi:[1,0,0]
    v_pk_fma_f32 v[162:163], v[16:17], v[206:207], v[162:163] op_sel:[1,0,0] op_sel_hi:[1,1,1]
    v_pk_fma_f32 v[164:165], v[18:19], v[210:211], v[164:165] op_sel:[0,0,0] op_sel_hi:[0,1,1]
    v_pk_fma_f32 v[166:167], v[18:19], v[212:213], v[166:167] op_sel:[0,0,0] op_sel_hi:[0,1,1]
    v_pk_fma_f32 v[164:165], v[18:19], v[212:213], v[164:165] op_sel:[1,0,0] op_sel_hi:[1,1,1] neg_lo:[1,0,0] neg_hi:[1,0,0]
    v_pk_fma_f32 v[166:167], v[18:19], v[210:211], v[166:167] op_sel:[1,0,0] op_sel_hi:[1,1,1]
    v_pk_fma_f32 v[64:65], v[30:31], v[162:163], v[64:65] op_sel:[0,0,0] op_sel_hi:[0,1,1] neg_lo:[1,0,0] neg_hi:[1,0,0]
    v_pk_fma_f32 v[128:129], v[30:31], v[160:161], v[128:129] op_sel:[0,0,0] op_sel_hi:[0,1,1]
    v_pk_fma_f32 v[64:65], v[28:29], v[160:161], v[64:65] op_sel:[0,0,0] op_sel_hi:[0,1,1]
    v_pk_fma_f32 v[128:129], v[28:29], v[162:163], v[128:129] op_sel:[0,0,0] op_sel_hi:[0,1,1]
    v_pk_fma_f32 v[68:69], v[30:31], v[166:167], v[68:69] op_sel:[1,0,0] op_sel_hi:[1,1,1] neg_lo:[1,0,0] neg_hi:[1,0,0]
    v_pk_fma_f32 v[144:145], v[30:31], v[164:165], v[144:145] op_sel:[1,0,0] op_sel_hi:[1,1,1]
    v_pk_fma_f32 v[68:69], v[28:29], v[164:165], v[68:69] op_sel:[1,0,0] op_sel_hi:[1,1,1]
    v_pk_fma_f32 v[144:145], v[28:29], v[166:167], v[144:145] op_sel:[1,0,0] op_sel_hi:[1,1,1]
    v_pk_fma_f32 v[66:67], v[30:31], v[128:129], v[66:67] op_sel:[0,0,0] op_sel_hi:[0,1,1] neg_lo:[1,0,0] neg_hi:[1,0,0]
    v_pk_fma_f32 v[130:131], v[30:31], v[64:65], v[130:131] op_sel:[0,0,0] op_sel_hi:[0,1,1]
    v_pk_fma_f32 v[66:67], v[28:29], v[64:65], v[66:67] op_sel:[0,0,0] op_sel_hi:[0,1,1]
    v_pk_fma_f32 v[130:131], v[28:29], v[128:129], v[130:131] op_sel:[0,0,0] op_sel_hi:[0,1,1]
    v_pk_fma_f32 v[70:71], v[30:31], v[144:145], v[70:71] op_sel:[1,0,0] op_sel_hi:[1,1,1] neg_lo:[1,0,0] neg_hi:[1,0,0]
    v_pk_fma_f32 v[146:147], v[30:31], v[68:69], v[146:147] op_sel:[1,0,0] op_sel_hi:[1,1,1]
    v_pk_fma_f32 v[70:71], v[28:29], v[68:69], v[70:71] op_sel:[1,0,0] op_sel_hi:[1,1,1]
    v_pk_fma_f32 v[146:147], v[28:29], v[144:145], v[146:147] op_sel:[1,0,0] op_sel_hi:[1,1,1]
    v_cvt_pk_bf16_f32 v224, v64, v66
    v_cvt_pk_bf16_f32 v232, -v128, -v130
    v_cvt_pk_bf16_f32 v228, v65, v67
    v_cvt_pk_bf16_f32 v236, -v129, -v131
    v_cvt_pk_bf16_f32 v240, v68, v70
    v_cvt_pk_bf16_f32 v248, -v144, -v146
    v_cvt_pk_bf16_f32 v244, v69, v71
    v_cvt_pk_bf16_f32 v252, -v145, -v147
    v_pk_fma_f32 v[80:81], v[30:31], v[130:131], v[80:81] op_sel:[0,0,0] op_sel_hi:[0,1,1] neg_lo:[1,0,0] neg_hi:[1,0,0]
    v_pk_fma_f32 v[132:133], v[30:31], v[66:67], v[132:133] op_sel:[0,0,0] op_sel_hi:[0,1,1]
    v_pk_fma_f32 v[80:81], v[28:29], v[66:67], v[80:81] op_sel:[0,0,0] op_sel_hi:[0,1,1]
    v_pk_fma_f32 v[132:133], v[28:29], v[130:131], v[132:133] op_sel:[0,0,0] op_sel_hi:[0,1,1]
    v_pk_fma_f32 v[84:85], v[30:31], v[146:147], v[84:85] op_sel:[1,0,0] op_sel_hi:[1,1,1] neg_lo:[1,0,0] neg_hi:[1,0,0]
    v_pk_fma_f32 v[148:149], v[30:31], v[70:71], v[148:149] op_sel:[1,0,0] op_sel_hi:[1,1,1]
    v_pk_fma_f32 v[84:85], v[28:29], v[70:71], v[84:85] op_sel:[1,0,0] op_sel_hi:[1,1,1]
    v_pk_fma_f32 v[148:149], v[28:29], v[146:147], v[148:149] op_sel:[1,0,0] op_sel_hi:[1,1,1]
    v_pk_fma_f32 v[82:83], v[30:31], v[132:133], v[82:83] op_sel:[0,0,0] op_sel_hi:[0,1,1] neg_lo:[1,0,0] neg_hi:[1,0,0]
    v_pk_fma_f32 v[134:135], v[30:31], v[80:81], v[134:135] op_sel:[0,0,0] op_sel_hi:[0,1,1]
    v_pk_fma_f32 v[82:83], v[28:29], v[80:81], v[82:83] op_sel:[0,0,0] op_sel_hi:[0,1,1]
    v_pk_fma_f32 v[134:135], v[28:29], v[132:133], v[134:135] op_sel:[0,0,0] op_sel_hi:[0,1,1]
    v_pk_fma_f32 v[86:87], v[30:31], v[148:149], v[86:87] op_sel:[1,0,0] op_sel_hi:[1,1,1] neg_lo:[1,0,0] neg_hi:[1,0,0]
    v_pk_fma_f32 v[150:151], v[30:31], v[84:85], v[150:151] op_sel:[1,0,0] op_sel_hi:[1,1,1]
    v_pk_fma_f32 v[86:87], v[28:29], v[84:85], v[86:87] op_sel:[1,0,0] op_sel_hi:[1,1,1]
    v_pk_fma_f32 v[150:151], v[28:29], v[148:149], v[150:151] op_sel:[1,0,0] op_sel_hi:[1,1,1]
    v_cvt_pk_bf16_f32 v225, v80, v82
    v_cvt_pk_bf16_f32 v233, -v132, -v134
    v_cvt_pk_bf16_f32 v229, v81, v83
    v_cvt_pk_bf16_f32 v237, -v133, -v135
    v_cvt_pk_bf16_f32 v241, v84, v86
    v_cvt_pk_bf16_f32 v249, -v148, -v150
    v_cvt_pk_bf16_f32 v245, v85, v87
    v_cvt_pk_bf16_f32 v253, -v149, -v151
    v_pk_fma_f32 v[96:97], v[30:31], v[134:135], v[96:97] op_sel:[0,0,0] op_sel_hi:[0,1,1] neg_lo:[1,0,0] neg_hi:[1,0,0]
    v_pk_fma_f32 v[136:137], v[30:31], v[82:83], v[136:137] op_sel:[0,0,0] op_sel_hi:[0,1,1]
    v_pk_fma_f32 v[96:97], v[28:29], v[82:83], v[96:97] op_sel:[0,0,0] op_sel_hi:[0,1,1]
    v_pk_fma_f32 v[136:137], v[28:29], v[134:135], v[136:137] op_sel:[0,0,0] op_sel_hi:[0,1,1]
    v_pk_fma_f32 v[100:101], v[30:31], v[150:151], v[100:101] op_sel:[1,0,0] op_sel_hi:[1,1,1] neg_lo:[1,0,0] neg_hi:[1,0,0]
    v_pk_fma_f32 v[152:153], v[30:31], v[86:87], v[152:153] op_sel:[1,0,0] op_sel_hi:[1,1,1]
    v_pk_fma_f32 v[100:101], v[28:29], v[86:87], v[100:101] op_sel:[1,0,0] op_sel_hi:[1,1,1]
    v_pk_fma_f32 v[152:153], v[28:29], v[150:151], v[152:153] op_sel:[1,0,0] op_sel_hi:[1,1,1]
    v_pk_fma_f32 v[98:99], v[30:31], v[136:137], v[98:99] op_sel:[0,0,0] op_sel_hi:[0,1,1] neg_lo:[1,0,0] neg_hi:[1,0,0]
    v_pk_fma_f32 v[138:139], v[30:31], v[96:97], v[138:139] op_sel:[0,0,0] op_sel_hi:[0,1,1]
    v_pk_fma_f32 v[98:99], v[28:29], v[96:97], v[98:99] op_sel:[0,0,0] op_sel_hi:[0,1,1]
    v_pk_fma_f32 v[138:139], v[28:29], v[136:137], v[138:139] op_sel:[0,0,0] op_sel_hi:[0,1,1]
    v_pk_fma_f32 v[102:103], v[30:31], v[152:153], v[102:103] op_sel:[1,0,0] op_sel_hi:[1,1,1] neg_lo:[1,0,0] neg_hi:[1,0,0]
    v_pk_fma_f32 v[154:155], v[30:31], v[100:101], v[154:155] op_sel:[1,0,0] op_sel_hi:[1,1,1]
    v_pk_fma_f32 v[102:103], v[28:29], v[100:101], v[102:103] op_sel:[1,0,0] op_sel_hi:[1,1,1]
    v_pk_fma_f32 v[154:155], v[28:29], v[152:153], v[154:155] op_sel:[1,0,0] op_sel_hi:[1,1,1]
    v_cvt_pk_bf16_f32 v226, v96, v98
    v_cvt_pk_bf16_f32 v234, -v136, -v138
    v_cvt_pk_bf16_f32 v230, v97, v99
    v_cvt_pk_bf16_f32 v238, -v137, -v139
    v_cvt_pk_bf16_f32 v242, v100, v102
    v_cvt_pk_bf16_f32 v250, -v152, -v154
    v_cvt_pk_bf16_f32 v246, v101, v103
    v_cvt_pk_bf16_f32 v254, -v153, -v155
    v_pk_fma_f32 v[112:113], v[30:31], v[138:139], v[112:113] op_sel:[0,0,0] op_sel_hi:[0,1,1] neg_lo:[1,0,0] neg_hi:[1,0,0]
    v_pk_fma_f32 v[140:141], v[30:31], v[98:99], v[140:141] op_sel:[0,0,0] op_sel_hi:[0,1,1]
    v_pk_fma_f32 v[112:113], v[28:29], v[98:99], v[112:113] op_sel:[0,0,0] op_sel_hi:[0,1,1]
    v_pk_fma_f32 v[140:141], v[28:29], v[138:139], v[140:141] op_sel:[0,0,0] op_sel_hi:[0,1,1]
    v_pk_fma_f32 v[116:117], v[30:31], v[154:155], v[116:117] op_sel:[1,0,0] op_sel_hi:[1,1,1] neg_lo:[1,0,0] neg_hi:[1,0,0]
    v_pk_fma_f32 v[156:157], v[30:31], v[102:103], v[156:157] op_sel:[1,0,0] op_sel_hi:[1,1,1]
    v_pk_fma_f32 v[116:117], v[28:29], v[102:103], v[116:117] op_sel:[1,0,0] op_sel_hi:[1,1,1]
    v_pk_fma_f32 v[156:157], v[28:29], v[154:155], v[156:157] op_sel:[1,0,0] op_sel_hi:[1,1,1]
    v_pk_fma_f32 v[114:115], v[30:31], v[140:141], v[114:115] op_sel:[0,0,0] op_sel_hi:[0,1,1] neg_lo:[1,0,0] neg_hi:[1,0,0]
    v_pk_fma_f32 v[142:143], v[30:31], v[112:113], v[142:143] op_sel:[0,0,0] op_sel_hi:[0,1,1]
    v_pk_fma_f32 v[114:115], v[28:29], v[112:113], v[114:115] op_sel:[0,0,0] op_sel_hi:[0,1,1]
    v_pk_fma_f32 v[142:143], v[28:29], v[140:141], v[142:143] op_sel:[0,0,0] op_sel_hi:[0,1,1]
    v_pk_fma_f32 v[118:119], v[30:31], v[156:157], v[118:119] op_sel:[1,0,0] op_sel_hi:[1,1,1] neg_lo:[1,0,0] neg_hi:[1,0,0]
    v_pk_fma_f32 v[158:159], v[30:31], v[116:117], v[158:159] op_sel:[1,0,0] op_sel_hi:[1,1,1]
    v_pk_fma_f32 v[118:119], v[28:29], v[116:117], v[118:119] op_sel:[1,0,0] op_sel_hi:[1,1,1]
    v_pk_fma_f32 v[158:159], v[28:29], v[156:157], v[158:159] op_sel:[1,0,0] op_sel_hi:[1,1,1]
    v_cvt_pk_bf16_f32 v227, v112, v114
    v_cvt_pk_bf16_f32 v235, -v140, -v142
    v_cvt_pk_bf16_f32 v231, v113, v115
    v_cvt_pk_bf16_f32 v239, -v141, -v143
    v_cvt_pk_bf16_f32 v243, v116, v118
    v_cvt_pk_bf16_f32 v251, -v156, -v158
    v_cvt_pk_bf16_f32 v247, v117, v119
    v_cvt_pk_bf16_f32 v255, -v157, -v159
    ds_write_b128 v195, v[224:227] offset:0
    ds_write_b128 v195, v[228:231] offset:16
    ds_write_b128 v195, v[240:243] offset:2304
    ds_write_b128 v195, v[244:247] offset:2320
    ds_write_b128 v195, v[232:235] offset:4608
    ds_write_b128 v195, v[236:239] offset:4624
    ds_write_b128 v195, v[248:251] offset:6912
    ds_write_b128 v195, v[252:255] offset:6928
    s_waitcnt lgkmcnt(4)
    ds_read_b64_tr_b16 v[64:65], v196 offset:0
    ds_read_b64_tr_b16 v[66:67], v196 offset:576
    ds_read_b64_tr_b16 v[68:69], v196 offset:32
    ds_read_b64_tr_b16 v[70:71], v196 offset:608
    ds_read_b64_tr_b16 v[72:73], v196 offset:64
    ds_read_b64_tr_b16 v[74:75], v196 offset:640
    ds_read_b64_tr_b16 v[76:77], v196 offset:96
    ds_read_b64_tr_b16 v[78:79], v196 offset:672
    s_waitcnt lgkmcnt(8)
    ds_read_b64_tr_b16 v[80:81], v196 offset:4608
    ds_read_b64_tr_b16 v[82:83], v196 offset:5184
    ds_read_b64_tr_b16 v[84:85], v196 offset:4640
    ds_read_b64_tr_b16 v[86:87], v196 offset:5216
    ds_read_b64_tr_b16 v[88:89], v196 offset:4672
    ds_read_b64_tr_b16 v[90:91], v196 offset:5248
    ds_read_b64_tr_b16 v[92:93], v196 offset:4704
    ds_read_b64_tr_b16 v[94:95], v196 offset:5280
    v_cmp_ne_u32 vcc, s97, v2
    s_nop 1
    s_cmp_eq_u64 vcc, 0
    s_cselect_b32 s97, 1, 0
    s_cmp_eq_u32 s97, 1
    s_cbranch_scc1 L_hs_fast
    s_add_u32 s39, s53, 0
    s_waitcnt lgkmcnt(14)
    buffer_store_dwordx4 v[64:67], v197, s[12:15], s39 offen offset:0 sc1
    s_waitcnt lgkmcnt(12)
    buffer_store_dwordx4 v[68:71], v197, s[12:15], s39 offen offset:1024 sc1
    s_add_u32 s39, s53, 8192
    s_waitcnt lgkmcnt(10)
    buffer_store_dwordx4 v[72:75], v197, s[12:15], s39 offen offset:0 sc1
    s_waitcnt lgkmcnt(8)
    buffer_store_dwordx4 v[76:79], v197, s[12:15], s39 offen offset:1024 sc1
    s_add_u32 s39, s53, 4096
    s_waitcnt lgkmcnt(6)
    buffer_store_dwordx4 v[80:83], v197, s[12:15], s39 offen offset:0 sc1
    s_waitcnt lgkmcnt(4)
    buffer_store_dwordx4 v[84:87], v197, s[12:15], s39 offen offset:1024 sc1
    s_add_u32 s39, s53, 12288
    s_waitcnt lgkmcnt(2)
    buffer_store_dwordx4 v[88:91], v197, s[12:15], s39 offen offset:0 sc1
    s_waitcnt lgkmcnt(0)
    buffer_store_dwordx4 v[92:95], v197, s[12:15], s39 offen offset:1024 sc1
    s_branch L_hs_done
L_hs_fast:
    s_add_u32 s39, s53, 0
    s_waitcnt lgkmcnt(14)
    buffer_store_dwordx4 v[64:67], v197, s[12:15], s39 offen offset:0
    s_waitcnt lgkmcnt(12)
    buffer_store_dwordx4 v[68:71], v197, s[12:15], s39 offen offset:1024
    s_add_u32 s39, s53, 8192
    s_waitcnt lgkmcnt(10)
    buffer_store_dwordx4 v[72:75], v197, s[12:15], s39 offen offset:0
    s_waitcnt lgkmcnt(8)
    buffer_store_dwordx4 v[76:79], v197, s[12:15], s39 offen offset:1024
    s_add_u32 s39, s53, 4096
    s_waitcnt lgkmcnt(6)
    buffer_store_dwordx4 v[80:83], v197, s[12:15], s39 offen offset:0
    s_waitcnt lgkmcnt(4)
    buffer_store_dwordx4 v[84:87], v197, s[12:15], s39 offen offset:1024
    s_add_u32 s39, s53, 12288
    s_waitcnt lgkmcnt(2)
    buffer_store_dwordx4 v[88:91], v197, s[12:15], s39 offen offset:0
    s_waitcnt lgkmcnt(0)
    buffer_store_dwordx4 v[92:95], v197, s[12:15], s39 offen offset:1024
L_hs_done:
    v_mov_b32 v16, v202
    v_mov_b32 v17, v203
    v_mov_b32 v18, v204
    v_mov_b32 v19, v205
    v_mov_b32 v8, v197
    v_add_u32 v9, 4096, v197
    s_mov_b32 s4, s40
    s_mov_b32 s5, s41
    s_mov_b32 s6, 4194304
    s_mov_b32 s7, 0x20000
    s_lshl_b32 s38, s18, 13
    s_add_u32 s50, s48, s38
    v_lshlrev_b32 v12, 11, v25
    v_lshl_add_u32 v12, v26, 3, v12
    v_lshlrev_b32 v13, 3, v25
    s_lshl_b32 s51, s16, 7
    s_lshl_b32 s38, s18, 5
    s_add_u32 s51, s51, s38
    v_bfe_u32 v59, v24, 1, 3
    v_xor_b32 v59, v59, v25
    v_lshlrev_b32 v59, 4, v59
    v_lshl_add_u32 v59, v26, 7, v59
    v_xor_b32 v20, 0, v59
    v_add_u32 v22, 0x10000, v20
    v_xor_b32 v21, 64, v59
    v_add_u32 v23, 0x10000, v21
    v_add_u32 v14, s55, v26
    v_and_b32 v14, 15, v14
    v_lshlrev_b32 v14, 8, v14
    v_mov_b32 v58, s93
    v_lshlrev_b32 v59, 2, v24
    v_mov_b32 v56, 73732
    v_mov_b32 v57, 1
    s_lshl_b32 s52, s16, 12
    s_add_u32 s52, s52, 9502720
    s_lshl_b32 s38, s17, 8
    s_add_u32 s38, s38, s52
    s_lshl_b32 s54, s51, 3
    s_add_u32 s54, s54, 9453568
    v_lshlrev_b32 v15, 3, v26
    s_waitcnt vmcnt(0)
    s_mov_b64 exec, 1
    ds_add_rtn_u32 v57, v56, v57
    s_mov_b64 exec, -1
    s_waitcnt lgkmcnt(0)
    v_readfirstlane_b32 s39, v57
    s_nop 1
    s_cmp_lg_u32 s39, 3
    s_cbranch_scc1 L_nohf
    s_cmp_eq_u32 s97, 1
    s_cbranch_scc1 L_hf_fast
    s_mov_b32 exec_hi, 0
    buffer_store_dword v58, v59, s[12:15], s38 offen sc1
    s_mov_b32 exec_hi, -1
    s_branch L_nohf
L_hf_fast:
    s_mov_b32 exec_hi, 0
    buffer_store_dword v58, v59, s[12:15], s38 offen
    s_mov_b32 exec_hi, -1
L_nohf:
    s_mov_b64 exec, 0xffff
L_hpoll:
    buffer_load_dword v61, v14, s[12:15], s52 offen sc1
    s_waitcnt vmcnt(0)
    v_cmp_ne_u32 vcc, s93, v61
    s_nop 1
    s_and_b32 s38, vcc_lo, 65535
    s_cbranch_scc0 L_hgo
    s_sub_u32 s96, s96, 1
    s_cbranch_scc1 L_hgo
    s_sleep 2
    s_branch L_hpoll
L_hgo:
    s_mov_b64 exec, -1
    s_add_u32 s49, s55, 0
    s_and_b32 s49, s49, 15
    s_lshl_b32 s49, s49, 15
    s_add_u32 s49, s49, s50
    buffer_load_dwordx4 v[160:163], v8, s[12:15], s49 offen offset:0 sc1
    buffer_load_dwordx4 v[164:167], v8, s[12:15], s49 offen offset:1024 sc1
    buffer_load_dwordx4 v[168:171], v8, s[12:15], s49 offen offset:2048 sc1
    buffer_load_dwordx4 v[172:175], v8, s[12:15], s49 offen offset:3072 sc1
    s_mov_b32 s53, 0xffff0000
    s_barrier
    ds_read_b128 v[96:99], v22 offset:16384
    ds_read_b128 v[100:103], v22 offset:18432
    ds_read_b128 v[104:107], v22 offset:20480
    ds_read_b128 v[108:111], v22 offset:22528
    buffer_load_dwordx4 v[176:179], v9, s[12:15], s49 offen offset:0 sc1
    buffer_load_dwordx4 v[180:183], v9, s[12:15], s49 offen offset:1024 sc1
    buffer_load_dwordx4 v[184:187], v9, s[12:15], s49 offen offset:2048 sc1
    buffer_load_dwordx4 v[188:191], v9, s[12:15], s49 offen offset:3072 sc1
    s_add_u32 s49, s55, 1
    s_and_b32 s49, s49, 15
    s_lshl_b32 s49, s49, 15
    s_add_u32 s49, s49, s50
    buffer_load_dwordx4 v[192:195], v8, s[12:15], s49 offen offset:0 sc1
    buffer_load_dwordx4 v[196:199], v8, s[12:15], s49 offen offset:1024 sc1
    buffer_load_dwordx4 v[200:203], v8, s[12:15], s49 offen offset:2048 sc1
    buffer_load_dwordx4 v[204:207], v8, s[12:15], s49 offen offset:3072 sc1
    buffer_load_dwordx4 v[208:211], v9, s[12:15], s49 offen offset:0 sc1
    buffer_load_dwordx4 v[212:215], v9, s[12:15], s49 offen offset:1024 sc1
    buffer_load_dwordx4 v[216:219], v9, s[12:15], s49 offen offset:2048 sc1
    buffer_load_dwordx4 v[220:223], v9, s[12:15], s49 offen offset:3072 sc1
    ds_read_b128 v[112:115], v23 offset:16384
    ds_read_b128 v[116:119], v23 offset:18432
    ds_read_b128 v[120:123], v23 offset:20480
    ds_read_b128 v[124:127], v23 offset:22528
    s_waitcnt vmcnt(14) lgkmcnt(4)
    v_mfma_f32_16x16x32_bf16 v[64:67], v[96:99], v[160:163], 0
    v_mfma_f32_16x16x32_bf16 v[68:71], v[100:103], v[160:163], 0
    v_mfma_f32_16x16x32_bf16 v[72:75], v[104:107], v[160:163], 0
    v_mfma_f32_16x16x32_bf16 v[76:79], v[108:111], v[160:163], 0
    s_add_u32 s49, s55, 2
    s_and_b32 s49, s49, 15
    s_lshl_b32 s49, s49, 15
    s_add_u32 s49, s49, s50
    buffer_load_dwordx4 v[160:163], v8, s[12:15], s49 offen offset:0 sc1
    s_add_u32 m0, s23, 32768
    s_add_u32 s21, s55, 3
    s_and_b32 s21, s21, 15
    s_lshl_b32 s21, s21, 7
    buffer_load_dwordx4 v16, s[28:31], s21 offen offset:0  lds
    v_mfma_f32_16x16x32_bf16 v[80:83], v[96:99], v[164:167], 0
    v_mfma_f32_16x16x32_bf16 v[84:87], v[100:103], v[164:167], 0
    v_mfma_f32_16x16x32_bf16 v[88:91], v[104:107], v[164:167], 0
    v_mfma_f32_16x16x32_bf16 v[92:95], v[108:111], v[164:167], 0
    buffer_load_dwordx4 v[164:167], v8, s[12:15], s49 offen offset:1024 sc1
    buffer_load_dwordx4 v17, s[28:31], s21 offen offset:1024  lds
    ds_read_b128 v[96:99], v22 offset:24576
    ds_read_b128 v[100:103], v22 offset:26624
    ds_read_b128 v[104:107], v22 offset:28672
    ds_read_b128 v[108:111], v22 offset:30720
    s_waitcnt vmcnt(16) lgkmcnt(4)
    v_mfma_f32_16x16x32_bf16 v[64:67], v[112:115], v[168:171], v[64:67]
    v_mfma_f32_16x16x32_bf16 v[68:71], v[116:119], v[168:171], v[68:71]
    v_mfma_f32_16x16x32_bf16 v[72:75], v[120:123], v[168:171], v[72:75]
    v_mfma_f32_16x16x32_bf16 v[76:79], v[124:127], v[168:171], v[76:79]
    buffer_load_dwordx4 v[168:171], v8, s[12:15], s49 offen offset:2048 sc1
    buffer_load_dwordx4 v18, s[28:31], s21 offen offset:2048  lds
    v_mfma_f32_16x16x32_bf16 v[80:83], v[112:115], v[172:175], v[80:83]
    v_mfma_f32_16x16x32_bf16 v[84:87], v[116:119], v[172:175], v[84:87]
    v_mfma_f32_16x16x32_bf16 v[88:91], v[120:123], v[172:175], v[88:91]
    v_mfma_f32_16x16x32_bf16 v[92:95], v[124:127], v[172:175], v[92:95]
    buffer_load_dwordx4 v[172:175], v8, s[12:15], s49 offen offset:3072 sc1
    buffer_load_dwordx4 v19, s[28:31], s21 offen offset:3072  lds
    ds_read_b128 v[112:115], v23 offset:24576
    ds_read_b128 v[116:119], v23 offset:26624
    ds_read_b128 v[120:123], v23 offset:28672
    ds_read_b128 v[124:127], v23 offset:30720
    s_waitcnt vmcnt(18) lgkmcnt(4)
    v_mfma_f32_16x16x32_bf16 v[64:67], v[96:99], v[176:179], v[64:67]
    v_mfma_f32_16x16x32_bf16 v[68:71], v[100:103], v[176:179], v[68:71]
    v_mfma_f32_16x16x32_bf16 v[72:75], v[104:107], v[176:179], v[72:75]
    v_mfma_f32_16x16x32_bf16 v[76:79], v[108:111], v[176:179], v[76:79]
    buffer_load_dwordx4 v[176:179], v9, s[12:15], s49 offen offset:0 sc1
    s_add_u32 m0, s23, 49152
    s_add_u32 s21, s55, 4
    s_and_b32 s21, s21, 15
    s_lshl_b32 s21, s21, 7
    buffer_load_dwordx4 v16, s[28:31], s21 offen offset:0  lds
    v_mfma_f32_16x16x32_bf16 v[80:83], v[96:99], v[180:183], v[80:83]
    v_mfma_f32_16x16x32_bf16 v[84:87], v[100:103], v[180:183], v[84:87]
    v_mfma_f32_16x16x32_bf16 v[88:91], v[104:107], v[180:183], v[88:91]
    v_mfma_f32_16x16x32_bf16 v[92:95], v[108:111], v[180:183], v[92:95]
    buffer_load_dwordx4 v[180:183], v9, s[12:15], s49 offen offset:1024 sc1
    buffer_load_dwordx4 v17, s[28:31], s21 offen offset:1024  lds
    s_waitcnt vmcnt(29) lgkmcnt(0)
    s_barrier
    ds_read_b128 v[96:99], v20 offset:0
    ds_read_b128 v[100:103], v20 offset:2048
    ds_read_b128 v[104:107], v20 offset:4096
    ds_read_b128 v[108:111], v20 offset:6144
    s_waitcnt vmcnt(20)
    v_mfma_f32_16x16x32_bf16 v[64:67], v[112:115], v[184:187], v[64:67]
    v_mfma_f32_16x16x32_bf16 v[68:71], v[116:119], v[184:187], v[68:71]
    v_mfma_f32_16x16x32_bf16 v[72:75], v[120:123], v[184:187], v[72:75]
    v_mfma_f32_16x16x32_bf16 v[76:79], v[124:127], v[184:187], v[76:79]
    buffer_load_dwordx4 v[184:187], v9, s[12:15], s49 offen offset:2048 sc1
    buffer_load_dwordx4 v18, s[28:31], s21 offen offset:2048  lds
    v_mfma_f32_16x16x32_bf16 v[80:83], v[112:115], v[188:191], v[80:83]
    v_mfma_f32_16x16x32_bf16 v[84:87], v[116:119], v[188:191], v[84:87]
    v_mfma_f32_16x16x32_bf16 v[88:91], v[120:123], v[188:191], v[88:91]
    v_mfma_f32_16x16x32_bf16 v[92:95], v[124:127], v[188:191], v[92:95]
    buffer_load_dwordx4 v[188:191], v9, s[12:15], s49 offen offset:3072 sc1
    buffer_load_dwordx4 v19, s[28:31], s21 offen offset:3072  lds
    s_lshl_b32 s38, s51, 11
    s_lshl_b32 s39, s17, 7
    s_add_u32 s38, s38, s39
    buffer_load_dwordx2 v[28:29], v12, s[4:7], s38 offen
    s_add_u32 s38, s38, 8192
    buffer_load_dwordx2 v[30:31], v12, s[4:7], s38 offen
    s_add_u32 s38, s38, 8192
    buffer_load_dwordx2 v[32:33], v12, s[4:7], s38 offen
    s_add_u32 s38, s38, 8192
    buffer_load_dwordx2 v[34:35], v12, s[4:7], s38 offen
    s_add_u32 s38, s38, 8192
    buffer_load_dwordx2 v[36:37], v12, s[4:7], s38 offen
    s_add_u32 s38, s38, 8192
    buffer_load_dwordx2 v[38:39], v12, s[4:7], s38 offen
    s_add_u32 s38, s38, 8192
    buffer_load_dwordx2 v[40:41], v12, s[4:7], s38 offen
    s_add_u32 s38, s38, 8192
    buffer_load_dwordx2 v[42:43], v12, s[4:7], s38 offen
    s_add_u32 s38, s38, 8192
    buffer_load_dwordx2 v[224:225], v13, s[12:15], s54 offen offset:0 sc1
    buffer_load_dwordx2 v[226:227], v13, s[12:15], s54 offen offset:32 sc1
    buffer_load_dwordx2 v[228:229], v13, s[12:15], s54 offen offset:64 sc1
    buffer_load_dwordx2 v[230:231], v13, s[12:15], s54 offen offset:96 sc1
    buffer_load_dwordx2 v[232:233], v13, s[12:15], s54 offen offset:128 sc1
    buffer_load_dwordx2 v[234:235], v13, s[12:15], s54 offen offset:160 sc1
    buffer_load_dwordx2 v[236:237], v13, s[12:15], s54 offen offset:192 sc1
    buffer_load_dwordx2 v[238:239], v13, s[12:15], s54 offen offset:224 sc1
    buffer_load_dwordx2 v[240:241], v15, s[12:15], s54 offen offset:0 sc1
    buffer_load_dwordx2 v[242:243], v15, s[12:15], s54 offen offset:128 sc1
    v_add_u32 v59, s39, v15
    global_load_dwordx2 v[62:63], v59, s[58:59]
    ds_read_b128 v[112:115], v21 offset:0
    ds_read_b128 v[116:119], v21 offset:2048
    ds_read_b128 v[120:123], v21 offset:4096
    ds_read_b128 v[124:127], v21 offset:6144
    s_waitcnt vmcnt(41) lgkmcnt(4)
    v_mfma_f32_16x16x32_bf16 v[64:67], v[96:99], v[192:195], v[64:67]
    v_mfma_f32_16x16x32_bf16 v[68:71], v[100:103], v[192:195], v[68:71]
    v_mfma_f32_16x16x32_bf16 v[72:75], v[104:107], v[192:195], v[72:75]
    v_mfma_f32_16x16x32_bf16 v[76:79], v[108:111], v[192:195], v[76:79]
    s_add_u32 s49, s55, 3
    s_and_b32 s49, s49, 15
    s_lshl_b32 s49, s49, 15
    s_add_u32 s49, s49, s50
    buffer_load_dwordx4 v[192:195], v8, s[12:15], s49 offen offset:0 sc1
    s_add_u32 m0, s23, 65536
    s_add_u32 s21, s55, 5
    s_and_b32 s21, s21, 15
    s_lshl_b32 s21, s21, 7
    buffer_load_dwordx4 v16, s[28:31], s21 offen offset:0  lds
    v_mfma_f32_16x16x32_bf16 v[80:83], v[96:99], v[196:199], v[80:83]
    v_mfma_f32_16x16x32_bf16 v[84:87], v[100:103], v[196:199], v[84:87]
    v_mfma_f32_16x16x32_bf16 v[88:91], v[104:107], v[196:199], v[88:91]
    v_mfma_f32_16x16x32_bf16 v[92:95], v[108:111], v[196:199], v[92:95]
    buffer_load_dwordx4 v[196:199], v8, s[12:15], s49 offen offset:1024 sc1
    buffer_load_dwordx4 v17, s[28:31], s21 offen offset:1024  lds
    ds_read_b128 v[96:99], v20 offset:8192
    ds_read_b128 v[100:103], v20 offset:10240
    ds_read_b128 v[104:107], v20 offset:12288
    ds_read_b128 v[108:111], v20 offset:14336
    s_waitcnt vmcnt(43) lgkmcnt(4)
    v_mfma_f32_16x16x32_bf16 v[64:67], v[112:115], v[200:203], v[64:67]
    v_mfma_f32_16x16x32_bf16 v[68:71], v[116:119], v[200:203], v[68:71]
    v_mfma_f32_16x16x32_bf16 v[72:75], v[120:123], v[200:203], v[72:75]
    v_mfma_f32_16x16x32_bf16 v[76:79], v[124:127], v[200:203], v[76:79]
    buffer_load_dwordx4 v[200:203], v8, s[12:15], s49 offen offset:2048 sc1
    buffer_load_dwordx4 v18, s[28:31], s21 offen offset:2048  lds
    v_mfma_f32_16x16x32_bf16 v[80:83], v[112:115], v[204:207], v[80:83]
    v_mfma_f32_16x16x32_bf16 v[84:87], v[116:119], v[204:207], v[84:87]
    v_mfma_f32_16x16x32_bf16 v[88:91], v[120:123], v[204:207], v[88:91]
    v_mfma_f32_16x16x32_bf16 v[92:95], v[124:127], v[204:207], v[92:95]
    buffer_load_dwordx4 v[204:207], v8, s[12:15], s49 offen offset:3072 sc1
    buffer_load_dwordx4 v19, s[28:31], s21 offen offset:3072  lds
    ds_read_b128 v[112:115], v21 offset:8192
    ds_read_b128 v[116:119], v21 offset:10240
    ds_read_b128 v[120:123], v21 offset:12288
    ds_read_b128 v[124:127], v21 offset:14336
    s_waitcnt vmcnt(45) lgkmcnt(4)
    v_mfma_f32_16x16x32_bf16 v[64:67], v[96:99], v[208:211], v[64:67]
    v_mfma_f32_16x16x32_bf16 v[68:71], v[100:103], v[208:211], v[68:71]
    v_mfma_f32_16x16x32_bf16 v[72:75], v[104:107], v[208:211], v[72:75]
    v_mfma_f32_16x16x32_bf16 v[76:79], v[108:111], v[208:211], v[76:79]
    buffer_load_dwordx4 v[208:211], v9, s[12:15], s49 offen offset:0 sc1
    s_add_u32 m0, s23, 81920
    s_add_u32 s21, s55, 6
    s_and_b32 s21, s21, 15
    s_lshl_b32 s21, s21, 7
    buffer_load_dwordx4 v16, s[28:31], s21 offen offset:0  lds
    v_mfma_f32_16x16x32_bf16 v[80:83], v[96:99], v[212:215], v[80:83]
    v_mfma_f32_16x16x32_bf16 v[84:87], v[100:103], v[212:215], v[84:87]
    v_mfma_f32_16x16x32_bf16 v[88:91], v[104:107], v[212:215], v[88:91]
    v_mfma_f32_16x16x32_bf16 v[92:95], v[108:111], v[212:215], v[92:95]
    buffer_load_dwordx4 v[212:215], v9, s[12:15], s49 offen offset:1024 sc1
    s_waitcnt vmcnt(62) lgkmcnt(0)
    s_barrier
    ds_read_b128 v[96:99], v20 offset:16384
    ds_read_b128 v[100:103], v20 offset:18432
    ds_read_b128 v[104:107], v20 offset:20480
    ds_read_b128 v[108:111], v20 offset:22528
    s_waitcnt vmcnt(46)
    v_mfma_f32_16x16x32_bf16 v[64:67], v[112:115], v[216:219], v[64:67]
    v_mfma_f32_16x16x32_bf16 v[68:71], v[116:119], v[216:219], v[68:71]
    v_mfma_f32_16x16x32_bf16 v[72:75], v[120:123], v[216:219], v[72:75]
    v_mfma_f32_16x16x32_bf16 v[76:79], v[124:127], v[216:219], v[76:79]
    buffer_load_dwordx4 v[216:219], v9, s[12:15], s49 offen offset:2048 sc1
    buffer_load_dwordx4 v17, s[28:31], s21 offen offset:1024  lds
    v_mfma_f32_16x16x32_bf16 v[80:83], v[112:115], v[220:223], v[80:83]
    v_mfma_f32_16x16x32_bf16 v[84:87], v[116:119], v[220:223], v[84:87]
    v_mfma_f32_16x16x32_bf16 v[88:91], v[120:123], v[220:223], v[88:91]
    v_mfma_f32_16x16x32_bf16 v[92:95], v[124:127], v[220:223], v[92:95]
    buffer_load_dwordx4 v[220:223], v9, s[12:15], s49 offen offset:3072 sc1
    buffer_load_dwordx4 v18, s[28:31], s21 offen offset:2048  lds
    ds_read_b128 v[112:115], v21 offset:16384
    ds_read_b128 v[116:119], v21 offset:18432
    ds_read_b128 v[120:123], v21 offset:20480
    ds_read_b128 v[124:127], v21 offset:22528
    s_waitcnt vmcnt(47) lgkmcnt(4)
    v_mfma_f32_16x16x32_bf16 v[64:67], v[96:99], v[160:163], v[64:67]
    v_mfma_f32_16x16x32_bf16 v[68:71], v[100:103], v[160:163], v[68:71]
    v_mfma_f32_16x16x32_bf16 v[72:75], v[104:107], v[160:163], v[72:75]
    v_mfma_f32_16x16x32_bf16 v[76:79], v[108:111], v[160:163], v[76:79]
    s_add_u32 s49, s55, 4
    s_and_b32 s49, s49, 15
    s_lshl_b32 s49, s49, 15
    s_add_u32 s49, s49, s50
    buffer_load_dwordx4 v[160:163], v8, s[12:15], s49 offen offset:0 sc1
    buffer_load_dwordx4 v19, s[28:31], s21 offen offset:3072  lds
    v_mfma_f32_16x16x32_bf16 v[80:83], v[96:99], v[164:167], v[80:83]
    v_mfma_f32_16x16x32_bf16 v[84:87], v[100:103], v[164:167], v[84:87]
    v_mfma_f32_16x16x32_bf16 v[88:91], v[104:107], v[164:167], v[88:91]
    v_mfma_f32_16x16x32_bf16 v[92:95], v[108:111], v[164:167], v[92:95]
    buffer_load_dwordx4 v[164:167], v8, s[12:15], s49 offen offset:1024 sc1
    ds_read_b128 v[96:99], v20 offset:24576
    ds_read_b128 v[100:103], v20 offset:26624
    ds_read_b128 v[104:107], v20 offset:28672
    ds_read_b128 v[108:111], v20 offset:30720
    s_waitcnt vmcnt(46) lgkmcnt(4)
    v_mfma_f32_16x16x32_bf16 v[64:67], v[112:115], v[168:171], v[64:67]
    v_mfma_f32_16x16x32_bf16 v[68:71], v[116:119], v[168:171], v[68:71]
    v_mfma_f32_16x16x32_bf16 v[72:75], v[120:123], v[168:171], v[72:75]
    v_mfma_f32_16x16x32_bf16 v[76:79], v[124:127], v[168:171], v[76:79]
    buffer_load_dwordx4 v[168:171], v8, s[12:15], s49 offen offset:2048 sc1
    s_add_u32 m0, s23, 0
    s_add_u32 s21, s55, 7
    s_and_b32 s21, s21, 15
    s_lshl_b32 s21, s21, 7
    buffer_load_dwordx4 v16, s[28:31], s21 offen offset:0  lds
    v_mfma_f32_16x16x32_bf16 v[80:83], v[112:115], v[172:175], v[80:83]
    v_mfma_f32_16x16x32_bf16 v[84:87], v[116:119], v[172:175], v[84:87]
    v_mfma_f32_16x16x32_bf16 v[88:91], v[120:123], v[172:175], v[88:91]
    v_mfma_f32_16x16x32_bf16 v[92:95], v[124:127], v[172:175], v[92:95]
    buffer_load_dwordx4 v[172:175], v8, s[12:15], s49 offen offset:3072 sc1
    ds_read_b128 v[112:115], v21 offset:24576
    ds_read_b128 v[116:119], v21 offset:26624
    ds_read_b128 v[120:123], v21 offset:28672
    ds_read_b128 v[124:127], v21 offset:30720
    s_waitcnt vmcnt(45) lgkmcnt(4)
    v_mfma_f32_16x16x32_bf16 v[64:67], v[96:99], v[176:179], v[64:67]
    v_mfma_f32_16x16x32_bf16 v[68:71], v[100:103], v[176:179], v[68:71]
    v_mfma_f32_16x16x32_bf16 v[72:75], v[104:107], v[176:179], v[72:75]
    v_mfma_f32_16x16x32_bf16 v[76:79], v[108:111], v[176:179], v[76:79]
    buffer_load_dwordx4 v[176:179], v9, s[12:15], s49 offen offset:0 sc1
    buffer_load_dwordx4 v17, s[28:31], s21 offen offset:1024  lds
    v_mfma_f32_16x16x32_bf16 v[80:83], v[96:99], v[180:183], v[80:83]
    v_mfma_f32_16x16x32_bf16 v[84:87], v[100:103], v[180:183], v[84:87]
    v_mfma_f32_16x16x32_bf16 v[88:91], v[104:107], v[180:183], v[88:91]
    v_mfma_f32_16x16x32_bf16 v[92:95], v[108:111], v[180:183], v[92:95]
    buffer_load_dwordx4 v[180:183], v9, s[12:15], s49 offen offset:1024 sc1
    s_waitcnt vmcnt(51) lgkmcnt(0)
    s_barrier
    ds_read_b128 v[96:99], v20 offset:32768
    ds_read_b128 v[100:103], v20 offset:34816
    ds_read_b128 v[104:107], v20 offset:36864
    ds_read_b128 v[108:111], v20 offset:38912
    s_waitcnt vmcnt(44)
    v_mfma_f32_16x16x32_bf16 v[64:67], v[112:115], v[184:187], v[64:67]
    v_mfma_f32_16x16x32_bf16 v[68:71], v[116:119], v[184:187], v[68:71]
    v_mfma_f32_16x16x32_bf16 v[72:75], v[120:123], v[184:187], v[72:75]
    v_mfma_f32_16x16x32_bf16 v[76:79], v[124:127], v[184:187], v[76:79]
    buffer_load_dwordx4 v[184:187], v9, s[12:15], s49 offen offset:2048 sc1
    buffer_load_dwordx4 v18, s[28:31], s21 offen offset:2048  lds
    v_mfma_f32_16x16x32_bf16 v[80:83], v[112:115], v[188:191], v[80:83]
    v_mfma_f32_16x16x32_bf16 v[84:87], v[116:119], v[188:191], v[84:87]
    v_mfma_f32_16x16x32_bf16 v[88:91], v[120:123], v[188:191], v[88:91]
    v_mfma_f32_16x16x32_bf16 v[92:95], v[124:127], v[188:191], v[92:95]
    buffer_load_dwordx4 v[188:191], v9, s[12:15], s49 offen offset:3072 sc1
    buffer_load_dwordx4 v19, s[28:31], s21 offen offset:3072  lds
    ds_read_b128 v[112:115], v21 offset:32768
    ds_read_b128 v[116:119], v21 offset:34816
    ds_read_b128 v[120:123], v21 offset:36864
    ds_read_b128 v[124:127], v21 offset:38912
    s_waitcnt vmcnt(25) lgkmcnt(4)
    v_mfma_f32_16x16x32_bf16 v[64:67], v[96:99], v[192:195], v[64:67]
    v_mfma_f32_16x16x32_bf16 v[68:71], v[100:103], v[192:195], v[68:71]
    v_mfma_f32_16x16x32_bf16 v[72:75], v[104:107], v[192:195], v[72:75]
    v_mfma_f32_16x16x32_bf16 v[76:79], v[108:111], v[192:195], v[76:79]
    s_add_u32 s49, s55, 5
    s_and_b32 s49, s49, 15
    s_lshl_b32 s49, s49, 15
    s_add_u32 s49, s49, s50
    buffer_load_dwordx4 v[192:195], v8, s[12:15], s49 offen offset:0 sc1
    s_add_u32 m0, s23, 16384
    s_add_u32 s21, s55, 8
    s_and_b32 s21, s21, 15
    s_lshl_b32 s21, s21, 7
    buffer_load_dwordx4 v16, s[28:31], s21 offen offset:0  lds
    v_mfma_f32_16x16x32_bf16 v[80:83], v[96:99], v[196:199], v[80:83]
    v_mfma_f32_16x16x32_bf16 v[84:87], v[100:103], v[196:199], v[84:87]
    v_mfma_f32_16x16x32_bf16 v[88:91], v[104:107], v[196:199], v[88:91]
    v_mfma_f32_16x16x32_bf16 v[92:95], v[108:111], v[196:199], v[92:95]
    buffer_load_dwordx4 v[196:199], v8, s[12:15], s49 offen offset:1024 sc1
    ds_read_b128 v[96:99], v20 offset:40960
    ds_read_b128 v[100:103], v20 offset:43008
    ds_read_b128 v[104:107], v20 offset:45056
    ds_read_b128 v[108:111], v20 offset:47104
    s_waitcnt vmcnt(24) lgkmcnt(4)
    v_mfma_f32_16x16x32_bf16 v[64:67], v[112:115], v[200:203], v[64:67]
    v_mfma_f32_16x16x32_bf16 v[68:71], v[116:119], v[200:203], v[68:71]
    v_mfma_f32_16x16x32_bf16 v[72:75], v[120:123], v[200:203], v[72:75]
    v_mfma_f32_16x16x32_bf16 v[76:79], v[124:127], v[200:203], v[76:79]
    buffer_load_dwordx4 v[200:203], v8, s[12:15], s49 offen offset:2048 sc1
    buffer_load_dwordx4 v17, s[28:31], s21 offen offset:1024  lds
    v_mfma_f32_16x16x32_bf16 v[80:83], v[112:115], v[204:207], v[80:83]
    v_mfma_f32_16x16x32_bf16 v[84:87], v[116:119], v[204:207], v[84:87]
    v_mfma_f32_16x16x32_bf16 v[88:91], v[120:123], v[204:207], v[88:91]
    v_mfma_f32_16x16x32_bf16 v[92:95], v[124:127], v[204:207], v[92:95]
    buffer_load_dwordx4 v[204:207], v8, s[12:15], s49 offen offset:3072 sc1
    s_waitcnt vmcnt(34)
L_gchk:
    v_xor_b32 v225, s93, v225
    v_mov_b32 v44, v224
    v_xor_b32 v227, s93, v227
    v_mov_b32 v45, v226
    v_xor_b32 v229, s93, v229
    v_mov_b32 v46, v228
    v_xor_b32 v231, s93, v231
    v_mov_b32 v47, v230
    v_xor_b32 v233, s93, v233
    v_mov_b32 v48, v232
    v_xor_b32 v235, s93, v235
    v_mov_b32 v49, v234
    v_xor_b32 v237, s93, v237
    v_mov_b32 v50, v236
    v_xor_b32 v239, s93, v239
    v_mov_b32 v51, v238
    v_xor_b32 v241, s93, v241
    v_mov_b32 v10, v240
    v_xor_b32 v243, s93, v243
    v_mov_b32 v11, v242
    v_or3_b32 v58, v225, v227, v229
    v_or3_b32 v58, v58, v231, v233
    v_or3_b32 v58, v58, v235, v237
    v_or3_b32 v58, v58, v239, v241
    v_or_b32 v58, v58, v243
    v_cmp_ne_u32 vcc, 0, v58
    s_nop 1
    s_cmp_eq_u64 vcc, 0
    s_cbranch_scc1 L_gok
    s_sub_u32 s96, s96, 1
    s_cbranch_scc1 L_gok
    buffer_load_dwordx2 v[224:225], v13, s[12:15], s54 offen offset:0 sc1
    buffer_load_dwordx2 v[226:227], v13, s[12:15], s54 offen offset:32 sc1
    buffer_load_dwordx2 v[228:229], v13, s[12:15], s54 offen offset:64 sc1
    buffer_load_dwordx2 v[230:231], v13, s[12:15], s54 offen offset:96 sc1
    buffer_load_dwordx2 v[232:233], v13, s[12:15], s54 offen offset:128 sc1
    buffer_load_dwordx2 v[234:235], v13, s[12:15], s54 offen offset:160 sc1
    buffer_load_dwordx2 v[236:237], v13, s[12:15], s54 offen offset:192 sc1
    buffer_load_dwordx2 v[238:239], v13, s[12:15], s54 offen offset:224 sc1
    buffer_load_dwordx2 v[240:241], v15, s[12:15], s54 offen offset:0 sc1
    buffer_load_dwordx2 v[242:243], v15, s[12:15], s54 offen offset:128 sc1
    s_waitcnt vmcnt(0)
    s_branch L_gchk
L_gok:
    ds_read_b128 v[112:115], v21 offset:40960
    ds_read_b128 v[116:119], v21 offset:43008
    ds_read_b128 v[120:123], v21 offset:45056
    ds_read_b128 v[124:127], v21 offset:47104
    s_waitcnt vmcnt(23) lgkmcnt(4)
    v_mfma_f32_16x16x32_bf16 v[64:67], v[96:99], v[208:211], v[64:67]
    v_lshlrev_b32 v52, 16, v62
    v_mfma_f32_16x16x32_bf16 v[68:71], v[100:103], v[208:211], v[68:71]
    v_and_b32 v53, s53, v62
    v_mfma_f32_16x16x32_bf16 v[72:75], v[104:107], v[208:211], v[72:75]
    v_lshlrev_b32 v54, 16, v63
    v_mfma_f32_16x16x32_bf16 v[76:79], v[108:111], v[208:211], v[76:79]
    buffer_load_dwordx4 v[208:211], v9, s[12:15], s49 offen offset:0 sc1
    buffer_load_dwordx4 v18, s[28:31], s21 offen offset:2048  lds
    v_mfma_f32_16x16x32_bf16 v[80:83], v[96:99], v[212:215], v[80:83]
    v_and_b32 v55, s53, v63
    v_mfma_f32_16x16x32_bf16 v[84:87], v[100:103], v[212:215], v[84:87]
    v_sub_f32 v60, 1.0, v44
    v_mfma_f32_16x16x32_bf16 v[88:91], v[104:107], v[212:215], v[88:91]
    v_cvt_pk_bf16_f32 v60, v60, v60
    v_mfma_f32_16x16x32_bf16 v[92:95], v[108:111], v[212:215], v[92:95]
    buffer_load_dwordx4 v[212:215], v9, s[12:15], s49 offen offset:1024 sc1
    s_waitcnt vmcnt(56) lgkmcnt(0)
    s_barrier
    ds_read_b128 v[96:99], v20 offset:49152
    ds_read_b128 v[100:103], v20 offset:51200
    ds_read_b128 v[104:107], v20 offset:53248
    ds_read_b128 v[108:111], v20 offset:55296
    s_waitcnt vmcnt(23)
    v_mfma_f32_16x16x32_bf16 v[64:67], v[112:115], v[216:219], v[64:67]
    v_lshlrev_b32 v60, 16, v60
    v_mfma_f32_16x16x32_bf16 v[68:71], v[116:119], v[216:219], v[68:71]
    v_lshlrev_b32 v56, 16, v28
    v_mfma_f32_16x16x32_bf16 v[72:75], v[120:123], v[216:219], v[72:75]
    v_and_b32 v57, s53, v28
    v_mfma_f32_16x16x32_bf16 v[76:79], v[124:127], v[216:219], v[76:79]
    buffer_load_dwordx4 v[216:219], v9, s[12:15], s49 offen offset:2048 sc1
    buffer_load_dwordx4 v19, s[28:31], s21 offen offset:3072  lds
    v_mfma_f32_16x16x32_bf16 v[80:83], v[112:115], v[220:223], v[80:83]
    v_mul_f32 v58, v56, v52
    v_mfma_f32_16x16x32_bf16 v[84:87], v[116:119], v[220:223], v[84:87]
    v_mul_f32 v59, v57, v53
    v_mfma_f32_16x16x32_bf16 v[88:91], v[120:123], v[220:223], v[88:91]
    v_cvt_pk_bf16_f32 v58, v58, v59
    v_mfma_f32_16x16x32_bf16 v[92:95], v[124:127], v[220:223], v[92:95]
    buffer_load_dwordx4 v[220:223], v9, s[12:15], s49 offen offset:3072 sc1
    ds_read_b128 v[112:115], v21 offset:49152
    ds_read_b128 v[116:119], v21 offset:51200
    ds_read_b128 v[120:123], v21 offset:53248
    ds_read_b128 v[124:127], v21 offset:55296
    s_waitcnt vmcnt(22) lgkmcnt(4)
    v_mfma_f32_16x16x32_bf16 v[64:67], v[96:99], v[160:163], v[64:67]
    v_mul_f32 v56, v56, v60
    v_mfma_f32_16x16x32_bf16 v[68:71], v[100:103], v[160:163], v[68:71]
    v_mul_f32 v57, v57, v60
    v_mfma_f32_16x16x32_bf16 v[72:75], v[104:107], v[160:163], v[72:75]
    v_cvt_pk_bf16_f32 v56, v56, v57
    v_mfma_f32_16x16x32_bf16 v[76:79], v[108:111], v[160:163], v[76:79]
    s_add_u32 s49, s55, 6
    s_and_b32 s49, s49, 15
    s_lshl_b32 s49, s49, 15
    s_add_u32 s49, s49, s50
    buffer_load_dwordx4 v[160:163], v8, s[12:15], s49 offen offset:0 sc1
    s_add_u32 m0, s23, 32768
    s_add_u32 s21, s55, 9
    s_and_b32 s21, s21, 15
    s_lshl_b32 s21, s21, 7
    buffer_load_dwordx4 v16, s[28:31], s21 offen offset:0  lds
    v_mfma_f32_16x16x32_bf16 v[80:83], v[96:99], v[164:167], v[80:83]
    v_and_b32 v59, s53, v58
    v_mfma_f32_16x16x32_bf16 v[84:87], v[100:103], v[164:167], v[84:87]
    v_lshlrev_b32 v58, 16, v58
    v_mfma_f32_16x16x32_bf16 v[88:91], v[104:107], v[164:167], v[88:91]
    v_and_b32 v57, s53, v56
    v_mfma_f32_16x16x32_bf16 v[92:95], v[108:111], v[164:167], v[92:95]
    buffer_load_dwordx4 v[164:167], v8, s[12:15], s49 offen offset:1024 sc1
    ds_read_b128 v[96:99], v20 offset:57344
    ds_read_b128 v[100:103], v20 offset:59392
    ds_read_b128 v[104:107], v20 offset:61440
    ds_read_b128 v[108:111], v20 offset:63488
    s_waitcnt vmcnt(22) lgkmcnt(4)
    v_mfma_f32_16x16x32_bf16 v[64:67], v[112:115], v[168:171], v[64:67]
    v_lshlrev_b32 v56, 16, v56
    v_mfma_f32_16x16x32_bf16 v[68:71], v[116:119], v[168:171], v[68:71]
    v_fma_f32 v128, v44, v58, v56
    v_mfma_f32_16x16x32_bf16 v[72:75], v[120:123], v[168:171], v[72:75]
    v_fma_f32 v129, v44, v59, v57
    v_mfma_f32_16x16x32_bf16 v[76:79], v[124:127], v[168:171], v[76:79]
    buffer_load_dwordx4 v[168:171], v8, s[12:15], s49 offen offset:2048 sc1
    buffer_load_dwordx4 v17, s[28:31], s21 offen offset:1024  lds
    v_mfma_f32_16x16x32_bf16 v[80:83], v[112:115], v[172:175], v[80:83]
    v_lshlrev_b32 v56, 16, v29
    v_mfma_f32_16x16x32_bf16 v[84:87], v[116:119], v[172:175], v[84:87]
    v_and_b32 v57, s53, v29
    v_mfma_f32_16x16x32_bf16 v[88:91], v[120:123], v[172:175], v[88:91]
    v_mul_f32 v58, v56, v54
    v_mfma_f32_16x16x32_bf16 v[92:95], v[124:127], v[172:175], v[92:95]
    buffer_load_dwordx4 v[172:175], v8, s[12:15], s49 offen offset:3072 sc1
    ds_read_b128 v[112:115], v21 offset:57344
    ds_read_b128 v[116:119], v21 offset:59392
    ds_read_b128 v[120:123], v21 offset:61440
    ds_read_b128 v[124:127], v21 offset:63488
    s_waitcnt vmcnt(22) lgkmcnt(4)
    v_mfma_f32_16x16x32_bf16 v[64:67], v[96:99], v[176:179], v[64:67]
    v_mul_f32 v59, v57, v55
    v_mfma_f32_16x16x32_bf16 v[68:71], v[100:103], v[176:179], v[68:71]
    v_cvt_pk_bf16_f32 v58, v58, v59
    v_mfma_f32_16x16x32_bf16 v[72:75], v[104:107], v[176:179], v[72:75]
    v_mul_f32 v56, v56, v60
    v_mfma_f32_16x16x32_bf16 v[76:79], v[108:111], v[176:179], v[76:79]
    buffer_load_dwordx4 v[176:179], v9, s[12:15], s49 offen offset:0 sc1
    buffer_load_dwordx4 v18, s[28:31], s21 offen offset:2048  lds
    v_mfma_f32_16x16x32_bf16 v[80:83], v[96:99], v[180:183], v[80:83]
    v_mul_f32 v57, v57, v60
    v_mfma_f32_16x16x32_bf16 v[84:87], v[100:103], v[180:183], v[84:87]
    v_cvt_pk_bf16_f32 v56, v56, v57
    v_mfma_f32_16x16x32_bf16 v[88:91], v[104:107], v[180:183], v[88:91]
    v_and_b32 v59, s53, v58
    v_mfma_f32_16x16x32_bf16 v[92:95], v[108:111], v[180:183], v[92:95]
    buffer_load_dwordx4 v[180:183], v9, s[12:15], s49 offen offset:1024 sc1
    s_waitcnt vmcnt(41) lgkmcnt(0)
    s_barrier
    ds_read_b128 v[96:99], v22 offset:0
    ds_read_b128 v[100:103], v22 offset:2048
    ds_read_b128 v[104:107], v22 offset:4096
    ds_read_b128 v[108:111], v22 offset:6144
    s_waitcnt vmcnt(22)
    v_mfma_f32_16x16x32_bf16 v[64:67], v[112:115], v[184:187], v[64:67]
    v_lshlrev_b32 v58, 16, v58
    v_mfma_f32_16x16x32_bf16 v[68:71], v[116:119], v[184:187], v[68:71]
    v_and_b32 v57, s53, v56
    v_mfma_f32_16x16x32_bf16 v[72:75], v[120:123], v[184:187], v[72:75]
    v_lshlrev_b32 v56, 16, v56
    v_mfma_f32_16x16x32_bf16 v[76:79], v[124:127], v[184:187], v[76:79]
    buffer_load_dwordx4 v[184:187], v9, s[12:15], s49 offen offset:2048 sc1
    buffer_load_dwordx4 v19, s[28:31], s21 offen offset:3072  lds
    v_mfma_f32_16x16x32_bf16 v[80:83], v[112:115], v[188:191], v[80:83]
    v_fma_f32 v130, v44, v58, v56
    v_mfma_f32_16x16x32_bf16 v[84:87], v[116:119], v[188:191], v[84:87]
    v_fma_f32 v131, v44, v59, v57
    v_mfma_f32_16x16x32_bf16 v[88:91], v[120:123], v[188:191], v[88:91]
    v_sub_f32 v60, 1.0, v45
    v_mfma_f32_16x16x32_bf16 v[92:95], v[124:127], v[188:191], v[92:95]
    buffer_load_dwordx4 v[188:191], v9, s[12:15], s49 offen offset:3072 sc1
    ds_read_b128 v[112:115], v23 offset:0
    ds_read_b128 v[116:119], v23 offset:2048
    ds_read_b128 v[120:123], v23 offset:4096
    ds_read_b128 v[124:127], v23 offset:6144
    s_waitcnt vmcnt(21) lgkmcnt(4)
    v_mfma_f32_16x16x32_bf16 v[64:67], v[96:99], v[192:195], v[64:67]
    v_cvt_pk_bf16_f32 v60, v60, v60
    v_mfma_f32_16x16x32_bf16 v[68:71], v[100:103], v[192:195], v[68:71]
    v_lshlrev_b32 v60, 16, v60
    v_mfma_f32_16x16x32_bf16 v[72:75], v[104:107], v[192:195], v[72:75]
    v_lshlrev_b32 v56, 16, v30
    v_mfma_f32_16x16x32_bf16 v[76:79], v[108:111], v[192:195], v[76:79]
    s_add_u32 s49, s55, 7
    s_and_b32 s49, s49, 15
    s_lshl_b32 s49, s49, 15
    s_add_u32 s49, s49, s50
    buffer_load_dwordx4 v[192:195], v8, s[12:15], s49 offen offset:0 sc1
    s_add_u32 m0, s23, 49152
    s_add_u32 s21, s55, 10
    s_and_b32 s21, s21, 15
    s_lshl_b32 s21, s21, 7
    buffer_load_dwordx4 v16, s[28:31], s21 offen offset:0  lds
    v_mfma_f32_16x16x32_bf16 v[80:83], v[96:99], v[196:199], v[80:83]
    v_and_b32 v57, s53, v30
    v_mfma_f32_16x16x32_bf16 v[84:87], v[100:103], v[196:199], v[84:87]
    v_mul_f32 v58, v56, v52
    v_mfma_f32_16x16x32_bf16 v[88:91], v[104:107], v[196:199], v[88:91]
    v_mul_f32 v59, v57, v53
    v_mfma_f32_16x16x32_bf16 v[92:95], v[108:111], v[196:199], v[92:95]
    buffer_load_dwordx4 v[196:199], v8, s[12:15], s49 offen offset:1024 sc1
    ds_read_b128 v[96:99], v22 offset:8192
    ds_read_b128 v[100:103], v22 offset:10240
    ds_read_b128 v[104:107], v22 offset:12288
    ds_read_b128 v[108:111], v22 offset:14336
    s_waitcnt vmcnt(21) lgkmcnt(4)
    v_mfma_f32_16x16x32_bf16 v[64:67], v[112:115], v[200:203], v[64:67]
    v_cvt_pk_bf16_f32 v58, v58, v59
    v_mfma_f32_16x16x32_bf16 v[68:71], v[116:119], v[200:203], v[68:71]
    v_mul_f32 v56, v56, v60
    v_mfma_f32_16x16x32_bf16 v[72:75], v[120:123], v[200:203], v[72:75]
    v_mul_f32 v57, v57, v60
    v_mfma_f32_16x16x32_bf16 v[76:79], v[124:127], v[200:203], v[76:79]
    buffer_load_dwordx4 v[200:203], v8, s[12:15], s49 offen offset:2048 sc1
    buffer_load_dwordx4 v17, s[28:31], s21 offen offset:1024  lds
    v_mfma_f32_16x16x32_bf16 v[80:83], v[112:115], v[204:207], v[80:83]
    v_cvt_pk_bf16_f32 v56, v56, v57
    v_mfma_f32_16x16x32_bf16 v[84:87], v[116:119], v[204:207], v[84:87]
    v_and_b32 v59, s53, v58
    v_mfma_f32_16x16x32_bf16 v[88:91], v[120:123], v[204:207], v[88:91]
    v_lshlrev_b32 v58, 16, v58
    v_mfma_f32_16x16x32_bf16 v[92:95], v[124:127], v[204:207], v[92:95]
    buffer_load_dwordx4 v[204:207], v8, s[12:15], s49 offen offset:3072 sc1
    ds_read_b128 v[112:115], v23 offset:8192
    ds_read_b128 v[116:119], v23 offset:10240
    ds_read_b128 v[120:123], v23 offset:12288
    ds_read_b128 v[124:127], v23 offset:14336
    s_waitcnt vmcnt(21) lgkmcnt(4)
    v_mfma_f32_16x16x32_bf16 v[64:67], v[96:99], v[208:211], v[64:67]
    v_and_b32 v57, s53, v56
    v_mfma_f32_16x16x32_bf16 v[68:71], v[100:103], v[208:211], v[68:71]
    v_lshlrev_b32 v56, 16, v56
    v_mfma_f32_16x16x32_bf16 v[72:75], v[104:107], v[208:211], v[72:75]
    v_fma_f32 v132, v45, v58, v56
    v_mfma_f32_16x16x32_bf16 v[76:79], v[108:111], v[208:211], v[76:79]
    buffer_load_dwordx4 v[208:211], v9, s[12:15], s49 offen offset:0 sc1
    buffer_load_dwordx4 v18, s[28:31], s21 offen offset:2048  lds
    v_mfma_f32_16x16x32_bf16 v[80:83], v[96:99], v[212:215], v[80:83]
    v_fma_f32 v133, v45, v59, v57
    v_mfma_f32_16x16x32_bf16 v[84:87], v[100:103], v[212:215], v[84:87]
    v_lshlrev_b32 v56, 16, v31
    v_mfma_f32_16x16x32_bf16 v[88:91], v[104:107], v[212:215], v[88:91]
    v_and_b32 v57, s53, v31
    v_mfma_f32_16x16x32_bf16 v[92:95], v[108:111], v[212:215], v[92:95]
    buffer_load_dwordx4 v[212:215], v9, s[12:15], s49 offen offset:1024 sc1
    s_waitcnt vmcnt(44) lgkmcnt(0)
    s_barrier
    ds_read_b128 v[96:99], v22 offset:16384
    ds_read_b128 v[100:103], v22 offset:18432
    ds_read_b128 v[104:107], v22 offset:20480
    ds_read_b128 v[108:111], v22 offset:22528
    s_waitcnt vmcnt(21)
    v_mfma_f32_16x16x32_bf16 v[64:67], v[112:115], v[216:219], v[64:67]
    v_mul_f32 v58, v56, v54
    v_mfma_f32_16x16x32_bf16 v[68:71], v[116:119], v[216:219], v[68:71]
    v_mul_f32 v59, v57, v55
    v_mfma_f32_16x16x32_bf16 v[72:75], v[120:123], v[216:219], v[72:75]
    v_cvt_pk_bf16_f32 v58, v58, v59
    v_mfma_f32_16x16x32_bf16 v[76:79], v[124:127], v[216:219], v[76:79]
    buffer_load_dwordx4 v[216:219], v9, s[12:15], s49 offen offset:2048 sc1
    buffer_load_dwordx4 v19, s[28:31], s21 offen offset:3072  lds
    v_mfma_f32_16x16x32_bf16 v[80:83], v[112:115], v[220:223], v[80:83]
    v_mul_f32 v56, v56, v60
    v_mfma_f32_16x16x32_bf16 v[84:87], v[116:119], v[220:223], v[84:87]
    v_mul_f32 v57, v57, v60
    v_mfma_f32_16x16x32_bf16 v[88:91], v[120:123], v[220:223], v[88:91]
    v_cvt_pk_bf16_f32 v56, v56, v57
    v_mfma_f32_16x16x32_bf16 v[92:95], v[124:127], v[220:223], v[92:95]
    buffer_load_dwordx4 v[220:223], v9, s[12:15], s49 offen offset:3072 sc1
    ds_read_b128 v[112:115], v23 offset:16384
    ds_read_b128 v[116:119], v23 offset:18432
    ds_read_b128 v[120:123], v23 offset:20480
    ds_read_b128 v[124:127], v23 offset:22528
    s_waitcnt vmcnt(21) lgkmcnt(4)
    v_mfma_f32_16x16x32_bf16 v[64:67], v[96:99], v[160:163], v[64:67]
    v_and_b32 v59, s53, v58
    v_mfma_f32_16x16x32_bf16 v[68:71], v[100:103], v[160:163], v[68:71]
    v_lshlrev_b32 v58, 16, v58
    v_mfma_f32_16x16x32_bf16 v[72:75], v[104:107], v[160:163], v[72:75]
    v_and_b32 v57, s53, v56
    v_mfma_f32_16x16x32_bf16 v[76:79], v[108:111], v[160:163], v[76:79]
    s_add_u32 s49, s55, 8
    s_and_b32 s49, s49, 15
    s_lshl_b32 s49, s49, 15
    s_add_u32 s49, s49, s50
    buffer_load_dwordx4 v[160:163], v8, s[12:15], s49 offen offset:0 sc1
    s_add_u32 m0, s23, 65536
    s_add_u32 s21, s55, 11
    s_and_b32 s21, s21, 15
    s_lshl_b32 s21, s21, 7
    buffer_load_dwordx4 v16, s[28:31], s21 offen offset:0  lds
    v_mfma_f32_16x16x32_bf16 v[80:83], v[96:99], v[164:167], v[80:83]
    v_lshlrev_b32 v56, 16, v56
    v_mfma_f32_16x16x32_bf16 v[84:87], v[100:103], v[164:167], v[84:87]
    v_fma_f32 v134, v45, v58, v56
    v_mfma_f32_16x16x32_bf16 v[88:91], v[104:107], v[164:167], v[88:91]
    v_fma_f32 v135, v45, v59, v57
    v_mfma_f32_16x16x32_bf16 v[92:95], v[108:111], v[164:167], v[92:95]
    buffer_load_dwordx4 v[164:167], v8, s[12:15], s49 offen offset:1024 sc1
    ds_read_b128 v[96:99], v22 offset:24576
    ds_read_b128 v[100:103], v22 offset:26624
    ds_read_b128 v[104:107], v22 offset:28672
    ds_read_b128 v[108:111], v22 offset:30720
    s_waitcnt vmcnt(21) lgkmcnt(4)
    v_mfma_f32_16x16x32_bf16 v[64:67], v[112:115], v[168:171], v[64:67]
    v_sub_f32 v60, 1.0, v46
    v_mfma_f32_16x16x32_bf16 v[68:71], v[116:119], v[168:171], v[68:71]
    v_cvt_pk_bf16_f32 v60, v60, v60
    v_mfma_f32_16x16x32_bf16 v[72:75], v[120:123], v[168:171], v[72:75]
    v_lshlrev_b32 v60, 16, v60
    v_mfma_f32_16x16x32_bf16 v[76:79], v[124:127], v[168:171], v[76:79]
    buffer_load_dwordx4 v[168:171], v8, s[12:15], s49 offen offset:2048 sc1
    buffer_load_dwordx4 v17, s[28:31], s21 offen offset:1024  lds
    v_mfma_f32_16x16x32_bf16 v[80:83], v[112:115], v[172:175], v[80:83]
    v_lshlrev_b32 v56, 16, v32
    v_mfma_f32_16x16x32_bf16 v[84:87], v[116:119], v[172:175], v[84:87]
    v_and_b32 v57, s53, v32
    v_mfma_f32_16x16x32_bf16 v[88:91], v[120:123], v[172:175], v[88:91]
    v_mul_f32 v58, v56, v52
    v_mfma_f32_16x16x32_bf16 v[92:95], v[124:127], v[172:175], v[92:95]
    buffer_load_dwordx4 v[172:175], v8, s[12:15], s49 offen offset:3072 sc1
    ds_read_b128 v[112:115], v23 offset:24576
    ds_read_b128 v[116:119], v23 offset:26624
    ds_read_b128 v[120:123], v23 offset:28672
    ds_read_b128 v[124:127], v23 offset:30720
    s_waitcnt vmcnt(21) lgkmcnt(4)
    v_mfma_f32_16x16x32_bf16 v[64:67], v[96:99], v[176:179], v[64:67]
    v_mul_f32 v59, v57, v53
    v_mfma_f32_16x16x32_bf16 v[68:71], v[100:103], v[176:179], v[68:71]
    v_cvt_pk_bf16_f32 v58, v58, v59
    v_mfma_f32_16x16x32_bf16 v[72:75], v[104:107], v[176:179], v[72:75]
    v_mul_f32 v56, v56, v60
    v_mfma_f32_16x16x32_bf16 v[76:79], v[108:111], v[176:179], v[76:79]
    buffer_load_dwordx4 v[176:179], v9, s[12:15], s49 offen offset:0 sc1
    buffer_load_dwordx4 v18, s[28:31], s21 offen offset:2048  lds
    v_mfma_f32_16x16x32_bf16 v[80:83], v[96:99], v[180:183], v[80:83]
    v_mul_f32 v57, v57, v60
    v_mfma_f32_16x16x32_bf16 v[84:87], v[100:103], v[180:183], v[84:87]
    v_cvt_pk_bf16_f32 v56, v56, v57
    v_mfma_f32_16x16x32_bf16 v[88:91], v[104:107], v[180:183], v[88:91]
    v_and_b32 v59, s53, v58
    v_mfma_f32_16x16x32_bf16 v[92:95], v[108:111], v[180:183], v[92:95]
    buffer_load_dwordx4 v[180:183], v9, s[12:15], s49 offen offset:1024 sc1
    s_waitcnt vmcnt(45) lgkmcnt(0)
    s_barrier
    ds_read_b128 v[96:99], v20 offset:0
    ds_read_b128 v[100:103], v20 offset:2048
    ds_read_b128 v[104:107], v20 offset:4096
    ds_read_b128 v[108:111], v20 offset:6144
    s_waitcnt vmcnt(21)
    v_mfma_f32_16x16x32_bf16 v[64:67], v[112:115], v[184:187], v[64:67]
    v_lshlrev_b32 v58, 16, v58
    v_mfma_f32_16x16x32_bf16 v[68:71], v[116:119], v[184:187], v[68:71]
    v_and_b32 v57, s53, v56
    v_mfma_f32_16x16x32_bf16 v[72:75], v[120:123], v[184:187], v[72:75]
    v_lshlrev_b32 v56, 16, v56
    v_mfma_f32_16x16x32_bf16 v[76:79], v[124:127], v[184:187], v[76:79]
    buffer_load_dwordx4 v[184:187], v9, s[12:15], s49 offen offset:2048 sc1
    buffer_load_dwordx4 v19, s[28:31], s21 offen offset:3072  lds
    v_mfma_f32_16x16x32_bf16 v[80:83], v[112:115], v[188:191], v[80:83]
    v_fma_f32 v136, v46, v58, v56
    v_mfma_f32_16x16x32_bf16 v[84:87], v[116:119], v[188:191], v[84:87]
    v_fma_f32 v137, v46, v59, v57
    v_mfma_f32_16x16x32_bf16 v[88:91], v[120:123], v[188:191], v[88:91]
    v_lshlrev_b32 v56, 16, v33
    v_mfma_f32_16x16x32_bf16 v[92:95], v[124:127], v[188:191], v[92:95]
    buffer_load_dwordx4 v[188:191], v9, s[12:15], s49 offen offset:3072 sc1
    ds_read_b128 v[112:115], v21 offset:0
    ds_read_b128 v[116:119], v21 offset:2048
    ds_read_b128 v[120:123], v21 offset:4096
    ds_read_b128 v[124:127], v21 offset:6144
    s_waitcnt vmcnt(21) lgkmcnt(4)
    v_mfma_f32_16x16x32_bf16 v[64:67], v[96:99], v[192:195], v[64:67]
    v_and_b32 v57, s53, v33
    v_mfma_f32_16x16x32_bf16 v[68:71], v[100:103], v[192:195], v[68:71]
    v_mul_f32 v58, v56, v54
    v_mfma_f32_16x16x32_bf16 v[72:75], v[104:107], v[192:195], v[72:75]
    v_mul_f32 v59, v57, v55
    v_mfma_f32_16x16x32_bf16 v[76:79], v[108:111], v[192:195], v[76:79]
    s_add_u32 s49, s55, 9
    s_and_b32 s49, s49, 15
    s_lshl_b32 s49, s49, 15
    s_add_u32 s49, s49, s50
    buffer_load_dwordx4 v[192:195], v8, s[12:15], s49 offen offset:0 sc1
    s_add_u32 m0, s23, 81920
    s_add_u32 s21, s55, 12
    s_and_b32 s21, s21, 15
    s_lshl_b32 s21, s21, 7
    buffer_load_dwordx4 v16, s[28:31], s21 offen offset:0  lds
    v_mfma_f32_16x16x32_bf16 v[80:83], v[96:99], v[196:199], v[80:83]
    v_cvt_pk_bf16_f32 v58, v58, v59
    v_mfma_f32_16x16x32_bf16 v[84:87], v[100:103], v[196:199], v[84:87]
    v_mul_f32 v56, v56, v60
    v_mfma_f32_16x16x32_bf16 v[88:91], v[104:107], v[196:199], v[88:91]
    v_mul_f32 v57, v57, v60
    v_mfma_f32_16x16x32_bf16 v[92:95], v[108:111], v[196:199], v[92:95]
    buffer_load_dwordx4 v[196:199], v8, s[12:15], s49 offen offset:1024 sc1
    ds_read_b128 v[96:99], v20 offset:8192
    ds_read_b128 v[100:103], v20 offset:10240
    ds_read_b128 v[104:107], v20 offset:12288
    ds_read_b128 v[108:111], v20 offset:14336
    s_waitcnt vmcnt(21) lgkmcnt(4)
    v_mfma_f32_16x16x32_bf16 v[64:67], v[112:115], v[200:203], v[64:67]
    v_cvt_pk_bf16_f32 v56, v56, v57
    v_mfma_f32_16x16x32_bf16 v[68:71], v[116:119], v[200:203], v[68:71]
    v_and_b32 v59, s53, v58
    v_mfma_f32_16x16x32_bf16 v[72:75], v[120:123], v[200:203], v[72:75]
    v_lshlrev_b32 v58, 16, v58
    v_mfma_f32_16x16x32_bf16 v[76:79], v[124:127], v[200:203], v[76:79]
    buffer_load_dwordx4 v[200:203], v8, s[12:15], s49 offen offset:2048 sc1
    buffer_load_dwordx4 v17, s[28:31], s21 offen offset:1024  lds
    v_mfma_f32_16x16x32_bf16 v[80:83], v[112:115], v[204:207], v[80:83]
    v_and_b32 v57, s53, v56
    v_mfma_f32_16x16x32_bf16 v[84:87], v[116:119], v[204:207], v[84:87]
    v_lshlrev_b32 v56, 16, v56
    v_mfma_f32_16x16x32_bf16 v[88:91], v[120:123], v[204:207], v[88:91]
    v_fma_f32 v138, v46, v58, v56
    v_mfma_f32_16x16x32_bf16 v[92:95], v[124:127], v[204:207], v[92:95]
    buffer_load_dwordx4 v[204:207], v8, s[12:15], s49 offen offset:3072 sc1
    ds_read_b128 v[112:115], v21 offset:8192
    ds_read_b128 v[116:119], v21 offset:10240
    ds_read_b128 v[120:123], v21 offset:12288
    ds_read_b128 v[124:127], v21 offset:14336
    s_waitcnt vmcnt(21) lgkmcnt(4)
    v_mfma_f32_16x16x32_bf16 v[64:67], v[96:99], v[208:211], v[64:67]
    v_fma_f32 v139, v46, v59, v57
    v_mfma_f32_16x16x32_bf16 v[68:71], v[100:103], v[208:211], v[68:71]
    v_sub_f32 v60, 1.0, v47
    v_mfma_f32_16x16x32_bf16 v[72:75], v[104:107], v[208:211], v[72:75]
    v_cvt_pk_bf16_f32 v60, v60, v60
    v_mfma_f32_16x16x32_bf16 v[76:79], v[108:111], v[208:211], v[76:79]
    buffer_load_dwordx4 v[208:211], v9, s[12:15], s49 offen offset:0 sc1
    buffer_load_dwordx4 v18, s[28:31], s21 offen offset:2048  lds
    v_mfma_f32_16x16x32_bf16 v[80:83], v[96:99], v[212:215], v[80:83]
    v_lshlrev_b32 v60, 16, v60
    v_mfma_f32_16x16x32_bf16 v[84:87], v[100:103], v[212:215], v[84:87]
    v_lshlrev_b32 v56, 16, v34
    v_mfma_f32_16x16x32_bf16 v[88:91], v[104:107], v[212:215], v[88:91]
    v_and_b32 v57, s53, v34
    v_mfma_f32_16x16x32_bf16 v[92:95], v[108:111], v[212:215], v[92:95]
    buffer_load_dwordx4 v[212:215], v9, s[12:15], s49 offen offset:1024 sc1
    s_waitcnt vmcnt(46) lgkmcnt(0)
    s_barrier
    ds_read_b128 v[96:99], v20 offset:16384
    ds_read_b128 v[100:103], v20 offset:18432
    ds_read_b128 v[104:107], v20 offset:20480
    ds_read_b128 v[108:111], v20 offset:22528
    s_waitcnt vmcnt(21)
    v_mfma_f32_16x16x32_bf16 v[64:67], v[112:115], v[216:219], v[64:67]
    v_mul_f32 v58, v56, v52
    v_mfma_f32_16x16x32_bf16 v[68:71], v[116:119], v[216:219], v[68:71]
    v_mul_f32 v59, v57, v53
    v_mfma_f32_16x16x32_bf16 v[72:75], v[120:123], v[216:219], v[72:75]
    v_cvt_pk_bf16_f32 v58, v58, v59
    v_mfma_f32_16x16x32_bf16 v[76:79], v[124:127], v[216:219], v[76:79]
    buffer_load_dwordx4 v[216:219], v9, s[12:15], s49 offen offset:2048 sc1
    buffer_load_dwordx4 v19, s[28:31], s21 offen offset:3072  lds
    v_mfma_f32_16x16x32_bf16 v[80:83], v[112:115], v[220:223], v[80:83]
    v_mul_f32 v56, v56, v60
    v_mfma_f32_16x16x32_bf16 v[84:87], v[116:119], v[220:223], v[84:87]
    v_mul_f32 v57, v57, v60
    v_mfma_f32_16x16x32_bf16 v[88:91], v[120:123], v[220:223], v[88:91]
    v_cvt_pk_bf16_f32 v56, v56, v57
    v_mfma_f32_16x16x32_bf16 v[92:95], v[124:127], v[220:223], v[92:95]
    buffer_load_dwordx4 v[220:223], v9, s[12:15], s49 offen offset:3072 sc1
    ds_read_b128 v[112:115], v21 offset:16384
    ds_read_b128 v[116:119], v21 offset:18432
    ds_read_b128 v[120:123], v21 offset:20480
    ds_read_b128 v[124:127], v21 offset:22528
    s_waitcnt vmcnt(21) lgkmcnt(4)
    v_mfma_f32_16x16x32_bf16 v[64:67], v[96:99], v[160:163], v[64:67]
    v_and_b32 v59, s53, v58
    v_mfma_f32_16x16x32_bf16 v[68:71], v[100:103], v[160:163], v[68:71]
    v_lshlrev_b32 v58, 16, v58
    v_mfma_f32_16x16x32_bf16 v[72:75], v[104:107], v[160:163], v[72:75]
    v_and_b32 v57, s53, v56
    v_mfma_f32_16x16x32_bf16 v[76:79], v[108:111], v[160:163], v[76:79]
    s_add_u32 s49, s55, 10
    s_and_b32 s49, s49, 15
    s_lshl_b32 s49, s49, 15
    s_add_u32 s49, s49, s50
    buffer_load_dwordx4 v[160:163], v8, s[12:15], s49 offen offset:0 sc1
    s_add_u32 m0, s23, 0
    s_add_u32 s21, s55, 13
    s_and_b32 s21, s21, 15
    s_lshl_b32 s21, s21, 7
    buffer_load_dwordx4 v16, s[28:31], s21 offen offset:0  lds
    v_mfma_f32_16x16x32_bf16 v[80:83], v[96:99], v[164:167], v[80:83]
    v_lshlrev_b32 v56, 16, v56
    v_mfma_f32_16x16x32_bf16 v[84:87], v[100:103], v[164:167], v[84:87]
    v_fma_f32 v140, v47, v58, v56
    v_mfma_f32_16x16x32_bf16 v[88:91], v[104:107], v[164:167], v[88:91]
    v_fma_f32 v141, v47, v59, v57
    v_mfma_f32_16x16x32_bf16 v[92:95], v[108:111], v[164:167], v[92:95]
    buffer_load_dwordx4 v[164:167], v8, s[12:15], s49 offen offset:1024 sc1
    ds_read_b128 v[96:99], v20 offset:24576
    ds_read_b128 v[100:103], v20 offset:26624
    ds_read_b128 v[104:107], v20 offset:28672
    ds_read_b128 v[108:111], v20 offset:30720
    s_waitcnt vmcnt(21) lgkmcnt(4)
    v_mfma_f32_16x16x32_bf16 v[64:67], v[112:115], v[168:171], v[64:67]
    v_lshlrev_b32 v56, 16, v35
    v_mfma_f32_16x16x32_bf16 v[68:71], v[116:119], v[168:171], v[68:71]
    v_and_b32 v57, s53, v35
    v_mfma_f32_16x16x32_bf16 v[72:75], v[120:123], v[168:171], v[72:75]
    v_mul_f32 v58, v56, v54
    v_mfma_f32_16x16x32_bf16 v[76:79], v[124:127], v[168:171], v[76:79]
    buffer_load_dwordx4 v[168:171], v8, s[12:15], s49 offen offset:2048 sc1
    buffer_load_dwordx4 v17, s[28:31], s21 offen offset:1024  lds
    v_mfma_f32_16x16x32_bf16 v[80:83], v[112:115], v[172:175], v[80:83]
    v_mul_f32 v59, v57, v55
    v_mfma_f32_16x16x32_bf16 v[84:87], v[116:119], v[172:175], v[84:87]
    v_cvt_pk_bf16_f32 v58, v58, v59
    v_mfma_f32_16x16x32_bf16 v[88:91], v[120:123], v[172:175], v[88:91]
    v_mul_f32 v56, v56, v60
    v_mfma_f32_16x16x32_bf16 v[92:95], v[124:127], v[172:175], v[92:95]
    buffer_load_dwordx4 v[172:175], v8, s[12:15], s49 offen offset:3072 sc1
    ds_read_b128 v[112:115], v21 offset:24576
    ds_read_b128 v[116:119], v21 offset:26624
    ds_read_b128 v[120:123], v21 offset:28672
    ds_read_b128 v[124:127], v21 offset:30720
    s_waitcnt vmcnt(21) lgkmcnt(4)
    v_mfma_f32_16x16x32_bf16 v[64:67], v[96:99], v[176:179], v[64:67]
    v_mul_f32 v57, v57, v60
    v_mfma_f32_16x16x32_bf16 v[68:71], v[100:103], v[176:179], v[68:71]
    v_cvt_pk_bf16_f32 v56, v56, v57
    v_mfma_f32_16x16x32_bf16 v[72:75], v[104:107], v[176:179], v[72:75]
    v_and_b32 v59, s53, v58
    v_mfma_f32_16x16x32_bf16 v[76:79], v[108:111], v[176:179], v[76:79]
    buffer_load_dwordx4 v[176:179], v9, s[12:15], s49 offen offset:0 sc1
    buffer_load_dwordx4 v18, s[28:31], s21 offen offset:2048  lds
    v_mfma_f32_16x16x32_bf16 v[80:83], v[96:99], v[180:183], v[80:83]
    v_lshlrev_b32 v58, 16, v58
    v_mfma_f32_16x16x32_bf16 v[84:87], v[100:103], v[180:183], v[84:87]
    v_and_b32 v57, s53, v56
    v_mfma_f32_16x16x32_bf16 v[88:91], v[104:107], v[180:183], v[88:91]
    v_lshlrev_b32 v56, 16, v56
    v_mfma_f32_16x16x32_bf16 v[92:95], v[108:111], v[180:183], v[92:95]
    buffer_load_dwordx4 v[180:183], v9, s[12:15], s49 offen offset:1024 sc1
    s_waitcnt vmcnt(46) lgkmcnt(0)
    s_barrier
    ds_read_b128 v[96:99], v20 offset:32768
    ds_read_b128 v[100:103], v20 offset:34816
    ds_read_b128 v[104:107], v20 offset:36864
    ds_read_b128 v[108:111], v20 offset:38912
    s_waitcnt vmcnt(21)
    v_mfma_f32_16x16x32_bf16 v[64:67], v[112:115], v[184:187], v[64:67]
    v_fma_f32 v142, v47, v58, v56
    v_mfma_f32_16x16x32_bf16 v[68:71], v[116:119], v[184:187], v[68:71]
    v_fma_f32 v143, v47, v59, v57
    v_mfma_f32_16x16x32_bf16 v[72:75], v[120:123], v[184:187], v[72:75]
    v_sub_f32 v60, 1.0, v48
    v_mfma_f32_16x16x32_bf16 v[76:79], v[124:127], v[184:187], v[76:79]
    buffer_load_dwordx4 v[184:187], v9, s[12:15], s49 offen offset:2048 sc1
    buffer_load_dwordx4 v19, s[28:31], s21 offen offset:3072  lds
    v_mfma_f32_16x16x32_bf16 v[80:83], v[112:115], v[188:191], v[80:83]
    v_cvt_pk_bf16_f32 v60, v60, v60
    v_mfma_f32_16x16x32_bf16 v[84:87], v[116:119], v[188:191], v[84:87]
    v_lshlrev_b32 v60, 16, v60
    v_mfma_f32_16x16x32_bf16 v[88:91], v[120:123], v[188:191], v[88:91]
    v_lshlrev_b32 v56, 16, v36
    v_mfma_f32_16x16x32_bf16 v[92:95], v[124:127], v[188:191], v[92:95]
    buffer_load_dwordx4 v[188:191], v9, s[12:15], s49 offen offset:3072 sc1
    ds_read_b128 v[112:115], v21 offset:32768
    ds_read_b128 v[116:119], v21 offset:34816
    ds_read_b128 v[120:123], v21 offset:36864
    ds_read_b128 v[124:127], v21 offset:38912
    s_waitcnt vmcnt(21) lgkmcnt(4)
    v_mfma_f32_16x16x32_bf16 v[64:67], v[96:99], v[192:195], v[64:67]
    v_and_b32 v57, s53, v36
    v_mfma_f32_16x16x32_bf16 v[68:71], v[100:103], v[192:195], v[68:71]
    v_mul_f32 v58, v56, v52
    v_mfma_f32_16x16x32_bf16 v[72:75], v[104:107], v[192:195], v[72:75]
    v_mul_f32 v59, v57, v53
    v_mfma_f32_16x16x32_bf16 v[76:79], v[108:111], v[192:195], v[76:79]
    s_add_u32 s49, s55, 11
    s_and_b32 s49, s49, 15
    s_lshl_b32 s49, s49, 15
    s_add_u32 s49, s49, s50
    buffer_load_dwordx4 v[192:195], v8, s[12:15], s49 offen offset:0 sc1
    s_add_u32 m0, s23, 16384
    s_add_u32 s21, s55, 14
    s_and_b32 s21, s21, 15
    s_lshl_b32 s21, s21, 7
    buffer_load_dwordx4 v16, s[28:31], s21 offen offset:0  lds
    v_mfma_f32_16x16x32_bf16 v[80:83], v[96:99], v[196:199], v[80:83]
    v_cvt_pk_bf16_f32 v58, v58, v59
    v_mfma_f32_16x16x32_bf16 v[84:87], v[100:103], v[196:199], v[84:87]
    v_mul_f32 v56, v56, v60
    v_mfma_f32_16x16x32_bf16 v[88:91], v[104:107], v[196:199], v[88:91]
    v_mul_f32 v57, v57, v60
    v_mfma_f32_16x16x32_bf16 v[92:95], v[108:111], v[196:199], v[92:95]
    buffer_load_dwordx4 v[196:199], v8, s[12:15], s49 offen offset:1024 sc1
    ds_read_b128 v[96:99], v20 offset:40960
    ds_read_b128 v[100:103], v20 offset:43008
    ds_read_b128 v[104:107], v20 offset:45056
    ds_read_b128 v[108:111], v20 offset:47104
    s_waitcnt vmcnt(21) lgkmcnt(4)
    v_mfma_f32_16x16x32_bf16 v[64:67], v[112:115], v[200:203], v[64:67]
    v_cvt_pk_bf16_f32 v56, v56, v57
    v_mfma_f32_16x16x32_bf16 v[68:71], v[116:119], v[200:203], v[68:71]
    v_and_b32 v59, s53, v58
    v_mfma_f32_16x16x32_bf16 v[72:75], v[120:123], v[200:203], v[72:75]
    v_lshlrev_b32 v58, 16, v58
    v_mfma_f32_16x16x32_bf16 v[76:79], v[124:127], v[200:203], v[76:79]
    buffer_load_dwordx4 v[200:203], v8, s[12:15], s49 offen offset:2048 sc1
    buffer_load_dwordx4 v17, s[28:31], s21 offen offset:1024  lds
    v_mfma_f32_16x16x32_bf16 v[80:83], v[112:115], v[204:207], v[80:83]
    v_and_b32 v57, s53, v56
    v_mfma_f32_16x16x32_bf16 v[84:87], v[116:119], v[204:207], v[84:87]
    v_lshlrev_b32 v56, 16, v56
    v_mfma_f32_16x16x32_bf16 v[88:91], v[120:123], v[204:207], v[88:91]
    v_fma_f32 v144, v48, v58, v56
    v_mfma_f32_16x16x32_bf16 v[92:95], v[124:127], v[204:207], v[92:95]
    buffer_load_dwordx4 v[204:207], v8, s[12:15], s49 offen offset:3072 sc1
    ds_read_b128 v[112:115], v21 offset:40960
    ds_read_b128 v[116:119], v21 offset:43008
    ds_read_b128 v[120:123], v21 offset:45056
    ds_read_b128 v[124:127], v21 offset:47104
    s_waitcnt vmcnt(21) lgkmcnt(4)
    v_mfma_f32_16x16x32_bf16 v[64:67], v[96:99], v[208:211], v[64:67]
    v_fma_f32 v145, v48, v59, v57
    v_mfma_f32_16x16x32_bf16 v[68:71], v[100:103], v[208:211], v[68:71]
    v_lshlrev_b32 v56, 16, v37
    v_mfma_f32_16x16x32_bf16 v[72:75], v[104:107], v[208:211], v[72:75]
    v_and_b32 v57, s53, v37
    v_mfma_f32_16x16x32_bf16 v[76:79], v[108:111], v[208:211], v[76:79]
    buffer_load_dwordx4 v[208:211], v9, s[12:15], s49 offen offset:0 sc1
    buffer_load_dwordx4 v18, s[28:31], s21 offen offset:2048  lds
    v_mfma_f32_16x16x32_bf16 v[80:83], v[96:99], v[212:215], v[80:83]
    v_mul_f32 v58, v56, v54
    v_mfma_f32_16x16x32_bf16 v[84:87], v[100:103], v[212:215], v[84:87]
    v_mul_f32 v59, v57, v55
    v_mfma_f32_16x16x32_bf16 v[88:91], v[104:107], v[212:215], v[88:91]
    v_cvt_pk_bf16_f32 v58, v58, v59
    v_mfma_f32_16x16x32_bf16 v[92:95], v[108:111], v[212:215], v[92:95]
    buffer_load_dwordx4 v[212:215], v9, s[12:15], s49 offen offset:1024 sc1
    s_waitcnt vmcnt(46) lgkmcnt(0)
    s_barrier
    ds_read_b128 v[96:99], v20 offset:49152
    ds_read_b128 v[100:103], v20 offset:51200
    ds_read_b128 v[104:107], v20 offset:53248
    ds_read_b128 v[108:111], v20 offset:55296
    s_waitcnt vmcnt(21)
    v_mfma_f32_16x16x32_bf16 v[64:67], v[112:115], v[216:219], v[64:67]
    v_mul_f32 v56, v56, v60
    v_mfma_f32_16x16x32_bf16 v[68:71], v[116:119], v[216:219], v[68:71]
    v_mul_f32 v57, v57, v60
    v_mfma_f32_16x16x32_bf16 v[72:75], v[120:123], v[216:219], v[72:75]
    v_cvt_pk_bf16_f32 v56, v56, v57
    v_mfma_f32_16x16x32_bf16 v[76:79], v[124:127], v[216:219], v[76:79]
    buffer_load_dwordx4 v[216:219], v9, s[12:15], s49 offen offset:2048 sc1
    buffer_load_dwordx4 v19, s[28:31], s21 offen offset:3072  lds
    v_mfma_f32_16x16x32_bf16 v[80:83], v[112:115], v[220:223], v[80:83]
    v_and_b32 v59, s53, v58
    v_mfma_f32_16x16x32_bf16 v[84:87], v[116:119], v[220:223], v[84:87]
    v_lshlrev_b32 v58, 16, v58
    v_mfma_f32_16x16x32_bf16 v[88:91], v[120:123], v[220:223], v[88:91]
    v_and_b32 v57, s53, v56
    v_mfma_f32_16x16x32_bf16 v[92:95], v[124:127], v[220:223], v[92:95]
    buffer_load_dwordx4 v[220:223], v9, s[12:15], s49 offen offset:3072 sc1
    ds_read_b128 v[112:115], v21 offset:49152
    ds_read_b128 v[116:119], v21 offset:51200
    ds_read_b128 v[120:123], v21 offset:53248
    ds_read_b128 v[124:127], v21 offset:55296
    s_waitcnt vmcnt(21) lgkmcnt(4)
    v_mfma_f32_16x16x32_bf16 v[64:67], v[96:99], v[160:163], v[64:67]
    v_lshlrev_b32 v56, 16, v56
    v_mfma_f32_16x16x32_bf16 v[68:71], v[100:103], v[160:163], v[68:71]
    v_fma_f32 v146, v48, v58, v56
    v_mfma_f32_16x16x32_bf16 v[72:75], v[104:107], v[160:163], v[72:75]
    v_fma_f32 v147, v48, v59, v57
    v_mfma_f32_16x16x32_bf16 v[76:79], v[108:111], v[160:163], v[76:79]
    s_add_u32 s49, s55, 12
    s_and_b32 s49, s49, 15
    s_lshl_b32 s49, s49, 15
    s_add_u32 s49, s49, s50
    buffer_load_dwordx4 v[160:163], v8, s[12:15], s49 offen offset:0 sc1
    s_add_u32 m0, s23, 32768
    s_add_u32 s21, s55, 15
    s_and_b32 s21, s21, 15
    s_lshl_b32 s21, s21, 7
    buffer_load_dwordx4 v16, s[28:31], s21 offen offset:0  lds
    v_mfma_f32_16x16x32_bf16 v[80:83], v[96:99], v[164:167], v[80:83]
    v_sub_f32 v60, 1.0, v49
    v_mfma_f32_16x16x32_bf16 v[84:87], v[100:103], v[164:167], v[84:87]
    v_cvt_pk_bf16_f32 v60, v60, v60
    v_mfma_f32_16x16x32_bf16 v[88:91], v[104:107], v[164:167], v[88:91]
    v_lshlrev_b32 v60, 16, v60
    v_mfma_f32_16x16x32_bf16 v[92:95], v[108:111], v[164:167], v[92:95]
    buffer_load_dwordx4 v[164:167], v8, s[12:15], s49 offen offset:1024 sc1
    ds_read_b128 v[96:99], v20 offset:57344
    ds_read_b128 v[100:103], v20 offset:59392
    ds_read_b128 v[104:107], v20 offset:61440
    ds_read_b128 v[108:111], v20 offset:63488
    s_waitcnt vmcnt(21) lgkmcnt(4)
    v_mfma_f32_16x16x32_bf16 v[64:67], v[112:115], v[168:171], v[64:67]
    v_lshlrev_b32 v56, 16, v38
    v_mfma_f32_16x16x32_bf16 v[68:71], v[116:119], v[168:171], v[68:71]
    v_and_b32 v57, s53, v38
    v_mfma_f32_16x16x32_bf16 v[72:75], v[120:123], v[168:171], v[72:75]
    v_mul_f32 v58, v56, v52
    v_mfma_f32_16x16x32_bf16 v[76:79], v[124:127], v[168:171], v[76:79]
    buffer_load_dwordx4 v[168:171], v8, s[12:15], s49 offen offset:2048 sc1
    buffer_load_dwordx4 v17, s[28:31], s21 offen offset:1024  lds
    v_mfma_f32_16x16x32_bf16 v[80:83], v[112:115], v[172:175], v[80:83]
    v_mul_f32 v59, v57, v53
    v_mfma_f32_16x16x32_bf16 v[84:87], v[116:119], v[172:175], v[84:87]
    v_cvt_pk_bf16_f32 v58, v58, v59
    v_mfma_f32_16x16x32_bf16 v[88:91], v[120:123], v[172:175], v[88:91]
    v_mul_f32 v56, v56, v60
    v_mfma_f32_16x16x32_bf16 v[92:95], v[124:127], v[172:175], v[92:95]
    buffer_load_dwordx4 v[172:175], v8, s[12:15], s49 offen offset:3072 sc1
    ds_read_b128 v[112:115], v21 offset:57344
    ds_read_b128 v[116:119], v21 offset:59392
    ds_read_b128 v[120:123], v21 offset:61440
    ds_read_b128 v[124:127], v21 offset:63488
    s_waitcnt vmcnt(21) lgkmcnt(4)
    v_mfma_f32_16x16x32_bf16 v[64:67], v[96:99], v[176:179], v[64:67]
    v_mul_f32 v57, v57, v60
    v_mfma_f32_16x16x32_bf16 v[68:71], v[100:103], v[176:179], v[68:71]
    v_cvt_pk_bf16_f32 v56, v56, v57
    v_mfma_f32_16x16x32_bf16 v[72:75], v[104:107], v[176:179], v[72:75]
    v_and_b32 v59, s53, v58
    v_mfma_f32_16x16x32_bf16 v[76:79], v[108:111], v[176:179], v[76:79]
    buffer_load_dwordx4 v[176:179], v9, s[12:15], s49 offen offset:0 sc1
    buffer_load_dwordx4 v18, s[28:31], s21 offen offset:2048  lds
    v_mfma_f32_16x16x32_bf16 v[80:83], v[96:99], v[180:183], v[80:83]
    v_lshlrev_b32 v58, 16, v58
    v_mfma_f32_16x16x32_bf16 v[84:87], v[100:103], v[180:183], v[84:87]
    v_and_b32 v57, s53, v56
    v_mfma_f32_16x16x32_bf16 v[88:91], v[104:107], v[180:183], v[88:91]
    v_lshlrev_b32 v56, 16, v56
    v_mfma_f32_16x16x32_bf16 v[92:95], v[108:111], v[180:183], v[92:95]
    buffer_load_dwordx4 v[180:183], v9, s[12:15], s49 offen offset:1024 sc1
    s_waitcnt vmcnt(46) lgkmcnt(0)
    s_barrier
    ds_read_b128 v[96:99], v22 offset:0
    ds_read_b128 v[100:103], v22 offset:2048
    ds_read_b128 v[104:107], v22 offset:4096
    ds_read_b128 v[108:111], v22 offset:6144
    s_waitcnt vmcnt(21)
    v_mfma_f32_16x16x32_bf16 v[64:67], v[112:115], v[184:187], v[64:67]
    v_fma_f32 v148, v49, v58, v56
    v_mfma_f32_16x16x32_bf16 v[68:71], v[116:119], v[184:187], v[68:71]
    v_fma_f32 v149, v49, v59, v57
    v_mfma_f32_16x16x32_bf16 v[72:75], v[120:123], v[184:187], v[72:75]
    v_lshlrev_b32 v56, 16, v39
    v_mfma_f32_16x16x32_bf16 v[76:79], v[124:127], v[184:187], v[76:79]
    buffer_load_dwordx4 v[184:187], v9, s[12:15], s49 offen offset:2048 sc1
    buffer_load_dwordx4 v19, s[28:31], s21 offen offset:3072  lds
    v_mfma_f32_16x16x32_bf16 v[80:83], v[112:115], v[188:191], v[80:83]
    v_and_b32 v57, s53, v39
    v_mfma_f32_16x16x32_bf16 v[84:87], v[116:119], v[188:191], v[84:87]
    v_mul_f32 v58, v56, v54
    v_mfma_f32_16x16x32_bf16 v[88:91], v[120:123], v[188:191], v[88:91]
    v_mul_f32 v59, v57, v55
    v_mfma_f32_16x16x32_bf16 v[92:95], v[124:127], v[188:191], v[92:95]
    buffer_load_dwordx4 v[188:191], v9, s[12:15], s49 offen offset:3072 sc1
    ds_read_b128 v[112:115], v23 offset:0
    ds_read_b128 v[116:119], v23 offset:2048
    ds_read_b128 v[120:123], v23 offset:4096
    ds_read_b128 v[124:127], v23 offset:6144
    s_waitcnt vmcnt(21) lgkmcnt(4)
    v_mfma_f32_16x16x32_bf16 v[64:67], v[96:99], v[192:195], v[64:67]
    v_cvt_pk_bf16_f32 v58, v58, v59
    v_mfma_f32_16x16x32_bf16 v[68:71], v[100:103], v[192:195], v[68:71]
    v_mul_f32 v56, v56, v60
    v_mfma_f32_16x16x32_bf16 v[72:75], v[104:107], v[192:195], v[72:75]
    v_mul_f32 v57, v57, v60
    v_mfma_f32_16x16x32_bf16 v[76:79], v[108:111], v[192:195], v[76:79]
    s_add_u32 s49, s55, 13
    s_and_b32 s49, s49, 15
    s_lshl_b32 s49, s49, 15
    s_add_u32 s49, s49, s50
    buffer_load_dwordx4 v[192:195], v8, s[12:15], s49 offen offset:0 sc1
    v_mfma_f32_16x16x32_bf16 v[80:83], v[96:99], v[196:199], v[80:83]
    v_cvt_pk_bf16_f32 v56, v56, v57
    v_mfma_f32_16x16x32_bf16 v[84:87], v[100:103], v[196:199], v[84:87]
    v_and_b32 v59, s53, v58
    v_mfma_f32_16x16x32_bf16 v[88:91], v[104:107], v[196:199], v[88:91]
    v_lshlrev_b32 v58, 16, v58
    v_mfma_f32_16x16x32_bf16 v[92:95], v[108:111], v[196:199], v[92:95]
    buffer_load_dwordx4 v[196:199], v8, s[12:15], s49 offen offset:1024 sc1
    ds_read_b128 v[96:99], v22 offset:8192
    ds_read_b128 v[100:103], v22 offset:10240
    ds_read_b128 v[104:107], v22 offset:12288
    ds_read_b128 v[108:111], v22 offset:14336
    s_waitcnt vmcnt(20) lgkmcnt(4)
    v_mfma_f32_16x16x32_bf16 v[64:67], v[112:115], v[200:203], v[64:67]
    v_and_b32 v57, s53, v56
    v_mfma_f32_16x16x32_bf16 v[68:71], v[116:119], v[200:203], v[68:71]
    v_lshlrev_b32 v56, 16, v56
    v_mfma_f32_16x16x32_bf16 v[72:75], v[120:123], v[200:203], v[72:75]
    v_fma_f32 v150, v49, v58, v56
    v_mfma_f32_16x16x32_bf16 v[76:79], v[124:127], v[200:203], v[76:79]
    buffer_load_dwordx4 v[200:203], v8, s[12:15], s49 offen offset:2048 sc1
    v_mfma_f32_16x16x32_bf16 v[80:83], v[112:115], v[204:207], v[80:83]
    v_fma_f32 v151, v49, v59, v57
    v_mfma_f32_16x16x32_bf16 v[84:87], v[116:119], v[204:207], v[84:87]
    v_sub_f32 v60, 1.0, v50
    v_mfma_f32_16x16x32_bf16 v[88:91], v[120:123], v[204:207], v[88:91]
    v_cvt_pk_bf16_f32 v60, v60, v60
    v_mfma_f32_16x16x32_bf16 v[92:95], v[124:127], v[204:207], v[92:95]
    buffer_load_dwordx4 v[204:207], v8, s[12:15], s49 offen offset:3072 sc1
    ds_read_b128 v[112:115], v23 offset:8192
    ds_read_b128 v[116:119], v23 offset:10240
    ds_read_b128 v[120:123], v23 offset:12288
    ds_read_b128 v[124:127], v23 offset:14336
    s_waitcnt vmcnt(19) lgkmcnt(4)
    v_mfma_f32_16x16x32_bf16 v[64:67], v[96:99], v[208:211], v[64:67]
    v_lshlrev_b32 v60, 16, v60
    v_mfma_f32_16x16x32_bf16 v[68:71], v[100:103], v[208:211], v[68:71]
    v_lshlrev_b32 v56, 16, v40
    v_mfma_f32_16x16x32_bf16 v[72:75], v[104:107], v[208:211], v[72:75]
    v_and_b32 v57, s53, v40
    v_mfma_f32_16x16x32_bf16 v[76:79], v[108:111], v[208:211], v[76:79]
    buffer_load_dwordx4 v[208:211], v9, s[12:15], s49 offen offset:0 sc1
    v_mfma_f32_16x16x32_bf16 v[80:83], v[96:99], v[212:215], v[80:83]
    v_mul_f32 v58, v56, v52
    v_mfma_f32_16x16x32_bf16 v[84:87], v[100:103], v[212:215], v[84:87]
    v_mul_f32 v59, v57, v53
    v_mfma_f32_16x16x32_bf16 v[88:91], v[104:107], v[212:215], v[88:91]
    v_cvt_pk_bf16_f32 v58, v58, v59
    v_mfma_f32_16x16x32_bf16 v[92:95], v[108:111], v[212:215], v[92:95]
    buffer_load_dwordx4 v[212:215], v9, s[12:15], s49 offen offset:1024 sc1
    s_waitcnt vmcnt(43) lgkmcnt(0)
    s_barrier
    ds_read_b128 v[96:99], v22 offset:16384
    ds_read_b128 v[100:103], v22 offset:18432
    ds_read_b128 v[104:107], v22 offset:20480
    ds_read_b128 v[108:111], v22 offset:22528
    s_waitcnt vmcnt(18)
    v_mfma_f32_16x16x32_bf16 v[64:67], v[112:115], v[216:219], v[64:67]
    v_mul_f32 v56, v56, v60
    v_mfma_f32_16x16x32_bf16 v[68:71], v[116:119], v[216:219], v[68:71]
    v_mul_f32 v57, v57, v60
    v_mfma_f32_16x16x32_bf16 v[72:75], v[120:123], v[216:219], v[72:75]
    v_cvt_pk_bf16_f32 v56, v56, v57
    v_mfma_f32_16x16x32_bf16 v[76:79], v[124:127], v[216:219], v[76:79]
    buffer_load_dwordx4 v[216:219], v9, s[12:15], s49 offen offset:2048 sc1
    v_mfma_f32_16x16x32_bf16 v[80:83], v[112:115], v[220:223], v[80:83]
    v_and_b32 v59, s53, v58
    v_mfma_f32_16x16x32_bf16 v[84:87], v[116:119], v[220:223], v[84:87]
    v_lshlrev_b32 v58, 16, v58
    v_mfma_f32_16x16x32_bf16 v[88:91], v[120:123], v[220:223], v[88:91]
    v_and_b32 v57, s53, v56
    v_mfma_f32_16x16x32_bf16 v[92:95], v[124:127], v[220:223], v[92:95]
    buffer_load_dwordx4 v[220:223], v9, s[12:15], s49 offen offset:3072 sc1
    ds_read_b128 v[112:115], v23 offset:16384
    ds_read_b128 v[116:119], v23 offset:18432
    ds_read_b128 v[120:123], v23 offset:20480
    ds_read_b128 v[124:127], v23 offset:22528
    s_waitcnt vmcnt(17) lgkmcnt(4)
    v_mfma_f32_16x16x32_bf16 v[64:67], v[96:99], v[160:163], v[64:67]
    v_lshlrev_b32 v56, 16, v56
    v_mfma_f32_16x16x32_bf16 v[68:71], v[100:103], v[160:163], v[68:71]
    v_fma_f32 v152, v50, v58, v56
    v_mfma_f32_16x16x32_bf16 v[72:75], v[104:107], v[160:163], v[72:75]
    v_fma_f32 v153, v50, v59, v57
    v_mfma_f32_16x16x32_bf16 v[76:79], v[108:111], v[160:163], v[76:79]
    s_add_u32 s49, s55, 14
    s_and_b32 s49, s49, 15
    s_lshl_b32 s49, s49, 15
    s_add_u32 s49, s49, s50
    buffer_load_dwordx4 v[160:163], v8, s[12:15], s49 offen offset:0 sc1
    v_mfma_f32_16x16x32_bf16 v[80:83], v[96:99], v[164:167], v[80:83]
    v_lshlrev_b32 v56, 16, v41
    v_mfma_f32_16x16x32_bf16 v[84:87], v[100:103], v[164:167], v[84:87]
    v_and_b32 v57, s53, v41
    v_mfma_f32_16x16x32_bf16 v[88:91], v[104:107], v[164:167], v[88:91]
    v_mul_f32 v58, v56, v54
    v_mfma_f32_16x16x32_bf16 v[92:95], v[108:111], v[164:167], v[92:95]
    buffer_load_dwordx4 v[164:167], v8, s[12:15], s49 offen offset:1024 sc1
    ds_read_b128 v[96:99], v22 offset:24576
    ds_read_b128 v[100:103], v22 offset:26624
    ds_read_b128 v[104:107], v22 offset:28672
    ds_read_b128 v[108:111], v22 offset:30720
    s_waitcnt vmcnt(16) lgkmcnt(4)
    v_mfma_f32_16x16x32_bf16 v[64:67], v[112:115], v[168:171], v[64:67]
    v_mul_f32 v59, v57, v55
    v_mfma_f32_16x16x32_bf16 v[68:71], v[116:119], v[168:171], v[68:71]
    v_cvt_pk_bf16_f32 v58, v58, v59
    v_mfma_f32_16x16x32_bf16 v[72:75], v[120:123], v[168:171], v[72:75]
    v_mul_f32 v56, v56, v60
    v_mfma_f32_16x16x32_bf16 v[76:79], v[124:127], v[168:171], v[76:79]
    buffer_load_dwordx4 v[168:171], v8, s[12:15], s49 offen offset:2048 sc1
    v_mfma_f32_16x16x32_bf16 v[80:83], v[112:115], v[172:175], v[80:83]
    v_mul_f32 v57, v57, v60
    v_mfma_f32_16x16x32_bf16 v[84:87], v[116:119], v[172:175], v[84:87]
    v_cvt_pk_bf16_f32 v56, v56, v57
    v_mfma_f32_16x16x32_bf16 v[88:91], v[120:123], v[172:175], v[88:91]
    v_and_b32 v59, s53, v58
    v_mfma_f32_16x16x32_bf16 v[92:95], v[124:127], v[172:175], v[92:95]
    buffer_load_dwordx4 v[172:175], v8, s[12:15], s49 offen offset:3072 sc1
    ds_read_b128 v[112:115], v23 offset:24576
    ds_read_b128 v[116:119], v23 offset:26624
    ds_read_b128 v[120:123], v23 offset:28672
    ds_read_b128 v[124:127], v23 offset:30720
    s_waitcnt vmcnt(15) lgkmcnt(4)
    v_mfma_f32_16x16x32_bf16 v[64:67], v[96:99], v[176:179], v[64:67]
    v_lshlrev_b32 v58, 16, v58
    v_mfma_f32_16x16x32_bf16 v[68:71], v[100:103], v[176:179], v[68:71]
    v_and_b32 v57, s53, v56
    v_mfma_f32_16x16x32_bf16 v[72:75], v[104:107], v[176:179], v[72:75]
    v_lshlrev_b32 v56, 16, v56
    v_mfma_f32_16x16x32_bf16 v[76:79], v[108:111], v[176:179], v[76:79]
    buffer_load_dwordx4 v[176:179], v9, s[12:15], s49 offen offset:0 sc1
    v_mfma_f32_16x16x32_bf16 v[80:83], v[96:99], v[180:183], v[80:83]
    v_fma_f32 v154, v50, v58, v56
    v_mfma_f32_16x16x32_bf16 v[84:87], v[100:103], v[180:183], v[84:87]
    v_fma_f32 v155, v50, v59, v57
    v_mfma_f32_16x16x32_bf16 v[88:91], v[104:107], v[180:183], v[88:91]
    v_sub_f32 v60, 1.0, v51
    v_mfma_f32_16x16x32_bf16 v[92:95], v[108:111], v[180:183], v[92:95]
    buffer_load_dwordx4 v[180:183], v9, s[12:15], s49 offen offset:1024 sc1
    s_waitcnt vmcnt(39) lgkmcnt(0)
    s_barrier
    ds_read_b128 v[96:99], v20 offset:0
    ds_read_b128 v[100:103], v20 offset:2048
    ds_read_b128 v[104:107], v20 offset:4096
    ds_read_b128 v[108:111], v20 offset:6144
    s_waitcnt vmcnt(14)
    v_mfma_f32_16x16x32_bf16 v[64:67], v[112:115], v[184:187], v[64:67]
    v_cvt_pk_bf16_f32 v60, v60, v60
    v_mfma_f32_16x16x32_bf16 v[68:71], v[116:119], v[184:187], v[68:71]
    v_lshlrev_b32 v60, 16, v60
    v_mfma_f32_16x16x32_bf16 v[72:75], v[120:123], v[184:187], v[72:75]
    v_lshlrev_b32 v56, 16, v42
    v_mfma_f32_16x16x32_bf16 v[76:79], v[124:127], v[184:187], v[76:79]
    buffer_load_dwordx4 v[184:187], v9, s[12:15], s49 offen offset:2048 sc1
    v_mfma_f32_16x16x32_bf16 v[80:83], v[112:115], v[188:191], v[80:83]
    v_and_b32 v57, s53, v42
    v_mfma_f32_16x16x32_bf16 v[84:87], v[116:119], v[188:191], v[84:87]
    v_mul_f32 v58, v56, v52
    v_mfma_f32_16x16x32_bf16 v[88:91], v[120:123], v[188:191], v[88:91]
    v_mul_f32 v59, v57, v53
    v_mfma_f32_16x16x32_bf16 v[92:95], v[124:127], v[188:191], v[92:95]
    buffer_load_dwordx4 v[188:191], v9, s[12:15], s49 offen offset:3072 sc1
    ds_read_b128 v[112:115], v21 offset:0
    ds_read_b128 v[116:119], v21 offset:2048
    ds_read_b128 v[120:123], v21 offset:4096
    ds_read_b128 v[124:127], v21 offset:6144
    s_waitcnt vmcnt(14) lgkmcnt(4)
    v_mfma_f32_16x16x32_bf16 v[64:67], v[96:99], v[192:195], v[64:67]
    v_cvt_pk_bf16_f32 v58, v58, v59
    v_mfma_f32_16x16x32_bf16 v[68:71], v[100:103], v[192:195], v[68:71]
    v_mul_f32 v56, v56, v60
    v_mfma_f32_16x16x32_bf16 v[72:75], v[104:107], v[192:195], v[72:75]
    v_mul_f32 v57, v57, v60
    v_mfma_f32_16x16x32_bf16 v[76:79], v[108:111], v[192:195], v[76:79]
    s_add_u32 s49, s55, 15
    s_and_b32 s49, s49, 15
    s_lshl_b32 s49, s49, 15
    s_add_u32 s49, s49, s50
    buffer_load_dwordx4 v[192:195], v8, s[12:15], s49 offen offset:0 sc1
    v_mfma_f32_16x16x32_bf16 v[80:83], v[96:99], v[196:199], v[80:83]
    v_cvt_pk_bf16_f32 v56, v56, v57
    v_mfma_f32_16x16x32_bf16 v[84:87], v[100:103], v[196:199], v[84:87]
    v_and_b32 v59, s53, v58
    v_mfma_f32_16x16x32_bf16 v[88:91], v[104:107], v[196:199], v[88:91]
    v_lshlrev_b32 v58, 16, v58
    v_mfma_f32_16x16x32_bf16 v[92:95], v[108:111], v[196:199], v[92:95]
    buffer_load_dwordx4 v[196:199], v8, s[12:15], s49 offen offset:1024 sc1
    ds_read_b128 v[96:99], v20 offset:8192
    ds_read_b128 v[100:103], v20 offset:10240
    ds_read_b128 v[104:107], v20 offset:12288
    ds_read_b128 v[108:111], v20 offset:14336
    s_waitcnt vmcnt(14) lgkmcnt(4)
    v_mfma_f32_16x16x32_bf16 v[64:67], v[112:115], v[200:203], v[64:67]
    v_and_b32 v57, s53, v56
    v_mfma_f32_16x16x32_bf16 v[68:71], v[116:119], v[200:203], v[68:71]
    v_lshlrev_b32 v56, 16, v56
    v_mfma_f32_16x16x32_bf16 v[72:75], v[120:123], v[200:203], v[72:75]
    v_fma_f32 v156, v51, v58, v56
    v_mfma_f32_16x16x32_bf16 v[76:79], v[124:127], v[200:203], v[76:79]
    buffer_load_dwordx4 v[200:203], v8, s[12:15], s49 offen offset:2048 sc1
    v_mfma_f32_16x16x32_bf16 v[80:83], v[112:115], v[204:207], v[80:83]
    v_fma_f32 v157, v51, v59, v57
    v_mfma_f32_16x16x32_bf16 v[84:87], v[116:119], v[204:207], v[84:87]
    v_lshlrev_b32 v56, 16, v43
    v_mfma_f32_16x16x32_bf16 v[88:91], v[120:123], v[204:207], v[88:91]
    v_and_b32 v57, s53, v43
    v_mfma_f32_16x16x32_bf16 v[92:95], v[124:127], v[204:207], v[92:95]
    buffer_load_dwordx4 v[204:207], v8, s[12:15], s49 offen offset:3072 sc1
    ds_read_b128 v[112:115], v21 offset:8192
    ds_read_b128 v[116:119], v21 offset:10240
    ds_read_b128 v[120:123], v21 offset:12288
    ds_read_b128 v[124:127], v21 offset:14336
    s_waitcnt vmcnt(14) lgkmcnt(4)
    v_mfma_f32_16x16x32_bf16 v[64:67], v[96:99], v[208:211], v[64:67]
    v_mul_f32 v58, v56, v54
    v_mfma_f32_16x16x32_bf16 v[68:71], v[100:103], v[208:211], v[68:71]
    v_mul_f32 v59, v57, v55
    v_mfma_f32_16x16x32_bf16 v[72:75], v[104:107], v[208:211], v[72:75]
    v_cvt_pk_bf16_f32 v58, v58, v59
    v_mfma_f32_16x16x32_bf16 v[76:79], v[108:111], v[208:211], v[76:79]
    buffer_load_dwordx4 v[208:211], v9, s[12:15], s49 offen offset:0 sc1
    v_mfma_f32_16x16x32_bf16 v[80:83], v[96:99], v[212:215], v[80:83]
    v_mul_f32 v56, v56, v60
    v_mfma_f32_16x16x32_bf16 v[84:87], v[100:103], v[212:215], v[84:87]
    v_mul_f32 v57, v57, v60
    v_mfma_f32_16x16x32_bf16 v[88:91], v[104:107], v[212:215], v[88:91]
    v_cvt_pk_bf16_f32 v56, v56, v57
    v_mfma_f32_16x16x32_bf16 v[92:95], v[108:111], v[212:215], v[92:95]
    buffer_load_dwordx4 v[212:215], v9, s[12:15], s49 offen offset:1024 sc1
    s_waitcnt vmcnt(35) lgkmcnt(0)
    s_barrier
    ds_read_b128 v[96:99], v20 offset:16384
    ds_read_b128 v[100:103], v20 offset:18432
    ds_read_b128 v[104:107], v20 offset:20480
    ds_read_b128 v[108:111], v20 offset:22528
    s_waitcnt vmcnt(14)
    v_mfma_f32_16x16x32_bf16 v[64:67], v[112:115], v[216:219], v[64:67]
    v_and_b32 v59, s53, v58
    v_mfma_f32_16x16x32_bf16 v[68:71], v[116:119], v[216:219], v[68:71]
    v_lshlrev_b32 v58, 16, v58
    v_mfma_f32_16x16x32_bf16 v[72:75], v[120:123], v[216:219], v[72:75]
    v_and_b32 v57, s53, v56
    v_mfma_f32_16x16x32_bf16 v[76:79], v[124:127], v[216:219], v[76:79]
    buffer_load_dwordx4 v[216:219], v9, s[12:15], s49 offen offset:2048 sc1
    v_mfma_f32_16x16x32_bf16 v[80:83], v[112:115], v[220:223], v[80:83]
    v_lshlrev_b32 v56, 16, v56
    v_mfma_f32_16x16x32_bf16 v[84:87], v[116:119], v[220:223], v[84:87]
    v_fma_f32 v158, v51, v58, v56
    v_mfma_f32_16x16x32_bf16 v[88:91], v[120:123], v[220:223], v[88:91]
    v_fma_f32 v159, v51, v59, v57
    v_mfma_f32_16x16x32_bf16 v[92:95], v[124:127], v[220:223], v[92:95]
    buffer_load_dwordx4 v[220:223], v9, s[12:15], s49 offen offset:3072 sc1
    ds_read_b128 v[112:115], v21 offset:16384
    ds_read_b128 v[116:119], v21 offset:18432
    ds_read_b128 v[120:123], v21 offset:20480
    ds_read_b128 v[124:127], v21 offset:22528
    s_waitcnt vmcnt(14) lgkmcnt(4)
    v_mfma_f32_16x16x32_bf16 v[64:67], v[96:99], v[160:163], v[64:67]
    v_mfma_f32_16x16x32_bf16 v[68:71], v[100:103], v[160:163], v[68:71]
    v_mfma_f32_16x16x32_bf16 v[72:75], v[104:107], v[160:163], v[72:75]
    v_mfma_f32_16x16x32_bf16 v[76:79], v[108:111], v[160:163], v[76:79]
    v_mfma_f32_16x16x32_bf16 v[80:83], v[96:99], v[164:167], v[80:83]
    v_mfma_f32_16x16x32_bf16 v[84:87], v[100:103], v[164:167], v[84:87]
    v_mfma_f32_16x16x32_bf16 v[88:91], v[104:107], v[164:167], v[88:91]
    v_mfma_f32_16x16x32_bf16 v[92:95], v[108:111], v[164:167], v[92:95]
    ds_read_b128 v[96:99], v20 offset:24576
    ds_read_b128 v[100:103], v20 offset:26624
    ds_read_b128 v[104:107], v20 offset:28672
    ds_read_b128 v[108:111], v20 offset:30720
    s_waitcnt vmcnt(12) lgkmcnt(4)
    v_mfma_f32_16x16x32_bf16 v[64:67], v[112:115], v[168:171], v[64:67]
    v_mfma_f32_16x16x32_bf16 v[68:71], v[116:119], v[168:171], v[68:71]
    v_mfma_f32_16x16x32_bf16 v[72:75], v[120:123], v[168:171], v[72:75]
    v_mfma_f32_16x16x32_bf16 v[76:79], v[124:127], v[168:171], v[76:79]
    v_mfma_f32_16x16x32_bf16 v[80:83], v[112:115], v[172:175], v[80:83]
    v_mfma_f32_16x16x32_bf16 v[84:87], v[116:119], v[172:175], v[84:87]
    v_mfma_f32_16x16x32_bf16 v[88:91], v[120:123], v[172:175], v[88:91]
    v_mfma_f32_16x16x32_bf16 v[92:95], v[124:127], v[172:175], v[92:95]
    ds_read_b128 v[112:115], v21 offset:24576
    ds_read_b128 v[116:119], v21 offset:26624
    ds_read_b128 v[120:123], v21 offset:28672
    ds_read_b128 v[124:127], v21 offset:30720
    s_waitcnt vmcnt(10) lgkmcnt(4)
    v_mfma_f32_16x16x32_bf16 v[64:67], v[96:99], v[176:179], v[64:67]
    v_mfma_f32_16x16x32_bf16 v[68:71], v[100:103], v[176:179], v[68:71]
    v_mfma_f32_16x16x32_bf16 v[72:75], v[104:107], v[176:179], v[72:75]
    v_mfma_f32_16x16x32_bf16 v[76:79], v[108:111], v[176:179], v[76:79]
    v_mfma_f32_16x16x32_bf16 v[80:83], v[96:99], v[180:183], v[80:83]
    v_mfma_f32_16x16x32_bf16 v[84:87], v[100:103], v[180:183], v[84:87]
    v_mfma_f32_16x16x32_bf16 v[88:91], v[104:107], v[180:183], v[88:91]
    v_mfma_f32_16x16x32_bf16 v[92:95], v[108:111], v[180:183], v[92:95]
    s_waitcnt vmcnt(25) lgkmcnt(0)
    s_barrier
    ds_read_b128 v[96:99], v20 offset:32768
    ds_read_b128 v[100:103], v20 offset:34816
    ds_read_b128 v[104:107], v20 offset:36864
    ds_read_b128 v[108:111], v20 offset:38912
    s_waitcnt vmcnt(8)
    v_mfma_f32_16x16x32_bf16 v[64:67], v[112:115], v[184:187], v[64:67]
    v_mfma_f32_16x16x32_bf16 v[68:71], v[116:119], v[184:187], v[68:71]
    v_mfma_f32_16x16x32_bf16 v[72:75], v[120:123], v[184:187], v[72:75]
    v_mfma_f32_16x16x32_bf16 v[76:79], v[124:127], v[184:187], v[76:79]
    v_mfma_f32_16x16x32_bf16 v[80:83], v[112:115], v[188:191], v[80:83]
    v_mfma_f32_16x16x32_bf16 v[84:87], v[116:119], v[188:191], v[84:87]
    v_mfma_f32_16x16x32_bf16 v[88:91], v[120:123], v[188:191], v[88:91]
    v_mfma_f32_16x16x32_bf16 v[92:95], v[124:127], v[188:191], v[92:95]
    ds_read_b128 v[112:115], v21 offset:32768
    ds_read_b128 v[116:119], v21 offset:34816
    ds_read_b128 v[120:123], v21 offset:36864
    ds_read_b128 v[124:127], v21 offset:38912
    s_waitcnt vmcnt(6) lgkmcnt(4)
    v_mfma_f32_16x16x32_bf16 v[64:67], v[96:99], v[192:195], v[64:67]
    v_mfma_f32_16x16x32_bf16 v[68:71], v[100:103], v[192:195], v[68:71]
    v_mfma_f32_16x16x32_bf16 v[72:75], v[104:107], v[192:195], v[72:75]
    v_mfma_f32_16x16x32_bf16 v[76:79], v[108:111], v[192:195], v[76:79]
    v_mfma_f32_16x16x32_bf16 v[80:83], v[96:99], v[196:199], v[80:83]
    v_mfma_f32_16x16x32_bf16 v[84:87], v[100:103], v[196:199], v[84:87]
    v_mfma_f32_16x16x32_bf16 v[88:91], v[104:107], v[196:199], v[88:91]
    v_mfma_f32_16x16x32_bf16 v[92:95], v[108:111], v[196:199], v[92:95]
    ds_read_b128 v[96:99], v20 offset:40960
    ds_read_b128 v[100:103], v20 offset:43008
    ds_read_b128 v[104:107], v20 offset:45056
    ds_read_b128 v[108:111], v20 offset:47104
    s_waitcnt vmcnt(4) lgkmcnt(4)
    v_mfma_f32_16x16x32_bf16 v[64:67], v[112:115], v[200:203], v[64:67]
    v_mfma_f32_16x16x32_bf16 v[68:71], v[116:119], v[200:203], v[68:71]
    v_mfma_f32_16x16x32_bf16 v[72:75], v[120:123], v[200:203], v[72:75]
    v_mfma_f32_16x16x32_bf16 v[76:79], v[124:127], v[200:203], v[76:79]
    v_mfma_f32_16x16x32_bf16 v[80:83], v[112:115], v[204:207], v[80:83]
    v_mfma_f32_16x16x32_bf16 v[84:87], v[116:119], v[204:207], v[84:87]
    v_mfma_f32_16x16x32_bf16 v[88:91], v[120:123], v[204:207], v[88:91]
    v_mfma_f32_16x16x32_bf16 v[92:95], v[124:127], v[204:207], v[92:95]
    ds_read_b128 v[112:115], v21 offset:40960
    ds_read_b128 v[116:119], v21 offset:43008
    ds_read_b128 v[120:123], v21 offset:45056
    ds_read_b128 v[124:127], v21 offset:47104
    s_waitcnt vmcnt(2) lgkmcnt(4)
    v_mfma_f32_16x16x32_bf16 v[64:67], v[96:99], v[208:211], v[64:67]
    v_mfma_f32_16x16x32_bf16 v[68:71], v[100:103], v[208:211], v[68:71]
    v_mfma_f32_16x16x32_bf16 v[72:75], v[104:107], v[208:211], v[72:75]
    v_mfma_f32_16x16x32_bf16 v[76:79], v[108:111], v[208:211], v[76:79]
    v_mfma_f32_16x16x32_bf16 v[80:83], v[96:99], v[212:215], v[80:83]
    v_mfma_f32_16x16x32_bf16 v[84:87], v[100:103], v[212:215], v[84:87]
    v_mfma_f32_16x16x32_bf16 v[88:91], v[104:107], v[212:215], v[88:91]
    v_mfma_f32_16x16x32_bf16 v[92:95], v[108:111], v[212:215], v[92:95]
    s_waitcnt vmcnt(0) lgkmcnt(0)
    v_mfma_f32_16x16x32_bf16 v[64:67], v[112:115], v[216:219], v[64:67]
    v_mfma_f32_16x16x32_bf16 v[68:71], v[116:119], v[216:219], v[68:71]
    v_mfma_f32_16x16x32_bf16 v[72:75], v[120:123], v[216:219], v[72:75]
    v_mfma_f32_16x16x32_bf16 v[76:79], v[124:127], v[216:219], v[76:79]
    v_mfma_f32_16x16x32_bf16 v[80:83], v[112:115], v[220:223], v[80:83]
    v_mfma_f32_16x16x32_bf16 v[84:87], v[116:119], v[220:223], v[84:87]
    v_mfma_f32_16x16x32_bf16 v[88:91], v[120:123], v[220:223], v[88:91]
    v_mfma_f32_16x16x32_bf16 v[92:95], v[124:127], v[220:223], v[92:95]
    s_mul_i32 s38, s18, 8704
    s_add_u32 s56, s38, 49152
    v_mul_u32_u24 v56, 272, v26
    v_lshl_add_u32 v56, v25, 4, v56
    v_add_u32 v56, s56, v56
    v_mul_u32_u24 v57, 272, v25
    v_lshl_add_u32 v57, v26, 4, v57
    v_add_u32 v57, s56, v57
    v_lshlrev_b32 v58, 12, v25
    v_lshl_add_u32 v58, v26, 4, v58
    v_lshlrev_b32 v59, 2, v24
    v_add_u32 v59, 102400, v59
    ds_read_b32 v60, v59
    v_pk_mul_f32 v[64:65], v[10:11], v[64:65] op_sel:[0,0] op_sel_hi:[0,1]
    v_pk_mul_f32 v[66:67], v[10:11], v[66:67] op_sel:[0,0] op_sel_hi:[0,1]
    ds_write_b128 v56, v[64:67] offset:0
    v_pk_mul_f32 v[68:69], v[10:11], v[68:69] op_sel:[0,0] op_sel_hi:[0,1]
    v_pk_mul_f32 v[70:71], v[10:11], v[70:71] op_sel:[0,0] op_sel_hi:[0,1]
    ds_write_b128 v56, v[68:71] offset:64
    v_pk_mul_f32 v[72:73], v[10:11], v[72:73] op_sel:[0,0] op_sel_hi:[0,1]
    v_pk_mul_f32 v[74:75], v[10:11], v[74:75] op_sel:[0,0] op_sel_hi:[0,1]
    ds_write_b128 v56, v[72:75] offset:128
    v_pk_mul_f32 v[76:77], v[10:11], v[76:77] op_sel:[0,0] op_sel_hi:[0,1]
    v_pk_mul_f32 v[78:79], v[10:11], v[78:79] op_sel:[0,0] op_sel_hi:[0,1]
    ds_write_b128 v56, v[76:79] offset:192
    v_pk_mul_f32 v[80:81], v[10:11], v[80:81] op_sel:[1,0] op_sel_hi:[1,1]
    v_pk_mul_f32 v[82:83], v[10:11], v[82:83] op_sel:[1,0] op_sel_hi:[1,1]
    ds_write_b128 v56, v[80:83] offset:4352
    v_pk_mul_f32 v[84:85], v[10:11], v[84:85] op_sel:[1,0] op_sel_hi:[1,1]
    v_pk_mul_f32 v[86:87], v[10:11], v[86:87] op_sel:[1,0] op_sel_hi:[1,1]
    ds_write_b128 v56, v[84:87] offset:4416
    v_pk_mul_f32 v[88:89], v[10:11], v[88:89] op_sel:[1,0] op_sel_hi:[1,1]
    v_pk_mul_f32 v[90:91], v[10:11], v[90:91] op_sel:[1,0] op_sel_hi:[1,1]
    ds_write_b128 v56, v[88:91] offset:4480
    v_pk_mul_f32 v[92:93], v[10:11], v[92:93] op_sel:[1,0] op_sel_hi:[1,1]
    v_pk_mul_f32 v[94:95], v[10:11], v[94:95] op_sel:[1,0] op_sel_hi:[1,1]
    ds_write_b128 v56, v[92:95] offset:4544
    s_waitcnt lgkmcnt(8)
    v_and_b32 v60, 0x7ff, v60
    s_sub_u32 s38, 2047, s51
    v_sub_u32 v60, s38, v60
    v_cmp_gt_u32 vcc, 32, v60
    s_waitcnt lgkmcnt(0)
    s_barrier
    s_and_b32 s57, vcc_lo, 0xff
L_fix:
    s_cmp_eq_u32 s57, 0
    s_cbranch_scc1 L_fixd
    s_ff1_i32_b32 s38, s57
    s_bitset0_b32 s57, s38
    v_readlane_b32 s39, v60, s38
    s_lshl_b32 s38, s38, 8
    s_add_u32 s38, s38, 100352
    v_lshl_add_u32 v169, v26, 4, s38
    s_mul_i32 s39, s39, 272
    s_add_u32 s39, s39, s56
    v_lshl_add_u32 v168, v26, 4, s39
    ds_read_b128 v[160:163], v168
    ds_read_b128 v[164:167], v169
    s_waitcnt lgkmcnt(0)
    v_pk_add_f32 v[160:161], v[160:161], v[164:165]
    v_pk_add_f32 v[162:163], v[162:163], v[166:167]
    ds_write_b128 v168, v[160:163]
    s_waitcnt lgkmcnt(0)
    s_branch L_fix
L_fixd:
    ds_read_b128 v[64:67], v57 offset:0
    ds_read_b128 v[68:71], v57 offset:1088
    ds_read_b128 v[72:75], v57 offset:2176
    ds_read_b128 v[76:79], v57 offset:3264
    ds_read_b128 v[80:83], v57 offset:4352
    ds_read_b128 v[84:87], v57 offset:5440
    ds_read_b128 v[88:91], v57 offset:6528
    ds_read_b128 v[92:95], v57 offset:7616
    s_lshl_b32 s38, s51, 12
    s_lshl_b32 s39, s17, 8
    s_add_u32 s38, s38, s39
    s_waitcnt lgkmcnt(7)
    v_pk_add_f32 v[64:65], v[64:65], v[128:129]
    v_pk_add_f32 v[66:67], v[66:67], v[130:131]
    buffer_store_dwordx4 v[64:67], v58, s[32:35], s38 offen
    s_add_u32 s38, s38, 16384
    s_waitcnt lgkmcnt(6)
    v_pk_add_f32 v[68:69], v[68:69], v[132:133]
    v_pk_add_f32 v[70:71], v[70:71], v[134:135]
    buffer_store_dwordx4 v[68:71], v58, s[32:35], s38 offen
    s_add_u32 s38, s38, 16384
    s_waitcnt lgkmcnt(5)
    v_pk_add_f32 v[72:73], v[72:73], v[136:137]
    v_pk_add_f32 v[74:75], v[74:75], v[138:139]
    buffer_store_dwordx4 v[72:75], v58, s[32:35], s38 offen
    s_add_u32 s38, s38, 16384
    s_waitcnt lgkmcnt(4)
    v_pk_add_f32 v[76:77], v[76:77], v[140:141]
    v_pk_add_f32 v[78:79], v[78:79], v[142:143]
    buffer_store_dwordx4 v[76:79], v58, s[32:35], s38 offen
    s_add_u32 s38, s38, 16384
    s_waitcnt lgkmcnt(3)
    v_pk_add_f32 v[80:81], v[80:81], v[144:145]
    v_pk_add_f32 v[82:83], v[82:83], v[146:147]
    buffer_store_dwordx4 v[80:83], v58, s[32:35], s38 offen
    s_add_u32 s38, s38, 16384
    s_waitcnt lgkmcnt(2)
    v_pk_add_f32 v[84:85], v[84:85], v[148:149]
    v_pk_add_f32 v[86:87], v[86:87], v[150:151]
    buffer_store_dwordx4 v[84:87], v58, s[32:35], s38 offen
    s_add_u32 s38, s38, 16384
    s_waitcnt lgkmcnt(1)
    v_pk_add_f32 v[88:89], v[88:89], v[152:153]
    v_pk_add_f32 v[90:91], v[90:91], v[154:155]
    buffer_store_dwordx4 v[88:91], v58, s[32:35], s38 offen
    s_add_u32 s38, s38, 16384
    s_waitcnt lgkmcnt(0)
    v_pk_add_f32 v[92:93], v[92:93], v[156:157]
    v_pk_add_f32 v[94:95], v[94:95], v[158:159]
    buffer_store_dwordx4 v[92:95], v58, s[32:35], s38 offen
    s_add_u32 s38, s38, 16384
    s_endpgm
L_exit:
    s_endpgm
L_side:
    s_load_dwordx2 s[40:41], s[0:1], 0
    s_load_dwordx8 s[44:51], s[0:1], 80
    s_load_dwordx2 s[36:37], s[0:1], 112
    s_load_dwordx2 s[42:43], s[0:1], 136
    s_load_dwordx4 s[52:55], s[0:1], 40
    s_sub_u32 s18, s18, 4
    v_and_b32 v2, 63, v0
    v_lshlrev_b32 v3, 4, v2
    s_getpc_b64 s[32:33]
L_pc:
    s_sub_u32 s32, s32, L_pc-L_code_start
    s_subb_u32 s33, s33, 0
    s_mov_b32 s34, L_code_end-L_code_start
    s_mov_b32 s35, 0x20000
    s_lshr_b32 s59, s2, 3
    s_lshl_b32 s59, s59, 2
    s_add_u32 s59, s59, s18
    s_lshl_b32 s59, s59, 10
    buffer_load_dwordx4 v[60:63], v3, s[32:35], s59 offen
    s_and_b32 s3, s2, 7
    s_sub_u32 s39, 11, s3
    s_cmp_lt_u32 s3, 4
    s_cselect_b32 s3, s3, s39
    s_lshr_b32 s38, s2, 3
    s_lshl_b32 s16, s3, 1
    s_and_b32 s39, s38, 1
    s_add_u32 s16, s16, s39
    s_lshr_b32 s17, s38, 1
    s_lshl_b32 s3, s3, 8
    s_lshl_b32 s38, s38, 3
    s_add_u32 s3, s3, s38
    s_lshl_b32 s38, s18, 1
    s_add_u32 s19, s3, s38
    s_lshl_b32 s20, s19, 11
    s_mul_hi_u32 s23, s2, 76695845
    s_mul_i32 s38, s23, 56
    s_sub_u32 s22, s2, s38
    s_waitcnt lgkmcnt(0)
    s_mov_b32 s4, s40
    s_mov_b32 s5, s41
    s_mov_b32 s6, 4194304
    s_mov_b32 s7, 0x20000
    buffer_load_dwordx4 v[8:11], v3, s[4:7], s20 offen offset:0
    buffer_load_dwordx4 v[12:15], v3, s[4:7], s20 offen offset:1024
    buffer_load_dwordx4 v[16:19], v3, s[4:7], s20 offen offset:2048
    buffer_load_dwordx4 v[20:23], v3, s[4:7], s20 offen offset:3072
    global_load_dwordx4 v[24:27], v3, s[44:45] offset:0
    global_load_dwordx4 v[32:35], v3, s[36:37] offset:0
    global_load_dwordx4 v[28:31], v3, s[44:45] offset:1024
    global_load_dwordx4 v[36:39], v3, s[36:37] offset:1024
    s_mov_b32 s12, s42
    s_mov_b32 s13, s43
    s_mov_b32 s14, 16777216
    s_mov_b32 s15, 0x20000
    s_mov_b32 s8, s46
    s_mov_b32 s9, s47
    s_mov_b32 s10, 7340032
    s_mov_b32 s11, 0x20000
    s_mov_b32 s24, s48
    s_mov_b32 s25, s49
    s_mov_b32 s26, 7340032
    s_mov_b32 s27, 0x20000
    s_mov_b32 s28, s50
    s_mov_b32 s29, s51
    s_mov_b32 s30, 7340032
    s_mov_b32 s31, 0x20000
    s_add_u32 s94, s42, 9469952
    s_addc_u32 s95, s43, 0
    s_load_dword s93, s[94:95], 0
    s_mov_b32 s21, 0xffff0000
    v_mov_b32 v40, 0
    v_mov_b32 v41, 0
    v_mov_b32 v42, 0
    v_mov_b32 v43, 0
    s_barrier
    s_waitcnt vmcnt(0) lgkmcnt(0)
    s_mul_i32 s93, s93, 1664525
    s_add_u32 s93, s93, 1013904223
    v_lshlrev_b32 v44, 16, v32
    v_and_b32 v45, s21, v32
    v_dot2c_f32_bf16 v40, v8, v24
    v_lshlrev_b32 v46, 16, v8
    v_and_b32 v47, s21, v8
    v_pk_mul_f32 v[46:47], v[46:47], v[44:45] op_sel:[0,0] op_sel_hi:[1,1]
    v_cvt_pk_bf16_f32 v46, v46, v47
    v_lshlrev_b32 v47, 16, v46
    v_and_b32 v46, s21, v46
    v_add_f32 v42, v42, v47
    v_add_f32 v42, v42, v46
    v_dot2c_f32_bf16 v41, v16, v24
    v_lshlrev_b32 v46, 16, v16
    v_and_b32 v47, s21, v16
    v_pk_mul_f32 v[46:47], v[46:47], v[44:45] op_sel:[0,0] op_sel_hi:[1,1]
    v_cvt_pk_bf16_f32 v46, v46, v47
    v_lshlrev_b32 v47, 16, v46
    v_and_b32 v46, s21, v46
    v_add_f32 v43, v43, v47
    v_add_f32 v43, v43, v46
    v_lshlrev_b32 v44, 16, v33
    v_and_b32 v45, s21, v33
    v_dot2c_f32_bf16 v40, v9, v25
    v_lshlrev_b32 v46, 16, v9
    v_and_b32 v47, s21, v9
    v_pk_mul_f32 v[46:47], v[46:47], v[44:45] op_sel:[0,0] op_sel_hi:[1,1]
    v_cvt_pk_bf16_f32 v46, v46, v47
    v_lshlrev_b32 v47, 16, v46
    v_and_b32 v46, s21, v46
    v_add_f32 v42, v42, v47
    v_add_f32 v42, v42, v46
    v_dot2c_f32_bf16 v41, v17, v25
    v_lshlrev_b32 v46, 16, v17
    v_and_b32 v47, s21, v17
    v_pk_mul_f32 v[46:47], v[46:47], v[44:45] op_sel:[0,0] op_sel_hi:[1,1]
    v_cvt_pk_bf16_f32 v46, v46, v47
    v_lshlrev_b32 v47, 16, v46
    v_and_b32 v46, s21, v46
    v_add_f32 v43, v43, v47
    v_add_f32 v43, v43, v46
    v_lshlrev_b32 v44, 16, v34
    v_and_b32 v45, s21, v34
    v_dot2c_f32_bf16 v40, v10, v26
    v_lshlrev_b32 v46, 16, v10
    v_and_b32 v47, s21, v10
    v_pk_mul_f32 v[46:47], v[46:47], v[44:45] op_sel:[0,0] op_sel_hi:[1,1]
    v_cvt_pk_bf16_f32 v46, v46, v47
    v_lshlrev_b32 v47, 16, v46
    v_and_b32 v46, s21, v46
    v_add_f32 v42, v42, v47
    v_add_f32 v42, v42, v46
    v_dot2c_f32_bf16 v41, v18, v26
    v_lshlrev_b32 v46, 16, v18
    v_and_b32 v47, s21, v18
    v_pk_mul_f32 v[46:47], v[46:47], v[44:45] op_sel:[0,0] op_sel_hi:[1,1]
    v_cvt_pk_bf16_f32 v46, v46, v47
    v_lshlrev_b32 v47, 16, v46
    v_and_b32 v46, s21, v46
    v_add_f32 v43, v43, v47
    v_add_f32 v43, v43, v46
    v_lshlrev_b32 v44, 16, v35
    v_and_b32 v45, s21, v35
    v_dot2c_f32_bf16 v40, v11, v27
    v_lshlrev_b32 v46, 16, v11
    v_and_b32 v47, s21, v11
    v_pk_mul_f32 v[46:47], v[46:47], v[44:45] op_sel:[0,0] op_sel_hi:[1,1]
    v_cvt_pk_bf16_f32 v46, v46, v47
    v_lshlrev_b32 v47, 16, v46
    v_and_b32 v46, s21, v46
    v_add_f32 v42, v42, v47
    v_add_f32 v42, v42, v46
    v_dot2c_f32_bf16 v41, v19, v27
    v_lshlrev_b32 v46, 16, v19
    v_and_b32 v47, s21, v19
    v_pk_mul_f32 v[46:47], v[46:47], v[44:45] op_sel:[0,0] op_sel_hi:[1,1]
    v_cvt_pk_bf16_f32 v46, v46, v47
    v_lshlrev_b32 v47, 16, v46
    v_and_b32 v46, s21, v46
    v_add_f32 v43, v43, v47
    v_add_f32 v43, v43, v46
    v_lshlrev_b32 v44, 16, v36
    v_and_b32 v45, s21, v36
    v_dot2c_f32_bf16 v40, v12, v28
    v_lshlrev_b32 v46, 16, v12
    v_and_b32 v47, s21, v12
    v_pk_mul_f32 v[46:47], v[46:47], v[44:45] op_sel:[0,0] op_sel_hi:[1,1]
    v_cvt_pk_bf16_f32 v46, v46, v47
    v_lshlrev_b32 v47, 16, v46
    v_and_b32 v46, s21, v46
    v_add_f32 v42, v42, v47
    v_add_f32 v42, v42, v46
    v_dot2c_f32_bf16 v41, v20, v28
    v_lshlrev_b32 v46, 16, v20
    v_and_b32 v47, s21, v20
    v_pk_mul_f32 v[46:47], v[46:47], v[44:45] op_sel:[0,0] op_sel_hi:[1,1]
    v_cvt_pk_bf16_f32 v46, v46, v47
    v_lshlrev_b32 v47, 16, v46
    v_and_b32 v46, s21, v46
    v_add_f32 v43, v43, v47
    v_add_f32 v43, v43, v46
    s_barrier
    v_lshlrev_b32 v44, 16, v37
    v_and_b32 v45, s21, v37
    v_dot2c_f32_bf16 v40, v13, v29
    v_lshlrev_b32 v46, 16, v13
    v_and_b32 v47, s21, v13
    v_pk_mul_f32 v[46:47], v[46:47], v[44:45] op_sel:[0,0] op_sel_hi:[1,1]
    v_cvt_pk_bf16_f32 v46, v46, v47
    v_lshlrev_b32 v47, 16, v46
    v_and_b32 v46, s21, v46
    v_add_f32 v42, v42, v47
    v_add_f32 v42, v42, v46
    v_dot2c_f32_bf16 v41, v21, v29
    v_lshlrev_b32 v46, 16, v21
    v_and_b32 v47, s21, v21
    v_pk_mul_f32 v[46:47], v[46:47], v[44:45] op_sel:[0,0] op_sel_hi:[1,1]
    v_cvt_pk_bf16_f32 v46, v46, v47
    v_lshlrev_b32 v47, 16, v46
    v_and_b32 v46, s21, v46
    v_add_f32 v43, v43, v47
    v_add_f32 v43, v43, v46
    v_lshlrev_b32 v44, 16, v38
    v_and_b32 v45, s21, v38
    v_dot2c_f32_bf16 v40, v14, v30
    v_lshlrev_b32 v46, 16, v14
    v_and_b32 v47, s21, v14
    v_pk_mul_f32 v[46:47], v[46:47], v[44:45] op_sel:[0,0] op_sel_hi:[1,1]
    v_cvt_pk_bf16_f32 v46, v46, v47
    v_lshlrev_b32 v47, 16, v46
    v_and_b32 v46, s21, v46
    v_add_f32 v42, v42, v47
    v_add_f32 v42, v42, v46
    v_dot2c_f32_bf16 v41, v22, v30
    v_lshlrev_b32 v46, 16, v22
    v_and_b32 v47, s21, v22
    v_pk_mul_f32 v[46:47], v[46:47], v[44:45] op_sel:[0,0] op_sel_hi:[1,1]
    v_cvt_pk_bf16_f32 v46, v46, v47
    v_lshlrev_b32 v47, 16, v46
    v_and_b32 v46, s21, v46
    v_add_f32 v43, v43, v47
    v_add_f32 v43, v43, v46
    v_lshlrev_b32 v44, 16, v39
    v_and_b32 v45, s21, v39
    v_dot2c_f32_bf16 v40, v15, v31
    v_lshlrev_b32 v46, 16, v15
    v_and_b32 v47, s21, v15
    v_pk_mul_f32 v[46:47], v[46:47], v[44:45] op_sel:[0,0] op_sel_hi:[1,1]
    v_cvt_pk_bf16_f32 v46, v46, v47
    v_lshlrev_b32 v47, 16, v46
    v_and_b32 v46, s21, v46
    v_add_f32 v42, v42, v47
    v_add_f32 v42, v42, v46
    v_dot2c_f32_bf16 v41, v23, v31
    v_lshlrev_b32 v46, 16, v23
    v_and_b32 v47, s21, v23
    v_pk_mul_f32 v[46:47], v[46:47], v[44:45] op_sel:[0,0] op_sel_hi:[1,1]
    v_cvt_pk_bf16_f32 v46, v46, v47
    v_lshlrev_b32 v47, 16, v46
    v_and_b32 v46, s21, v46
    v_add_f32 v43, v43, v47
    v_add_f32 v43, v43, v46
    s_nop 3
    v_add_f32_dpp v40, v40, v40 row_ror:8 row_mask:0xf bank_mask:0xf
    v_add_f32_dpp v41, v41, v41 row_ror:8 row_mask:0xf bank_mask:0xf
    v_add_f32_dpp v42, v42, v42 row_ror:8 row_mask:0xf bank_mask:0xf
    v_add_f32_dpp v43, v43, v43 row_ror:8 row_mask:0xf bank_mask:0xf
    v_add_f32_dpp v40, v40, v40 row_ror:4 row_mask:0xf bank_mask:0xf
    v_add_f32_dpp v41, v41, v41 row_ror:4 row_mask:0xf bank_mask:0xf
    v_add_f32_dpp v42, v42, v42 row_ror:4 row_mask:0xf bank_mask:0xf
    v_add_f32_dpp v43, v43, v43 row_ror:4 row_mask:0xf bank_mask:0xf
    v_add_f32_dpp v40, v40, v40 row_ror:2 row_mask:0xf bank_mask:0xf
    v_add_f32_dpp v41, v41, v41 row_ror:2 row_mask:0xf bank_mask:0xf
    v_add_f32_dpp v42, v42, v42 row_ror:2 row_mask:0xf bank_mask:0xf
    v_add_f32_dpp v43, v43, v43 row_ror:2 row_mask:0xf bank_mask:0xf
    v_add_f32_dpp v40, v40, v40 row_ror:1 row_mask:0xf bank_mask:0xf
    v_add_f32_dpp v41, v41, v41 row_ror:1 row_mask:0xf bank_mask:0xf
    v_add_f32_dpp v42, v42, v42 row_ror:1 row_mask:0xf bank_mask:0xf
    v_add_f32_dpp v43, v43, v43 row_ror:1 row_mask:0xf bank_mask:0xf
    v_mov_b32 v44, v40
    v_mov_b32 v45, v41
    v_mov_b32 v46, v42
    v_mov_b32 v47, v43
    s_nop 1
    v_permlane16_swap_b32 v40, v44
    v_permlane16_swap_b32 v41, v45
    v_permlane16_swap_b32 v42, v46
    v_permlane16_swap_b32 v43, v47
    s_nop 1
    v_add_f32 v40, v40, v44
    v_add_f32 v41, v41, v45
    v_add_f32 v42, v42, v46
    v_add_f32 v43, v43, v47
    v_mov_b32 v44, v40
    v_mov_b32 v45, v41
    v_mov_b32 v46, v42
    v_mov_b32 v47, v43
    s_nop 1
    v_permlane32_swap_b32 v40, v44
    v_permlane32_swap_b32 v41, v45
    v_permlane32_swap_b32 v42, v46
    v_permlane32_swap_b32 v43, v47
    s_nop 1
    v_add_f32 v40, v40, v44
    v_add_f32 v41, v41, v45
    v_add_f32 v42, v42, v46
    v_add_f32 v43, v43, v47
    v_cvt_pk_bf16_f32 v46, v42, v42
    v_lshlrev_b32 v46, 16, v46
    v_mul_f32 v48, 0xbfb8aa3b, v46
    v_exp_f32 v48, v48
    s_nop 0
    v_add_f32 v48, 1.0, v48
    v_rcp_f32 v48, v48
    s_nop 0
    v_cvt_pk_bf16_f32 v48, v48, v48
    v_lshlrev_b32 v48, 16, v48
    v_cvt_pk_bf16_f32 v46, v43, v43
    v_lshlrev_b32 v46, 16, v46
    v_mul_f32 v49, 0xbfb8aa3b, v46
    v_exp_f32 v49, v49
    s_nop 0
    v_add_f32 v49, 1.0, v49
    v_rcp_f32 v49, v49
    s_nop 0
    v_cvt_pk_bf16_f32 v49, v49, v49
    v_lshlrev_b32 v49, 16, v49
    v_mov_b32 v50, v49
    v_mov_b32 v49, s93
    v_mov_b32 v51, s93
    v_cvt_pk_bf16_f32 v44, v40, v40
    v_lshlrev_b32 v44, 16, v44
    v_ashrrev_i32 v52, 31, v44
    v_or_b32 v52, 0x80000000, v52
    v_xor_b32 v44, v44, v52
    v_and_b32 v44, s21, v44
    s_sub_u32 s38, 2047, s19
    v_or_b32 v44, s38, v44
    v_mov_b32 v45, s93
    v_cvt_pk_bf16_f32 v46, v41, v41
    v_lshlrev_b32 v46, 16, v46
    v_ashrrev_i32 v52, 31, v46
    v_or_b32 v52, 0x80000000, v52
    v_xor_b32 v46, v46, v52
    v_and_b32 v46, s21, v46
    s_sub_u32 s38, 2046, s19
    v_or_b32 v46, s38, v46
    v_mov_b32 v47, s93
    s_lshl_b32 s38, s18, 4
    s_add_u32 s38, s38, 163584
    v_mov_b32 v4, s38
    s_mov_b64 exec, 1
    ds_write_b128 v4, v[44:47]
    ds_write_b128 v4, v[48:51] offset:64
    s_mov_b64 exec, -1
    s_waitcnt lgkmcnt(0)
    s_barrier
    s_cmp_lg_u32 s18, 0
    s_cbranch_scc1 L_s_nokey
    v_add_u32 v4, 163584, v3
    s_mov_b64 exec, 0xff
    ds_read_b128 v[44:47], v4
    v_and_b32 v5, 3, v2
    v_lshlrev_b32 v5, 4, v5
    v_lshrrev_b32 v6, 2, v2
    v_lshl_add_u32 v5, v6, 14, v5
    s_lshl_b32 s38, s19, 3
    s_add_u32 s38, s38, 9437184
    s_waitcnt lgkmcnt(0)
    buffer_store_dwordx4 v[44:47], v5, s[12:15], s38 offen sc1
    s_mov_b64 exec, -1
L_s_nokey:
    v_lshrrev_b32 v5, 3, v2
    v_and_b32 v6, 7, v2
    v_and_b32 v7, 3, v5
    v_lshlrev_b32 v7, 1, v7
    v_xor_b32 v6, v6, v7
    v_mul_u32_u24 v4, 7168, v5
    v_lshl_add_u32 v4, v6, 4, v4
    v_lshlrev_b32 v5, 11, v5
    v_lshl_add_u32 v5, v6, 4, v5
    s_lshl_b32 s38, s18, 6
    s_lshl_b32 s39, s23, 8
    s_add_u32 s44, s38, s39
    s_mul_i32 s45, s44, 7168
    s_lshl_b32 s39, s22, 7
    s_add_u32 s45, s45, s39
    s_lshl_b32 s46, s18, 14
    s_add_u32 s46, s46, 98304
    v_lshrrev_b32 v10, 4, v2
    v_and_b32 v11, 15, v2
    v_bfe_u32 v12, v2, 2, 2
    v_lshl_add_u32 v13, v10, 3, v12
    v_lshlrev_b32 v13, 7, v13
    v_and_b32 v14, 3, v2
    v_lshl_add_u32 v13, v14, 3, v13
    v_add_u32 v13, s46, v13
    v_xor_b32 v14, 0, v12
    v_lshl_add_u32 v16, v14, 5, v13
    v_xor_b32 v14, 1, v12
    v_lshl_add_u32 v17, v14, 5, v13
    v_xor_b32 v14, 2, v12
    v_lshl_add_u32 v18, v14, 5, v13
    v_xor_b32 v14, 3, v12
    v_lshl_add_u32 v19, v14, 5, v13
    s_cmp_ge_u32 s2, 224
    s_cselect_b32 s10, 0, s10
    s_cselect_b32 s26, 0, s26
    s_barrier
    s_barrier
    s_barrier
    s_barrier
    s_barrier
    s_barrier
    s_barrier
    s_barrier
    s_barrier
    s_barrier
    s_barrier
    s_lshl_b32 s58, s18, 12
    s_add_u32 s58, s58, 9437184
    buffer_load_dwordx4 v[80:83], v3, s[12:15], s58 offen offset:0 sc1
    buffer_load_dwordx4 v[84:87], v3, s[12:15], s58 offen offset:1024 sc1
    buffer_load_dwordx4 v[88:91], v3, s[12:15], s58 offen offset:2048 sc1
    buffer_load_dwordx4 v[92:95], v3, s[12:15], s58 offen offset:3072 sc1
    v_mov_b32 v8, 0
    s_mov_b32 s57, -1
    s_barrier
    s_add_u32 m0, s46, 0
    s_add_u32 s38, s45, 0
    buffer_load_dwordx4 v4, s[8:11], s38 offen lds
    s_add_u32 m0, s46, 1024
    s_add_u32 s38, s45, 57344
    buffer_load_dwordx4 v4, s[8:11], s38 offen lds
    s_add_u32 m0, s46, 2048
    s_add_u32 s38, s45, 114688
    buffer_load_dwordx4 v4, s[8:11], s38 offen lds
    s_add_u32 m0, s46, 3072
    s_add_u32 s38, s45, 172032
    buffer_load_dwordx4 v4, s[8:11], s38 offen lds
    s_add_u32 m0, s46, 4096
    s_add_u32 s38, s45, 229376
    buffer_load_dwordx4 v4, s[8:11], s38 offen lds
    s_add_u32 m0, s46, 5120
    s_add_u32 s38, s45, 286720
    buffer_load_dwordx4 v4, s[8:11], s38 offen lds
    s_barrier
    s_add_u32 m0, s46, 6144
    s_add_u32 s38, s45, 344064
    buffer_load_dwordx4 v4, s[8:11], s38 offen lds
    s_add_u32 m0, s46, 7168
    s_add_u32 s38, s45, 401408
    buffer_load_dwordx4 v4, s[8:11], s38 offen lds
    s_barrier
    s_waitcnt vmcnt(8)
L_s_poll:
    v_xor_b32 v81, s93, v81
    v_xor_b32 v83, s93, v83
    v_xor_b32 v85, s93, v85
    v_xor_b32 v87, s93, v87
    v_xor_b32 v89, s93, v89
    v_xor_b32 v91, s93, v91
    v_xor_b32 v93, s93, v93
    v_xor_b32 v95, s93, v95
    v_or3_b32 v9, v81, v83, v85
    v_or3_b32 v9, v9, v87, v89
    v_or3_b32 v9, v9, v91, v93
    v_or_b32 v9, v9, v95
    v_cmp_ne_u32 vcc, 0, v9
    s_nop 1
    s_cmp_eq_u64 vcc, 0
    s_cbranch_scc1 L_s_go
    s_sub_u32 s96, s96, 1
    s_cbranch_scc1 L_s_go
    s_sleep 8
    buffer_load_dwordx4 v[80:83], v3, s[12:15], s58 offen offset:0 sc1
    buffer_load_dwordx4 v[84:87], v3, s[12:15], s58 offen offset:1024 sc1
    buffer_load_dwordx4 v[88:91], v3, s[12:15], s58 offen offset:2048 sc1
    buffer_load_dwordx4 v[92:95], v3, s[12:15], s58 offen offset:3072 sc1
    s_waitcnt vmcnt(0)
    s_branch L_s_poll
L_s_go:
    s_waitcnt vmcnt(2)
    s_add_u32 m0, s46, 8192
    s_add_u32 s38, s45, 0
    buffer_load_dwordx4 v4, s[24:27], s38 offen lds
    v_sub_u32 v72, s57, v80
    v_sub_u32 v73, s57, v82
    v_sub_u32 v74, s57, v84
    v_sub_u32 v75, s57, v86
    v_sub_u32 v76, s57, v88
    v_sub_u32 v77, s57, v90
    v_sub_u32 v78, s57, v92
    v_sub_u32 v79, s57, v94
    v_min3_u32 v9, v72, v73, v74
    v_min3_u32 v15, v75, v76, v77
    v_min3_u32 v9, v9, v78, v79
    v_min_u32 v9, v9, v15
    s_nop 1
    v_min_u32_dpp v9, v9, v9 row_ror:8 row_mask:0xf bank_mask:0xf
    s_nop 1
    v_min_u32_dpp v9, v9, v9 row_ror:4 row_mask:0xf bank_mask:0xf
    s_nop 1
    v_min_u32_dpp v9, v9, v9 row_ror:2 row_mask:0xf bank_mask:0xf
    s_nop 1
    v_min_u32_dpp v9, v9, v9 row_ror:1 row_mask:0xf bank_mask:0xf
    s_nop 0
    v_readlane_b32 s48, v9, 0
    v_readlane_b32 s49, v9, 16
    v_readlane_b32 s50, v9, 32
    v_readlane_b32 s51, v9, 48
    s_nop 0
    s_min_u32 s48, s48, s49
    s_min_u32 s50, s50, s51
    s_min_u32 s48, s48, s50
    s_sub_u32 s57, s57, s48
    v_writelane_b32 v8, s57, 0
    s_sub_u32 s57, s57, 1
    s_waitcnt vmcnt(2)
    s_add_u32 m0, s46, 9216
    s_add_u32 s38, s45, 57344
    buffer_load_dwordx4 v4, s[24:27], s38 offen lds
    v_sub_u32 v72, s57, v80
    v_sub_u32 v73, s57, v82
    v_sub_u32 v74, s57, v84
    v_sub_u32 v75, s57, v86
    v_sub_u32 v76, s57, v88
    v_sub_u32 v77, s57, v90
    v_sub_u32 v78, s57, v92
    v_sub_u32 v79, s57, v94
    v_min3_u32 v9, v72, v73, v74
    v_min3_u32 v15, v75, v76, v77
    v_min3_u32 v9, v9, v78, v79
    v_min_u32 v9, v9, v15
    s_nop 1
    v_min_u32_dpp v9, v9, v9 row_ror:8 row_mask:0xf bank_mask:0xf
    s_nop 1
    v_min_u32_dpp v9, v9, v9 row_ror:4 row_mask:0xf bank_mask:0xf
    s_nop 1
    v_min_u32_dpp v9, v9, v9 row_ror:2 row_mask:0xf bank_mask:0xf
    s_nop 1
    v_min_u32_dpp v9, v9, v9 row_ror:1 row_mask:0xf bank_mask:0xf
    s_nop 0
    v_readlane_b32 s48, v9, 0
    v_readlane_b32 s49, v9, 16
    v_readlane_b32 s50, v9, 32
    v_readlane_b32 s51, v9, 48
    s_nop 0
    s_min_u32 s48, s48, s49
    s_min_u32 s50, s50, s51
    s_min_u32 s48, s48, s50
    s_sub_u32 s57, s57, s48
    v_writelane_b32 v8, s57, 1
    s_sub_u32 s57, s57, 1
    s_waitcnt vmcnt(2)
    s_add_u32 m0, s46, 10240
    s_add_u32 s38, s45, 114688
    buffer_load_dwordx4 v4, s[24:27], s38 offen lds
    v_sub_u32 v72, s57, v80
    v_sub_u32 v73, s57, v82
    v_sub_u32 v74, s57, v84
    v_sub_u32 v75, s57, v86
    v_sub_u32 v76, s57, v88
    v_sub_u32 v77, s57, v90
    v_sub_u32 v78, s57, v92
    v_sub_u32 v79, s57, v94
    v_min3_u32 v9, v72, v73, v74
    v_min3_u32 v15, v75, v76, v77
    v_min3_u32 v9, v9, v78, v79
    v_min_u32 v9, v9, v15
    s_nop 1
    v_min_u32_dpp v9, v9, v9 row_ror:8 row_mask:0xf bank_mask:0xf
    s_nop 1
    v_min_u32_dpp v9, v9, v9 row_ror:4 row_mask:0xf bank_mask:0xf
    s_nop 1
    v_min_u32_dpp v9, v9, v9 row_ror:2 row_mask:0xf bank_mask:0xf
    s_nop 1
    v_min_u32_dpp v9, v9, v9 row_ror:1 row_mask:0xf bank_mask:0xf
    s_nop 0
    v_readlane_b32 s48, v9, 0
    v_readlane_b32 s49, v9, 16
    v_readlane_b32 s50, v9, 32
    v_readlane_b32 s51, v9, 48
    s_nop 0
    s_min_u32 s48, s48, s49
    s_min_u32 s50, s50, s51
    s_min_u32 s48, s48, s50
    s_sub_u32 s57, s57, s48
    v_writelane_b32 v8, s57, 2
    s_sub_u32 s57, s57, 1
    s_waitcnt vmcnt(2)
    s_add_u32 m0, s46, 11264
    s_add_u32 s38, s45, 172032
    buffer_load_dwordx4 v4, s[24:27], s38 offen lds
    v_sub_u32 v72, s57, v80
    v_sub_u32 v73, s57, v82
    v_sub_u32 v74, s57, v84
    v_sub_u32 v75, s57, v86
    v_sub_u32 v76, s57, v88
    v_sub_u32 v77, s57, v90
    v_sub_u32 v78, s57, v92
    v_sub_u32 v79, s57, v94
    v_min3_u32 v9, v72, v73, v74
    v_min3_u32 v15, v75, v76, v77
    v_min3_u32 v9, v9, v78, v79
    v_min_u32 v9, v9, v15
    s_nop 1
    v_min_u32_dpp v9, v9, v9 row_ror:8 row_mask:0xf bank_mask:0xf
    s_nop 1
    v_min_u32_dpp v9, v9, v9 row_ror:4 row_mask:0xf bank_mask:0xf
    s_nop 1
    v_min_u32_dpp v9, v9, v9 row_ror:2 row_mask:0xf bank_mask:0xf
    s_nop 1
    v_min_u32_dpp v9, v9, v9 row_ror:1 row_mask:0xf bank_mask:0xf
    s_nop 0
    v_readlane_b32 s48, v9, 0
    v_readlane_b32 s49, v9, 16
    v_readlane_b32 s50, v9, 32
    v_readlane_b32 s51, v9, 48
    s_nop 0
    s_min_u32 s48, s48, s49
    s_min_u32 s50, s50, s51
    s_min_u32 s48, s48, s50
    s_sub_u32 s57, s57, s48
    v_writelane_b32 v8, s57, 3
    s_sub_u32 s57, s57, 1
    s_waitcnt vmcnt(2)
    s_add_u32 m0, s46, 12288
    s_add_u32 s38, s45, 229376
    buffer_load_dwordx4 v4, s[24:27], s38 offen lds
    v_sub_u32 v72, s57, v80
    v_sub_u32 v73, s57, v82
    v_sub_u32 v74, s57, v84
    v_sub_u32 v75, s57, v86
    v_sub_u32 v76, s57, v88
    v_sub_u32 v77, s57, v90
    v_sub_u32 v78, s57, v92
    v_sub_u32 v79, s57, v94
    v_min3_u32 v9, v72, v73, v74
    v_min3_u32 v15, v75, v76, v77
    v_min3_u32 v9, v9, v78, v79
    v_min_u32 v9, v9, v15
    s_nop 1
    v_min_u32_dpp v9, v9, v9 row_ror:8 row_mask:0xf bank_mask:0xf
    s_nop 1
    v_min_u32_dpp v9, v9, v9 row_ror:4 row_mask:0xf bank_mask:0xf
    s_nop 1
    v_min_u32_dpp v9, v9, v9 row_ror:2 row_mask:0xf bank_mask:0xf
    s_nop 1
    v_min_u32_dpp v9, v9, v9 row_ror:1 row_mask:0xf bank_mask:0xf
    s_nop 0
    v_readlane_b32 s48, v9, 0
    v_readlane_b32 s49, v9, 16
    v_readlane_b32 s50, v9, 32
    v_readlane_b32 s51, v9, 48
    s_nop 0
    s_min_u32 s48, s48, s49
    s_min_u32 s50, s50, s51
    s_min_u32 s48, s48, s50
    s_sub_u32 s57, s57, s48
    v_writelane_b32 v8, s57, 4
    s_sub_u32 s57, s57, 1
    s_waitcnt vmcnt(2)
    s_add_u32 m0, s46, 13312
    s_add_u32 s38, s45, 286720
    buffer_load_dwordx4 v4, s[24:27], s38 offen lds
    v_sub_u32 v72, s57, v80
    v_sub_u32 v73, s57, v82
    v_sub_u32 v74, s57, v84
    v_sub_u32 v75, s57, v86
    v_sub_u32 v76, s57, v88
    v_sub_u32 v77, s57, v90
    v_sub_u32 v78, s57, v92
    v_sub_u32 v79, s57, v94
    v_min3_u32 v9, v72, v73, v74
    v_min3_u32 v15, v75, v76, v77
    v_min3_u32 v9, v9, v78, v79
    v_min_u32 v9, v9, v15
    s_nop 1
    v_min_u32_dpp v9, v9, v9 row_ror:8 row_mask:0xf bank_mask:0xf
    s_nop 1
    v_min_u32_dpp v9, v9, v9 row_ror:4 row_mask:0xf bank_mask:0xf
    s_nop 1
    v_min_u32_dpp v9, v9, v9 row_ror:2 row_mask:0xf bank_mask:0xf
    s_nop 1
    v_min_u32_dpp v9, v9, v9 row_ror:1 row_mask:0xf bank_mask:0xf
    s_nop 0
    v_readlane_b32 s48, v9, 0
    v_readlane_b32 s49, v9, 16
    v_readlane_b32 s50, v9, 32
    v_readlane_b32 s51, v9, 48
    s_nop 0
    s_min_u32 s48, s48, s49
    s_min_u32 s50, s50, s51
    s_min_u32 s48, s48, s50
    s_sub_u32 s57, s57, s48
    v_writelane_b32 v8, s57, 5
    s_sub_u32 s57, s57, 1
    s_waitcnt vmcnt(2)
    s_add_u32 m0, s46, 14336
    s_add_u32 s38, s45, 344064
    buffer_load_dwordx4 v4, s[24:27], s38 offen lds
    v_sub_u32 v72, s57, v80
    v_sub_u32 v73, s57, v82
    v_sub_u32 v74, s57, v84
    v_sub_u32 v75, s57, v86
    v_sub_u32 v76, s57, v88
    v_sub_u32 v77, s57, v90
    v_sub_u32 v78, s57, v92
    v_sub_u32 v79, s57, v94
    v_min3_u32 v9, v72, v73, v74
    v_min3_u32 v15, v75, v76, v77
    v_min3_u32 v9, v9, v78, v79
    v_min_u32 v9, v9, v15
    s_nop 1
    v_min_u32_dpp v9, v9, v9 row_ror:8 row_mask:0xf bank_mask:0xf
    s_nop 1
    v_min_u32_dpp v9, v9, v9 row_ror:4 row_mask:0xf bank_mask:0xf
    s_nop 1
    v_min_u32_dpp v9, v9, v9 row_ror:2 row_mask:0xf bank_mask:0xf
    s_nop 1
    v_min_u32_dpp v9, v9, v9 row_ror:1 row_mask:0xf bank_mask:0xf
    s_nop 0
    v_readlane_b32 s48, v9, 0
    v_readlane_b32 s49, v9, 16
    v_readlane_b32 s50, v9, 32
    v_readlane_b32 s51, v9, 48
    s_nop 0
    s_min_u32 s48, s48, s49
    s_min_u32 s50, s50, s51
    s_min_u32 s48, s48, s50
    s_sub_u32 s57, s57, s48
    v_writelane_b32 v8, s57, 6
    s_sub_u32 s57, s57, 1
    s_waitcnt vmcnt(2)
    s_add_u32 m0, s46, 15360
    s_add_u32 s38, s45, 401408
    buffer_load_dwordx4 v4, s[24:27], s38 offen lds
    v_sub_u32 v72, s57, v80
    v_sub_u32 v73, s57, v82
    v_sub_u32 v74, s57, v84
    v_sub_u32 v75, s57, v86
    v_sub_u32 v76, s57, v88
    v_sub_u32 v77, s57, v90
    v_sub_u32 v78, s57, v92
    v_sub_u32 v79, s57, v94
    v_min3_u32 v9, v72, v73, v74
    v_min3_u32 v15, v75, v76, v77
    v_min3_u32 v9, v9, v78, v79
    v_min_u32 v9, v9, v15
    s_nop 1
    v_min_u32_dpp v9, v9, v9 row_ror:8 row_mask:0xf bank_mask:0xf
    s_nop 1
    v_min_u32_dpp v9, v9, v9 row_ror:4 row_mask:0xf bank_mask:0xf
    s_nop 1
    v_min_u32_dpp v9, v9, v9 row_ror:2 row_mask:0xf bank_mask:0xf
    s_nop 1
    v_min_u32_dpp v9, v9, v9 row_ror:1 row_mask:0xf bank_mask:0xf
    s_nop 0
    v_readlane_b32 s48, v9, 0
    v_readlane_b32 s49, v9, 16
    v_readlane_b32 s50, v9, 32
    v_readlane_b32 s51, v9, 48
    s_nop 0
    s_min_u32 s48, s48, s49
    s_min_u32 s50, s50, s51
    s_min_u32 s48, s48, s50
    s_sub_u32 s57, s57, s48
    v_writelane_b32 v8, s57, 7
    s_sub_u32 s57, s57, 1
    s_lshl_b32 s38, s18, 5
    s_add_u32 s38, s38, 73792
    v_lshl_add_u32 v9, v2, 2, s38
    v_mov_b32 v14, 73736
    v_mov_b32 v15, 1
    s_mov_b64 exec, 0xff
    ds_write_b32 v9, v8
    s_mov_b64 exec, 1
    ds_add_u32 v14, v15
    s_mov_b64 exec, -1
L_s_cw:
    ds_read_b32 v15, v14
    s_waitcnt lgkmcnt(0)
    v_readfirstlane_b32 s38, v15
    s_nop 1
    s_cmp_ge_u32 s38, 4
    s_cbranch_scc1 L_s_cgo
    s_sub_u32 s96, s96, 1
    s_cbranch_scc1 L_s_cgo
    s_sleep 1
    s_branch L_s_cw
L_s_cgo:
    v_and_b32 v9, 31, v2
    v_lshlrev_b32 v9, 2, v9
    v_add_u32 v9, 73792, v9
    v_mov_b32 v15, 73792
    ds_read_b32 v14, v9
    ds_read_b128 v[64:67], v15 offset:0
    ds_read_b128 v[68:71], v15 offset:16
    ds_read_b128 v[72:75], v15 offset:32
    ds_read_b128 v[76:79], v15 offset:48
    ds_read_b128 v[80:83], v15 offset:64
    ds_read_b128 v[84:87], v15 offset:80
    ds_read_b128 v[88:91], v15 offset:96
    ds_read_b128 v[92:95], v15 offset:112
    v_mov_b32 v12, 0
    s_waitcnt lgkmcnt(0)
    v_cmp_gt_u32 s[48:49], v64, v14
    v_cmp_gt_u32 s[50:51], v65, v14
    s_nop 0
    v_addc_co_u32 v12, vcc, 0, v12, s[48:49]
    v_addc_co_u32 v12, vcc, 0, v12, s[50:51]
    v_cmp_gt_u32 s[48:49], v66, v14
    v_cmp_gt_u32 s[50:51], v67, v14
    s_nop 0
    v_addc_co_u32 v12, vcc, 0, v12, s[48:49]
    v_addc_co_u32 v12, vcc, 0, v12, s[50:51]
    v_cmp_gt_u32 s[48:49], v68, v14
    v_cmp_gt_u32 s[50:51], v69, v14
    s_nop 0
    v_addc_co_u32 v12, vcc, 0, v12, s[48:49]
    v_addc_co_u32 v12, vcc, 0, v12, s[50:51]
    v_cmp_gt_u32 s[48:49], v70, v14
    v_cmp_gt_u32 s[50:51], v71, v14
    s_nop 0
    v_addc_co_u32 v12, vcc, 0, v12, s[48:49]
    v_addc_co_u32 v12, vcc, 0, v12, s[50:51]
    v_cmp_gt_u32 s[48:49], v72, v14
    v_cmp_gt_u32 s[50:51], v73, v14
    s_nop 0
    v_addc_co_u32 v12, vcc, 0, v12, s[48:49]
    v_addc_co_u32 v12, vcc, 0, v12, s[50:51]
    v_cmp_gt_u32 s[48:49], v74, v14
    v_cmp_gt_u32 s[50:51], v75, v14
    s_nop 0
    v_addc_co_u32 v12, vcc, 0, v12, s[48:49]
    v_addc_co_u32 v12, vcc, 0, v12, s[50:51]
    v_cmp_gt_u32 s[48:49], v76, v14
    v_cmp_gt_u32 s[50:51], v77, v14
    s_nop 0
    v_addc_co_u32 v12, vcc, 0, v12, s[48:49]
    v_addc_co_u32 v12, vcc, 0, v12, s[50:51]
    v_cmp_gt_u32 s[48:49], v78, v14
    v_cmp_gt_u32 s[50:51], v79, v14
    s_nop 0
    v_addc_co_u32 v12, vcc, 0, v12, s[48:49]
    v_addc_co_u32 v12, vcc, 0, v12, s[50:51]
    v_cmp_gt_u32 s[48:49], v80, v14
    v_cmp_gt_u32 s[50:51], v81, v14
    s_nop 0
    v_addc_co_u32 v12, vcc, 0, v12, s[48:49]
    v_addc_co_u32 v12, vcc, 0, v12, s[50:51]
    v_cmp_gt_u32 s[48:49], v82, v14
    v_cmp_gt_u32 s[50:51], v83, v14
    s_nop 0
    v_addc_co_u32 v12, vcc, 0, v12, s[48:49]
    v_addc_co_u32 v12, vcc, 0, v12, s[50:51]
    v_cmp_gt_u32 s[48:49], v84, v14
    v_cmp_gt_u32 s[50:51], v85, v14
    s_nop 0
    v_addc_co_u32 v12, vcc, 0, v12, s[48:49]
    v_addc_co_u32 v12, vcc, 0, v12, s[50:51]
    v_cmp_gt_u32 s[48:49], v86, v14
    v_cmp_gt_u32 s[50:51], v87, v14
    s_nop 0
    v_addc_co_u32 v12, vcc, 0, v12, s[48:49]
    v_addc_co_u32 v12, vcc, 0, v12, s[50:51]
    v_cmp_gt_u32 s[48:49], v88, v14
    v_cmp_gt_u32 s[50:51], v89, v14
    s_nop 0
    v_addc_co_u32 v12, vcc, 0, v12, s[48:49]
    v_addc_co_u32 v12, vcc, 0, v12, s[50:51]
    v_cmp_gt_u32 s[48:49], v90, v14
    v_cmp_gt_u32 s[50:51], v91, v14
    s_nop 0
    v_addc_co_u32 v12, vcc, 0, v12, s[48:49]
    v_addc_co_u32 v12, vcc, 0, v12, s[50:51]
    v_cmp_gt_u32 s[48:49], v92, v14
    v_cmp_gt_u32 s[50:51], v93, v14
    s_nop 0
    v_addc_co_u32 v12, vcc, 0, v12, s[48:49]
    v_addc_co_u32 v12, vcc, 0, v12, s[50:51]
    v_cmp_gt_u32 s[48:49], v94, v14
    v_cmp_gt_u32 s[50:51], v95, v14
    s_nop 0
    v_addc_co_u32 v12, vcc, 0, v12, s[48:49]
    v_addc_co_u32 v12, vcc, 0, v12, s[50:51]
    v_lshlrev_b32 v12, 2, v12
    s_mov_b32 exec_hi, 0
    ds_permute_b32 v13, v12, v14
    s_mov_b64 exec, -1
    v_and_b32 v12, 7, v2
    v_lshlrev_b32 v12, 2, v12
    s_waitcnt lgkmcnt(0)
    ds_bpermute_b32 v8, v12, v13
    s_waitcnt lgkmcnt(0)
    s_or_b32 s38, s2, s18
    s_cbranch_scc1 L_s_noep
    s_mov_b64 exec, 1
    s_mov_b32 s38, 9469952
    v_mov_b32 v13, s93
    v_mov_b32 v9, 0
    buffer_store_dword v13, v9, s[12:15], s38 offen
    s_mov_b64 exec, -1
L_s_noep:
    v_and_b32 v9, 0x7ff, v8
    v_sub_u32 v9, 2047, v9
    v_lshlrev_b32 v9, 11, v9
    v_lshl_add_u32 v9, v10, 4, v9
    s_lshl_b32 s38, s44, 1
    s_and_b32 s38, s38, 2047
    buffer_load_dwordx4 v[64:67], v9, s[4:7], s38 offen offset:0
    buffer_load_dwordx4 v[68:71], v9, s[4:7], s38 offen offset:64
    s_waitcnt vmcnt(0)
    buffer_load_dwordx4 v[56:59], v3, s[32:35], s59 offen
    s_cmp_ge_u32 s2, 224
    s_cbranch_scc1 L_s_gudone
    ds_read_b64_tr_b16 v[100:101], v16 offset:0
    ds_read_b64_tr_b16 v[102:103], v16 offset:512
    ds_read_b64_tr_b16 v[104:105], v16 offset:4096
    ds_read_b64_tr_b16 v[106:107], v16 offset:4608
    ds_read_b64_tr_b16 v[108:109], v17 offset:0
    ds_read_b64_tr_b16 v[110:111], v17 offset:512
    ds_read_b64_tr_b16 v[112:113], v17 offset:4096
    ds_read_b64_tr_b16 v[114:115], v17 offset:4608
    ds_read_b64_tr_b16 v[116:117], v18 offset:0
    ds_read_b64_tr_b16 v[118:119], v18 offset:512
    ds_read_b64_tr_b16 v[120:121], v18 offset:4096
    ds_read_b64_tr_b16 v[122:123], v18 offset:4608
    ds_read_b64_tr_b16 v[124:125], v19 offset:0
    ds_read_b64_tr_b16 v[126:127], v19 offset:512
    ds_read_b64_tr_b16 v[128:129], v19 offset:4096
    ds_read_b64_tr_b16 v[130:131], v19 offset:4608
    s_waitcnt lgkmcnt(0)
    ds_read_b64_tr_b16 v[132:133], v16 offset:8192
    ds_read_b64_tr_b16 v[134:135], v16 offset:8704
    ds_read_b64_tr_b16 v[136:137], v16 offset:12288
    ds_read_b64_tr_b16 v[138:139], v16 offset:12800
    ds_read_b64_tr_b16 v[140:141], v17 offset:8192
    ds_read_b64_tr_b16 v[142:143], v17 offset:8704
    ds_read_b64_tr_b16 v[144:145], v17 offset:12288
    ds_read_b64_tr_b16 v[146:147], v17 offset:12800
    ds_read_b64_tr_b16 v[148:149], v18 offset:8192
    ds_read_b64_tr_b16 v[150:151], v18 offset:8704
    ds_read_b64_tr_b16 v[152:153], v18 offset:12288
    ds_read_b64_tr_b16 v[154:155], v18 offset:12800
    ds_read_b64_tr_b16 v[156:157], v19 offset:8192
    ds_read_b64_tr_b16 v[158:159], v19 offset:8704
    ds_read_b64_tr_b16 v[160:161], v19 offset:12288
    ds_read_b64_tr_b16 v[162:163], v19 offset:12800
    s_waitcnt lgkmcnt(0)
    v_mfma_f32_16x16x32_bf16 v[24:27], v[100:103], v[64:67], 0
    v_mfma_f32_16x16x32_bf16 v[28:31], v[108:111], v[64:67], 0
    v_mfma_f32_16x16x32_bf16 v[32:35], v[116:119], v[64:67], 0
    v_mfma_f32_16x16x32_bf16 v[36:39], v[124:127], v[64:67], 0
    v_mfma_f32_16x16x32_bf16 v[40:43], v[132:135], v[64:67], 0
    v_mfma_f32_16x16x32_bf16 v[44:47], v[140:143], v[64:67], 0
    v_mfma_f32_16x16x32_bf16 v[48:51], v[148:151], v[64:67], 0
    v_mfma_f32_16x16x32_bf16 v[52:55], v[156:159], v[64:67], 0
    v_mfma_f32_16x16x32_bf16 v[24:27], v[104:107], v[68:71], v[24:27]
    v_mfma_f32_16x16x32_bf16 v[28:31], v[112:115], v[68:71], v[28:31]
    v_mfma_f32_16x16x32_bf16 v[32:35], v[120:123], v[68:71], v[32:35]
    v_mfma_f32_16x16x32_bf16 v[36:39], v[128:131], v[68:71], v[36:39]
    v_mfma_f32_16x16x32_bf16 v[40:43], v[136:139], v[68:71], v[40:43]
    v_mfma_f32_16x16x32_bf16 v[44:47], v[144:147], v[68:71], v[44:47]
    v_mfma_f32_16x16x32_bf16 v[48:51], v[152:155], v[68:71], v[48:51]
    v_mfma_f32_16x16x32_bf16 v[52:55], v[160:163], v[68:71], v[52:55]
    v_add_u32 v13, s46, v3
    v_mov_b32 v14, 73728
    v_mov_b32 v15, 1
    s_nop 7
    ds_write_b128 v13, v[24:27] offset:0
    ds_write_b128 v13, v[28:31] offset:1024
    ds_write_b128 v13, v[32:35] offset:2048
    ds_write_b128 v13, v[36:39] offset:3072
    ds_write_b128 v13, v[40:43] offset:4096
    ds_write_b128 v13, v[44:47] offset:5120
    ds_write_b128 v13, v[48:51] offset:6144
    ds_write_b128 v13, v[52:55] offset:7168
    s_waitcnt lgkmcnt(0)
    s_mov_b64 exec, 1
    ds_add_rtn_u32 v15, v14, v15
    s_mov_b64 exec, -1
    s_waitcnt lgkmcnt(0)
    v_readfirstlane_b32 s47, v15
    s_nop 1
    s_cmp_lg_u32 s47, 3
    s_cbranch_scc1 L_s_gudone
    v_add_u32 v13, 98304, v3
    ds_read_b128 v[100:103], v13 offset:0
    ds_read_b128 v[104:107], v13 offset:1024
    ds_read_b128 v[108:111], v13 offset:2048
    ds_read_b128 v[112:115], v13 offset:3072
    ds_read_b128 v[116:119], v13 offset:4096
    ds_read_b128 v[120:123], v13 offset:5120
    ds_read_b128 v[124:127], v13 offset:6144
    ds_read_b128 v[128:131], v13 offset:7168
    ds_read_b128 v[132:135], v13 offset:16384
    ds_read_b128 v[136:139], v13 offset:17408
    ds_read_b128 v[140:143], v13 offset:18432
    ds_read_b128 v[144:147], v13 offset:19456
    ds_read_b128 v[148:151], v13 offset:20480
    ds_read_b128 v[152:155], v13 offset:21504
    ds_read_b128 v[156:159], v13 offset:22528
    ds_read_b128 v[160:163], v13 offset:23552
    s_waitcnt lgkmcnt(0)
    ds_read_b128 v[164:167], v13 offset:32768
    ds_read_b128 v[168:171], v13 offset:33792
    ds_read_b128 v[172:175], v13 offset:34816
    ds_read_b128 v[176:179], v13 offset:35840
    ds_read_b128 v[180:183], v13 offset:36864
    ds_read_b128 v[184:187], v13 offset:37888
    ds_read_b128 v[188:191], v13 offset:38912
    ds_read_b128 v[192:195], v13 offset:39936
    ds_read_b128 v[196:199], v13 offset:49152
    ds_read_b128 v[200:203], v13 offset:50176
    ds_read_b128 v[204:207], v13 offset:51200
    ds_read_b128 v[208:211], v13 offset:52224
    ds_read_b128 v[212:215], v13 offset:53248
    ds_read_b128 v[216:219], v13 offset:54272
    ds_read_b128 v[220:223], v13 offset:55296
    ds_read_b128 v[224:227], v13 offset:56320
    s_waitcnt lgkmcnt(0)
    v_pk_add_f32 v[100:101], v[100:101], v[132:133]
    v_pk_add_f32 v[164:165], v[164:165], v[196:197]
    v_pk_add_f32 v[100:101], v[100:101], v[164:165]
    v_pk_add_f32 v[102:103], v[102:103], v[134:135]
    v_pk_add_f32 v[166:167], v[166:167], v[198:199]
    v_pk_add_f32 v[102:103], v[102:103], v[166:167]
    v_pk_add_f32 v[104:105], v[104:105], v[136:137]
    v_pk_add_f32 v[168:169], v[168:169], v[200:201]
    v_pk_add_f32 v[104:105], v[104:105], v[168:169]
    v_pk_add_f32 v[106:107], v[106:107], v[138:139]
    v_pk_add_f32 v[170:171], v[170:171], v[202:203]
    v_pk_add_f32 v[106:107], v[106:107], v[170:171]
    v_pk_add_f32 v[108:109], v[108:109], v[140:141]
    v_pk_add_f32 v[172:173], v[172:173], v[204:205]
    v_pk_add_f32 v[108:109], v[108:109], v[172:173]
    v_pk_add_f32 v[110:111], v[110:111], v[142:143]
    v_pk_add_f32 v[174:175], v[174:175], v[206:207]
    v_pk_add_f32 v[110:111], v[110:111], v[174:175]
    v_pk_add_f32 v[112:113], v[112:113], v[144:145]
    v_pk_add_f32 v[176:177], v[176:177], v[208:209]
    v_pk_add_f32 v[112:113], v[112:113], v[176:177]
    v_pk_add_f32 v[114:115], v[114:115], v[146:147]
    v_pk_add_f32 v[178:179], v[178:179], v[210:211]
    v_pk_add_f32 v[114:115], v[114:115], v[178:179]
    v_pk_add_f32 v[116:117], v[116:117], v[148:149]
    v_pk_add_f32 v[180:181], v[180:181], v[212:213]
    v_pk_add_f32 v[116:117], v[116:117], v[180:181]
    v_pk_add_f32 v[118:119], v[118:119], v[150:151]
    v_pk_add_f32 v[182:183], v[182:183], v[214:215]
    v_pk_add_f32 v[118:119], v[118:119], v[182:183]
    v_pk_add_f32 v[120:121], v[120:121], v[152:153]
    v_pk_add_f32 v[184:185], v[184:185], v[216:217]
    v_pk_add_f32 v[120:121], v[120:121], v[184:185]
    v_pk_add_f32 v[122:123], v[122:123], v[154:155]
    v_pk_add_f32 v[186:187], v[186:187], v[218:219]
    v_pk_add_f32 v[122:123], v[122:123], v[186:187]
    v_pk_add_f32 v[124:125], v[124:125], v[156:157]
    v_pk_add_f32 v[188:189], v[188:189], v[220:221]
    v_pk_add_f32 v[124:125], v[124:125], v[188:189]
    v_pk_add_f32 v[126:127], v[126:127], v[158:159]
    v_pk_add_f32 v[190:191], v[190:191], v[222:223]
    v_pk_add_f32 v[126:127], v[126:127], v[190:191]
    v_pk_add_f32 v[128:129], v[128:129], v[160:161]
    v_pk_add_f32 v[192:193], v[192:193], v[224:225]
    v_pk_add_f32 v[128:129], v[128:129], v[192:193]
    v_pk_add_f32 v[130:131], v[130:131], v[162:163]
    v_pk_add_f32 v[194:195], v[194:195], v[226:227]
    v_pk_add_f32 v[130:131], v[130:131], v[194:195]
    v_mul_u32_u24 v13, 14336, v11
    v_lshl_add_u32 v13, v10, 4, v13
    s_mul_i32 s38, s23, 229376
    s_lshl_b32 s39, s22, 8
    s_add_u32 s38, s38, s39
    s_add_u32 s38, s38, 10485760
    s_add_u32 s39, s38, 114688
    v_cmp_gt_u32 vcc, 8, v11
    s_nop 1
    s_mov_b64 exec, vcc
    buffer_store_dwordx4 v[100:103], v13, s[12:15], s38 offen offset:0 sc1
    buffer_store_dwordx4 v[104:107], v13, s[12:15], s38 offen offset:64 sc1
    buffer_store_dwordx4 v[108:111], v13, s[12:15], s38 offen offset:128 sc1
    buffer_store_dwordx4 v[112:115], v13, s[12:15], s38 offen offset:192 sc1
    buffer_store_dwordx4 v[116:119], v13, s[12:15], s39 offen offset:0 sc1
    buffer_store_dwordx4 v[120:123], v13, s[12:15], s39 offen offset:64 sc1
    buffer_store_dwordx4 v[124:127], v13, s[12:15], s39 offen offset:128 sc1
    buffer_store_dwordx4 v[128:131], v13, s[12:15], s39 offen offset:192 sc1
    s_mov_b64 exec, -1
L_s_gudone:
    s_barrier
    v_lshlrev_b32 v9, 2, v2
    v_add_u32 v9, 102400, v9
    s_mov_b64 exec, 0xff
    ds_write_b32 v9, v8
    s_mov_b64 exec, -1
    s_mov_b32 s59, 12
    s_cmp_ge_u32 s2, 224
    s_cbranch_scc1 L_s_cons
    s_barrier
    s_cmp_lg_u32 s47, 3
    s_cbranch_scc1 L_s_nogf
    s_waitcnt vmcnt(0)
    s_lshl_b32 s38, s22, 10
    s_lshl_b32 s39, s23, 8
    s_add_u32 s38, s38, s39
    s_add_u32 s38, s38, 9568256
    v_mov_b32 v13, s93
    v_lshlrev_b32 v14, 2, v2
    s_mov_b32 exec_hi, 0
    buffer_store_dword v13, v14, s[12:15], s38 offen sc1
    s_mov_b32 exec_hi, -1
L_s_nogf:
    s_lshr_b32 s58, s2, 3
    s_and_b32 s58, s58, 1
    s_sub_u32 s59, s59, s58
    s_sub_u32 s59, s59, 8
L_s_pre_l:
    s_cmp_eq_u32 s58, 0
    s_cbranch_scc1 L_s_pre_d
    s_barrier
    s_sub_u32 s58, s58, 1
    s_branch L_s_pre_l
L_s_pre_d:
    s_lshl_b32 s38, s22, 17
    s_lshl_b32 s39, s23, 9
    s_add_u32 s38, s38, s39
    s_lshl_b32 s39, s18, 7
    s_add_u32 s38, s38, s39
    s_add_u32 m0, s46, 8192
    s_nop 0
    buffer_load_dwordx4 v5, s[28:31], s38 offen lds
    s_add_u32 s38, s38, 16384
    s_add_u32 m0, s46, 9216
    s_nop 0
    buffer_load_dwordx4 v5, s[28:31], s38 offen lds
    s_add_u32 s38, s38, 16384
    s_add_u32 m0, s46, 10240
    s_nop 0
    buffer_load_dwordx4 v5, s[28:31], s38 offen lds
    s_add_u32 s38, s38, 16384
    s_add_u32 m0, s46, 11264
    s_nop 0
    buffer_load_dwordx4 v5, s[28:31], s38 offen lds
    s_add_u32 s38, s38, 16384
    s_add_u32 m0, s46, 12288
    s_nop 0
    buffer_load_dwordx4 v5, s[28:31], s38 offen lds
    s_add_u32 s38, s38, 16384
    s_add_u32 m0, s46, 13312
    s_nop 0
    buffer_load_dwordx4 v5, s[28:31], s38 offen lds
    s_add_u32 s38, s38, 16384
    s_add_u32 m0, s46, 14336
    s_nop 0
    buffer_load_dwordx4 v5, s[28:31], s38 offen lds
    s_add_u32 s38, s38, 16384
    s_add_u32 m0, s46, 15360
    s_nop 0
    buffer_load_dwordx4 v5, s[28:31], s38 offen lds
    s_add_u32 s38, s38, 16384
    s_barrier
    s_lshl_b32 s56, s22, 10
    s_add_u32 s56, s56, 9568256
    v_and_b32 v13, 3, v2
    v_lshlrev_b32 v13, 8, v13
    buffer_load_dword v14, v13, s[12:15], s56 offen sc1
    v_and_b32 v1, 255, v0
    v_lshrrev_b32 v6, 5, v1
    v_and_b32 v7, 31, v1
    v_mul_u32_u24 v9, 14336, v6
    v_lshl_add_u32 v9, v7, 3, v9
    s_barrier
L_s_gpoll:
    s_waitcnt vmcnt(0)
    v_cmp_ne_u32 vcc, s93, v14
    s_nop 1
    s_cmp_eq_u64 vcc, 0
    s_cbranch_scc1 L_s_ggo
    s_sub_u32 s96, s96, 1
    s_cbranch_scc1 L_s_ggo
    s_sleep 4
    buffer_load_dword v14, v13, s[12:15], s56 offen sc1
    s_branch L_s_gpoll
L_s_ggo:
    s_lshl_b32 s38, s22, 8
    s_add_u32 s38, s38, 10485760
    buffer_load_dwordx2 v[24:25], v9, s[12:15], s38 offen sc1
    s_add_u32 s38, s38, 114688
    buffer_load_dwordx2 v[26:27], v9, s[12:15], s38 offen sc1
    s_add_u32 s38, s38, 114688
    buffer_load_dwordx2 v[28:29], v9, s[12:15], s38 offen sc1
    s_add_u32 s38, s38, 114688
    buffer_load_dwordx2 v[30:31], v9, s[12:15], s38 offen sc1
    s_add_u32 s38, s38, 114688
    buffer_load_dwordx2 v[32:33], v9, s[12:15], s38 offen sc1
    s_add_u32 s38, s38, 114688
    buffer_load_dwordx2 v[34:35], v9, s[12:15], s38 offen sc1
    s_add_u32 s38, s38, 114688
    buffer_load_dwordx2 v[36:37], v9, s[12:15], s38 offen sc1
    s_add_u32 s38, s38, 114688
    buffer_load_dwordx2 v[38:39], v9, s[12:15], s38 offen sc1
    s_add_u32 s38, s38, 114688
    s_barrier
    s_barrier
    s_waitcnt vmcnt(0)
    v_add_f32 v24, v24, v28
    v_add_f32 v32, v32, v36
    v_add_f32 v24, v24, v32
    v_cvt_pk_bf16_f32 v24, v24, v24
    v_lshlrev_b32 v24, 16, v24
    v_add_f32 v25, v25, v29
    v_add_f32 v33, v33, v37
    v_add_f32 v25, v25, v33
    v_cvt_pk_bf16_f32 v25, v25, v25
    v_lshlrev_b32 v25, 16, v25
    v_add_f32 v26, v26, v30
    v_add_f32 v34, v34, v38
    v_add_f32 v26, v26, v34
    v_cvt_pk_bf16_f32 v26, v26, v26
    v_lshlrev_b32 v26, 16, v26
    v_add_f32 v27, v27, v31
    v_add_f32 v35, v35, v39
    v_add_f32 v27, v27, v35
    v_cvt_pk_bf16_f32 v27, v27, v27
    v_lshlrev_b32 v27, 16, v27
    v_mul_f32 v40, 0xbfb8aa3b, v24
    v_exp_f32 v40, v40
    s_nop 0
    v_add_f32 v40, 1.0, v40
    v_rcp_f32 v40, v40
    s_nop 0
    v_mul_f32 v40, v40, v24
    v_cvt_pk_bf16_f32 v40, v40, v40
    v_lshlrev_b32 v40, 16, v40
    v_mul_f32 v40, v40, v26
    v_mul_f32 v41, 0xbfb8aa3b, v25
    v_exp_f32 v41, v41
    s_nop 0
    v_add_f32 v41, 1.0, v41
    v_rcp_f32 v41, v41
    s_nop 0
    v_mul_f32 v41, v41, v25
    v_cvt_pk_bf16_f32 v41, v41, v41
    v_lshlrev_b32 v41, 16, v41
    v_mul_f32 v41, v41, v27
    v_cvt_pk_bf16_f32 v40, v40, v41
    v_mul_u32_u24 v9, 144, v6
    v_lshl_add_u32 v9, v7, 2, v9
    v_add_u32 v9, 98304, v9
    ds_write_b32 v9, v40
    v_and_b32 v9, 7, v2
    v_mul_u32_u24 v9, 144, v9
    v_lshl_add_u32 v9, v10, 4, v9
    v_add_u32 v9, 98304, v9
    ds_read_b64_tr_b16 v[64:65], v16 offset:8192
    ds_read_b64_tr_b16 v[66:67], v16 offset:8704
    ds_read_b64_tr_b16 v[68:69], v16 offset:12288
    ds_read_b64_tr_b16 v[70:71], v16 offset:12800
    ds_read_b64_tr_b16 v[72:73], v17 offset:8192
    ds_read_b64_tr_b16 v[74:75], v17 offset:8704
    ds_read_b64_tr_b16 v[76:77], v17 offset:12288
    ds_read_b64_tr_b16 v[78:79], v17 offset:12800
    ds_read_b64_tr_b16 v[80:81], v18 offset:8192
    ds_read_b64_tr_b16 v[82:83], v18 offset:8704
    ds_read_b64_tr_b16 v[84:85], v18 offset:12288
    ds_read_b64_tr_b16 v[86:87], v18 offset:12800
    ds_read_b64_tr_b16 v[88:89], v19 offset:8192
    ds_read_b64_tr_b16 v[90:91], v19 offset:8704
    ds_read_b64_tr_b16 v[92:93], v19 offset:12288
    ds_read_b64_tr_b16 v[94:95], v19 offset:12800
    s_waitcnt lgkmcnt(0)
    s_barrier
    ds_read_b128 v[40:43], v9
    ds_read_b128 v[44:47], v9 offset:64
    s_mov_b32 s38, 229376
    v_mul_lo_u32 v15, v11, s38
    v_lshl_add_u32 v15, v10, 4, v15
    s_lshl_b32 s38, s22, 12
    s_lshl_b32 s39, s23, 10
    s_add_u32 s38, s38, s39
    s_lshl_b32 s39, s18, 8
    s_add_u32 s38, s38, s39
    s_add_u32 s38, s38, 13631488
    v_cmp_gt_u32 vcc, 8, v11
    s_waitcnt lgkmcnt(0)
    v_mfma_f32_16x16x32_bf16 v[48:51], v[64:67], v[40:43], 0
    v_mfma_f32_16x16x32_bf16 v[52:55], v[72:75], v[40:43], 0
    v_mfma_f32_16x16x32_bf16 v[56:59], v[80:83], v[40:43], 0
    v_mfma_f32_16x16x32_bf16 v[60:63], v[88:91], v[40:43], 0
    v_mfma_f32_16x16x32_bf16 v[48:51], v[68:71], v[44:47], v[48:51]
    v_mfma_f32_16x16x32_bf16 v[52:55], v[76:79], v[44:47], v[52:55]
    v_mfma_f32_16x16x32_bf16 v[56:59], v[84:87], v[44:47], v[56:59]
    v_mfma_f32_16x16x32_bf16 v[60:63], v[92:95], v[44:47], v[60:63]
    s_nop 7
    s_mov_b64 exec, vcc
    buffer_store_dwordx4 v[48:51], v15, s[12:15], s38 offen offset:0 sc1
    buffer_store_dwordx4 v[52:55], v15, s[12:15], s38 offen offset:64 sc1
    buffer_store_dwordx4 v[56:59], v15, s[12:15], s38 offen offset:128 sc1
    buffer_store_dwordx4 v[60:63], v15, s[12:15], s38 offen offset:192 sc1
    s_mov_b64 exec, -1
    s_lshl_b32 s38, s23, 14
    s_lshl_b32 s39, s22, 8
    s_add_u32 s38, s38, s39
    s_add_u32 s38, s38, 9633792
    v_mov_b32 v13, s93
    v_lshlrev_b32 v14, 2, v2
    s_barrier
    s_waitcnt vmcnt(0)
    s_barrier
    s_cmp_lg_u32 s18, 0
    s_cbranch_scc1 L_s_cons
    s_mov_b32 exec_hi, 0
    buffer_store_dword v13, v14, s[12:15], s38 offen sc1
    s_mov_b32 exec_hi, -1
L_s_cons:
    s_add_u32 s38, s18, 4
    v_readlane_b32 s24, v8, s18
    v_readlane_b32 s25, v8, s38
    s_lshl_b32 s45, s16, 7
    s_and_b32 s26, s24, 0x7ff
    s_sub_u32 s26, 2047, s26
    s_sub_u32 s56, s26, s45
    s_and_b32 s27, s25, 0x7ff
    s_sub_u32 s27, 2047, s27
    s_sub_u32 s57, s27, s45
    s_waitcnt lgkmcnt(0)
    s_min_u32 s38, s56, s57
    s_cmp_ge_u32 s38, 128
    s_cbranch_scc1 L_s_end
L_s_cb_l:
    s_cmp_eq_u32 s59, 0
    s_cbranch_scc1 L_s_cb_d
    s_barrier
    s_sub_u32 s59, s59, 1
    s_branch L_s_cb_l
L_s_cb_d:
    s_lshr_b32 s58, s17, 2
    s_lshl_b32 s58, s58, 14
    s_add_u32 s58, s58, 9633792
    v_min_u32 v4, 55, v2
    v_lshlrev_b32 v4, 8, v4
    buffer_load_dword v5, v4, s[12:15], s58 offen sc1
    v_lshlrev_b32 v6, 12, v10
    v_lshl_add_u32 v6, v11, 4, v6
    v_lshlrev_b32 v9, 3, v11
    v_mov_b32 v7, 0
    s_barrier
L_s_ypoll:
    s_waitcnt vmcnt(0)
    v_cmp_ne_u32 vcc, s93, v5
    s_nop 1
    s_cmp_eq_u64 vcc, 0
    s_cbranch_scc1 L_s_ygo
    s_sub_u32 s96, s96, 1
    s_cbranch_scc1 L_s_ygo
    s_sleep 4
    buffer_load_dword v5, v4, s[12:15], s58 offen sc1
    s_branch L_s_ypoll
L_s_ygo:
    s_cmp_ge_u32 s56, 128
    s_cbranch_scc1 L_s_sk0
    s_add_u32 s39, s18, 0
    s_mul_i32 s39, s39, 229376
    s_lshl_b32 s3, s17, 8
    s_add_u32 s39, s39, s3
    s_add_u32 s39, s39, 13631488
    buffer_load_dwordx4 v[20:23], v6, s[12:15], s39 offen sc1
    s_add_u32 s39, s39, 16384
    buffer_load_dwordx4 v[24:27], v6, s[12:15], s39 offen sc1
    s_add_u32 s39, s39, 16384
    buffer_load_dwordx4 v[28:31], v6, s[12:15], s39 offen sc1
    s_add_u32 s39, s39, 16384
    buffer_load_dwordx4 v[32:35], v6, s[12:15], s39 offen sc1
    s_add_u32 s39, s39, 16384
    buffer_load_dwordx4 v[36:39], v6, s[12:15], s39 offen sc1
    s_add_u32 s39, s39, 16384
    buffer_load_dwordx4 v[40:43], v6, s[12:15], s39 offen sc1
    s_add_u32 s39, s39, 16384
    buffer_load_dwordx4 v[44:47], v6, s[12:15], s39 offen sc1
    s_add_u32 s39, s39, 16384
    buffer_load_dwordx4 v[48:51], v6, s[12:15], s39 offen sc1
    s_add_u32 s39, s39, 16384
    buffer_load_dwordx4 v[52:55], v6, s[12:15], s39 offen sc1
    s_add_u32 s39, s39, 16384
    buffer_load_dwordx4 v[56:59], v6, s[12:15], s39 offen sc1
    s_add_u32 s39, s39, 16384
    buffer_load_dwordx4 v[60:63], v6, s[12:15], s39 offen sc1
    s_add_u32 s39, s39, 16384
    buffer_load_dwordx4 v[64:67], v6, s[12:15], s39 offen sc1
    s_add_u32 s39, s39, 16384
    buffer_load_dwordx4 v[68:71], v6, s[12:15], s39 offen sc1
    s_add_u32 s39, s39, 16384
    buffer_load_dwordx4 v[72:75], v6, s[12:15], s39 offen sc1
    s_add_u32 s39, s39, 16384
    s_lshl_b32 s39, s26, 11
    s_lshl_b32 s3, s17, 7
    s_add_u32 s39, s39, s3
    buffer_load_dwordx2 v[76:77], v9, s[4:7], s39 offen
    s_lshl_b32 s39, s26, 3
    s_add_u32 s39, s39, 9453568
    buffer_load_dword v78, v7, s[12:15], s39 offen sc1
L_s_sk0:
    s_cmp_ge_u32 s57, 128
    s_cbranch_scc1 L_s_sk1
    s_add_u32 s39, s18, 4
    s_mul_i32 s39, s39, 229376
    s_lshl_b32 s3, s17, 8
    s_add_u32 s39, s39, s3
    s_add_u32 s39, s39, 13631488
    buffer_load_dwordx4 v[84:87], v6, s[12:15], s39 offen sc1
    s_add_u32 s39, s39, 16384
    buffer_load_dwordx4 v[88:91], v6, s[12:15], s39 offen sc1
    s_add_u32 s39, s39, 16384
    buffer_load_dwordx4 v[92:95], v6, s[12:15], s39 offen sc1
    s_add_u32 s39, s39, 16384
    buffer_load_dwordx4 v[96:99], v6, s[12:15], s39 offen sc1
    s_add_u32 s39, s39, 16384
    buffer_load_dwordx4 v[100:103], v6, s[12:15], s39 offen sc1
    s_add_u32 s39, s39, 16384
    buffer_load_dwordx4 v[104:107], v6, s[12:15], s39 offen sc1
    s_add_u32 s39, s39, 16384
    buffer_load_dwordx4 v[108:111], v6, s[12:15], s39 offen sc1
    s_add_u32 s39, s39, 16384
    buffer_load_dwordx4 v[112:115], v6, s[12:15], s39 offen sc1
    s_add_u32 s39, s39, 16384
    buffer_load_dwordx4 v[116:119], v6, s[12:15], s39 offen sc1
    s_add_u32 s39, s39, 16384
    buffer_load_dwordx4 v[120:123], v6, s[12:15], s39 offen sc1
    s_add_u32 s39, s39, 16384
    buffer_load_dwordx4 v[124:127], v6, s[12:15], s39 offen sc1
    s_add_u32 s39, s39, 16384
    buffer_load_dwordx4 v[128:131], v6, s[12:15], s39 offen sc1
    s_add_u32 s39, s39, 16384
    buffer_load_dwordx4 v[132:135], v6, s[12:15], s39 offen sc1
    s_add_u32 s39, s39, 16384
    buffer_load_dwordx4 v[136:139], v6, s[12:15], s39 offen sc1
    s_add_u32 s39, s39, 16384
    s_lshl_b32 s39, s27, 11
    s_lshl_b32 s3, s17, 7
    s_add_u32 s39, s39, s3
    buffer_load_dwordx2 v[140:141], v9, s[4:7], s39 offen
    s_lshl_b32 s39, s27, 3
    s_add_u32 s39, s39, 9453568
    buffer_load_dword v142, v7, s[12:15], s39 offen sc1
L_s_sk1:
    s_barrier
    s_barrier
    s_waitcnt vmcnt(0)
    s_cmp_ge_u32 s56, 128
    s_cbranch_scc1 L_s_sc0
    s_ashr_i32 s39, s24, 31
    s_not_b32 s39, s39
    s_or_b32 s39, s39, 0x80000000
    s_xor_b32 s39, s24, s39
    s_and_b32 s39, s39, 0xffff0000
    v_mov_b32 v82, s39
    v_mul_f32 v79, 0xbfb8aa3b, v82
    v_exp_f32 v79, v79
    s_nop 0
    v_add_f32 v79, 1.0, v79
    v_rcp_f32 v79, v79
    s_nop 0
    v_cvt_pk_bf16_f32 v79, v79, v79
    v_lshlrev_b32 v79, 16, v79
    v_pk_add_f32 v[20:21], v[20:21], v[24:25]
    v_pk_add_f32 v[22:23], v[22:23], v[26:27]
    v_pk_add_f32 v[20:21], v[20:21], v[28:29]
    v_pk_add_f32 v[22:23], v[22:23], v[30:31]
    v_pk_add_f32 v[20:21], v[20:21], v[32:33]
    v_pk_add_f32 v[22:23], v[22:23], v[34:35]
    v_pk_add_f32 v[20:21], v[20:21], v[36:37]
    v_pk_add_f32 v[22:23], v[22:23], v[38:39]
    v_pk_add_f32 v[20:21], v[20:21], v[40:41]
    v_pk_add_f32 v[22:23], v[22:23], v[42:43]
    v_pk_add_f32 v[20:21], v[20:21], v[44:45]
    v_pk_add_f32 v[22:23], v[22:23], v[46:47]
    v_pk_add_f32 v[20:21], v[20:21], v[48:49]
    v_pk_add_f32 v[22:23], v[22:23], v[50:51]
    v_pk_add_f32 v[20:21], v[20:21], v[52:53]
    v_pk_add_f32 v[22:23], v[22:23], v[54:55]
    v_pk_add_f32 v[20:21], v[20:21], v[56:57]
    v_pk_add_f32 v[22:23], v[22:23], v[58:59]
    v_pk_add_f32 v[20:21], v[20:21], v[60:61]
    v_pk_add_f32 v[22:23], v[22:23], v[62:63]
    v_pk_add_f32 v[20:21], v[20:21], v[64:65]
    v_pk_add_f32 v[22:23], v[22:23], v[66:67]
    v_pk_add_f32 v[20:21], v[20:21], v[68:69]
    v_pk_add_f32 v[22:23], v[22:23], v[70:71]
    v_pk_add_f32 v[20:21], v[20:21], v[72:73]
    v_pk_add_f32 v[22:23], v[22:23], v[74:75]
    v_mov_b32 v24, v20
    v_mov_b32 v25, v21
    v_mov_b32 v26, v22
    v_mov_b32 v27, v23
    s_nop 1
    v_permlane16_swap_b32 v20, v24
    v_permlane16_swap_b32 v21, v25
    v_permlane16_swap_b32 v22, v26
    v_permlane16_swap_b32 v23, v27
    s_nop 1
    v_add_f32 v20, v20, v24
    v_add_f32 v21, v21, v25
    v_add_f32 v22, v22, v26
    v_add_f32 v23, v23, v27
    v_mov_b32 v24, v20
    v_mov_b32 v25, v21
    v_mov_b32 v26, v22
    v_mov_b32 v27, v23
    s_nop 1
    v_permlane32_swap_b32 v20, v24
    v_permlane32_swap_b32 v21, v25
    v_permlane32_swap_b32 v22, v26
    v_permlane32_swap_b32 v23, v27
    s_nop 1
    v_add_f32 v20, v20, v24
    v_add_f32 v21, v21, v25
    v_add_f32 v22, v22, v26
    v_add_f32 v23, v23, v27
    v_sub_f32 v78, 1.0, v78
    v_cvt_pk_bf16_f32 v78, v78, v78
    v_lshlrev_b32 v78, 16, v78
    v_lshlrev_b32 v28, 16, v76
    v_and_b32 v29, s21, v76
    v_lshlrev_b32 v30, 16, v77
    v_and_b32 v31, s21, v77
    v_cvt_pk_bf16_f32 v20, v20, v20
    v_lshlrev_b32 v20, 16, v20
    v_mul_f32 v20, v20, v79
    v_cvt_pk_bf16_f32 v20, v20, v20
    v_lshlrev_b32 v20, 16, v20
    v_add_f32 v20, v20, v28
    v_cvt_pk_bf16_f32 v20, v20, v20
    v_lshlrev_b32 v20, 16, v20
    v_mul_f32 v20, v20, v78
    v_cvt_pk_bf16_f32 v20, v20, v20
    v_lshlrev_b32 v20, 16, v20
    v_mul_f32 v28, v28, v78
    v_cvt_pk_bf16_f32 v28, v28, v28
    v_lshlrev_b32 v28, 16, v28
    v_sub_f32 v20, v20, v28
    v_cvt_pk_bf16_f32 v21, v21, v21
    v_lshlrev_b32 v21, 16, v21
    v_mul_f32 v21, v21, v79
    v_cvt_pk_bf16_f32 v21, v21, v21
    v_lshlrev_b32 v21, 16, v21
    v_add_f32 v21, v21, v29
    v_cvt_pk_bf16_f32 v21, v21, v21
    v_lshlrev_b32 v21, 16, v21
    v_mul_f32 v21, v21, v78
    v_cvt_pk_bf16_f32 v21, v21, v21
    v_lshlrev_b32 v21, 16, v21
    v_mul_f32 v29, v29, v78
    v_cvt_pk_bf16_f32 v29, v29, v29
    v_lshlrev_b32 v29, 16, v29
    v_sub_f32 v21, v21, v29
    v_cvt_pk_bf16_f32 v22, v22, v22
    v_lshlrev_b32 v22, 16, v22
    v_mul_f32 v22, v22, v79
    v_cvt_pk_bf16_f32 v22, v22, v22
    v_lshlrev_b32 v22, 16, v22
    v_add_f32 v22, v22, v30
    v_cvt_pk_bf16_f32 v22, v22, v22
    v_lshlrev_b32 v22, 16, v22
    v_mul_f32 v22, v22, v78
    v_cvt_pk_bf16_f32 v22, v22, v22
    v_lshlrev_b32 v22, 16, v22
    v_mul_f32 v30, v30, v78
    v_cvt_pk_bf16_f32 v30, v30, v30
    v_lshlrev_b32 v30, 16, v30
    v_sub_f32 v22, v22, v30
    v_cvt_pk_bf16_f32 v23, v23, v23
    v_lshlrev_b32 v23, 16, v23
    v_mul_f32 v23, v23, v79
    v_cvt_pk_bf16_f32 v23, v23, v23
    v_lshlrev_b32 v23, 16, v23
    v_add_f32 v23, v23, v31
    v_cvt_pk_bf16_f32 v23, v23, v23
    v_lshlrev_b32 v23, 16, v23
    v_mul_f32 v23, v23, v78
    v_cvt_pk_bf16_f32 v23, v23, v23
    v_lshlrev_b32 v23, 16, v23
    v_mul_f32 v31, v31, v78
    v_cvt_pk_bf16_f32 v31, v31, v31
    v_lshlrev_b32 v31, 16, v31
    v_sub_f32 v23, v23, v31
    s_lshl_b32 s39, s18, 8
    s_add_u32 s39, s39, 100352
    v_lshl_add_u32 v80, v11, 4, s39
    ds_write_b128 v80, v[20:23]
L_s_sc0:
    s_cmp_ge_u32 s57, 128
    s_cbranch_scc1 L_s_sc1
    s_ashr_i32 s39, s25, 31
    s_not_b32 s39, s39
    s_or_b32 s39, s39, 0x80000000
    s_xor_b32 s39, s25, s39
    s_and_b32 s39, s39, 0xffff0000
    v_mov_b32 v146, s39
    v_mul_f32 v143, 0xbfb8aa3b, v146
    v_exp_f32 v143, v143
    s_nop 0
    v_add_f32 v143, 1.0, v143
    v_rcp_f32 v143, v143
    s_nop 0
    v_cvt_pk_bf16_f32 v143, v143, v143
    v_lshlrev_b32 v143, 16, v143
    v_pk_add_f32 v[84:85], v[84:85], v[88:89]
    v_pk_add_f32 v[86:87], v[86:87], v[90:91]
    v_pk_add_f32 v[84:85], v[84:85], v[92:93]
    v_pk_add_f32 v[86:87], v[86:87], v[94:95]
    v_pk_add_f32 v[84:85], v[84:85], v[96:97]
    v_pk_add_f32 v[86:87], v[86:87], v[98:99]
    v_pk_add_f32 v[84:85], v[84:85], v[100:101]
    v_pk_add_f32 v[86:87], v[86:87], v[102:103]
    v_pk_add_f32 v[84:85], v[84:85], v[104:105]
    v_pk_add_f32 v[86:87], v[86:87], v[106:107]
    v_pk_add_f32 v[84:85], v[84:85], v[108:109]
    v_pk_add_f32 v[86:87], v[86:87], v[110:111]
    v_pk_add_f32 v[84:85], v[84:85], v[112:113]
    v_pk_add_f32 v[86:87], v[86:87], v[114:115]
    v_pk_add_f32 v[84:85], v[84:85], v[116:117]
    v_pk_add_f32 v[86:87], v[86:87], v[118:119]
    v_pk_add_f32 v[84:85], v[84:85], v[120:121]
    v_pk_add_f32 v[86:87], v[86:87], v[122:123]
    v_pk_add_f32 v[84:85], v[84:85], v[124:125]
    v_pk_add_f32 v[86:87], v[86:87], v[126:127]
    v_pk_add_f32 v[84:85], v[84:85], v[128:129]
    v_pk_add_f32 v[86:87], v[86:87], v[130:131]
    v_pk_add_f32 v[84:85], v[84:85], v[132:133]
    v_pk_add_f32 v[86:87], v[86:87], v[134:135]
    v_pk_add_f32 v[84:85], v[84:85], v[136:137]
    v_pk_add_f32 v[86:87], v[86:87], v[138:139]
    v_mov_b32 v88, v84
    v_mov_b32 v89, v85
    v_mov_b32 v90, v86
    v_mov_b32 v91, v87
    s_nop 1
    v_permlane16_swap_b32 v84, v88
    v_permlane16_swap_b32 v85, v89
    v_permlane16_swap_b32 v86, v90
    v_permlane16_swap_b32 v87, v91
    s_nop 1
    v_add_f32 v84, v84, v88
    v_add_f32 v85, v85, v89
    v_add_f32 v86, v86, v90
    v_add_f32 v87, v87, v91
    v_mov_b32 v88, v84
    v_mov_b32 v89, v85
    v_mov_b32 v90, v86
    v_mov_b32 v91, v87
    s_nop 1
    v_permlane32_swap_b32 v84, v88
    v_permlane32_swap_b32 v85, v89
    v_permlane32_swap_b32 v86, v90
    v_permlane32_swap_b32 v87, v91
    s_nop 1
    v_add_f32 v84, v84, v88
    v_add_f32 v85, v85, v89
    v_add_f32 v86, v86, v90
    v_add_f32 v87, v87, v91
    v_sub_f32 v142, 1.0, v142
    v_cvt_pk_bf16_f32 v142, v142, v142
    v_lshlrev_b32 v142, 16, v142
    v_lshlrev_b32 v92, 16, v140
    v_and_b32 v93, s21, v140
    v_lshlrev_b32 v94, 16, v141
    v_and_b32 v95, s21, v141
    v_cvt_pk_bf16_f32 v84, v84, v84
    v_lshlrev_b32 v84, 16, v84
    v_mul_f32 v84, v84, v143
    v_cvt_pk_bf16_f32 v84, v84, v84
    v_lshlrev_b32 v84, 16, v84
    v_add_f32 v84, v84, v92
    v_cvt_pk_bf16_f32 v84, v84, v84
    v_lshlrev_b32 v84, 16, v84
    v_mul_f32 v84, v84, v142
    v_cvt_pk_bf16_f32 v84, v84, v84
    v_lshlrev_b32 v84, 16, v84
    v_mul_f32 v92, v92, v142
    v_cvt_pk_bf16_f32 v92, v92, v92
    v_lshlrev_b32 v92, 16, v92
    v_sub_f32 v84, v84, v92
    v_cvt_pk_bf16_f32 v85, v85, v85
    v_lshlrev_b32 v85, 16, v85
    v_mul_f32 v85, v85, v143
    v_cvt_pk_bf16_f32 v85, v85, v85
    v_lshlrev_b32 v85, 16, v85
    v_add_f32 v85, v85, v93
    v_cvt_pk_bf16_f32 v85, v85, v85
    v_lshlrev_b32 v85, 16, v85
    v_mul_f32 v85, v85, v142
    v_cvt_pk_bf16_f32 v85, v85, v85
    v_lshlrev_b32 v85, 16, v85
    v_mul_f32 v93, v93, v142
    v_cvt_pk_bf16_f32 v93, v93, v93
    v_lshlrev_b32 v93, 16, v93
    v_sub_f32 v85, v85, v93
    v_cvt_pk_bf16_f32 v86, v86, v86
    v_lshlrev_b32 v86, 16, v86
    v_mul_f32 v86, v86, v143
    v_cvt_pk_bf16_f32 v86, v86, v86
    v_lshlrev_b32 v86, 16, v86
    v_add_f32 v86, v86, v94
    v_cvt_pk_bf16_f32 v86, v86, v86
    v_lshlrev_b32 v86, 16, v86
    v_mul_f32 v86, v86, v142
    v_cvt_pk_bf16_f32 v86, v86, v86
    v_lshlrev_b32 v86, 16, v86
    v_mul_f32 v94, v94, v142
    v_cvt_pk_bf16_f32 v94, v94, v94
    v_lshlrev_b32 v94, 16, v94
    v_sub_f32 v86, v86, v94
    v_cvt_pk_bf16_f32 v87, v87, v87
    v_lshlrev_b32 v87, 16, v87
    v_mul_f32 v87, v87, v143
    v_cvt_pk_bf16_f32 v87, v87, v87
    v_lshlrev_b32 v87, 16, v87
    v_add_f32 v87, v87, v95
    v_cvt_pk_bf16_f32 v87, v87, v87
    v_lshlrev_b32 v87, 16, v87
    v_mul_f32 v87, v87, v142
    v_cvt_pk_bf16_f32 v87, v87, v87
    v_lshlrev_b32 v87, 16, v87
    v_mul_f32 v95, v95, v142
    v_cvt_pk_bf16_f32 v95, v95, v95
    v_lshlrev_b32 v95, 16, v95
    v_sub_f32 v87, v87, v95
    s_lshl_b32 s39, s18, 8
    s_add_u32 s39, s39, 101376
    v_lshl_add_u32 v144, v11, 4, s39
    ds_write_b128 v144, v[84:87]
L_s_sc1:
    s_waitcnt lgkmcnt(0)
    s_barrier
L_s_end:
    s_endpgm
L_code_end:
.section .rodata,"a"
.p2align 6
.amdhsa_kernel gated_mix__ssm_conv_s5__moe_arch_mod__prompt_kernel
  .amdhsa_next_free_vgpr 256
  .amdhsa_next_free_sgpr 98
  .amdhsa_accum_offset 256
  .amdhsa_group_segment_fixed_size 0
  .amdhsa_kernarg_size 144
  .amdhsa_user_sgpr_count 2
  .amdhsa_user_sgpr_kernarg_segment_ptr 1
  .amdhsa_system_sgpr_workgroup_id_x 1
  .amdhsa_float_denorm_mode_32 3
.end_amdhsa_kernel
```

```asm
; @launch grid=(256,1,1) block=(512,1,1) lds=163840
.amdgcn_target "amdgcn-amd-amdhsa--gfx950"
.text
.globl gated_mix__ssm_conv_s5__moe_arch_mod__prompt_kernel
.p2align 8
.type gated_mix__ssm_conv_s5__moe_arch_mod__prompt_kernel,@function
gated_mix__ssm_conv_s5__moe_arch_mod__prompt_kernel:
L_code_start:
    s_getpc_b64 s[32:33]
    s_load_dwordx2 s[40:41], s[0:1], 0
    s_load_dwordx16 s[64:79], s[0:1], 8
    s_load_dwordx8 s[44:51], s[0:1], 80
    s_load_dwordx4 s[80:83], s[0:1], 112
    s_load_dwordx2 s[42:43], s[0:1], 136
    v_lshrrev_b32 v1, 6, v0
    s_cmp_ge_u32 s2, 256
    s_cbranch_scc1 L_exit
    s_sub_u32 s32, s32, 4
    s_subb_u32 s33, s33, 0
    s_mov_b32 s34, L_code_end-L_code_start
    s_mov_b32 s35, 0x20000
    s_lshr_b32 s59, s2, 3
    s_lshl_b32 s59, s59, 11
    v_lshlrev_b32 v2, 2, v0
    buffer_load_dword v9, v2, s[32:35], s59 offen
    v_readfirstlane_b32 s18, v1
    s_mov_b32 s96, 1048576
    s_and_b32 s3, s2, 7
    s_sub_u32 s39, 11, s3
    s_cmp_lt_u32 s3, 4
    s_cselect_b32 s3, s3, s39
    s_lshr_b32 s38, s2, 3
    s_lshl_b32 s16, s3, 1
    s_and_b32 s39, s38, 1
    s_add_u32 s16, s16, s39
    s_lshr_b32 s17, s38, 1
    s_cmp_ge_u32 s18, 4
    s_cbranch_scc1 L_side
    v_and_b32 v26, 15, v0
    v_bfe_u32 v4, v0, 7, 1
    v_lshl_add_u32 v4, v4, 5, v26
    s_lshl_b32 s39, s17, 6
    v_add_lshl_u32 v255, s39, v4, 1
    s_waitcnt lgkmcnt(0)
    global_load_ushort v224, v255, s[64:65] offset:0
    global_load_ushort v226, v255, s[66:67] offset:0
    global_load_ushort v228, v255, s[76:77] offset:0
    global_load_ushort v225, v255, s[64:65] offset:32
    global_load_ushort v227, v255, s[66:67] offset:32
    global_load_ushort v229, v255, s[76:77] offset:32
    s_branch L_gemm
L_side:
    s_sub_u32 s18, s18, 4
    v_and_b32 v2, 63, v0
    s_lshl_b32 s19, s3, 8
    s_lshl_b32 s39, s38, 3
    s_add_u32 s19, s19, s39
    s_lshr_b32 s38, s16, 1
    s_mul_i32 s56, s38, 0
    s_and_b32 s38, s16, 1
    s_mul_i32 s38, s38, 0
    s_add_u32 s56, s56, s38
    s_mul_i32 s38, s17, 128
    s_add_u32 s56, s56, s38
    s_lshl_b32 s58, s18, 12
    v_lshrrev_b32 v4, 3, v2
    v_and_b32 v5, 7, v2
    v_lshrrev_b32 v6, 4, v2
    v_xor_b32 v5, v5, v6
    v_lshlrev_b32 v5, 4, v5
    v_lshrrev_b32 v7, 1, v2
    v_and_b32 v7, 16, v7
    v_and_or_b32 v7, v2, 8, v7
    v_and_or_b32 v6, v6, 1, v7
    s_lshr_b32 s20, s18, 1
    s_and_b32 s21, s18, 1
    s_lshl_b32 s38, s20, 6
    s_lshl_b32 s39, s21, 2
    s_add_u32 s38, s38, s39
    s_lshl_b32 s39, s16, 7
    s_add_u32 s38, s38, s39
    v_add_u32 v6, s38, v6
    v_lshl_add_u32 v6, v6, 11, v5
    v_xor_b32 v7, 64, v6
    v_add_u32 v100, 3072, v6
    v_add_u32 v101, 67584, v7
    v_add_u32 v102, 5120, v6
    v_add_u32 v103, 69632, v7
    s_lshl_b32 s38, s17, 6
    s_lshl_b32 s39, s20, 5
    s_add_u32 s38, s38, s39
    v_add_u32 v6, s38, v4
    v_lshl_add_u32 v6, v6, 11, v5
    v_xor_b32 v7, 64, v6
    v_add_u32 v104, 3072, v6
    v_add_u32 v105, 18432, v7
    v_add_u32 v106, 33792, v6
    v_add_u32 v107, 49152, v7
    s_waitcnt lgkmcnt(0)
    s_sub_u32 s8, s40, 3072
    s_subb_u32 s9, s41, 0
    s_mov_b32 s10, 4197376
    s_mov_b32 s11, 0x20000
    s_add_u32 m0, s58, 0
    s_add_u32 s57, s56, 0
    s_and_b32 s57, s57, 2047
    buffer_load_dwordx4 v100, s[8:11], s57 offen offset:0 lds
    buffer_load_dwordx4 v101, s[8:11], s57 offen offset:1024 lds
    buffer_load_dwordx4 v102, s[8:11], s57 offen offset:2048 lds
    buffer_load_dwordx4 v103, s[8:11], s57 offen offset:3072 lds
    s_cmp_eq_u32 s21, 0
    s_cselect_b32 s24, s68, s70
    s_cselect_b32 s25, s69, s71
    s_sub_u32 s24, s24, 3072
    s_subb_u32 s25, s25, 0
    s_mov_b32 s26, 2100224
    s_mov_b32 s27, 0x20000
    s_add_u32 m0, s58, 16384
    s_nop 0
    buffer_load_dwordx4 v104, s[24:27], s57 offen offset:0 lds
    buffer_load_dwordx4 v105, s[24:27], s57 offen offset:1024 lds
    buffer_load_dwordx4 v106, s[24:27], s57 offen offset:2048 lds
    buffer_load_dwordx4 v107, s[24:27], s57 offen offset:3072 lds
    s_add_u32 s94, s42, 9469952
    s_addc_u32 s95, s43, 0
    s_load_dword s93, s[94:95], 0
    s_mov_b32 s12, s42
    s_mov_b32 s13, s43
    s_mov_b32 s14, 25165824
    s_mov_b32 s15, 0x20000
    s_mov_b32 s21, 0xffff0000
    v_and_b32 v11, 15, v2
    s_add_u32 m0, s58, 32768
    s_add_u32 s57, s56, 128
    s_and_b32 s57, s57, 2047
    buffer_load_dwordx4 v100, s[8:11], s57 offen offset:0 lds
    buffer_load_dwordx4 v101, s[8:11], s57 offen offset:1024 lds
    buffer_load_dwordx4 v102, s[8:11], s57 offen offset:2048 lds
    buffer_load_dwordx4 v103, s[8:11], s57 offen offset:3072 lds
    s_add_u32 m0, s58, 49152
    s_nop 0
    buffer_load_dwordx4 v104, s[24:27], s57 offen offset:0 lds
    buffer_load_dwordx4 v105, s[24:27], s57 offen offset:1024 lds
    buffer_load_dwordx4 v106, s[24:27], s57 offen offset:2048 lds
    buffer_load_dwordx4 v107, s[24:27], s57 offen offset:3072 lds
    v_lshlrev_b32 v3, 4, v2
    s_mul_hi_u32 s23, s2, 76695845
    s_mul_i32 s38, s23, 56
    s_sub_u32 s22, s2, s38
    v_lshrrev_b32 v5, 3, v2
    v_and_b32 v8, 7, v2
    v_and_b32 v12, 3, v5
    v_lshlrev_b32 v12, 1, v12
    v_xor_b32 v8, v8, v12
    v_mul_u32_u24 v4, 7168, v5
    v_lshl_add_u32 v4, v8, 4, v4
    s_lshl_b32 s38, s18, 6
    s_lshl_b32 s39, s23, 8
    s_add_u32 s44, s38, s39
    s_mul_i32 s45, s44, 7168
    s_lshl_b32 s39, s22, 7
    s_add_u32 s45, s45, s39
    s_lshl_b32 s92, s18, 14
    s_add_u32 s92, s92, 98304
    s_mov_b32 s52, s46
    s_mov_b32 s53, s47
    s_mov_b32 s54, 7340032
    s_mov_b32 s55, 0x20000
    s_mov_b32 s28, s48
    s_mov_b32 s29, s49
    s_mov_b32 s30, 7340032
    s_mov_b32 s31, 0x20000
    s_mov_b32 s46, s92
    s_cmp_ge_u32 s2, 224
    s_cselect_b32 s54, 0, s54
    s_cselect_b32 s30, 0, s30
    s_waitcnt vmcnt(8) lgkmcnt(0)
    s_barrier
    s_mul_i32 s93, s93, 1664525
    s_add_u32 s93, s93, 1013904223
    s_add_u32 m0, s58, 65536
    s_add_u32 s57, s56, 256
    s_and_b32 s57, s57, 2047
    buffer_load_dwordx4 v100, s[8:11], s57 offen offset:0 lds
    buffer_load_dwordx4 v101, s[8:11], s57 offen offset:1024 lds
    buffer_load_dwordx4 v102, s[8:11], s57 offen offset:2048 lds
    buffer_load_dwordx4 v103, s[8:11], s57 offen offset:3072 lds
    s_add_u32 m0, s58, 81920
    s_nop 0
    buffer_load_dwordx4 v104, s[24:27], s57 offen offset:0 lds
    buffer_load_dwordx4 v105, s[24:27], s57 offen offset:1024 lds
    buffer_load_dwordx4 v106, s[24:27], s57 offen offset:2048 lds
    buffer_load_dwordx4 v107, s[24:27], s57 offen offset:3072 lds
    s_cmp_lg_u32 s18, 0
    s_cbranch_scc1 L_s_nk0
    v_lshlrev_b32 v6, 2, v11
    v_add_u32 v6, 163328, v6
    ds_read_b32 v24, v6 offset:0
    ds_read_b32 v25, v6 offset:64
    ds_read_b32 v26, v6 offset:128
    ds_read_b32 v27, v6 offset:192
    ds_read_b32 v28, v6 offset:256
    ds_read_b32 v29, v6 offset:320
    ds_read_b32 v30, v6 offset:384
    ds_read_b32 v31, v6 offset:448
L_s_nk0:
    s_waitcnt vmcnt(8)
    s_barrier
    s_add_u32 m0, s58, 0
    s_add_u32 s57, s56, 384
    s_and_b32 s57, s57, 2047
    buffer_load_dwordx4 v100, s[8:11], s57 offen offset:0 lds
    buffer_load_dwordx4 v101, s[8:11], s57 offen offset:1024 lds
    buffer_load_dwordx4 v102, s[8:11], s57 offen offset:2048 lds
    buffer_load_dwordx4 v103, s[8:11], s57 offen offset:3072 lds
    s_add_u32 m0, s58, 16384
    s_nop 0
    buffer_load_dwordx4 v104, s[24:27], s57 offen offset:0 lds
    buffer_load_dwordx4 v105, s[24:27], s57 offen offset:1024 lds
    buffer_load_dwordx4 v106, s[24:27], s57 offen offset:2048 lds
    buffer_load_dwordx4 v107, s[24:27], s57 offen offset:3072 lds
    s_cmp_lg_u32 s18, 0
    s_cbranch_scc1 L_s_nk1
    v_and_b32 v7, 7, v2
    s_sub_u32 s38, 2047, s19
    v_sub_u32 v21, s38, v7
    v_lshlrev_b32 v7, 3, v7
    v_bfe_u32 v20, v2, 3, 1
    v_lshl_add_u32 v7, v20, 14, v7
    s_waitcnt lgkmcnt(0)
    v_pk_add_f32 v[24:25], v[24:25], v[26:27]
    v_pk_add_f32 v[28:29], v[28:29], v[30:31]
    v_pk_add_f32 v[24:25], v[24:25], v[28:29]
    v_add_f32 v24, v24, v25
L_s_nk1:
    s_waitcnt vmcnt(8)
    s_barrier
    s_add_u32 m0, s58, 32768
    s_add_u32 s57, s56, 512
    s_and_b32 s57, s57, 2047
    buffer_load_dwordx4 v100, s[8:11], s57 offen offset:0 lds
    buffer_load_dwordx4 v101, s[8:11], s57 offen offset:1024 lds
    buffer_load_dwordx4 v102, s[8:11], s57 offen offset:2048 lds
    buffer_load_dwordx4 v103, s[8:11], s57 offen offset:3072 lds
    s_add_u32 m0, s58, 49152
    s_nop 0
    buffer_load_dwordx4 v104, s[24:27], s57 offen offset:0 lds
    buffer_load_dwordx4 v105, s[24:27], s57 offen offset:1024 lds
    buffer_load_dwordx4 v106, s[24:27], s57 offen offset:2048 lds
    buffer_load_dwordx4 v107, s[24:27], s57 offen offset:3072 lds
    s_cmp_lg_u32 s18, 0
    s_cbranch_scc1 L_s_nk2
    v_cvt_pk_bf16_f32 v24, v24, v24
    v_lshlrev_b32 v24, 16, v24
    v_mul_f32 v26, 0xbfb8aa3b, v24
    v_exp_f32 v26, v26
    s_nop 0
    v_add_f32 v26, 1.0, v26
    v_rcp_f32 v26, v26
    s_nop 0
    v_cvt_pk_bf16_f32 v26, v26, v26
    v_lshlrev_b32 v26, 16, v26
    v_cmp_eq_u32 vcc, 1, v20
L_s_nk2:
    s_waitcnt vmcnt(8)
    s_barrier
    s_add_u32 m0, s58, 65536
    s_add_u32 s57, s56, 640
    s_and_b32 s57, s57, 2047
    buffer_load_dwordx4 v100, s[8:11], s57 offen offset:0 lds
    buffer_load_dwordx4 v101, s[8:11], s57 offen offset:1024 lds
    buffer_load_dwordx4 v102, s[8:11], s57 offen offset:2048 lds
    buffer_load_dwordx4 v103, s[8:11], s57 offen offset:3072 lds
    s_add_u32 m0, s58, 81920
    s_nop 0
    buffer_load_dwordx4 v104, s[24:27], s57 offen offset:0 lds
    buffer_load_dwordx4 v105, s[24:27], s57 offen offset:1024 lds
    buffer_load_dwordx4 v106, s[24:27], s57 offen offset:2048 lds
    buffer_load_dwordx4 v107, s[24:27], s57 offen offset:3072 lds
    s_cmp_lg_u32 s18, 0
    s_cbranch_scc1 L_s_nk3
    v_ashrrev_i32 v25, 31, v24
    v_or_b32 v25, 0x80000000, v25
    v_xor_b32 v24, v24, v25
    v_and_or_b32 v24, v24, s21, v21
    v_cndmask_b32 v24, v24, v26, vcc
    v_mov_b32 v25, s93
    s_lshl_b32 s38, s19, 3
    s_add_u32 s38, s38, 9437184
    s_mov_b64 exec, 0xffff
    buffer_store_dwordx2 v[24:25], v7, s[12:15], s38 offen sc1
    s_mov_b64 exec, -1
L_s_nk3:
    s_waitcnt vmcnt(8)
    s_barrier
    s_add_u32 m0, s58, 0
    s_add_u32 s57, s56, 768
    s_and_b32 s57, s57, 2047
    buffer_load_dwordx4 v100, s[8:11], s57 offen offset:0 lds
    buffer_load_dwordx4 v101, s[8:11], s57 offen offset:1024 lds
    buffer_load_dwordx4 v102, s[8:11], s57 offen offset:2048 lds
    buffer_load_dwordx4 v103, s[8:11], s57 offen offset:3072 lds
    s_add_u32 m0, s58, 16384
    s_nop 0
    buffer_load_dwordx4 v104, s[24:27], s57 offen offset:0 lds
    buffer_load_dwordx4 v105, s[24:27], s57 offen offset:1024 lds
    buffer_load_dwordx4 v106, s[24:27], s57 offen offset:2048 lds
    buffer_load_dwordx4 v107, s[24:27], s57 offen offset:3072 lds
    s_waitcnt vmcnt(8)
    s_barrier
    s_add_u32 m0, s58, 32768
    s_add_u32 s57, s56, 896
    s_and_b32 s57, s57, 2047
    buffer_load_dwordx4 v100, s[8:11], s57 offen offset:0 lds
    buffer_load_dwordx4 v101, s[8:11], s57 offen offset:1024 lds
    buffer_load_dwordx4 v102, s[8:11], s57 offen offset:2048 lds
    buffer_load_dwordx4 v103, s[8:11], s57 offen offset:3072 lds
    s_add_u32 m0, s58, 49152
    s_nop 0
    buffer_load_dwordx4 v104, s[24:27], s57 offen offset:0 lds
    buffer_load_dwordx4 v105, s[24:27], s57 offen offset:1024 lds
    buffer_load_dwordx4 v106, s[24:27], s57 offen offset:2048 lds
    buffer_load_dwordx4 v107, s[24:27], s57 offen offset:3072 lds
    s_waitcnt vmcnt(8)
    s_barrier
    s_add_u32 m0, s58, 65536
    s_add_u32 s57, s56, 1024
    s_and_b32 s57, s57, 2047
    buffer_load_dwordx4 v100, s[8:11], s57 offen offset:0 lds
    buffer_load_dwordx4 v101, s[8:11], s57 offen offset:1024 lds
    buffer_load_dwordx4 v102, s[8:11], s57 offen offset:2048 lds
    buffer_load_dwordx4 v103, s[8:11], s57 offen offset:3072 lds
    s_add_u32 m0, s58, 81920
    s_nop 0
    buffer_load_dwordx4 v104, s[24:27], s57 offen offset:0 lds
    buffer_load_dwordx4 v105, s[24:27], s57 offen offset:1024 lds
    buffer_load_dwordx4 v106, s[24:27], s57 offen offset:2048 lds
    buffer_load_dwordx4 v107, s[24:27], s57 offen offset:3072 lds
    s_waitcnt vmcnt(8)
    s_barrier
    s_add_u32 m0, s58, 0
    s_add_u32 s57, s56, 1152
    s_and_b32 s57, s57, 2047
    buffer_load_dwordx4 v100, s[8:11], s57 offen offset:0 lds
    buffer_load_dwordx4 v101, s[8:11], s57 offen offset:1024 lds
    buffer_load_dwordx4 v102, s[8:11], s57 offen offset:2048 lds
    buffer_load_dwordx4 v103, s[8:11], s57 offen offset:3072 lds
    s_add_u32 m0, s58, 16384
    s_nop 0
    buffer_load_dwordx4 v104, s[24:27], s57 offen offset:0 lds
    buffer_load_dwordx4 v105, s[24:27], s57 offen offset:1024 lds
    buffer_load_dwordx4 v106, s[24:27], s57 offen offset:2048 lds
    buffer_load_dwordx4 v107, s[24:27], s57 offen offset:3072 lds
    s_waitcnt vmcnt(8)
    s_barrier
    s_add_u32 m0, s58, 32768
    s_add_u32 s57, s56, 1280
    s_and_b32 s57, s57, 2047
    buffer_load_dwordx4 v100, s[8:11], s57 offen offset:0 lds
    buffer_load_dwordx4 v101, s[8:11], s57 offen offset:1024 lds
    buffer_load_dwordx4 v102, s[8:11], s57 offen offset:2048 lds
    buffer_load_dwordx4 v103, s[8:11], s57 offen offset:3072 lds
    s_add_u32 m0, s58, 49152
    s_nop 0
    buffer_load_dwordx4 v104, s[24:27], s57 offen offset:0 lds
    buffer_load_dwordx4 v105, s[24:27], s57 offen offset:1024 lds
    buffer_load_dwordx4 v106, s[24:27], s57 offen offset:2048 lds
    buffer_load_dwordx4 v107, s[24:27], s57 offen offset:3072 lds
    s_waitcnt vmcnt(8)
    s_barrier
    s_add_u32 m0, s58, 65536
    s_add_u32 s57, s56, 1408
    s_and_b32 s57, s57, 2047
    buffer_load_dwordx4 v100, s[8:11], s57 offen offset:0 lds
    buffer_load_dwordx4 v101, s[8:11], s57 offen offset:1024 lds
    buffer_load_dwordx4 v102, s[8:11], s57 offen offset:2048 lds
    buffer_load_dwordx4 v103, s[8:11], s57 offen offset:3072 lds
    s_add_u32 m0, s58, 81920
    s_nop 0
    buffer_load_dwordx4 v104, s[24:27], s57 offen offset:0 lds
    buffer_load_dwordx4 v105, s[24:27], s57 offen offset:1024 lds
    buffer_load_dwordx4 v106, s[24:27], s57 offen offset:2048 lds
    buffer_load_dwordx4 v107, s[24:27], s57 offen offset:3072 lds
    s_waitcnt vmcnt(8)
    s_barrier
    s_add_u32 m0, s58, 0
    s_add_u32 s57, s56, 1536
    s_and_b32 s57, s57, 2047
    buffer_load_dwordx4 v100, s[8:11], s57 offen offset:0 lds
    buffer_load_dwordx4 v101, s[8:11], s57 offen offset:1024 lds
    buffer_load_dwordx4 v102, s[8:11], s57 offen offset:2048 lds
    buffer_load_dwordx4 v103, s[8:11], s57 offen offset:3072 lds
    s_add_u32 m0, s58, 16384
    s_nop 0
    buffer_load_dwordx4 v104, s[24:27], s57 offen offset:0 lds
    buffer_load_dwordx4 v105, s[24:27], s57 offen offset:1024 lds
    buffer_load_dwordx4 v106, s[24:27], s57 offen offset:2048 lds
    buffer_load_dwordx4 v107, s[24:27], s57 offen offset:3072 lds
    s_waitcnt vmcnt(8)
    s_barrier
    s_add_u32 m0, s58, 32768
    s_add_u32 s57, s56, 1664
    s_and_b32 s57, s57, 2047
    buffer_load_dwordx4 v100, s[8:11], s57 offen offset:0 lds
    buffer_load_dwordx4 v101, s[8:11], s57 offen offset:1024 lds
    buffer_load_dwordx4 v102, s[8:11], s57 offen offset:2048 lds
    buffer_load_dwordx4 v103, s[8:11], s57 offen offset:3072 lds
    s_add_u32 m0, s58, 49152
    s_nop 0
    buffer_load_dwordx4 v104, s[24:27], s57 offen offset:0 lds
    buffer_load_dwordx4 v105, s[24:27], s57 offen offset:1024 lds
    buffer_load_dwordx4 v106, s[24:27], s57 offen offset:2048 lds
    buffer_load_dwordx4 v107, s[24:27], s57 offen offset:3072 lds
    s_waitcnt vmcnt(8)
    s_barrier
    s_add_u32 m0, s58, 65536
    s_add_u32 s57, s56, 1792
    s_and_b32 s57, s57, 2047
    buffer_load_dwordx4 v100, s[8:11], s57 offen offset:0 lds
    buffer_load_dwordx4 v101, s[8:11], s57 offen offset:1024 lds
    buffer_load_dwordx4 v102, s[8:11], s57 offen offset:2048 lds
    buffer_load_dwordx4 v103, s[8:11], s57 offen offset:3072 lds
    s_add_u32 m0, s58, 81920
    s_nop 0
    buffer_load_dwordx4 v104, s[24:27], s57 offen offset:0 lds
    buffer_load_dwordx4 v105, s[24:27], s57 offen offset:1024 lds
    buffer_load_dwordx4 v106, s[24:27], s57 offen offset:2048 lds
    buffer_load_dwordx4 v107, s[24:27], s57 offen offset:3072 lds
    s_waitcnt vmcnt(8)
    s_barrier
    s_add_u32 m0, s58, 0
    s_add_u32 s57, s56, 1920
    s_and_b32 s57, s57, 2047
    buffer_load_dwordx4 v100, s[8:11], s57 offen offset:0 lds
    buffer_load_dwordx4 v101, s[8:11], s57 offen offset:1024 lds
    buffer_load_dwordx4 v102, s[8:11], s57 offen offset:2048 lds
    buffer_load_dwordx4 v103, s[8:11], s57 offen offset:3072 lds
    s_add_u32 m0, s58, 16384
    s_nop 0
    buffer_load_dwordx4 v104, s[24:27], s57 offen offset:0 lds
    buffer_load_dwordx4 v105, s[24:27], s57 offen offset:1024 lds
    buffer_load_dwordx4 v106, s[24:27], s57 offen offset:2048 lds
    buffer_load_dwordx4 v107, s[24:27], s57 offen offset:3072 lds
    s_lshl_b32 s58, s18, 12
    s_add_u32 s58, s58, 9437184
    s_mov_b32 s57, -1
    buffer_load_dwordx4 v[80:83], v3, s[12:15], s58 offen offset:0 sc1
    buffer_load_dwordx4 v[84:87], v3, s[12:15], s58 offen offset:1024 sc1
    buffer_load_dwordx4 v[88:91], v3, s[12:15], s58 offen offset:2048 sc1
    buffer_load_dwordx4 v[92:95], v3, s[12:15], s58 offen offset:3072 sc1
    s_add_u32 m0, s46, 0
    s_add_u32 s39, s45, 0
    buffer_load_dwordx4 v4, s[52:55], s39 offen lds
    s_waitcnt vmcnt(13)
    s_barrier
    s_add_u32 m0, s46, 1024
    s_add_u32 s39, s45, 57344
    buffer_load_dwordx4 v4, s[52:55], s39 offen lds
    s_add_u32 m0, s46, 2048
    s_add_u32 s39, s45, 114688
    buffer_load_dwordx4 v4, s[52:55], s39 offen lds
    s_add_u32 m0, s46, 3072
    s_add_u32 s39, s45, 172032
    buffer_load_dwordx4 v4, s[52:55], s39 offen lds
    s_add_u32 m0, s46, 4096
    s_add_u32 s39, s45, 229376
    buffer_load_dwordx4 v4, s[52:55], s39 offen lds
    s_add_u32 m0, s46, 5120
    s_add_u32 s39, s45, 286720
    buffer_load_dwordx4 v4, s[52:55], s39 offen lds
    s_add_u32 m0, s46, 6144
    s_add_u32 s39, s45, 344064
    buffer_load_dwordx4 v4, s[52:55], s39 offen lds
    s_add_u32 m0, s46, 7168
    s_add_u32 s39, s45, 401408
    buffer_load_dwordx4 v4, s[52:55], s39 offen lds
    s_add_u32 m0, s46, 8192
    s_add_u32 s39, s45, 0
    buffer_load_dwordx4 v4, s[28:31], s39 offen lds
    s_add_u32 m0, s46, 9216
    s_add_u32 s39, s45, 57344
    buffer_load_dwordx4 v4, s[28:31], s39 offen lds
    s_add_u32 m0, s46, 10240
    s_add_u32 s39, s45, 114688
    buffer_load_dwordx4 v4, s[28:31], s39 offen lds
    s_waitcnt vmcnt(15)
    s_barrier
    v_lshlrev_b32 v5, 11, v5
    v_lshl_add_u32 v5, v8, 4, v5
    v_lshrrev_b32 v10, 4, v2
    v_bfe_u32 v12, v2, 2, 2
    v_lshl_add_u32 v13, v10, 3, v12
    v_lshlrev_b32 v13, 7, v13
    v_and_b32 v14, 3, v2
    v_lshl_add_u32 v13, v14, 3, v13
    v_add_u32 v13, s92, v13
    v_xor_b32 v14, 0, v12
    v_lshl_add_u32 v16, v14, 5, v13
    v_xor_b32 v14, 1, v12
    v_lshl_add_u32 v17, v14, 5, v13
    v_xor_b32 v14, 2, v12
    v_lshl_add_u32 v18, v14, 5, v13
    v_xor_b32 v14, 3, v12
    v_lshl_add_u32 v19, v14, 5, v13
    s_mov_b32 s4, s40
    s_mov_b32 s5, s41
    s_mov_b32 s6, 4194304
    s_mov_b32 s7, 0x20000
    s_mov_b32 s8, s50
    s_mov_b32 s9, s51
    s_mov_b32 s10, 7340032
    s_mov_b32 s11, 0x20000
    v_mov_b32 v8, 0
    s_add_u32 m0, s46, 11264
    s_add_u32 s39, s45, 172032
    buffer_load_dwordx4 v4, s[28:31], s39 offen lds
    s_add_u32 m0, s46, 12288
    s_add_u32 s39, s45, 229376
    buffer_load_dwordx4 v4, s[28:31], s39 offen lds
    s_add_u32 m0, s46, 13312
    s_add_u32 s39, s45, 286720
    buffer_load_dwordx4 v4, s[28:31], s39 offen lds
    s_add_u32 m0, s46, 14336
    s_add_u32 s39, s45, 344064
    buffer_load_dwordx4 v4, s[28:31], s39 offen lds
    s_add_u32 m0, s46, 15360
    s_add_u32 s39, s45, 401408
    buffer_load_dwordx4 v4, s[28:31], s39 offen lds
    s_barrier
    s_waitcnt vmcnt(16)
L_s_poll:
    v_xor_b32 v81, s93, v81
    v_xor_b32 v83, s93, v83
    v_xor_b32 v85, s93, v85
    v_xor_b32 v87, s93, v87
    v_xor_b32 v89, s93, v89
    v_xor_b32 v91, s93, v91
    v_xor_b32 v93, s93, v93
    v_xor_b32 v95, s93, v95
    v_or3_b32 v9, v81, v83, v85
    v_or3_b32 v9, v9, v87, v89
    v_or3_b32 v9, v9, v91, v93
    v_or_b32 v9, v9, v95
    v_cmp_ne_u32 vcc, 0, v9
    s_nop 1
    s_cmp_eq_u64 vcc, 0
    s_cbranch_scc1 L_s_go
    s_sub_u32 s96, s96, 1
    s_cbranch_scc1 L_s_go
    s_sleep 8
    buffer_load_dwordx4 v[80:83], v3, s[12:15], s58 offen offset:0 sc1
    buffer_load_dwordx4 v[84:87], v3, s[12:15], s58 offen offset:1024 sc1
    buffer_load_dwordx4 v[88:91], v3, s[12:15], s58 offen offset:2048 sc1
    buffer_load_dwordx4 v[92:95], v3, s[12:15], s58 offen offset:3072 sc1
    s_waitcnt vmcnt(0)
    s_branch L_s_poll
L_s_go:
    v_sub_u32 v72, s57, v80
    v_sub_u32 v73, s57, v82
    v_sub_u32 v74, s57, v84
    v_sub_u32 v75, s57, v86
    v_sub_u32 v76, s57, v88
    v_sub_u32 v77, s57, v90
    v_sub_u32 v78, s57, v92
    v_sub_u32 v79, s57, v94
    v_min3_u32 v9, v72, v73, v74
    v_min3_u32 v15, v75, v76, v77
    v_min3_u32 v9, v9, v78, v79
    v_min_u32 v9, v9, v15
    s_nop 1
    v_min_u32_dpp v9, v9, v9 row_ror:8 row_mask:0xf bank_mask:0xf
    s_nop 1
    v_min_u32_dpp v9, v9, v9 row_ror:4 row_mask:0xf bank_mask:0xf
    s_nop 1
    v_min_u32_dpp v9, v9, v9 row_ror:2 row_mask:0xf bank_mask:0xf
    s_nop 1
    v_min_u32_dpp v9, v9, v9 row_ror:1 row_mask:0xf bank_mask:0xf
    s_nop 0
    v_readlane_b32 s48, v9, 0
    v_readlane_b32 s49, v9, 16
    v_readlane_b32 s50, v9, 32
    v_readlane_b32 s51, v9, 48
    s_nop 0
    s_min_u32 s48, s48, s49
    s_min_u32 s50, s50, s51
    s_min_u32 s48, s48, s50
    s_sub_u32 s57, s57, s48
    v_writelane_b32 v8, s57, 0
    s_sub_u32 s57, s57, 1
    v_sub_u32 v72, s57, v80
    v_sub_u32 v73, s57, v82
    v_sub_u32 v74, s57, v84
    v_sub_u32 v75, s57, v86
    v_sub_u32 v76, s57, v88
    v_sub_u32 v77, s57, v90
    v_sub_u32 v78, s57, v92
    v_sub_u32 v79, s57, v94
    v_min3_u32 v9, v72, v73, v74
    v_min3_u32 v15, v75, v76, v77
    v_min3_u32 v9, v9, v78, v79
    v_min_u32 v9, v9, v15
    s_nop 1
    v_min_u32_dpp v9, v9, v9 row_ror:8 row_mask:0xf bank_mask:0xf
    s_nop 1
    v_min_u32_dpp v9, v9, v9 row_ror:4 row_mask:0xf bank_mask:0xf
    s_nop 1
    v_min_u32_dpp v9, v9, v9 row_ror:2 row_mask:0xf bank_mask:0xf
    s_nop 1
    v_min_u32_dpp v9, v9, v9 row_ror:1 row_mask:0xf bank_mask:0xf
    s_nop 0
    v_readlane_b32 s48, v9, 0
    v_readlane_b32 s49, v9, 16
    v_readlane_b32 s50, v9, 32
    v_readlane_b32 s51, v9, 48
    s_nop 0
    s_min_u32 s48, s48, s49
    s_min_u32 s50, s50, s51
    s_min_u32 s48, s48, s50
    s_sub_u32 s57, s57, s48
    v_writelane_b32 v8, s57, 1
    s_sub_u32 s57, s57, 1
    v_sub_u32 v72, s57, v80
    v_sub_u32 v73, s57, v82
    v_sub_u32 v74, s57, v84
    v_sub_u32 v75, s57, v86
    v_sub_u32 v76, s57, v88
    v_sub_u32 v77, s57, v90
    v_sub_u32 v78, s57, v92
    v_sub_u32 v79, s57, v94
    v_min3_u32 v9, v72, v73, v74
    v_min3_u32 v15, v75, v76, v77
    v_min3_u32 v9, v9, v78, v79
    v_min_u32 v9, v9, v15
    s_nop 1
    v_min_u32_dpp v9, v9, v9 row_ror:8 row_mask:0xf bank_mask:0xf
    s_nop 1
    v_min_u32_dpp v9, v9, v9 row_ror:4 row_mask:0xf bank_mask:0xf
    s_nop 1
    v_min_u32_dpp v9, v9, v9 row_ror:2 row_mask:0xf bank_mask:0xf
    s_nop 1
    v_min_u32_dpp v9, v9, v9 row_ror:1 row_mask:0xf bank_mask:0xf
    s_nop 0
    v_readlane_b32 s48, v9, 0
    v_readlane_b32 s49, v9, 16
    v_readlane_b32 s50, v9, 32
    v_readlane_b32 s51, v9, 48
    s_nop 0
    s_min_u32 s48, s48, s49
    s_min_u32 s50, s50, s51
    s_min_u32 s48, s48, s50
    s_sub_u32 s57, s57, s48
    v_writelane_b32 v8, s57, 2
    s_sub_u32 s57, s57, 1
    v_sub_u32 v72, s57, v80
    v_sub_u32 v73, s57, v82
    v_sub_u32 v74, s57, v84
    v_sub_u32 v75, s57, v86
    v_sub_u32 v76, s57, v88
    v_sub_u32 v77, s57, v90
    v_sub_u32 v78, s57, v92
    v_sub_u32 v79, s57, v94
    v_min3_u32 v9, v72, v73, v74
    v_min3_u32 v15, v75, v76, v77
    v_min3_u32 v9, v9, v78, v79
    v_min_u32 v9, v9, v15
    s_nop 1
    v_min_u32_dpp v9, v9, v9 row_ror:8 row_mask:0xf bank_mask:0xf
    s_nop 1
    v_min_u32_dpp v9, v9, v9 row_ror:4 row_mask:0xf bank_mask:0xf
    s_nop 1
    v_min_u32_dpp v9, v9, v9 row_ror:2 row_mask:0xf bank_mask:0xf
    s_nop 1
    v_min_u32_dpp v9, v9, v9 row_ror:1 row_mask:0xf bank_mask:0xf
    s_nop 0
    v_readlane_b32 s48, v9, 0
    v_readlane_b32 s49, v9, 16
    v_readlane_b32 s50, v9, 32
    v_readlane_b32 s51, v9, 48
    s_nop 0
    s_min_u32 s48, s48, s49
    s_min_u32 s50, s50, s51
    s_min_u32 s48, s48, s50
    s_sub_u32 s57, s57, s48
    v_writelane_b32 v8, s57, 3
    s_sub_u32 s57, s57, 1
    v_sub_u32 v72, s57, v80
    v_sub_u32 v73, s57, v82
    v_sub_u32 v74, s57, v84
    v_sub_u32 v75, s57, v86
    v_sub_u32 v76, s57, v88
    v_sub_u32 v77, s57, v90
    v_sub_u32 v78, s57, v92
    v_sub_u32 v79, s57, v94
    v_min3_u32 v9, v72, v73, v74
    v_min3_u32 v15, v75, v76, v77
    v_min3_u32 v9, v9, v78, v79
    v_min_u32 v9, v9, v15
    s_nop 1
    v_min_u32_dpp v9, v9, v9 row_ror:8 row_mask:0xf bank_mask:0xf
    s_nop 1
    v_min_u32_dpp v9, v9, v9 row_ror:4 row_mask:0xf bank_mask:0xf
    s_nop 1
    v_min_u32_dpp v9, v9, v9 row_ror:2 row_mask:0xf bank_mask:0xf
    s_nop 1
    v_min_u32_dpp v9, v9, v9 row_ror:1 row_mask:0xf bank_mask:0xf
    s_nop 0
    v_readlane_b32 s48, v9, 0
    v_readlane_b32 s49, v9, 16
    v_readlane_b32 s50, v9, 32
    v_readlane_b32 s51, v9, 48
    s_nop 0
    s_min_u32 s48, s48, s49
    s_min_u32 s50, s50, s51
    s_min_u32 s48, s48, s50
    s_sub_u32 s57, s57, s48
    v_writelane_b32 v8, s57, 4
    s_sub_u32 s57, s57, 1
    v_sub_u32 v72, s57, v80
    v_sub_u32 v73, s57, v82
    v_sub_u32 v74, s57, v84
    v_sub_u32 v75, s57, v86
    v_sub_u32 v76, s57, v88
    v_sub_u32 v77, s57, v90
    v_sub_u32 v78, s57, v92
    v_sub_u32 v79, s57, v94
    v_min3_u32 v9, v72, v73, v74
    v_min3_u32 v15, v75, v76, v77
    v_min3_u32 v9, v9, v78, v79
    v_min_u32 v9, v9, v15
    s_nop 1
    v_min_u32_dpp v9, v9, v9 row_ror:8 row_mask:0xf bank_mask:0xf
    s_nop 1
    v_min_u32_dpp v9, v9, v9 row_ror:4 row_mask:0xf bank_mask:0xf
    s_nop 1
    v_min_u32_dpp v9, v9, v9 row_ror:2 row_mask:0xf bank_mask:0xf
    s_nop 1
    v_min_u32_dpp v9, v9, v9 row_ror:1 row_mask:0xf bank_mask:0xf
    s_nop 0
    v_readlane_b32 s48, v9, 0
    v_readlane_b32 s49, v9, 16
    v_readlane_b32 s50, v9, 32
    v_readlane_b32 s51, v9, 48
    s_nop 0
    s_min_u32 s48, s48, s49
    s_min_u32 s50, s50, s51
    s_min_u32 s48, s48, s50
    s_sub_u32 s57, s57, s48
    v_writelane_b32 v8, s57, 5
    s_sub_u32 s57, s57, 1
    v_sub_u32 v72, s57, v80
    v_sub_u32 v73, s57, v82
    v_sub_u32 v74, s57, v84
    v_sub_u32 v75, s57, v86
    v_sub_u32 v76, s57, v88
    v_sub_u32 v77, s57, v90
    v_sub_u32 v78, s57, v92
    v_sub_u32 v79, s57, v94
    v_min3_u32 v9, v72, v73, v74
    v_min3_u32 v15, v75, v76, v77
    v_min3_u32 v9, v9, v78, v79
    v_min_u32 v9, v9, v15
    s_nop 1
    v_min_u32_dpp v9, v9, v9 row_ror:8 row_mask:0xf bank_mask:0xf
    s_nop 1
    v_min_u32_dpp v9, v9, v9 row_ror:4 row_mask:0xf bank_mask:0xf
    s_nop 1
    v_min_u32_dpp v9, v9, v9 row_ror:2 row_mask:0xf bank_mask:0xf
    s_nop 1
    v_min_u32_dpp v9, v9, v9 row_ror:1 row_mask:0xf bank_mask:0xf
    s_nop 0
    v_readlane_b32 s48, v9, 0
    v_readlane_b32 s49, v9, 16
    v_readlane_b32 s50, v9, 32
    v_readlane_b32 s51, v9, 48
    s_nop 0
    s_min_u32 s48, s48, s49
    s_min_u32 s50, s50, s51
    s_min_u32 s48, s48, s50
    s_sub_u32 s57, s57, s48
    v_writelane_b32 v8, s57, 6
    s_sub_u32 s57, s57, 1
    v_sub_u32 v72, s57, v80
    v_sub_u32 v73, s57, v82
    v_sub_u32 v74, s57, v84
    v_sub_u32 v75, s57, v86
    v_sub_u32 v76, s57, v88
    v_sub_u32 v77, s57, v90
    v_sub_u32 v78, s57, v92
    v_sub_u32 v79, s57, v94
    v_min3_u32 v9, v72, v73, v74
    v_min3_u32 v15, v75, v76, v77
    v_min3_u32 v9, v9, v78, v79
    v_min_u32 v9, v9, v15
    s_nop 1
    v_min_u32_dpp v9, v9, v9 row_ror:8 row_mask:0xf bank_mask:0xf
    s_nop 1
    v_min_u32_dpp v9, v9, v9 row_ror:4 row_mask:0xf bank_mask:0xf
    s_nop 1
    v_min_u32_dpp v9, v9, v9 row_ror:2 row_mask:0xf bank_mask:0xf
    s_nop 1
    v_min_u32_dpp v9, v9, v9 row_ror:1 row_mask:0xf bank_mask:0xf
    s_nop 0
    v_readlane_b32 s48, v9, 0
    v_readlane_b32 s49, v9, 16
    v_readlane_b32 s50, v9, 32
    v_readlane_b32 s51, v9, 48
    s_nop 0
    s_min_u32 s48, s48, s49
    s_min_u32 s50, s50, s51
    s_min_u32 s48, s48, s50
    s_sub_u32 s57, s57, s48
    v_writelane_b32 v8, s57, 7
    s_sub_u32 s57, s57, 1
    s_lshl_b32 s47, s22, 17
    s_lshl_b32 s39, s23, 9
    s_add_u32 s47, s47, s39
    s_lshl_b32 s39, s18, 7
    s_add_u32 s47, s47, s39
    s_lshl_b32 s38, s18, 5
    s_add_u32 s38, s38, 73856
    v_lshl_add_u32 v9, v2, 2, s38
    v_mov_b32 v20, 73728
    v_mov_b32 v21, 1
    s_mov_b64 exec, 0xff
    ds_write_b32 v9, v8
    s_mov_b64 exec, 1
    ds_add_u32 v20, v21 offset:8
    s_mov_b64 exec, -1
L_s_cw:
    ds_read_b32 v15, v20 offset:8
    s_waitcnt lgkmcnt(0)
    v_readfirstlane_b32 s38, v15
    s_nop 1
    s_cmp_ge_u32 s38, 4
    s_cbranch_scc1 L_s_cw_ok
    s_sub_u32 s96, s96, 1
    s_cbranch_scc1 L_s_cw_ok
    s_sleep 1
    s_branch L_s_cw
L_s_cw_ok:
    v_and_b32 v9, 31, v2
    v_lshlrev_b32 v9, 2, v9
    v_add_u32 v9, 73856, v9
    v_mov_b32 v15, 73856
    ds_read_b32 v14, v9
    ds_read_b128 v[64:67], v15 offset:0
    ds_read_b128 v[68:71], v15 offset:16
    ds_read_b128 v[72:75], v15 offset:32
    ds_read_b128 v[76:79], v15 offset:48
    ds_read_b128 v[80:83], v15 offset:64
    ds_read_b128 v[84:87], v15 offset:80
    ds_read_b128 v[88:91], v15 offset:96
    ds_read_b128 v[92:95], v15 offset:112
    v_mov_b32 v12, 0
    s_waitcnt lgkmcnt(0)
    v_cmp_gt_u32 s[48:49], v64, v14
    v_cmp_gt_u32 s[50:51], v65, v14
    s_nop 0
    v_addc_co_u32 v12, vcc, 0, v12, s[48:49]
    v_addc_co_u32 v12, vcc, 0, v12, s[50:51]
    v_cmp_gt_u32 s[48:49], v66, v14
    v_cmp_gt_u32 s[50:51], v67, v14
    s_nop 0
    v_addc_co_u32 v12, vcc, 0, v12, s[48:49]
    v_addc_co_u32 v12, vcc, 0, v12, s[50:51]
    v_cmp_gt_u32 s[48:49], v68, v14
    v_cmp_gt_u32 s[50:51], v69, v14
    s_nop 0
    v_addc_co_u32 v12, vcc, 0, v12, s[48:49]
    v_addc_co_u32 v12, vcc, 0, v12, s[50:51]
    v_cmp_gt_u32 s[48:49], v70, v14
    v_cmp_gt_u32 s[50:51], v71, v14
    s_nop 0
    v_addc_co_u32 v12, vcc, 0, v12, s[48:49]
    v_addc_co_u32 v12, vcc, 0, v12, s[50:51]
    v_cmp_gt_u32 s[48:49], v72, v14
    v_cmp_gt_u32 s[50:51], v73, v14
    s_nop 0
    v_addc_co_u32 v12, vcc, 0, v12, s[48:49]
    v_addc_co_u32 v12, vcc, 0, v12, s[50:51]
    v_cmp_gt_u32 s[48:49], v74, v14
    v_cmp_gt_u32 s[50:51], v75, v14
    s_nop 0
    v_addc_co_u32 v12, vcc, 0, v12, s[48:49]
    v_addc_co_u32 v12, vcc, 0, v12, s[50:51]
    v_cmp_gt_u32 s[48:49], v76, v14
    v_cmp_gt_u32 s[50:51], v77, v14
    s_nop 0
    v_addc_co_u32 v12, vcc, 0, v12, s[48:49]
    v_addc_co_u32 v12, vcc, 0, v12, s[50:51]
    v_cmp_gt_u32 s[48:49], v78, v14
    v_cmp_gt_u32 s[50:51], v79, v14
    s_nop 0
    v_addc_co_u32 v12, vcc, 0, v12, s[48:49]
    v_addc_co_u32 v12, vcc, 0, v12, s[50:51]
    v_cmp_gt_u32 s[48:49], v80, v14
    v_cmp_gt_u32 s[50:51], v81, v14
    s_nop 0
    v_addc_co_u32 v12, vcc, 0, v12, s[48:49]
    v_addc_co_u32 v12, vcc, 0, v12, s[50:51]
    v_cmp_gt_u32 s[48:49], v82, v14
    v_cmp_gt_u32 s[50:51], v83, v14
    s_nop 0
    v_addc_co_u32 v12, vcc, 0, v12, s[48:49]
    v_addc_co_u32 v12, vcc, 0, v12, s[50:51]
    v_cmp_gt_u32 s[48:49], v84, v14
    v_cmp_gt_u32 s[50:51], v85, v14
    s_nop 0
    v_addc_co_u32 v12, vcc, 0, v12, s[48:49]
    v_addc_co_u32 v12, vcc, 0, v12, s[50:51]
    v_cmp_gt_u32 s[48:49], v86, v14
    v_cmp_gt_u32 s[50:51], v87, v14
    s_nop 0
    v_addc_co_u32 v12, vcc, 0, v12, s[48:49]
    v_addc_co_u32 v12, vcc, 0, v12, s[50:51]
    v_cmp_gt_u32 s[48:49], v88, v14
    v_cmp_gt_u32 s[50:51], v89, v14
    s_nop 0
    v_addc_co_u32 v12, vcc, 0, v12, s[48:49]
    v_addc_co_u32 v12, vcc, 0, v12, s[50:51]
    v_cmp_gt_u32 s[48:49], v90, v14
    v_cmp_gt_u32 s[50:51], v91, v14
    s_nop 0
    v_addc_co_u32 v12, vcc, 0, v12, s[48:49]
    v_addc_co_u32 v12, vcc, 0, v12, s[50:51]
    v_cmp_gt_u32 s[48:49], v92, v14
    v_cmp_gt_u32 s[50:51], v93, v14
    s_nop 0
    v_addc_co_u32 v12, vcc, 0, v12, s[48:49]
    v_addc_co_u32 v12, vcc, 0, v12, s[50:51]
    v_cmp_gt_u32 s[48:49], v94, v14
    v_cmp_gt_u32 s[50:51], v95, v14
    s_nop 0
    v_addc_co_u32 v12, vcc, 0, v12, s[48:49]
    v_addc_co_u32 v12, vcc, 0, v12, s[50:51]
    v_lshlrev_b32 v12, 2, v12
    s_mov_b32 exec_hi, 0
    ds_permute_b32 v13, v12, v14
    s_mov_b64 exec, -1
    v_and_b32 v12, 7, v2
    v_lshlrev_b32 v12, 2, v12
    s_waitcnt lgkmcnt(0)
    ds_bpermute_b32 v8, v12, v13
    s_waitcnt lgkmcnt(0)
    v_lshlrev_b32 v9, 2, v2
    v_add_u32 v9, 73984, v9
    s_mov_b64 exec, 0xff
    ds_write_b32 v9, v8
    s_mov_b64 exec, 1
    ds_add_u32 v20, v21 offset:32
    s_mov_b64 exec, -1
    s_or_b32 s38, s2, s18
    s_cbranch_scc1 L_s_noep
    s_mov_b64 exec, 1
    s_mov_b32 s38, 9469952
    v_mov_b32 v13, s93
    v_mov_b32 v9, 0
    buffer_store_dword v13, v9, s[12:15], s38 offen
    s_mov_b64 exec, -1
L_s_noep:
    v_and_b32 v9, 0x7ff, v8
    v_sub_u32 v9, 2047, v9
    v_lshlrev_b32 v9, 11, v9
    v_lshl_add_u32 v9, v10, 4, v9
    s_lshl_b32 s38, s44, 1
    s_and_b32 s38, s38, 2047
    buffer_load_dwordx4 v[64:67], v9, s[4:7], s38 offen offset:0
    buffer_load_dwordx4 v[68:71], v9, s[4:7], s38 offen offset:64
    s_waitcnt vmcnt(0)
    v_lshlrev_b32 v60, 3, v0
    v_and_b32 v60, 2047, v60
    buffer_load_dwordx2 v[62:63], v60, s[32:35], s59 offen
    s_mov_b32 s59, 0
    s_cmp_ge_u32 s2, 224
    s_cbranch_scc1 L_s_gudone
    ds_read_b64_tr_b16 v[100:101], v16 offset:0
    ds_read_b64_tr_b16 v[102:103], v16 offset:512
    ds_read_b64_tr_b16 v[104:105], v16 offset:4096
    ds_read_b64_tr_b16 v[106:107], v16 offset:4608
    ds_read_b64_tr_b16 v[108:109], v17 offset:0
    ds_read_b64_tr_b16 v[110:111], v17 offset:512
    ds_read_b64_tr_b16 v[112:113], v17 offset:4096
    ds_read_b64_tr_b16 v[114:115], v17 offset:4608
    ds_read_b64_tr_b16 v[116:117], v18 offset:0
    ds_read_b64_tr_b16 v[118:119], v18 offset:512
    ds_read_b64_tr_b16 v[120:121], v18 offset:4096
    ds_read_b64_tr_b16 v[122:123], v18 offset:4608
    ds_read_b64_tr_b16 v[124:125], v19 offset:0
    ds_read_b64_tr_b16 v[126:127], v19 offset:512
    ds_read_b64_tr_b16 v[128:129], v19 offset:4096
    ds_read_b64_tr_b16 v[130:131], v19 offset:4608
    s_waitcnt lgkmcnt(0)
    ds_read_b64_tr_b16 v[132:133], v16 offset:8192
    ds_read_b64_tr_b16 v[134:135], v16 offset:8704
    ds_read_b64_tr_b16 v[136:137], v16 offset:12288
    ds_read_b64_tr_b16 v[138:139], v16 offset:12800
    ds_read_b64_tr_b16 v[140:141], v17 offset:8192
    ds_read_b64_tr_b16 v[142:143], v17 offset:8704
    ds_read_b64_tr_b16 v[144:145], v17 offset:12288
    ds_read_b64_tr_b16 v[146:147], v17 offset:12800
    ds_read_b64_tr_b16 v[148:149], v18 offset:8192
    ds_read_b64_tr_b16 v[150:151], v18 offset:8704
    ds_read_b64_tr_b16 v[152:153], v18 offset:12288
    ds_read_b64_tr_b16 v[154:155], v18 offset:12800
    ds_read_b64_tr_b16 v[156:157], v19 offset:8192
    ds_read_b64_tr_b16 v[158:159], v19 offset:8704
    ds_read_b64_tr_b16 v[160:161], v19 offset:12288
    ds_read_b64_tr_b16 v[162:163], v19 offset:12800
    s_waitcnt lgkmcnt(0)
    v_mfma_f32_16x16x32_bf16 v[24:27], v[100:103], v[64:67], 0
    v_mfma_f32_16x16x32_bf16 v[28:31], v[108:111], v[64:67], 0
    v_mfma_f32_16x16x32_bf16 v[32:35], v[116:119], v[64:67], 0
    v_mfma_f32_16x16x32_bf16 v[36:39], v[124:127], v[64:67], 0
    v_mfma_f32_16x16x32_bf16 v[40:43], v[132:135], v[64:67], 0
    v_mfma_f32_16x16x32_bf16 v[44:47], v[140:143], v[64:67], 0
    v_mfma_f32_16x16x32_bf16 v[48:51], v[148:151], v[64:67], 0
    v_mfma_f32_16x16x32_bf16 v[52:55], v[156:159], v[64:67], 0
    v_mfma_f32_16x16x32_bf16 v[24:27], v[104:107], v[68:71], v[24:27]
    v_mfma_f32_16x16x32_bf16 v[28:31], v[112:115], v[68:71], v[28:31]
    v_mfma_f32_16x16x32_bf16 v[32:35], v[120:123], v[68:71], v[32:35]
    v_mfma_f32_16x16x32_bf16 v[36:39], v[128:131], v[68:71], v[36:39]
    v_mfma_f32_16x16x32_bf16 v[40:43], v[136:139], v[68:71], v[40:43]
    v_mfma_f32_16x16x32_bf16 v[44:47], v[144:147], v[68:71], v[44:47]
    v_mfma_f32_16x16x32_bf16 v[48:51], v[152:155], v[68:71], v[48:51]
    v_mfma_f32_16x16x32_bf16 v[52:55], v[160:163], v[68:71], v[52:55]
    v_add_u32 v13, s46, v3
    s_nop 7
    ds_write_b128 v13, v[24:27] offset:0
    ds_write_b128 v13, v[28:31] offset:1024
    ds_write_b128 v13, v[32:35] offset:2048
    ds_write_b128 v13, v[36:39] offset:3072
    ds_write_b128 v13, v[40:43] offset:4096
    ds_write_b128 v13, v[44:47] offset:5120
    ds_write_b128 v13, v[48:51] offset:6144
    ds_write_b128 v13, v[52:55] offset:7168
    s_add_u32 m0, s46, 8192
    s_nop 0
    buffer_load_dwordx4 v5, s[8:11], s47 offen lds
    s_add_u32 s47, s47, 16384
    s_add_u32 m0, s46, 9216
    s_nop 0
    buffer_load_dwordx4 v5, s[8:11], s47 offen lds
    s_add_u32 s47, s47, 16384
    s_add_u32 m0, s46, 10240
    s_nop 0
    buffer_load_dwordx4 v5, s[8:11], s47 offen lds
    s_add_u32 s47, s47, 16384
    s_add_u32 m0, s46, 11264
    s_nop 0
    buffer_load_dwordx4 v5, s[8:11], s47 offen lds
    s_add_u32 s47, s47, 16384
    s_add_u32 m0, s46, 12288
    s_nop 0
    buffer_load_dwordx4 v5, s[8:11], s47 offen lds
    s_add_u32 s47, s47, 16384
    s_add_u32 m0, s46, 13312
    s_nop 0
    buffer_load_dwordx4 v5, s[8:11], s47 offen lds
    s_add_u32 s47, s47, 16384
    s_add_u32 m0, s46, 14336
    s_nop 0
    buffer_load_dwordx4 v5, s[8:11], s47 offen lds
    s_add_u32 s47, s47, 16384
    s_add_u32 m0, s46, 15360
    s_nop 0
    buffer_load_dwordx4 v5, s[8:11], s47 offen lds
    s_add_u32 s47, s47, 16384
    v_mov_b32 v15, 1
    s_mov_b64 exec, 1
    ds_add_rtn_u32 v15, v20, v15 offset:0
    s_mov_b64 exec, -1
    s_waitcnt lgkmcnt(0)
    v_readfirstlane_b32 s39, v15
    s_nop 1
    s_cmp_lg_u32 s39, 3
    s_cbranch_scc1 L_s_gudone
    v_add_u32 v13, 98304, v3
    ds_read_b128 v[100:103], v13 offset:0
    ds_read_b128 v[104:107], v13 offset:1024
    ds_read_b128 v[108:111], v13 offset:2048
    ds_read_b128 v[112:115], v13 offset:3072
    ds_read_b128 v[116:119], v13 offset:4096
    ds_read_b128 v[120:123], v13 offset:5120
    ds_read_b128 v[124:127], v13 offset:6144
    ds_read_b128 v[128:131], v13 offset:7168
    ds_read_b128 v[132:135], v13 offset:16384
    ds_read_b128 v[136:139], v13 offset:17408
    ds_read_b128 v[140:143], v13 offset:18432
    ds_read_b128 v[144:147], v13 offset:19456
    ds_read_b128 v[148:151], v13 offset:20480
    ds_read_b128 v[152:155], v13 offset:21504
    ds_read_b128 v[156:159], v13 offset:22528
    ds_read_b128 v[160:163], v13 offset:23552
    s_waitcnt lgkmcnt(0)
    ds_read_b128 v[164:167], v13 offset:32768
    ds_read_b128 v[168:171], v13 offset:33792
    ds_read_b128 v[172:175], v13 offset:34816
    ds_read_b128 v[176:179], v13 offset:35840
    ds_read_b128 v[180:183], v13 offset:36864
    ds_read_b128 v[184:187], v13 offset:37888
    ds_read_b128 v[188:191], v13 offset:38912
    ds_read_b128 v[192:195], v13 offset:39936
    ds_read_b128 v[196:199], v13 offset:49152
    ds_read_b128 v[200:203], v13 offset:50176
    ds_read_b128 v[204:207], v13 offset:51200
    ds_read_b128 v[208:211], v13 offset:52224
    ds_read_b128 v[212:215], v13 offset:53248
    ds_read_b128 v[216:219], v13 offset:54272
    ds_read_b128 v[220:223], v13 offset:55296
    ds_read_b128 v[224:227], v13 offset:56320
    s_waitcnt lgkmcnt(0)
    v_pk_add_f32 v[100:101], v[100:101], v[132:133]
    v_pk_add_f32 v[164:165], v[164:165], v[196:197]
    v_pk_add_f32 v[100:101], v[100:101], v[164:165]
    v_pk_add_f32 v[102:103], v[102:103], v[134:135]
    v_pk_add_f32 v[166:167], v[166:167], v[198:199]
    v_pk_add_f32 v[102:103], v[102:103], v[166:167]
    v_pk_add_f32 v[104:105], v[104:105], v[136:137]
    v_pk_add_f32 v[168:169], v[168:169], v[200:201]
    v_pk_add_f32 v[104:105], v[104:105], v[168:169]
    v_pk_add_f32 v[106:107], v[106:107], v[138:139]
    v_pk_add_f32 v[170:171], v[170:171], v[202:203]
    v_pk_add_f32 v[106:107], v[106:107], v[170:171]
    v_pk_add_f32 v[108:109], v[108:109], v[140:141]
    v_pk_add_f32 v[172:173], v[172:173], v[204:205]
    v_pk_add_f32 v[108:109], v[108:109], v[172:173]
    v_pk_add_f32 v[110:111], v[110:111], v[142:143]
    v_pk_add_f32 v[174:175], v[174:175], v[206:207]
    v_pk_add_f32 v[110:111], v[110:111], v[174:175]
    v_pk_add_f32 v[112:113], v[112:113], v[144:145]
    v_pk_add_f32 v[176:177], v[176:177], v[208:209]
    v_pk_add_f32 v[112:113], v[112:113], v[176:177]
    v_pk_add_f32 v[114:115], v[114:115], v[146:147]
    v_pk_add_f32 v[178:179], v[178:179], v[210:211]
    v_pk_add_f32 v[114:115], v[114:115], v[178:179]
    v_pk_add_f32 v[116:117], v[116:117], v[148:149]
    v_pk_add_f32 v[180:181], v[180:181], v[212:213]
    v_pk_add_f32 v[116:117], v[116:117], v[180:181]
    v_pk_add_f32 v[118:119], v[118:119], v[150:151]
    v_pk_add_f32 v[182:183], v[182:183], v[214:215]
    v_pk_add_f32 v[118:119], v[118:119], v[182:183]
    v_pk_add_f32 v[120:121], v[120:121], v[152:153]
    v_pk_add_f32 v[184:185], v[184:185], v[216:217]
    v_pk_add_f32 v[120:121], v[120:121], v[184:185]
    v_pk_add_f32 v[122:123], v[122:123], v[154:155]
    v_pk_add_f32 v[186:187], v[186:187], v[218:219]
    v_pk_add_f32 v[122:123], v[122:123], v[186:187]
    v_pk_add_f32 v[124:125], v[124:125], v[156:157]
    v_pk_add_f32 v[188:189], v[188:189], v[220:221]
    v_pk_add_f32 v[124:125], v[124:125], v[188:189]
    v_pk_add_f32 v[126:127], v[126:127], v[158:159]
    v_pk_add_f32 v[190:191], v[190:191], v[222:223]
    v_pk_add_f32 v[126:127], v[126:127], v[190:191]
    v_pk_add_f32 v[128:129], v[128:129], v[160:161]
    v_pk_add_f32 v[192:193], v[192:193], v[224:225]
    v_pk_add_f32 v[128:129], v[128:129], v[192:193]
    v_pk_add_f32 v[130:131], v[130:131], v[162:163]
    v_pk_add_f32 v[194:195], v[194:195], v[226:227]
    v_pk_add_f32 v[130:131], v[130:131], v[194:195]
    v_and_b32 v13, 7, v2
    v_mul_u32_u24 v13, 14336, v13
    v_lshl_add_u32 v13, v10, 4, v13
    v_and_b32 v14, 8, v2
    v_lshl_add_u32 v13, v14, 3, v13
    v_cmp_eq_u32 vcc, 8, v14
    s_mul_i32 s38, s23, 229376
    s_lshl_b32 s39, s22, 8
    s_add_u32 s38, s38, s39
    s_add_u32 s38, s38, 10485760
    s_add_u32 s39, s38, 114688
    v_cndmask_b32 v100, v100, v104, vcc
    v_cndmask_b32 v101, v101, v105, vcc
    v_cndmask_b32 v102, v102, v106, vcc
    v_cndmask_b32 v103, v103, v107, vcc
    buffer_store_dwordx4 v[100:103], v13, s[12:15], s38 offen offset:0 sc1
    v_cndmask_b32 v108, v108, v112, vcc
    v_cndmask_b32 v109, v109, v113, vcc
    v_cndmask_b32 v110, v110, v114, vcc
    v_cndmask_b32 v111, v111, v115, vcc
    buffer_store_dwordx4 v[108:111], v13, s[12:15], s38 offen offset:128 sc1
    v_cndmask_b32 v116, v116, v120, vcc
    v_cndmask_b32 v117, v117, v121, vcc
    v_cndmask_b32 v118, v118, v122, vcc
    v_cndmask_b32 v119, v119, v123, vcc
    buffer_store_dwordx4 v[116:119], v13, s[12:15], s39 offen offset:0 sc1
    v_cndmask_b32 v124, v124, v128, vcc
    v_cndmask_b32 v125, v125, v129, vcc
    v_cndmask_b32 v126, v126, v130, vcc
    v_cndmask_b32 v127, v127, v131, vcc
    buffer_store_dwordx4 v[124:127], v13, s[12:15], s39 offen offset:128 sc1
    s_mov_b32 s59, 1
L_s_gudone:
    s_cmp_eq_u32 s59, 0
    s_cbranch_scc1 L_s_nogf
    s_lshl_b32 s38, s22, 10
    s_lshl_b32 s39, s23, 8
    s_add_u32 s38, s38, s39
    s_add_u32 s38, s38, 9568256
    v_mov_b32 v13, s93
    v_lshlrev_b32 v14, 2, v2
    s_waitcnt vmcnt(0)
    s_mov_b32 exec_hi, 0
    buffer_store_dword v13, v14, s[12:15], s38 offen sc1
    s_mov_b32 exec_hi, -1
L_s_nogf:
L_s_h2done:
    s_cmp_ge_u32 s2, 224
    s_cbranch_scc1 L_s_cons
    s_lshl_b32 s56, s22, 10
    s_add_u32 s56, s56, 9568256
    v_and_b32 v13, 3, v2
    v_lshlrev_b32 v13, 8, v13
    v_and_b32 v1, 255, v0
    v_lshrrev_b32 v6, 5, v1
    v_and_b32 v7, 31, v1
    v_mul_u32_u24 v9, 14336, v6
    v_lshl_add_u32 v9, v7, 3, v9
L_s_gpoll:
    buffer_load_dword v14, v13, s[12:15], s56 offen sc1
    s_waitcnt vmcnt(0)
    v_cmp_ne_u32 vcc, s93, v14
    s_nop 1
    s_cmp_eq_u64 vcc, 0
    s_cbranch_scc1 L_s_ggo
    s_sub_u32 s96, s96, 1
    s_cbranch_scc1 L_s_ggo
    s_sleep 16
    s_branch L_s_gpoll
L_s_ggo:
    s_lshl_b32 s38, s22, 8
    s_add_u32 s38, s38, 10485760
    buffer_load_dwordx2 v[24:25], v9, s[12:15], s38 offen sc1
    s_add_u32 s38, s38, 114688
    buffer_load_dwordx2 v[26:27], v9, s[12:15], s38 offen sc1
    s_add_u32 s38, s38, 114688
    buffer_load_dwordx2 v[28:29], v9, s[12:15], s38 offen sc1
    s_add_u32 s38, s38, 114688
    buffer_load_dwordx2 v[30:31], v9, s[12:15], s38 offen sc1
    s_add_u32 s38, s38, 114688
    buffer_load_dwordx2 v[32:33], v9, s[12:15], s38 offen sc1
    s_add_u32 s38, s38, 114688
    buffer_load_dwordx2 v[34:35], v9, s[12:15], s38 offen sc1
    s_add_u32 s38, s38, 114688
    buffer_load_dwordx2 v[36:37], v9, s[12:15], s38 offen sc1
    s_add_u32 s38, s38, 114688
    buffer_load_dwordx2 v[38:39], v9, s[12:15], s38 offen sc1
    s_add_u32 s38, s38, 114688
    ds_read_b64_tr_b16 v[64:65], v16 offset:8192
    ds_read_b64_tr_b16 v[66:67], v16 offset:8704
    ds_read_b64_tr_b16 v[68:69], v16 offset:12288
    ds_read_b64_tr_b16 v[70:71], v16 offset:12800
    ds_read_b64_tr_b16 v[72:73], v17 offset:8192
    ds_read_b64_tr_b16 v[74:75], v17 offset:8704
    ds_read_b64_tr_b16 v[76:77], v17 offset:12288
    ds_read_b64_tr_b16 v[78:79], v17 offset:12800
    ds_read_b64_tr_b16 v[80:81], v18 offset:8192
    ds_read_b64_tr_b16 v[82:83], v18 offset:8704
    ds_read_b64_tr_b16 v[84:85], v18 offset:12288
    ds_read_b64_tr_b16 v[86:87], v18 offset:12800
    ds_read_b64_tr_b16 v[88:89], v19 offset:8192
    ds_read_b64_tr_b16 v[90:91], v19 offset:8704
    ds_read_b64_tr_b16 v[92:93], v19 offset:12288
    ds_read_b64_tr_b16 v[94:95], v19 offset:12800
    s_waitcnt vmcnt(0)
    v_add_f32 v24, v24, v28
    v_add_f32 v32, v32, v36
    v_add_f32 v24, v24, v32
    v_cvt_pk_bf16_f32 v24, v24, v24
    v_lshlrev_b32 v24, 16, v24
    v_add_f32 v25, v25, v29
    v_add_f32 v33, v33, v37
    v_add_f32 v25, v25, v33
    v_cvt_pk_bf16_f32 v25, v25, v25
    v_lshlrev_b32 v25, 16, v25
    v_add_f32 v26, v26, v30
    v_add_f32 v34, v34, v38
    v_add_f32 v26, v26, v34
    v_cvt_pk_bf16_f32 v26, v26, v26
    v_lshlrev_b32 v26, 16, v26
    v_add_f32 v27, v27, v31
    v_add_f32 v35, v35, v39
    v_add_f32 v27, v27, v35
    v_cvt_pk_bf16_f32 v27, v27, v27
    v_lshlrev_b32 v27, 16, v27
    v_mul_f32 v40, 0xbfb8aa3b, v24
    v_exp_f32 v40, v40
    s_nop 0
    v_add_f32 v40, 1.0, v40
    v_rcp_f32 v40, v40
    s_nop 0
    v_mul_f32 v40, v40, v24
    v_cvt_pk_bf16_f32 v40, v40, v40
    v_lshlrev_b32 v40, 16, v40
    v_mul_f32 v40, v40, v26
    v_mul_f32 v41, 0xbfb8aa3b, v25
    v_exp_f32 v41, v41
    s_nop 0
    v_add_f32 v41, 1.0, v41
    v_rcp_f32 v41, v41
    s_nop 0
    v_mul_f32 v41, v41, v25
    v_cvt_pk_bf16_f32 v41, v41, v41
    v_lshlrev_b32 v41, 16, v41
    v_mul_f32 v41, v41, v27
    v_cvt_pk_bf16_f32 v40, v40, v41
    v_mul_u32_u24 v9, 144, v6
    v_lshl_add_u32 v9, v7, 2, v9
    v_add_u32 v9, 74240, v9
    ds_write_b32 v9, v40
    s_mov_b64 exec, 1
    ds_add_u32 v20, v21 offset:20
    s_mov_b64 exec, -1
    v_and_b32 v9, 7, v2
    v_mul_u32_u24 v9, 144, v9
    v_lshl_add_u32 v9, v10, 4, v9
    v_add_u32 v9, 74240, v9
L_s_aw:
    ds_read_b32 v15, v20 offset:20
    s_waitcnt lgkmcnt(0)
    v_readfirstlane_b32 s38, v15
    s_nop 1
    s_cmp_ge_u32 s38, 4
    s_cbranch_scc1 L_s_aw_ok
    s_sub_u32 s96, s96, 1
    s_cbranch_scc1 L_s_aw_ok
    s_sleep 1
    s_branch L_s_aw
L_s_aw_ok:
    ds_read_b128 v[40:43], v9
    ds_read_b128 v[44:47], v9 offset:64
    s_mov_b32 s38, 229376
    v_and_b32 v15, 7, v2
    v_mul_lo_u32 v15, v15, s38
    v_lshl_add_u32 v15, v10, 4, v15
    v_and_b32 v14, 8, v2
    v_lshl_add_u32 v15, v14, 3, v15
    s_lshl_b32 s38, s22, 12
    s_lshl_b32 s39, s23, 10
    s_add_u32 s38, s38, s39
    s_lshl_b32 s39, s18, 8
    s_add_u32 s38, s38, s39
    s_add_u32 s38, s38, 13631488
    v_cmp_eq_u32 vcc, 8, v14
    s_waitcnt lgkmcnt(0)
    v_mfma_f32_16x16x32_bf16 v[48:51], v[64:67], v[40:43], 0
    v_mfma_f32_16x16x32_bf16 v[52:55], v[72:75], v[40:43], 0
    v_mfma_f32_16x16x32_bf16 v[56:59], v[80:83], v[40:43], 0
    v_mfma_f32_16x16x32_bf16 v[60:63], v[88:91], v[40:43], 0
    v_mfma_f32_16x16x32_bf16 v[48:51], v[68:71], v[44:47], v[48:51]
    v_mfma_f32_16x16x32_bf16 v[52:55], v[76:79], v[44:47], v[52:55]
    v_mfma_f32_16x16x32_bf16 v[56:59], v[84:87], v[44:47], v[56:59]
    v_mfma_f32_16x16x32_bf16 v[60:63], v[92:95], v[44:47], v[60:63]
    s_nop 7
    v_cndmask_b32 v48, v48, v52, vcc
    v_cndmask_b32 v49, v49, v53, vcc
    v_cndmask_b32 v50, v50, v54, vcc
    v_cndmask_b32 v51, v51, v55, vcc
    buffer_store_dwordx4 v[48:51], v15, s[12:15], s38 offen offset:0 sc1
    v_cndmask_b32 v56, v56, v60, vcc
    v_cndmask_b32 v57, v57, v61, vcc
    v_cndmask_b32 v58, v58, v62, vcc
    v_cndmask_b32 v59, v59, v63, vcc
    buffer_store_dwordx4 v[56:59], v15, s[12:15], s38 offen offset:128 sc1
    s_lshl_b32 s58, s23, 14
    s_lshl_b32 s39, s22, 8
    s_add_u32 s58, s58, s39
    s_add_u32 s58, s58, 9633792
    v_mov_b32 v13, s93
    v_lshlrev_b32 v14, 2, v2
    s_waitcnt vmcnt(0)
    v_mov_b32 v15, 1
    s_mov_b64 exec, 1
    ds_add_rtn_u32 v15, v20, v15 offset:24
    s_mov_b64 exec, -1
    s_waitcnt lgkmcnt(0)
    v_readfirstlane_b32 s39, v15
    s_nop 1
    s_cmp_lg_u32 s39, 3
    s_cbranch_scc1 L_s_cons
    s_mov_b32 exec_hi, 0
    buffer_store_dword v13, v14, s[12:15], s58 offen sc1
    s_mov_b32 exec_hi, -1
L_s_cons:
    s_add_u32 s38, s18, 4
    v_readlane_b32 s24, v8, s18
    v_readlane_b32 s25, v8, s38
    s_lshl_b32 s45, s16, 7
    s_and_b32 s26, s24, 0x7ff
    s_sub_u32 s26, 2047, s26
    s_sub_u32 s56, s26, s45
    s_and_b32 s27, s25, 0x7ff
    s_sub_u32 s27, 2047, s27
    s_sub_u32 s57, s27, s45
    s_waitcnt lgkmcnt(0)
    s_min_u32 s38, s56, s57
    s_cmp_ge_u32 s38, 128
    s_cbranch_scc1 L_s_end
L_s_pw:
    ds_read_b32 v15, v20 offset:16
    s_waitcnt lgkmcnt(0)
    v_readfirstlane_b32 s38, v15
    s_nop 1
    s_cmp_ge_u32 s38, 40
    s_cbranch_scc1 L_s_pw_ok
    s_sub_u32 s96, s96, 1
    s_cbranch_scc1 L_s_pw_ok
    s_sleep 8
    s_branch L_s_pw
L_s_pw_ok:
    s_lshr_b32 s58, s17, 2
    s_lshl_b32 s58, s58, 14
    s_add_u32 s58, s58, 9633792
    v_min_u32 v4, 55, v2
    v_lshlrev_b32 v4, 8, v4
    v_lshlrev_b32 v6, 12, v10
    v_lshl_add_u32 v6, v11, 4, v6
    v_lshlrev_b32 v9, 3, v11
    v_mov_b32 v7, 0
L_s_ypoll:
    buffer_load_dword v5, v4, s[12:15], s58 offen sc1
    s_waitcnt vmcnt(0)
    v_cmp_ne_u32 vcc, s93, v5
    s_nop 1
    s_cmp_eq_u64 vcc, 0
    s_cbranch_scc1 L_s_ygo
    s_sub_u32 s96, s96, 1
    s_cbranch_scc1 L_s_ygo
    s_sleep 12
    s_branch L_s_ypoll
L_s_ygo:
    s_cmp_ge_u32 s56, 128
    s_cbranch_scc1 L_s_sk0
    s_add_u32 s39, s18, 0
    s_mul_i32 s39, s39, 229376
    s_lshl_b32 s3, s17, 8
    s_add_u32 s39, s39, s3
    s_add_u32 s39, s39, 13631488
    buffer_load_dwordx4 v[24:27], v6, s[12:15], s39 offen sc1
    s_add_u32 s39, s39, 16384
    buffer_load_dwordx4 v[28:31], v6, s[12:15], s39 offen sc1
    s_add_u32 s39, s39, 16384
    buffer_load_dwordx4 v[32:35], v6, s[12:15], s39 offen sc1
    s_add_u32 s39, s39, 16384
    buffer_load_dwordx4 v[36:39], v6, s[12:15], s39 offen sc1
    s_add_u32 s39, s39, 16384
    buffer_load_dwordx4 v[40:43], v6, s[12:15], s39 offen sc1
    s_add_u32 s39, s39, 16384
    buffer_load_dwordx4 v[44:47], v6, s[12:15], s39 offen sc1
    s_add_u32 s39, s39, 16384
    buffer_load_dwordx4 v[48:51], v6, s[12:15], s39 offen sc1
    s_add_u32 s39, s39, 16384
    buffer_load_dwordx4 v[52:55], v6, s[12:15], s39 offen sc1
    s_add_u32 s39, s39, 16384
    buffer_load_dwordx4 v[56:59], v6, s[12:15], s39 offen sc1
    s_add_u32 s39, s39, 16384
    buffer_load_dwordx4 v[60:63], v6, s[12:15], s39 offen sc1
    s_add_u32 s39, s39, 16384
    buffer_load_dwordx4 v[64:67], v6, s[12:15], s39 offen sc1
    s_add_u32 s39, s39, 16384
    buffer_load_dwordx4 v[68:71], v6, s[12:15], s39 offen sc1
    s_add_u32 s39, s39, 16384
    buffer_load_dwordx4 v[72:75], v6, s[12:15], s39 offen sc1
    s_add_u32 s39, s39, 16384
    buffer_load_dwordx4 v[76:79], v6, s[12:15], s39 offen sc1
    s_add_u32 s39, s39, 16384
    s_lshl_b32 s39, s26, 11
    s_lshl_b32 s3, s17, 7
    s_add_u32 s39, s39, s3
    buffer_load_dwordx2 v[80:81], v9, s[4:7], s39 offen
    s_lshl_b32 s39, s26, 3
    s_add_u32 s39, s39, 9453568
    buffer_load_dword v82, v7, s[12:15], s39 offen sc1
L_s_sk0:
    s_cmp_ge_u32 s57, 128
    s_cbranch_scc1 L_s_sk1
    s_add_u32 s39, s18, 4
    s_mul_i32 s39, s39, 229376
    s_lshl_b32 s3, s17, 8
    s_add_u32 s39, s39, s3
    s_add_u32 s39, s39, 13631488
    buffer_load_dwordx4 v[88:91], v6, s[12:15], s39 offen sc1
    s_add_u32 s39, s39, 16384
    buffer_load_dwordx4 v[92:95], v6, s[12:15], s39 offen sc1
    s_add_u32 s39, s39, 16384
    buffer_load_dwordx4 v[96:99], v6, s[12:15], s39 offen sc1
    s_add_u32 s39, s39, 16384
    buffer_load_dwordx4 v[100:103], v6, s[12:15], s39 offen sc1
    s_add_u32 s39, s39, 16384
    buffer_load_dwordx4 v[104:107], v6, s[12:15], s39 offen sc1
    s_add_u32 s39, s39, 16384
    buffer_load_dwordx4 v[108:111], v6, s[12:15], s39 offen sc1
    s_add_u32 s39, s39, 16384
    buffer_load_dwordx4 v[112:115], v6, s[12:15], s39 offen sc1
    s_add_u32 s39, s39, 16384
    buffer_load_dwordx4 v[116:119], v6, s[12:15], s39 offen sc1
    s_add_u32 s39, s39, 16384
    buffer_load_dwordx4 v[120:123], v6, s[12:15], s39 offen sc1
    s_add_u32 s39, s39, 16384
    buffer_load_dwordx4 v[124:127], v6, s[12:15], s39 offen sc1
    s_add_u32 s39, s39, 16384
    buffer_load_dwordx4 v[128:131], v6, s[12:15], s39 offen sc1
    s_add_u32 s39, s39, 16384
    buffer_load_dwordx4 v[132:135], v6, s[12:15], s39 offen sc1
    s_add_u32 s39, s39, 16384
    buffer_load_dwordx4 v[136:139], v6, s[12:15], s39 offen sc1
    s_add_u32 s39, s39, 16384
    buffer_load_dwordx4 v[140:143], v6, s[12:15], s39 offen sc1
    s_add_u32 s39, s39, 16384
    s_lshl_b32 s39, s27, 11
    s_lshl_b32 s3, s17, 7
    s_add_u32 s39, s39, s3
    buffer_load_dwordx2 v[144:145], v9, s[4:7], s39 offen
    s_lshl_b32 s39, s27, 3
    s_add_u32 s39, s39, 9453568
    buffer_load_dword v146, v7, s[12:15], s39 offen sc1
L_s_sk1:
    s_waitcnt vmcnt(0)
    s_cmp_ge_u32 s56, 128
    s_cbranch_scc1 L_s_sc0
    s_ashr_i32 s39, s24, 31
    s_not_b32 s39, s39
    s_or_b32 s39, s39, 0x80000000
    s_xor_b32 s39, s24, s39
    s_and_b32 s39, s39, 0xffff0000
    v_mov_b32 v86, s39
    v_mul_f32 v83, 0xbfb8aa3b, v86
    v_exp_f32 v83, v83
    s_nop 0
    v_add_f32 v83, 1.0, v83
    v_rcp_f32 v83, v83
    s_nop 0
    v_cvt_pk_bf16_f32 v83, v83, v83
    v_lshlrev_b32 v83, 16, v83
    v_pk_add_f32 v[24:25], v[24:25], v[28:29]
    v_pk_add_f32 v[26:27], v[26:27], v[30:31]
    v_pk_add_f32 v[24:25], v[24:25], v[32:33]
    v_pk_add_f32 v[26:27], v[26:27], v[34:35]
    v_pk_add_f32 v[24:25], v[24:25], v[36:37]
    v_pk_add_f32 v[26:27], v[26:27], v[38:39]
    v_pk_add_f32 v[24:25], v[24:25], v[40:41]
    v_pk_add_f32 v[26:27], v[26:27], v[42:43]
    v_pk_add_f32 v[24:25], v[24:25], v[44:45]
    v_pk_add_f32 v[26:27], v[26:27], v[46:47]
    v_pk_add_f32 v[24:25], v[24:25], v[48:49]
    v_pk_add_f32 v[26:27], v[26:27], v[50:51]
    v_pk_add_f32 v[24:25], v[24:25], v[52:53]
    v_pk_add_f32 v[26:27], v[26:27], v[54:55]
    v_pk_add_f32 v[24:25], v[24:25], v[56:57]
    v_pk_add_f32 v[26:27], v[26:27], v[58:59]
    v_pk_add_f32 v[24:25], v[24:25], v[60:61]
    v_pk_add_f32 v[26:27], v[26:27], v[62:63]
    v_pk_add_f32 v[24:25], v[24:25], v[64:65]
    v_pk_add_f32 v[26:27], v[26:27], v[66:67]
    v_pk_add_f32 v[24:25], v[24:25], v[68:69]
    v_pk_add_f32 v[26:27], v[26:27], v[70:71]
    v_pk_add_f32 v[24:25], v[24:25], v[72:73]
    v_pk_add_f32 v[26:27], v[26:27], v[74:75]
    v_pk_add_f32 v[24:25], v[24:25], v[76:77]
    v_pk_add_f32 v[26:27], v[26:27], v[78:79]
    v_mov_b32 v28, v24
    v_mov_b32 v29, v25
    v_mov_b32 v30, v26
    v_mov_b32 v31, v27
    s_nop 1
    v_permlane16_swap_b32 v24, v28
    v_permlane16_swap_b32 v25, v29
    v_permlane16_swap_b32 v26, v30
    v_permlane16_swap_b32 v27, v31
    s_nop 1
    v_add_f32 v24, v24, v28
    v_add_f32 v25, v25, v29
    v_add_f32 v26, v26, v30
    v_add_f32 v27, v27, v31
    v_mov_b32 v28, v24
    v_mov_b32 v29, v25
    v_mov_b32 v30, v26
    v_mov_b32 v31, v27
    s_nop 1
    v_permlane32_swap_b32 v24, v28
    v_permlane32_swap_b32 v25, v29
    v_permlane32_swap_b32 v26, v30
    v_permlane32_swap_b32 v27, v31
    s_nop 1
    v_add_f32 v24, v24, v28
    v_add_f32 v25, v25, v29
    v_add_f32 v26, v26, v30
    v_add_f32 v27, v27, v31
    v_sub_f32 v82, 1.0, v82
    v_cvt_pk_bf16_f32 v82, v82, v82
    v_lshlrev_b32 v82, 16, v82
    v_lshlrev_b32 v32, 16, v80
    v_and_b32 v33, s21, v80
    v_lshlrev_b32 v34, 16, v81
    v_and_b32 v35, s21, v81
    v_cvt_pk_bf16_f32 v24, v24, v24
    v_lshlrev_b32 v24, 16, v24
    v_mul_f32 v24, v24, v83
    v_cvt_pk_bf16_f32 v24, v24, v24
    v_lshlrev_b32 v24, 16, v24
    v_add_f32 v24, v24, v32
    v_cvt_pk_bf16_f32 v24, v24, v24
    v_lshlrev_b32 v24, 16, v24
    v_mul_f32 v24, v24, v82
    v_cvt_pk_bf16_f32 v24, v24, v24
    v_lshlrev_b32 v24, 16, v24
    v_mul_f32 v32, v32, v82
    v_cvt_pk_bf16_f32 v32, v32, v32
    v_lshlrev_b32 v32, 16, v32
    v_sub_f32 v24, v24, v32
    v_cvt_pk_bf16_f32 v25, v25, v25
    v_lshlrev_b32 v25, 16, v25
    v_mul_f32 v25, v25, v83
    v_cvt_pk_bf16_f32 v25, v25, v25
    v_lshlrev_b32 v25, 16, v25
    v_add_f32 v25, v25, v33
    v_cvt_pk_bf16_f32 v25, v25, v25
    v_lshlrev_b32 v25, 16, v25
    v_mul_f32 v25, v25, v82
    v_cvt_pk_bf16_f32 v25, v25, v25
    v_lshlrev_b32 v25, 16, v25
    v_mul_f32 v33, v33, v82
    v_cvt_pk_bf16_f32 v33, v33, v33
    v_lshlrev_b32 v33, 16, v33
    v_sub_f32 v25, v25, v33
    v_cvt_pk_bf16_f32 v26, v26, v26
    v_lshlrev_b32 v26, 16, v26
    v_mul_f32 v26, v26, v83
    v_cvt_pk_bf16_f32 v26, v26, v26
    v_lshlrev_b32 v26, 16, v26
    v_add_f32 v26, v26, v34
    v_cvt_pk_bf16_f32 v26, v26, v26
    v_lshlrev_b32 v26, 16, v26
    v_mul_f32 v26, v26, v82
    v_cvt_pk_bf16_f32 v26, v26, v26
    v_lshlrev_b32 v26, 16, v26
    v_mul_f32 v34, v34, v82
    v_cvt_pk_bf16_f32 v34, v34, v34
    v_lshlrev_b32 v34, 16, v34
    v_sub_f32 v26, v26, v34
    v_cvt_pk_bf16_f32 v27, v27, v27
    v_lshlrev_b32 v27, 16, v27
    v_mul_f32 v27, v27, v83
    v_cvt_pk_bf16_f32 v27, v27, v27
    v_lshlrev_b32 v27, 16, v27
    v_add_f32 v27, v27, v35
    v_cvt_pk_bf16_f32 v27, v27, v27
    v_lshlrev_b32 v27, 16, v27
    v_mul_f32 v27, v27, v82
    v_cvt_pk_bf16_f32 v27, v27, v27
    v_lshlrev_b32 v27, 16, v27
    v_mul_f32 v35, v35, v82
    v_cvt_pk_bf16_f32 v35, v35, v35
    v_lshlrev_b32 v35, 16, v35
    v_sub_f32 v27, v27, v35
    s_lshl_b32 s39, s18, 8
    s_add_u32 s39, s39, 75776
    v_lshl_add_u32 v84, v11, 4, s39
    ds_write_b128 v84, v[24:27]
    v_lshl_add_u32 v85, s18, 2, v20
    s_mov_b64 exec, 1
    ds_add_u32 v85, v21 offset:36
    s_mov_b64 exec, -1
L_s_sc0:
    s_cmp_ge_u32 s57, 128
    s_cbranch_scc1 L_s_sc1
    s_ashr_i32 s39, s25, 31
    s_not_b32 s39, s39
    s_or_b32 s39, s39, 0x80000000
    s_xor_b32 s39, s25, s39
    s_and_b32 s39, s39, 0xffff0000
    v_mov_b32 v150, s39
    v_mul_f32 v147, 0xbfb8aa3b, v150
    v_exp_f32 v147, v147
    s_nop 0
    v_add_f32 v147, 1.0, v147
    v_rcp_f32 v147, v147
    s_nop 0
    v_cvt_pk_bf16_f32 v147, v147, v147
    v_lshlrev_b32 v147, 16, v147
    v_pk_add_f32 v[88:89], v[88:89], v[92:93]
    v_pk_add_f32 v[90:91], v[90:91], v[94:95]
    v_pk_add_f32 v[88:89], v[88:89], v[96:97]
    v_pk_add_f32 v[90:91], v[90:91], v[98:99]
    v_pk_add_f32 v[88:89], v[88:89], v[100:101]
    v_pk_add_f32 v[90:91], v[90:91], v[102:103]
    v_pk_add_f32 v[88:89], v[88:89], v[104:105]
    v_pk_add_f32 v[90:91], v[90:91], v[106:107]
    v_pk_add_f32 v[88:89], v[88:89], v[108:109]
    v_pk_add_f32 v[90:91], v[90:91], v[110:111]
    v_pk_add_f32 v[88:89], v[88:89], v[112:113]
    v_pk_add_f32 v[90:91], v[90:91], v[114:115]
    v_pk_add_f32 v[88:89], v[88:89], v[116:117]
    v_pk_add_f32 v[90:91], v[90:91], v[118:119]
    v_pk_add_f32 v[88:89], v[88:89], v[120:121]
    v_pk_add_f32 v[90:91], v[90:91], v[122:123]
    v_pk_add_f32 v[88:89], v[88:89], v[124:125]
    v_pk_add_f32 v[90:91], v[90:91], v[126:127]
    v_pk_add_f32 v[88:89], v[88:89], v[128:129]
    v_pk_add_f32 v[90:91], v[90:91], v[130:131]
    v_pk_add_f32 v[88:89], v[88:89], v[132:133]
    v_pk_add_f32 v[90:91], v[90:91], v[134:135]
    v_pk_add_f32 v[88:89], v[88:89], v[136:137]
    v_pk_add_f32 v[90:91], v[90:91], v[138:139]
    v_pk_add_f32 v[88:89], v[88:89], v[140:141]
    v_pk_add_f32 v[90:91], v[90:91], v[142:143]
    v_mov_b32 v92, v88
    v_mov_b32 v93, v89
    v_mov_b32 v94, v90
    v_mov_b32 v95, v91
    s_nop 1
    v_permlane16_swap_b32 v88, v92
    v_permlane16_swap_b32 v89, v93
    v_permlane16_swap_b32 v90, v94
    v_permlane16_swap_b32 v91, v95
    s_nop 1
    v_add_f32 v88, v88, v92
    v_add_f32 v89, v89, v93
    v_add_f32 v90, v90, v94
    v_add_f32 v91, v91, v95
    v_mov_b32 v92, v88
    v_mov_b32 v93, v89
    v_mov_b32 v94, v90
    v_mov_b32 v95, v91
    s_nop 1
    v_permlane32_swap_b32 v88, v92
    v_permlane32_swap_b32 v89, v93
    v_permlane32_swap_b32 v90, v94
    v_permlane32_swap_b32 v91, v95
    s_nop 1
    v_add_f32 v88, v88, v92
    v_add_f32 v89, v89, v93
    v_add_f32 v90, v90, v94
    v_add_f32 v91, v91, v95
    v_sub_f32 v146, 1.0, v146
    v_cvt_pk_bf16_f32 v146, v146, v146
    v_lshlrev_b32 v146, 16, v146
    v_lshlrev_b32 v96, 16, v144
    v_and_b32 v97, s21, v144
    v_lshlrev_b32 v98, 16, v145
    v_and_b32 v99, s21, v145
    v_cvt_pk_bf16_f32 v88, v88, v88
    v_lshlrev_b32 v88, 16, v88
    v_mul_f32 v88, v88, v147
    v_cvt_pk_bf16_f32 v88, v88, v88
    v_lshlrev_b32 v88, 16, v88
    v_add_f32 v88, v88, v96
    v_cvt_pk_bf16_f32 v88, v88, v88
    v_lshlrev_b32 v88, 16, v88
    v_mul_f32 v88, v88, v146
    v_cvt_pk_bf16_f32 v88, v88, v88
    v_lshlrev_b32 v88, 16, v88
    v_mul_f32 v96, v96, v146
    v_cvt_pk_bf16_f32 v96, v96, v96
    v_lshlrev_b32 v96, 16, v96
    v_sub_f32 v88, v88, v96
    v_cvt_pk_bf16_f32 v89, v89, v89
    v_lshlrev_b32 v89, 16, v89
    v_mul_f32 v89, v89, v147
    v_cvt_pk_bf16_f32 v89, v89, v89
    v_lshlrev_b32 v89, 16, v89
    v_add_f32 v89, v89, v97
    v_cvt_pk_bf16_f32 v89, v89, v89
    v_lshlrev_b32 v89, 16, v89
    v_mul_f32 v89, v89, v146
    v_cvt_pk_bf16_f32 v89, v89, v89
    v_lshlrev_b32 v89, 16, v89
    v_mul_f32 v97, v97, v146
    v_cvt_pk_bf16_f32 v97, v97, v97
    v_lshlrev_b32 v97, 16, v97
    v_sub_f32 v89, v89, v97
    v_cvt_pk_bf16_f32 v90, v90, v90
    v_lshlrev_b32 v90, 16, v90
    v_mul_f32 v90, v90, v147
    v_cvt_pk_bf16_f32 v90, v90, v90
    v_lshlrev_b32 v90, 16, v90
    v_add_f32 v90, v90, v98
    v_cvt_pk_bf16_f32 v90, v90, v90
    v_lshlrev_b32 v90, 16, v90
    v_mul_f32 v90, v90, v146
    v_cvt_pk_bf16_f32 v90, v90, v90
    v_lshlrev_b32 v90, 16, v90
    v_mul_f32 v98, v98, v146
    v_cvt_pk_bf16_f32 v98, v98, v98
    v_lshlrev_b32 v98, 16, v98
    v_sub_f32 v90, v90, v98
    v_cvt_pk_bf16_f32 v91, v91, v91
    v_lshlrev_b32 v91, 16, v91
    v_mul_f32 v91, v91, v147
    v_cvt_pk_bf16_f32 v91, v91, v91
    v_lshlrev_b32 v91, 16, v91
    v_add_f32 v91, v91, v99
    v_cvt_pk_bf16_f32 v91, v91, v91
    v_lshlrev_b32 v91, 16, v91
    v_mul_f32 v91, v91, v146
    v_cvt_pk_bf16_f32 v91, v91, v91
    v_lshlrev_b32 v91, 16, v91
    v_mul_f32 v99, v99, v146
    v_cvt_pk_bf16_f32 v99, v99, v99
    v_lshlrev_b32 v99, 16, v99
    v_sub_f32 v91, v91, v99
    s_lshl_b32 s39, s18, 8
    s_add_u32 s39, s39, 76800
    v_lshl_add_u32 v148, v11, 4, s39
    ds_write_b128 v148, v[88:91]
    v_lshl_add_u32 v149, s18, 2, v20
    s_mov_b64 exec, 1
    ds_add_u32 v149, v21 offset:52
    s_mov_b64 exec, -1
L_s_sc1:
L_s_end:
    s_endpgm
L_exit:
    s_endpgm
L_gemm:
    s_add_u32 s94, s42, 9469952
    s_addc_u32 s95, s43, 0
    s_load_dword s93, s[94:95], 0
    s_lshr_b32 s20, s18, 1
    s_lshl_b32 s50, s3, 8
    s_lshl_b32 s39, s38, 3
    s_add_u32 s50, s50, s39
    s_lshl_b32 s50, s50, 11
    s_lshl_b32 s51, s18, 9
    s_add_u32 s50, s50, s51
    s_lshl_b32 s39, s18, 14
    s_add_u32 m0, s39, 98304
    v_and_b32 v4, 31, v0
    v_lshlrev_b32 v4, 4, v4
    v_bfe_u32 v5, v0, 5, 1
    v_lshl_add_u32 v5, v5, 11, v4
    v_add_u32 v4, s51, v4
    v_mov_b32 v6, s44
    v_mov_b32 v7, s45
    s_mov_b32 exec_lo, 0
    v_mov_b32 v6, s80
    v_mov_b32 v7, s81
    s_mov_b32 exec_lo, -1
    v_add_co_u32 v6, vcc, v6, v4
    s_mov_b32 s4, s40
    s_mov_b32 s5, s41
    s_mov_b32 s6, 4194304
    s_mov_b32 s7, 0x20000
    v_addc_co_u32 v7, vcc, 0, v7, vcc
    buffer_load_dwordx4 v5, s[4:7], s50 offen lds
    s_add_u32 m0, m0, 1024
    s_add_u32 s50, s50, 4096
    buffer_load_dwordx4 v5, s[4:7], s50 offen lds
    s_add_u32 m0, m0, 1024
    s_add_u32 s50, s50, 4096
    buffer_load_dwordx4 v5, s[4:7], s50 offen lds
    s_add_u32 m0, m0, 1024
    s_add_u32 s50, s50, 4096
    buffer_load_dwordx4 v5, s[4:7], s50 offen lds
    s_add_u32 m0, m0, 1024
    s_add_u32 s50, s50, 4096
    global_load_lds_dwordx4 v[6:7], off
    s_lshl_b32 s50, s3, 7
    s_lshl_b32 s39, s38, 2
    s_add_u32 s50, s50, s39
    s_add_u32 s50, s50, s18
    s_lshl_b32 s50, s50, 11
    v_and_b32 v4, 63, v0
    v_lshl_add_u32 v3, v4, 5, s50
    global_load_dword v10, v3, s[68:69]
    global_load_dword v11, v3, s[70:71]
    s_mov_b64 s[8:9], s[72:73]
    s_mov_b64 s[10:11], s[74:75]
    s_mov_b64 s[52:53], s[72:73]
    s_mov_b64 s[54:55], s[74:75]
    s_mov_b64 s[58:59], s[78:79]
    s_mov_b64 s[36:37], s[82:83]
    v_and_b32 v24, 63, v0
    s_and_b32 s19, s18, 1
    s_lshl_b32 s23, s18, 12
    v_lshrrev_b32 v25, 4, v24
    v_lshrrev_b32 v56, 3, v24
    v_and_b32 v57, 7, v24
    v_lshrrev_b32 v58, 1, v56
    v_xor_b32 v57, v57, v58
    v_lshlrev_b32 v57, 4, v57
    s_mov_b32 s12, s42
    s_mov_b32 s13, s43
    s_mov_b32 s14, 25165824
    s_mov_b32 s15, 0x20000
    s_lshl_b32 s38, s17, 14
    s_add_u32 s38, s38, 8388608
    s_add_u32 s24, s42, s38
    s_addc_u32 s25, s43, 0
    s_mov_b32 s26, 16384
    s_mov_b32 s27, 0x20000
    s_cmp_lt_u32 s18, 2
    s_cselect_b32 s28, s52, s54
    s_cselect_b32 s29, s53, s55
    s_sub_u32 s28, s28, 3072
    s_subb_u32 s29, s29, 0
    s_mov_b32 s30, 2100224
    s_mov_b32 s31, 0x20000
    s_mov_b32 s32, s36
    s_mov_b32 s33, s37
    s_mov_b32 s34, 8388608
    s_mov_b32 s35, 0x20000
    v_bfe_u32 v59, v24, 1, 3
    v_xor_b32 v59, v59, v25
    v_lshlrev_b32 v59, 4, v59
    v_lshl_add_u32 v59, v26, 7, v59
    s_lshl_b32 s38, s19, 13
    s_lshl_b32 s39, s20, 13
    v_xor_b32 v58, 0, v59
    v_add_u32 v16, s38, v58
    v_add_u32 v18, s39, v58
    v_add_u32 v20, 0x10000, v16
    v_add_u32 v22, 0x10000, v18
    v_xor_b32 v58, 64, v59
    v_add_u32 v17, s38, v58
    v_add_u32 v19, s39, v58
    v_add_u32 v21, 0x10000, v17
    v_add_u32 v23, 0x10000, v19
    v_and_b32 v58, 31, v24
    v_lshlrev_b32 v27, 4, v58
    s_sub_u32 s38, 15, s16
    s_lshl_b32 s38, s38, 10
    s_lshl_b32 s39, s20, 9
    s_add_u32 s92, s38, s39
    v_add_u32 v27, s92, v27
    s_cmp_eq_u32 s19, 1
    s_cselect_b64 s[98:99], -1, 0
    s_waitcnt lgkmcnt(0)
    s_mul_i32 s93, s93, 1664525
    s_add_u32 s93, s93, 1013904223
    s_lshl_b32 s38, s20, 8
    s_add_u32 s38, s38, 32768
    v_lshl_add_u32 v193, v26, 4, s38
    s_lshl_b32 s39, s19, 11
    v_lshl_add_u32 v192, v25, 9, v193
    v_add_u32 v192, s39, v192
    v_lshlrev_b32 v194, 10, v25
    v_lshl_add_u32 v194, v26, 4, v194
    s_add_u32 s38, s92, 1024
    v_add_u32 v194, s38, v194
    v_sub_u32 v58, s16, v25
    v_mov_b32 v59, s93
    v_cmp_lt_i32 vcc, 0, v58
    s_nop 1
    v_cndmask_b32 v198, 0, v59, vcc
    v_cmp_lt_i32 vcc, 4, v58
    s_nop 1
    v_cndmask_b32 v199, 0, v59, vcc
    v_cmp_lt_i32 vcc, 8, v58
    s_nop 1
    v_cndmask_b32 v200, 0, v59, vcc
    v_cmp_lt_i32 vcc, 12, v58
    s_nop 1
    v_cndmask_b32 v201, 0, v59, vcc
    s_mul_i32 s38, s18, 9216
    s_add_u32 s38, s38, 36864
    v_mul_u32_u24 v195, 144, v26
    v_lshl_add_u32 v195, v25, 5, v195
    v_add_u32 v195, s38, v195
    v_bfe_u32 v196, v24, 2, 2
    v_lshl_add_u32 v196, v25, 3, v196
    v_mul_u32_u24 v196, 144, v196
    v_and_b32 v58, 3, v24
    v_lshl_add_u32 v196, v58, 3, v196
    v_add_u32 v196, s38, v196
    v_lshlrev_b32 v197, 4, v24
    s_lshl_b32 s38, s17, 6
    s_lshl_b32 s39, s19, 5
    s_add_u32 s38, s38, s39
    v_add_u32 v58, s38, v56
    v_lshl_add_u32 v58, v58, 11, v57
    v_xor_b32 v59, 64, v58
    v_add_u32 v202, 3072, v58
    v_add_u32 v203, 18432, v59
    v_add_u32 v204, 33792, v58
    v_add_u32 v205, 49152, v59
    s_mov_b32 s55, 0
    s_and_b32 s54, s17, 0
    s_lshl_b32 s48, s16, 19
    s_lshl_b32 s39, s17, 15
    s_add_u32 s53, s48, s39
    s_lshl_b32 s39, s20, 11
    s_add_u32 s53, s53, s39
    s_lshl_b32 s39, s19, 14
    s_add_u32 s53, s53, s39
    s_lshl_b32 s51, s16, 7
    s_lshl_b32 s38, s18, 5
    s_add_u32 s51, s51, s38
    s_lshl_b32 s57, s51, 3
    s_add_u32 s57, s57, 9453568
    s_lshl_b32 s56, s51, 11
    s_lshl_b32 s39, s17, 7
    s_add_u32 s56, s56, s39
    v_lshlrev_b32 v220, 11, v25
    v_lshl_add_u32 v220, v26, 3, v220
    v_and_b32 v221, 31, v24
    v_lshlrev_b32 v221, 3, v221
    v_lshl_add_u32 v222, v26, 3, s39
    s_getreg_b32 s97, hwreg(HW_REG_XCC_ID, 0, 4)
    s_xor_b32 s97, s97, s93
    s_lshl_b32 s52, s16, 12
    s_add_u32 s52, s52, 9764864
    s_lshl_b32 s38, s17, 8
    s_add_u32 s38, s38, s52
    v_mov_b32 v58, s97
    v_lshlrev_b32 v59, 2, v24
    v_and_b32 v1, 15, v24
    v_or_b32 v1, s54, v1
    v_lshlrev_b32 v1, 8, v1
    s_cmp_lg_u32 s18, 0
    s_lshl_b32 s39, s18, 14
    s_add_u32 s39, s39, 98304
    v_and_b32 v4, 7, v24
    v_lshlrev_b32 v4, 9, v4
    v_bfe_u32 v5, v24, 3, 1
    v_lshl_add_u32 v4, v5, 6, v4
    v_lshl_add_u32 v4, v25, 4, v4
    v_add_u32 v4, s39, v4
    v_and_b32 v7, 1, v24
    v_lshlrev_b32 v5, 9, v7
    v_bfe_u32 v6, v24, 1, 1
    v_lshl_add_u32 v5, v6, 6, v5
    v_lshl_add_u32 v5, v25, 4, v5
    v_add_u32 v5, s39, v5
    v_lshrrev_b32 v6, 1, v25
    v_lshlrev_b32 v6, 6, v6
    v_lshl_add_u32 v6, v7, 5, v6
    v_and_b32 v7, 1, v25
    v_lshl_add_u32 v6, v7, 4, v6
    s_lshl_b32 s39, s18, 7
    s_add_u32 s39, s39, 163328
    v_add_u32 v6, s39, v6
    s_waitcnt vmcnt(7)
    v_lshlrev_b32 v224, 16, v224
    v_lshlrev_b32 v225, 16, v225
    v_lshlrev_b32 v226, 16, v226
    v_lshlrev_b32 v227, 16, v227
    v_lshlrev_b32 v228, 16, v228
    v_lshlrev_b32 v229, 16, v229
    v_mul_f32 v230, 1069066811, v228
    v_mul_f32 v231, 1069066811, v229
    v_exp_f32 v230, v230
    v_exp_f32 v231, v231
    s_nop 0
    v_cvt_pk_bf16_f32 v230, v230, v230
    v_lshlrev_b32 v230, 16, v230
    v_cvt_pk_bf16_f32 v231, v231, v231
    v_lshlrev_b32 v231, 16, v231
    v_pk_mul_f32 v[232:233], v[230:231], v[224:225] op_sel:[0,0] op_sel_hi:[1,1]
    v_pk_mul_f32 v[234:235], v[230:231], v[226:227] op_sel:[0,0] op_sel_hi:[1,1]
    v_mul_f32 v232, 1069066811, v232
    v_mul_f32 v234, 1042479491, v234
    v_mul_f32 v233, 1069066811, v233
    v_mul_f32 v235, 1042479491, v235
    v_exp_f32 v232, v232
    v_rndne_f32 v236, v234
    v_exp_f32 v233, v233
    v_rndne_f32 v237, v235
    v_sub_f32 v234, v234, v236
    v_sub_f32 v235, v235, v237
    v_cos_f32 v236, v234
    v_sin_f32 v238, v234
    v_cos_f32 v237, v235
    v_sin_f32 v239, v235
    v_pk_mul_f32 v[240:241], v[224:225], v[224:225] op_sel:[0,0] op_sel_hi:[1,1]
    v_pk_fma_f32 v[240:241], v[226:227], v[226:227], v[240:241] op_sel:[0,0,0] op_sel_hi:[1,1,1]
    v_pk_mul_f32 v[28:29], v[232:233], v[236:237] op_sel:[0,0] op_sel_hi:[1,1]
    v_pk_mul_f32 v[30:31], v[232:233], v[238:239] op_sel:[0,0] op_sel_hi:[1,1]
    v_rcp_f32 v240, v240
    v_rcp_f32 v241, v241
    v_add_f32 v230, -1.0, v28
    v_add_f32 v231, -1.0, v29
    v_pk_add_f32 v[240:241], v[240:241], v[240:241]
    v_pk_mul_f32 v[232:233], v[230:231], v[224:225] op_sel:[0,0] op_sel_hi:[1,1]
    v_pk_fma_f32 v[232:233], v[30:31], v[226:227], v[232:233] op_sel:[0,0,0] op_sel_hi:[1,1,1]
    v_pk_mul_f32 v[234:235], v[30:31], v[224:225] op_sel:[0,0] op_sel_hi:[1,1]
    v_pk_fma_f32 v[234:235], v[230:231], v[226:227], v[234:235] op_sel:[0,0,0] op_sel_hi:[1,1,1] neg_lo:[1,0,0] neg_hi:[1,0,0]
    v_pk_mul_f32 v[32:33], v[232:233], v[240:241] op_sel:[0,0] op_sel_hi:[1,1]
    v_pk_mul_f32 v[34:35], v[234:235], v[240:241] op_sel:[0,0] op_sel_hi:[1,1]
    v_pk_mul_f32 v[224:225], v[28:29], v[28:29] op_sel:[0,0] op_sel_hi:[1,1]
    v_pk_mul_f32 v[226:227], v[28:29], v[30:31] op_sel:[0,0] op_sel_hi:[1,1]
    v_pk_fma_f32 v[224:225], v[30:31], v[30:31], v[224:225] op_sel:[0,0,0] op_sel_hi:[1,1,1] neg_lo:[1,0,0] neg_hi:[1,0,0]
    v_pk_add_f32 v[226:227], v[226:227], v[226:227]
    v_pk_mul_f32 v[228:229], v[224:225], v[224:225] op_sel:[0,0] op_sel_hi:[1,1]
    v_pk_mul_f32 v[230:231], v[224:225], v[226:227] op_sel:[0,0] op_sel_hi:[1,1]
    v_pk_fma_f32 v[228:229], v[226:227], v[226:227], v[228:229] op_sel:[0,0,0] op_sel_hi:[1,1,1] neg_lo:[1,0,0] neg_hi:[1,0,0]
    v_pk_add_f32 v[230:231], v[230:231], v[230:231]
    v_pk_mul_f32 v[36:37], v[228:229], v[228:229] op_sel:[0,0] op_sel_hi:[1,1]
    v_pk_mul_f32 v[38:39], v[228:229], v[230:231] op_sel:[0,0] op_sel_hi:[1,1]
    v_pk_fma_f32 v[36:37], v[230:231], v[230:231], v[36:37] op_sel:[0,0,0] op_sel_hi:[1,1,1] neg_lo:[1,0,0] neg_hi:[1,0,0]
    v_pk_add_f32 v[38:39], v[38:39], v[38:39]
    v_pk_mul_f32 v[40:41], v[36:37], v[36:37] op_sel:[0,0] op_sel_hi:[1,1]
    v_pk_mul_f32 v[42:43], v[36:37], v[38:39] op_sel:[0,0] op_sel_hi:[1,1]
    v_pk_fma_f32 v[40:41], v[38:39], v[38:39], v[40:41] op_sel:[0,0,0] op_sel_hi:[1,1,1] neg_lo:[1,0,0] neg_hi:[1,0,0]
    v_pk_add_f32 v[42:43], v[42:43], v[42:43]
    v_pk_mul_f32 v[224:225], v[40:41], v[40:41] op_sel:[0,0] op_sel_hi:[1,1]
    v_pk_mul_f32 v[226:227], v[40:41], v[42:43] op_sel:[0,0] op_sel_hi:[1,1]
    v_pk_fma_f32 v[224:225], v[42:43], v[42:43], v[224:225] op_sel:[0,0,0] op_sel_hi:[1,1,1] neg_lo:[1,0,0] neg_hi:[1,0,0]
    v_pk_add_f32 v[226:227], v[226:227], v[226:227]
    v_pk_mul_f32 v[228:229], v[224:225], v[224:225] op_sel:[0,0] op_sel_hi:[1,1]
    v_pk_mul_f32 v[230:231], v[224:225], v[226:227] op_sel:[0,0] op_sel_hi:[1,1]
    v_pk_fma_f32 v[228:229], v[226:227], v[226:227], v[228:229] op_sel:[0,0,0] op_sel_hi:[1,1,1] neg_lo:[1,0,0] neg_hi:[1,0,0]
    v_pk_add_f32 v[230:231], v[230:231], v[230:231]
    v_and_b32 v240, 1, v25
    v_cmp_eq_u32 s[84:85], 1, v240
    v_cmp_lt_u32 s[86:87], 1, v25
    s_nop 0
    v_cndmask_b32 v232, 1.0, v40, s[84:85]
    v_cndmask_b32 v234, 0, v42, s[84:85]
    v_cndmask_b32 v233, 1.0, v41, s[84:85]
    v_cndmask_b32 v235, 0, v43, s[84:85]
    v_cndmask_b32 v236, 1.0, v224, s[86:87]
    v_cndmask_b32 v238, 0, v226, s[86:87]
    v_cndmask_b32 v237, 1.0, v225, s[86:87]
    v_cndmask_b32 v239, 0, v227, s[86:87]
    v_pk_mul_f32 v[242:243], v[232:233], v[236:237] op_sel:[0,0] op_sel_hi:[1,1]
    v_pk_mul_f32 v[244:245], v[232:233], v[238:239] op_sel:[0,0] op_sel_hi:[1,1]
    v_pk_fma_f32 v[242:243], v[234:235], v[238:239], v[242:243] op_sel:[0,0,0] op_sel_hi:[1,1,1] neg_lo:[1,0,0] neg_hi:[1,0,0]
    v_pk_fma_f32 v[244:245], v[234:235], v[236:237], v[244:245] op_sel:[0,0,0] op_sel_hi:[1,1,1]
    v_cndmask_b32 v232, 1.0, v228, s[98:99]
    v_cndmask_b32 v234, 0, v230, s[98:99]
    v_cndmask_b32 v233, 1.0, v229, s[98:99]
    v_cndmask_b32 v235, 0, v231, s[98:99]
    v_pk_mul_f32 v[52:53], v[242:243], v[232:233] op_sel:[0,0] op_sel_hi:[1,1]
    v_pk_mul_f32 v[54:55], v[242:243], v[234:235] op_sel:[0,0] op_sel_hi:[1,1]
    v_pk_fma_f32 v[52:53], v[244:245], v[234:235], v[52:53] op_sel:[0,0,0] op_sel_hi:[1,1,1] neg_lo:[1,0,0] neg_hi:[1,0,0]
    v_pk_fma_f32 v[54:55], v[244:245], v[232:233], v[54:55] op_sel:[0,0,0] op_sel_hi:[1,1,1]
    v_pk_mul_f32 v[224:225], v[228:229], v[228:229] op_sel:[0,0] op_sel_hi:[1,1]
    v_pk_mul_f32 v[226:227], v[228:229], v[230:231] op_sel:[0,0] op_sel_hi:[1,1]
    v_pk_fma_f32 v[224:225], v[230:231], v[230:231], v[224:225] op_sel:[0,0,0] op_sel_hi:[1,1,1] neg_lo:[1,0,0] neg_hi:[1,0,0]
    v_pk_add_f32 v[226:227], v[226:227], v[226:227]
    v_pk_mul_f32 v[228:229], v[224:225], v[224:225] op_sel:[0,0] op_sel_hi:[1,1]
    v_pk_mul_f32 v[230:231], v[224:225], v[226:227] op_sel:[0,0] op_sel_hi:[1,1]
    v_pk_fma_f32 v[228:229], v[226:227], v[226:227], v[228:229] op_sel:[0,0,0] op_sel_hi:[1,1,1] neg_lo:[1,0,0] neg_hi:[1,0,0]
    v_pk_add_f32 v[230:231], v[230:231], v[230:231]
    v_pk_mul_f32 v[44:45], v[228:229], v[228:229] op_sel:[0,0] op_sel_hi:[1,1]
    v_pk_mul_f32 v[46:47], v[228:229], v[230:231] op_sel:[0,0] op_sel_hi:[1,1]
    v_pk_fma_f32 v[44:45], v[230:231], v[230:231], v[44:45] op_sel:[0,0,0] op_sel_hi:[1,1,1] neg_lo:[1,0,0] neg_hi:[1,0,0]
    v_pk_add_f32 v[46:47], v[46:47], v[46:47]
    v_cndmask_b32 v232, 1.0, v224, s[84:85]
    v_cndmask_b32 v234, 0, v226, s[84:85]
    v_cndmask_b32 v233, 1.0, v225, s[84:85]
    v_cndmask_b32 v235, 0, v227, s[84:85]
    v_cndmask_b32 v236, 1.0, v228, s[86:87]
    v_cndmask_b32 v238, 0, v230, s[86:87]
    v_cndmask_b32 v237, 1.0, v229, s[86:87]
    v_cndmask_b32 v239, 0, v231, s[86:87]
    v_pk_mul_f32 v[48:49], v[232:233], v[236:237] op_sel:[0,0] op_sel_hi:[1,1]
    v_pk_mul_f32 v[50:51], v[232:233], v[238:239] op_sel:[0,0] op_sel_hi:[1,1]
    v_pk_fma_f32 v[48:49], v[234:235], v[238:239], v[48:49] op_sel:[0,0,0] op_sel_hi:[1,1,1] neg_lo:[1,0,0] neg_hi:[1,0,0]
    v_pk_fma_f32 v[50:51], v[234:235], v[236:237], v[50:51] op_sel:[0,0,0] op_sel_hi:[1,1,1]
    v_mov_b32 v224, v52
    v_mov_b32 v226, v54
    v_mul_f32 v225, v36, v52
    v_mul_f32 v227, v36, v54
    v_fma_f32 v225, -v38, v54, v225
    v_fma_f32 v227, v38, v52, v227
    v_pk_mul_f32 v[206:207], v[32:33], v[224:225] op_sel:[0,0] op_sel_hi:[0,1]
    v_pk_mul_f32 v[208:209], v[32:33], v[226:227] op_sel:[0,0] op_sel_hi:[0,1]
    v_pk_fma_f32 v[206:207], v[34:35], v[226:227], v[206:207] op_sel:[0,0,0] op_sel_hi:[0,1,1] neg_lo:[1,0,0] neg_hi:[1,0,0]
    v_pk_fma_f32 v[208:209], v[34:35], v[224:225], v[208:209] op_sel:[0,0,0] op_sel_hi:[0,1,1]
    v_mov_b32 v224, v53
    v_mov_b32 v226, v55
    v_mul_f32 v225, v37, v53
    v_mul_f32 v227, v37, v55
    v_fma_f32 v225, -v39, v55, v225
    v_fma_f32 v227, v39, v53, v227
    v_pk_mul_f32 v[210:211], v[32:33], v[224:225] op_sel:[1,0] op_sel_hi:[1,1]
    v_pk_mul_f32 v[212:213], v[32:33], v[226:227] op_sel:[1,0] op_sel_hi:[1,1]
    v_pk_fma_f32 v[210:211], v[34:35], v[226:227], v[210:211] op_sel:[1,0,0] op_sel_hi:[1,1,1] neg_lo:[1,0,0] neg_hi:[1,0,0]
    v_pk_fma_f32 v[212:213], v[34:35], v[224:225], v[212:213] op_sel:[1,0,0] op_sel_hi:[1,1,1]
    s_waitcnt vmcnt(2)
    ds_read_b128 v[224:227], v4 offset:0
    ds_read_b128 v[240:243], v5 offset:4096
    ds_read_b128 v[228:231], v4 offset:128
    ds_read_b128 v[244:247], v5 offset:4224
    ds_read_b128 v[232:235], v4 offset:256
    ds_read_b128 v[248:251], v5 offset:4352
    ds_read_b128 v[236:239], v4 offset:384
    ds_read_b128 v[252:255], v5 offset:4480
    s_waitcnt lgkmcnt(0)
    v_mfma_f32_16x16x32_bf16 v[12:15], v[224:227], v[240:243], 0
    v_mfma_f32_16x16x32_bf16 v[12:15], v[228:231], v[244:247], v[12:15]
    v_mfma_f32_16x16x32_bf16 v[12:15], v[232:235], v[248:251], v[12:15]
    v_mfma_f32_16x16x32_bf16 v[12:15], v[236:239], v[252:255], v[12:15]
    s_nop 7
    s_mov_b32 exec_lo, 0x00030003
    s_mov_b32 exec_hi, 0x000c000c
    ds_write_b128 v6, v[12:15]
    s_mov_b64 exec, -1
    s_cmp_lg_u32 s18, 0
    s_cbranch_scc1 L_noxc
    s_mov_b32 exec_hi, 0
    buffer_store_dword v58, v59, s[12:15], s38 offen sc1
    s_mov_b32 exec_hi, -1
L_noxc:
    s_waitcnt lgkmcnt(0)
    s_barrier
    ds_read_b128 v[128:131], v16 offset:0
    ds_read_b128 v[144:147], v18 offset:16384
    ds_read_b128 v[148:151], v18 offset:18432
    ds_read_b128 v[152:155], v18 offset:20480
    ds_read_b128 v[156:159], v18 offset:22528
    ds_read_b128 v[132:135], v16 offset:2048
    ds_read_b128 v[136:139], v16 offset:4096
    ds_read_b128 v[140:143], v16 offset:6144
    s_waitcnt lgkmcnt(0)
    v_mfma_f32_16x16x32_bf16 v[64:67], v[128:131], v[144:147], 0
    ds_read_b128 v[160:163], v17 offset:0
    v_mfma_f32_16x16x32_bf16 v[68:71], v[128:131], v[148:151], 0
    ds_read_b128 v[176:179], v19 offset:16384
    v_mfma_f32_16x16x32_bf16 v[72:75], v[128:131], v[152:155], 0
    v_mfma_f32_16x16x32_bf16 v[76:79], v[128:131], v[156:159], 0
    ds_read_b128 v[180:183], v19 offset:18432
    v_mfma_f32_16x16x32_bf16 v[80:83], v[132:135], v[144:147], 0
    ds_read_b128 v[184:187], v19 offset:20480
    v_mfma_f32_16x16x32_bf16 v[84:87], v[132:135], v[148:151], 0
    v_mfma_f32_16x16x32_bf16 v[88:91], v[132:135], v[152:155], 0
    ds_read_b128 v[188:191], v19 offset:22528
    v_mfma_f32_16x16x32_bf16 v[92:95], v[132:135], v[156:159], 0
    ds_read_b128 v[164:167], v17 offset:2048
    v_mfma_f32_16x16x32_bf16 v[96:99], v[136:139], v[144:147], 0
    v_mfma_f32_16x16x32_bf16 v[100:103], v[136:139], v[148:151], 0
    ds_read_b128 v[168:171], v17 offset:4096
    v_mfma_f32_16x16x32_bf16 v[104:107], v[136:139], v[152:155], 0
    ds_read_b128 v[172:175], v17 offset:6144
    v_mfma_f32_16x16x32_bf16 v[108:111], v[136:139], v[156:159], 0
    v_mfma_f32_16x16x32_bf16 v[112:115], v[140:143], v[144:147], 0
    v_mfma_f32_16x16x32_bf16 v[116:119], v[140:143], v[148:151], 0
    v_mfma_f32_16x16x32_bf16 v[120:123], v[140:143], v[152:155], 0
    v_mfma_f32_16x16x32_bf16 v[124:127], v[140:143], v[156:159], 0
    s_waitcnt lgkmcnt(0)
    s_barrier
    v_mfma_f32_16x16x32_bf16 v[64:67], v[160:163], v[176:179], v[64:67]
    ds_read_b128 v[128:131], v16 offset:32768
    v_mfma_f32_16x16x32_bf16 v[68:71], v[160:163], v[180:183], v[68:71]
    ds_read_b128 v[144:147], v18 offset:49152
    v_mfma_f32_16x16x32_bf16 v[72:75], v[160:163], v[184:187], v[72:75]
    v_mfma_f32_16x16x32_bf16 v[76:79], v[160:163], v[188:191], v[76:79]
    ds_read_b128 v[148:151], v18 offset:51200
    v_mfma_f32_16x16x32_bf16 v[80:83], v[164:167], v[176:179], v[80:83]
    ds_read_b128 v[152:155], v18 offset:53248
    v_mfma_f32_16x16x32_bf16 v[84:87], v[164:167], v[180:183], v[84:87]
    v_mfma_f32_16x16x32_bf16 v[88:91], v[164:167], v[184:187], v[88:91]
    ds_read_b128 v[156:159], v18 offset:55296
    v_mfma_f32_16x16x32_bf16 v[92:95], v[164:167], v[188:191], v[92:95]
    ds_read_b128 v[132:135], v16 offset:34816
    v_mfma_f32_16x16x32_bf16 v[96:99], v[168:171], v[176:179], v[96:99]
    v_mfma_f32_16x16x32_bf16 v[100:103], v[168:171], v[180:183], v[100:103]
    ds_read_b128 v[136:139], v16 offset:36864
    v_mfma_f32_16x16x32_bf16 v[104:107], v[168:171], v[184:187], v[104:107]
    ds_read_b128 v[140:143], v16 offset:38912
    v_mfma_f32_16x16x32_bf16 v[108:111], v[168:171], v[188:191], v[108:111]
    v_mfma_f32_16x16x32_bf16 v[112:115], v[172:175], v[176:179], v[112:115]
    v_mfma_f32_16x16x32_bf16 v[116:119], v[172:175], v[180:183], v[116:119]
    v_mfma_f32_16x16x32_bf16 v[120:123], v[172:175], v[184:187], v[120:123]
    v_mfma_f32_16x16x32_bf16 v[124:127], v[172:175], v[188:191], v[124:127]
    s_waitcnt lgkmcnt(0)
    v_mfma_f32_16x16x32_bf16 v[64:67], v[128:131], v[144:147], v[64:67]
    ds_read_b128 v[160:163], v17 offset:32768
    v_mfma_f32_16x16x32_bf16 v[68:71], v[128:131], v[148:151], v[68:71]
    ds_read_b128 v[176:179], v19 offset:49152
    v_mfma_f32_16x16x32_bf16 v[72:75], v[128:131], v[152:155], v[72:75]
    v_mfma_f32_16x16x32_bf16 v[76:79], v[128:131], v[156:159], v[76:79]
    ds_read_b128 v[180:183], v19 offset:51200
    v_mfma_f32_16x16x32_bf16 v[80:83], v[132:135], v[144:147], v[80:83]
    ds_read_b128 v[184:187], v19 offset:53248
    v_mfma_f32_16x16x32_bf16 v[84:87], v[132:135], v[148:151], v[84:87]
    v_mfma_f32_16x16x32_bf16 v[88:91], v[132:135], v[152:155], v[88:91]
    ds_read_b128 v[188:191], v19 offset:55296
    v_mfma_f32_16x16x32_bf16 v[92:95], v[132:135], v[156:159], v[92:95]
    ds_read_b128 v[164:167], v17 offset:34816
    v_mfma_f32_16x16x32_bf16 v[96:99], v[136:139], v[144:147], v[96:99]
    v_mfma_f32_16x16x32_bf16 v[100:103], v[136:139], v[148:151], v[100:103]
    ds_read_b128 v[168:171], v17 offset:36864
    v_mfma_f32_16x16x32_bf16 v[104:107], v[136:139], v[152:155], v[104:107]
    ds_read_b128 v[172:175], v17 offset:38912
    v_mfma_f32_16x16x32_bf16 v[108:111], v[136:139], v[156:159], v[108:111]
    v_mfma_f32_16x16x32_bf16 v[112:115], v[140:143], v[144:147], v[112:115]
    v_mfma_f32_16x16x32_bf16 v[116:119], v[140:143], v[148:151], v[116:119]
    v_mfma_f32_16x16x32_bf16 v[120:123], v[140:143], v[152:155], v[120:123]
    v_mfma_f32_16x16x32_bf16 v[124:127], v[140:143], v[156:159], v[124:127]
    s_waitcnt lgkmcnt(0)
    s_barrier
    v_mfma_f32_16x16x32_bf16 v[64:67], v[160:163], v[176:179], v[64:67]
    ds_read_b128 v[128:131], v20 offset:0
    v_mfma_f32_16x16x32_bf16 v[68:71], v[160:163], v[180:183], v[68:71]
    ds_read_b128 v[144:147], v22 offset:16384
    v_mfma_f32_16x16x32_bf16 v[72:75], v[160:163], v[184:187], v[72:75]
    v_mfma_f32_16x16x32_bf16 v[76:79], v[160:163], v[188:191], v[76:79]
    ds_read_b128 v[148:151], v22 offset:18432
    v_mfma_f32_16x16x32_bf16 v[80:83], v[164:167], v[176:179], v[80:83]
    ds_read_b128 v[152:155], v22 offset:20480
    v_mfma_f32_16x16x32_bf16 v[84:87], v[164:167], v[180:183], v[84:87]
    v_mfma_f32_16x16x32_bf16 v[88:91], v[164:167], v[184:187], v[88:91]
    ds_read_b128 v[156:159], v22 offset:22528
    v_mfma_f32_16x16x32_bf16 v[92:95], v[164:167], v[188:191], v[92:95]
    ds_read_b128 v[132:135], v20 offset:2048
    v_mfma_f32_16x16x32_bf16 v[96:99], v[168:171], v[176:179], v[96:99]
    v_mfma_f32_16x16x32_bf16 v[100:103], v[168:171], v[180:183], v[100:103]
    ds_read_b128 v[136:139], v20 offset:4096
    v_mfma_f32_16x16x32_bf16 v[104:107], v[168:171], v[184:187], v[104:107]
    ds_read_b128 v[140:143], v20 offset:6144
    v_mfma_f32_16x16x32_bf16 v[108:111], v[168:171], v[188:191], v[108:111]
    v_mfma_f32_16x16x32_bf16 v[112:115], v[172:175], v[176:179], v[112:115]
    v_mfma_f32_16x16x32_bf16 v[116:119], v[172:175], v[180:183], v[116:119]
    v_mfma_f32_16x16x32_bf16 v[120:123], v[172:175], v[184:187], v[120:123]
    v_mfma_f32_16x16x32_bf16 v[124:127], v[172:175], v[188:191], v[124:127]
    s_waitcnt lgkmcnt(0)
    v_mfma_f32_16x16x32_bf16 v[64:67], v[128:131], v[144:147], v[64:67]
    ds_read_b128 v[160:163], v21 offset:0
    v_mfma_f32_16x16x32_bf16 v[68:71], v[128:131], v[148:151], v[68:71]
    ds_read_b128 v[176:179], v23 offset:16384
    v_mfma_f32_16x16x32_bf16 v[72:75], v[128:131], v[152:155], v[72:75]
    v_mfma_f32_16x16x32_bf16 v[76:79], v[128:131], v[156:159], v[76:79]
    ds_read_b128 v[180:183], v23 offset:18432
    v_mfma_f32_16x16x32_bf16 v[80:83], v[132:135], v[144:147], v[80:83]
    ds_read_b128 v[184:187], v23 offset:20480
    v_mfma_f32_16x16x32_bf16 v[84:87], v[132:135], v[148:151], v[84:87]
    v_mfma_f32_16x16x32_bf16 v[88:91], v[132:135], v[152:155], v[88:91]
    ds_read_b128 v[188:191], v23 offset:22528
    v_mfma_f32_16x16x32_bf16 v[92:95], v[132:135], v[156:159], v[92:95]
    ds_read_b128 v[164:167], v21 offset:2048
    v_mfma_f32_16x16x32_bf16 v[96:99], v[136:139], v[144:147], v[96:99]
    v_mfma_f32_16x16x32_bf16 v[100:103], v[136:139], v[148:151], v[100:103]
    ds_read_b128 v[168:171], v21 offset:4096
    v_mfma_f32_16x16x32_bf16 v[104:107], v[136:139], v[152:155], v[104:107]
    ds_read_b128 v[172:175], v21 offset:6144
    v_mfma_f32_16x16x32_bf16 v[108:111], v[136:139], v[156:159], v[108:111]
    v_mfma_f32_16x16x32_bf16 v[112:115], v[140:143], v[144:147], v[112:115]
    v_mfma_f32_16x16x32_bf16 v[116:119], v[140:143], v[148:151], v[116:119]
    v_mfma_f32_16x16x32_bf16 v[120:123], v[140:143], v[152:155], v[120:123]
    v_mfma_f32_16x16x32_bf16 v[124:127], v[140:143], v[156:159], v[124:127]
    s_waitcnt lgkmcnt(0)
    s_barrier
    v_mfma_f32_16x16x32_bf16 v[64:67], v[160:163], v[176:179], v[64:67]
    ds_read_b128 v[128:131], v16 offset:0
    v_mfma_f32_16x16x32_bf16 v[68:71], v[160:163], v[180:183], v[68:71]
    ds_read_b128 v[144:147], v18 offset:16384
    v_mfma_f32_16x16x32_bf16 v[72:75], v[160:163], v[184:187], v[72:75]
    v_mfma_f32_16x16x32_bf16 v[76:79], v[160:163], v[188:191], v[76:79]
    ds_read_b128 v[148:151], v18 offset:18432
    v_mfma_f32_16x16x32_bf16 v[80:83], v[164:167], v[176:179], v[80:83]
    ds_read_b128 v[152:155], v18 offset:20480
    v_mfma_f32_16x16x32_bf16 v[84:87], v[164:167], v[180:183], v[84:87]
    v_mfma_f32_16x16x32_bf16 v[88:91], v[164:167], v[184:187], v[88:91]
    ds_read_b128 v[156:159], v18 offset:22528
    v_mfma_f32_16x16x32_bf16 v[92:95], v[164:167], v[188:191], v[92:95]
    ds_read_b128 v[132:135], v16 offset:2048
    v_mfma_f32_16x16x32_bf16 v[96:99], v[168:171], v[176:179], v[96:99]
    v_mfma_f32_16x16x32_bf16 v[100:103], v[168:171], v[180:183], v[100:103]
    ds_read_b128 v[136:139], v16 offset:4096
    v_mfma_f32_16x16x32_bf16 v[104:107], v[168:171], v[184:187], v[104:107]
    ds_read_b128 v[140:143], v16 offset:6144
    v_mfma_f32_16x16x32_bf16 v[108:111], v[168:171], v[188:191], v[108:111]
    v_mfma_f32_16x16x32_bf16 v[112:115], v[172:175], v[176:179], v[112:115]
    v_mfma_f32_16x16x32_bf16 v[116:119], v[172:175], v[180:183], v[116:119]
    v_mfma_f32_16x16x32_bf16 v[120:123], v[172:175], v[184:187], v[120:123]
    v_mfma_f32_16x16x32_bf16 v[124:127], v[172:175], v[188:191], v[124:127]
    s_waitcnt lgkmcnt(0)
    v_mfma_f32_16x16x32_bf16 v[64:67], v[128:131], v[144:147], v[64:67]
    ds_read_b128 v[160:163], v17 offset:0
    v_mfma_f32_16x16x32_bf16 v[68:71], v[128:131], v[148:151], v[68:71]
    ds_read_b128 v[176:179], v19 offset:16384
    v_mfma_f32_16x16x32_bf16 v[72:75], v[128:131], v[152:155], v[72:75]
    v_mfma_f32_16x16x32_bf16 v[76:79], v[128:131], v[156:159], v[76:79]
    ds_read_b128 v[180:183], v19 offset:18432
    v_mfma_f32_16x16x32_bf16 v[80:83], v[132:135], v[144:147], v[80:83]
    ds_read_b128 v[184:187], v19 offset:20480
    v_mfma_f32_16x16x32_bf16 v[84:87], v[132:135], v[148:151], v[84:87]
    v_mfma_f32_16x16x32_bf16 v[88:91], v[132:135], v[152:155], v[88:91]
    ds_read_b128 v[188:191], v19 offset:22528
    v_mfma_f32_16x16x32_bf16 v[92:95], v[132:135], v[156:159], v[92:95]
    ds_read_b128 v[164:167], v17 offset:2048
    v_mfma_f32_16x16x32_bf16 v[96:99], v[136:139], v[144:147], v[96:99]
    v_mfma_f32_16x16x32_bf16 v[100:103], v[136:139], v[148:151], v[100:103]
    ds_read_b128 v[168:171], v17 offset:4096
    v_mfma_f32_16x16x32_bf16 v[104:107], v[136:139], v[152:155], v[104:107]
    ds_read_b128 v[172:175], v17 offset:6144
    v_mfma_f32_16x16x32_bf16 v[108:111], v[136:139], v[156:159], v[108:111]
    v_mfma_f32_16x16x32_bf16 v[112:115], v[140:143], v[144:147], v[112:115]
    v_mfma_f32_16x16x32_bf16 v[116:119], v[140:143], v[148:151], v[116:119]
    v_mfma_f32_16x16x32_bf16 v[120:123], v[140:143], v[152:155], v[120:123]
    v_mfma_f32_16x16x32_bf16 v[124:127], v[140:143], v[156:159], v[124:127]
    s_waitcnt lgkmcnt(0)
    s_barrier
    v_mfma_f32_16x16x32_bf16 v[64:67], v[160:163], v[176:179], v[64:67]
    ds_read_b128 v[128:131], v16 offset:32768
    v_mfma_f32_16x16x32_bf16 v[68:71], v[160:163], v[180:183], v[68:71]
    ds_read_b128 v[144:147], v18 offset:49152
    v_mfma_f32_16x16x32_bf16 v[72:75], v[160:163], v[184:187], v[72:75]
    v_mfma_f32_16x16x32_bf16 v[76:79], v[160:163], v[188:191], v[76:79]
    ds_read_b128 v[148:151], v18 offset:51200
    v_mfma_f32_16x16x32_bf16 v[80:83], v[164:167], v[176:179], v[80:83]
    ds_read_b128 v[152:155], v18 offset:53248
    v_mfma_f32_16x16x32_bf16 v[84:87], v[164:167], v[180:183], v[84:87]
    v_mfma_f32_16x16x32_bf16 v[88:91], v[164:167], v[184:187], v[88:91]
    ds_read_b128 v[156:159], v18 offset:55296
    v_mfma_f32_16x16x32_bf16 v[92:95], v[164:167], v[188:191], v[92:95]
    ds_read_b128 v[132:135], v16 offset:34816
    v_mfma_f32_16x16x32_bf16 v[96:99], v[168:171], v[176:179], v[96:99]
    v_mfma_f32_16x16x32_bf16 v[100:103], v[168:171], v[180:183], v[100:103]
    ds_read_b128 v[136:139], v16 offset:36864
    v_mfma_f32_16x16x32_bf16 v[104:107], v[168:171], v[184:187], v[104:107]
    ds_read_b128 v[140:143], v16 offset:38912
    v_mfma_f32_16x16x32_bf16 v[108:111], v[168:171], v[188:191], v[108:111]
    v_mfma_f32_16x16x32_bf16 v[112:115], v[172:175], v[176:179], v[112:115]
    v_mfma_f32_16x16x32_bf16 v[116:119], v[172:175], v[180:183], v[116:119]
    v_mfma_f32_16x16x32_bf16 v[120:123], v[172:175], v[184:187], v[120:123]
    v_mfma_f32_16x16x32_bf16 v[124:127], v[172:175], v[188:191], v[124:127]
    s_waitcnt lgkmcnt(0)
    v_mfma_f32_16x16x32_bf16 v[64:67], v[128:131], v[144:147], v[64:67]
    ds_read_b128 v[160:163], v17 offset:32768
    v_mfma_f32_16x16x32_bf16 v[68:71], v[128:131], v[148:151], v[68:71]
    ds_read_b128 v[176:179], v19 offset:49152
    v_mfma_f32_16x16x32_bf16 v[72:75], v[128:131], v[152:155], v[72:75]
    v_mfma_f32_16x16x32_bf16 v[76:79], v[128:131], v[156:159], v[76:79]
    ds_read_b128 v[180:183], v19 offset:51200
    v_mfma_f32_16x16x32_bf16 v[80:83], v[132:135], v[144:147], v[80:83]
    ds_read_b128 v[184:187], v19 offset:53248
    v_mfma_f32_16x16x32_bf16 v[84:87], v[132:135], v[148:151], v[84:87]
    v_mfma_f32_16x16x32_bf16 v[88:91], v[132:135], v[152:155], v[88:91]
    ds_read_b128 v[188:191], v19 offset:55296
    v_mfma_f32_16x16x32_bf16 v[92:95], v[132:135], v[156:159], v[92:95]
    ds_read_b128 v[164:167], v17 offset:34816
    v_mfma_f32_16x16x32_bf16 v[96:99], v[136:139], v[144:147], v[96:99]
    v_mfma_f32_16x16x32_bf16 v[100:103], v[136:139], v[148:151], v[100:103]
    ds_read_b128 v[168:171], v17 offset:36864
    v_mfma_f32_16x16x32_bf16 v[104:107], v[136:139], v[152:155], v[104:107]
    ds_read_b128 v[172:175], v17 offset:38912
    v_mfma_f32_16x16x32_bf16 v[108:111], v[136:139], v[156:159], v[108:111]
    v_mfma_f32_16x16x32_bf16 v[112:115], v[140:143], v[144:147], v[112:115]
    v_mfma_f32_16x16x32_bf16 v[116:119], v[140:143], v[148:151], v[116:119]
    v_mfma_f32_16x16x32_bf16 v[120:123], v[140:143], v[152:155], v[120:123]
    v_mfma_f32_16x16x32_bf16 v[124:127], v[140:143], v[156:159], v[124:127]
    s_waitcnt lgkmcnt(0)
    s_barrier
    v_mfma_f32_16x16x32_bf16 v[64:67], v[160:163], v[176:179], v[64:67]
    ds_read_b128 v[128:131], v20 offset:0
    v_mfma_f32_16x16x32_bf16 v[68:71], v[160:163], v[180:183], v[68:71]
    ds_read_b128 v[144:147], v22 offset:16384
    v_mfma_f32_16x16x32_bf16 v[72:75], v[160:163], v[184:187], v[72:75]
    v_mfma_f32_16x16x32_bf16 v[76:79], v[160:163], v[188:191], v[76:79]
    ds_read_b128 v[148:151], v22 offset:18432
    v_mfma_f32_16x16x32_bf16 v[80:83], v[164:167], v[176:179], v[80:83]
    ds_read_b128 v[152:155], v22 offset:20480
    v_mfma_f32_16x16x32_bf16 v[84:87], v[164:167], v[180:183], v[84:87]
    v_mfma_f32_16x16x32_bf16 v[88:91], v[164:167], v[184:187], v[88:91]
    ds_read_b128 v[156:159], v22 offset:22528
    v_mfma_f32_16x16x32_bf16 v[92:95], v[164:167], v[188:191], v[92:95]
    ds_read_b128 v[132:135], v20 offset:2048
    v_mfma_f32_16x16x32_bf16 v[96:99], v[168:171], v[176:179], v[96:99]
    v_mfma_f32_16x16x32_bf16 v[100:103], v[168:171], v[180:183], v[100:103]
    ds_read_b128 v[136:139], v20 offset:4096
    v_mfma_f32_16x16x32_bf16 v[104:107], v[168:171], v[184:187], v[104:107]
    ds_read_b128 v[140:143], v20 offset:6144
    v_mfma_f32_16x16x32_bf16 v[108:111], v[168:171], v[188:191], v[108:111]
    v_mfma_f32_16x16x32_bf16 v[112:115], v[172:175], v[176:179], v[112:115]
    v_mfma_f32_16x16x32_bf16 v[116:119], v[172:175], v[180:183], v[116:119]
    v_mfma_f32_16x16x32_bf16 v[120:123], v[172:175], v[184:187], v[120:123]
    v_mfma_f32_16x16x32_bf16 v[124:127], v[172:175], v[188:191], v[124:127]
    s_waitcnt lgkmcnt(0)
    v_mfma_f32_16x16x32_bf16 v[64:67], v[128:131], v[144:147], v[64:67]
    ds_read_b128 v[160:163], v21 offset:0
    v_mfma_f32_16x16x32_bf16 v[68:71], v[128:131], v[148:151], v[68:71]
    ds_read_b128 v[176:179], v23 offset:16384
    v_mfma_f32_16x16x32_bf16 v[72:75], v[128:131], v[152:155], v[72:75]
    v_mfma_f32_16x16x32_bf16 v[76:79], v[128:131], v[156:159], v[76:79]
    ds_read_b128 v[180:183], v23 offset:18432
    v_mfma_f32_16x16x32_bf16 v[80:83], v[132:135], v[144:147], v[80:83]
    ds_read_b128 v[184:187], v23 offset:20480
    v_mfma_f32_16x16x32_bf16 v[84:87], v[132:135], v[148:151], v[84:87]
    v_mfma_f32_16x16x32_bf16 v[88:91], v[132:135], v[152:155], v[88:91]
    ds_read_b128 v[188:191], v23 offset:22528
    v_mfma_f32_16x16x32_bf16 v[92:95], v[132:135], v[156:159], v[92:95]
    ds_read_b128 v[164:167], v21 offset:2048
    v_mfma_f32_16x16x32_bf16 v[96:99], v[136:139], v[144:147], v[96:99]
    v_mfma_f32_16x16x32_bf16 v[100:103], v[136:139], v[148:151], v[100:103]
    ds_read_b128 v[168:171], v21 offset:4096
    v_mfma_f32_16x16x32_bf16 v[104:107], v[136:139], v[152:155], v[104:107]
    ds_read_b128 v[172:175], v21 offset:6144
    v_mfma_f32_16x16x32_bf16 v[108:111], v[136:139], v[156:159], v[108:111]
    v_mfma_f32_16x16x32_bf16 v[112:115], v[140:143], v[144:147], v[112:115]
    v_mfma_f32_16x16x32_bf16 v[116:119], v[140:143], v[148:151], v[116:119]
    v_mfma_f32_16x16x32_bf16 v[120:123], v[140:143], v[152:155], v[120:123]
    v_mfma_f32_16x16x32_bf16 v[124:127], v[140:143], v[156:159], v[124:127]
    s_waitcnt lgkmcnt(0)
    s_barrier
    v_mfma_f32_16x16x32_bf16 v[64:67], v[160:163], v[176:179], v[64:67]
    ds_read_b128 v[128:131], v16 offset:0
    v_mfma_f32_16x16x32_bf16 v[68:71], v[160:163], v[180:183], v[68:71]
    ds_read_b128 v[144:147], v18 offset:16384
    v_mfma_f32_16x16x32_bf16 v[72:75], v[160:163], v[184:187], v[72:75]
    v_mfma_f32_16x16x32_bf16 v[76:79], v[160:163], v[188:191], v[76:79]
    ds_read_b128 v[148:151], v18 offset:18432
    v_mfma_f32_16x16x32_bf16 v[80:83], v[164:167], v[176:179], v[80:83]
    ds_read_b128 v[152:155], v18 offset:20480
    v_mfma_f32_16x16x32_bf16 v[84:87], v[164:167], v[180:183], v[84:87]
    v_mfma_f32_16x16x32_bf16 v[88:91], v[164:167], v[184:187], v[88:91]
    ds_read_b128 v[156:159], v18 offset:22528
    v_mfma_f32_16x16x32_bf16 v[92:95], v[164:167], v[188:191], v[92:95]
    ds_read_b128 v[132:135], v16 offset:2048
    v_mfma_f32_16x16x32_bf16 v[96:99], v[168:171], v[176:179], v[96:99]
    v_mfma_f32_16x16x32_bf16 v[100:103], v[168:171], v[180:183], v[100:103]
    ds_read_b128 v[136:139], v16 offset:4096
    v_mfma_f32_16x16x32_bf16 v[104:107], v[168:171], v[184:187], v[104:107]
    ds_read_b128 v[140:143], v16 offset:6144
    v_mfma_f32_16x16x32_bf16 v[108:111], v[168:171], v[188:191], v[108:111]
    v_mfma_f32_16x16x32_bf16 v[112:115], v[172:175], v[176:179], v[112:115]
    v_mfma_f32_16x16x32_bf16 v[116:119], v[172:175], v[180:183], v[116:119]
    v_mfma_f32_16x16x32_bf16 v[120:123], v[172:175], v[184:187], v[120:123]
    v_mfma_f32_16x16x32_bf16 v[124:127], v[172:175], v[188:191], v[124:127]
    s_waitcnt lgkmcnt(0)
    v_mfma_f32_16x16x32_bf16 v[64:67], v[128:131], v[144:147], v[64:67]
    ds_read_b128 v[160:163], v17 offset:0
    v_mfma_f32_16x16x32_bf16 v[68:71], v[128:131], v[148:151], v[68:71]
    ds_read_b128 v[176:179], v19 offset:16384
    v_mfma_f32_16x16x32_bf16 v[72:75], v[128:131], v[152:155], v[72:75]
    v_mfma_f32_16x16x32_bf16 v[76:79], v[128:131], v[156:159], v[76:79]
    ds_read_b128 v[180:183], v19 offset:18432
    v_mfma_f32_16x16x32_bf16 v[80:83], v[132:135], v[144:147], v[80:83]
    ds_read_b128 v[184:187], v19 offset:20480
    v_mfma_f32_16x16x32_bf16 v[84:87], v[132:135], v[148:151], v[84:87]
    v_mfma_f32_16x16x32_bf16 v[88:91], v[132:135], v[152:155], v[88:91]
    ds_read_b128 v[188:191], v19 offset:22528
    v_mfma_f32_16x16x32_bf16 v[92:95], v[132:135], v[156:159], v[92:95]
    ds_read_b128 v[164:167], v17 offset:2048
    v_mfma_f32_16x16x32_bf16 v[96:99], v[136:139], v[144:147], v[96:99]
    v_mfma_f32_16x16x32_bf16 v[100:103], v[136:139], v[148:151], v[100:103]
    ds_read_b128 v[168:171], v17 offset:4096
    v_mfma_f32_16x16x32_bf16 v[104:107], v[136:139], v[152:155], v[104:107]
    ds_read_b128 v[172:175], v17 offset:6144
    v_mfma_f32_16x16x32_bf16 v[108:111], v[136:139], v[156:159], v[108:111]
    v_mfma_f32_16x16x32_bf16 v[112:115], v[140:143], v[144:147], v[112:115]
    v_mfma_f32_16x16x32_bf16 v[116:119], v[140:143], v[148:151], v[116:119]
    v_mfma_f32_16x16x32_bf16 v[120:123], v[140:143], v[152:155], v[120:123]
    v_mfma_f32_16x16x32_bf16 v[124:127], v[140:143], v[156:159], v[124:127]
    s_waitcnt lgkmcnt(0)
    s_barrier
    v_mfma_f32_16x16x32_bf16 v[64:67], v[160:163], v[176:179], v[64:67]
    ds_read_b128 v[128:131], v16 offset:32768
    v_mfma_f32_16x16x32_bf16 v[68:71], v[160:163], v[180:183], v[68:71]
    ds_read_b128 v[144:147], v18 offset:49152
    v_mfma_f32_16x16x32_bf16 v[72:75], v[160:163], v[184:187], v[72:75]
    v_mfma_f32_16x16x32_bf16 v[76:79], v[160:163], v[188:191], v[76:79]
    ds_read_b128 v[148:151], v18 offset:51200
    v_mfma_f32_16x16x32_bf16 v[80:83], v[164:167], v[176:179], v[80:83]
    ds_read_b128 v[152:155], v18 offset:53248
    v_mfma_f32_16x16x32_bf16 v[84:87], v[164:167], v[180:183], v[84:87]
    v_mfma_f32_16x16x32_bf16 v[88:91], v[164:167], v[184:187], v[88:91]
    ds_read_b128 v[156:159], v18 offset:55296
    v_mfma_f32_16x16x32_bf16 v[92:95], v[164:167], v[188:191], v[92:95]
    ds_read_b128 v[132:135], v16 offset:34816
    v_mfma_f32_16x16x32_bf16 v[96:99], v[168:171], v[176:179], v[96:99]
    v_mfma_f32_16x16x32_bf16 v[100:103], v[168:171], v[180:183], v[100:103]
    ds_read_b128 v[136:139], v16 offset:36864
    v_mfma_f32_16x16x32_bf16 v[104:107], v[168:171], v[184:187], v[104:107]
    ds_read_b128 v[140:143], v16 offset:38912
    v_mfma_f32_16x16x32_bf16 v[108:111], v[168:171], v[188:191], v[108:111]
    v_mfma_f32_16x16x32_bf16 v[112:115], v[172:175], v[176:179], v[112:115]
    v_mfma_f32_16x16x32_bf16 v[116:119], v[172:175], v[180:183], v[116:119]
    v_mfma_f32_16x16x32_bf16 v[120:123], v[172:175], v[184:187], v[120:123]
    v_mfma_f32_16x16x32_bf16 v[124:127], v[172:175], v[188:191], v[124:127]
    s_waitcnt lgkmcnt(0)
    v_mfma_f32_16x16x32_bf16 v[64:67], v[128:131], v[144:147], v[64:67]
    ds_read_b128 v[160:163], v17 offset:32768
    v_mfma_f32_16x16x32_bf16 v[68:71], v[128:131], v[148:151], v[68:71]
    ds_read_b128 v[176:179], v19 offset:49152
    v_mfma_f32_16x16x32_bf16 v[72:75], v[128:131], v[152:155], v[72:75]
    v_mfma_f32_16x16x32_bf16 v[76:79], v[128:131], v[156:159], v[76:79]
    ds_read_b128 v[180:183], v19 offset:51200
    v_mfma_f32_16x16x32_bf16 v[80:83], v[132:135], v[144:147], v[80:83]
    ds_read_b128 v[184:187], v19 offset:53248
    v_mfma_f32_16x16x32_bf16 v[84:87], v[132:135], v[148:151], v[84:87]
    v_mfma_f32_16x16x32_bf16 v[88:91], v[132:135], v[152:155], v[88:91]
    ds_read_b128 v[188:191], v19 offset:55296
    v_mfma_f32_16x16x32_bf16 v[92:95], v[132:135], v[156:159], v[92:95]
    ds_read_b128 v[164:167], v17 offset:34816
    v_mfma_f32_16x16x32_bf16 v[96:99], v[136:139], v[144:147], v[96:99]
    v_mfma_f32_16x16x32_bf16 v[100:103], v[136:139], v[148:151], v[100:103]
    ds_read_b128 v[168:171], v17 offset:36864
    v_mfma_f32_16x16x32_bf16 v[104:107], v[136:139], v[152:155], v[104:107]
    ds_read_b128 v[172:175], v17 offset:38912
    v_mfma_f32_16x16x32_bf16 v[108:111], v[136:139], v[156:159], v[108:111]
    v_mfma_f32_16x16x32_bf16 v[112:115], v[140:143], v[144:147], v[112:115]
    v_mfma_f32_16x16x32_bf16 v[116:119], v[140:143], v[148:151], v[116:119]
    v_mfma_f32_16x16x32_bf16 v[120:123], v[140:143], v[152:155], v[120:123]
    v_mfma_f32_16x16x32_bf16 v[124:127], v[140:143], v[156:159], v[124:127]
    s_waitcnt lgkmcnt(0)
    s_barrier
    v_mfma_f32_16x16x32_bf16 v[64:67], v[160:163], v[176:179], v[64:67]
    ds_read_b128 v[128:131], v20 offset:0
    v_mfma_f32_16x16x32_bf16 v[68:71], v[160:163], v[180:183], v[68:71]
    ds_read_b128 v[144:147], v22 offset:16384
    v_mfma_f32_16x16x32_bf16 v[72:75], v[160:163], v[184:187], v[72:75]
    v_mfma_f32_16x16x32_bf16 v[76:79], v[160:163], v[188:191], v[76:79]
    ds_read_b128 v[148:151], v22 offset:18432
    v_mfma_f32_16x16x32_bf16 v[80:83], v[164:167], v[176:179], v[80:83]
    ds_read_b128 v[152:155], v22 offset:20480
    v_mfma_f32_16x16x32_bf16 v[84:87], v[164:167], v[180:183], v[84:87]
    v_mfma_f32_16x16x32_bf16 v[88:91], v[164:167], v[184:187], v[88:91]
    ds_read_b128 v[156:159], v22 offset:22528
    v_mfma_f32_16x16x32_bf16 v[92:95], v[164:167], v[188:191], v[92:95]
    ds_read_b128 v[132:135], v20 offset:2048
    v_mfma_f32_16x16x32_bf16 v[96:99], v[168:171], v[176:179], v[96:99]
    v_mfma_f32_16x16x32_bf16 v[100:103], v[168:171], v[180:183], v[100:103]
    ds_read_b128 v[136:139], v20 offset:4096
    v_mfma_f32_16x16x32_bf16 v[104:107], v[168:171], v[184:187], v[104:107]
    ds_read_b128 v[140:143], v20 offset:6144
    v_mfma_f32_16x16x32_bf16 v[108:111], v[168:171], v[188:191], v[108:111]
    v_mfma_f32_16x16x32_bf16 v[112:115], v[172:175], v[176:179], v[112:115]
    v_mfma_f32_16x16x32_bf16 v[116:119], v[172:175], v[180:183], v[116:119]
    v_mfma_f32_16x16x32_bf16 v[120:123], v[172:175], v[184:187], v[120:123]
    v_mfma_f32_16x16x32_bf16 v[124:127], v[172:175], v[188:191], v[124:127]
    s_waitcnt lgkmcnt(0)
    v_mfma_f32_16x16x32_bf16 v[64:67], v[128:131], v[144:147], v[64:67]
    ds_read_b128 v[160:163], v21 offset:0
    v_mfma_f32_16x16x32_bf16 v[68:71], v[128:131], v[148:151], v[68:71]
    ds_read_b128 v[176:179], v23 offset:16384
    v_mfma_f32_16x16x32_bf16 v[72:75], v[128:131], v[152:155], v[72:75]
    v_mfma_f32_16x16x32_bf16 v[76:79], v[128:131], v[156:159], v[76:79]
    ds_read_b128 v[180:183], v23 offset:18432
    v_mfma_f32_16x16x32_bf16 v[80:83], v[132:135], v[144:147], v[80:83]
    ds_read_b128 v[184:187], v23 offset:20480
    v_mfma_f32_16x16x32_bf16 v[84:87], v[132:135], v[148:151], v[84:87]
    v_mfma_f32_16x16x32_bf16 v[88:91], v[132:135], v[152:155], v[88:91]
    ds_read_b128 v[188:191], v23 offset:22528
    v_mfma_f32_16x16x32_bf16 v[92:95], v[132:135], v[156:159], v[92:95]
    ds_read_b128 v[164:167], v21 offset:2048
    v_mfma_f32_16x16x32_bf16 v[96:99], v[136:139], v[144:147], v[96:99]
    v_mfma_f32_16x16x32_bf16 v[100:103], v[136:139], v[148:151], v[100:103]
    ds_read_b128 v[168:171], v21 offset:4096
    v_mfma_f32_16x16x32_bf16 v[104:107], v[136:139], v[152:155], v[104:107]
    ds_read_b128 v[172:175], v21 offset:6144
    v_mfma_f32_16x16x32_bf16 v[108:111], v[136:139], v[156:159], v[108:111]
    v_mfma_f32_16x16x32_bf16 v[112:115], v[140:143], v[144:147], v[112:115]
    v_mfma_f32_16x16x32_bf16 v[116:119], v[140:143], v[148:151], v[116:119]
    v_mfma_f32_16x16x32_bf16 v[120:123], v[140:143], v[152:155], v[120:123]
    v_mfma_f32_16x16x32_bf16 v[124:127], v[140:143], v[156:159], v[124:127]
    s_waitcnt lgkmcnt(0)
    s_barrier
    v_mfma_f32_16x16x32_bf16 v[64:67], v[160:163], v[176:179], v[64:67]
    ds_read_b128 v[128:131], v16 offset:0
    v_mfma_f32_16x16x32_bf16 v[68:71], v[160:163], v[180:183], v[68:71]
    ds_read_b128 v[144:147], v18 offset:16384
    v_mfma_f32_16x16x32_bf16 v[72:75], v[160:163], v[184:187], v[72:75]
    v_mfma_f32_16x16x32_bf16 v[76:79], v[160:163], v[188:191], v[76:79]
    ds_read_b128 v[148:151], v18 offset:18432
    v_mfma_f32_16x16x32_bf16 v[80:83], v[164:167], v[176:179], v[80:83]
    ds_read_b128 v[152:155], v18 offset:20480
    v_mfma_f32_16x16x32_bf16 v[84:87], v[164:167], v[180:183], v[84:87]
    v_mfma_f32_16x16x32_bf16 v[88:91], v[164:167], v[184:187], v[88:91]
    ds_read_b128 v[156:159], v18 offset:22528
    v_mfma_f32_16x16x32_bf16 v[92:95], v[164:167], v[188:191], v[92:95]
    ds_read_b128 v[132:135], v16 offset:2048
    v_mfma_f32_16x16x32_bf16 v[96:99], v[168:171], v[176:179], v[96:99]
    v_mfma_f32_16x16x32_bf16 v[100:103], v[168:171], v[180:183], v[100:103]
    ds_read_b128 v[136:139], v16 offset:4096
    v_mfma_f32_16x16x32_bf16 v[104:107], v[168:171], v[184:187], v[104:107]
    ds_read_b128 v[140:143], v16 offset:6144
    v_mfma_f32_16x16x32_bf16 v[108:111], v[168:171], v[188:191], v[108:111]
    v_mfma_f32_16x16x32_bf16 v[112:115], v[172:175], v[176:179], v[112:115]
    v_mfma_f32_16x16x32_bf16 v[116:119], v[172:175], v[180:183], v[116:119]
    v_mfma_f32_16x16x32_bf16 v[120:123], v[172:175], v[184:187], v[120:123]
    v_mfma_f32_16x16x32_bf16 v[124:127], v[172:175], v[188:191], v[124:127]
    s_waitcnt lgkmcnt(0)
    v_mfma_f32_16x16x32_bf16 v[64:67], v[128:131], v[144:147], v[64:67]
    ds_read_b128 v[160:163], v17 offset:0
    v_mfma_f32_16x16x32_bf16 v[68:71], v[128:131], v[148:151], v[68:71]
    ds_read_b128 v[176:179], v19 offset:16384
    v_mfma_f32_16x16x32_bf16 v[72:75], v[128:131], v[152:155], v[72:75]
    v_mfma_f32_16x16x32_bf16 v[76:79], v[128:131], v[156:159], v[76:79]
    ds_read_b128 v[180:183], v19 offset:18432
    v_mfma_f32_16x16x32_bf16 v[80:83], v[132:135], v[144:147], v[80:83]
    ds_read_b128 v[184:187], v19 offset:20480
    v_mfma_f32_16x16x32_bf16 v[84:87], v[132:135], v[148:151], v[84:87]
    v_mfma_f32_16x16x32_bf16 v[88:91], v[132:135], v[152:155], v[88:91]
    ds_read_b128 v[188:191], v19 offset:22528
    v_mfma_f32_16x16x32_bf16 v[92:95], v[132:135], v[156:159], v[92:95]
    ds_read_b128 v[164:167], v17 offset:2048
    v_mfma_f32_16x16x32_bf16 v[96:99], v[136:139], v[144:147], v[96:99]
    v_mfma_f32_16x16x32_bf16 v[100:103], v[136:139], v[148:151], v[100:103]
    ds_read_b128 v[168:171], v17 offset:4096
    v_mfma_f32_16x16x32_bf16 v[104:107], v[136:139], v[152:155], v[104:107]
    ds_read_b128 v[172:175], v17 offset:6144
    v_mfma_f32_16x16x32_bf16 v[108:111], v[136:139], v[156:159], v[108:111]
    v_mfma_f32_16x16x32_bf16 v[112:115], v[140:143], v[144:147], v[112:115]
    v_mfma_f32_16x16x32_bf16 v[116:119], v[140:143], v[148:151], v[116:119]
    v_mfma_f32_16x16x32_bf16 v[120:123], v[140:143], v[152:155], v[120:123]
    v_mfma_f32_16x16x32_bf16 v[124:127], v[140:143], v[156:159], v[124:127]
    global_load_dword v10, v3, s[8:9]
    global_load_dword v11, v3, s[10:11]
    s_waitcnt lgkmcnt(0)
    s_barrier
    v_mfma_f32_16x16x32_bf16 v[64:67], v[160:163], v[176:179], v[64:67]
    ds_read_b128 v[128:131], v16 offset:32768
    v_mfma_f32_16x16x32_bf16 v[68:71], v[160:163], v[180:183], v[68:71]
    ds_read_b128 v[144:147], v18 offset:49152
    v_mfma_f32_16x16x32_bf16 v[72:75], v[160:163], v[184:187], v[72:75]
    v_mfma_f32_16x16x32_bf16 v[76:79], v[160:163], v[188:191], v[76:79]
    ds_read_b128 v[148:151], v18 offset:51200
    v_mfma_f32_16x16x32_bf16 v[80:83], v[164:167], v[176:179], v[80:83]
    ds_read_b128 v[152:155], v18 offset:53248
    v_mfma_f32_16x16x32_bf16 v[84:87], v[164:167], v[180:183], v[84:87]
    v_mfma_f32_16x16x32_bf16 v[88:91], v[164:167], v[184:187], v[88:91]
    ds_read_b128 v[156:159], v18 offset:55296
    v_mfma_f32_16x16x32_bf16 v[92:95], v[164:167], v[188:191], v[92:95]
    ds_read_b128 v[132:135], v16 offset:34816
    v_mfma_f32_16x16x32_bf16 v[96:99], v[168:171], v[176:179], v[96:99]
    v_mfma_f32_16x16x32_bf16 v[100:103], v[168:171], v[180:183], v[100:103]
    ds_read_b128 v[136:139], v16 offset:36864
    v_mfma_f32_16x16x32_bf16 v[104:107], v[168:171], v[184:187], v[104:107]
    ds_read_b128 v[140:143], v16 offset:38912
    v_mfma_f32_16x16x32_bf16 v[108:111], v[168:171], v[188:191], v[108:111]
    v_mfma_f32_16x16x32_bf16 v[112:115], v[172:175], v[176:179], v[112:115]
    v_mfma_f32_16x16x32_bf16 v[116:119], v[172:175], v[180:183], v[116:119]
    v_mfma_f32_16x16x32_bf16 v[120:123], v[172:175], v[184:187], v[120:123]
    v_mfma_f32_16x16x32_bf16 v[124:127], v[172:175], v[188:191], v[124:127]
    s_waitcnt lgkmcnt(0)
    v_mfma_f32_16x16x32_bf16 v[64:67], v[128:131], v[144:147], v[64:67]
    ds_read_b128 v[160:163], v17 offset:32768
    v_mfma_f32_16x16x32_bf16 v[68:71], v[128:131], v[148:151], v[68:71]
    ds_read_b128 v[176:179], v19 offset:49152
    v_mfma_f32_16x16x32_bf16 v[72:75], v[128:131], v[152:155], v[72:75]
    v_mfma_f32_16x16x32_bf16 v[76:79], v[128:131], v[156:159], v[76:79]
    ds_read_b128 v[180:183], v19 offset:51200
    v_mfma_f32_16x16x32_bf16 v[80:83], v[132:135], v[144:147], v[80:83]
    ds_read_b128 v[184:187], v19 offset:53248
    v_mfma_f32_16x16x32_bf16 v[84:87], v[132:135], v[148:151], v[84:87]
    v_mfma_f32_16x16x32_bf16 v[88:91], v[132:135], v[152:155], v[88:91]
    ds_read_b128 v[188:191], v19 offset:55296
    v_mfma_f32_16x16x32_bf16 v[92:95], v[132:135], v[156:159], v[92:95]
    ds_read_b128 v[164:167], v17 offset:34816
    v_mfma_f32_16x16x32_bf16 v[96:99], v[136:139], v[144:147], v[96:99]
    v_mfma_f32_16x16x32_bf16 v[100:103], v[136:139], v[148:151], v[100:103]
    ds_read_b128 v[168:171], v17 offset:36864
    v_mfma_f32_16x16x32_bf16 v[104:107], v[136:139], v[152:155], v[104:107]
    ds_read_b128 v[172:175], v17 offset:38912
    v_mfma_f32_16x16x32_bf16 v[108:111], v[136:139], v[156:159], v[108:111]
    v_mfma_f32_16x16x32_bf16 v[112:115], v[140:143], v[144:147], v[112:115]
    v_mfma_f32_16x16x32_bf16 v[116:119], v[140:143], v[148:151], v[116:119]
    v_mfma_f32_16x16x32_bf16 v[120:123], v[140:143], v[152:155], v[120:123]
    v_mfma_f32_16x16x32_bf16 v[124:127], v[140:143], v[156:159], v[124:127]
    s_waitcnt lgkmcnt(0)
    s_barrier
    v_mfma_f32_16x16x32_bf16 v[64:67], v[160:163], v[176:179], v[64:67]
    ds_read_b128 v[128:131], v20 offset:0
    v_mfma_f32_16x16x32_bf16 v[68:71], v[160:163], v[180:183], v[68:71]
    ds_read_b128 v[144:147], v22 offset:16384
    v_mfma_f32_16x16x32_bf16 v[72:75], v[160:163], v[184:187], v[72:75]
    v_mfma_f32_16x16x32_bf16 v[76:79], v[160:163], v[188:191], v[76:79]
    ds_read_b128 v[148:151], v22 offset:18432
    v_mfma_f32_16x16x32_bf16 v[80:83], v[164:167], v[176:179], v[80:83]
    ds_read_b128 v[152:155], v22 offset:20480
    v_mfma_f32_16x16x32_bf16 v[84:87], v[164:167], v[180:183], v[84:87]
    v_mfma_f32_16x16x32_bf16 v[88:91], v[164:167], v[184:187], v[88:91]
    ds_read_b128 v[156:159], v22 offset:22528
    v_mfma_f32_16x16x32_bf16 v[92:95], v[164:167], v[188:191], v[92:95]
    ds_read_b128 v[132:135], v20 offset:2048
    v_mfma_f32_16x16x32_bf16 v[96:99], v[168:171], v[176:179], v[96:99]
    v_mfma_f32_16x16x32_bf16 v[100:103], v[168:171], v[180:183], v[100:103]
    ds_read_b128 v[136:139], v20 offset:4096
    v_mfma_f32_16x16x32_bf16 v[104:107], v[168:171], v[184:187], v[104:107]
    ds_read_b128 v[140:143], v20 offset:6144
    v_mfma_f32_16x16x32_bf16 v[108:111], v[168:171], v[188:191], v[108:111]
    v_mfma_f32_16x16x32_bf16 v[112:115], v[172:175], v[176:179], v[112:115]
    v_mfma_f32_16x16x32_bf16 v[116:119], v[172:175], v[180:183], v[116:119]
    v_mfma_f32_16x16x32_bf16 v[120:123], v[172:175], v[184:187], v[120:123]
    v_mfma_f32_16x16x32_bf16 v[124:127], v[172:175], v[188:191], v[124:127]
    s_waitcnt lgkmcnt(0)
    v_mfma_f32_16x16x32_bf16 v[64:67], v[128:131], v[144:147], v[64:67]
    ds_read_b128 v[160:163], v21 offset:0
    v_mfma_f32_16x16x32_bf16 v[68:71], v[128:131], v[148:151], v[68:71]
    ds_read_b128 v[176:179], v23 offset:16384
    v_mfma_f32_16x16x32_bf16 v[72:75], v[128:131], v[152:155], v[72:75]
    v_mfma_f32_16x16x32_bf16 v[76:79], v[128:131], v[156:159], v[76:79]
    ds_read_b128 v[180:183], v23 offset:18432
    v_mfma_f32_16x16x32_bf16 v[80:83], v[132:135], v[144:147], v[80:83]
    ds_read_b128 v[184:187], v23 offset:20480
    v_mfma_f32_16x16x32_bf16 v[84:87], v[132:135], v[148:151], v[84:87]
    v_mfma_f32_16x16x32_bf16 v[88:91], v[132:135], v[152:155], v[88:91]
    ds_read_b128 v[188:191], v23 offset:22528
    v_mfma_f32_16x16x32_bf16 v[92:95], v[132:135], v[156:159], v[92:95]
    ds_read_b128 v[164:167], v21 offset:2048
    v_mfma_f32_16x16x32_bf16 v[96:99], v[136:139], v[144:147], v[96:99]
    v_mfma_f32_16x16x32_bf16 v[100:103], v[136:139], v[148:151], v[100:103]
    ds_read_b128 v[168:171], v21 offset:4096
    v_mfma_f32_16x16x32_bf16 v[104:107], v[136:139], v[152:155], v[104:107]
    ds_read_b128 v[172:175], v21 offset:6144
    v_mfma_f32_16x16x32_bf16 v[108:111], v[136:139], v[156:159], v[108:111]
    v_mfma_f32_16x16x32_bf16 v[112:115], v[140:143], v[144:147], v[112:115]
    v_mfma_f32_16x16x32_bf16 v[116:119], v[140:143], v[148:151], v[116:119]
    v_mfma_f32_16x16x32_bf16 v[120:123], v[140:143], v[152:155], v[120:123]
    v_mfma_f32_16x16x32_bf16 v[124:127], v[140:143], v[156:159], v[124:127]
    buffer_load_dword v2, v1, s[12:15], s52 offen sc1
    buffer_load_dwordx2 v[240:241], v221, s[12:15], s57 offen sc1
    global_load_dwordx2 v[242:243], v222, s[58:59]
    s_waitcnt lgkmcnt(0)
    s_barrier
    v_mfma_f32_16x16x32_bf16 v[64:67], v[160:163], v[176:179], v[64:67]
    ds_read_b128 v[128:131], v16 offset:0
    v_mfma_f32_16x16x32_bf16 v[68:71], v[160:163], v[180:183], v[68:71]
    ds_read_b128 v[144:147], v18 offset:16384
    v_mfma_f32_16x16x32_bf16 v[72:75], v[160:163], v[184:187], v[72:75]
    buffer_load_dwordx2 v[224:225], v220, s[4:7], s56 offen
    s_add_u32 s56, s56, 8192
    v_mfma_f32_16x16x32_bf16 v[76:79], v[160:163], v[188:191], v[76:79]
    ds_read_b128 v[148:151], v18 offset:18432
    v_mfma_f32_16x16x32_bf16 v[80:83], v[164:167], v[176:179], v[80:83]
    ds_read_b128 v[152:155], v18 offset:20480
    v_mfma_f32_16x16x32_bf16 v[84:87], v[164:167], v[180:183], v[84:87]
    buffer_load_dwordx2 v[226:227], v220, s[4:7], s56 offen
    s_add_u32 s56, s56, 8192
    v_mfma_f32_16x16x32_bf16 v[88:91], v[164:167], v[184:187], v[88:91]
    ds_read_b128 v[156:159], v18 offset:22528
    v_mfma_f32_16x16x32_bf16 v[92:95], v[164:167], v[188:191], v[92:95]
    ds_read_b128 v[132:135], v16 offset:2048
    v_mfma_f32_16x16x32_bf16 v[96:99], v[168:171], v[176:179], v[96:99]
    buffer_load_dwordx2 v[228:229], v220, s[4:7], s56 offen
    s_add_u32 s56, s56, 8192
    v_mfma_f32_16x16x32_bf16 v[100:103], v[168:171], v[180:183], v[100:103]
    ds_read_b128 v[136:139], v16 offset:4096
    v_mfma_f32_16x16x32_bf16 v[104:107], v[168:171], v[184:187], v[104:107]
    ds_read_b128 v[140:143], v16 offset:6144
    v_mfma_f32_16x16x32_bf16 v[108:111], v[168:171], v[188:191], v[108:111]
    buffer_load_dwordx2 v[230:231], v220, s[4:7], s56 offen
    s_add_u32 s56, s56, 8192
    v_mfma_f32_16x16x32_bf16 v[112:115], v[172:175], v[176:179], v[112:115]
    buffer_load_dwordx2 v[232:233], v220, s[4:7], s56 offen
    s_add_u32 s56, s56, 8192
    v_mfma_f32_16x16x32_bf16 v[116:119], v[172:175], v[180:183], v[116:119]
    buffer_load_dwordx2 v[234:235], v220, s[4:7], s56 offen
    s_add_u32 s56, s56, 8192
    v_mfma_f32_16x16x32_bf16 v[120:123], v[172:175], v[184:187], v[120:123]
    buffer_load_dwordx2 v[236:237], v220, s[4:7], s56 offen
    s_add_u32 s56, s56, 8192
    v_mfma_f32_16x16x32_bf16 v[124:127], v[172:175], v[188:191], v[124:127]
    buffer_load_dwordx2 v[238:239], v220, s[4:7], s56 offen
    s_add_u32 s56, s56, 8192
    s_waitcnt lgkmcnt(0)
    v_mfma_f32_16x16x32_bf16 v[64:67], v[128:131], v[144:147], v[64:67]
    ds_read_b128 v[160:163], v17 offset:0
    v_mfma_f32_16x16x32_bf16 v[68:71], v[128:131], v[148:151], v[68:71]
    ds_read_b128 v[176:179], v19 offset:16384
    v_mfma_f32_16x16x32_bf16 v[72:75], v[128:131], v[152:155], v[72:75]
    v_mfma_f32_16x16x32_bf16 v[76:79], v[128:131], v[156:159], v[76:79]
    ds_read_b128 v[180:183], v19 offset:18432
    v_mfma_f32_16x16x32_bf16 v[80:83], v[132:135], v[144:147], v[80:83]
    ds_read_b128 v[184:187], v19 offset:20480
    v_mfma_f32_16x16x32_bf16 v[84:87], v[132:135], v[148:151], v[84:87]
    v_mfma_f32_16x16x32_bf16 v[88:91], v[132:135], v[152:155], v[88:91]
    ds_read_b128 v[188:191], v19 offset:22528
    v_mfma_f32_16x16x32_bf16 v[92:95], v[132:135], v[156:159], v[92:95]
    ds_read_b128 v[164:167], v17 offset:2048
    v_mfma_f32_16x16x32_bf16 v[96:99], v[136:139], v[144:147], v[96:99]
    v_mfma_f32_16x16x32_bf16 v[100:103], v[136:139], v[148:151], v[100:103]
    ds_read_b128 v[168:171], v17 offset:4096
    v_mfma_f32_16x16x32_bf16 v[104:107], v[136:139], v[152:155], v[104:107]
    ds_read_b128 v[172:175], v17 offset:6144
    v_mfma_f32_16x16x32_bf16 v[108:111], v[136:139], v[156:159], v[108:111]
    v_mfma_f32_16x16x32_bf16 v[112:115], v[140:143], v[144:147], v[112:115]
    v_mfma_f32_16x16x32_bf16 v[116:119], v[140:143], v[148:151], v[116:119]
    v_mfma_f32_16x16x32_bf16 v[120:123], v[140:143], v[152:155], v[120:123]
    v_mfma_f32_16x16x32_bf16 v[124:127], v[140:143], v[156:159], v[124:127]
    s_waitcnt lgkmcnt(0)
    s_barrier
    v_mfma_f32_16x16x32_bf16 v[64:67], v[160:163], v[176:179], v[64:67]
    ds_read_b128 v[128:131], v16 offset:32768
    v_mfma_f32_16x16x32_bf16 v[68:71], v[160:163], v[180:183], v[68:71]
    ds_read_b128 v[144:147], v18 offset:49152
    v_mfma_f32_16x16x32_bf16 v[72:75], v[160:163], v[184:187], v[72:75]
    v_mfma_f32_16x16x32_bf16 v[76:79], v[160:163], v[188:191], v[76:79]
    ds_read_b128 v[148:151], v18 offset:51200
    v_mfma_f32_16x16x32_bf16 v[80:83], v[164:167], v[176:179], v[80:83]
    ds_read_b128 v[152:155], v18 offset:53248
    v_mfma_f32_16x16x32_bf16 v[84:87], v[164:167], v[180:183], v[84:87]
    v_mfma_f32_16x16x32_bf16 v[88:91], v[164:167], v[184:187], v[88:91]
    ds_read_b128 v[156:159], v18 offset:55296
    v_mfma_f32_16x16x32_bf16 v[92:95], v[164:167], v[188:191], v[92:95]
    ds_read_b128 v[132:135], v16 offset:34816
    v_mfma_f32_16x16x32_bf16 v[96:99], v[168:171], v[176:179], v[96:99]
    v_mfma_f32_16x16x32_bf16 v[100:103], v[168:171], v[180:183], v[100:103]
    ds_read_b128 v[136:139], v16 offset:36864
    v_mfma_f32_16x16x32_bf16 v[104:107], v[168:171], v[184:187], v[104:107]
    ds_read_b128 v[140:143], v16 offset:38912
    v_mfma_f32_16x16x32_bf16 v[108:111], v[168:171], v[188:191], v[108:111]
    v_mfma_f32_16x16x32_bf16 v[112:115], v[172:175], v[176:179], v[112:115]
    v_mfma_f32_16x16x32_bf16 v[116:119], v[172:175], v[180:183], v[116:119]
    v_mfma_f32_16x16x32_bf16 v[120:123], v[172:175], v[184:187], v[120:123]
    v_mfma_f32_16x16x32_bf16 v[124:127], v[172:175], v[188:191], v[124:127]
    s_waitcnt lgkmcnt(0)
    v_mfma_f32_16x16x32_bf16 v[64:67], v[128:131], v[144:147], v[64:67]
    ds_read_b128 v[160:163], v17 offset:32768
    v_mfma_f32_16x16x32_bf16 v[68:71], v[128:131], v[148:151], v[68:71]
    ds_read_b128 v[176:179], v19 offset:49152
    v_mfma_f32_16x16x32_bf16 v[72:75], v[128:131], v[152:155], v[72:75]
    v_mfma_f32_16x16x32_bf16 v[76:79], v[128:131], v[156:159], v[76:79]
    ds_read_b128 v[180:183], v19 offset:51200
    v_mfma_f32_16x16x32_bf16 v[80:83], v[132:135], v[144:147], v[80:83]
    ds_read_b128 v[184:187], v19 offset:53248
    v_mfma_f32_16x16x32_bf16 v[84:87], v[132:135], v[148:151], v[84:87]
    v_mfma_f32_16x16x32_bf16 v[88:91], v[132:135], v[152:155], v[88:91]
    ds_read_b128 v[188:191], v19 offset:55296
    v_mfma_f32_16x16x32_bf16 v[92:95], v[132:135], v[156:159], v[92:95]
    ds_read_b128 v[164:167], v17 offset:34816
    v_mfma_f32_16x16x32_bf16 v[96:99], v[136:139], v[144:147], v[96:99]
    v_mfma_f32_16x16x32_bf16 v[100:103], v[136:139], v[148:151], v[100:103]
    ds_read_b128 v[168:171], v17 offset:36864
    v_mfma_f32_16x16x32_bf16 v[104:107], v[136:139], v[152:155], v[104:107]
    ds_read_b128 v[172:175], v17 offset:38912
    v_mfma_f32_16x16x32_bf16 v[108:111], v[136:139], v[156:159], v[108:111]
    v_mfma_f32_16x16x32_bf16 v[112:115], v[140:143], v[144:147], v[112:115]
    v_mfma_f32_16x16x32_bf16 v[116:119], v[140:143], v[148:151], v[116:119]
    v_mfma_f32_16x16x32_bf16 v[120:123], v[140:143], v[152:155], v[120:123]
    v_mfma_f32_16x16x32_bf16 v[124:127], v[140:143], v[156:159], v[124:127]
    s_waitcnt lgkmcnt(0)
    s_barrier
    v_mfma_f32_16x16x32_bf16 v[64:67], v[160:163], v[176:179], v[64:67]
    ds_read_b128 v[128:131], v20 offset:0
    v_mfma_f32_16x16x32_bf16 v[68:71], v[160:163], v[180:183], v[68:71]
    ds_read_b128 v[144:147], v22 offset:16384
    v_mfma_f32_16x16x32_bf16 v[72:75], v[160:163], v[184:187], v[72:75]
    v_mfma_f32_16x16x32_bf16 v[76:79], v[160:163], v[188:191], v[76:79]
    ds_read_b128 v[148:151], v22 offset:18432
    v_mfma_f32_16x16x32_bf16 v[80:83], v[164:167], v[176:179], v[80:83]
    ds_read_b128 v[152:155], v22 offset:20480
    v_mfma_f32_16x16x32_bf16 v[84:87], v[164:167], v[180:183], v[84:87]
    v_mfma_f32_16x16x32_bf16 v[88:91], v[164:167], v[184:187], v[88:91]
    ds_read_b128 v[156:159], v22 offset:22528
    v_mfma_f32_16x16x32_bf16 v[92:95], v[164:167], v[188:191], v[92:95]
    ds_read_b128 v[132:135], v20 offset:2048
    v_mfma_f32_16x16x32_bf16 v[96:99], v[168:171], v[176:179], v[96:99]
    v_mfma_f32_16x16x32_bf16 v[100:103], v[168:171], v[180:183], v[100:103]
    ds_read_b128 v[136:139], v20 offset:4096
    v_mfma_f32_16x16x32_bf16 v[104:107], v[168:171], v[184:187], v[104:107]
    ds_read_b128 v[140:143], v20 offset:6144
    v_mfma_f32_16x16x32_bf16 v[108:111], v[168:171], v[188:191], v[108:111]
    v_mfma_f32_16x16x32_bf16 v[112:115], v[172:175], v[176:179], v[112:115]
    v_mfma_f32_16x16x32_bf16 v[116:119], v[172:175], v[180:183], v[116:119]
    v_mfma_f32_16x16x32_bf16 v[120:123], v[172:175], v[184:187], v[120:123]
    v_mfma_f32_16x16x32_bf16 v[124:127], v[172:175], v[188:191], v[124:127]
    s_waitcnt lgkmcnt(0)
    v_mfma_f32_16x16x32_bf16 v[64:67], v[128:131], v[144:147], v[64:67]
    ds_read_b128 v[160:163], v21 offset:0
    v_mfma_f32_16x16x32_bf16 v[68:71], v[128:131], v[148:151], v[68:71]
    ds_read_b128 v[176:179], v23 offset:16384
    v_mfma_f32_16x16x32_bf16 v[72:75], v[128:131], v[152:155], v[72:75]
    v_mfma_f32_16x16x32_bf16 v[76:79], v[128:131], v[156:159], v[76:79]
    ds_read_b128 v[180:183], v23 offset:18432
    v_mfma_f32_16x16x32_bf16 v[80:83], v[132:135], v[144:147], v[80:83]
    ds_read_b128 v[184:187], v23 offset:20480
    v_mfma_f32_16x16x32_bf16 v[84:87], v[132:135], v[148:151], v[84:87]
    v_mfma_f32_16x16x32_bf16 v[88:91], v[132:135], v[152:155], v[88:91]
    ds_read_b128 v[188:191], v23 offset:22528
    v_mfma_f32_16x16x32_bf16 v[92:95], v[132:135], v[156:159], v[92:95]
    ds_read_b128 v[164:167], v21 offset:2048
    v_mfma_f32_16x16x32_bf16 v[96:99], v[136:139], v[144:147], v[96:99]
    v_mfma_f32_16x16x32_bf16 v[100:103], v[136:139], v[148:151], v[100:103]
    ds_read_b128 v[168:171], v21 offset:4096
    v_mfma_f32_16x16x32_bf16 v[104:107], v[136:139], v[152:155], v[104:107]
    ds_read_b128 v[172:175], v21 offset:6144
    v_mfma_f32_16x16x32_bf16 v[108:111], v[136:139], v[156:159], v[108:111]
    v_mfma_f32_16x16x32_bf16 v[112:115], v[140:143], v[144:147], v[112:115]
    v_mfma_f32_16x16x32_bf16 v[116:119], v[140:143], v[148:151], v[116:119]
    v_mfma_f32_16x16x32_bf16 v[120:123], v[140:143], v[152:155], v[120:123]
    v_mfma_f32_16x16x32_bf16 v[124:127], v[140:143], v[156:159], v[124:127]
    s_waitcnt lgkmcnt(0)
    s_barrier
    v_mfma_f32_16x16x32_bf16 v[64:67], v[160:163], v[176:179], v[64:67]
    ds_read_b128 v[128:131], v16 offset:0
    v_mfma_f32_16x16x32_bf16 v[68:71], v[160:163], v[180:183], v[68:71]
    ds_read_b128 v[144:147], v18 offset:16384
    v_mfma_f32_16x16x32_bf16 v[72:75], v[160:163], v[184:187], v[72:75]
    v_mfma_f32_16x16x32_bf16 v[76:79], v[160:163], v[188:191], v[76:79]
    ds_read_b128 v[148:151], v18 offset:18432
    v_mfma_f32_16x16x32_bf16 v[80:83], v[164:167], v[176:179], v[80:83]
    ds_read_b128 v[152:155], v18 offset:20480
    v_mfma_f32_16x16x32_bf16 v[84:87], v[164:167], v[180:183], v[84:87]
    v_mfma_f32_16x16x32_bf16 v[88:91], v[164:167], v[184:187], v[88:91]
    ds_read_b128 v[156:159], v18 offset:22528
    v_mfma_f32_16x16x32_bf16 v[92:95], v[164:167], v[188:191], v[92:95]
    ds_read_b128 v[132:135], v16 offset:2048
    v_mfma_f32_16x16x32_bf16 v[96:99], v[168:171], v[176:179], v[96:99]
    v_mfma_f32_16x16x32_bf16 v[100:103], v[168:171], v[180:183], v[100:103]
    ds_read_b128 v[136:139], v16 offset:4096
    v_mfma_f32_16x16x32_bf16 v[104:107], v[168:171], v[184:187], v[104:107]
    ds_read_b128 v[140:143], v16 offset:6144
    v_mfma_f32_16x16x32_bf16 v[108:111], v[168:171], v[188:191], v[108:111]
    v_mfma_f32_16x16x32_bf16 v[112:115], v[172:175], v[176:179], v[112:115]
    v_mfma_f32_16x16x32_bf16 v[116:119], v[172:175], v[180:183], v[116:119]
    v_mfma_f32_16x16x32_bf16 v[120:123], v[172:175], v[184:187], v[120:123]
    v_mfma_f32_16x16x32_bf16 v[124:127], v[172:175], v[188:191], v[124:127]
    s_waitcnt lgkmcnt(0)
    v_mfma_f32_16x16x32_bf16 v[64:67], v[128:131], v[144:147], v[64:67]
    ds_read_b128 v[160:163], v17 offset:0
    v_mfma_f32_16x16x32_bf16 v[68:71], v[128:131], v[148:151], v[68:71]
    ds_read_b128 v[176:179], v19 offset:16384
    v_mfma_f32_16x16x32_bf16 v[72:75], v[128:131], v[152:155], v[72:75]
    v_mfma_f32_16x16x32_bf16 v[76:79], v[128:131], v[156:159], v[76:79]
    ds_read_b128 v[180:183], v19 offset:18432
    v_mfma_f32_16x16x32_bf16 v[80:83], v[132:135], v[144:147], v[80:83]
    ds_read_b128 v[184:187], v19 offset:20480
    v_mfma_f32_16x16x32_bf16 v[84:87], v[132:135], v[148:151], v[84:87]
    v_mfma_f32_16x16x32_bf16 v[88:91], v[132:135], v[152:155], v[88:91]
    ds_read_b128 v[188:191], v19 offset:22528
    v_mfma_f32_16x16x32_bf16 v[92:95], v[132:135], v[156:159], v[92:95]
    ds_read_b128 v[164:167], v17 offset:2048
    v_mfma_f32_16x16x32_bf16 v[96:99], v[136:139], v[144:147], v[96:99]
    v_mfma_f32_16x16x32_bf16 v[100:103], v[136:139], v[148:151], v[100:103]
    ds_read_b128 v[168:171], v17 offset:4096
    v_mfma_f32_16x16x32_bf16 v[104:107], v[136:139], v[152:155], v[104:107]
    ds_read_b128 v[172:175], v17 offset:6144
    v_mfma_f32_16x16x32_bf16 v[108:111], v[136:139], v[156:159], v[108:111]
    v_mfma_f32_16x16x32_bf16 v[112:115], v[140:143], v[144:147], v[112:115]
    v_mfma_f32_16x16x32_bf16 v[116:119], v[140:143], v[148:151], v[116:119]
    v_mfma_f32_16x16x32_bf16 v[120:123], v[140:143], v[152:155], v[120:123]
    v_mfma_f32_16x16x32_bf16 v[124:127], v[140:143], v[156:159], v[124:127]
    s_waitcnt lgkmcnt(0) vmcnt(0)
    v_mfma_f32_16x16x32_bf16 v[64:67], v[160:163], v[176:179], v[64:67]
    v_mfma_f32_16x16x32_bf16 v[68:71], v[160:163], v[180:183], v[68:71]
    v_mfma_f32_16x16x32_bf16 v[72:75], v[160:163], v[184:187], v[72:75]
    v_mfma_f32_16x16x32_bf16 v[76:79], v[160:163], v[188:191], v[76:79]
    v_mfma_f32_16x16x32_bf16 v[80:83], v[164:167], v[176:179], v[80:83]
    v_mfma_f32_16x16x32_bf16 v[84:87], v[164:167], v[180:183], v[84:87]
    v_mfma_f32_16x16x32_bf16 v[88:91], v[164:167], v[184:187], v[88:91]
    v_mfma_f32_16x16x32_bf16 v[92:95], v[164:167], v[188:191], v[92:95]
    v_mfma_f32_16x16x32_bf16 v[96:99], v[168:171], v[176:179], v[96:99]
    v_mfma_f32_16x16x32_bf16 v[100:103], v[168:171], v[180:183], v[100:103]
    v_mfma_f32_16x16x32_bf16 v[104:107], v[168:171], v[184:187], v[104:107]
    v_mfma_f32_16x16x32_bf16 v[108:111], v[168:171], v[188:191], v[108:111]
    v_mfma_f32_16x16x32_bf16 v[112:115], v[172:175], v[176:179], v[112:115]
    v_mfma_f32_16x16x32_bf16 v[116:119], v[172:175], v[180:183], v[116:119]
    v_mfma_f32_16x16x32_bf16 v[120:123], v[172:175], v[184:187], v[120:123]
    v_mfma_f32_16x16x32_bf16 v[124:127], v[172:175], v[188:191], v[124:127]
    s_mov_b32 s44, 0
    s_mov_b32 s45, 4096
    s_mov_b32 s46, 8192
    s_mov_b32 s47, 12288
    v_mov_b32 v61, s93
    v_mov_b32 v63, s93
    v_and_b32 v216, 31, v24
    v_lshlrev_b32 v216, 2, v216
    v_add_u32 v216, 73728, v216
    v_mov_b32 v218, 0
    ds_write_b32 v216, v218
    v_pk_fma_f32 v[16:17], v[30:31], v[72:73], v[66:67] op_sel:[0,0,0] op_sel_hi:[0,1,1] neg_lo:[1,0,0] neg_hi:[1,0,0]
    v_pk_fma_f32 v[18:19], v[30:31], v[64:65], v[74:75] op_sel:[0,0,0] op_sel_hi:[0,1,1]
    v_pk_fma_f32 v[8:9], v[28:29], v[64:65], v[16:17] op_sel:[0,0,0] op_sel_hi:[0,1,1]
    v_pk_fma_f32 v[10:11], v[28:29], v[72:73], v[18:19] op_sel:[0,0,0] op_sel_hi:[0,1,1]
    v_pk_fma_f32 v[20:21], v[30:31], v[76:77], v[70:71] op_sel:[1,0,0] op_sel_hi:[1,1,1] neg_lo:[1,0,0] neg_hi:[1,0,0]
    v_pk_fma_f32 v[22:23], v[30:31], v[68:69], v[78:79] op_sel:[1,0,0] op_sel_hi:[1,1,1]
    v_pk_fma_f32 v[12:13], v[28:29], v[68:69], v[20:21] op_sel:[1,0,0] op_sel_hi:[1,1,1]
    v_pk_fma_f32 v[14:15], v[28:29], v[76:77], v[22:23] op_sel:[1,0,0] op_sel_hi:[1,1,1]
    v_pk_fma_f32 v[16:17], v[30:31], v[10:11], v[80:81] op_sel:[0,0,0] op_sel_hi:[0,1,1] neg_lo:[1,0,0] neg_hi:[1,0,0]
    v_pk_fma_f32 v[18:19], v[30:31], v[8:9], v[88:89] op_sel:[0,0,0] op_sel_hi:[0,1,1]
    v_pk_fma_f32 v[8:9], v[28:29], v[8:9], v[16:17] op_sel:[0,0,0] op_sel_hi:[0,1,1]
    v_pk_fma_f32 v[10:11], v[28:29], v[10:11], v[18:19] op_sel:[0,0,0] op_sel_hi:[0,1,1]
    v_pk_fma_f32 v[20:21], v[30:31], v[14:15], v[84:85] op_sel:[1,0,0] op_sel_hi:[1,1,1] neg_lo:[1,0,0] neg_hi:[1,0,0]
    v_pk_fma_f32 v[22:23], v[30:31], v[12:13], v[92:93] op_sel:[1,0,0] op_sel_hi:[1,1,1]
    v_pk_fma_f32 v[12:13], v[28:29], v[12:13], v[20:21] op_sel:[1,0,0] op_sel_hi:[1,1,1]
    v_pk_fma_f32 v[14:15], v[28:29], v[14:15], v[22:23] op_sel:[1,0,0] op_sel_hi:[1,1,1]
    v_pk_fma_f32 v[16:17], v[30:31], v[10:11], v[82:83] op_sel:[0,0,0] op_sel_hi:[0,1,1] neg_lo:[1,0,0] neg_hi:[1,0,0]
    v_pk_fma_f32 v[18:19], v[30:31], v[8:9], v[90:91] op_sel:[0,0,0] op_sel_hi:[0,1,1]
    v_pk_fma_f32 v[8:9], v[28:29], v[8:9], v[16:17] op_sel:[0,0,0] op_sel_hi:[0,1,1]
    v_pk_fma_f32 v[10:11], v[28:29], v[10:11], v[18:19] op_sel:[0,0,0] op_sel_hi:[0,1,1]
    v_pk_fma_f32 v[20:21], v[30:31], v[14:15], v[86:87] op_sel:[1,0,0] op_sel_hi:[1,1,1] neg_lo:[1,0,0] neg_hi:[1,0,0]
    v_pk_fma_f32 v[22:23], v[30:31], v[12:13], v[94:95] op_sel:[1,0,0] op_sel_hi:[1,1,1]
    v_pk_fma_f32 v[12:13], v[28:29], v[12:13], v[20:21] op_sel:[1,0,0] op_sel_hi:[1,1,1]
    v_pk_fma_f32 v[14:15], v[28:29], v[14:15], v[22:23] op_sel:[1,0,0] op_sel_hi:[1,1,1]
    v_pk_fma_f32 v[16:17], v[30:31], v[10:11], v[96:97] op_sel:[0,0,0] op_sel_hi:[0,1,1] neg_lo:[1,0,0] neg_hi:[1,0,0]
    v_pk_fma_f32 v[18:19], v[30:31], v[8:9], v[104:105] op_sel:[0,0,0] op_sel_hi:[0,1,1]
    v_pk_fma_f32 v[8:9], v[28:29], v[8:9], v[16:17] op_sel:[0,0,0] op_sel_hi:[0,1,1]
    v_pk_fma_f32 v[10:11], v[28:29], v[10:11], v[18:19] op_sel:[0,0,0] op_sel_hi:[0,1,1]
    v_pk_fma_f32 v[20:21], v[30:31], v[14:15], v[100:101] op_sel:[1,0,0] op_sel_hi:[1,1,1] neg_lo:[1,0,0] neg_hi:[1,0,0]
    v_pk_fma_f32 v[22:23], v[30:31], v[12:13], v[108:109] op_sel:[1,0,0] op_sel_hi:[1,1,1]
    v_pk_fma_f32 v[12:13], v[28:29], v[12:13], v[20:21] op_sel:[1,0,0] op_sel_hi:[1,1,1]
    v_pk_fma_f32 v[14:15], v[28:29], v[14:15], v[22:23] op_sel:[1,0,0] op_sel_hi:[1,1,1]
    v_pk_fma_f32 v[16:17], v[30:31], v[10:11], v[98:99] op_sel:[0,0,0] op_sel_hi:[0,1,1] neg_lo:[1,0,0] neg_hi:[1,0,0]
    v_pk_fma_f32 v[18:19], v[30:31], v[8:9], v[106:107] op_sel:[0,0,0] op_sel_hi:[0,1,1]
    v_pk_fma_f32 v[8:9], v[28:29], v[8:9], v[16:17] op_sel:[0,0,0] op_sel_hi:[0,1,1]
    v_pk_fma_f32 v[10:11], v[28:29], v[10:11], v[18:19] op_sel:[0,0,0] op_sel_hi:[0,1,1]
    v_pk_fma_f32 v[20:21], v[30:31], v[14:15], v[102:103] op_sel:[1,0,0] op_sel_hi:[1,1,1] neg_lo:[1,0,0] neg_hi:[1,0,0]
    v_pk_fma_f32 v[22:23], v[30:31], v[12:13], v[110:111] op_sel:[1,0,0] op_sel_hi:[1,1,1]
    v_pk_fma_f32 v[12:13], v[28:29], v[12:13], v[20:21] op_sel:[1,0,0] op_sel_hi:[1,1,1]
    v_pk_fma_f32 v[14:15], v[28:29], v[14:15], v[22:23] op_sel:[1,0,0] op_sel_hi:[1,1,1]
    v_pk_fma_f32 v[16:17], v[30:31], v[10:11], v[112:113] op_sel:[0,0,0] op_sel_hi:[0,1,1] neg_lo:[1,0,0] neg_hi:[1,0,0]
    v_pk_fma_f32 v[18:19], v[30:31], v[8:9], v[120:121] op_sel:[0,0,0] op_sel_hi:[0,1,1]
    v_pk_fma_f32 v[8:9], v[28:29], v[8:9], v[16:17] op_sel:[0,0,0] op_sel_hi:[0,1,1]
    v_pk_fma_f32 v[10:11], v[28:29], v[10:11], v[18:19] op_sel:[0,0,0] op_sel_hi:[0,1,1]
    v_pk_fma_f32 v[20:21], v[30:31], v[14:15], v[116:117] op_sel:[1,0,0] op_sel_hi:[1,1,1] neg_lo:[1,0,0] neg_hi:[1,0,0]
    v_pk_fma_f32 v[22:23], v[30:31], v[12:13], v[124:125] op_sel:[1,0,0] op_sel_hi:[1,1,1]
    v_pk_fma_f32 v[12:13], v[28:29], v[12:13], v[20:21] op_sel:[1,0,0] op_sel_hi:[1,1,1]
    v_pk_fma_f32 v[14:15], v[28:29], v[14:15], v[22:23] op_sel:[1,0,0] op_sel_hi:[1,1,1]
    v_pk_fma_f32 v[16:17], v[30:31], v[10:11], v[114:115] op_sel:[0,0,0] op_sel_hi:[0,1,1] neg_lo:[1,0,0] neg_hi:[1,0,0]
    v_pk_fma_f32 v[18:19], v[30:31], v[8:9], v[122:123] op_sel:[0,0,0] op_sel_hi:[0,1,1]
    v_pk_fma_f32 v[8:9], v[28:29], v[8:9], v[16:17] op_sel:[0,0,0] op_sel_hi:[0,1,1]
    v_pk_fma_f32 v[10:11], v[28:29], v[10:11], v[18:19] op_sel:[0,0,0] op_sel_hi:[0,1,1]
    v_pk_fma_f32 v[20:21], v[30:31], v[14:15], v[118:119] op_sel:[1,0,0] op_sel_hi:[1,1,1] neg_lo:[1,0,0] neg_hi:[1,0,0]
    v_pk_fma_f32 v[22:23], v[30:31], v[12:13], v[126:127] op_sel:[1,0,0] op_sel_hi:[1,1,1]
    v_pk_fma_f32 v[12:13], v[28:29], v[12:13], v[20:21] op_sel:[1,0,0] op_sel_hi:[1,1,1]
    v_pk_fma_f32 v[14:15], v[28:29], v[14:15], v[22:23] op_sel:[1,0,0] op_sel_hi:[1,1,1]
    v_fma_f32 v56, -v38, v10, v9
    v_fma_f32 v58, v38, v8, v11
    v_fma_f32 v57, -v39, v14, v13
    v_fma_f32 v59, v39, v12, v15
    v_fma_f32 v56, v36, v8, v56
    v_fma_f32 v58, v36, v10, v58
    v_fma_f32 v57, v37, v12, v57
    v_fma_f32 v59, v37, v14, v59
    ds_write_b128 v192, v[56:59]
    s_waitcnt lgkmcnt(0)
    s_barrier
    ds_read_b128 v[160:163], v193 offset:0
    ds_read_b128 v[164:167], v193 offset:512
    ds_read_b128 v[168:171], v193 offset:1024
    ds_read_b128 v[172:175], v193 offset:1536
    ds_read_b128 v[176:179], v193 offset:2048
    ds_read_b128 v[180:183], v193 offset:2560
    ds_read_b128 v[184:187], v193 offset:3072
    ds_read_b128 v[188:191], v193 offset:3584
    s_waitcnt lgkmcnt(6)
    v_pk_fma_f32 v[164:165], v[42:43], v[162:163], v[164:165] op_sel:[0,0,0] op_sel_hi:[1,1,1] neg_lo:[1,0,0] neg_hi:[1,0,0]
    v_pk_fma_f32 v[166:167], v[42:43], v[160:161], v[166:167] op_sel:[0,0,0] op_sel_hi:[1,1,1]
    v_pk_fma_f32 v[164:165], v[40:41], v[160:161], v[164:165] op_sel:[0,0,0] op_sel_hi:[1,1,1]
    v_pk_fma_f32 v[166:167], v[40:41], v[162:163], v[166:167] op_sel:[0,0,0] op_sel_hi:[1,1,1]
    s_waitcnt lgkmcnt(5)
    v_pk_fma_f32 v[168:169], v[42:43], v[166:167], v[168:169] op_sel:[0,0,0] op_sel_hi:[1,1,1] neg_lo:[1,0,0] neg_hi:[1,0,0]
    v_pk_fma_f32 v[170:171], v[42:43], v[164:165], v[170:171] op_sel:[0,0,0] op_sel_hi:[1,1,1]
    v_pk_fma_f32 v[168:169], v[40:41], v[164:165], v[168:169] op_sel:[0,0,0] op_sel_hi:[1,1,1]
    v_pk_fma_f32 v[170:171], v[40:41], v[166:167], v[170:171] op_sel:[0,0,0] op_sel_hi:[1,1,1]
    s_waitcnt lgkmcnt(4)
    v_pk_fma_f32 v[172:173], v[42:43], v[170:171], v[172:173] op_sel:[0,0,0] op_sel_hi:[1,1,1] neg_lo:[1,0,0] neg_hi:[1,0,0]
    v_pk_fma_f32 v[174:175], v[42:43], v[168:169], v[174:175] op_sel:[0,0,0] op_sel_hi:[1,1,1]
    v_pk_fma_f32 v[172:173], v[40:41], v[168:169], v[172:173] op_sel:[0,0,0] op_sel_hi:[1,1,1]
    v_pk_fma_f32 v[174:175], v[40:41], v[170:171], v[174:175] op_sel:[0,0,0] op_sel_hi:[1,1,1]
    s_waitcnt lgkmcnt(3)
    v_pk_fma_f32 v[176:177], v[42:43], v[174:175], v[176:177] op_sel:[0,0,0] op_sel_hi:[1,1,1] neg_lo:[1,0,0] neg_hi:[1,0,0]
    v_pk_fma_f32 v[178:179], v[42:43], v[172:173], v[178:179] op_sel:[0,0,0] op_sel_hi:[1,1,1]
    v_pk_fma_f32 v[176:177], v[40:41], v[172:173], v[176:177] op_sel:[0,0,0] op_sel_hi:[1,1,1]
    v_pk_fma_f32 v[178:179], v[40:41], v[174:175], v[178:179] op_sel:[0,0,0] op_sel_hi:[1,1,1]
    s_waitcnt lgkmcnt(2)
    v_pk_fma_f32 v[180:181], v[42:43], v[178:179], v[180:181] op_sel:[0,0,0] op_sel_hi:[1,1,1] neg_lo:[1,0,0] neg_hi:[1,0,0]
    v_pk_fma_f32 v[182:183], v[42:43], v[176:177], v[182:183] op_sel:[0,0,0] op_sel_hi:[1,1,1]
    v_pk_fma_f32 v[180:181], v[40:41], v[176:177], v[180:181] op_sel:[0,0,0] op_sel_hi:[1,1,1]
    v_pk_fma_f32 v[182:183], v[40:41], v[178:179], v[182:183] op_sel:[0,0,0] op_sel_hi:[1,1,1]
    s_waitcnt lgkmcnt(1)
    v_pk_fma_f32 v[184:185], v[42:43], v[182:183], v[184:185] op_sel:[0,0,0] op_sel_hi:[1,1,1] neg_lo:[1,0,0] neg_hi:[1,0,0]
    v_pk_fma_f32 v[186:187], v[42:43], v[180:181], v[186:187] op_sel:[0,0,0] op_sel_hi:[1,1,1]
    v_pk_fma_f32 v[184:185], v[40:41], v[180:181], v[184:185] op_sel:[0,0,0] op_sel_hi:[1,1,1]
    v_pk_fma_f32 v[186:187], v[40:41], v[182:183], v[186:187] op_sel:[0,0,0] op_sel_hi:[1,1,1]
    s_waitcnt lgkmcnt(0)
    v_pk_fma_f32 v[188:189], v[42:43], v[186:187], v[188:189] op_sel:[0,0,0] op_sel_hi:[1,1,1] neg_lo:[1,0,0] neg_hi:[1,0,0]
    v_pk_fma_f32 v[190:191], v[42:43], v[184:185], v[190:191] op_sel:[0,0,0] op_sel_hi:[1,1,1]
    v_pk_fma_f32 v[188:189], v[40:41], v[184:185], v[188:189] op_sel:[0,0,0] op_sel_hi:[1,1,1]
    v_pk_fma_f32 v[190:191], v[40:41], v[186:187], v[190:191] op_sel:[0,0,0] op_sel_hi:[1,1,1]
    v_cndmask_b32 v60, v188, v189, s[84:85]
    v_cndmask_b32 v62, v190, v191, s[84:85]
    s_cmp_lg_u32 s19, 0
    s_cbranch_scc1 L_nopub
    s_mov_b32 exec_hi, 0
    buffer_store_dwordx4 v[60:63], v27, s[24:27], 0 offen sc1
    s_mov_b32 exec_hi, -1
L_nopub:
    v_cndmask_b32 v16, 0, v172, s[98:99]
    v_cndmask_b32 v17, v160, v176, s[98:99]
    v_cndmask_b32 v18, v164, v180, s[98:99]
    v_cndmask_b32 v19, v168, v184, s[98:99]
    v_cndmask_b32 v16, v16, v17, s[84:85]
    v_cndmask_b32 v18, v18, v19, s[84:85]
    v_cndmask_b32 v216, v16, v18, s[86:87]
    v_cndmask_b32 v16, 0, v173, s[98:99]
    v_cndmask_b32 v17, v161, v177, s[98:99]
    v_cndmask_b32 v18, v165, v181, s[98:99]
    v_cndmask_b32 v19, v169, v185, s[98:99]
    v_cndmask_b32 v16, v16, v17, s[84:85]
    v_cndmask_b32 v18, v18, v19, s[84:85]
    v_cndmask_b32 v217, v16, v18, s[86:87]
    v_cndmask_b32 v16, 0, v174, s[98:99]
    v_cndmask_b32 v17, v162, v178, s[98:99]
    v_cndmask_b32 v18, v166, v182, s[98:99]
    v_cndmask_b32 v19, v170, v186, s[98:99]
    v_cndmask_b32 v16, v16, v17, s[84:85]
    v_cndmask_b32 v18, v18, v19, s[84:85]
    v_cndmask_b32 v218, v16, v18, s[86:87]
    v_cndmask_b32 v16, 0, v175, s[98:99]
    v_cndmask_b32 v17, v163, v179, s[98:99]
    v_cndmask_b32 v18, v167, v183, s[98:99]
    v_cndmask_b32 v19, v171, v187, s[98:99]
    v_cndmask_b32 v16, v16, v17, s[84:85]
    v_cndmask_b32 v18, v18, v19, s[84:85]
    v_cndmask_b32 v219, v16, v18, s[86:87]
    v_mov_b32 v16, v216
    v_mov_b32 v18, v218
    v_fma_f32 v17, -v38, v218, v8
    v_fma_f32 v19, v38, v216, v10
    v_fma_f32 v17, v36, v216, v17
    v_fma_f32 v19, v36, v218, v19
    v_pk_mul_f32 v[56:57], v[32:33], v[16:17] op_sel:[0,0] op_sel_hi:[0,1]
    v_pk_mul_f32 v[58:59], v[32:33], v[18:19] op_sel:[0,0] op_sel_hi:[0,1]
    v_pk_fma_f32 v[56:57], v[34:35], v[18:19], v[56:57] op_sel:[0,0,0] op_sel_hi:[0,1,1] neg_lo:[1,0,0] neg_hi:[1,0,0]
    v_pk_fma_f32 v[58:59], v[34:35], v[16:17], v[58:59] op_sel:[0,0,0] op_sel_hi:[0,1,1]
    v_mov_b32 v16, v217
    v_mov_b32 v18, v219
    v_fma_f32 v17, -v39, v219, v12
    v_fma_f32 v19, v39, v217, v14
    v_fma_f32 v17, v37, v217, v17
    v_fma_f32 v19, v37, v219, v19
    v_pk_mul_f32 v[60:61], v[32:33], v[16:17] op_sel:[1,0] op_sel_hi:[1,1]
    v_pk_mul_f32 v[62:63], v[32:33], v[18:19] op_sel:[1,0] op_sel_hi:[1,1]
    v_pk_fma_f32 v[60:61], v[34:35], v[18:19], v[60:61] op_sel:[1,0,0] op_sel_hi:[1,1,1] neg_lo:[1,0,0] neg_hi:[1,0,0]
    v_pk_fma_f32 v[62:63], v[34:35], v[16:17], v[62:63] op_sel:[1,0,0] op_sel_hi:[1,1,1]
    v_pk_mul_f32 v[128:129], v[32:33], v[72:73] op_sel:[0,0] op_sel_hi:[0,1]
    v_pk_fma_f32 v[128:129], v[34:35], v[64:65], v[128:129] op_sel:[0,0,0] op_sel_hi:[0,1,1]
    v_pk_mul_f32 v[64:65], v[32:33], v[64:65] op_sel:[0,0] op_sel_hi:[0,1]
    v_pk_fma_f32 v[64:65], v[34:35], v[72:73], v[64:65] op_sel:[0,0,0] op_sel_hi:[0,1,1] neg_lo:[1,0,0] neg_hi:[1,0,0]
    v_pk_mul_f32 v[144:145], v[32:33], v[76:77] op_sel:[1,0] op_sel_hi:[1,1]
    v_pk_fma_f32 v[144:145], v[34:35], v[68:69], v[144:145] op_sel:[1,0,0] op_sel_hi:[1,1,1]
    v_pk_mul_f32 v[68:69], v[32:33], v[68:69] op_sel:[1,0] op_sel_hi:[1,1]
    v_pk_fma_f32 v[68:69], v[34:35], v[76:77], v[68:69] op_sel:[1,0,0] op_sel_hi:[1,1,1] neg_lo:[1,0,0] neg_hi:[1,0,0]
    v_pk_mul_f32 v[130:131], v[32:33], v[74:75] op_sel:[0,0] op_sel_hi:[0,1]
    v_pk_fma_f32 v[130:131], v[34:35], v[66:67], v[130:131] op_sel:[0,0,0] op_sel_hi:[0,1,1]
    v_pk_mul_f32 v[66:67], v[32:33], v[66:67] op_sel:[0,0] op_sel_hi:[0,1]
    v_pk_fma_f32 v[66:67], v[34:35], v[74:75], v[66:67] op_sel:[0,0,0] op_sel_hi:[0,1,1] neg_lo:[1,0,0] neg_hi:[1,0,0]
    buffer_load_dwordx4 v[160:163], v194, s[24:27], s44 offen offset:0 sc1
    buffer_load_dwordx4 v[164:167], v194, s[24:27], s45 offen offset:0 sc1
    buffer_load_dwordx4 v[168:171], v194, s[24:27], s46 offen offset:0 sc1
    buffer_load_dwordx4 v[172:175], v194, s[24:27], s47 offen offset:0 sc1
    buffer_load_dwordx4 v[176:179], v194, s[24:27], s44 offen offset:256 sc1
    buffer_load_dwordx4 v[180:183], v194, s[24:27], s45 offen offset:256 sc1
    buffer_load_dwordx4 v[184:187], v194, s[24:27], s46 offen offset:256 sc1
    buffer_load_dwordx4 v[188:191], v194, s[24:27], s47 offen offset:256 sc1
    v_pk_mul_f32 v[146:147], v[32:33], v[78:79] op_sel:[1,0] op_sel_hi:[1,1]
    v_pk_fma_f32 v[146:147], v[34:35], v[70:71], v[146:147] op_sel:[1,0,0] op_sel_hi:[1,1,1]
    v_pk_mul_f32 v[70:71], v[32:33], v[70:71] op_sel:[1,0] op_sel_hi:[1,1]
    v_pk_fma_f32 v[70:71], v[34:35], v[78:79], v[70:71] op_sel:[1,0,0] op_sel_hi:[1,1,1] neg_lo:[1,0,0] neg_hi:[1,0,0]
    v_pk_mul_f32 v[132:133], v[32:33], v[88:89] op_sel:[0,0] op_sel_hi:[0,1]
    v_pk_fma_f32 v[132:133], v[34:35], v[80:81], v[132:133] op_sel:[0,0,0] op_sel_hi:[0,1,1]
    v_pk_mul_f32 v[80:81], v[32:33], v[80:81] op_sel:[0,0] op_sel_hi:[0,1]
    v_pk_fma_f32 v[80:81], v[34:35], v[88:89], v[80:81] op_sel:[0,0,0] op_sel_hi:[0,1,1] neg_lo:[1,0,0] neg_hi:[1,0,0]
    v_pk_mul_f32 v[148:149], v[32:33], v[92:93] op_sel:[1,0] op_sel_hi:[1,1]
    v_pk_fma_f32 v[148:149], v[34:35], v[84:85], v[148:149] op_sel:[1,0,0] op_sel_hi:[1,1,1]
    v_pk_mul_f32 v[84:85], v[32:33], v[84:85] op_sel:[1,0] op_sel_hi:[1,1]
    v_pk_fma_f32 v[84:85], v[34:35], v[92:93], v[84:85] op_sel:[1,0,0] op_sel_hi:[1,1,1] neg_lo:[1,0,0] neg_hi:[1,0,0]
    v_pk_mul_f32 v[134:135], v[32:33], v[90:91] op_sel:[0,0] op_sel_hi:[0,1]
    v_pk_fma_f32 v[134:135], v[34:35], v[82:83], v[134:135] op_sel:[0,0,0] op_sel_hi:[0,1,1]
    v_pk_mul_f32 v[82:83], v[32:33], v[82:83] op_sel:[0,0] op_sel_hi:[0,1]
    v_pk_fma_f32 v[82:83], v[34:35], v[90:91], v[82:83] op_sel:[0,0,0] op_sel_hi:[0,1,1] neg_lo:[1,0,0] neg_hi:[1,0,0]
    v_pk_mul_f32 v[150:151], v[32:33], v[94:95] op_sel:[1,0] op_sel_hi:[1,1]
    v_pk_fma_f32 v[150:151], v[34:35], v[86:87], v[150:151] op_sel:[1,0,0] op_sel_hi:[1,1,1]
    v_pk_mul_f32 v[86:87], v[32:33], v[86:87] op_sel:[1,0] op_sel_hi:[1,1]
    v_pk_fma_f32 v[86:87], v[34:35], v[94:95], v[86:87] op_sel:[1,0,0] op_sel_hi:[1,1,1] neg_lo:[1,0,0] neg_hi:[1,0,0]
    v_pk_mul_f32 v[136:137], v[32:33], v[104:105] op_sel:[0,0] op_sel_hi:[0,1]
    v_pk_fma_f32 v[136:137], v[34:35], v[96:97], v[136:137] op_sel:[0,0,0] op_sel_hi:[0,1,1]
    v_pk_mul_f32 v[96:97], v[32:33], v[96:97] op_sel:[0,0] op_sel_hi:[0,1]
    v_pk_fma_f32 v[96:97], v[34:35], v[104:105], v[96:97] op_sel:[0,0,0] op_sel_hi:[0,1,1] neg_lo:[1,0,0] neg_hi:[1,0,0]
    v_pk_mul_f32 v[152:153], v[32:33], v[108:109] op_sel:[1,0] op_sel_hi:[1,1]
    v_pk_fma_f32 v[152:153], v[34:35], v[100:101], v[152:153] op_sel:[1,0,0] op_sel_hi:[1,1,1]
    v_pk_mul_f32 v[100:101], v[32:33], v[100:101] op_sel:[1,0] op_sel_hi:[1,1]
    v_pk_fma_f32 v[100:101], v[34:35], v[108:109], v[100:101] op_sel:[1,0,0] op_sel_hi:[1,1,1] neg_lo:[1,0,0] neg_hi:[1,0,0]
    v_pk_mul_f32 v[138:139], v[32:33], v[106:107] op_sel:[0,0] op_sel_hi:[0,1]
    v_pk_fma_f32 v[138:139], v[34:35], v[98:99], v[138:139] op_sel:[0,0,0] op_sel_hi:[0,1,1]
    v_pk_mul_f32 v[98:99], v[32:33], v[98:99] op_sel:[0,0] op_sel_hi:[0,1]
    v_pk_fma_f32 v[98:99], v[34:35], v[106:107], v[98:99] op_sel:[0,0,0] op_sel_hi:[0,1,1] neg_lo:[1,0,0] neg_hi:[1,0,0]
    v_pk_mul_f32 v[154:155], v[32:33], v[110:111] op_sel:[1,0] op_sel_hi:[1,1]
    v_pk_fma_f32 v[154:155], v[34:35], v[102:103], v[154:155] op_sel:[1,0,0] op_sel_hi:[1,1,1]
    v_pk_mul_f32 v[102:103], v[32:33], v[102:103] op_sel:[1,0] op_sel_hi:[1,1]
    v_pk_fma_f32 v[102:103], v[34:35], v[110:111], v[102:103] op_sel:[1,0,0] op_sel_hi:[1,1,1] neg_lo:[1,0,0] neg_hi:[1,0,0]
    v_pk_mul_f32 v[140:141], v[32:33], v[120:121] op_sel:[0,0] op_sel_hi:[0,1]
    v_pk_fma_f32 v[140:141], v[34:35], v[112:113], v[140:141] op_sel:[0,0,0] op_sel_hi:[0,1,1]
    v_pk_mul_f32 v[112:113], v[32:33], v[112:113] op_sel:[0,0] op_sel_hi:[0,1]
    v_pk_fma_f32 v[112:113], v[34:35], v[120:121], v[112:113] op_sel:[0,0,0] op_sel_hi:[0,1,1] neg_lo:[1,0,0] neg_hi:[1,0,0]
    v_pk_mul_f32 v[156:157], v[32:33], v[124:125] op_sel:[1,0] op_sel_hi:[1,1]
    v_pk_fma_f32 v[156:157], v[34:35], v[116:117], v[156:157] op_sel:[1,0,0] op_sel_hi:[1,1,1]
    v_pk_mul_f32 v[116:117], v[32:33], v[116:117] op_sel:[1,0] op_sel_hi:[1,1]
    v_pk_fma_f32 v[116:117], v[34:35], v[124:125], v[116:117] op_sel:[1,0,0] op_sel_hi:[1,1,1] neg_lo:[1,0,0] neg_hi:[1,0,0]
    v_pk_mul_f32 v[142:143], v[32:33], v[122:123] op_sel:[0,0] op_sel_hi:[0,1]
    v_pk_fma_f32 v[142:143], v[34:35], v[114:115], v[142:143] op_sel:[0,0,0] op_sel_hi:[0,1,1]
    v_pk_mul_f32 v[114:115], v[32:33], v[114:115] op_sel:[0,0] op_sel_hi:[0,1]
    v_pk_fma_f32 v[114:115], v[34:35], v[122:123], v[114:115] op_sel:[0,0,0] op_sel_hi:[0,1,1] neg_lo:[1,0,0] neg_hi:[1,0,0]
    v_pk_mul_f32 v[158:159], v[32:33], v[126:127] op_sel:[1,0] op_sel_hi:[1,1]
    v_pk_fma_f32 v[158:159], v[34:35], v[118:119], v[158:159] op_sel:[1,0,0] op_sel_hi:[1,1,1]
    v_pk_mul_f32 v[118:119], v[32:33], v[118:119] op_sel:[1,0] op_sel_hi:[1,1]
    v_pk_fma_f32 v[118:119], v[34:35], v[126:127], v[118:119] op_sel:[1,0,0] op_sel_hi:[1,1,1] neg_lo:[1,0,0] neg_hi:[1,0,0]
L_gchk:
    v_cmp_ne_u32 vcc, s93, v241
    s_nop 1
    s_cmp_eq_u64 vcc, 0
    s_cbranch_scc1 L_gok
    s_sub_u32 s96, s96, 1
    s_cbranch_scc1 L_gok
    buffer_load_dwordx2 v[240:241], v221, s[12:15], s57 offen sc1
    s_waitcnt vmcnt(0)
    s_branch L_gchk
L_gok:
    v_lshlrev_b32 v6, 2, v25
    v_lshlrev_b32 v7, 2, v26
    ds_bpermute_b32 v244, v6, v240 offset:0
    ds_bpermute_b32 v245, v6, v240 offset:16
    ds_bpermute_b32 v246, v6, v240 offset:32
    ds_bpermute_b32 v247, v6, v240 offset:48
    ds_bpermute_b32 v248, v6, v240 offset:64
    ds_bpermute_b32 v249, v6, v240 offset:80
    ds_bpermute_b32 v250, v6, v240 offset:96
    ds_bpermute_b32 v251, v6, v240 offset:112
    ds_bpermute_b32 v4, v7, v240 offset:0
    ds_bpermute_b32 v5, v7, v240 offset:64
    s_mov_b32 s10, 0xffff0000
    s_add_u32 m0, s23, 81920
    s_add_u32 s21, s55, 0
    s_and_b32 s21, s21, 15
    s_lshl_b32 s21, s21, 7
    buffer_load_dwordx4 v202, s[28:31], s21 offen offset:0  lds
    v_lshlrev_b32 v252, 16, v242
    v_and_b32 v253, s10, v242
    v_lshlrev_b32 v254, 16, v243
    v_and_b32 v255, s10, v243
    s_waitcnt lgkmcnt(0)
    v_sub_f32 v12, 1.0, v244
    v_cvt_pk_bf16_f32 v12, v12, v12
    v_lshlrev_b32 v12, 16, v12
    v_lshlrev_b32 v8, 16, v224
    v_and_b32 v9, s10, v224
    v_mul_f32 v10, v8, v252
    v_mul_f32 v11, v9, v253
    buffer_load_dwordx4 v203, s[28:31], s21 offen offset:1024  lds
    v_cvt_pk_bf16_f32 v10, v10, v11
    v_mul_f32 v8, v8, v12
    v_mul_f32 v9, v9, v12
    v_cvt_pk_bf16_f32 v8, v8, v9
    v_and_b32 v11, s10, v10
    v_lshlrev_b32 v10, 16, v10
    v_and_b32 v9, s10, v8
    v_lshlrev_b32 v8, 16, v8
    v_fma_f32 v72, v244, v10, v8
    v_fma_f32 v73, v244, v11, v9
    v_lshlrev_b32 v8, 16, v225
    v_and_b32 v9, s10, v225
    buffer_load_dwordx4 v204, s[28:31], s21 offen offset:2048  lds
    v_mul_f32 v10, v8, v254
    v_mul_f32 v11, v9, v255
    v_cvt_pk_bf16_f32 v10, v10, v11
    v_mul_f32 v8, v8, v12
    v_mul_f32 v9, v9, v12
    v_cvt_pk_bf16_f32 v8, v8, v9
    v_and_b32 v11, s10, v10
    v_lshlrev_b32 v10, 16, v10
    v_and_b32 v9, s10, v8
    v_lshlrev_b32 v8, 16, v8
    v_fma_f32 v74, v244, v10, v8
    v_fma_f32 v75, v244, v11, v9
    buffer_load_dwordx4 v205, s[28:31], s21 offen offset:3072  lds
    v_sub_f32 v12, 1.0, v245
    v_cvt_pk_bf16_f32 v12, v12, v12
    v_lshlrev_b32 v12, 16, v12
    v_lshlrev_b32 v8, 16, v226
    v_and_b32 v9, s10, v226
    v_mul_f32 v10, v8, v252
    v_mul_f32 v11, v9, v253
    v_cvt_pk_bf16_f32 v10, v10, v11
    v_mul_f32 v8, v8, v12
    v_mul_f32 v9, v9, v12
    v_cvt_pk_bf16_f32 v8, v8, v9
    v_and_b32 v11, s10, v10
    s_add_u32 m0, s23, 0
    s_add_u32 s21, s55, 1
    s_and_b32 s21, s21, 15
    s_lshl_b32 s21, s21, 7
    buffer_load_dwordx4 v202, s[28:31], s21 offen offset:0  lds
    v_lshlrev_b32 v10, 16, v10
    v_and_b32 v9, s10, v8
    v_lshlrev_b32 v8, 16, v8
    v_fma_f32 v76, v245, v10, v8
    v_fma_f32 v77, v245, v11, v9
    v_lshlrev_b32 v8, 16, v227
    v_and_b32 v9, s10, v227
    v_mul_f32 v10, v8, v254
    v_mul_f32 v11, v9, v255
    v_cvt_pk_bf16_f32 v10, v10, v11
    v_mul_f32 v8, v8, v12
    v_mul_f32 v9, v9, v12
    buffer_load_dwordx4 v203, s[28:31], s21 offen offset:1024  lds
    v_cvt_pk_bf16_f32 v8, v8, v9
    v_and_b32 v11, s10, v10
    v_lshlrev_b32 v10, 16, v10
    v_and_b32 v9, s10, v8
    v_lshlrev_b32 v8, 16, v8
    v_fma_f32 v78, v245, v10, v8
    v_fma_f32 v79, v245, v11, v9
    v_sub_f32 v12, 1.0, v246
    v_cvt_pk_bf16_f32 v12, v12, v12
    v_lshlrev_b32 v12, 16, v12
    v_lshlrev_b32 v8, 16, v228
    v_and_b32 v9, s10, v228
    buffer_load_dwordx4 v204, s[28:31], s21 offen offset:2048  lds
    v_mul_f32 v10, v8, v252
    v_mul_f32 v11, v9, v253
    v_cvt_pk_bf16_f32 v10, v10, v11
    v_mul_f32 v8, v8, v12
    v_mul_f32 v9, v9, v12
    v_cvt_pk_bf16_f32 v8, v8, v9
    v_and_b32 v11, s10, v10
    v_lshlrev_b32 v10, 16, v10
    v_and_b32 v9, s10, v8
    v_lshlrev_b32 v8, 16, v8
    v_fma_f32 v88, v246, v10, v8
    v_fma_f32 v89, v246, v11, v9
    buffer_load_dwordx4 v205, s[28:31], s21 offen offset:3072  lds
    v_lshlrev_b32 v8, 16, v229
    v_and_b32 v9, s10, v229
    v_mul_f32 v10, v8, v254
    v_mul_f32 v11, v9, v255
    v_cvt_pk_bf16_f32 v10, v10, v11
    v_mul_f32 v8, v8, v12
    v_mul_f32 v9, v9, v12
    v_cvt_pk_bf16_f32 v8, v8, v9
    v_and_b32 v11, s10, v10
    v_lshlrev_b32 v10, 16, v10
    v_and_b32 v9, s10, v8
    v_lshlrev_b32 v8, 16, v8
    s_add_u32 m0, s23, 16384
    s_add_u32 s21, s55, 2
    s_and_b32 s21, s21, 15
    s_lshl_b32 s21, s21, 7
    buffer_load_dwordx4 v202, s[28:31], s21 offen offset:0  lds
    v_fma_f32 v90, v246, v10, v8
    v_fma_f32 v91, v246, v11, v9
    v_sub_f32 v12, 1.0, v247
    v_cvt_pk_bf16_f32 v12, v12, v12
    v_lshlrev_b32 v12, 16, v12
    v_lshlrev_b32 v8, 16, v230
    v_and_b32 v9, s10, v230
    v_mul_f32 v10, v8, v252
    v_mul_f32 v11, v9, v253
    v_cvt_pk_bf16_f32 v10, v10, v11
    v_mul_f32 v8, v8, v12
    v_mul_f32 v9, v9, v12
    buffer_load_dwordx4 v203, s[28:31], s21 offen offset:1024  lds
    v_cvt_pk_bf16_f32 v8, v8, v9
    v_and_b32 v11, s10, v10
    v_lshlrev_b32 v10, 16, v10
    v_and_b32 v9, s10, v8
    v_lshlrev_b32 v8, 16, v8
    v_fma_f32 v92, v247, v10, v8
    v_fma_f32 v93, v247, v11, v9
    v_lshlrev_b32 v8, 16, v231
    v_and_b32 v9, s10, v231
    v_mul_f32 v10, v8, v254
    v_mul_f32 v11, v9, v255
    v_cvt_pk_bf16_f32 v10, v10, v11
    buffer_load_dwordx4 v204, s[28:31], s21 offen offset:2048  lds
    v_mul_f32 v8, v8, v12
    v_mul_f32 v9, v9, v12
    v_cvt_pk_bf16_f32 v8, v8, v9
    v_and_b32 v11, s10, v10
    v_lshlrev_b32 v10, 16, v10
    v_and_b32 v9, s10, v8
    v_lshlrev_b32 v8, 16, v8
    v_fma_f32 v94, v247, v10, v8
    v_fma_f32 v95, v247, v11, v9
    v_sub_f32 v12, 1.0, v248
    v_cvt_pk_bf16_f32 v12, v12, v12
    v_lshlrev_b32 v12, 16, v12
    buffer_load_dwordx4 v205, s[28:31], s21 offen offset:3072  lds
    v_lshlrev_b32 v8, 16, v232
    v_and_b32 v9, s10, v232
    v_mul_f32 v10, v8, v252
    v_mul_f32 v11, v9, v253
    v_cvt_pk_bf16_f32 v10, v10, v11
    v_mul_f32 v8, v8, v12
    v_mul_f32 v9, v9, v12
    v_cvt_pk_bf16_f32 v8, v8, v9
    v_and_b32 v11, s10, v10
    v_lshlrev_b32 v10, 16, v10
    v_and_b32 v9, s10, v8
    v_lshlrev_b32 v8, 16, v8
    v_fma_f32 v104, v248, v10, v8
    v_fma_f32 v105, v248, v11, v9
    v_lshlrev_b32 v8, 16, v233
    v_and_b32 v9, s10, v233
    v_mul_f32 v10, v8, v254
    v_mul_f32 v11, v9, v255
    v_cvt_pk_bf16_f32 v10, v10, v11
    v_mul_f32 v8, v8, v12
    v_mul_f32 v9, v9, v12
    v_cvt_pk_bf16_f32 v8, v8, v9
    v_and_b32 v11, s10, v10
    v_lshlrev_b32 v10, 16, v10
    v_and_b32 v9, s10, v8
    v_lshlrev_b32 v8, 16, v8
    v_fma_f32 v106, v248, v10, v8
    v_fma_f32 v107, v248, v11, v9
    v_sub_f32 v12, 1.0, v249
    v_cvt_pk_bf16_f32 v12, v12, v12
    v_lshlrev_b32 v12, 16, v12
    v_lshlrev_b32 v8, 16, v234
    v_and_b32 v9, s10, v234
    v_mul_f32 v10, v8, v252
    v_mul_f32 v11, v9, v253
    v_cvt_pk_bf16_f32 v10, v10, v11
    v_mul_f32 v8, v8, v12
    v_mul_f32 v9, v9, v12
    v_cvt_pk_bf16_f32 v8, v8, v9
    v_and_b32 v11, s10, v10
    v_lshlrev_b32 v10, 16, v10
    v_and_b32 v9, s10, v8
    v_lshlrev_b32 v8, 16, v8
    v_fma_f32 v108, v249, v10, v8
    v_fma_f32 v109, v249, v11, v9
    v_lshlrev_b32 v8, 16, v235
    v_and_b32 v9, s10, v235
    v_mul_f32 v10, v8, v254
    v_mul_f32 v11, v9, v255
    v_cvt_pk_bf16_f32 v10, v10, v11
    v_mul_f32 v8, v8, v12
    v_mul_f32 v9, v9, v12
    v_cvt_pk_bf16_f32 v8, v8, v9
    v_and_b32 v11, s10, v10
    v_lshlrev_b32 v10, 16, v10
    v_and_b32 v9, s10, v8
    v_lshlrev_b32 v8, 16, v8
    v_fma_f32 v110, v249, v10, v8
    v_fma_f32 v111, v249, v11, v9
    v_sub_f32 v12, 1.0, v250
    v_cvt_pk_bf16_f32 v12, v12, v12
    v_lshlrev_b32 v12, 16, v12
    v_lshlrev_b32 v8, 16, v236
    v_and_b32 v9, s10, v236
    v_mul_f32 v10, v8, v252
    v_mul_f32 v11, v9, v253
    v_cvt_pk_bf16_f32 v10, v10, v11
    v_mul_f32 v8, v8, v12
    v_mul_f32 v9, v9, v12
    v_cvt_pk_bf16_f32 v8, v8, v9
    v_and_b32 v11, s10, v10
    v_lshlrev_b32 v10, 16, v10
    v_and_b32 v9, s10, v8
    v_lshlrev_b32 v8, 16, v8
    v_fma_f32 v120, v250, v10, v8
    v_fma_f32 v121, v250, v11, v9
    v_lshlrev_b32 v8, 16, v237
    v_and_b32 v9, s10, v237
    v_mul_f32 v10, v8, v254
    v_mul_f32 v11, v9, v255
    v_cvt_pk_bf16_f32 v10, v10, v11
    v_mul_f32 v8, v8, v12
    v_mul_f32 v9, v9, v12
    v_cvt_pk_bf16_f32 v8, v8, v9
    v_and_b32 v11, s10, v10
    v_lshlrev_b32 v10, 16, v10
    v_and_b32 v9, s10, v8
    v_lshlrev_b32 v8, 16, v8
    v_fma_f32 v122, v250, v10, v8
    v_fma_f32 v123, v250, v11, v9
    v_sub_f32 v12, 1.0, v251
    v_cvt_pk_bf16_f32 v12, v12, v12
    v_lshlrev_b32 v12, 16, v12
    v_lshlrev_b32 v8, 16, v238
    v_and_b32 v9, s10, v238
    v_mul_f32 v10, v8, v252
    v_mul_f32 v11, v9, v253
    v_cvt_pk_bf16_f32 v10, v10, v11
    v_mul_f32 v8, v8, v12
    v_mul_f32 v9, v9, v12
    v_cvt_pk_bf16_f32 v8, v8, v9
    v_and_b32 v11, s10, v10
    v_lshlrev_b32 v10, 16, v10
    v_and_b32 v9, s10, v8
    v_lshlrev_b32 v8, 16, v8
    v_fma_f32 v124, v251, v10, v8
    v_fma_f32 v125, v251, v11, v9
    v_lshlrev_b32 v8, 16, v239
    v_and_b32 v9, s10, v239
    v_mul_f32 v10, v8, v254
    v_mul_f32 v11, v9, v255
    v_cvt_pk_bf16_f32 v10, v10, v11
    v_mul_f32 v8, v8, v12
    v_mul_f32 v9, v9, v12
    v_cvt_pk_bf16_f32 v8, v8, v9
    v_and_b32 v11, s10, v10
    v_lshlrev_b32 v10, 16, v10
    v_and_b32 v9, s10, v8
    v_lshlrev_b32 v8, 16, v8
    v_fma_f32 v126, v251, v10, v8
    v_fma_f32 v127, v251, v11, v9
    s_waitcnt vmcnt(12)
L_poll:
    v_xor_b32 v161, v161, v198
    v_xor_b32 v163, v163, v198
    v_xor_b32 v165, v165, v199
    v_xor_b32 v167, v167, v199
    v_xor_b32 v169, v169, v200
    v_xor_b32 v171, v171, v200
    v_xor_b32 v173, v173, v201
    v_xor_b32 v175, v175, v201
    v_xor_b32 v177, v177, v198
    v_xor_b32 v179, v179, v198
    v_xor_b32 v181, v181, v199
    v_xor_b32 v183, v183, v199
    v_xor_b32 v185, v185, v200
    v_xor_b32 v187, v187, v200
    v_xor_b32 v189, v189, v201
    v_xor_b32 v191, v191, v201
    v_or3_b32 v214, v161, v163, v165
    v_or3_b32 v214, v214, v167, v169
    v_or3_b32 v214, v214, v171, v173
    v_or3_b32 v214, v214, v175, v177
    v_or3_b32 v214, v214, v179, v181
    v_or3_b32 v214, v214, v183, v185
    v_or3_b32 v214, v214, v187, v189
    v_or_b32 v214, v214, v191
    v_cmp_ne_u32 vcc, 0, v214
    s_nop 1
    s_cmp_eq_u64 vcc, 0
    s_cbranch_scc1 L_got
    s_sub_u32 s96, s96, 1
    s_cbranch_scc1 L_got
    s_sleep 2
    buffer_load_dwordx4 v[160:163], v194, s[24:27], s44 offen offset:0 sc1
    buffer_load_dwordx4 v[164:167], v194, s[24:27], s45 offen offset:0 sc1
    buffer_load_dwordx4 v[168:171], v194, s[24:27], s46 offen offset:0 sc1
    buffer_load_dwordx4 v[172:175], v194, s[24:27], s47 offen offset:0 sc1
    buffer_load_dwordx4 v[176:179], v194, s[24:27], s44 offen offset:256 sc1
    buffer_load_dwordx4 v[180:183], v194, s[24:27], s45 offen offset:256 sc1
    buffer_load_dwordx4 v[184:187], v194, s[24:27], s46 offen offset:256 sc1
    buffer_load_dwordx4 v[188:191], v194, s[24:27], s47 offen offset:256 sc1
    s_waitcnt vmcnt(0)
    s_branch L_poll
L_got:
    v_mov_b32 v6, 73728
    v_mov_b32 v7, 1
    s_mov_b64 exec, 1
    ds_add_u32 v6, v7 offset:76
    s_mov_b64 exec, -1
    v_fma_f32 v168, -v46, v174, v168
    v_fma_f32 v170, v46, v172, v170
    v_fma_f32 v168, v44, v172, v168
    v_fma_f32 v170, v44, v174, v170
    v_fma_f32 v184, -v47, v190, v184
    v_fma_f32 v186, v47, v188, v186
    v_fma_f32 v184, v45, v188, v184
    v_fma_f32 v186, v45, v190, v186
    v_fma_f32 v164, -v46, v170, v164
    v_fma_f32 v166, v46, v168, v166
    v_fma_f32 v164, v44, v168, v164
    v_fma_f32 v166, v44, v170, v166
    v_fma_f32 v180, -v47, v186, v180
    v_fma_f32 v182, v47, v184, v182
    v_fma_f32 v180, v45, v184, v180
    v_fma_f32 v182, v45, v186, v182
    v_fma_f32 v160, -v46, v166, v160
    v_fma_f32 v162, v46, v164, v162
    v_fma_f32 v160, v44, v164, v160
    v_fma_f32 v162, v44, v166, v162
    v_fma_f32 v176, -v47, v182, v176
    v_fma_f32 v178, v47, v180, v178
    v_fma_f32 v176, v45, v180, v176
    v_fma_f32 v178, v45, v182, v178
    v_mul_f32 v16, v48, v160
    v_mul_f32 v17, v48, v162
    v_fma_f32 v16, -v50, v162, v16
    v_fma_f32 v17, v50, v160, v17
    v_mul_f32 v18, v49, v176
    v_mul_f32 v19, v49, v178
    v_fma_f32 v18, -v51, v178, v18
    v_fma_f32 v19, v51, v176, v19
    v_mov_b32 v20, v16
    v_mov_b32 v21, v17
    v_mov_b32 v22, v18
    v_mov_b32 v23, v19
    s_nop 1
    v_permlane16_swap_b32 v16, v20
    v_permlane16_swap_b32 v17, v21
    v_permlane16_swap_b32 v18, v22
    v_permlane16_swap_b32 v19, v23
    s_nop 1
    v_add_f32 v16, v16, v20
    v_add_f32 v17, v17, v21
    v_add_f32 v18, v18, v22
    v_add_f32 v19, v19, v23
    v_mov_b32 v20, v16
    v_mov_b32 v21, v17
    v_mov_b32 v22, v18
    v_mov_b32 v23, v19
    s_nop 1
    v_permlane32_swap_b32 v16, v20
    v_permlane32_swap_b32 v17, v21
    v_permlane32_swap_b32 v18, v22
    v_permlane32_swap_b32 v19, v23
    s_nop 1
    v_add_f32 v16, v16, v20
    v_add_f32 v17, v17, v21
    v_add_f32 v18, v18, v22
    v_add_f32 v19, v19, v23
    v_pk_fma_f32 v[56:57], v[16:17], v[206:207], v[56:57] op_sel:[0,0,0] op_sel_hi:[0,1,1]
    v_pk_fma_f32 v[58:59], v[16:17], v[208:209], v[58:59] op_sel:[0,0,0] op_sel_hi:[0,1,1]
    v_pk_fma_f32 v[56:57], v[16:17], v[208:209], v[56:57] op_sel:[1,0,0] op_sel_hi:[1,1,1] neg_lo:[1,0,0] neg_hi:[1,0,0]
    v_pk_fma_f32 v[58:59], v[16:17], v[206:207], v[58:59] op_sel:[1,0,0] op_sel_hi:[1,1,1]
    v_pk_fma_f32 v[60:61], v[18:19], v[210:211], v[60:61] op_sel:[0,0,0] op_sel_hi:[0,1,1]
    v_pk_fma_f32 v[62:63], v[18:19], v[212:213], v[62:63] op_sel:[0,0,0] op_sel_hi:[0,1,1]
    v_pk_fma_f32 v[60:61], v[18:19], v[212:213], v[60:61] op_sel:[1,0,0] op_sel_hi:[1,1,1] neg_lo:[1,0,0] neg_hi:[1,0,0]
    v_pk_fma_f32 v[62:63], v[18:19], v[210:211], v[62:63] op_sel:[1,0,0] op_sel_hi:[1,1,1]
    v_pk_fma_f32 v[64:65], v[30:31], v[58:59], v[64:65] op_sel:[0,0,0] op_sel_hi:[0,1,1] neg_lo:[1,0,0] neg_hi:[1,0,0]
    v_pk_fma_f32 v[128:129], v[30:31], v[56:57], v[128:129] op_sel:[0,0,0] op_sel_hi:[0,1,1]
    v_pk_fma_f32 v[64:65], v[28:29], v[56:57], v[64:65] op_sel:[0,0,0] op_sel_hi:[0,1,1]
    v_pk_fma_f32 v[128:129], v[28:29], v[58:59], v[128:129] op_sel:[0,0,0] op_sel_hi:[0,1,1]
    v_pk_fma_f32 v[68:69], v[30:31], v[62:63], v[68:69] op_sel:[1,0,0] op_sel_hi:[1,1,1] neg_lo:[1,0,0] neg_hi:[1,0,0]
    v_pk_fma_f32 v[144:145], v[30:31], v[60:61], v[144:145] op_sel:[1,0,0] op_sel_hi:[1,1,1]
    v_pk_fma_f32 v[68:69], v[28:29], v[60:61], v[68:69] op_sel:[1,0,0] op_sel_hi:[1,1,1]
    v_pk_fma_f32 v[144:145], v[28:29], v[62:63], v[144:145] op_sel:[1,0,0] op_sel_hi:[1,1,1]
    v_pk_fma_f32 v[66:67], v[30:31], v[128:129], v[66:67] op_sel:[0,0,0] op_sel_hi:[0,1,1] neg_lo:[1,0,0] neg_hi:[1,0,0]
    v_pk_fma_f32 v[130:131], v[30:31], v[64:65], v[130:131] op_sel:[0,0,0] op_sel_hi:[0,1,1]
    v_pk_fma_f32 v[66:67], v[28:29], v[64:65], v[66:67] op_sel:[0,0,0] op_sel_hi:[0,1,1]
    v_pk_fma_f32 v[130:131], v[28:29], v[128:129], v[130:131] op_sel:[0,0,0] op_sel_hi:[0,1,1]
    v_pk_fma_f32 v[70:71], v[30:31], v[144:145], v[70:71] op_sel:[1,0,0] op_sel_hi:[1,1,1] neg_lo:[1,0,0] neg_hi:[1,0,0]
    v_pk_fma_f32 v[146:147], v[30:31], v[68:69], v[146:147] op_sel:[1,0,0] op_sel_hi:[1,1,1]
    v_pk_fma_f32 v[70:71], v[28:29], v[68:69], v[70:71] op_sel:[1,0,0] op_sel_hi:[1,1,1]
    v_pk_fma_f32 v[146:147], v[28:29], v[144:145], v[146:147] op_sel:[1,0,0] op_sel_hi:[1,1,1]
    v_cvt_pk_bf16_f32 v160, v64, v66
    v_cvt_pk_bf16_f32 v168, -v128, -v130
    v_cvt_pk_bf16_f32 v164, v65, v67
    v_cvt_pk_bf16_f32 v172, -v129, -v131
    v_cvt_pk_bf16_f32 v176, v68, v70
    v_cvt_pk_bf16_f32 v184, -v144, -v146
    v_cvt_pk_bf16_f32 v180, v69, v71
    v_cvt_pk_bf16_f32 v188, -v145, -v147
    v_pk_fma_f32 v[80:81], v[30:31], v[130:131], v[80:81] op_sel:[0,0,0] op_sel_hi:[0,1,1] neg_lo:[1,0,0] neg_hi:[1,0,0]
    v_pk_fma_f32 v[132:133], v[30:31], v[66:67], v[132:133] op_sel:[0,0,0] op_sel_hi:[0,1,1]
    v_pk_fma_f32 v[80:81], v[28:29], v[66:67], v[80:81] op_sel:[0,0,0] op_sel_hi:[0,1,1]
    v_pk_fma_f32 v[132:133], v[28:29], v[130:131], v[132:133] op_sel:[0,0,0] op_sel_hi:[0,1,1]
    v_pk_fma_f32 v[84:85], v[30:31], v[146:147], v[84:85] op_sel:[1,0,0] op_sel_hi:[1,1,1] neg_lo:[1,0,0] neg_hi:[1,0,0]
    v_pk_fma_f32 v[148:149], v[30:31], v[70:71], v[148:149] op_sel:[1,0,0] op_sel_hi:[1,1,1]
    v_pk_fma_f32 v[84:85], v[28:29], v[70:71], v[84:85] op_sel:[1,0,0] op_sel_hi:[1,1,1]
    v_pk_fma_f32 v[148:149], v[28:29], v[146:147], v[148:149] op_sel:[1,0,0] op_sel_hi:[1,1,1]
    v_pk_fma_f32 v[82:83], v[30:31], v[132:133], v[82:83] op_sel:[0,0,0] op_sel_hi:[0,1,1] neg_lo:[1,0,0] neg_hi:[1,0,0]
    v_pk_fma_f32 v[134:135], v[30:31], v[80:81], v[134:135] op_sel:[0,0,0] op_sel_hi:[0,1,1]
    v_pk_fma_f32 v[82:83], v[28:29], v[80:81], v[82:83] op_sel:[0,0,0] op_sel_hi:[0,1,1]
    v_pk_fma_f32 v[134:135], v[28:29], v[132:133], v[134:135] op_sel:[0,0,0] op_sel_hi:[0,1,1]
    v_pk_fma_f32 v[86:87], v[30:31], v[148:149], v[86:87] op_sel:[1,0,0] op_sel_hi:[1,1,1] neg_lo:[1,0,0] neg_hi:[1,0,0]
    v_pk_fma_f32 v[150:151], v[30:31], v[84:85], v[150:151] op_sel:[1,0,0] op_sel_hi:[1,1,1]
    v_pk_fma_f32 v[86:87], v[28:29], v[84:85], v[86:87] op_sel:[1,0,0] op_sel_hi:[1,1,1]
    v_pk_fma_f32 v[150:151], v[28:29], v[148:149], v[150:151] op_sel:[1,0,0] op_sel_hi:[1,1,1]
    v_cvt_pk_bf16_f32 v161, v80, v82
    v_cvt_pk_bf16_f32 v169, -v132, -v134
    v_cvt_pk_bf16_f32 v165, v81, v83
    v_cvt_pk_bf16_f32 v173, -v133, -v135
    v_cvt_pk_bf16_f32 v177, v84, v86
    v_cvt_pk_bf16_f32 v185, -v148, -v150
    v_cvt_pk_bf16_f32 v181, v85, v87
    v_cvt_pk_bf16_f32 v189, -v149, -v151
    v_pk_fma_f32 v[96:97], v[30:31], v[134:135], v[96:97] op_sel:[0,0,0] op_sel_hi:[0,1,1] neg_lo:[1,0,0] neg_hi:[1,0,0]
    v_pk_fma_f32 v[136:137], v[30:31], v[82:83], v[136:137] op_sel:[0,0,0] op_sel_hi:[0,1,1]
    v_pk_fma_f32 v[96:97], v[28:29], v[82:83], v[96:97] op_sel:[0,0,0] op_sel_hi:[0,1,1]
    v_pk_fma_f32 v[136:137], v[28:29], v[134:135], v[136:137] op_sel:[0,0,0] op_sel_hi:[0,1,1]
    v_pk_fma_f32 v[100:101], v[30:31], v[150:151], v[100:101] op_sel:[1,0,0] op_sel_hi:[1,1,1] neg_lo:[1,0,0] neg_hi:[1,0,0]
    v_pk_fma_f32 v[152:153], v[30:31], v[86:87], v[152:153] op_sel:[1,0,0] op_sel_hi:[1,1,1]
    v_pk_fma_f32 v[100:101], v[28:29], v[86:87], v[100:101] op_sel:[1,0,0] op_sel_hi:[1,1,1]
    v_pk_fma_f32 v[152:153], v[28:29], v[150:151], v[152:153] op_sel:[1,0,0] op_sel_hi:[1,1,1]
    v_pk_fma_f32 v[98:99], v[30:31], v[136:137], v[98:99] op_sel:[0,0,0] op_sel_hi:[0,1,1] neg_lo:[1,0,0] neg_hi:[1,0,0]
    v_pk_fma_f32 v[138:139], v[30:31], v[96:97], v[138:139] op_sel:[0,0,0] op_sel_hi:[0,1,1]
    v_pk_fma_f32 v[98:99], v[28:29], v[96:97], v[98:99] op_sel:[0,0,0] op_sel_hi:[0,1,1]
    v_pk_fma_f32 v[138:139], v[28:29], v[136:137], v[138:139] op_sel:[0,0,0] op_sel_hi:[0,1,1]
    v_pk_fma_f32 v[102:103], v[30:31], v[152:153], v[102:103] op_sel:[1,0,0] op_sel_hi:[1,1,1] neg_lo:[1,0,0] neg_hi:[1,0,0]
    v_pk_fma_f32 v[154:155], v[30:31], v[100:101], v[154:155] op_sel:[1,0,0] op_sel_hi:[1,1,1]
    v_pk_fma_f32 v[102:103], v[28:29], v[100:101], v[102:103] op_sel:[1,0,0] op_sel_hi:[1,1,1]
    v_pk_fma_f32 v[154:155], v[28:29], v[152:153], v[154:155] op_sel:[1,0,0] op_sel_hi:[1,1,1]
    v_cvt_pk_bf16_f32 v162, v96, v98
    v_cvt_pk_bf16_f32 v170, -v136, -v138
    v_cvt_pk_bf16_f32 v166, v97, v99
    v_cvt_pk_bf16_f32 v174, -v137, -v139
    v_cvt_pk_bf16_f32 v178, v100, v102
    v_cvt_pk_bf16_f32 v186, -v152, -v154
    v_cvt_pk_bf16_f32 v182, v101, v103
    v_cvt_pk_bf16_f32 v190, -v153, -v155
    v_pk_fma_f32 v[112:113], v[30:31], v[138:139], v[112:113] op_sel:[0,0,0] op_sel_hi:[0,1,1] neg_lo:[1,0,0] neg_hi:[1,0,0]
    v_pk_fma_f32 v[140:141], v[30:31], v[98:99], v[140:141] op_sel:[0,0,0] op_sel_hi:[0,1,1]
    v_pk_fma_f32 v[112:113], v[28:29], v[98:99], v[112:113] op_sel:[0,0,0] op_sel_hi:[0,1,1]
    v_pk_fma_f32 v[140:141], v[28:29], v[138:139], v[140:141] op_sel:[0,0,0] op_sel_hi:[0,1,1]
    v_pk_fma_f32 v[116:117], v[30:31], v[154:155], v[116:117] op_sel:[1,0,0] op_sel_hi:[1,1,1] neg_lo:[1,0,0] neg_hi:[1,0,0]
    v_pk_fma_f32 v[156:157], v[30:31], v[102:103], v[156:157] op_sel:[1,0,0] op_sel_hi:[1,1,1]
    v_pk_fma_f32 v[116:117], v[28:29], v[102:103], v[116:117] op_sel:[1,0,0] op_sel_hi:[1,1,1]
    v_pk_fma_f32 v[156:157], v[28:29], v[154:155], v[156:157] op_sel:[1,0,0] op_sel_hi:[1,1,1]
    v_pk_fma_f32 v[114:115], v[30:31], v[140:141], v[114:115] op_sel:[0,0,0] op_sel_hi:[0,1,1] neg_lo:[1,0,0] neg_hi:[1,0,0]
    v_pk_fma_f32 v[142:143], v[30:31], v[112:113], v[142:143] op_sel:[0,0,0] op_sel_hi:[0,1,1]
    v_pk_fma_f32 v[114:115], v[28:29], v[112:113], v[114:115] op_sel:[0,0,0] op_sel_hi:[0,1,1]
    v_pk_fma_f32 v[142:143], v[28:29], v[140:141], v[142:143] op_sel:[0,0,0] op_sel_hi:[0,1,1]
    v_pk_fma_f32 v[118:119], v[30:31], v[156:157], v[118:119] op_sel:[1,0,0] op_sel_hi:[1,1,1] neg_lo:[1,0,0] neg_hi:[1,0,0]
    v_pk_fma_f32 v[158:159], v[30:31], v[116:117], v[158:159] op_sel:[1,0,0] op_sel_hi:[1,1,1]
    v_pk_fma_f32 v[118:119], v[28:29], v[116:117], v[118:119] op_sel:[1,0,0] op_sel_hi:[1,1,1]
    v_pk_fma_f32 v[158:159], v[28:29], v[156:157], v[158:159] op_sel:[1,0,0] op_sel_hi:[1,1,1]
    v_cvt_pk_bf16_f32 v163, v112, v114
    v_cvt_pk_bf16_f32 v171, -v140, -v142
    v_cvt_pk_bf16_f32 v167, v113, v115
    v_cvt_pk_bf16_f32 v175, -v141, -v143
    v_cvt_pk_bf16_f32 v179, v116, v118
    v_cvt_pk_bf16_f32 v187, -v156, -v158
    v_cvt_pk_bf16_f32 v183, v117, v119
    v_cvt_pk_bf16_f32 v191, -v157, -v159
    ds_write_b128 v195, v[160:163] offset:0
    ds_write_b128 v195, v[164:167] offset:16
    ds_write_b128 v195, v[176:179] offset:2304
    ds_write_b128 v195, v[180:183] offset:2320
    ds_write_b128 v195, v[168:171] offset:4608
    ds_write_b128 v195, v[172:175] offset:4624
    ds_write_b128 v195, v[184:187] offset:6912
    ds_write_b128 v195, v[188:191] offset:6928
    s_waitcnt lgkmcnt(4)
    ds_read_b64_tr_b16 v[128:129], v196 offset:0
    ds_read_b64_tr_b16 v[130:131], v196 offset:576
    ds_read_b64_tr_b16 v[132:133], v196 offset:32
    ds_read_b64_tr_b16 v[134:135], v196 offset:608
    ds_read_b64_tr_b16 v[136:137], v196 offset:64
    ds_read_b64_tr_b16 v[138:139], v196 offset:640
    ds_read_b64_tr_b16 v[140:141], v196 offset:96
    ds_read_b64_tr_b16 v[142:143], v196 offset:672
    s_waitcnt lgkmcnt(8)
    ds_read_b64_tr_b16 v[144:145], v196 offset:4608
    ds_read_b64_tr_b16 v[146:147], v196 offset:5184
    ds_read_b64_tr_b16 v[148:149], v196 offset:4640
    ds_read_b64_tr_b16 v[150:151], v196 offset:5216
    ds_read_b64_tr_b16 v[152:153], v196 offset:4672
    ds_read_b64_tr_b16 v[154:155], v196 offset:5248
    ds_read_b64_tr_b16 v[156:157], v196 offset:4704
    ds_read_b64_tr_b16 v[158:159], v196 offset:5280
    s_mov_b32 s44, s53
    v_cmp_ne_u32 vcc, s97, v2
    s_waitcnt lgkmcnt(14)
    s_add_u32 s39, s44, 0
    buffer_store_dwordx4 v[128:131], v197, s[12:15], s39 offen offset:0
    s_waitcnt lgkmcnt(12)
    s_add_u32 s39, s44, 0
    buffer_store_dwordx4 v[132:135], v197, s[12:15], s39 offen offset:1024
    s_waitcnt lgkmcnt(10)
    s_add_u32 s39, s44, 8192
    buffer_store_dwordx4 v[136:139], v197, s[12:15], s39 offen offset:0
    s_waitcnt lgkmcnt(8)
    s_add_u32 s39, s44, 8192
    buffer_store_dwordx4 v[140:143], v197, s[12:15], s39 offen offset:1024
    s_waitcnt lgkmcnt(6)
    s_add_u32 s39, s44, 4096
    buffer_store_dwordx4 v[144:147], v197, s[12:15], s39 offen offset:0
    s_waitcnt lgkmcnt(4)
    s_add_u32 s39, s44, 4096
    buffer_store_dwordx4 v[148:151], v197, s[12:15], s39 offen offset:1024
    s_waitcnt lgkmcnt(2)
    s_add_u32 s39, s44, 12288
    buffer_store_dwordx4 v[152:155], v197, s[12:15], s39 offen offset:0
    s_waitcnt lgkmcnt(0)
    s_add_u32 s39, s44, 12288
    buffer_store_dwordx4 v[156:159], v197, s[12:15], s39 offen offset:1024
    s_cmp_eq_u64 vcc, 0
    s_cselect_b32 s45, 1, 0
    v_mov_b32 v16, v202
    v_mov_b32 v17, v203
    v_mov_b32 v18, v204
    v_mov_b32 v19, v205
    v_mov_b32 v28, v197
    v_add_u32 v29, 4096, v197
    s_lshl_b32 s38, s18, 13
    s_add_u32 s50, s48, s38
    s_add_u32 s56, s50, 16777216
    v_mov_b32 v32, 73728
    v_mov_b32 v33, 1
    v_mov_b32 v58, s97
    v_lshlrev_b32 v59, 2, v24
    s_lshl_b32 s52, s16, 12
    s_add_u32 s52, s52, 9502720
    s_lshl_b32 s46, s17, 8
    s_add_u32 s46, s46, s52
    s_add_u32 s47, s46, 196608
    s_waitcnt vmcnt(0)
    v_mov_b32 v57, 1
    s_mov_b64 exec, 1
    ds_add_rtn_u32 v57, v32, v57 offset:4
    s_mov_b64 exec, -1
    s_waitcnt lgkmcnt(0)
    v_readfirstlane_b32 s39, v57
    s_nop 1
    s_cmp_lg_u32 s39, 3
    s_cbranch_scc1 L_nohl
    s_mov_b32 exec_hi, 0
    buffer_store_dword v58, v59, s[12:15], s47 offen
    s_mov_b32 exec_hi, -1
L_nohl:
    v_bfe_u32 v59, v24, 1, 3
    v_xor_b32 v59, v59, v25
    v_lshlrev_b32 v59, 4, v59
    v_lshl_add_u32 v59, v26, 7, v59
    v_xor_b32 v20, 0, v59
    v_add_u32 v22, 0x10000, v20
    v_xor_b32 v21, 64, v59
    v_add_u32 v23, 0x10000, v21
    v_xor_b32 v30, s54, v26
    v_lshlrev_b32 v30, 8, v30
    s_mov_b32 s38, 196608
    v_mul_lo_u32 v58, v25, s38
    v_add_u32 v30, v30, v58
    v_mov_b32 v35, s93
    v_mov_b32 v58, s97
    v_cndmask_b32 v35, v35, v58, s[84:85]
    s_cmp_eq_u32 s45, 1
    s_mov_b32 s9, 4294901760
    s_cselect_b32 s8, s9, 4294967295
    s_mov_b32 s9, 0
    v_mov_b32 v31, v35
    v_not_b32 v31, v31
    s_cmp_eq_u32 s45, 1
    s_cbranch_scc1 L_nohf
    s_add_u32 s39, s44, 16777216
    buffer_store_dwordx4 v[128:131], v28, s[12:15], s39 offen offset:0 sc1
    s_add_u32 s39, s44, 16777216
    buffer_store_dwordx4 v[132:135], v28, s[12:15], s39 offen offset:1024 sc1
    s_add_u32 s39, s44, 16785408
    buffer_store_dwordx4 v[136:139], v28, s[12:15], s39 offen offset:0 sc1
    s_add_u32 s39, s44, 16785408
    buffer_store_dwordx4 v[140:143], v28, s[12:15], s39 offen offset:1024 sc1
    s_add_u32 s39, s44, 16781312
    buffer_store_dwordx4 v[144:147], v28, s[12:15], s39 offen offset:0 sc1
    s_add_u32 s39, s44, 16781312
    buffer_store_dwordx4 v[148:151], v28, s[12:15], s39 offen offset:1024 sc1
    s_add_u32 s39, s44, 16789504
    buffer_store_dwordx4 v[152:155], v28, s[12:15], s39 offen offset:0 sc1
    s_add_u32 s39, s44, 16789504
    buffer_store_dwordx4 v[156:159], v28, s[12:15], s39 offen offset:1024 sc1
    s_waitcnt vmcnt(0)
    v_mov_b32 v57, 1
    s_mov_b64 exec, 1
    ds_add_rtn_u32 v57, v32, v57 offset:12
    s_mov_b64 exec, -1
    s_waitcnt lgkmcnt(0)
    v_readfirstlane_b32 s39, v57
    s_nop 1
    s_cmp_lg_u32 s39, 3
    s_cbranch_scc1 L_nohf
    v_mov_b32 v58, s93
    v_lshlrev_b32 v59, 2, v24
    s_mov_b32 exec_hi, 0
    buffer_store_dword v58, v59, s[12:15], s46 offen sc1
    s_mov_b32 exec_hi, -1
L_nohf:
    s_mov_b64 exec, s[8:9]
    buffer_load_dword v31, v30, s[12:15], s52 offen sc1
    s_mov_b64 exec, -1
L_hpoll:
    s_waitcnt vmcnt(0)
    v_cmp_ne_u32 vcc, v35, v31
    s_nop 1
    s_and_b32 s38, vcc_lo, 4294901760
    s_cbranch_scc0 L_hgo
    s_and_b32 s38, vcc_lo, 65535
    s_cbranch_scc0 L_hgo2
    s_sub_u32 s96, s96, 1
    s_cbranch_scc1 L_hgo
    s_sleep 1
    s_mov_b64 exec, s[8:9]
    buffer_load_dword v31, v30, s[12:15], s52 offen sc1
    s_mov_b64 exec, -1
    s_branch L_hpoll
L_hgo2:
    s_mov_b32 s50, s56
L_hgo:
    s_mov_b64 exec, 1
    ds_add_u32 v32, v33 offset:72
    s_mov_b64 exec, -1
    s_add_u32 s49, s55, 0
    s_and_b32 s49, s49, 15
    s_lshl_b32 s49, s49, 15
    s_add_u32 s49, s49, s50
    buffer_load_dwordx4 v[160:163], v28, s[12:15], s49 offen offset:0 sc1
    buffer_load_dwordx4 v[164:167], v28, s[12:15], s49 offen offset:1024 sc1
    buffer_load_dwordx4 v[168:171], v28, s[12:15], s49 offen offset:2048 sc1
    buffer_load_dwordx4 v[172:175], v28, s[12:15], s49 offen offset:3072 sc1
L_sync0:
    ds_read_b32 v34, v32 offset:4
    s_waitcnt lgkmcnt(0)
    v_readfirstlane_b32 s38, v34
    s_nop 1
    s_cmp_ge_u32 s38, 4
    s_cbranch_scc1 L_sync0_ok
    s_sub_u32 s96, s96, 1
    s_cbranch_scc1 L_sync0_ok
    s_sleep 1
    s_branch L_sync0
L_sync0_ok:
    ds_read_b128 v[224:227], v22 offset:16384
    ds_read_b128 v[228:231], v22 offset:18432
    ds_read_b128 v[232:235], v22 offset:20480
    ds_read_b128 v[236:239], v22 offset:22528
    buffer_load_dwordx4 v[176:179], v29, s[12:15], s49 offen offset:0 sc1
    buffer_load_dwordx4 v[180:183], v29, s[12:15], s49 offen offset:1024 sc1
    buffer_load_dwordx4 v[184:187], v29, s[12:15], s49 offen offset:2048 sc1
    buffer_load_dwordx4 v[188:191], v29, s[12:15], s49 offen offset:3072 sc1
    s_add_u32 s49, s55, 1
    s_and_b32 s49, s49, 15
    s_lshl_b32 s49, s49, 15
    s_add_u32 s49, s49, s50
    buffer_load_dwordx4 v[192:195], v28, s[12:15], s49 offen offset:0 sc1
    buffer_load_dwordx4 v[196:199], v28, s[12:15], s49 offen offset:1024 sc1
    buffer_load_dwordx4 v[200:203], v28, s[12:15], s49 offen offset:2048 sc1
    buffer_load_dwordx4 v[204:207], v28, s[12:15], s49 offen offset:3072 sc1
    buffer_load_dwordx4 v[208:211], v29, s[12:15], s49 offen offset:0 sc1
    buffer_load_dwordx4 v[212:215], v29, s[12:15], s49 offen offset:1024 sc1
    buffer_load_dwordx4 v[216:219], v29, s[12:15], s49 offen offset:2048 sc1
    buffer_load_dwordx4 v[220:223], v29, s[12:15], s49 offen offset:3072 sc1
    ds_read_b128 v[240:243], v23 offset:16384
    ds_read_b128 v[244:247], v23 offset:18432
    ds_read_b128 v[248:251], v23 offset:20480
    ds_read_b128 v[252:255], v23 offset:22528
    s_waitcnt vmcnt(14) lgkmcnt(4)
    v_mfma_f32_16x16x32_bf16 v[128:131], v[224:227], v[160:163], 0
    v_mfma_f32_16x16x32_bf16 v[132:135], v[228:231], v[160:163], 0
    v_mfma_f32_16x16x32_bf16 v[136:139], v[232:235], v[160:163], 0
    v_mfma_f32_16x16x32_bf16 v[140:143], v[236:239], v[160:163], 0
    s_add_u32 s49, s55, 2
    s_and_b32 s49, s49, 15
    s_lshl_b32 s49, s49, 15
    s_add_u32 s49, s49, s50
    buffer_load_dwordx4 v[160:163], v28, s[12:15], s49 offen offset:0 sc1
    s_add_u32 m0, s23, 32768
    s_add_u32 s21, s55, 3
    s_and_b32 s21, s21, 15
    s_lshl_b32 s21, s21, 7
    buffer_load_dwordx4 v16, s[28:31], s21 offen offset:0  lds
    v_mfma_f32_16x16x32_bf16 v[144:147], v[224:227], v[164:167], 0
    v_mfma_f32_16x16x32_bf16 v[148:151], v[228:231], v[164:167], 0
    v_mfma_f32_16x16x32_bf16 v[152:155], v[232:235], v[164:167], 0
    v_mfma_f32_16x16x32_bf16 v[156:159], v[236:239], v[164:167], 0
    buffer_load_dwordx4 v[164:167], v28, s[12:15], s49 offen offset:1024 sc1
    ds_read_b128 v[224:227], v22 offset:24576
    ds_read_b128 v[228:231], v22 offset:26624
    ds_read_b128 v[232:235], v22 offset:28672
    ds_read_b128 v[236:239], v22 offset:30720
    s_waitcnt vmcnt(15) lgkmcnt(4)
    s_mov_b64 exec, 1
    ds_add_u32 v32, v33 offset:16
    s_mov_b64 exec, -1
    v_mfma_f32_16x16x32_bf16 v[128:131], v[240:243], v[168:171], v[128:131]
    v_mfma_f32_16x16x32_bf16 v[132:135], v[244:247], v[168:171], v[132:135]
    v_mfma_f32_16x16x32_bf16 v[136:139], v[248:251], v[168:171], v[136:139]
    v_mfma_f32_16x16x32_bf16 v[140:143], v[252:255], v[168:171], v[140:143]
    buffer_load_dwordx4 v[168:171], v28, s[12:15], s49 offen offset:2048 sc1
    buffer_load_dwordx4 v17, s[28:31], s21 offen offset:1024  lds
    v_mfma_f32_16x16x32_bf16 v[144:147], v[240:243], v[172:175], v[144:147]
    v_mfma_f32_16x16x32_bf16 v[148:151], v[244:247], v[172:175], v[148:151]
    v_mfma_f32_16x16x32_bf16 v[152:155], v[248:251], v[172:175], v[152:155]
    v_mfma_f32_16x16x32_bf16 v[156:159], v[252:255], v[172:175], v[156:159]
    buffer_load_dwordx4 v[172:175], v28, s[12:15], s49 offen offset:3072 sc1
    ds_read_b128 v[240:243], v23 offset:24576
    ds_read_b128 v[244:247], v23 offset:26624
    ds_read_b128 v[248:251], v23 offset:28672
    ds_read_b128 v[252:255], v23 offset:30720
    s_waitcnt vmcnt(16) lgkmcnt(4)
    v_mfma_f32_16x16x32_bf16 v[128:131], v[224:227], v[176:179], v[128:131]
    v_mfma_f32_16x16x32_bf16 v[132:135], v[228:231], v[176:179], v[132:135]
    v_mfma_f32_16x16x32_bf16 v[136:139], v[232:235], v[176:179], v[136:139]
    v_mfma_f32_16x16x32_bf16 v[140:143], v[236:239], v[176:179], v[140:143]
    ds_read_b32 v34, v32 offset:16
    buffer_load_dwordx4 v[176:179], v29, s[12:15], s49 offen offset:0 sc1
    buffer_load_dwordx4 v18, s[28:31], s21 offen offset:2048  lds
    v_mfma_f32_16x16x32_bf16 v[144:147], v[224:227], v[180:183], v[144:147]
    v_mfma_f32_16x16x32_bf16 v[148:151], v[228:231], v[180:183], v[148:151]
    v_mfma_f32_16x16x32_bf16 v[152:155], v[232:235], v[180:183], v[152:155]
    v_mfma_f32_16x16x32_bf16 v[156:159], v[236:239], v[180:183], v[156:159]
    buffer_load_dwordx4 v[180:183], v29, s[12:15], s49 offen offset:1024 sc1
    s_waitcnt lgkmcnt(0)
    v_readfirstlane_b32 s38, v34
    s_nop 1
    s_cmp_ge_u32 s38, 4
    s_cbranch_scc1 L_st0_ok
L_st0:
    ds_read_b32 v34, v32 offset:16
    s_waitcnt lgkmcnt(0)
    v_readfirstlane_b32 s38, v34
    s_nop 1
    s_cmp_ge_u32 s38, 4
    s_cbranch_scc1 L_st0_ok
    s_sub_u32 s96, s96, 1
    s_cbranch_scc1 L_st0_ok
    s_sleep 0
    s_branch L_st0
L_st0_ok:
    ds_read_b128 v[224:227], v20 offset:0
    ds_read_b128 v[228:231], v20 offset:2048
    ds_read_b128 v[232:235], v20 offset:4096
    ds_read_b128 v[236:239], v20 offset:6144
    s_waitcnt vmcnt(17)
    v_mfma_f32_16x16x32_bf16 v[128:131], v[240:243], v[184:187], v[128:131]
    v_mfma_f32_16x16x32_bf16 v[132:135], v[244:247], v[184:187], v[132:135]
    v_mfma_f32_16x16x32_bf16 v[136:139], v[248:251], v[184:187], v[136:139]
    v_mfma_f32_16x16x32_bf16 v[140:143], v[252:255], v[184:187], v[140:143]
    buffer_load_dwordx4 v[184:187], v29, s[12:15], s49 offen offset:2048 sc1
    buffer_load_dwordx4 v19, s[28:31], s21 offen offset:3072  lds
    v_mfma_f32_16x16x32_bf16 v[144:147], v[240:243], v[188:191], v[144:147]
    v_mfma_f32_16x16x32_bf16 v[148:151], v[244:247], v[188:191], v[148:151]
    v_mfma_f32_16x16x32_bf16 v[152:155], v[248:251], v[188:191], v[152:155]
    v_mfma_f32_16x16x32_bf16 v[156:159], v[252:255], v[188:191], v[156:159]
    buffer_load_dwordx4 v[188:191], v29, s[12:15], s49 offen offset:3072 sc1
    ds_read_b128 v[240:243], v21 offset:0
    ds_read_b128 v[244:247], v21 offset:2048
    ds_read_b128 v[248:251], v21 offset:4096
    ds_read_b128 v[252:255], v21 offset:6144
    s_waitcnt vmcnt(18) lgkmcnt(4)
    v_mfma_f32_16x16x32_bf16 v[128:131], v[224:227], v[192:195], v[128:131]
    v_mfma_f32_16x16x32_bf16 v[132:135], v[228:231], v[192:195], v[132:135]
    v_mfma_f32_16x16x32_bf16 v[136:139], v[232:235], v[192:195], v[136:139]
    v_mfma_f32_16x16x32_bf16 v[140:143], v[236:239], v[192:195], v[140:143]
    s_add_u32 s49, s55, 3
    s_and_b32 s49, s49, 15
    s_lshl_b32 s49, s49, 15
    s_add_u32 s49, s49, s50
    buffer_load_dwordx4 v[192:195], v28, s[12:15], s49 offen offset:0 sc1
    s_add_u32 m0, s23, 49152
    s_add_u32 s21, s55, 4
    s_and_b32 s21, s21, 15
    s_lshl_b32 s21, s21, 7
    buffer_load_dwordx4 v16, s[28:31], s21 offen offset:0  lds
    v_mfma_f32_16x16x32_bf16 v[144:147], v[224:227], v[196:199], v[144:147]
    v_mfma_f32_16x16x32_bf16 v[148:151], v[228:231], v[196:199], v[148:151]
    v_mfma_f32_16x16x32_bf16 v[152:155], v[232:235], v[196:199], v[152:155]
    v_mfma_f32_16x16x32_bf16 v[156:159], v[236:239], v[196:199], v[156:159]
    buffer_load_dwordx4 v[196:199], v28, s[12:15], s49 offen offset:1024 sc1
    ds_read_b128 v[224:227], v20 offset:8192
    ds_read_b128 v[228:231], v20 offset:10240
    ds_read_b128 v[232:235], v20 offset:12288
    ds_read_b128 v[236:239], v20 offset:14336
    s_waitcnt vmcnt(19) lgkmcnt(4)
    s_mov_b64 exec, 1
    ds_add_u32 v32, v33 offset:16
    s_mov_b64 exec, -1
    v_mfma_f32_16x16x32_bf16 v[128:131], v[240:243], v[200:203], v[128:131]
    v_mfma_f32_16x16x32_bf16 v[132:135], v[244:247], v[200:203], v[132:135]
    v_mfma_f32_16x16x32_bf16 v[136:139], v[248:251], v[200:203], v[136:139]
    v_mfma_f32_16x16x32_bf16 v[140:143], v[252:255], v[200:203], v[140:143]
    buffer_load_dwordx4 v[200:203], v28, s[12:15], s49 offen offset:2048 sc1
    buffer_load_dwordx4 v17, s[28:31], s21 offen offset:1024  lds
    v_mfma_f32_16x16x32_bf16 v[144:147], v[240:243], v[204:207], v[144:147]
    v_mfma_f32_16x16x32_bf16 v[148:151], v[244:247], v[204:207], v[148:151]
    v_mfma_f32_16x16x32_bf16 v[152:155], v[248:251], v[204:207], v[152:155]
    v_mfma_f32_16x16x32_bf16 v[156:159], v[252:255], v[204:207], v[156:159]
    buffer_load_dwordx4 v[204:207], v28, s[12:15], s49 offen offset:3072 sc1
    ds_read_b128 v[240:243], v21 offset:8192
    ds_read_b128 v[244:247], v21 offset:10240
    ds_read_b128 v[248:251], v21 offset:12288
    ds_read_b128 v[252:255], v21 offset:14336
    s_waitcnt vmcnt(20) lgkmcnt(4)
    v_mfma_f32_16x16x32_bf16 v[128:131], v[224:227], v[208:211], v[128:131]
    v_mfma_f32_16x16x32_bf16 v[132:135], v[228:231], v[208:211], v[132:135]
    v_mfma_f32_16x16x32_bf16 v[136:139], v[232:235], v[208:211], v[136:139]
    v_mfma_f32_16x16x32_bf16 v[140:143], v[236:239], v[208:211], v[140:143]
    ds_read_b32 v34, v32 offset:16
    buffer_load_dwordx4 v[208:211], v29, s[12:15], s49 offen offset:0 sc1
    buffer_load_dwordx4 v18, s[28:31], s21 offen offset:2048  lds
    v_mfma_f32_16x16x32_bf16 v[144:147], v[224:227], v[212:215], v[144:147]
    v_mfma_f32_16x16x32_bf16 v[148:151], v[228:231], v[212:215], v[148:151]
    v_mfma_f32_16x16x32_bf16 v[152:155], v[232:235], v[212:215], v[152:155]
    v_mfma_f32_16x16x32_bf16 v[156:159], v[236:239], v[212:215], v[156:159]
    buffer_load_dwordx4 v[212:215], v29, s[12:15], s49 offen offset:1024 sc1
    s_waitcnt lgkmcnt(0)
    v_readfirstlane_b32 s38, v34
    s_nop 1
    s_cmp_ge_u32 s38, 8
    s_cbranch_scc1 L_st1_ok
L_st1:
    ds_read_b32 v34, v32 offset:16
    s_waitcnt lgkmcnt(0)
    v_readfirstlane_b32 s38, v34
    s_nop 1
    s_cmp_ge_u32 s38, 8
    s_cbranch_scc1 L_st1_ok
    s_sub_u32 s96, s96, 1
    s_cbranch_scc1 L_st1_ok
    s_sleep 0
    s_branch L_st1
L_st1_ok:
    ds_read_b128 v[224:227], v20 offset:16384
    ds_read_b128 v[228:231], v20 offset:18432
    ds_read_b128 v[232:235], v20 offset:20480
    ds_read_b128 v[236:239], v20 offset:22528
    s_waitcnt vmcnt(21)
    v_mfma_f32_16x16x32_bf16 v[128:131], v[240:243], v[216:219], v[128:131]
    v_mfma_f32_16x16x32_bf16 v[132:135], v[244:247], v[216:219], v[132:135]
    v_mfma_f32_16x16x32_bf16 v[136:139], v[248:251], v[216:219], v[136:139]
    v_mfma_f32_16x16x32_bf16 v[140:143], v[252:255], v[216:219], v[140:143]
    buffer_load_dwordx4 v[216:219], v29, s[12:15], s49 offen offset:2048 sc1
    buffer_load_dwordx4 v19, s[28:31], s21 offen offset:3072  lds
    v_mfma_f32_16x16x32_bf16 v[144:147], v[240:243], v[220:223], v[144:147]
    v_mfma_f32_16x16x32_bf16 v[148:151], v[244:247], v[220:223], v[148:151]
    v_mfma_f32_16x16x32_bf16 v[152:155], v[248:251], v[220:223], v[152:155]
    v_mfma_f32_16x16x32_bf16 v[156:159], v[252:255], v[220:223], v[156:159]
    buffer_load_dwordx4 v[220:223], v29, s[12:15], s49 offen offset:3072 sc1
    ds_read_b128 v[240:243], v21 offset:16384
    ds_read_b128 v[244:247], v21 offset:18432
    ds_read_b128 v[248:251], v21 offset:20480
    ds_read_b128 v[252:255], v21 offset:22528
    s_waitcnt vmcnt(21) lgkmcnt(4)
    v_mfma_f32_16x16x32_bf16 v[128:131], v[224:227], v[160:163], v[128:131]
    v_mfma_f32_16x16x32_bf16 v[132:135], v[228:231], v[160:163], v[132:135]
    v_mfma_f32_16x16x32_bf16 v[136:139], v[232:235], v[160:163], v[136:139]
    v_mfma_f32_16x16x32_bf16 v[140:143], v[236:239], v[160:163], v[140:143]
    s_add_u32 s49, s55, 4
    s_and_b32 s49, s49, 15
    s_lshl_b32 s49, s49, 15
    s_add_u32 s49, s49, s50
    buffer_load_dwordx4 v[160:163], v28, s[12:15], s49 offen offset:0 sc1
    s_add_u32 m0, s23, 81920
    s_add_u32 s21, s55, 5
    s_and_b32 s21, s21, 15
    s_lshl_b32 s21, s21, 7
    buffer_load_dwordx4 v16, s[28:31], s21 offen offset:0  lds
    v_mfma_f32_16x16x32_bf16 v[144:147], v[224:227], v[164:167], v[144:147]
    v_mfma_f32_16x16x32_bf16 v[148:151], v[228:231], v[164:167], v[148:151]
    v_mfma_f32_16x16x32_bf16 v[152:155], v[232:235], v[164:167], v[152:155]
    v_mfma_f32_16x16x32_bf16 v[156:159], v[236:239], v[164:167], v[156:159]
    buffer_load_dwordx4 v[164:167], v28, s[12:15], s49 offen offset:1024 sc1
    ds_read_b128 v[224:227], v20 offset:24576
    ds_read_b128 v[228:231], v20 offset:26624
    ds_read_b128 v[232:235], v20 offset:28672
    ds_read_b128 v[236:239], v20 offset:30720
    s_waitcnt vmcnt(16) lgkmcnt(4)
    s_mov_b64 exec, 1
    ds_add_u32 v32, v33 offset:16
    s_mov_b64 exec, -1
    v_mfma_f32_16x16x32_bf16 v[128:131], v[240:243], v[168:171], v[128:131]
    v_mfma_f32_16x16x32_bf16 v[132:135], v[244:247], v[168:171], v[132:135]
    v_mfma_f32_16x16x32_bf16 v[136:139], v[248:251], v[168:171], v[136:139]
    v_mfma_f32_16x16x32_bf16 v[140:143], v[252:255], v[168:171], v[140:143]
    buffer_load_dwordx4 v[168:171], v28, s[12:15], s49 offen offset:2048 sc1
    buffer_load_dwordx4 v17, s[28:31], s21 offen offset:1024  lds
    v_mfma_f32_16x16x32_bf16 v[144:147], v[240:243], v[172:175], v[144:147]
    v_mfma_f32_16x16x32_bf16 v[148:151], v[244:247], v[172:175], v[148:151]
    v_mfma_f32_16x16x32_bf16 v[152:155], v[248:251], v[172:175], v[152:155]
    v_mfma_f32_16x16x32_bf16 v[156:159], v[252:255], v[172:175], v[156:159]
    buffer_load_dwordx4 v[172:175], v28, s[12:15], s49 offen offset:3072 sc1
    ds_read_b128 v[240:243], v21 offset:24576
    ds_read_b128 v[244:247], v21 offset:26624
    ds_read_b128 v[248:251], v21 offset:28672
    ds_read_b128 v[252:255], v21 offset:30720
    s_waitcnt vmcnt(21) lgkmcnt(4)
    v_mfma_f32_16x16x32_bf16 v[128:131], v[224:227], v[176:179], v[128:131]
    v_mfma_f32_16x16x32_bf16 v[132:135], v[228:231], v[176:179], v[132:135]
    v_mfma_f32_16x16x32_bf16 v[136:139], v[232:235], v[176:179], v[136:139]
    v_mfma_f32_16x16x32_bf16 v[140:143], v[236:239], v[176:179], v[140:143]
    ds_read_b32 v34, v32 offset:16
    buffer_load_dwordx4 v[176:179], v29, s[12:15], s49 offen offset:0 sc1
    buffer_load_dwordx4 v18, s[28:31], s21 offen offset:2048  lds
    v_mfma_f32_16x16x32_bf16 v[144:147], v[224:227], v[180:183], v[144:147]
    v_mfma_f32_16x16x32_bf16 v[148:151], v[228:231], v[180:183], v[148:151]
    v_mfma_f32_16x16x32_bf16 v[152:155], v[232:235], v[180:183], v[152:155]
    v_mfma_f32_16x16x32_bf16 v[156:159], v[236:239], v[180:183], v[156:159]
    buffer_load_dwordx4 v[180:183], v29, s[12:15], s49 offen offset:1024 sc1
    s_waitcnt lgkmcnt(0)
    v_readfirstlane_b32 s38, v34
    s_nop 1
    s_cmp_ge_u32 s38, 12
    s_cbranch_scc1 L_st2_ok
L_st2:
    ds_read_b32 v34, v32 offset:16
    s_waitcnt lgkmcnt(0)
    v_readfirstlane_b32 s38, v34
    s_nop 1
    s_cmp_ge_u32 s38, 12
    s_cbranch_scc1 L_st2_ok
    s_sub_u32 s96, s96, 1
    s_cbranch_scc1 L_st2_ok
    s_sleep 0
    s_branch L_st2
L_st2_ok:
    ds_read_b128 v[224:227], v20 offset:32768
    ds_read_b128 v[228:231], v20 offset:34816
    ds_read_b128 v[232:235], v20 offset:36864
    ds_read_b128 v[236:239], v20 offset:38912
    s_waitcnt vmcnt(21)
    v_mfma_f32_16x16x32_bf16 v[128:131], v[240:243], v[184:187], v[128:131]
    v_mfma_f32_16x16x32_bf16 v[132:135], v[244:247], v[184:187], v[132:135]
    v_mfma_f32_16x16x32_bf16 v[136:139], v[248:251], v[184:187], v[136:139]
    v_mfma_f32_16x16x32_bf16 v[140:143], v[252:255], v[184:187], v[140:143]
    buffer_load_dwordx4 v[184:187], v29, s[12:15], s49 offen offset:2048 sc1
    buffer_load_dwordx4 v19, s[28:31], s21 offen offset:3072  lds
    v_mfma_f32_16x16x32_bf16 v[144:147], v[240:243], v[188:191], v[144:147]
    v_mfma_f32_16x16x32_bf16 v[148:151], v[244:247], v[188:191], v[148:151]
    v_mfma_f32_16x16x32_bf16 v[152:155], v[248:251], v[188:191], v[152:155]
    v_mfma_f32_16x16x32_bf16 v[156:159], v[252:255], v[188:191], v[156:159]
    buffer_load_dwordx4 v[188:191], v29, s[12:15], s49 offen offset:3072 sc1
    ds_read_b128 v[240:243], v21 offset:32768
    ds_read_b128 v[244:247], v21 offset:34816
    ds_read_b128 v[248:251], v21 offset:36864
    ds_read_b128 v[252:255], v21 offset:38912
    s_waitcnt vmcnt(21) lgkmcnt(4)
    v_mfma_f32_16x16x32_bf16 v[128:131], v[224:227], v[192:195], v[128:131]
    v_mfma_f32_16x16x32_bf16 v[132:135], v[228:231], v[192:195], v[132:135]
    v_mfma_f32_16x16x32_bf16 v[136:139], v[232:235], v[192:195], v[136:139]
    v_mfma_f32_16x16x32_bf16 v[140:143], v[236:239], v[192:195], v[140:143]
    s_add_u32 s49, s55, 5
    s_and_b32 s49, s49, 15
    s_lshl_b32 s49, s49, 15
    s_add_u32 s49, s49, s50
    buffer_load_dwordx4 v[192:195], v28, s[12:15], s49 offen offset:0 sc1
    s_add_u32 m0, s23, 0
    s_add_u32 s21, s55, 6
    s_and_b32 s21, s21, 15
    s_lshl_b32 s21, s21, 7
    buffer_load_dwordx4 v16, s[28:31], s21 offen offset:0  lds
    v_mfma_f32_16x16x32_bf16 v[144:147], v[224:227], v[196:199], v[144:147]
    v_mfma_f32_16x16x32_bf16 v[148:151], v[228:231], v[196:199], v[148:151]
    v_mfma_f32_16x16x32_bf16 v[152:155], v[232:235], v[196:199], v[152:155]
    v_mfma_f32_16x16x32_bf16 v[156:159], v[236:239], v[196:199], v[156:159]
    buffer_load_dwordx4 v[196:199], v28, s[12:15], s49 offen offset:1024 sc1
    ds_read_b128 v[224:227], v20 offset:40960
    ds_read_b128 v[228:231], v20 offset:43008
    ds_read_b128 v[232:235], v20 offset:45056
    ds_read_b128 v[236:239], v20 offset:47104
    s_waitcnt vmcnt(16) lgkmcnt(4)
    s_mov_b64 exec, 1
    ds_add_u32 v32, v33 offset:16
    s_mov_b64 exec, -1
    v_mfma_f32_16x16x32_bf16 v[128:131], v[240:243], v[200:203], v[128:131]
    v_mfma_f32_16x16x32_bf16 v[132:135], v[244:247], v[200:203], v[132:135]
    v_mfma_f32_16x16x32_bf16 v[136:139], v[248:251], v[200:203], v[136:139]
    v_mfma_f32_16x16x32_bf16 v[140:143], v[252:255], v[200:203], v[140:143]
    buffer_load_dwordx4 v[200:203], v28, s[12:15], s49 offen offset:2048 sc1
    buffer_load_dwordx4 v17, s[28:31], s21 offen offset:1024  lds
    v_mfma_f32_16x16x32_bf16 v[144:147], v[240:243], v[204:207], v[144:147]
    v_mfma_f32_16x16x32_bf16 v[148:151], v[244:247], v[204:207], v[148:151]
    v_mfma_f32_16x16x32_bf16 v[152:155], v[248:251], v[204:207], v[152:155]
    v_mfma_f32_16x16x32_bf16 v[156:159], v[252:255], v[204:207], v[156:159]
    buffer_load_dwordx4 v[204:207], v28, s[12:15], s49 offen offset:3072 sc1
    ds_read_b128 v[240:243], v21 offset:40960
    ds_read_b128 v[244:247], v21 offset:43008
    ds_read_b128 v[248:251], v21 offset:45056
    ds_read_b128 v[252:255], v21 offset:47104
    s_waitcnt vmcnt(21) lgkmcnt(4)
    v_mfma_f32_16x16x32_bf16 v[128:131], v[224:227], v[208:211], v[128:131]
    v_mfma_f32_16x16x32_bf16 v[132:135], v[228:231], v[208:211], v[132:135]
    v_mfma_f32_16x16x32_bf16 v[136:139], v[232:235], v[208:211], v[136:139]
    v_mfma_f32_16x16x32_bf16 v[140:143], v[236:239], v[208:211], v[140:143]
    ds_read_b32 v34, v32 offset:16
    buffer_load_dwordx4 v[208:211], v29, s[12:15], s49 offen offset:0 sc1
    buffer_load_dwordx4 v18, s[28:31], s21 offen offset:2048  lds
    v_mfma_f32_16x16x32_bf16 v[144:147], v[224:227], v[212:215], v[144:147]
    v_mfma_f32_16x16x32_bf16 v[148:151], v[228:231], v[212:215], v[148:151]
    v_mfma_f32_16x16x32_bf16 v[152:155], v[232:235], v[212:215], v[152:155]
    v_mfma_f32_16x16x32_bf16 v[156:159], v[236:239], v[212:215], v[156:159]
    buffer_load_dwordx4 v[212:215], v29, s[12:15], s49 offen offset:1024 sc1
    s_waitcnt lgkmcnt(0)
    v_readfirstlane_b32 s38, v34
    s_nop 1
    s_cmp_ge_u32 s38, 16
    s_cbranch_scc1 L_st3_ok
L_st3:
    ds_read_b32 v34, v32 offset:16
    s_waitcnt lgkmcnt(0)
    v_readfirstlane_b32 s38, v34
    s_nop 1
    s_cmp_ge_u32 s38, 16
    s_cbranch_scc1 L_st3_ok
    s_sub_u32 s96, s96, 1
    s_cbranch_scc1 L_st3_ok
    s_sleep 0
    s_branch L_st3
L_st3_ok:
    ds_read_b128 v[224:227], v20 offset:49152
    ds_read_b128 v[228:231], v20 offset:51200
    ds_read_b128 v[232:235], v20 offset:53248
    ds_read_b128 v[236:239], v20 offset:55296
    s_waitcnt vmcnt(21)
    v_mfma_f32_16x16x32_bf16 v[128:131], v[240:243], v[216:219], v[128:131]
    v_mfma_f32_16x16x32_bf16 v[132:135], v[244:247], v[216:219], v[132:135]
    v_mfma_f32_16x16x32_bf16 v[136:139], v[248:251], v[216:219], v[136:139]
    v_mfma_f32_16x16x32_bf16 v[140:143], v[252:255], v[216:219], v[140:143]
    buffer_load_dwordx4 v[216:219], v29, s[12:15], s49 offen offset:2048 sc1
    buffer_load_dwordx4 v19, s[28:31], s21 offen offset:3072  lds
    v_mfma_f32_16x16x32_bf16 v[144:147], v[240:243], v[220:223], v[144:147]
    v_mfma_f32_16x16x32_bf16 v[148:151], v[244:247], v[220:223], v[148:151]
    v_mfma_f32_16x16x32_bf16 v[152:155], v[248:251], v[220:223], v[152:155]
    v_mfma_f32_16x16x32_bf16 v[156:159], v[252:255], v[220:223], v[156:159]
    buffer_load_dwordx4 v[220:223], v29, s[12:15], s49 offen offset:3072 sc1
    ds_read_b128 v[240:243], v21 offset:49152
    ds_read_b128 v[244:247], v21 offset:51200
    ds_read_b128 v[248:251], v21 offset:53248
    ds_read_b128 v[252:255], v21 offset:55296
    s_waitcnt vmcnt(21) lgkmcnt(4)
    v_mfma_f32_16x16x32_bf16 v[128:131], v[224:227], v[160:163], v[128:131]
    v_mfma_f32_16x16x32_bf16 v[132:135], v[228:231], v[160:163], v[132:135]
    v_mfma_f32_16x16x32_bf16 v[136:139], v[232:235], v[160:163], v[136:139]
    v_mfma_f32_16x16x32_bf16 v[140:143], v[236:239], v[160:163], v[140:143]
    s_add_u32 s49, s55, 6
    s_and_b32 s49, s49, 15
    s_lshl_b32 s49, s49, 15
    s_add_u32 s49, s49, s50
    buffer_load_dwordx4 v[160:163], v28, s[12:15], s49 offen offset:0 sc1
    s_add_u32 m0, s23, 16384
    s_add_u32 s21, s55, 7
    s_and_b32 s21, s21, 15
    s_lshl_b32 s21, s21, 7
    buffer_load_dwordx4 v16, s[28:31], s21 offen offset:0  lds
    v_mfma_f32_16x16x32_bf16 v[144:147], v[224:227], v[164:167], v[144:147]
    v_mfma_f32_16x16x32_bf16 v[148:151], v[228:231], v[164:167], v[148:151]
    v_mfma_f32_16x16x32_bf16 v[152:155], v[232:235], v[164:167], v[152:155]
    v_mfma_f32_16x16x32_bf16 v[156:159], v[236:239], v[164:167], v[156:159]
    buffer_load_dwordx4 v[164:167], v28, s[12:15], s49 offen offset:1024 sc1
    ds_read_b128 v[224:227], v20 offset:57344
    ds_read_b128 v[228:231], v20 offset:59392
    ds_read_b128 v[232:235], v20 offset:61440
    ds_read_b128 v[236:239], v20 offset:63488
    s_waitcnt vmcnt(16) lgkmcnt(4)
    s_mov_b64 exec, 1
    ds_add_u32 v32, v33 offset:16
    s_mov_b64 exec, -1
    v_mfma_f32_16x16x32_bf16 v[128:131], v[240:243], v[168:171], v[128:131]
    v_mfma_f32_16x16x32_bf16 v[132:135], v[244:247], v[168:171], v[132:135]
    v_mfma_f32_16x16x32_bf16 v[136:139], v[248:251], v[168:171], v[136:139]
    v_mfma_f32_16x16x32_bf16 v[140:143], v[252:255], v[168:171], v[140:143]
    buffer_load_dwordx4 v[168:171], v28, s[12:15], s49 offen offset:2048 sc1
    buffer_load_dwordx4 v17, s[28:31], s21 offen offset:1024  lds
    v_mfma_f32_16x16x32_bf16 v[144:147], v[240:243], v[172:175], v[144:147]
    v_mfma_f32_16x16x32_bf16 v[148:151], v[244:247], v[172:175], v[148:151]
    v_mfma_f32_16x16x32_bf16 v[152:155], v[248:251], v[172:175], v[152:155]
    v_mfma_f32_16x16x32_bf16 v[156:159], v[252:255], v[172:175], v[156:159]
    buffer_load_dwordx4 v[172:175], v28, s[12:15], s49 offen offset:3072 sc1
    ds_read_b128 v[240:243], v21 offset:57344
    ds_read_b128 v[244:247], v21 offset:59392
    ds_read_b128 v[248:251], v21 offset:61440
    ds_read_b128 v[252:255], v21 offset:63488
    s_waitcnt vmcnt(21) lgkmcnt(4)
    v_mfma_f32_16x16x32_bf16 v[128:131], v[224:227], v[176:179], v[128:131]
    v_mfma_f32_16x16x32_bf16 v[132:135], v[228:231], v[176:179], v[132:135]
    v_mfma_f32_16x16x32_bf16 v[136:139], v[232:235], v[176:179], v[136:139]
    v_mfma_f32_16x16x32_bf16 v[140:143], v[236:239], v[176:179], v[140:143]
    ds_read_b32 v34, v32 offset:16
    buffer_load_dwordx4 v[176:179], v29, s[12:15], s49 offen offset:0 sc1
    buffer_load_dwordx4 v18, s[28:31], s21 offen offset:2048  lds
    v_mfma_f32_16x16x32_bf16 v[144:147], v[224:227], v[180:183], v[144:147]
    v_mfma_f32_16x16x32_bf16 v[148:151], v[228:231], v[180:183], v[148:151]
    v_mfma_f32_16x16x32_bf16 v[152:155], v[232:235], v[180:183], v[152:155]
    v_mfma_f32_16x16x32_bf16 v[156:159], v[236:239], v[180:183], v[156:159]
    buffer_load_dwordx4 v[180:183], v29, s[12:15], s49 offen offset:1024 sc1
    s_waitcnt lgkmcnt(0)
    v_readfirstlane_b32 s38, v34
    s_nop 1
    s_cmp_ge_u32 s38, 20
    s_cbranch_scc1 L_st4_ok
L_st4:
    ds_read_b32 v34, v32 offset:16
    s_waitcnt lgkmcnt(0)
    v_readfirstlane_b32 s38, v34
    s_nop 1
    s_cmp_ge_u32 s38, 20
    s_cbranch_scc1 L_st4_ok
    s_sub_u32 s96, s96, 1
    s_cbranch_scc1 L_st4_ok
    s_sleep 0
    s_branch L_st4
L_st4_ok:
    ds_read_b128 v[224:227], v22 offset:16384
    ds_read_b128 v[228:231], v22 offset:18432
    ds_read_b128 v[232:235], v22 offset:20480
    ds_read_b128 v[236:239], v22 offset:22528
    s_waitcnt vmcnt(21)
    v_mfma_f32_16x16x32_bf16 v[128:131], v[240:243], v[184:187], v[128:131]
    v_mfma_f32_16x16x32_bf16 v[132:135], v[244:247], v[184:187], v[132:135]
    v_mfma_f32_16x16x32_bf16 v[136:139], v[248:251], v[184:187], v[136:139]
    v_mfma_f32_16x16x32_bf16 v[140:143], v[252:255], v[184:187], v[140:143]
    buffer_load_dwordx4 v[184:187], v29, s[12:15], s49 offen offset:2048 sc1
    buffer_load_dwordx4 v19, s[28:31], s21 offen offset:3072  lds
    v_mfma_f32_16x16x32_bf16 v[144:147], v[240:243], v[188:191], v[144:147]
    v_mfma_f32_16x16x32_bf16 v[148:151], v[244:247], v[188:191], v[148:151]
    v_mfma_f32_16x16x32_bf16 v[152:155], v[248:251], v[188:191], v[152:155]
    v_mfma_f32_16x16x32_bf16 v[156:159], v[252:255], v[188:191], v[156:159]
    buffer_load_dwordx4 v[188:191], v29, s[12:15], s49 offen offset:3072 sc1
    ds_read_b128 v[240:243], v23 offset:16384
    ds_read_b128 v[244:247], v23 offset:18432
    ds_read_b128 v[248:251], v23 offset:20480
    ds_read_b128 v[252:255], v23 offset:22528
    s_waitcnt vmcnt(21) lgkmcnt(4)
    v_mfma_f32_16x16x32_bf16 v[128:131], v[224:227], v[192:195], v[128:131]
    v_mfma_f32_16x16x32_bf16 v[132:135], v[228:231], v[192:195], v[132:135]
    v_mfma_f32_16x16x32_bf16 v[136:139], v[232:235], v[192:195], v[136:139]
    v_mfma_f32_16x16x32_bf16 v[140:143], v[236:239], v[192:195], v[140:143]
    s_add_u32 s49, s55, 7
    s_and_b32 s49, s49, 15
    s_lshl_b32 s49, s49, 15
    s_add_u32 s49, s49, s50
    buffer_load_dwordx4 v[192:195], v28, s[12:15], s49 offen offset:0 sc1
    s_add_u32 m0, s23, 32768
    s_add_u32 s21, s55, 8
    s_and_b32 s21, s21, 15
    s_lshl_b32 s21, s21, 7
    buffer_load_dwordx4 v16, s[28:31], s21 offen offset:0  lds
    v_mfma_f32_16x16x32_bf16 v[144:147], v[224:227], v[196:199], v[144:147]
    v_mfma_f32_16x16x32_bf16 v[148:151], v[228:231], v[196:199], v[148:151]
    v_mfma_f32_16x16x32_bf16 v[152:155], v[232:235], v[196:199], v[152:155]
    v_mfma_f32_16x16x32_bf16 v[156:159], v[236:239], v[196:199], v[156:159]
    buffer_load_dwordx4 v[196:199], v28, s[12:15], s49 offen offset:1024 sc1
    ds_read_b128 v[224:227], v22 offset:24576
    ds_read_b128 v[228:231], v22 offset:26624
    ds_read_b128 v[232:235], v22 offset:28672
    ds_read_b128 v[236:239], v22 offset:30720
    s_waitcnt vmcnt(16) lgkmcnt(4)
    s_mov_b64 exec, 1
    ds_add_u32 v32, v33 offset:16
    s_mov_b64 exec, -1
    v_mfma_f32_16x16x32_bf16 v[128:131], v[240:243], v[200:203], v[128:131]
    v_mfma_f32_16x16x32_bf16 v[132:135], v[244:247], v[200:203], v[132:135]
    v_mfma_f32_16x16x32_bf16 v[136:139], v[248:251], v[200:203], v[136:139]
    v_mfma_f32_16x16x32_bf16 v[140:143], v[252:255], v[200:203], v[140:143]
    buffer_load_dwordx4 v[200:203], v28, s[12:15], s49 offen offset:2048 sc1
    buffer_load_dwordx4 v17, s[28:31], s21 offen offset:1024  lds
    v_mfma_f32_16x16x32_bf16 v[144:147], v[240:243], v[204:207], v[144:147]
    v_mfma_f32_16x16x32_bf16 v[148:151], v[244:247], v[204:207], v[148:151]
    v_mfma_f32_16x16x32_bf16 v[152:155], v[248:251], v[204:207], v[152:155]
    v_mfma_f32_16x16x32_bf16 v[156:159], v[252:255], v[204:207], v[156:159]
    buffer_load_dwordx4 v[204:207], v28, s[12:15], s49 offen offset:3072 sc1
    ds_read_b128 v[240:243], v23 offset:24576
    ds_read_b128 v[244:247], v23 offset:26624
    ds_read_b128 v[248:251], v23 offset:28672
    ds_read_b128 v[252:255], v23 offset:30720
    s_waitcnt vmcnt(21) lgkmcnt(4)
    v_mfma_f32_16x16x32_bf16 v[128:131], v[224:227], v[208:211], v[128:131]
    v_mfma_f32_16x16x32_bf16 v[132:135], v[228:231], v[208:211], v[132:135]
    v_mfma_f32_16x16x32_bf16 v[136:139], v[232:235], v[208:211], v[136:139]
    v_mfma_f32_16x16x32_bf16 v[140:143], v[236:239], v[208:211], v[140:143]
    ds_read_b32 v34, v32 offset:16
    buffer_load_dwordx4 v[208:211], v29, s[12:15], s49 offen offset:0 sc1
    buffer_load_dwordx4 v18, s[28:31], s21 offen offset:2048  lds
    v_mfma_f32_16x16x32_bf16 v[144:147], v[224:227], v[212:215], v[144:147]
    v_mfma_f32_16x16x32_bf16 v[148:151], v[228:231], v[212:215], v[148:151]
    v_mfma_f32_16x16x32_bf16 v[152:155], v[232:235], v[212:215], v[152:155]
    v_mfma_f32_16x16x32_bf16 v[156:159], v[236:239], v[212:215], v[156:159]
    buffer_load_dwordx4 v[212:215], v29, s[12:15], s49 offen offset:1024 sc1
    s_waitcnt lgkmcnt(0)
    v_readfirstlane_b32 s38, v34
    s_nop 1
    s_cmp_ge_u32 s38, 24
    s_cbranch_scc1 L_st5_ok
L_st5:
    ds_read_b32 v34, v32 offset:16
    s_waitcnt lgkmcnt(0)
    v_readfirstlane_b32 s38, v34
    s_nop 1
    s_cmp_ge_u32 s38, 24
    s_cbranch_scc1 L_st5_ok
    s_sub_u32 s96, s96, 1
    s_cbranch_scc1 L_st5_ok
    s_sleep 0
    s_branch L_st5
L_st5_ok:
    ds_read_b128 v[224:227], v20 offset:0
    ds_read_b128 v[228:231], v20 offset:2048
    ds_read_b128 v[232:235], v20 offset:4096
    ds_read_b128 v[236:239], v20 offset:6144
    s_waitcnt vmcnt(21)
    v_mfma_f32_16x16x32_bf16 v[128:131], v[240:243], v[216:219], v[128:131]
    v_mfma_f32_16x16x32_bf16 v[132:135], v[244:247], v[216:219], v[132:135]
    v_mfma_f32_16x16x32_bf16 v[136:139], v[248:251], v[216:219], v[136:139]
    v_mfma_f32_16x16x32_bf16 v[140:143], v[252:255], v[216:219], v[140:143]
    buffer_load_dwordx4 v[216:219], v29, s[12:15], s49 offen offset:2048 sc1
    buffer_load_dwordx4 v19, s[28:31], s21 offen offset:3072  lds
    v_mfma_f32_16x16x32_bf16 v[144:147], v[240:243], v[220:223], v[144:147]
    v_mfma_f32_16x16x32_bf16 v[148:151], v[244:247], v[220:223], v[148:151]
    v_mfma_f32_16x16x32_bf16 v[152:155], v[248:251], v[220:223], v[152:155]
    v_mfma_f32_16x16x32_bf16 v[156:159], v[252:255], v[220:223], v[156:159]
    buffer_load_dwordx4 v[220:223], v29, s[12:15], s49 offen offset:3072 sc1
    ds_read_b128 v[240:243], v21 offset:0
    ds_read_b128 v[244:247], v21 offset:2048
    ds_read_b128 v[248:251], v21 offset:4096
    ds_read_b128 v[252:255], v21 offset:6144
    s_waitcnt vmcnt(21) lgkmcnt(4)
    v_mfma_f32_16x16x32_bf16 v[128:131], v[224:227], v[160:163], v[128:131]
    v_mfma_f32_16x16x32_bf16 v[132:135], v[228:231], v[160:163], v[132:135]
    v_mfma_f32_16x16x32_bf16 v[136:139], v[232:235], v[160:163], v[136:139]
    v_mfma_f32_16x16x32_bf16 v[140:143], v[236:239], v[160:163], v[140:143]
    s_add_u32 s49, s55, 8
    s_and_b32 s49, s49, 15
    s_lshl_b32 s49, s49, 15
    s_add_u32 s49, s49, s50
    buffer_load_dwordx4 v[160:163], v28, s[12:15], s49 offen offset:0 sc1
    s_add_u32 m0, s23, 49152
    s_add_u32 s21, s55, 9
    s_and_b32 s21, s21, 15
    s_lshl_b32 s21, s21, 7
    buffer_load_dwordx4 v16, s[28:31], s21 offen offset:0  lds
    v_mfma_f32_16x16x32_bf16 v[144:147], v[224:227], v[164:167], v[144:147]
    v_mfma_f32_16x16x32_bf16 v[148:151], v[228:231], v[164:167], v[148:151]
    v_mfma_f32_16x16x32_bf16 v[152:155], v[232:235], v[164:167], v[152:155]
    v_mfma_f32_16x16x32_bf16 v[156:159], v[236:239], v[164:167], v[156:159]
    buffer_load_dwordx4 v[164:167], v28, s[12:15], s49 offen offset:1024 sc1
    ds_read_b128 v[224:227], v20 offset:8192
    ds_read_b128 v[228:231], v20 offset:10240
    ds_read_b128 v[232:235], v20 offset:12288
    ds_read_b128 v[236:239], v20 offset:14336
    s_waitcnt vmcnt(16) lgkmcnt(4)
    s_mov_b64 exec, 1
    ds_add_u32 v32, v33 offset:16
    s_mov_b64 exec, -1
    v_mfma_f32_16x16x32_bf16 v[128:131], v[240:243], v[168:171], v[128:131]
    v_mfma_f32_16x16x32_bf16 v[132:135], v[244:247], v[168:171], v[132:135]
    v_mfma_f32_16x16x32_bf16 v[136:139], v[248:251], v[168:171], v[136:139]
    v_mfma_f32_16x16x32_bf16 v[140:143], v[252:255], v[168:171], v[140:143]
    buffer_load_dwordx4 v[168:171], v28, s[12:15], s49 offen offset:2048 sc1
    buffer_load_dwordx4 v17, s[28:31], s21 offen offset:1024  lds
    v_mfma_f32_16x16x32_bf16 v[144:147], v[240:243], v[172:175], v[144:147]
    v_mfma_f32_16x16x32_bf16 v[148:151], v[244:247], v[172:175], v[148:151]
    v_mfma_f32_16x16x32_bf16 v[152:155], v[248:251], v[172:175], v[152:155]
    v_mfma_f32_16x16x32_bf16 v[156:159], v[252:255], v[172:175], v[156:159]
    buffer_load_dwordx4 v[172:175], v28, s[12:15], s49 offen offset:3072 sc1
    ds_read_b128 v[240:243], v21 offset:8192
    ds_read_b128 v[244:247], v21 offset:10240
    ds_read_b128 v[248:251], v21 offset:12288
    ds_read_b128 v[252:255], v21 offset:14336
    s_waitcnt vmcnt(21) lgkmcnt(4)
    v_mfma_f32_16x16x32_bf16 v[128:131], v[224:227], v[176:179], v[128:131]
    v_mfma_f32_16x16x32_bf16 v[132:135], v[228:231], v[176:179], v[132:135]
    v_mfma_f32_16x16x32_bf16 v[136:139], v[232:235], v[176:179], v[136:139]
    v_mfma_f32_16x16x32_bf16 v[140:143], v[236:239], v[176:179], v[140:143]
    ds_read_b32 v34, v32 offset:16
    buffer_load_dwordx4 v[176:179], v29, s[12:15], s49 offen offset:0 sc1
    buffer_load_dwordx4 v18, s[28:31], s21 offen offset:2048  lds
    v_mfma_f32_16x16x32_bf16 v[144:147], v[224:227], v[180:183], v[144:147]
    v_mfma_f32_16x16x32_bf16 v[148:151], v[228:231], v[180:183], v[148:151]
    v_mfma_f32_16x16x32_bf16 v[152:155], v[232:235], v[180:183], v[152:155]
    v_mfma_f32_16x16x32_bf16 v[156:159], v[236:239], v[180:183], v[156:159]
    buffer_load_dwordx4 v[180:183], v29, s[12:15], s49 offen offset:1024 sc1
    s_waitcnt lgkmcnt(0)
    v_readfirstlane_b32 s38, v34
    s_nop 1
    s_cmp_ge_u32 s38, 28
    s_cbranch_scc1 L_st6_ok
L_st6:
    ds_read_b32 v34, v32 offset:16
    s_waitcnt lgkmcnt(0)
    v_readfirstlane_b32 s38, v34
    s_nop 1
    s_cmp_ge_u32 s38, 28
    s_cbranch_scc1 L_st6_ok
    s_sub_u32 s96, s96, 1
    s_cbranch_scc1 L_st6_ok
    s_sleep 0
    s_branch L_st6
L_st6_ok:
    ds_read_b128 v[224:227], v20 offset:16384
    ds_read_b128 v[228:231], v20 offset:18432
    ds_read_b128 v[232:235], v20 offset:20480
    ds_read_b128 v[236:239], v20 offset:22528
    s_waitcnt vmcnt(21)
    v_mfma_f32_16x16x32_bf16 v[128:131], v[240:243], v[184:187], v[128:131]
    v_mfma_f32_16x16x32_bf16 v[132:135], v[244:247], v[184:187], v[132:135]
    v_mfma_f32_16x16x32_bf16 v[136:139], v[248:251], v[184:187], v[136:139]
    v_mfma_f32_16x16x32_bf16 v[140:143], v[252:255], v[184:187], v[140:143]
    buffer_load_dwordx4 v[184:187], v29, s[12:15], s49 offen offset:2048 sc1
    buffer_load_dwordx4 v19, s[28:31], s21 offen offset:3072  lds
    v_mfma_f32_16x16x32_bf16 v[144:147], v[240:243], v[188:191], v[144:147]
    v_mfma_f32_16x16x32_bf16 v[148:151], v[244:247], v[188:191], v[148:151]
    v_mfma_f32_16x16x32_bf16 v[152:155], v[248:251], v[188:191], v[152:155]
    v_mfma_f32_16x16x32_bf16 v[156:159], v[252:255], v[188:191], v[156:159]
    buffer_load_dwordx4 v[188:191], v29, s[12:15], s49 offen offset:3072 sc1
    ds_read_b128 v[240:243], v21 offset:16384
    ds_read_b128 v[244:247], v21 offset:18432
    ds_read_b128 v[248:251], v21 offset:20480
    ds_read_b128 v[252:255], v21 offset:22528
    s_waitcnt vmcnt(21) lgkmcnt(4)
    v_mfma_f32_16x16x32_bf16 v[128:131], v[224:227], v[192:195], v[128:131]
    v_mfma_f32_16x16x32_bf16 v[132:135], v[228:231], v[192:195], v[132:135]
    v_mfma_f32_16x16x32_bf16 v[136:139], v[232:235], v[192:195], v[136:139]
    v_mfma_f32_16x16x32_bf16 v[140:143], v[236:239], v[192:195], v[140:143]
    s_add_u32 s49, s55, 9
    s_and_b32 s49, s49, 15
    s_lshl_b32 s49, s49, 15
    s_add_u32 s49, s49, s50
    buffer_load_dwordx4 v[192:195], v28, s[12:15], s49 offen offset:0 sc1
    s_add_u32 m0, s23, 81920
    s_add_u32 s21, s55, 10
    s_and_b32 s21, s21, 15
    s_lshl_b32 s21, s21, 7
    buffer_load_dwordx4 v16, s[28:31], s21 offen offset:0  lds
    v_mfma_f32_16x16x32_bf16 v[144:147], v[224:227], v[196:199], v[144:147]
    v_mfma_f32_16x16x32_bf16 v[148:151], v[228:231], v[196:199], v[148:151]
    v_mfma_f32_16x16x32_bf16 v[152:155], v[232:235], v[196:199], v[152:155]
    v_mfma_f32_16x16x32_bf16 v[156:159], v[236:239], v[196:199], v[156:159]
    buffer_load_dwordx4 v[196:199], v28, s[12:15], s49 offen offset:1024 sc1
    ds_read_b128 v[224:227], v20 offset:24576
    ds_read_b128 v[228:231], v20 offset:26624
    ds_read_b128 v[232:235], v20 offset:28672
    ds_read_b128 v[236:239], v20 offset:30720
    s_waitcnt vmcnt(16) lgkmcnt(4)
    s_mov_b64 exec, 1
    ds_add_u32 v32, v33 offset:16
    s_mov_b64 exec, -1
    v_mfma_f32_16x16x32_bf16 v[128:131], v[240:243], v[200:203], v[128:131]
    v_mfma_f32_16x16x32_bf16 v[132:135], v[244:247], v[200:203], v[132:135]
    v_mfma_f32_16x16x32_bf16 v[136:139], v[248:251], v[200:203], v[136:139]
    v_mfma_f32_16x16x32_bf16 v[140:143], v[252:255], v[200:203], v[140:143]
    buffer_load_dwordx4 v[200:203], v28, s[12:15], s49 offen offset:2048 sc1
    buffer_load_dwordx4 v17, s[28:31], s21 offen offset:1024  lds
    v_mfma_f32_16x16x32_bf16 v[144:147], v[240:243], v[204:207], v[144:147]
    v_mfma_f32_16x16x32_bf16 v[148:151], v[244:247], v[204:207], v[148:151]
    v_mfma_f32_16x16x32_bf16 v[152:155], v[248:251], v[204:207], v[152:155]
    v_mfma_f32_16x16x32_bf16 v[156:159], v[252:255], v[204:207], v[156:159]
    buffer_load_dwordx4 v[204:207], v28, s[12:15], s49 offen offset:3072 sc1
    ds_read_b128 v[240:243], v21 offset:24576
    ds_read_b128 v[244:247], v21 offset:26624
    ds_read_b128 v[248:251], v21 offset:28672
    ds_read_b128 v[252:255], v21 offset:30720
    s_waitcnt vmcnt(21) lgkmcnt(4)
    v_mfma_f32_16x16x32_bf16 v[128:131], v[224:227], v[208:211], v[128:131]
    v_mfma_f32_16x16x32_bf16 v[132:135], v[228:231], v[208:211], v[132:135]
    v_mfma_f32_16x16x32_bf16 v[136:139], v[232:235], v[208:211], v[136:139]
    v_mfma_f32_16x16x32_bf16 v[140:143], v[236:239], v[208:211], v[140:143]
    ds_read_b32 v34, v32 offset:16
    buffer_load_dwordx4 v[208:211], v29, s[12:15], s49 offen offset:0 sc1
    buffer_load_dwordx4 v18, s[28:31], s21 offen offset:2048  lds
    v_mfma_f32_16x16x32_bf16 v[144:147], v[224:227], v[212:215], v[144:147]
    v_mfma_f32_16x16x32_bf16 v[148:151], v[228:231], v[212:215], v[148:151]
    v_mfma_f32_16x16x32_bf16 v[152:155], v[232:235], v[212:215], v[152:155]
    v_mfma_f32_16x16x32_bf16 v[156:159], v[236:239], v[212:215], v[156:159]
    buffer_load_dwordx4 v[212:215], v29, s[12:15], s49 offen offset:1024 sc1
    s_waitcnt lgkmcnt(0)
    v_readfirstlane_b32 s38, v34
    s_nop 1
    s_cmp_ge_u32 s38, 32
    s_cbranch_scc1 L_st7_ok
L_st7:
    ds_read_b32 v34, v32 offset:16
    s_waitcnt lgkmcnt(0)
    v_readfirstlane_b32 s38, v34
    s_nop 1
    s_cmp_ge_u32 s38, 32
    s_cbranch_scc1 L_st7_ok
    s_sub_u32 s96, s96, 1
    s_cbranch_scc1 L_st7_ok
    s_sleep 0
    s_branch L_st7
L_st7_ok:
    ds_read_b128 v[224:227], v20 offset:32768
    ds_read_b128 v[228:231], v20 offset:34816
    ds_read_b128 v[232:235], v20 offset:36864
    ds_read_b128 v[236:239], v20 offset:38912
    s_waitcnt vmcnt(21)
    v_mfma_f32_16x16x32_bf16 v[128:131], v[240:243], v[216:219], v[128:131]
    v_mfma_f32_16x16x32_bf16 v[132:135], v[244:247], v[216:219], v[132:135]
    v_mfma_f32_16x16x32_bf16 v[136:139], v[248:251], v[216:219], v[136:139]
    v_mfma_f32_16x16x32_bf16 v[140:143], v[252:255], v[216:219], v[140:143]
    buffer_load_dwordx4 v[216:219], v29, s[12:15], s49 offen offset:2048 sc1
    buffer_load_dwordx4 v19, s[28:31], s21 offen offset:3072  lds
    v_mfma_f32_16x16x32_bf16 v[144:147], v[240:243], v[220:223], v[144:147]
    v_mfma_f32_16x16x32_bf16 v[148:151], v[244:247], v[220:223], v[148:151]
    v_mfma_f32_16x16x32_bf16 v[152:155], v[248:251], v[220:223], v[152:155]
    v_mfma_f32_16x16x32_bf16 v[156:159], v[252:255], v[220:223], v[156:159]
    buffer_load_dwordx4 v[220:223], v29, s[12:15], s49 offen offset:3072 sc1
    ds_read_b128 v[240:243], v21 offset:32768
    ds_read_b128 v[244:247], v21 offset:34816
    ds_read_b128 v[248:251], v21 offset:36864
    ds_read_b128 v[252:255], v21 offset:38912
    s_waitcnt vmcnt(21) lgkmcnt(4)
    v_mfma_f32_16x16x32_bf16 v[128:131], v[224:227], v[160:163], v[128:131]
    v_mfma_f32_16x16x32_bf16 v[132:135], v[228:231], v[160:163], v[132:135]
    v_mfma_f32_16x16x32_bf16 v[136:139], v[232:235], v[160:163], v[136:139]
    v_mfma_f32_16x16x32_bf16 v[140:143], v[236:239], v[160:163], v[140:143]
    s_add_u32 s49, s55, 10
    s_and_b32 s49, s49, 15
    s_lshl_b32 s49, s49, 15
    s_add_u32 s49, s49, s50
    buffer_load_dwordx4 v[160:163], v28, s[12:15], s49 offen offset:0 sc1
    s_add_u32 m0, s23, 0
    s_add_u32 s21, s55, 11
    s_and_b32 s21, s21, 15
    s_lshl_b32 s21, s21, 7
    buffer_load_dwordx4 v16, s[28:31], s21 offen offset:0  lds
    v_mfma_f32_16x16x32_bf16 v[144:147], v[224:227], v[164:167], v[144:147]
    v_mfma_f32_16x16x32_bf16 v[148:151], v[228:231], v[164:167], v[148:151]
    v_mfma_f32_16x16x32_bf16 v[152:155], v[232:235], v[164:167], v[152:155]
    v_mfma_f32_16x16x32_bf16 v[156:159], v[236:239], v[164:167], v[156:159]
    buffer_load_dwordx4 v[164:167], v28, s[12:15], s49 offen offset:1024 sc1
    ds_read_b128 v[224:227], v20 offset:40960
    ds_read_b128 v[228:231], v20 offset:43008
    ds_read_b128 v[232:235], v20 offset:45056
    ds_read_b128 v[236:239], v20 offset:47104
    s_waitcnt vmcnt(16) lgkmcnt(4)
    s_mov_b64 exec, 1
    ds_add_u32 v32, v33 offset:16
    s_mov_b64 exec, -1
    v_mfma_f32_16x16x32_bf16 v[128:131], v[240:243], v[168:171], v[128:131]
    v_mfma_f32_16x16x32_bf16 v[132:135], v[244:247], v[168:171], v[132:135]
    v_mfma_f32_16x16x32_bf16 v[136:139], v[248:251], v[168:171], v[136:139]
    v_mfma_f32_16x16x32_bf16 v[140:143], v[252:255], v[168:171], v[140:143]
    buffer_load_dwordx4 v[168:171], v28, s[12:15], s49 offen offset:2048 sc1
    buffer_load_dwordx4 v17, s[28:31], s21 offen offset:1024  lds
    v_mfma_f32_16x16x32_bf16 v[144:147], v[240:243], v[172:175], v[144:147]
    v_mfma_f32_16x16x32_bf16 v[148:151], v[244:247], v[172:175], v[148:151]
    v_mfma_f32_16x16x32_bf16 v[152:155], v[248:251], v[172:175], v[152:155]
    v_mfma_f32_16x16x32_bf16 v[156:159], v[252:255], v[172:175], v[156:159]
    buffer_load_dwordx4 v[172:175], v28, s[12:15], s49 offen offset:3072 sc1
    ds_read_b128 v[240:243], v21 offset:40960
    ds_read_b128 v[244:247], v21 offset:43008
    ds_read_b128 v[248:251], v21 offset:45056
    ds_read_b128 v[252:255], v21 offset:47104
    s_waitcnt vmcnt(21) lgkmcnt(4)
    v_mfma_f32_16x16x32_bf16 v[128:131], v[224:227], v[176:179], v[128:131]
    v_mfma_f32_16x16x32_bf16 v[132:135], v[228:231], v[176:179], v[132:135]
    v_mfma_f32_16x16x32_bf16 v[136:139], v[232:235], v[176:179], v[136:139]
    v_mfma_f32_16x16x32_bf16 v[140:143], v[236:239], v[176:179], v[140:143]
    ds_read_b32 v34, v32 offset:16
    buffer_load_dwordx4 v[176:179], v29, s[12:15], s49 offen offset:0 sc1
    buffer_load_dwordx4 v18, s[28:31], s21 offen offset:2048  lds
    v_mfma_f32_16x16x32_bf16 v[144:147], v[224:227], v[180:183], v[144:147]
    v_mfma_f32_16x16x32_bf16 v[148:151], v[228:231], v[180:183], v[148:151]
    v_mfma_f32_16x16x32_bf16 v[152:155], v[232:235], v[180:183], v[152:155]
    v_mfma_f32_16x16x32_bf16 v[156:159], v[236:239], v[180:183], v[156:159]
    buffer_load_dwordx4 v[180:183], v29, s[12:15], s49 offen offset:1024 sc1
    s_waitcnt lgkmcnt(0)
    v_readfirstlane_b32 s38, v34
    s_nop 1
    s_cmp_ge_u32 s38, 36
    s_cbranch_scc1 L_st8_ok
L_st8:
    ds_read_b32 v34, v32 offset:16
    s_waitcnt lgkmcnt(0)
    v_readfirstlane_b32 s38, v34
    s_nop 1
    s_cmp_ge_u32 s38, 36
    s_cbranch_scc1 L_st8_ok
    s_sub_u32 s96, s96, 1
    s_cbranch_scc1 L_st8_ok
    s_sleep 0
    s_branch L_st8
L_st8_ok:
    ds_read_b128 v[224:227], v20 offset:49152
    ds_read_b128 v[228:231], v20 offset:51200
    ds_read_b128 v[232:235], v20 offset:53248
    ds_read_b128 v[236:239], v20 offset:55296
    s_waitcnt vmcnt(21)
    v_mfma_f32_16x16x32_bf16 v[128:131], v[240:243], v[184:187], v[128:131]
    v_mfma_f32_16x16x32_bf16 v[132:135], v[244:247], v[184:187], v[132:135]
    v_mfma_f32_16x16x32_bf16 v[136:139], v[248:251], v[184:187], v[136:139]
    v_mfma_f32_16x16x32_bf16 v[140:143], v[252:255], v[184:187], v[140:143]
    buffer_load_dwordx4 v[184:187], v29, s[12:15], s49 offen offset:2048 sc1
    buffer_load_dwordx4 v19, s[28:31], s21 offen offset:3072  lds
    v_mfma_f32_16x16x32_bf16 v[144:147], v[240:243], v[188:191], v[144:147]
    v_mfma_f32_16x16x32_bf16 v[148:151], v[244:247], v[188:191], v[148:151]
    v_mfma_f32_16x16x32_bf16 v[152:155], v[248:251], v[188:191], v[152:155]
    v_mfma_f32_16x16x32_bf16 v[156:159], v[252:255], v[188:191], v[156:159]
    buffer_load_dwordx4 v[188:191], v29, s[12:15], s49 offen offset:3072 sc1
    ds_read_b128 v[240:243], v21 offset:49152
    ds_read_b128 v[244:247], v21 offset:51200
    ds_read_b128 v[248:251], v21 offset:53248
    ds_read_b128 v[252:255], v21 offset:55296
    s_waitcnt vmcnt(21) lgkmcnt(4)
    v_mfma_f32_16x16x32_bf16 v[128:131], v[224:227], v[192:195], v[128:131]
    v_mfma_f32_16x16x32_bf16 v[132:135], v[228:231], v[192:195], v[132:135]
    v_mfma_f32_16x16x32_bf16 v[136:139], v[232:235], v[192:195], v[136:139]
    v_mfma_f32_16x16x32_bf16 v[140:143], v[236:239], v[192:195], v[140:143]
    s_add_u32 s49, s55, 11
    s_and_b32 s49, s49, 15
    s_lshl_b32 s49, s49, 15
    s_add_u32 s49, s49, s50
    buffer_load_dwordx4 v[192:195], v28, s[12:15], s49 offen offset:0 sc1
    s_add_u32 m0, s23, 16384
    s_add_u32 s21, s55, 12
    s_and_b32 s21, s21, 15
    s_lshl_b32 s21, s21, 7
    buffer_load_dwordx4 v16, s[28:31], s21 offen offset:0  lds
    v_mfma_f32_16x16x32_bf16 v[144:147], v[224:227], v[196:199], v[144:147]
    v_mfma_f32_16x16x32_bf16 v[148:151], v[228:231], v[196:199], v[148:151]
    v_mfma_f32_16x16x32_bf16 v[152:155], v[232:235], v[196:199], v[152:155]
    v_mfma_f32_16x16x32_bf16 v[156:159], v[236:239], v[196:199], v[156:159]
    buffer_load_dwordx4 v[196:199], v28, s[12:15], s49 offen offset:1024 sc1
    ds_read_b128 v[224:227], v20 offset:57344
    ds_read_b128 v[228:231], v20 offset:59392
    ds_read_b128 v[232:235], v20 offset:61440
    ds_read_b128 v[236:239], v20 offset:63488
    s_waitcnt vmcnt(16) lgkmcnt(4)
    s_mov_b64 exec, 1
    ds_add_u32 v32, v33 offset:16
    s_mov_b64 exec, -1
    v_mfma_f32_16x16x32_bf16 v[128:131], v[240:243], v[200:203], v[128:131]
    v_mfma_f32_16x16x32_bf16 v[132:135], v[244:247], v[200:203], v[132:135]
    v_mfma_f32_16x16x32_bf16 v[136:139], v[248:251], v[200:203], v[136:139]
    v_mfma_f32_16x16x32_bf16 v[140:143], v[252:255], v[200:203], v[140:143]
    buffer_load_dwordx4 v[200:203], v28, s[12:15], s49 offen offset:2048 sc1
    buffer_load_dwordx4 v17, s[28:31], s21 offen offset:1024  lds
    v_mfma_f32_16x16x32_bf16 v[144:147], v[240:243], v[204:207], v[144:147]
    v_mfma_f32_16x16x32_bf16 v[148:151], v[244:247], v[204:207], v[148:151]
    v_mfma_f32_16x16x32_bf16 v[152:155], v[248:251], v[204:207], v[152:155]
    v_mfma_f32_16x16x32_bf16 v[156:159], v[252:255], v[204:207], v[156:159]
    buffer_load_dwordx4 v[204:207], v28, s[12:15], s49 offen offset:3072 sc1
    ds_read_b128 v[240:243], v21 offset:57344
    ds_read_b128 v[244:247], v21 offset:59392
    ds_read_b128 v[248:251], v21 offset:61440
    ds_read_b128 v[252:255], v21 offset:63488
    s_waitcnt vmcnt(21) lgkmcnt(4)
    v_mfma_f32_16x16x32_bf16 v[128:131], v[224:227], v[208:211], v[128:131]
    v_mfma_f32_16x16x32_bf16 v[132:135], v[228:231], v[208:211], v[132:135]
    v_mfma_f32_16x16x32_bf16 v[136:139], v[232:235], v[208:211], v[136:139]
    v_mfma_f32_16x16x32_bf16 v[140:143], v[236:239], v[208:211], v[140:143]
    ds_read_b32 v34, v32 offset:16
    buffer_load_dwordx4 v[208:211], v29, s[12:15], s49 offen offset:0 sc1
    buffer_load_dwordx4 v18, s[28:31], s21 offen offset:2048  lds
    v_mfma_f32_16x16x32_bf16 v[144:147], v[224:227], v[212:215], v[144:147]
    v_mfma_f32_16x16x32_bf16 v[148:151], v[228:231], v[212:215], v[148:151]
    v_mfma_f32_16x16x32_bf16 v[152:155], v[232:235], v[212:215], v[152:155]
    v_mfma_f32_16x16x32_bf16 v[156:159], v[236:239], v[212:215], v[156:159]
    buffer_load_dwordx4 v[212:215], v29, s[12:15], s49 offen offset:1024 sc1
    s_waitcnt lgkmcnt(0)
    v_readfirstlane_b32 s38, v34
    s_nop 1
    s_cmp_ge_u32 s38, 40
    s_cbranch_scc1 L_st9_ok
L_st9:
    ds_read_b32 v34, v32 offset:16
    s_waitcnt lgkmcnt(0)
    v_readfirstlane_b32 s38, v34
    s_nop 1
    s_cmp_ge_u32 s38, 40
    s_cbranch_scc1 L_st9_ok
    s_sub_u32 s96, s96, 1
    s_cbranch_scc1 L_st9_ok
    s_sleep 0
    s_branch L_st9
L_st9_ok:
    ds_read_b128 v[224:227], v22 offset:16384
    ds_read_b128 v[228:231], v22 offset:18432
    ds_read_b128 v[232:235], v22 offset:20480
    ds_read_b128 v[236:239], v22 offset:22528
    s_waitcnt vmcnt(21)
    v_mfma_f32_16x16x32_bf16 v[128:131], v[240:243], v[216:219], v[128:131]
    v_mfma_f32_16x16x32_bf16 v[132:135], v[244:247], v[216:219], v[132:135]
    v_mfma_f32_16x16x32_bf16 v[136:139], v[248:251], v[216:219], v[136:139]
    v_mfma_f32_16x16x32_bf16 v[140:143], v[252:255], v[216:219], v[140:143]
    buffer_load_dwordx4 v[216:219], v29, s[12:15], s49 offen offset:2048 sc1
    buffer_load_dwordx4 v19, s[28:31], s21 offen offset:3072  lds
    v_mfma_f32_16x16x32_bf16 v[144:147], v[240:243], v[220:223], v[144:147]
    v_mfma_f32_16x16x32_bf16 v[148:151], v[244:247], v[220:223], v[148:151]
    v_mfma_f32_16x16x32_bf16 v[152:155], v[248:251], v[220:223], v[152:155]
    v_mfma_f32_16x16x32_bf16 v[156:159], v[252:255], v[220:223], v[156:159]
    buffer_load_dwordx4 v[220:223], v29, s[12:15], s49 offen offset:3072 sc1
    ds_read_b128 v[240:243], v23 offset:16384
    ds_read_b128 v[244:247], v23 offset:18432
    ds_read_b128 v[248:251], v23 offset:20480
    ds_read_b128 v[252:255], v23 offset:22528
    s_waitcnt vmcnt(21) lgkmcnt(4)
    v_mfma_f32_16x16x32_bf16 v[128:131], v[224:227], v[160:163], v[128:131]
    v_mfma_f32_16x16x32_bf16 v[132:135], v[228:231], v[160:163], v[132:135]
    v_mfma_f32_16x16x32_bf16 v[136:139], v[232:235], v[160:163], v[136:139]
    v_mfma_f32_16x16x32_bf16 v[140:143], v[236:239], v[160:163], v[140:143]
    s_add_u32 s49, s55, 12
    s_and_b32 s49, s49, 15
    s_lshl_b32 s49, s49, 15
    s_add_u32 s49, s49, s50
    buffer_load_dwordx4 v[160:163], v28, s[12:15], s49 offen offset:0 sc1
    s_add_u32 m0, s23, 32768
    s_add_u32 s21, s55, 13
    s_and_b32 s21, s21, 15
    s_lshl_b32 s21, s21, 7
    buffer_load_dwordx4 v16, s[28:31], s21 offen offset:0  lds
    v_mfma_f32_16x16x32_bf16 v[144:147], v[224:227], v[164:167], v[144:147]
    v_mfma_f32_16x16x32_bf16 v[148:151], v[228:231], v[164:167], v[148:151]
    v_mfma_f32_16x16x32_bf16 v[152:155], v[232:235], v[164:167], v[152:155]
    v_mfma_f32_16x16x32_bf16 v[156:159], v[236:239], v[164:167], v[156:159]
    buffer_load_dwordx4 v[164:167], v28, s[12:15], s49 offen offset:1024 sc1
    ds_read_b128 v[224:227], v22 offset:24576
    ds_read_b128 v[228:231], v22 offset:26624
    ds_read_b128 v[232:235], v22 offset:28672
    ds_read_b128 v[236:239], v22 offset:30720
    s_waitcnt vmcnt(16) lgkmcnt(4)
    s_mov_b64 exec, 1
    ds_add_u32 v32, v33 offset:16
    s_mov_b64 exec, -1
    v_mfma_f32_16x16x32_bf16 v[128:131], v[240:243], v[168:171], v[128:131]
    v_mfma_f32_16x16x32_bf16 v[132:135], v[244:247], v[168:171], v[132:135]
    v_mfma_f32_16x16x32_bf16 v[136:139], v[248:251], v[168:171], v[136:139]
    v_mfma_f32_16x16x32_bf16 v[140:143], v[252:255], v[168:171], v[140:143]
    buffer_load_dwordx4 v[168:171], v28, s[12:15], s49 offen offset:2048 sc1
    buffer_load_dwordx4 v17, s[28:31], s21 offen offset:1024  lds
    v_mfma_f32_16x16x32_bf16 v[144:147], v[240:243], v[172:175], v[144:147]
    v_mfma_f32_16x16x32_bf16 v[148:151], v[244:247], v[172:175], v[148:151]
    v_mfma_f32_16x16x32_bf16 v[152:155], v[248:251], v[172:175], v[152:155]
    v_mfma_f32_16x16x32_bf16 v[156:159], v[252:255], v[172:175], v[156:159]
    buffer_load_dwordx4 v[172:175], v28, s[12:15], s49 offen offset:3072 sc1
    ds_read_b128 v[240:243], v23 offset:24576
    ds_read_b128 v[244:247], v23 offset:26624
    ds_read_b128 v[248:251], v23 offset:28672
    ds_read_b128 v[252:255], v23 offset:30720
    s_waitcnt vmcnt(21) lgkmcnt(4)
    v_mfma_f32_16x16x32_bf16 v[128:131], v[224:227], v[176:179], v[128:131]
    v_mfma_f32_16x16x32_bf16 v[132:135], v[228:231], v[176:179], v[132:135]
    v_mfma_f32_16x16x32_bf16 v[136:139], v[232:235], v[176:179], v[136:139]
    v_mfma_f32_16x16x32_bf16 v[140:143], v[236:239], v[176:179], v[140:143]
    ds_read_b32 v34, v32 offset:16
    buffer_load_dwordx4 v[176:179], v29, s[12:15], s49 offen offset:0 sc1
    buffer_load_dwordx4 v18, s[28:31], s21 offen offset:2048  lds
    v_mfma_f32_16x16x32_bf16 v[144:147], v[224:227], v[180:183], v[144:147]
    v_mfma_f32_16x16x32_bf16 v[148:151], v[228:231], v[180:183], v[148:151]
    v_mfma_f32_16x16x32_bf16 v[152:155], v[232:235], v[180:183], v[152:155]
    v_mfma_f32_16x16x32_bf16 v[156:159], v[236:239], v[180:183], v[156:159]
    buffer_load_dwordx4 v[180:183], v29, s[12:15], s49 offen offset:1024 sc1
    s_waitcnt lgkmcnt(0)
    v_readfirstlane_b32 s38, v34
    s_nop 1
    s_cmp_ge_u32 s38, 44
    s_cbranch_scc1 L_st10_ok
L_st10:
    ds_read_b32 v34, v32 offset:16
    s_waitcnt lgkmcnt(0)
    v_readfirstlane_b32 s38, v34
    s_nop 1
    s_cmp_ge_u32 s38, 44
    s_cbranch_scc1 L_st10_ok
    s_sub_u32 s96, s96, 1
    s_cbranch_scc1 L_st10_ok
    s_sleep 0
    s_branch L_st10
L_st10_ok:
    ds_read_b128 v[224:227], v20 offset:0
    ds_read_b128 v[228:231], v20 offset:2048
    ds_read_b128 v[232:235], v20 offset:4096
    ds_read_b128 v[236:239], v20 offset:6144
    s_waitcnt vmcnt(21)
    v_mfma_f32_16x16x32_bf16 v[128:131], v[240:243], v[184:187], v[128:131]
    v_mfma_f32_16x16x32_bf16 v[132:135], v[244:247], v[184:187], v[132:135]
    v_mfma_f32_16x16x32_bf16 v[136:139], v[248:251], v[184:187], v[136:139]
    v_mfma_f32_16x16x32_bf16 v[140:143], v[252:255], v[184:187], v[140:143]
    buffer_load_dwordx4 v[184:187], v29, s[12:15], s49 offen offset:2048 sc1
    buffer_load_dwordx4 v19, s[28:31], s21 offen offset:3072  lds
    v_mfma_f32_16x16x32_bf16 v[144:147], v[240:243], v[188:191], v[144:147]
    v_mfma_f32_16x16x32_bf16 v[148:151], v[244:247], v[188:191], v[148:151]
    v_mfma_f32_16x16x32_bf16 v[152:155], v[248:251], v[188:191], v[152:155]
    v_mfma_f32_16x16x32_bf16 v[156:159], v[252:255], v[188:191], v[156:159]
    buffer_load_dwordx4 v[188:191], v29, s[12:15], s49 offen offset:3072 sc1
    ds_read_b128 v[240:243], v21 offset:0
    ds_read_b128 v[244:247], v21 offset:2048
    ds_read_b128 v[248:251], v21 offset:4096
    ds_read_b128 v[252:255], v21 offset:6144
    s_waitcnt vmcnt(21) lgkmcnt(4)
    v_mfma_f32_16x16x32_bf16 v[128:131], v[224:227], v[192:195], v[128:131]
    v_mfma_f32_16x16x32_bf16 v[132:135], v[228:231], v[192:195], v[132:135]
    v_mfma_f32_16x16x32_bf16 v[136:139], v[232:235], v[192:195], v[136:139]
    v_mfma_f32_16x16x32_bf16 v[140:143], v[236:239], v[192:195], v[140:143]
    s_add_u32 s49, s55, 13
    s_and_b32 s49, s49, 15
    s_lshl_b32 s49, s49, 15
    s_add_u32 s49, s49, s50
    buffer_load_dwordx4 v[192:195], v28, s[12:15], s49 offen offset:0 sc1
    s_add_u32 m0, s23, 49152
    s_add_u32 s21, s55, 14
    s_and_b32 s21, s21, 15
    s_lshl_b32 s21, s21, 7
    buffer_load_dwordx4 v16, s[28:31], s21 offen offset:0  lds
    v_mfma_f32_16x16x32_bf16 v[144:147], v[224:227], v[196:199], v[144:147]
    v_mfma_f32_16x16x32_bf16 v[148:151], v[228:231], v[196:199], v[148:151]
    v_mfma_f32_16x16x32_bf16 v[152:155], v[232:235], v[196:199], v[152:155]
    v_mfma_f32_16x16x32_bf16 v[156:159], v[236:239], v[196:199], v[156:159]
    buffer_load_dwordx4 v[196:199], v28, s[12:15], s49 offen offset:1024 sc1
    ds_read_b128 v[224:227], v20 offset:8192
    ds_read_b128 v[228:231], v20 offset:10240
    ds_read_b128 v[232:235], v20 offset:12288
    ds_read_b128 v[236:239], v20 offset:14336
    s_waitcnt vmcnt(16) lgkmcnt(4)
    s_mov_b64 exec, 1
    ds_add_u32 v32, v33 offset:16
    s_mov_b64 exec, -1
    v_mfma_f32_16x16x32_bf16 v[128:131], v[240:243], v[200:203], v[128:131]
    v_mfma_f32_16x16x32_bf16 v[132:135], v[244:247], v[200:203], v[132:135]
    v_mfma_f32_16x16x32_bf16 v[136:139], v[248:251], v[200:203], v[136:139]
    v_mfma_f32_16x16x32_bf16 v[140:143], v[252:255], v[200:203], v[140:143]
    buffer_load_dwordx4 v[200:203], v28, s[12:15], s49 offen offset:2048 sc1
    buffer_load_dwordx4 v17, s[28:31], s21 offen offset:1024  lds
    v_mfma_f32_16x16x32_bf16 v[144:147], v[240:243], v[204:207], v[144:147]
    v_mfma_f32_16x16x32_bf16 v[148:151], v[244:247], v[204:207], v[148:151]
    v_mfma_f32_16x16x32_bf16 v[152:155], v[248:251], v[204:207], v[152:155]
    v_mfma_f32_16x16x32_bf16 v[156:159], v[252:255], v[204:207], v[156:159]
    buffer_load_dwordx4 v[204:207], v28, s[12:15], s49 offen offset:3072 sc1
    ds_read_b128 v[240:243], v21 offset:8192
    ds_read_b128 v[244:247], v21 offset:10240
    ds_read_b128 v[248:251], v21 offset:12288
    ds_read_b128 v[252:255], v21 offset:14336
    s_waitcnt vmcnt(21) lgkmcnt(4)
    v_mfma_f32_16x16x32_bf16 v[128:131], v[224:227], v[208:211], v[128:131]
    v_mfma_f32_16x16x32_bf16 v[132:135], v[228:231], v[208:211], v[132:135]
    v_mfma_f32_16x16x32_bf16 v[136:139], v[232:235], v[208:211], v[136:139]
    v_mfma_f32_16x16x32_bf16 v[140:143], v[236:239], v[208:211], v[140:143]
    ds_read_b32 v34, v32 offset:16
    buffer_load_dwordx4 v[208:211], v29, s[12:15], s49 offen offset:0 sc1
    buffer_load_dwordx4 v18, s[28:31], s21 offen offset:2048  lds
    v_mfma_f32_16x16x32_bf16 v[144:147], v[224:227], v[212:215], v[144:147]
    v_mfma_f32_16x16x32_bf16 v[148:151], v[228:231], v[212:215], v[148:151]
    v_mfma_f32_16x16x32_bf16 v[152:155], v[232:235], v[212:215], v[152:155]
    v_mfma_f32_16x16x32_bf16 v[156:159], v[236:239], v[212:215], v[156:159]
    buffer_load_dwordx4 v[212:215], v29, s[12:15], s49 offen offset:1024 sc1
    s_waitcnt lgkmcnt(0)
    v_readfirstlane_b32 s38, v34
    s_nop 1
    s_cmp_ge_u32 s38, 48
    s_cbranch_scc1 L_st11_ok
L_st11:
    ds_read_b32 v34, v32 offset:16
    s_waitcnt lgkmcnt(0)
    v_readfirstlane_b32 s38, v34
    s_nop 1
    s_cmp_ge_u32 s38, 48
    s_cbranch_scc1 L_st11_ok
    s_sub_u32 s96, s96, 1
    s_cbranch_scc1 L_st11_ok
    s_sleep 0
    s_branch L_st11
L_st11_ok:
    ds_read_b128 v[224:227], v20 offset:16384
    ds_read_b128 v[228:231], v20 offset:18432
    ds_read_b128 v[232:235], v20 offset:20480
    ds_read_b128 v[236:239], v20 offset:22528
    s_waitcnt vmcnt(21)
    v_mfma_f32_16x16x32_bf16 v[128:131], v[240:243], v[216:219], v[128:131]
    v_mfma_f32_16x16x32_bf16 v[132:135], v[244:247], v[216:219], v[132:135]
    v_mfma_f32_16x16x32_bf16 v[136:139], v[248:251], v[216:219], v[136:139]
    v_mfma_f32_16x16x32_bf16 v[140:143], v[252:255], v[216:219], v[140:143]
    buffer_load_dwordx4 v[216:219], v29, s[12:15], s49 offen offset:2048 sc1
    buffer_load_dwordx4 v19, s[28:31], s21 offen offset:3072  lds
    v_mfma_f32_16x16x32_bf16 v[144:147], v[240:243], v[220:223], v[144:147]
    v_mfma_f32_16x16x32_bf16 v[148:151], v[244:247], v[220:223], v[148:151]
    v_mfma_f32_16x16x32_bf16 v[152:155], v[248:251], v[220:223], v[152:155]
    v_mfma_f32_16x16x32_bf16 v[156:159], v[252:255], v[220:223], v[156:159]
    buffer_load_dwordx4 v[220:223], v29, s[12:15], s49 offen offset:3072 sc1
    ds_read_b128 v[240:243], v21 offset:16384
    ds_read_b128 v[244:247], v21 offset:18432
    ds_read_b128 v[248:251], v21 offset:20480
    ds_read_b128 v[252:255], v21 offset:22528
    s_waitcnt vmcnt(21) lgkmcnt(4)
    v_mfma_f32_16x16x32_bf16 v[128:131], v[224:227], v[160:163], v[128:131]
    v_mfma_f32_16x16x32_bf16 v[132:135], v[228:231], v[160:163], v[132:135]
    v_mfma_f32_16x16x32_bf16 v[136:139], v[232:235], v[160:163], v[136:139]
    v_mfma_f32_16x16x32_bf16 v[140:143], v[236:239], v[160:163], v[140:143]
    s_add_u32 s49, s55, 14
    s_and_b32 s49, s49, 15
    s_lshl_b32 s49, s49, 15
    s_add_u32 s49, s49, s50
    buffer_load_dwordx4 v[160:163], v28, s[12:15], s49 offen offset:0 sc1
    s_add_u32 m0, s23, 81920
    s_add_u32 s21, s55, 15
    s_and_b32 s21, s21, 15
    s_lshl_b32 s21, s21, 7
    buffer_load_dwordx4 v16, s[28:31], s21 offen offset:0  lds
    v_mfma_f32_16x16x32_bf16 v[144:147], v[224:227], v[164:167], v[144:147]
    v_mfma_f32_16x16x32_bf16 v[148:151], v[228:231], v[164:167], v[148:151]
    v_mfma_f32_16x16x32_bf16 v[152:155], v[232:235], v[164:167], v[152:155]
    v_mfma_f32_16x16x32_bf16 v[156:159], v[236:239], v[164:167], v[156:159]
    buffer_load_dwordx4 v[164:167], v28, s[12:15], s49 offen offset:1024 sc1
    ds_read_b128 v[224:227], v20 offset:24576
    ds_read_b128 v[228:231], v20 offset:26624
    ds_read_b128 v[232:235], v20 offset:28672
    ds_read_b128 v[236:239], v20 offset:30720
    s_waitcnt vmcnt(16) lgkmcnt(4)
    s_mov_b64 exec, 1
    ds_add_u32 v32, v33 offset:16
    s_mov_b64 exec, -1
    v_mfma_f32_16x16x32_bf16 v[128:131], v[240:243], v[168:171], v[128:131]
    v_mfma_f32_16x16x32_bf16 v[132:135], v[244:247], v[168:171], v[132:135]
    v_mfma_f32_16x16x32_bf16 v[136:139], v[248:251], v[168:171], v[136:139]
    v_mfma_f32_16x16x32_bf16 v[140:143], v[252:255], v[168:171], v[140:143]
    buffer_load_dwordx4 v[168:171], v28, s[12:15], s49 offen offset:2048 sc1
    buffer_load_dwordx4 v17, s[28:31], s21 offen offset:1024  lds
    v_mfma_f32_16x16x32_bf16 v[144:147], v[240:243], v[172:175], v[144:147]
    v_mfma_f32_16x16x32_bf16 v[148:151], v[244:247], v[172:175], v[148:151]
    v_mfma_f32_16x16x32_bf16 v[152:155], v[248:251], v[172:175], v[152:155]
    v_mfma_f32_16x16x32_bf16 v[156:159], v[252:255], v[172:175], v[156:159]
    buffer_load_dwordx4 v[172:175], v28, s[12:15], s49 offen offset:3072 sc1
    ds_read_b128 v[240:243], v21 offset:24576
    ds_read_b128 v[244:247], v21 offset:26624
    ds_read_b128 v[248:251], v21 offset:28672
    ds_read_b128 v[252:255], v21 offset:30720
    s_waitcnt vmcnt(21) lgkmcnt(4)
    v_mfma_f32_16x16x32_bf16 v[128:131], v[224:227], v[176:179], v[128:131]
    v_mfma_f32_16x16x32_bf16 v[132:135], v[228:231], v[176:179], v[132:135]
    v_mfma_f32_16x16x32_bf16 v[136:139], v[232:235], v[176:179], v[136:139]
    v_mfma_f32_16x16x32_bf16 v[140:143], v[236:239], v[176:179], v[140:143]
    ds_read_b32 v34, v32 offset:16
    buffer_load_dwordx4 v[176:179], v29, s[12:15], s49 offen offset:0 sc1
    buffer_load_dwordx4 v18, s[28:31], s21 offen offset:2048  lds
    v_mfma_f32_16x16x32_bf16 v[144:147], v[224:227], v[180:183], v[144:147]
    v_mfma_f32_16x16x32_bf16 v[148:151], v[228:231], v[180:183], v[148:151]
    v_mfma_f32_16x16x32_bf16 v[152:155], v[232:235], v[180:183], v[152:155]
    v_mfma_f32_16x16x32_bf16 v[156:159], v[236:239], v[180:183], v[156:159]
    buffer_load_dwordx4 v[180:183], v29, s[12:15], s49 offen offset:1024 sc1
    s_waitcnt lgkmcnt(0)
    v_readfirstlane_b32 s38, v34
    s_nop 1
    s_cmp_ge_u32 s38, 52
    s_cbranch_scc1 L_st12_ok
L_st12:
    ds_read_b32 v34, v32 offset:16
    s_waitcnt lgkmcnt(0)
    v_readfirstlane_b32 s38, v34
    s_nop 1
    s_cmp_ge_u32 s38, 52
    s_cbranch_scc1 L_st12_ok
    s_sub_u32 s96, s96, 1
    s_cbranch_scc1 L_st12_ok
    s_sleep 0
    s_branch L_st12
L_st12_ok:
    ds_read_b128 v[224:227], v20 offset:32768
    ds_read_b128 v[228:231], v20 offset:34816
    ds_read_b128 v[232:235], v20 offset:36864
    ds_read_b128 v[236:239], v20 offset:38912
    s_waitcnt vmcnt(21)
    v_mfma_f32_16x16x32_bf16 v[128:131], v[240:243], v[184:187], v[128:131]
    v_mfma_f32_16x16x32_bf16 v[132:135], v[244:247], v[184:187], v[132:135]
    v_mfma_f32_16x16x32_bf16 v[136:139], v[248:251], v[184:187], v[136:139]
    v_mfma_f32_16x16x32_bf16 v[140:143], v[252:255], v[184:187], v[140:143]
    buffer_load_dwordx4 v[184:187], v29, s[12:15], s49 offen offset:2048 sc1
    buffer_load_dwordx4 v19, s[28:31], s21 offen offset:3072  lds
    v_mfma_f32_16x16x32_bf16 v[144:147], v[240:243], v[188:191], v[144:147]
    v_mfma_f32_16x16x32_bf16 v[148:151], v[244:247], v[188:191], v[148:151]
    v_mfma_f32_16x16x32_bf16 v[152:155], v[248:251], v[188:191], v[152:155]
    v_mfma_f32_16x16x32_bf16 v[156:159], v[252:255], v[188:191], v[156:159]
    buffer_load_dwordx4 v[188:191], v29, s[12:15], s49 offen offset:3072 sc1
    ds_read_b128 v[240:243], v21 offset:32768
    ds_read_b128 v[244:247], v21 offset:34816
    ds_read_b128 v[248:251], v21 offset:36864
    ds_read_b128 v[252:255], v21 offset:38912
    s_waitcnt vmcnt(21) lgkmcnt(4)
    v_mfma_f32_16x16x32_bf16 v[128:131], v[224:227], v[192:195], v[128:131]
    v_mfma_f32_16x16x32_bf16 v[132:135], v[228:231], v[192:195], v[132:135]
    v_mfma_f32_16x16x32_bf16 v[136:139], v[232:235], v[192:195], v[136:139]
    v_mfma_f32_16x16x32_bf16 v[140:143], v[236:239], v[192:195], v[140:143]
    s_add_u32 s49, s55, 15
    s_and_b32 s49, s49, 15
    s_lshl_b32 s49, s49, 15
    s_add_u32 s49, s49, s50
    buffer_load_dwordx4 v[192:195], v28, s[12:15], s49 offen offset:0 sc1
    v_mfma_f32_16x16x32_bf16 v[144:147], v[224:227], v[196:199], v[144:147]
    v_mfma_f32_16x16x32_bf16 v[148:151], v[228:231], v[196:199], v[148:151]
    v_mfma_f32_16x16x32_bf16 v[152:155], v[232:235], v[196:199], v[152:155]
    v_mfma_f32_16x16x32_bf16 v[156:159], v[236:239], v[196:199], v[156:159]
    buffer_load_dwordx4 v[196:199], v28, s[12:15], s49 offen offset:1024 sc1
    ds_read_b128 v[224:227], v20 offset:40960
    ds_read_b128 v[228:231], v20 offset:43008
    ds_read_b128 v[232:235], v20 offset:45056
    ds_read_b128 v[236:239], v20 offset:47104
    s_waitcnt vmcnt(15) lgkmcnt(4)
    s_mov_b64 exec, 1
    ds_add_u32 v32, v33 offset:16
    s_mov_b64 exec, -1
    v_mfma_f32_16x16x32_bf16 v[128:131], v[240:243], v[200:203], v[128:131]
    v_mfma_f32_16x16x32_bf16 v[132:135], v[244:247], v[200:203], v[132:135]
    v_mfma_f32_16x16x32_bf16 v[136:139], v[248:251], v[200:203], v[136:139]
    v_mfma_f32_16x16x32_bf16 v[140:143], v[252:255], v[200:203], v[140:143]
    buffer_load_dwordx4 v[200:203], v28, s[12:15], s49 offen offset:2048 sc1
    v_mfma_f32_16x16x32_bf16 v[144:147], v[240:243], v[204:207], v[144:147]
    v_mfma_f32_16x16x32_bf16 v[148:151], v[244:247], v[204:207], v[148:151]
    v_mfma_f32_16x16x32_bf16 v[152:155], v[248:251], v[204:207], v[152:155]
    v_mfma_f32_16x16x32_bf16 v[156:159], v[252:255], v[204:207], v[156:159]
    buffer_load_dwordx4 v[204:207], v28, s[12:15], s49 offen offset:3072 sc1
    ds_read_b128 v[240:243], v21 offset:40960
    ds_read_b128 v[244:247], v21 offset:43008
    ds_read_b128 v[248:251], v21 offset:45056
    ds_read_b128 v[252:255], v21 offset:47104
    s_waitcnt vmcnt(19) lgkmcnt(4)
    v_mfma_f32_16x16x32_bf16 v[128:131], v[224:227], v[208:211], v[128:131]
    v_mfma_f32_16x16x32_bf16 v[132:135], v[228:231], v[208:211], v[132:135]
    v_mfma_f32_16x16x32_bf16 v[136:139], v[232:235], v[208:211], v[136:139]
    v_mfma_f32_16x16x32_bf16 v[140:143], v[236:239], v[208:211], v[140:143]
    ds_read_b32 v34, v32 offset:16
    buffer_load_dwordx4 v[208:211], v29, s[12:15], s49 offen offset:0 sc1
    v_mfma_f32_16x16x32_bf16 v[144:147], v[224:227], v[212:215], v[144:147]
    v_mfma_f32_16x16x32_bf16 v[148:151], v[228:231], v[212:215], v[148:151]
    v_mfma_f32_16x16x32_bf16 v[152:155], v[232:235], v[212:215], v[152:155]
    v_mfma_f32_16x16x32_bf16 v[156:159], v[236:239], v[212:215], v[156:159]
    buffer_load_dwordx4 v[212:215], v29, s[12:15], s49 offen offset:1024 sc1
    s_waitcnt lgkmcnt(0)
    v_readfirstlane_b32 s38, v34
    s_nop 1
    s_cmp_ge_u32 s38, 56
    s_cbranch_scc1 L_st13_ok
L_st13:
    ds_read_b32 v34, v32 offset:16
    s_waitcnt lgkmcnt(0)
    v_readfirstlane_b32 s38, v34
    s_nop 1
    s_cmp_ge_u32 s38, 56
    s_cbranch_scc1 L_st13_ok
    s_sub_u32 s96, s96, 1
    s_cbranch_scc1 L_st13_ok
    s_sleep 0
    s_branch L_st13
L_st13_ok:
    ds_read_b128 v[224:227], v20 offset:49152
    ds_read_b128 v[228:231], v20 offset:51200
    ds_read_b128 v[232:235], v20 offset:53248
    ds_read_b128 v[236:239], v20 offset:55296
    s_waitcnt vmcnt(18)
    v_mfma_f32_16x16x32_bf16 v[128:131], v[240:243], v[216:219], v[128:131]
    v_mfma_f32_16x16x32_bf16 v[132:135], v[244:247], v[216:219], v[132:135]
    v_mfma_f32_16x16x32_bf16 v[136:139], v[248:251], v[216:219], v[136:139]
    v_mfma_f32_16x16x32_bf16 v[140:143], v[252:255], v[216:219], v[140:143]
    buffer_load_dwordx4 v[216:219], v29, s[12:15], s49 offen offset:2048 sc1
    v_mfma_f32_16x16x32_bf16 v[144:147], v[240:243], v[220:223], v[144:147]
    v_mfma_f32_16x16x32_bf16 v[148:151], v[244:247], v[220:223], v[148:151]
    v_mfma_f32_16x16x32_bf16 v[152:155], v[248:251], v[220:223], v[152:155]
    v_mfma_f32_16x16x32_bf16 v[156:159], v[252:255], v[220:223], v[156:159]
    buffer_load_dwordx4 v[220:223], v29, s[12:15], s49 offen offset:3072 sc1
    ds_read_b128 v[240:243], v21 offset:49152
    ds_read_b128 v[244:247], v21 offset:51200
    ds_read_b128 v[248:251], v21 offset:53248
    ds_read_b128 v[252:255], v21 offset:55296
    s_waitcnt vmcnt(17) lgkmcnt(4)
    v_mfma_f32_16x16x32_bf16 v[128:131], v[224:227], v[160:163], v[128:131]
    v_mfma_f32_16x16x32_bf16 v[132:135], v[228:231], v[160:163], v[132:135]
    v_mfma_f32_16x16x32_bf16 v[136:139], v[232:235], v[160:163], v[136:139]
    v_mfma_f32_16x16x32_bf16 v[140:143], v[236:239], v[160:163], v[140:143]
    v_mfma_f32_16x16x32_bf16 v[144:147], v[224:227], v[164:167], v[144:147]
    v_mfma_f32_16x16x32_bf16 v[148:151], v[228:231], v[164:167], v[148:151]
    v_mfma_f32_16x16x32_bf16 v[152:155], v[232:235], v[164:167], v[152:155]
    v_mfma_f32_16x16x32_bf16 v[156:159], v[236:239], v[164:167], v[156:159]
    ds_read_b128 v[224:227], v20 offset:57344
    ds_read_b128 v[228:231], v20 offset:59392
    ds_read_b128 v[232:235], v20 offset:61440
    ds_read_b128 v[236:239], v20 offset:63488
    s_waitcnt vmcnt(9) lgkmcnt(4)
    s_mov_b64 exec, 1
    ds_add_u32 v32, v33 offset:16
    s_mov_b64 exec, -1
    v_mfma_f32_16x16x32_bf16 v[128:131], v[240:243], v[168:171], v[128:131]
    v_mfma_f32_16x16x32_bf16 v[132:135], v[244:247], v[168:171], v[132:135]
    v_mfma_f32_16x16x32_bf16 v[136:139], v[248:251], v[168:171], v[136:139]
    v_mfma_f32_16x16x32_bf16 v[140:143], v[252:255], v[168:171], v[140:143]
    v_mfma_f32_16x16x32_bf16 v[144:147], v[240:243], v[172:175], v[144:147]
    v_mfma_f32_16x16x32_bf16 v[148:151], v[244:247], v[172:175], v[148:151]
    v_mfma_f32_16x16x32_bf16 v[152:155], v[248:251], v[172:175], v[152:155]
    v_mfma_f32_16x16x32_bf16 v[156:159], v[252:255], v[172:175], v[156:159]
    ds_read_b128 v[240:243], v21 offset:57344
    ds_read_b128 v[244:247], v21 offset:59392
    ds_read_b128 v[248:251], v21 offset:61440
    ds_read_b128 v[252:255], v21 offset:63488
    s_waitcnt vmcnt(11) lgkmcnt(4)
    v_mfma_f32_16x16x32_bf16 v[128:131], v[224:227], v[176:179], v[128:131]
    v_mfma_f32_16x16x32_bf16 v[132:135], v[228:231], v[176:179], v[132:135]
    v_mfma_f32_16x16x32_bf16 v[136:139], v[232:235], v[176:179], v[136:139]
    v_mfma_f32_16x16x32_bf16 v[140:143], v[236:239], v[176:179], v[140:143]
    ds_read_b32 v34, v32 offset:16
    v_mfma_f32_16x16x32_bf16 v[144:147], v[224:227], v[180:183], v[144:147]
    v_mfma_f32_16x16x32_bf16 v[148:151], v[228:231], v[180:183], v[148:151]
    v_mfma_f32_16x16x32_bf16 v[152:155], v[232:235], v[180:183], v[152:155]
    v_mfma_f32_16x16x32_bf16 v[156:159], v[236:239], v[180:183], v[156:159]
    s_waitcnt lgkmcnt(0)
    v_readfirstlane_b32 s38, v34
    s_nop 1
    s_cmp_ge_u32 s38, 60
    s_cbranch_scc1 L_st14_ok
L_st14:
    ds_read_b32 v34, v32 offset:16
    s_waitcnt lgkmcnt(0)
    v_readfirstlane_b32 s38, v34
    s_nop 1
    s_cmp_ge_u32 s38, 60
    s_cbranch_scc1 L_st14_ok
    s_sub_u32 s96, s96, 1
    s_cbranch_scc1 L_st14_ok
    s_sleep 0
    s_branch L_st14
L_st14_ok:
    ds_read_b128 v[224:227], v22 offset:16384
    ds_read_b128 v[228:231], v22 offset:18432
    ds_read_b128 v[232:235], v22 offset:20480
    ds_read_b128 v[236:239], v22 offset:22528
    s_waitcnt vmcnt(8)
    v_mfma_f32_16x16x32_bf16 v[128:131], v[240:243], v[184:187], v[128:131]
    v_mfma_f32_16x16x32_bf16 v[132:135], v[244:247], v[184:187], v[132:135]
    v_mfma_f32_16x16x32_bf16 v[136:139], v[248:251], v[184:187], v[136:139]
    v_mfma_f32_16x16x32_bf16 v[140:143], v[252:255], v[184:187], v[140:143]
    v_mfma_f32_16x16x32_bf16 v[144:147], v[240:243], v[188:191], v[144:147]
    v_mfma_f32_16x16x32_bf16 v[148:151], v[244:247], v[188:191], v[148:151]
    v_mfma_f32_16x16x32_bf16 v[152:155], v[248:251], v[188:191], v[152:155]
    v_mfma_f32_16x16x32_bf16 v[156:159], v[252:255], v[188:191], v[156:159]
    ds_read_b128 v[240:243], v23 offset:16384
    ds_read_b128 v[244:247], v23 offset:18432
    ds_read_b128 v[248:251], v23 offset:20480
    ds_read_b128 v[252:255], v23 offset:22528
    s_waitcnt vmcnt(6) lgkmcnt(4)
    v_mfma_f32_16x16x32_bf16 v[128:131], v[224:227], v[192:195], v[128:131]
    v_mfma_f32_16x16x32_bf16 v[132:135], v[228:231], v[192:195], v[132:135]
    v_mfma_f32_16x16x32_bf16 v[136:139], v[232:235], v[192:195], v[136:139]
    v_mfma_f32_16x16x32_bf16 v[140:143], v[236:239], v[192:195], v[140:143]
    v_mfma_f32_16x16x32_bf16 v[144:147], v[224:227], v[196:199], v[144:147]
    v_mfma_f32_16x16x32_bf16 v[148:151], v[228:231], v[196:199], v[148:151]
    v_mfma_f32_16x16x32_bf16 v[152:155], v[232:235], v[196:199], v[152:155]
    v_mfma_f32_16x16x32_bf16 v[156:159], v[236:239], v[196:199], v[156:159]
    ds_read_b128 v[224:227], v22 offset:24576
    ds_read_b128 v[228:231], v22 offset:26624
    ds_read_b128 v[232:235], v22 offset:28672
    ds_read_b128 v[236:239], v22 offset:30720
    s_waitcnt vmcnt(4) lgkmcnt(4)
    v_mfma_f32_16x16x32_bf16 v[128:131], v[240:243], v[200:203], v[128:131]
    v_mfma_f32_16x16x32_bf16 v[132:135], v[244:247], v[200:203], v[132:135]
    v_mfma_f32_16x16x32_bf16 v[136:139], v[248:251], v[200:203], v[136:139]
    v_mfma_f32_16x16x32_bf16 v[140:143], v[252:255], v[200:203], v[140:143]
    v_mfma_f32_16x16x32_bf16 v[144:147], v[240:243], v[204:207], v[144:147]
    v_mfma_f32_16x16x32_bf16 v[148:151], v[244:247], v[204:207], v[148:151]
    v_mfma_f32_16x16x32_bf16 v[152:155], v[248:251], v[204:207], v[152:155]
    v_mfma_f32_16x16x32_bf16 v[156:159], v[252:255], v[204:207], v[156:159]
    ds_read_b128 v[240:243], v23 offset:24576
    ds_read_b128 v[244:247], v23 offset:26624
    ds_read_b128 v[248:251], v23 offset:28672
    ds_read_b128 v[252:255], v23 offset:30720
    s_waitcnt vmcnt(2) lgkmcnt(4)
    v_mfma_f32_16x16x32_bf16 v[128:131], v[224:227], v[208:211], v[128:131]
    v_mfma_f32_16x16x32_bf16 v[132:135], v[228:231], v[208:211], v[132:135]
    v_mfma_f32_16x16x32_bf16 v[136:139], v[232:235], v[208:211], v[136:139]
    v_mfma_f32_16x16x32_bf16 v[140:143], v[236:239], v[208:211], v[140:143]
    v_mfma_f32_16x16x32_bf16 v[144:147], v[224:227], v[212:215], v[144:147]
    v_mfma_f32_16x16x32_bf16 v[148:151], v[228:231], v[212:215], v[148:151]
    v_mfma_f32_16x16x32_bf16 v[152:155], v[232:235], v[212:215], v[152:155]
    v_mfma_f32_16x16x32_bf16 v[156:159], v[236:239], v[212:215], v[156:159]
    s_waitcnt vmcnt(0) lgkmcnt(0)
    v_mfma_f32_16x16x32_bf16 v[128:131], v[240:243], v[216:219], v[128:131]
    v_mfma_f32_16x16x32_bf16 v[132:135], v[244:247], v[216:219], v[132:135]
    v_mfma_f32_16x16x32_bf16 v[136:139], v[248:251], v[216:219], v[136:139]
    v_mfma_f32_16x16x32_bf16 v[140:143], v[252:255], v[216:219], v[140:143]
    v_mfma_f32_16x16x32_bf16 v[144:147], v[240:243], v[220:223], v[144:147]
    v_mfma_f32_16x16x32_bf16 v[148:151], v[244:247], v[220:223], v[148:151]
    v_mfma_f32_16x16x32_bf16 v[152:155], v[248:251], v[220:223], v[152:155]
    v_mfma_f32_16x16x32_bf16 v[156:159], v[252:255], v[220:223], v[156:159]
    s_mul_i32 s38, s18, 8704
    s_add_u32 s56, s38, 0
    v_mul_u32_u24 v56, 272, v26
    v_lshl_add_u32 v56, v25, 4, v56
    v_add_u32 v56, s56, v56
    v_mul_u32_u24 v57, 272, v25
    v_lshl_add_u32 v57, v26, 4, v57
    v_add_u32 v57, s56, v57
    v_lshlrev_b32 v58, 12, v25
    v_lshl_add_u32 v58, v26, 4, v58
    v_lshlrev_b32 v59, 2, v24
    v_add_u32 v59, 73984, v59
L_topw:
    ds_read_b32 v34, v32 offset:32
    s_waitcnt lgkmcnt(0)
    v_readfirstlane_b32 s38, v34
    s_nop 1
    s_cmp_ge_u32 s38, 1
    s_cbranch_scc1 L_topw_ok
    s_sub_u32 s96, s96, 1
    s_cbranch_scc1 L_topw_ok
    s_sleep 1
    s_branch L_topw
L_topw_ok:
    ds_read_b32 v60, v59
    v_pk_mul_f32 v[128:129], v[4:5], v[128:129] op_sel:[0,0] op_sel_hi:[0,1]
    v_pk_mul_f32 v[130:131], v[4:5], v[130:131] op_sel:[0,0] op_sel_hi:[0,1]
    ds_write_b128 v56, v[128:131] offset:0
    v_pk_mul_f32 v[132:133], v[4:5], v[132:133] op_sel:[0,0] op_sel_hi:[0,1]
    v_pk_mul_f32 v[134:135], v[4:5], v[134:135] op_sel:[0,0] op_sel_hi:[0,1]
    ds_write_b128 v56, v[132:135] offset:64
    v_pk_mul_f32 v[136:137], v[4:5], v[136:137] op_sel:[0,0] op_sel_hi:[0,1]
    v_pk_mul_f32 v[138:139], v[4:5], v[138:139] op_sel:[0,0] op_sel_hi:[0,1]
    ds_write_b128 v56, v[136:139] offset:128
    v_pk_mul_f32 v[140:141], v[4:5], v[140:141] op_sel:[0,0] op_sel_hi:[0,1]
    v_pk_mul_f32 v[142:143], v[4:5], v[142:143] op_sel:[0,0] op_sel_hi:[0,1]
    ds_write_b128 v56, v[140:143] offset:192
    v_pk_mul_f32 v[144:145], v[4:5], v[144:145] op_sel:[1,0] op_sel_hi:[1,1]
    v_pk_mul_f32 v[146:147], v[4:5], v[146:147] op_sel:[1,0] op_sel_hi:[1,1]
    ds_write_b128 v56, v[144:147] offset:4352
    v_pk_mul_f32 v[148:149], v[4:5], v[148:149] op_sel:[1,0] op_sel_hi:[1,1]
    v_pk_mul_f32 v[150:151], v[4:5], v[150:151] op_sel:[1,0] op_sel_hi:[1,1]
    ds_write_b128 v56, v[148:151] offset:4416
    v_pk_mul_f32 v[152:153], v[4:5], v[152:153] op_sel:[1,0] op_sel_hi:[1,1]
    v_pk_mul_f32 v[154:155], v[4:5], v[154:155] op_sel:[1,0] op_sel_hi:[1,1]
    ds_write_b128 v56, v[152:155] offset:4480
    v_pk_mul_f32 v[156:157], v[4:5], v[156:157] op_sel:[1,0] op_sel_hi:[1,1]
    v_pk_mul_f32 v[158:159], v[4:5], v[158:159] op_sel:[1,0] op_sel_hi:[1,1]
    ds_write_b128 v56, v[156:159] offset:4544
    s_waitcnt lgkmcnt(8)
    v_and_b32 v60, 0x7ff, v60
    s_sub_u32 s38, 2047, s51
    v_sub_u32 v60, s38, v60
    v_cmp_gt_u32 vcc, 32, v60
    s_nop 1
    s_and_b32 s57, vcc_lo, 0xff
L_fix:
    s_cmp_eq_u32 s57, 0
    s_cbranch_scc1 L_fixd
    s_ff1_i32_b32 s38, s57
    s_bitset0_b32 s57, s38
    v_readlane_b32 s39, v60, s38
    s_mov_b32 s49, s38
    v_lshl_add_u32 v170, s49, 2, v32
L_dfw:
    ds_read_b32 v34, v170 offset:36
    s_waitcnt lgkmcnt(0)
    v_readfirstlane_b32 s38, v34
    s_nop 1
    s_cmp_ge_u32 s38, 1
    s_cbranch_scc1 L_dfw_ok
    s_sub_u32 s96, s96, 1
    s_cbranch_scc1 L_dfw_ok
    s_sleep 2
    s_branch L_dfw
L_dfw_ok:
    s_lshl_b32 s38, s49, 8
    s_add_u32 s38, s38, 75776
    v_lshl_add_u32 v169, v26, 4, s38
    s_mul_i32 s39, s39, 272
    s_add_u32 s39, s39, s56
    v_lshl_add_u32 v168, v26, 4, s39
    ds_read_b128 v[160:163], v168
    ds_read_b128 v[164:167], v169
    s_waitcnt lgkmcnt(0)
    v_pk_add_f32 v[160:161], v[160:161], v[164:165]
    v_pk_add_f32 v[162:163], v[162:163], v[166:167]
    ds_write_b128 v168, v[160:163]
    s_waitcnt lgkmcnt(0)
    s_branch L_fix
L_fixd:
    ds_read_b128 v[128:131], v57 offset:0
    ds_read_b128 v[132:135], v57 offset:1088
    ds_read_b128 v[136:139], v57 offset:2176
    ds_read_b128 v[140:143], v57 offset:3264
    ds_read_b128 v[144:147], v57 offset:4352
    ds_read_b128 v[148:151], v57 offset:5440
    ds_read_b128 v[152:155], v57 offset:6528
    ds_read_b128 v[156:159], v57 offset:7616
    s_lshl_b32 s38, s51, 12
    s_lshl_b32 s39, s17, 8
    s_add_u32 s38, s38, s39
    s_waitcnt lgkmcnt(7)
    v_pk_add_f32 v[128:129], v[128:129], v[72:73]
    v_pk_add_f32 v[130:131], v[130:131], v[74:75]
    buffer_store_dwordx4 v[128:131], v58, s[32:35], s38 offen sc1
    s_add_u32 s38, s38, 16384
    s_waitcnt lgkmcnt(6)
    v_pk_add_f32 v[132:133], v[132:133], v[76:77]
    v_pk_add_f32 v[134:135], v[134:135], v[78:79]
    buffer_store_dwordx4 v[132:135], v58, s[32:35], s38 offen sc1
    s_add_u32 s38, s38, 16384
    s_waitcnt lgkmcnt(5)
    v_pk_add_f32 v[136:137], v[136:137], v[88:89]
    v_pk_add_f32 v[138:139], v[138:139], v[90:91]
    buffer_store_dwordx4 v[136:139], v58, s[32:35], s38 offen sc1
    s_add_u32 s38, s38, 16384
    s_waitcnt lgkmcnt(4)
    v_pk_add_f32 v[140:141], v[140:141], v[92:93]
    v_pk_add_f32 v[142:143], v[142:143], v[94:95]
    buffer_store_dwordx4 v[140:143], v58, s[32:35], s38 offen sc1
    s_add_u32 s38, s38, 16384
    s_waitcnt lgkmcnt(3)
    v_pk_add_f32 v[144:145], v[144:145], v[104:105]
    v_pk_add_f32 v[146:147], v[146:147], v[106:107]
    buffer_store_dwordx4 v[144:147], v58, s[32:35], s38 offen sc1
    s_add_u32 s38, s38, 16384
    s_waitcnt lgkmcnt(2)
    v_pk_add_f32 v[148:149], v[148:149], v[108:109]
    v_pk_add_f32 v[150:151], v[150:151], v[110:111]
    buffer_store_dwordx4 v[148:151], v58, s[32:35], s38 offen sc1
    s_add_u32 s38, s38, 16384
    s_waitcnt lgkmcnt(1)
    v_pk_add_f32 v[152:153], v[152:153], v[120:121]
    v_pk_add_f32 v[154:155], v[154:155], v[122:123]
    buffer_store_dwordx4 v[152:155], v58, s[32:35], s38 offen sc1
    s_add_u32 s38, s38, 16384
    s_waitcnt lgkmcnt(0)
    v_pk_add_f32 v[156:157], v[156:157], v[124:125]
    v_pk_add_f32 v[158:159], v[158:159], v[126:127]
    buffer_store_dwordx4 v[156:159], v58, s[32:35], s38 offen sc1
    s_add_u32 s38, s38, 16384
    s_endpgm
L_code_end:
.section .rodata,"a"
.p2align 6
.amdhsa_kernel gated_mix__ssm_conv_s5__moe_arch_mod__prompt_kernel
  .amdhsa_next_free_vgpr 256
  .amdhsa_next_free_sgpr 100
  .amdhsa_accum_offset 256
  .amdhsa_group_segment_fixed_size 0
  .amdhsa_kernarg_size 144
  .amdhsa_user_sgpr_count 2
  .amdhsa_user_sgpr_kernarg_segment_ptr 1
  .amdhsa_system_sgpr_workgroup_id_x 1
  .amdhsa_float_denorm_mode_32 3
.end_amdhsa_kernel
```

```asm
; @launch grid=(256,1,1) block=(512,1,1) lds=163840
.amdgcn_target "amdgcn-amd-amdhsa--gfx950"
.text
.globl gated_mix__ssm_conv_s5__moe_arch_mod__prompt_kernel
.p2align 8
.type gated_mix__ssm_conv_s5__moe_arch_mod__prompt_kernel,@function
gated_mix__ssm_conv_s5__moe_arch_mod__prompt_kernel:
L_code_start:
    s_getpc_b64 s[32:33]
    s_load_dwordx2 s[40:41], s[0:1], 0
    s_load_dwordx16 s[64:79], s[0:1], 8
    s_load_dwordx8 s[44:51], s[0:1], 80
    s_load_dwordx4 s[80:83], s[0:1], 112
    s_load_dwordx2 s[42:43], s[0:1], 136
    v_lshrrev_b32 v1, 6, v0
    s_cmp_ge_u32 s2, 256
    s_cbranch_scc1 L_exit
    s_sub_u32 s32, s32, 4
    s_subb_u32 s33, s33, 0
    s_mov_b32 s34, L_code_end-L_code_start
    s_mov_b32 s35, 0x20000
    s_lshr_b32 s59, s2, 3
    s_lshl_b32 s59, s59, 11
    v_lshlrev_b32 v2, 2, v0
    buffer_load_dword v9, v2, s[32:35], s59 offen
    v_readfirstlane_b32 s18, v1
    s_mov_b32 s96, 1048576
    s_and_b32 s3, s2, 7
    s_lshr_b32 s39, s3, 2
    s_lshl_b32 s39, s39, 1
    s_xor_b32 s3, s3, s39
    s_lshr_b32 s38, s2, 3
    s_lshr_b32 s16, s3, 1
    s_lshl_b32 s16, s16, 2
    s_and_b32 s39, s38, 3
    s_add_u32 s16, s16, s39
    s_and_b32 s17, s3, 1
    s_lshl_b32 s17, s17, 3
    s_lshr_b32 s39, s38, 2
    s_add_u32 s17, s17, s39
    s_cmp_ge_u32 s18, 4
    s_cbranch_scc1 L_side
    v_and_b32 v26, 15, v0
    v_bfe_u32 v4, v0, 7, 1
    v_lshl_add_u32 v4, v4, 5, v26
    s_lshl_b32 s39, s17, 6
    v_add_lshl_u32 v255, s39, v4, 1
    s_waitcnt lgkmcnt(0)
    global_load_ushort v224, v255, s[64:65] offset:0
    global_load_ushort v226, v255, s[66:67] offset:0
    global_load_ushort v228, v255, s[76:77] offset:0
    global_load_ushort v225, v255, s[64:65] offset:32
    global_load_ushort v227, v255, s[66:67] offset:32
    global_load_ushort v229, v255, s[76:77] offset:32
    s_branch L_gemm
L_side:
    s_sub_u32 s18, s18, 4
    v_and_b32 v2, 63, v0
    s_lshl_b32 s19, s3, 8
    s_lshl_b32 s39, s38, 3
    s_add_u32 s19, s19, s39
    s_mov_b32 s56, 0
    s_lshl_b32 s58, s18, 12
    v_lshrrev_b32 v4, 3, v2
    v_and_b32 v5, 7, v2
    v_lshrrev_b32 v6, 4, v2
    v_xor_b32 v5, v5, v6
    v_lshlrev_b32 v5, 4, v5
    v_lshrrev_b32 v7, 1, v2
    v_and_b32 v7, 16, v7
    v_and_or_b32 v7, v2, 8, v7
    v_and_or_b32 v6, v6, 1, v7
    s_lshr_b32 s20, s18, 1
    s_and_b32 s21, s18, 1
    s_lshl_b32 s38, s20, 6
    s_lshl_b32 s39, s21, 2
    s_add_u32 s38, s38, s39
    s_lshl_b32 s39, s16, 7
    s_add_u32 s38, s38, s39
    v_add_u32 v6, s38, v6
    v_lshl_add_u32 v6, v6, 11, v5
    v_xor_b32 v7, 64, v6
    v_add_u32 v100, 3072, v6
    v_add_u32 v101, 67584, v7
    v_add_u32 v102, 5120, v6
    v_add_u32 v103, 69632, v7
    s_lshl_b32 s38, s17, 6
    s_lshl_b32 s39, s20, 5
    s_add_u32 s38, s38, s39
    v_add_u32 v6, s38, v4
    v_lshl_add_u32 v6, v6, 11, v5
    v_xor_b32 v7, 64, v6
    v_add_u32 v104, 3072, v6
    v_add_u32 v105, 18432, v7
    v_add_u32 v106, 33792, v6
    v_add_u32 v107, 49152, v7
    s_waitcnt lgkmcnt(0)
    s_sub_u32 s8, s40, 3072
    s_subb_u32 s9, s41, 0
    s_mov_b32 s10, 4197376
    s_mov_b32 s11, 0x20000
    s_add_u32 m0, s58, 0
    s_add_u32 s57, s56, 0
    s_and_b32 s57, s57, 2047
    buffer_load_dwordx4 v100, s[8:11], s57 offen offset:0  lds
    buffer_load_dwordx4 v101, s[8:11], s57 offen offset:1024  lds
    buffer_load_dwordx4 v102, s[8:11], s57 offen offset:2048  lds
    buffer_load_dwordx4 v103, s[8:11], s57 offen offset:3072  lds
    s_cmp_eq_u32 s21, 0
    s_cselect_b32 s24, s68, s70
    s_cselect_b32 s25, s69, s71
    s_sub_u32 s24, s24, 3072
    s_subb_u32 s25, s25, 0
    s_mov_b32 s26, 2100224
    s_mov_b32 s27, 0x20000
    s_add_u32 m0, s58, 16384
    s_nop 0
    buffer_load_dwordx4 v104, s[24:27], s57 offen offset:0  lds
    buffer_load_dwordx4 v105, s[24:27], s57 offen offset:1024  lds
    buffer_load_dwordx4 v106, s[24:27], s57 offen offset:2048  lds
    buffer_load_dwordx4 v107, s[24:27], s57 offen offset:3072  lds
    s_add_u32 s94, s42, 9469952
    s_addc_u32 s95, s43, 0
    s_load_dword s93, s[94:95], 0
    s_mov_b32 s12, s42
    s_mov_b32 s13, s43
    s_mov_b32 s14, 25165824
    s_mov_b32 s15, 0x20000
    s_mov_b32 s21, 0xffff0000
    v_and_b32 v11, 15, v2
    s_add_u32 m0, s58, 32768
    s_add_u32 s57, s56, 128
    s_and_b32 s57, s57, 2047
    buffer_load_dwordx4 v100, s[8:11], s57 offen offset:0  lds
    buffer_load_dwordx4 v101, s[8:11], s57 offen offset:1024  lds
    buffer_load_dwordx4 v102, s[8:11], s57 offen offset:2048  lds
    buffer_load_dwordx4 v103, s[8:11], s57 offen offset:3072  lds
    s_add_u32 m0, s58, 49152
    s_nop 0
    buffer_load_dwordx4 v104, s[24:27], s57 offen offset:0  lds
    buffer_load_dwordx4 v105, s[24:27], s57 offen offset:1024  lds
    buffer_load_dwordx4 v106, s[24:27], s57 offen offset:2048  lds
    buffer_load_dwordx4 v107, s[24:27], s57 offen offset:3072  lds
    v_lshlrev_b32 v3, 4, v2
    s_mul_hi_u32 s23, s2, 76695845
    s_mul_i32 s38, s23, 56
    s_sub_u32 s22, s2, s38
    v_lshrrev_b32 v5, 3, v2
    v_and_b32 v8, 7, v2
    v_and_b32 v12, 3, v5
    v_lshlrev_b32 v12, 1, v12
    v_xor_b32 v8, v8, v12
    v_mul_u32_u24 v4, 7168, v5
    v_lshl_add_u32 v4, v8, 4, v4
    s_lshl_b32 s38, s18, 6
    s_lshl_b32 s39, s23, 8
    s_add_u32 s44, s38, s39
    s_mul_i32 s45, s44, 7168
    s_lshl_b32 s39, s22, 7
    s_add_u32 s45, s45, s39
    s_lshl_b32 s92, s18, 14
    s_add_u32 s92, s92, 98304
    s_mov_b32 s52, s46
    s_mov_b32 s53, s47
    s_mov_b32 s54, 7340032
    s_mov_b32 s55, 0x20000
    s_mov_b32 s28, s48
    s_mov_b32 s29, s49
    s_mov_b32 s30, 7340032
    s_mov_b32 s31, 0x20000
    s_mov_b32 s46, s92
    s_cmp_ge_u32 s2, 224
    s_cselect_b32 s54, 0, s54
    s_cselect_b32 s30, 0, s30
    s_and_b32 s39, s3, 1
    s_lshl_b32 s36, s39, 9
    s_lshr_b32 s39, s3, 1
    s_lshl_b32 s39, s39, 7
    s_add_u32 s36, s36, s39
    s_lshr_b32 s39, s2, 3
    s_lshl_b32 s39, s39, 2
    s_add_u32 s36, s36, s39
    s_add_u32 s36, s36, s18
    s_lshl_b32 s36, s36, 11
    s_add_u32 s84, s72, s36
    s_addc_u32 s85, s73, 0
    s_add_u32 s86, s74, s36
    s_addc_u32 s87, s75, 0
    s_lshr_b32 s37, s2, 3
    s_mul_i32 s37, s37, 2
    s_lshr_b32 s37, s37, 5
    v_lshlrev_b32 v5, 11, v5
    v_lshl_add_u32 v5, v8, 4, v5
    s_lshl_b32 s47, s22, 17
    s_lshl_b32 s39, s23, 9
    s_add_u32 s47, s47, s39
    s_lshl_b32 s39, s18, 7
    s_add_u32 s47, s47, s39
    s_mov_b32 s4, s50
    s_mov_b32 s5, s51
    s_mov_b32 s6, 7340032
    s_mov_b32 s7, 0x20000
    s_cmp_ge_u32 s2, 224
    s_cselect_b32 s6, 0, s6
    s_waitcnt vmcnt(8) lgkmcnt(0)
    s_barrier
    s_mul_i32 s93, s93, 1664525
    s_add_u32 s93, s93, 1013904223
    s_add_u32 m0, s58, 65536
    s_add_u32 s57, s56, 256
    s_and_b32 s57, s57, 2047
    buffer_load_dwordx4 v100, s[8:11], s57 offen offset:0  lds
    buffer_load_dwordx4 v101, s[8:11], s57 offen offset:1024  lds
    buffer_load_dwordx4 v102, s[8:11], s57 offen offset:2048  lds
    buffer_load_dwordx4 v103, s[8:11], s57 offen offset:3072  lds
    s_add_u32 m0, s58, 81920
    s_nop 0
    buffer_load_dwordx4 v104, s[24:27], s57 offen offset:0  lds
    buffer_load_dwordx4 v105, s[24:27], s57 offen offset:1024  lds
    buffer_load_dwordx4 v106, s[24:27], s57 offen offset:2048  lds
    buffer_load_dwordx4 v107, s[24:27], s57 offen offset:3072  lds
    s_load_dword s36, s[84:85], 0
    s_load_dword s36, s[86:87], 0
    s_load_dword s36, s[84:85], 64
    s_load_dword s36, s[86:87], 64
    s_cmp_lg_u32 s18, 0
    s_cbranch_scc1 L_s_nk0
    v_lshlrev_b32 v6, 2, v11
    v_add_u32 v6, 163328, v6
    ds_read_b32 v24, v6 offset:0
    ds_read_b32 v25, v6 offset:64
    ds_read_b32 v26, v6 offset:128
    ds_read_b32 v27, v6 offset:192
    ds_read_b32 v28, v6 offset:256
    ds_read_b32 v29, v6 offset:320
    ds_read_b32 v30, v6 offset:384
    ds_read_b32 v31, v6 offset:448
L_s_nk0:
    s_waitcnt vmcnt(8)
    s_barrier
    s_add_u32 m0, s58, 0
    s_add_u32 s57, s56, 384
    s_and_b32 s57, s57, 2047
    buffer_load_dwordx4 v100, s[8:11], s57 offen offset:0  lds
    buffer_load_dwordx4 v101, s[8:11], s57 offen offset:1024  lds
    buffer_load_dwordx4 v102, s[8:11], s57 offen offset:2048  lds
    buffer_load_dwordx4 v103, s[8:11], s57 offen offset:3072  lds
    s_add_u32 m0, s58, 16384
    s_nop 0
    buffer_load_dwordx4 v104, s[24:27], s57 offen offset:0  lds
    buffer_load_dwordx4 v105, s[24:27], s57 offen offset:1024  lds
    buffer_load_dwordx4 v106, s[24:27], s57 offen offset:2048  lds
    buffer_load_dwordx4 v107, s[24:27], s57 offen offset:3072  lds
    s_load_dword s36, s[84:85], 128
    s_load_dword s36, s[86:87], 128
    s_load_dword s36, s[84:85], 192
    s_load_dword s36, s[86:87], 192
    s_cmp_lg_u32 s18, 0
    s_cbranch_scc1 L_s_nk1
    v_and_b32 v7, 7, v2
    s_sub_u32 s38, 2047, s19
    v_sub_u32 v21, s38, v7
    v_lshlrev_b32 v7, 3, v7
    v_bfe_u32 v20, v2, 3, 1
    v_lshl_add_u32 v7, v20, 14, v7
    s_waitcnt lgkmcnt(0)
    v_pk_add_f32 v[24:25], v[24:25], v[26:27]
    v_pk_add_f32 v[28:29], v[28:29], v[30:31]
    v_pk_add_f32 v[24:25], v[24:25], v[28:29]
    v_add_f32 v24, v24, v25
L_s_nk1:
    s_waitcnt vmcnt(8)
    s_barrier
    s_add_u32 m0, s58, 32768
    s_add_u32 s57, s56, 512
    s_and_b32 s57, s57, 2047
    buffer_load_dwordx4 v100, s[8:11], s57 offen offset:0  lds
    buffer_load_dwordx4 v101, s[8:11], s57 offen offset:1024  lds
    buffer_load_dwordx4 v102, s[8:11], s57 offen offset:2048  lds
    buffer_load_dwordx4 v103, s[8:11], s57 offen offset:3072  lds
    s_add_u32 m0, s58, 49152
    s_nop 0
    buffer_load_dwordx4 v104, s[24:27], s57 offen offset:0  lds
    buffer_load_dwordx4 v105, s[24:27], s57 offen offset:1024  lds
    buffer_load_dwordx4 v106, s[24:27], s57 offen offset:2048  lds
    buffer_load_dwordx4 v107, s[24:27], s57 offen offset:3072  lds
    s_load_dword s36, s[84:85], 256
    s_load_dword s36, s[86:87], 256
    s_load_dword s36, s[84:85], 320
    s_load_dword s36, s[86:87], 320
    s_cmp_lg_u32 s18, 0
    s_cbranch_scc1 L_s_nk2
    v_cvt_pk_bf16_f32 v24, v24, v24
    v_lshlrev_b32 v24, 16, v24
    v_mul_f32 v26, 0xbfb8aa3b, v24
    v_exp_f32 v26, v26
    s_nop 0
    v_add_f32 v26, 1.0, v26
    v_rcp_f32 v26, v26
    s_nop 0
    v_cvt_pk_bf16_f32 v26, v26, v26
    v_lshlrev_b32 v26, 16, v26
    v_cmp_eq_u32 vcc, 1, v20
L_s_nk2:
    s_waitcnt vmcnt(8)
    s_barrier
    s_add_u32 m0, s58, 65536
    s_add_u32 s57, s56, 640
    s_and_b32 s57, s57, 2047
    buffer_load_dwordx4 v100, s[8:11], s57 offen offset:0  lds
    buffer_load_dwordx4 v101, s[8:11], s57 offen offset:1024  lds
    buffer_load_dwordx4 v102, s[8:11], s57 offen offset:2048  lds
    buffer_load_dwordx4 v103, s[8:11], s57 offen offset:3072  lds
    s_add_u32 m0, s58, 81920
    s_nop 0
    buffer_load_dwordx4 v104, s[24:27], s57 offen offset:0  lds
    buffer_load_dwordx4 v105, s[24:27], s57 offen offset:1024  lds
    buffer_load_dwordx4 v106, s[24:27], s57 offen offset:2048  lds
    buffer_load_dwordx4 v107, s[24:27], s57 offen offset:3072  lds
    s_cmp_lg_u32 s37, 0
    s_cbranch_scc1 L_s_nb3
    s_add_u32 m0, s46, 0
    s_add_u32 s39, s45, 0
    buffer_load_dwordx4 v4, s[52:55], s39 offen nt lds
    s_add_u32 m0, s46, 1024
    s_add_u32 s39, s45, 57344
    buffer_load_dwordx4 v4, s[52:55], s39 offen nt lds
    s_add_u32 m0, s46, 2048
    s_add_u32 s39, s45, 114688
    buffer_load_dwordx4 v4, s[52:55], s39 offen nt lds
    s_add_u32 m0, s46, 3072
    s_add_u32 s39, s45, 172032
    buffer_load_dwordx4 v4, s[52:55], s39 offen nt lds
    s_add_u32 m0, s46, 4096
    s_add_u32 s39, s45, 229376
    buffer_load_dwordx4 v4, s[52:55], s39 offen nt lds
    s_add_u32 m0, s46, 5120
    s_add_u32 s39, s45, 286720
    buffer_load_dwordx4 v4, s[52:55], s39 offen nt lds
    s_add_u32 m0, s46, 6144
    s_add_u32 s39, s45, 344064
    buffer_load_dwordx4 v4, s[52:55], s39 offen nt lds
    s_add_u32 m0, s46, 7168
    s_add_u32 s39, s45, 401408
    buffer_load_dwordx4 v4, s[52:55], s39 offen nt lds
    s_add_u32 m0, s46, 8192
    s_add_u32 s39, s45, 0
    buffer_load_dwordx4 v4, s[28:31], s39 offen nt lds
    s_add_u32 m0, s46, 9216
    s_add_u32 s39, s45, 57344
    buffer_load_dwordx4 v4, s[28:31], s39 offen nt lds
    s_add_u32 m0, s46, 10240
    s_add_u32 s39, s45, 114688
    buffer_load_dwordx4 v4, s[28:31], s39 offen nt lds
    s_add_u32 m0, s46, 11264
    s_add_u32 s39, s45, 172032
    buffer_load_dwordx4 v4, s[28:31], s39 offen nt lds
    s_add_u32 m0, s46, 12288
    s_add_u32 s39, s45, 229376
    buffer_load_dwordx4 v4, s[28:31], s39 offen nt lds
    s_add_u32 m0, s46, 13312
    s_add_u32 s39, s45, 286720
    buffer_load_dwordx4 v4, s[28:31], s39 offen nt lds
    s_add_u32 m0, s46, 14336
    s_add_u32 s39, s45, 344064
    buffer_load_dwordx4 v4, s[28:31], s39 offen nt lds
    s_add_u32 m0, s46, 15360
    s_add_u32 s39, s45, 401408
    buffer_load_dwordx4 v4, s[28:31], s39 offen nt lds
L_s_nb3:
    s_load_dword s36, s[84:85], 384
    s_load_dword s36, s[86:87], 384
    s_load_dword s36, s[84:85], 448
    s_load_dword s36, s[86:87], 448
    s_cmp_lg_u32 s18, 0
    s_cbranch_scc1 L_s_nk3
    v_ashrrev_i32 v25, 31, v24
    v_or_b32 v25, 0x80000000, v25
    v_xor_b32 v24, v24, v25
    v_and_or_b32 v24, v24, s21, v21
    v_cndmask_b32 v24, v24, v26, vcc
    v_mov_b32 v25, s93
    s_lshl_b32 s38, s19, 3
    s_add_u32 s38, s38, 9437184
    s_mov_b64 exec, 0xffff
    buffer_store_dwordx2 v[24:25], v7, s[12:15], s38 offen sc1
    s_mov_b64 exec, -1
L_s_nk3:
    s_waitcnt vmcnt(8)
    s_barrier
    s_add_u32 m0, s58, 0
    s_add_u32 s57, s56, 768
    s_and_b32 s57, s57, 2047
    buffer_load_dwordx4 v100, s[8:11], s57 offen offset:0  lds
    buffer_load_dwordx4 v101, s[8:11], s57 offen offset:1024  lds
    buffer_load_dwordx4 v102, s[8:11], s57 offen offset:2048  lds
    buffer_load_dwordx4 v103, s[8:11], s57 offen offset:3072  lds
    s_add_u32 m0, s58, 16384
    s_nop 0
    buffer_load_dwordx4 v104, s[24:27], s57 offen offset:0  lds
    buffer_load_dwordx4 v105, s[24:27], s57 offen offset:1024  lds
    buffer_load_dwordx4 v106, s[24:27], s57 offen offset:2048  lds
    buffer_load_dwordx4 v107, s[24:27], s57 offen offset:3072  lds
    s_load_dword s36, s[84:85], 512
    s_load_dword s36, s[86:87], 512
    s_load_dword s36, s[84:85], 576
    s_load_dword s36, s[86:87], 576
    s_waitcnt vmcnt(8)
    s_barrier
    s_add_u32 m0, s58, 32768
    s_add_u32 s57, s56, 896
    s_and_b32 s57, s57, 2047
    buffer_load_dwordx4 v100, s[8:11], s57 offen offset:0  lds
    buffer_load_dwordx4 v101, s[8:11], s57 offen offset:1024  lds
    buffer_load_dwordx4 v102, s[8:11], s57 offen offset:2048  lds
    buffer_load_dwordx4 v103, s[8:11], s57 offen offset:3072  lds
    s_add_u32 m0, s58, 49152
    s_nop 0
    buffer_load_dwordx4 v104, s[24:27], s57 offen offset:0  lds
    buffer_load_dwordx4 v105, s[24:27], s57 offen offset:1024  lds
    buffer_load_dwordx4 v106, s[24:27], s57 offen offset:2048  lds
    buffer_load_dwordx4 v107, s[24:27], s57 offen offset:3072  lds
    s_load_dword s36, s[84:85], 640
    s_load_dword s36, s[86:87], 640
    s_load_dword s36, s[84:85], 704
    s_load_dword s36, s[86:87], 704
    s_waitcnt vmcnt(8)
    s_barrier
    s_add_u32 m0, s58, 65536
    s_add_u32 s57, s56, 1024
    s_and_b32 s57, s57, 2047
    buffer_load_dwordx4 v100, s[8:11], s57 offen offset:0  lds
    buffer_load_dwordx4 v101, s[8:11], s57 offen offset:1024  lds
    buffer_load_dwordx4 v102, s[8:11], s57 offen offset:2048  lds
    buffer_load_dwordx4 v103, s[8:11], s57 offen offset:3072  lds
    s_add_u32 m0, s58, 81920
    s_nop 0
    buffer_load_dwordx4 v104, s[24:27], s57 offen offset:0  lds
    buffer_load_dwordx4 v105, s[24:27], s57 offen offset:1024  lds
    buffer_load_dwordx4 v106, s[24:27], s57 offen offset:2048  lds
    buffer_load_dwordx4 v107, s[24:27], s57 offen offset:3072  lds
    s_load_dword s36, s[84:85], 768
    s_load_dword s36, s[86:87], 768
    s_load_dword s36, s[84:85], 832
    s_load_dword s36, s[86:87], 832
    s_waitcnt vmcnt(8)
    s_barrier
    s_add_u32 m0, s58, 0
    s_add_u32 s57, s56, 1152
    s_and_b32 s57, s57, 2047
    buffer_load_dwordx4 v100, s[8:11], s57 offen offset:0  lds
    buffer_load_dwordx4 v101, s[8:11], s57 offen offset:1024  lds
    buffer_load_dwordx4 v102, s[8:11], s57 offen offset:2048  lds
    buffer_load_dwordx4 v103, s[8:11], s57 offen offset:3072  lds
    s_add_u32 m0, s58, 16384
    s_nop 0
    buffer_load_dwordx4 v104, s[24:27], s57 offen offset:0  lds
    buffer_load_dwordx4 v105, s[24:27], s57 offen offset:1024  lds
    buffer_load_dwordx4 v106, s[24:27], s57 offen offset:2048  lds
    buffer_load_dwordx4 v107, s[24:27], s57 offen offset:3072  lds
    s_cmp_lg_u32 s37, 1
    s_cbranch_scc1 L_s_nb7
    s_add_u32 m0, s46, 0
    s_add_u32 s39, s45, 0
    buffer_load_dwordx4 v4, s[52:55], s39 offen nt lds
    s_add_u32 m0, s46, 1024
    s_add_u32 s39, s45, 57344
    buffer_load_dwordx4 v4, s[52:55], s39 offen nt lds
    s_add_u32 m0, s46, 2048
    s_add_u32 s39, s45, 114688
    buffer_load_dwordx4 v4, s[52:55], s39 offen nt lds
    s_add_u32 m0, s46, 3072
    s_add_u32 s39, s45, 172032
    buffer_load_dwordx4 v4, s[52:55], s39 offen nt lds
    s_add_u32 m0, s46, 4096
    s_add_u32 s39, s45, 229376
    buffer_load_dwordx4 v4, s[52:55], s39 offen nt lds
    s_add_u32 m0, s46, 5120
    s_add_u32 s39, s45, 286720
    buffer_load_dwordx4 v4, s[52:55], s39 offen nt lds
    s_add_u32 m0, s46, 6144
    s_add_u32 s39, s45, 344064
    buffer_load_dwordx4 v4, s[52:55], s39 offen nt lds
    s_add_u32 m0, s46, 7168
    s_add_u32 s39, s45, 401408
    buffer_load_dwordx4 v4, s[52:55], s39 offen nt lds
    s_add_u32 m0, s46, 8192
    s_add_u32 s39, s45, 0
    buffer_load_dwordx4 v4, s[28:31], s39 offen nt lds
    s_add_u32 m0, s46, 9216
    s_add_u32 s39, s45, 57344
    buffer_load_dwordx4 v4, s[28:31], s39 offen nt lds
    s_add_u32 m0, s46, 10240
    s_add_u32 s39, s45, 114688
    buffer_load_dwordx4 v4, s[28:31], s39 offen nt lds
    s_add_u32 m0, s46, 11264
    s_add_u32 s39, s45, 172032
    buffer_load_dwordx4 v4, s[28:31], s39 offen nt lds
    s_add_u32 m0, s46, 12288
    s_add_u32 s39, s45, 229376
    buffer_load_dwordx4 v4, s[28:31], s39 offen nt lds
    s_add_u32 m0, s46, 13312
    s_add_u32 s39, s45, 286720
    buffer_load_dwordx4 v4, s[28:31], s39 offen nt lds
    s_add_u32 m0, s46, 14336
    s_add_u32 s39, s45, 344064
    buffer_load_dwordx4 v4, s[28:31], s39 offen nt lds
    s_add_u32 m0, s46, 15360
    s_add_u32 s39, s45, 401408
    buffer_load_dwordx4 v4, s[28:31], s39 offen nt lds
L_s_nb7:
    s_load_dword s36, s[84:85], 896
    s_load_dword s36, s[86:87], 896
    s_load_dword s36, s[84:85], 960
    s_load_dword s36, s[86:87], 960
    s_waitcnt vmcnt(8)
    s_barrier
    s_add_u32 m0, s58, 32768
    s_add_u32 s57, s56, 1280
    s_and_b32 s57, s57, 2047
    buffer_load_dwordx4 v100, s[8:11], s57 offen offset:0  lds
    buffer_load_dwordx4 v101, s[8:11], s57 offen offset:1024  lds
    buffer_load_dwordx4 v102, s[8:11], s57 offen offset:2048  lds
    buffer_load_dwordx4 v103, s[8:11], s57 offen offset:3072  lds
    s_add_u32 m0, s58, 49152
    s_nop 0
    buffer_load_dwordx4 v104, s[24:27], s57 offen offset:0  lds
    buffer_load_dwordx4 v105, s[24:27], s57 offen offset:1024  lds
    buffer_load_dwordx4 v106, s[24:27], s57 offen offset:2048  lds
    buffer_load_dwordx4 v107, s[24:27], s57 offen offset:3072  lds
    s_load_dword s36, s[84:85], 1024
    s_load_dword s36, s[86:87], 1024
    s_load_dword s36, s[84:85], 1088
    s_load_dword s36, s[86:87], 1088
    s_waitcnt vmcnt(8)
    s_barrier
    s_add_u32 m0, s58, 65536
    s_add_u32 s57, s56, 1408
    s_and_b32 s57, s57, 2047
    buffer_load_dwordx4 v100, s[8:11], s57 offen offset:0  lds
    buffer_load_dwordx4 v101, s[8:11], s57 offen offset:1024  lds
    buffer_load_dwordx4 v102, s[8:11], s57 offen offset:2048  lds
    buffer_load_dwordx4 v103, s[8:11], s57 offen offset:3072  lds
    s_add_u32 m0, s58, 81920
    s_nop 0
    buffer_load_dwordx4 v104, s[24:27], s57 offen offset:0  lds
    buffer_load_dwordx4 v105, s[24:27], s57 offen offset:1024  lds
    buffer_load_dwordx4 v106, s[24:27], s57 offen offset:2048  lds
    buffer_load_dwordx4 v107, s[24:27], s57 offen offset:3072  lds
    s_load_dword s36, s[84:85], 1152
    s_load_dword s36, s[86:87], 1152
    s_load_dword s36, s[84:85], 1216
    s_load_dword s36, s[86:87], 1216
    s_waitcnt vmcnt(8)
    s_barrier
    s_add_u32 m0, s58, 0
    s_add_u32 s57, s56, 1536
    s_and_b32 s57, s57, 2047
    buffer_load_dwordx4 v100, s[8:11], s57 offen offset:0  lds
    buffer_load_dwordx4 v101, s[8:11], s57 offen offset:1024  lds
    buffer_load_dwordx4 v102, s[8:11], s57 offen offset:2048  lds
    buffer_load_dwordx4 v103, s[8:11], s57 offen offset:3072  lds
    s_add_u32 m0, s58, 16384
    s_nop 0
    buffer_load_dwordx4 v104, s[24:27], s57 offen offset:0  lds
    buffer_load_dwordx4 v105, s[24:27], s57 offen offset:1024  lds
    buffer_load_dwordx4 v106, s[24:27], s57 offen offset:2048  lds
    buffer_load_dwordx4 v107, s[24:27], s57 offen offset:3072  lds
    s_load_dword s36, s[84:85], 1280
    s_load_dword s36, s[86:87], 1280
    s_load_dword s36, s[84:85], 1344
    s_load_dword s36, s[86:87], 1344
    s_waitcnt vmcnt(8)
    s_barrier
    s_add_u32 m0, s58, 32768
    s_add_u32 s57, s56, 1664
    s_and_b32 s57, s57, 2047
    buffer_load_dwordx4 v100, s[8:11], s57 offen offset:0  lds
    buffer_load_dwordx4 v101, s[8:11], s57 offen offset:1024  lds
    buffer_load_dwordx4 v102, s[8:11], s57 offen offset:2048  lds
    buffer_load_dwordx4 v103, s[8:11], s57 offen offset:3072  lds
    s_add_u32 m0, s58, 49152
    s_nop 0
    buffer_load_dwordx4 v104, s[24:27], s57 offen offset:0  lds
    buffer_load_dwordx4 v105, s[24:27], s57 offen offset:1024  lds
    buffer_load_dwordx4 v106, s[24:27], s57 offen offset:2048  lds
    buffer_load_dwordx4 v107, s[24:27], s57 offen offset:3072  lds
    s_load_dword s36, s[84:85], 1408
    s_load_dword s36, s[86:87], 1408
    s_load_dword s36, s[84:85], 1472
    s_load_dword s36, s[86:87], 1472
    s_waitcnt vmcnt(8)
    s_barrier
    s_add_u32 m0, s58, 65536
    s_add_u32 s57, s56, 1792
    s_and_b32 s57, s57, 2047
    buffer_load_dwordx4 v100, s[8:11], s57 offen offset:0  lds
    buffer_load_dwordx4 v101, s[8:11], s57 offen offset:1024  lds
    buffer_load_dwordx4 v102, s[8:11], s57 offen offset:2048  lds
    buffer_load_dwordx4 v103, s[8:11], s57 offen offset:3072  lds
    s_add_u32 m0, s58, 81920
    s_nop 0
    buffer_load_dwordx4 v104, s[24:27], s57 offen offset:0  lds
    buffer_load_dwordx4 v105, s[24:27], s57 offen offset:1024  lds
    buffer_load_dwordx4 v106, s[24:27], s57 offen offset:2048  lds
    buffer_load_dwordx4 v107, s[24:27], s57 offen offset:3072  lds
    s_load_dword s36, s[84:85], 1536
    s_load_dword s36, s[86:87], 1536
    s_load_dword s36, s[84:85], 1600
    s_load_dword s36, s[86:87], 1600
    s_waitcnt vmcnt(8)
    s_barrier
    s_add_u32 m0, s58, 0
    s_add_u32 s57, s56, 1920
    s_and_b32 s57, s57, 2047
    buffer_load_dwordx4 v100, s[8:11], s57 offen offset:0  lds
    buffer_load_dwordx4 v101, s[8:11], s57 offen offset:1024  lds
    buffer_load_dwordx4 v102, s[8:11], s57 offen offset:2048  lds
    buffer_load_dwordx4 v103, s[8:11], s57 offen offset:3072  lds
    s_add_u32 m0, s58, 16384
    s_nop 0
    buffer_load_dwordx4 v104, s[24:27], s57 offen offset:0  lds
    buffer_load_dwordx4 v105, s[24:27], s57 offen offset:1024  lds
    buffer_load_dwordx4 v106, s[24:27], s57 offen offset:2048  lds
    buffer_load_dwordx4 v107, s[24:27], s57 offen offset:3072  lds
    s_load_dword s36, s[84:85], 1664
    s_load_dword s36, s[86:87], 1664
    s_load_dword s36, s[84:85], 1728
    s_load_dword s36, s[86:87], 1728
    s_lshl_b32 s58, s18, 12
    s_add_u32 s58, s58, 9437184
    s_mov_b32 s57, -1
    buffer_load_dwordx4 v[80:83], v3, s[12:15], s58 offen offset:0 sc1
    buffer_load_dwordx4 v[84:87], v3, s[12:15], s58 offen offset:1024 sc1
    buffer_load_dwordx4 v[88:91], v3, s[12:15], s58 offen offset:2048 sc1
    buffer_load_dwordx4 v[92:95], v3, s[12:15], s58 offen offset:3072 sc1
    s_waitcnt vmcnt(12)
    s_barrier
    buffer_load_dwordx4 v[200:203], v5, s[4:7], s47 offen nt
    s_add_u32 s47, s47, 16384
    buffer_load_dwordx4 v[204:207], v5, s[4:7], s47 offen nt
    s_add_u32 s47, s47, 16384
    buffer_load_dwordx4 v[208:211], v5, s[4:7], s47 offen nt
    s_add_u32 s47, s47, 16384
    buffer_load_dwordx4 v[212:215], v5, s[4:7], s47 offen nt
    s_add_u32 s47, s47, 16384
    buffer_load_dwordx4 v[216:219], v5, s[4:7], s47 offen nt
    s_add_u32 s47, s47, 16384
    buffer_load_dwordx4 v[220:223], v5, s[4:7], s47 offen nt
    s_add_u32 s47, s47, 16384
    buffer_load_dwordx4 v[224:227], v5, s[4:7], s47 offen nt
    s_add_u32 s47, s47, 16384
    s_load_dword s36, s[84:85], 1792
    s_load_dword s36, s[86:87], 1792
    s_load_dword s36, s[84:85], 1856
    s_load_dword s36, s[86:87], 1856
    s_waitcnt vmcnt(11)
    s_barrier
    buffer_load_dwordx4 v[228:231], v5, s[4:7], s47 offen nt
    s_add_u32 s47, s47, 16384
    s_load_dword s36, s[84:85], 1920
    s_load_dword s36, s[86:87], 1920
    s_load_dword s36, s[84:85], 1984
    s_load_dword s36, s[86:87], 1984
    v_lshrrev_b32 v10, 4, v2
    v_bfe_u32 v12, v2, 2, 2
    v_lshl_add_u32 v13, v10, 3, v12
    v_lshlrev_b32 v13, 7, v13
    v_and_b32 v14, 3, v2
    v_lshl_add_u32 v13, v14, 3, v13
    v_add_u32 v13, s92, v13
    v_xor_b32 v14, 0, v12
    v_lshl_add_u32 v16, v14, 5, v13
    v_xor_b32 v14, 1, v12
    v_lshl_add_u32 v17, v14, 5, v13
    v_xor_b32 v14, 2, v12
    v_lshl_add_u32 v18, v14, 5, v13
    v_xor_b32 v14, 3, v12
    v_lshl_add_u32 v19, v14, 5, v13
    s_load_dwordx4 s[24:27], s[0:1], 40
    s_mov_b32 s8, s40
    s_mov_b32 s9, s41
    s_mov_b32 s10, 4194304
    s_mov_b32 s11, 0x20000
    v_mov_b32 v8, 0
    s_barrier
    s_waitcnt vmcnt(8)
L_s_poll:
    v_xor_b32 v81, s93, v81
    v_xor_b32 v83, s93, v83
    v_xor_b32 v85, s93, v85
    v_xor_b32 v87, s93, v87
    v_xor_b32 v89, s93, v89
    v_xor_b32 v91, s93, v91
    v_xor_b32 v93, s93, v93
    v_xor_b32 v95, s93, v95
    v_or3_b32 v9, v81, v83, v85
    v_or3_b32 v9, v9, v87, v89
    v_or3_b32 v9, v9, v91, v93
    v_or_b32 v9, v9, v95
    v_cmp_ne_u32 vcc, 0, v9
    s_nop 1
    s_cmp_eq_u64 vcc, 0
    s_cbranch_scc1 L_s_go
    s_sub_u32 s96, s96, 1
    s_cbranch_scc1 L_s_go
    s_sleep 8
    buffer_load_dwordx4 v[80:83], v3, s[12:15], s58 offen offset:0 sc1
    buffer_load_dwordx4 v[84:87], v3, s[12:15], s58 offen offset:1024 sc1
    buffer_load_dwordx4 v[88:91], v3, s[12:15], s58 offen offset:2048 sc1
    buffer_load_dwordx4 v[92:95], v3, s[12:15], s58 offen offset:3072 sc1
    s_waitcnt vmcnt(0)
    s_branch L_s_poll
L_s_go:
    v_sub_u32 v72, s57, v80
    v_sub_u32 v73, s57, v82
    v_sub_u32 v74, s57, v84
    v_sub_u32 v75, s57, v86
    v_sub_u32 v76, s57, v88
    v_sub_u32 v77, s57, v90
    v_sub_u32 v78, s57, v92
    v_sub_u32 v79, s57, v94
    v_min3_u32 v9, v72, v73, v74
    v_min3_u32 v15, v75, v76, v77
    v_min3_u32 v9, v9, v78, v79
    v_min_u32 v9, v9, v15
    s_nop 1
    v_min_u32_dpp v9, v9, v9 row_ror:8 row_mask:0xf bank_mask:0xf
    s_nop 1
    v_min_u32_dpp v9, v9, v9 row_ror:4 row_mask:0xf bank_mask:0xf
    s_nop 1
    v_min_u32_dpp v9, v9, v9 row_ror:2 row_mask:0xf bank_mask:0xf
    s_nop 1
    v_min_u32_dpp v9, v9, v9 row_ror:1 row_mask:0xf bank_mask:0xf
    s_nop 0
    v_readlane_b32 s48, v9, 0
    v_readlane_b32 s49, v9, 16
    v_readlane_b32 s50, v9, 32
    v_readlane_b32 s51, v9, 48
    s_nop 0
    s_min_u32 s48, s48, s49
    s_min_u32 s50, s50, s51
    s_min_u32 s48, s48, s50
    s_sub_u32 s57, s57, s48
    v_writelane_b32 v8, s57, 0
    s_sub_u32 s57, s57, 1
    v_sub_u32 v72, s57, v80
    v_sub_u32 v73, s57, v82
    v_sub_u32 v74, s57, v84
    v_sub_u32 v75, s57, v86
    v_sub_u32 v76, s57, v88
    v_sub_u32 v77, s57, v90
    v_sub_u32 v78, s57, v92
    v_sub_u32 v79, s57, v94
    v_min3_u32 v9, v72, v73, v74
    v_min3_u32 v15, v75, v76, v77
    v_min3_u32 v9, v9, v78, v79
    v_min_u32 v9, v9, v15
    s_nop 1
    v_min_u32_dpp v9, v9, v9 row_ror:8 row_mask:0xf bank_mask:0xf
    s_nop 1
    v_min_u32_dpp v9, v9, v9 row_ror:4 row_mask:0xf bank_mask:0xf
    s_nop 1
    v_min_u32_dpp v9, v9, v9 row_ror:2 row_mask:0xf bank_mask:0xf
    s_nop 1
    v_min_u32_dpp v9, v9, v9 row_ror:1 row_mask:0xf bank_mask:0xf
    s_nop 0
    v_readlane_b32 s48, v9, 0
    v_readlane_b32 s49, v9, 16
    v_readlane_b32 s50, v9, 32
    v_readlane_b32 s51, v9, 48
    s_nop 0
    s_min_u32 s48, s48, s49
    s_min_u32 s50, s50, s51
    s_min_u32 s48, s48, s50
    s_sub_u32 s57, s57, s48
    v_writelane_b32 v8, s57, 1
    s_sub_u32 s57, s57, 1
    v_sub_u32 v72, s57, v80
    v_sub_u32 v73, s57, v82
    v_sub_u32 v74, s57, v84
    v_sub_u32 v75, s57, v86
    v_sub_u32 v76, s57, v88
    v_sub_u32 v77, s57, v90
    v_sub_u32 v78, s57, v92
    v_sub_u32 v79, s57, v94
    v_min3_u32 v9, v72, v73, v74
    v_min3_u32 v15, v75, v76, v77
    v_min3_u32 v9, v9, v78, v79
    v_min_u32 v9, v9, v15
    s_nop 1
    v_min_u32_dpp v9, v9, v9 row_ror:8 row_mask:0xf bank_mask:0xf
    s_nop 1
    v_min_u32_dpp v9, v9, v9 row_ror:4 row_mask:0xf bank_mask:0xf
    s_nop 1
    v_min_u32_dpp v9, v9, v9 row_ror:2 row_mask:0xf bank_mask:0xf
    s_nop 1
    v_min_u32_dpp v9, v9, v9 row_ror:1 row_mask:0xf bank_mask:0xf
    s_nop 0
    v_readlane_b32 s48, v9, 0
    v_readlane_b32 s49, v9, 16
    v_readlane_b32 s50, v9, 32
    v_readlane_b32 s51, v9, 48
    s_nop 0
    s_min_u32 s48, s48, s49
    s_min_u32 s50, s50, s51
    s_min_u32 s48, s48, s50
    s_sub_u32 s57, s57, s48
    v_writelane_b32 v8, s57, 2
    s_sub_u32 s57, s57, 1
    v_sub_u32 v72, s57, v80
    v_sub_u32 v73, s57, v82
    v_sub_u32 v74, s57, v84
    v_sub_u32 v75, s57, v86
    v_sub_u32 v76, s57, v88
    v_sub_u32 v77, s57, v90
    v_sub_u32 v78, s57, v92
    v_sub_u32 v79, s57, v94
    v_min3_u32 v9, v72, v73, v74
    v_min3_u32 v15, v75, v76, v77
    v_min3_u32 v9, v9, v78, v79
    v_min_u32 v9, v9, v15
    s_nop 1
    v_min_u32_dpp v9, v9, v9 row_ror:8 row_mask:0xf bank_mask:0xf
    s_nop 1
    v_min_u32_dpp v9, v9, v9 row_ror:4 row_mask:0xf bank_mask:0xf
    s_nop 1
    v_min_u32_dpp v9, v9, v9 row_ror:2 row_mask:0xf bank_mask:0xf
    s_nop 1
    v_min_u32_dpp v9, v9, v9 row_ror:1 row_mask:0xf bank_mask:0xf
    s_nop 0
    v_readlane_b32 s48, v9, 0
    v_readlane_b32 s49, v9, 16
    v_readlane_b32 s50, v9, 32
    v_readlane_b32 s51, v9, 48
    s_nop 0
    s_min_u32 s48, s48, s49
    s_min_u32 s50, s50, s51
    s_min_u32 s48, s48, s50
    s_sub_u32 s57, s57, s48
    v_writelane_b32 v8, s57, 3
    s_sub_u32 s57, s57, 1
    v_sub_u32 v72, s57, v80
    v_sub_u32 v73, s57, v82
    v_sub_u32 v74, s57, v84
    v_sub_u32 v75, s57, v86
    v_sub_u32 v76, s57, v88
    v_sub_u32 v77, s57, v90
    v_sub_u32 v78, s57, v92
    v_sub_u32 v79, s57, v94
    v_min3_u32 v9, v72, v73, v74
    v_min3_u32 v15, v75, v76, v77
    v_min3_u32 v9, v9, v78, v79
    v_min_u32 v9, v9, v15
    s_nop 1
    v_min_u32_dpp v9, v9, v9 row_ror:8 row_mask:0xf bank_mask:0xf
    s_nop 1
    v_min_u32_dpp v9, v9, v9 row_ror:4 row_mask:0xf bank_mask:0xf
    s_nop 1
    v_min_u32_dpp v9, v9, v9 row_ror:2 row_mask:0xf bank_mask:0xf
    s_nop 1
    v_min_u32_dpp v9, v9, v9 row_ror:1 row_mask:0xf bank_mask:0xf
    s_nop 0
    v_readlane_b32 s48, v9, 0
    v_readlane_b32 s49, v9, 16
    v_readlane_b32 s50, v9, 32
    v_readlane_b32 s51, v9, 48
    s_nop 0
    s_min_u32 s48, s48, s49
    s_min_u32 s50, s50, s51
    s_min_u32 s48, s48, s50
    s_sub_u32 s57, s57, s48
    v_writelane_b32 v8, s57, 4
    s_sub_u32 s57, s57, 1
    v_sub_u32 v72, s57, v80
    v_sub_u32 v73, s57, v82
    v_sub_u32 v74, s57, v84
    v_sub_u32 v75, s57, v86
    v_sub_u32 v76, s57, v88
    v_sub_u32 v77, s57, v90
    v_sub_u32 v78, s57, v92
    v_sub_u32 v79, s57, v94
    v_min3_u32 v9, v72, v73, v74
    v_min3_u32 v15, v75, v76, v77
    v_min3_u32 v9, v9, v78, v79
    v_min_u32 v9, v9, v15
    s_nop 1
    v_min_u32_dpp v9, v9, v9 row_ror:8 row_mask:0xf bank_mask:0xf
    s_nop 1
    v_min_u32_dpp v9, v9, v9 row_ror:4 row_mask:0xf bank_mask:0xf
    s_nop 1
    v_min_u32_dpp v9, v9, v9 row_ror:2 row_mask:0xf bank_mask:0xf
    s_nop 1
    v_min_u32_dpp v9, v9, v9 row_ror:1 row_mask:0xf bank_mask:0xf
    s_nop 0
    v_readlane_b32 s48, v9, 0
    v_readlane_b32 s49, v9, 16
    v_readlane_b32 s50, v9, 32
    v_readlane_b32 s51, v9, 48
    s_nop 0
    s_min_u32 s48, s48, s49
    s_min_u32 s50, s50, s51
    s_min_u32 s48, s48, s50
    s_sub_u32 s57, s57, s48
    v_writelane_b32 v8, s57, 5
    s_sub_u32 s57, s57, 1
    v_sub_u32 v72, s57, v80
    v_sub_u32 v73, s57, v82
    v_sub_u32 v74, s57, v84
    v_sub_u32 v75, s57, v86
    v_sub_u32 v76, s57, v88
    v_sub_u32 v77, s57, v90
    v_sub_u32 v78, s57, v92
    v_sub_u32 v79, s57, v94
    v_min3_u32 v9, v72, v73, v74
    v_min3_u32 v15, v75, v76, v77
    v_min3_u32 v9, v9, v78, v79
    v_min_u32 v9, v9, v15
    s_nop 1
    v_min_u32_dpp v9, v9, v9 row_ror:8 row_mask:0xf bank_mask:0xf
    s_nop 1
    v_min_u32_dpp v9, v9, v9 row_ror:4 row_mask:0xf bank_mask:0xf
    s_nop 1
    v_min_u32_dpp v9, v9, v9 row_ror:2 row_mask:0xf bank_mask:0xf
    s_nop 1
    v_min_u32_dpp v9, v9, v9 row_ror:1 row_mask:0xf bank_mask:0xf
    s_nop 0
    v_readlane_b32 s48, v9, 0
    v_readlane_b32 s49, v9, 16
    v_readlane_b32 s50, v9, 32
    v_readlane_b32 s51, v9, 48
    s_nop 0
    s_min_u32 s48, s48, s49
    s_min_u32 s50, s50, s51
    s_min_u32 s48, s48, s50
    s_sub_u32 s57, s57, s48
    v_writelane_b32 v8, s57, 6
    s_sub_u32 s57, s57, 1
    v_sub_u32 v72, s57, v80
    v_sub_u32 v73, s57, v82
    v_sub_u32 v74, s57, v84
    v_sub_u32 v75, s57, v86
    v_sub_u32 v76, s57, v88
    v_sub_u32 v77, s57, v90
    v_sub_u32 v78, s57, v92
    v_sub_u32 v79, s57, v94
    v_min3_u32 v9, v72, v73, v74
    v_min3_u32 v15, v75, v76, v77
    v_min3_u32 v9, v9, v78, v79
    v_min_u32 v9, v9, v15
    s_nop 1
    v_min_u32_dpp v9, v9, v9 row_ror:8 row_mask:0xf bank_mask:0xf
    s_nop 1
    v_min_u32_dpp v9, v9, v9 row_ror:4 row_mask:0xf bank_mask:0xf
    s_nop 1
    v_min_u32_dpp v9, v9, v9 row_ror:2 row_mask:0xf bank_mask:0xf
    s_nop 1
    v_min_u32_dpp v9, v9, v9 row_ror:1 row_mask:0xf bank_mask:0xf
    s_nop 0
    v_readlane_b32 s48, v9, 0
    v_readlane_b32 s49, v9, 16
    v_readlane_b32 s50, v9, 32
    v_readlane_b32 s51, v9, 48
    s_nop 0
    s_min_u32 s48, s48, s49
    s_min_u32 s50, s50, s51
    s_min_u32 s48, s48, s50
    s_sub_u32 s57, s57, s48
    v_writelane_b32 v8, s57, 7
    s_sub_u32 s57, s57, 1
    s_lshl_b32 s38, s18, 5
    s_add_u32 s38, s38, 73856
    v_lshl_add_u32 v9, v2, 2, s38
    v_mov_b32 v20, 73728
    v_mov_b32 v21, 1
    s_mov_b64 exec, 0xff
    ds_write_b32 v9, v8
    s_mov_b64 exec, 1
    ds_add_u32 v20, v21 offset:8
    s_mov_b64 exec, -1
L_s_cw:
    ds_read_b32 v15, v20 offset:8
    s_waitcnt lgkmcnt(0)
    v_readfirstlane_b32 s38, v15
    s_nop 1
    s_cmp_ge_u32 s38, 4
    s_cbranch_scc1 L_s_cw_ok
    s_sub_u32 s96, s96, 1
    s_cbranch_scc1 L_s_cw_ok
    s_sleep 1
    s_branch L_s_cw
L_s_cw_ok:
    v_and_b32 v9, 31, v2
    v_lshlrev_b32 v9, 2, v9
    v_add_u32 v9, 73856, v9
    v_mov_b32 v15, 73856
    ds_read_b32 v14, v9
    ds_read_b128 v[64:67], v15 offset:0
    ds_read_b128 v[68:71], v15 offset:16
    ds_read_b128 v[72:75], v15 offset:32
    ds_read_b128 v[76:79], v15 offset:48
    ds_read_b128 v[80:83], v15 offset:64
    ds_read_b128 v[84:87], v15 offset:80
    ds_read_b128 v[88:91], v15 offset:96
    ds_read_b128 v[92:95], v15 offset:112
    v_mov_b32 v12, 0
    s_waitcnt lgkmcnt(0)
    v_cmp_gt_u32 s[48:49], v64, v14
    v_cmp_gt_u32 s[50:51], v65, v14
    s_nop 0
    v_addc_co_u32 v12, vcc, 0, v12, s[48:49]
    v_addc_co_u32 v12, vcc, 0, v12, s[50:51]
    v_cmp_gt_u32 s[48:49], v66, v14
    v_cmp_gt_u32 s[50:51], v67, v14
    s_nop 0
    v_addc_co_u32 v12, vcc, 0, v12, s[48:49]
    v_addc_co_u32 v12, vcc, 0, v12, s[50:51]
    v_cmp_gt_u32 s[48:49], v68, v14
    v_cmp_gt_u32 s[50:51], v69, v14
    s_nop 0
    v_addc_co_u32 v12, vcc, 0, v12, s[48:49]
    v_addc_co_u32 v12, vcc, 0, v12, s[50:51]
    v_cmp_gt_u32 s[48:49], v70, v14
    v_cmp_gt_u32 s[50:51], v71, v14
    s_nop 0
    v_addc_co_u32 v12, vcc, 0, v12, s[48:49]
    v_addc_co_u32 v12, vcc, 0, v12, s[50:51]
    v_cmp_gt_u32 s[48:49], v72, v14
    v_cmp_gt_u32 s[50:51], v73, v14
    s_nop 0
    v_addc_co_u32 v12, vcc, 0, v12, s[48:49]
    v_addc_co_u32 v12, vcc, 0, v12, s[50:51]
    v_cmp_gt_u32 s[48:49], v74, v14
    v_cmp_gt_u32 s[50:51], v75, v14
    s_nop 0
    v_addc_co_u32 v12, vcc, 0, v12, s[48:49]
    v_addc_co_u32 v12, vcc, 0, v12, s[50:51]
    v_cmp_gt_u32 s[48:49], v76, v14
    v_cmp_gt_u32 s[50:51], v77, v14
    s_nop 0
    v_addc_co_u32 v12, vcc, 0, v12, s[48:49]
    v_addc_co_u32 v12, vcc, 0, v12, s[50:51]
    v_cmp_gt_u32 s[48:49], v78, v14
    v_cmp_gt_u32 s[50:51], v79, v14
    s_nop 0
    v_addc_co_u32 v12, vcc, 0, v12, s[48:49]
    v_addc_co_u32 v12, vcc, 0, v12, s[50:51]
    v_cmp_gt_u32 s[48:49], v80, v14
    v_cmp_gt_u32 s[50:51], v81, v14
    s_nop 0
    v_addc_co_u32 v12, vcc, 0, v12, s[48:49]
    v_addc_co_u32 v12, vcc, 0, v12, s[50:51]
    v_cmp_gt_u32 s[48:49], v82, v14
    v_cmp_gt_u32 s[50:51], v83, v14
    s_nop 0
    v_addc_co_u32 v12, vcc, 0, v12, s[48:49]
    v_addc_co_u32 v12, vcc, 0, v12, s[50:51]
    v_cmp_gt_u32 s[48:49], v84, v14
    v_cmp_gt_u32 s[50:51], v85, v14
    s_nop 0
    v_addc_co_u32 v12, vcc, 0, v12, s[48:49]
    v_addc_co_u32 v12, vcc, 0, v12, s[50:51]
    v_cmp_gt_u32 s[48:49], v86, v14
    v_cmp_gt_u32 s[50:51], v87, v14
    s_nop 0
    v_addc_co_u32 v12, vcc, 0, v12, s[48:49]
    v_addc_co_u32 v12, vcc, 0, v12, s[50:51]
    v_cmp_gt_u32 s[48:49], v88, v14
    v_cmp_gt_u32 s[50:51], v89, v14
    s_nop 0
    v_addc_co_u32 v12, vcc, 0, v12, s[48:49]
    v_addc_co_u32 v12, vcc, 0, v12, s[50:51]
    v_cmp_gt_u32 s[48:49], v90, v14
    v_cmp_gt_u32 s[50:51], v91, v14
    s_nop 0
    v_addc_co_u32 v12, vcc, 0, v12, s[48:49]
    v_addc_co_u32 v12, vcc, 0, v12, s[50:51]
    v_cmp_gt_u32 s[48:49], v92, v14
    v_cmp_gt_u32 s[50:51], v93, v14
    s_nop 0
    v_addc_co_u32 v12, vcc, 0, v12, s[48:49]
    v_addc_co_u32 v12, vcc, 0, v12, s[50:51]
    v_cmp_gt_u32 s[48:49], v94, v14
    v_cmp_gt_u32 s[50:51], v95, v14
    s_nop 0
    v_addc_co_u32 v12, vcc, 0, v12, s[48:49]
    v_addc_co_u32 v12, vcc, 0, v12, s[50:51]
    v_lshlrev_b32 v12, 2, v12
    s_mov_b32 exec_hi, 0
    ds_permute_b32 v13, v12, v14
    s_mov_b64 exec, -1
    v_and_b32 v12, 7, v2
    v_lshlrev_b32 v12, 2, v12
    s_waitcnt lgkmcnt(0)
    ds_bpermute_b32 v8, v12, v13
    s_waitcnt lgkmcnt(0)
    v_lshlrev_b32 v9, 2, v2
    v_add_u32 v9, 73984, v9
    s_mov_b64 exec, 0xff
    ds_write_b32 v9, v8
    s_mov_b64 exec, 1
    ds_add_u32 v20, v21 offset:32
    s_mov_b64 exec, -1
    s_or_b32 s38, s2, s18
    s_cbranch_scc1 L_s_noep
    s_mov_b64 exec, 1
    s_mov_b32 s38, 9469952
    v_mov_b32 v13, s93
    v_mov_b32 v9, 0
    buffer_store_dword v13, v9, s[12:15], s38 offen
    s_mov_b64 exec, -1
L_s_noep:
    v_and_b32 v9, 0x7ff, v8
    v_sub_u32 v9, 2047, v9
    v_lshlrev_b32 v9, 11, v9
    v_lshl_add_u32 v9, v10, 4, v9
    s_lshl_b32 s38, s44, 1
    s_and_b32 s38, s38, 2047
    buffer_load_dwordx4 v[64:67], v9, s[8:11], s38 offen offset:0
    buffer_load_dwordx4 v[68:71], v9, s[8:11], s38 offen offset:64
    s_and_b32 s39, s3, 1
    s_lshl_b32 s56, s39, 9
    s_lshr_b32 s39, s3, 1
    s_lshl_b32 s39, s39, 7
    s_add_u32 s56, s56, s39
    s_lshr_b32 s39, s2, 3
    s_lshl_b32 s39, s39, 2
    s_add_u32 s56, s56, s39
    s_add_u32 s56, s56, s18
    s_lshl_b32 s56, s56, 11
    v_lshl_add_u32 v60, v2, 5, s56
    s_waitcnt vmcnt(0)
    v_lshlrev_b32 v59, 3, v0
    v_and_b32 v59, 2047, v59
    buffer_load_dwordx2 v[62:63], v59, s[32:35], s59 offen
    s_mov_b32 s59, 0
    s_cmp_ge_u32 s2, 224
    s_cbranch_scc1 L_s_gudone
    ds_read_b64_tr_b16 v[100:101], v16 offset:0
    ds_read_b64_tr_b16 v[102:103], v16 offset:512
    ds_read_b64_tr_b16 v[104:105], v16 offset:4096
    ds_read_b64_tr_b16 v[106:107], v16 offset:4608
    ds_read_b64_tr_b16 v[108:109], v17 offset:0
    ds_read_b64_tr_b16 v[110:111], v17 offset:512
    ds_read_b64_tr_b16 v[112:113], v17 offset:4096
    ds_read_b64_tr_b16 v[114:115], v17 offset:4608
    ds_read_b64_tr_b16 v[116:117], v18 offset:0
    ds_read_b64_tr_b16 v[118:119], v18 offset:512
    ds_read_b64_tr_b16 v[120:121], v18 offset:4096
    ds_read_b64_tr_b16 v[122:123], v18 offset:4608
    ds_read_b64_tr_b16 v[124:125], v19 offset:0
    ds_read_b64_tr_b16 v[126:127], v19 offset:512
    ds_read_b64_tr_b16 v[128:129], v19 offset:4096
    ds_read_b64_tr_b16 v[130:131], v19 offset:4608
    s_waitcnt lgkmcnt(0)
    ds_read_b64_tr_b16 v[132:133], v16 offset:8192
    ds_read_b64_tr_b16 v[134:135], v16 offset:8704
    ds_read_b64_tr_b16 v[136:137], v16 offset:12288
    ds_read_b64_tr_b16 v[138:139], v16 offset:12800
    ds_read_b64_tr_b16 v[140:141], v17 offset:8192
    ds_read_b64_tr_b16 v[142:143], v17 offset:8704
    ds_read_b64_tr_b16 v[144:145], v17 offset:12288
    ds_read_b64_tr_b16 v[146:147], v17 offset:12800
    ds_read_b64_tr_b16 v[148:149], v18 offset:8192
    ds_read_b64_tr_b16 v[150:151], v18 offset:8704
    ds_read_b64_tr_b16 v[152:153], v18 offset:12288
    ds_read_b64_tr_b16 v[154:155], v18 offset:12800
    ds_read_b64_tr_b16 v[156:157], v19 offset:8192
    ds_read_b64_tr_b16 v[158:159], v19 offset:8704
    ds_read_b64_tr_b16 v[160:161], v19 offset:12288
    ds_read_b64_tr_b16 v[162:163], v19 offset:12800
    s_waitcnt lgkmcnt(0)
    v_mfma_f32_16x16x32_bf16 v[24:27], v[100:103], v[64:67], 0
    v_mfma_f32_16x16x32_bf16 v[28:31], v[108:111], v[64:67], 0
    v_mfma_f32_16x16x32_bf16 v[32:35], v[116:119], v[64:67], 0
    v_mfma_f32_16x16x32_bf16 v[36:39], v[124:127], v[64:67], 0
    v_mfma_f32_16x16x32_bf16 v[40:43], v[132:135], v[64:67], 0
    v_mfma_f32_16x16x32_bf16 v[44:47], v[140:143], v[64:67], 0
    v_mfma_f32_16x16x32_bf16 v[48:51], v[148:151], v[64:67], 0
    v_mfma_f32_16x16x32_bf16 v[52:55], v[156:159], v[64:67], 0
    v_mfma_f32_16x16x32_bf16 v[24:27], v[104:107], v[68:71], v[24:27]
    v_mfma_f32_16x16x32_bf16 v[28:31], v[112:115], v[68:71], v[28:31]
    v_mfma_f32_16x16x32_bf16 v[32:35], v[120:123], v[68:71], v[32:35]
    v_mfma_f32_16x16x32_bf16 v[36:39], v[128:131], v[68:71], v[36:39]
    v_mfma_f32_16x16x32_bf16 v[40:43], v[136:139], v[68:71], v[40:43]
    v_mfma_f32_16x16x32_bf16 v[44:47], v[144:147], v[68:71], v[44:47]
    v_mfma_f32_16x16x32_bf16 v[48:51], v[152:155], v[68:71], v[48:51]
    v_mfma_f32_16x16x32_bf16 v[52:55], v[160:163], v[68:71], v[52:55]
    v_add_u32 v13, s46, v3
    s_nop 7
    ds_write_b128 v13, v[24:27] offset:0
    ds_write_b128 v13, v[28:31] offset:1024
    ds_write_b128 v13, v[32:35] offset:2048
    ds_write_b128 v13, v[36:39] offset:3072
    ds_write_b128 v13, v[40:43] offset:4096
    ds_write_b128 v13, v[44:47] offset:5120
    ds_write_b128 v13, v[48:51] offset:6144
    ds_write_b128 v13, v[52:55] offset:7168
    v_mov_b32 v15, 1
    s_mov_b64 exec, 1
    ds_add_rtn_u32 v15, v20, v15 offset:0
    s_mov_b64 exec, -1
    s_waitcnt lgkmcnt(0)
    v_readfirstlane_b32 s39, v15
    s_nop 1
    s_cmp_lg_u32 s39, 3
    s_cbranch_scc1 L_s_gudone
    v_add_u32 v13, 98304, v3
    ds_read_b128 v[64:67], v13 offset:0
    ds_read_b128 v[68:71], v13 offset:1024
    ds_read_b128 v[72:75], v13 offset:2048
    ds_read_b128 v[76:79], v13 offset:3072
    ds_read_b128 v[80:83], v13 offset:4096
    ds_read_b128 v[84:87], v13 offset:5120
    ds_read_b128 v[88:91], v13 offset:6144
    ds_read_b128 v[92:95], v13 offset:7168
    ds_read_b128 v[96:99], v13 offset:16384
    ds_read_b128 v[100:103], v13 offset:17408
    ds_read_b128 v[104:107], v13 offset:18432
    ds_read_b128 v[108:111], v13 offset:19456
    ds_read_b128 v[112:115], v13 offset:20480
    ds_read_b128 v[116:119], v13 offset:21504
    ds_read_b128 v[120:123], v13 offset:22528
    ds_read_b128 v[124:127], v13 offset:23552
    s_waitcnt lgkmcnt(0)
    ds_read_b128 v[128:131], v13 offset:32768
    ds_read_b128 v[132:135], v13 offset:33792
    ds_read_b128 v[136:139], v13 offset:34816
    ds_read_b128 v[140:143], v13 offset:35840
    ds_read_b128 v[144:147], v13 offset:36864
    ds_read_b128 v[148:151], v13 offset:37888
    ds_read_b128 v[152:155], v13 offset:38912
    ds_read_b128 v[156:159], v13 offset:39936
    ds_read_b128 v[160:163], v13 offset:49152
    ds_read_b128 v[164:167], v13 offset:50176
    ds_read_b128 v[168:171], v13 offset:51200
    ds_read_b128 v[172:175], v13 offset:52224
    ds_read_b128 v[176:179], v13 offset:53248
    ds_read_b128 v[180:183], v13 offset:54272
    ds_read_b128 v[184:187], v13 offset:55296
    ds_read_b128 v[188:191], v13 offset:56320
    s_waitcnt lgkmcnt(0)
    v_pk_add_f32 v[64:65], v[64:65], v[96:97]
    v_pk_add_f32 v[128:129], v[128:129], v[160:161]
    v_pk_add_f32 v[64:65], v[64:65], v[128:129]
    v_pk_add_f32 v[66:67], v[66:67], v[98:99]
    v_pk_add_f32 v[130:131], v[130:131], v[162:163]
    v_pk_add_f32 v[66:67], v[66:67], v[130:131]
    v_pk_add_f32 v[68:69], v[68:69], v[100:101]
    v_pk_add_f32 v[132:133], v[132:133], v[164:165]
    v_pk_add_f32 v[68:69], v[68:69], v[132:133]
    v_pk_add_f32 v[70:71], v[70:71], v[102:103]
    v_pk_add_f32 v[134:135], v[134:135], v[166:167]
    v_pk_add_f32 v[70:71], v[70:71], v[134:135]
    v_pk_add_f32 v[72:73], v[72:73], v[104:105]
    v_pk_add_f32 v[136:137], v[136:137], v[168:169]
    v_pk_add_f32 v[72:73], v[72:73], v[136:137]
    v_pk_add_f32 v[74:75], v[74:75], v[106:107]
    v_pk_add_f32 v[138:139], v[138:139], v[170:171]
    v_pk_add_f32 v[74:75], v[74:75], v[138:139]
    v_pk_add_f32 v[76:77], v[76:77], v[108:109]
    v_pk_add_f32 v[140:141], v[140:141], v[172:173]
    v_pk_add_f32 v[76:77], v[76:77], v[140:141]
    v_pk_add_f32 v[78:79], v[78:79], v[110:111]
    v_pk_add_f32 v[142:143], v[142:143], v[174:175]
    v_pk_add_f32 v[78:79], v[78:79], v[142:143]
    v_pk_add_f32 v[80:81], v[80:81], v[112:113]
    v_pk_add_f32 v[144:145], v[144:145], v[176:177]
    v_pk_add_f32 v[80:81], v[80:81], v[144:145]
    v_pk_add_f32 v[82:83], v[82:83], v[114:115]
    v_pk_add_f32 v[146:147], v[146:147], v[178:179]
    v_pk_add_f32 v[82:83], v[82:83], v[146:147]
    v_pk_add_f32 v[84:85], v[84:85], v[116:117]
    v_pk_add_f32 v[148:149], v[148:149], v[180:181]
    v_pk_add_f32 v[84:85], v[84:85], v[148:149]
    v_pk_add_f32 v[86:87], v[86:87], v[118:119]
    v_pk_add_f32 v[150:151], v[150:151], v[182:183]
    v_pk_add_f32 v[86:87], v[86:87], v[150:151]
    v_pk_add_f32 v[88:89], v[88:89], v[120:121]
    v_pk_add_f32 v[152:153], v[152:153], v[184:185]
    v_pk_add_f32 v[88:89], v[88:89], v[152:153]
    v_pk_add_f32 v[90:91], v[90:91], v[122:123]
    v_pk_add_f32 v[154:155], v[154:155], v[186:187]
    v_pk_add_f32 v[90:91], v[90:91], v[154:155]
    v_pk_add_f32 v[92:93], v[92:93], v[124:125]
    v_pk_add_f32 v[156:157], v[156:157], v[188:189]
    v_pk_add_f32 v[92:93], v[92:93], v[156:157]
    v_pk_add_f32 v[94:95], v[94:95], v[126:127]
    v_pk_add_f32 v[158:159], v[158:159], v[190:191]
    v_pk_add_f32 v[94:95], v[94:95], v[158:159]
    v_and_b32 v13, 7, v2
    v_mul_u32_u24 v13, 14336, v13
    v_lshl_add_u32 v13, v10, 4, v13
    v_and_b32 v14, 8, v2
    v_lshl_add_u32 v13, v14, 3, v13
    v_cmp_eq_u32 vcc, 8, v14
    s_mul_i32 s38, s23, 229376
    s_lshl_b32 s39, s22, 8
    s_add_u32 s38, s38, s39
    s_add_u32 s38, s38, 10485760
    s_add_u32 s39, s38, 114688
    v_cndmask_b32 v64, v64, v68, vcc
    v_cndmask_b32 v65, v65, v69, vcc
    v_cndmask_b32 v66, v66, v70, vcc
    v_cndmask_b32 v67, v67, v71, vcc
    buffer_store_dwordx4 v[64:67], v13, s[12:15], s38 offen offset:0 sc1
    v_cndmask_b32 v72, v72, v76, vcc
    v_cndmask_b32 v73, v73, v77, vcc
    v_cndmask_b32 v74, v74, v78, vcc
    v_cndmask_b32 v75, v75, v79, vcc
    buffer_store_dwordx4 v[72:75], v13, s[12:15], s38 offen offset:128 sc1
    v_cndmask_b32 v80, v80, v84, vcc
    v_cndmask_b32 v81, v81, v85, vcc
    v_cndmask_b32 v82, v82, v86, vcc
    v_cndmask_b32 v83, v83, v87, vcc
    buffer_store_dwordx4 v[80:83], v13, s[12:15], s39 offen offset:0 sc1
    v_cndmask_b32 v88, v88, v92, vcc
    v_cndmask_b32 v89, v89, v93, vcc
    v_cndmask_b32 v90, v90, v94, vcc
    v_cndmask_b32 v91, v91, v95, vcc
    buffer_store_dwordx4 v[88:91], v13, s[12:15], s39 offen offset:128 sc1
    s_mov_b32 s59, 1
L_s_gudone:
    s_cmp_eq_u32 s59, 0
    s_cbranch_scc1 L_s_nogf
    s_lshl_b32 s38, s22, 10
    s_lshl_b32 s39, s23, 8
    s_add_u32 s38, s38, s39
    s_add_u32 s38, s38, 9568256
    v_mov_b32 v13, s93
    v_lshlrev_b32 v14, 2, v2
    s_waitcnt vmcnt(0)
    s_mov_b32 exec_hi, 0
    buffer_store_dword v13, v14, s[12:15], s38 offen sc1
    s_mov_b32 exec_hi, -1
L_s_nogf:
L_s_h2done:
    s_cmp_ge_u32 s2, 224
    s_cbranch_scc1 L_s_cons
    v_add_u32 v13, s46, v3
    s_waitcnt vmcnt(0)
    ds_write_b128 v13, v[200:203] offset:8192
    ds_write_b128 v13, v[204:207] offset:9216
    ds_write_b128 v13, v[208:211] offset:10240
    ds_write_b128 v13, v[212:215] offset:11264
    ds_write_b128 v13, v[216:219] offset:12288
    ds_write_b128 v13, v[220:223] offset:13312
    ds_write_b128 v13, v[224:227] offset:14336
    ds_write_b128 v13, v[228:231] offset:15360
    s_lshl_b32 s56, s22, 10
    s_add_u32 s56, s56, 9568256
    v_and_b32 v13, 3, v2
    v_lshlrev_b32 v13, 8, v13
    v_and_b32 v1, 255, v0
    v_lshrrev_b32 v6, 5, v1
    v_and_b32 v7, 31, v1
    v_mul_u32_u24 v9, 14336, v6
    v_lshl_add_u32 v9, v7, 3, v9
L_s_gpoll:
    buffer_load_dword v14, v13, s[12:15], s56 offen sc1
    s_waitcnt vmcnt(0)
    v_cmp_ne_u32 vcc, s93, v14
    s_nop 1
    s_cmp_eq_u64 vcc, 0
    s_cbranch_scc1 L_s_ggo
    s_sub_u32 s96, s96, 1
    s_cbranch_scc1 L_s_ggo
    s_sleep 16
    s_branch L_s_gpoll
L_s_ggo:
    s_lshl_b32 s38, s22, 8
    s_add_u32 s38, s38, 10485760
    buffer_load_dwordx2 v[24:25], v9, s[12:15], s38 offen sc1
    s_add_u32 s38, s38, 114688
    buffer_load_dwordx2 v[26:27], v9, s[12:15], s38 offen sc1
    s_add_u32 s38, s38, 114688
    buffer_load_dwordx2 v[28:29], v9, s[12:15], s38 offen sc1
    s_add_u32 s38, s38, 114688
    buffer_load_dwordx2 v[30:31], v9, s[12:15], s38 offen sc1
    s_add_u32 s38, s38, 114688
    buffer_load_dwordx2 v[32:33], v9, s[12:15], s38 offen sc1
    s_add_u32 s38, s38, 114688
    buffer_load_dwordx2 v[34:35], v9, s[12:15], s38 offen sc1
    s_add_u32 s38, s38, 114688
    buffer_load_dwordx2 v[36:37], v9, s[12:15], s38 offen sc1
    s_add_u32 s38, s38, 114688
    buffer_load_dwordx2 v[38:39], v9, s[12:15], s38 offen sc1
    s_add_u32 s38, s38, 114688
    ds_read_b64_tr_b16 v[64:65], v16 offset:8192
    ds_read_b64_tr_b16 v[66:67], v16 offset:8704
    ds_read_b64_tr_b16 v[68:69], v16 offset:12288
    ds_read_b64_tr_b16 v[70:71], v16 offset:12800
    ds_read_b64_tr_b16 v[72:73], v17 offset:8192
    ds_read_b64_tr_b16 v[74:75], v17 offset:8704
    ds_read_b64_tr_b16 v[76:77], v17 offset:12288
    ds_read_b64_tr_b16 v[78:79], v17 offset:12800
    ds_read_b64_tr_b16 v[80:81], v18 offset:8192
    ds_read_b64_tr_b16 v[82:83], v18 offset:8704
    ds_read_b64_tr_b16 v[84:85], v18 offset:12288
    ds_read_b64_tr_b16 v[86:87], v18 offset:12800
    ds_read_b64_tr_b16 v[88:89], v19 offset:8192
    ds_read_b64_tr_b16 v[90:91], v19 offset:8704
    ds_read_b64_tr_b16 v[92:93], v19 offset:12288
    ds_read_b64_tr_b16 v[94:95], v19 offset:12800
    s_waitcnt vmcnt(0)
    v_add_f32 v24, v24, v28
    v_add_f32 v32, v32, v36
    v_add_f32 v24, v24, v32
    v_cvt_pk_bf16_f32 v24, v24, v24
    v_lshlrev_b32 v24, 16, v24
    v_add_f32 v25, v25, v29
    v_add_f32 v33, v33, v37
    v_add_f32 v25, v25, v33
    v_cvt_pk_bf16_f32 v25, v25, v25
    v_lshlrev_b32 v25, 16, v25
    v_add_f32 v26, v26, v30
    v_add_f32 v34, v34, v38
    v_add_f32 v26, v26, v34
    v_cvt_pk_bf16_f32 v26, v26, v26
    v_lshlrev_b32 v26, 16, v26
    v_add_f32 v27, v27, v31
    v_add_f32 v35, v35, v39
    v_add_f32 v27, v27, v35
    v_cvt_pk_bf16_f32 v27, v27, v27
    v_lshlrev_b32 v27, 16, v27
    v_mul_f32 v40, 0xbfb8aa3b, v24
    v_exp_f32 v40, v40
    s_nop 0
    v_add_f32 v40, 1.0, v40
    v_rcp_f32 v40, v40
    s_nop 0
    v_mul_f32 v40, v40, v24
    v_cvt_pk_bf16_f32 v40, v40, v40
    v_lshlrev_b32 v40, 16, v40
    v_mul_f32 v40, v40, v26
    v_mul_f32 v41, 0xbfb8aa3b, v25
    v_exp_f32 v41, v41
    s_nop 0
    v_add_f32 v41, 1.0, v41
    v_rcp_f32 v41, v41
    s_nop 0
    v_mul_f32 v41, v41, v25
    v_cvt_pk_bf16_f32 v41, v41, v41
    v_lshlrev_b32 v41, 16, v41
    v_mul_f32 v41, v41, v27
    v_cvt_pk_bf16_f32 v40, v40, v41
    v_mul_u32_u24 v9, 144, v6
    v_lshl_add_u32 v9, v7, 2, v9
    v_add_u32 v9, 74240, v9
    ds_write_b32 v9, v40
    s_mov_b64 exec, 1
    ds_add_u32 v20, v21 offset:20
    s_mov_b64 exec, -1
    v_and_b32 v9, 7, v2
    v_mul_u32_u24 v9, 144, v9
    v_lshl_add_u32 v9, v10, 4, v9
    v_add_u32 v9, 74240, v9
L_s_aw:
    ds_read_b32 v15, v20 offset:20
    s_waitcnt lgkmcnt(0)
    v_readfirstlane_b32 s38, v15
    s_nop 1
    s_cmp_ge_u32 s38, 4
    s_cbranch_scc1 L_s_aw_ok
    s_sub_u32 s96, s96, 1
    s_cbranch_scc1 L_s_aw_ok
    s_sleep 1
    s_branch L_s_aw
L_s_aw_ok:
    ds_read_b128 v[40:43], v9
    ds_read_b128 v[44:47], v9 offset:64
    s_mov_b32 s38, 229376
    v_and_b32 v15, 7, v2
    v_mul_lo_u32 v15, v15, s38
    v_lshl_add_u32 v15, v10, 4, v15
    v_and_b32 v14, 8, v2
    v_lshl_add_u32 v15, v14, 3, v15
    s_lshl_b32 s38, s22, 12
    s_lshl_b32 s39, s23, 10
    s_add_u32 s38, s38, s39
    s_lshl_b32 s39, s18, 8
    s_add_u32 s38, s38, s39
    s_add_u32 s38, s38, 13631488
    v_cmp_eq_u32 vcc, 8, v14
    s_waitcnt lgkmcnt(0)
    v_mfma_f32_16x16x32_bf16 v[48:51], v[64:67], v[40:43], 0
    v_mfma_f32_16x16x32_bf16 v[52:55], v[72:75], v[40:43], 0
    v_mfma_f32_16x16x32_bf16 v[56:59], v[80:83], v[40:43], 0
    v_mfma_f32_16x16x32_bf16 v[60:63], v[88:91], v[40:43], 0
    v_mfma_f32_16x16x32_bf16 v[48:51], v[68:71], v[44:47], v[48:51]
    v_mfma_f32_16x16x32_bf16 v[52:55], v[76:79], v[44:47], v[52:55]
    v_mfma_f32_16x16x32_bf16 v[56:59], v[84:87], v[44:47], v[56:59]
    v_mfma_f32_16x16x32_bf16 v[60:63], v[92:95], v[44:47], v[60:63]
    s_nop 7
    v_cndmask_b32 v48, v48, v52, vcc
    v_cndmask_b32 v49, v49, v53, vcc
    v_cndmask_b32 v50, v50, v54, vcc
    v_cndmask_b32 v51, v51, v55, vcc
    buffer_store_dwordx4 v[48:51], v15, s[12:15], s38 offen offset:0 sc1
    v_cndmask_b32 v56, v56, v60, vcc
    v_cndmask_b32 v57, v57, v61, vcc
    v_cndmask_b32 v58, v58, v62, vcc
    v_cndmask_b32 v59, v59, v63, vcc
    buffer_store_dwordx4 v[56:59], v15, s[12:15], s38 offen offset:128 sc1
    s_lshl_b32 s58, s23, 14
    s_lshl_b32 s39, s22, 8
    s_add_u32 s58, s58, s39
    s_add_u32 s58, s58, 9633792
    v_mov_b32 v13, s93
    v_lshlrev_b32 v14, 2, v2
    s_waitcnt vmcnt(0)
    v_mov_b32 v15, 1
    s_mov_b64 exec, 1
    ds_add_rtn_u32 v15, v20, v15 offset:24
    s_mov_b64 exec, -1
    s_waitcnt lgkmcnt(0)
    v_readfirstlane_b32 s39, v15
    s_nop 1
    s_cmp_lg_u32 s39, 3
    s_cbranch_scc1 L_s_cons
    s_mov_b32 exec_hi, 0
    buffer_store_dword v13, v14, s[12:15], s58 offen sc1
    s_mov_b32 exec_hi, -1
L_s_cons:
    s_add_u32 s38, s18, 4
    v_readlane_b32 s24, v8, s18
    v_readlane_b32 s25, v8, s38
    s_lshl_b32 s45, s16, 7
    s_and_b32 s26, s24, 0x7ff
    s_sub_u32 s26, 2047, s26
    s_sub_u32 s56, s26, s45
    s_and_b32 s27, s25, 0x7ff
    s_sub_u32 s27, 2047, s27
    s_sub_u32 s57, s27, s45
    s_waitcnt lgkmcnt(0)
    s_min_u32 s38, s56, s57
    s_cmp_ge_u32 s38, 128
    s_cbranch_scc1 L_s_end
L_s_pw:
    ds_read_b32 v15, v20 offset:16
    s_waitcnt lgkmcnt(0)
    v_readfirstlane_b32 s38, v15
    s_nop 1
    s_cmp_ge_u32 s38, 40
    s_cbranch_scc1 L_s_pw_ok
    s_sub_u32 s96, s96, 1
    s_cbranch_scc1 L_s_pw_ok
    s_sleep 8
    s_branch L_s_pw
L_s_pw_ok:
    s_lshr_b32 s58, s17, 2
    s_lshl_b32 s58, s58, 14
    s_add_u32 s58, s58, 9633792
    v_min_u32 v4, 55, v2
    v_lshlrev_b32 v4, 8, v4
    v_lshlrev_b32 v6, 12, v10
    v_lshl_add_u32 v6, v11, 4, v6
    v_lshlrev_b32 v9, 3, v11
    v_mov_b32 v7, 0
L_s_ypoll:
    buffer_load_dword v5, v4, s[12:15], s58 offen sc1
    s_waitcnt vmcnt(0)
    v_cmp_ne_u32 vcc, s93, v5
    s_nop 1
    s_cmp_eq_u64 vcc, 0
    s_cbranch_scc1 L_s_ygo
    s_sub_u32 s96, s96, 1
    s_cbranch_scc1 L_s_ygo
    s_sleep 12
    s_branch L_s_ypoll
L_s_ygo:
    s_cmp_ge_u32 s56, 128
    s_cbranch_scc1 L_s_sk0
    s_add_u32 s39, s18, 0
    s_mul_i32 s39, s39, 229376
    s_lshl_b32 s3, s17, 8
    s_add_u32 s39, s39, s3
    s_add_u32 s39, s39, 13631488
    buffer_load_dwordx4 v[24:27], v6, s[12:15], s39 offen sc1
    s_add_u32 s39, s39, 16384
    buffer_load_dwordx4 v[28:31], v6, s[12:15], s39 offen sc1
    s_add_u32 s39, s39, 16384
    buffer_load_dwordx4 v[32:35], v6, s[12:15], s39 offen sc1
    s_add_u32 s39, s39, 16384
    buffer_load_dwordx4 v[36:39], v6, s[12:15], s39 offen sc1
    s_add_u32 s39, s39, 16384
    buffer_load_dwordx4 v[40:43], v6, s[12:15], s39 offen sc1
    s_add_u32 s39, s39, 16384
    buffer_load_dwordx4 v[44:47], v6, s[12:15], s39 offen sc1
    s_add_u32 s39, s39, 16384
    buffer_load_dwordx4 v[48:51], v6, s[12:15], s39 offen sc1
    s_add_u32 s39, s39, 16384
    buffer_load_dwordx4 v[52:55], v6, s[12:15], s39 offen sc1
    s_add_u32 s39, s39, 16384
    buffer_load_dwordx4 v[56:59], v6, s[12:15], s39 offen sc1
    s_add_u32 s39, s39, 16384
    buffer_load_dwordx4 v[60:63], v6, s[12:15], s39 offen sc1
    s_add_u32 s39, s39, 16384
    buffer_load_dwordx4 v[64:67], v6, s[12:15], s39 offen sc1
    s_add_u32 s39, s39, 16384
    buffer_load_dwordx4 v[68:71], v6, s[12:15], s39 offen sc1
    s_add_u32 s39, s39, 16384
    buffer_load_dwordx4 v[72:75], v6, s[12:15], s39 offen sc1
    s_add_u32 s39, s39, 16384
    buffer_load_dwordx4 v[76:79], v6, s[12:15], s39 offen sc1
    s_add_u32 s39, s39, 16384
    s_lshl_b32 s39, s26, 11
    s_lshl_b32 s3, s17, 7
    s_add_u32 s39, s39, s3
    buffer_load_dwordx2 v[80:81], v9, s[8:11], s39 offen
    s_lshl_b32 s39, s26, 3
    s_add_u32 s39, s39, 9453568
    buffer_load_dword v82, v7, s[12:15], s39 offen sc1
L_s_sk0:
    s_cmp_ge_u32 s57, 128
    s_cbranch_scc1 L_s_sk1
    s_add_u32 s39, s18, 4
    s_mul_i32 s39, s39, 229376
    s_lshl_b32 s3, s17, 8
    s_add_u32 s39, s39, s3
    s_add_u32 s39, s39, 13631488
    buffer_load_dwordx4 v[88:91], v6, s[12:15], s39 offen sc1
    s_add_u32 s39, s39, 16384
    buffer_load_dwordx4 v[92:95], v6, s[12:15], s39 offen sc1
    s_add_u32 s39, s39, 16384
    buffer_load_dwordx4 v[96:99], v6, s[12:15], s39 offen sc1
    s_add_u32 s39, s39, 16384
    buffer_load_dwordx4 v[100:103], v6, s[12:15], s39 offen sc1
    s_add_u32 s39, s39, 16384
    buffer_load_dwordx4 v[104:107], v6, s[12:15], s39 offen sc1
    s_add_u32 s39, s39, 16384
    buffer_load_dwordx4 v[108:111], v6, s[12:15], s39 offen sc1
    s_add_u32 s39, s39, 16384
    buffer_load_dwordx4 v[112:115], v6, s[12:15], s39 offen sc1
    s_add_u32 s39, s39, 16384
    buffer_load_dwordx4 v[116:119], v6, s[12:15], s39 offen sc1
    s_add_u32 s39, s39, 16384
    buffer_load_dwordx4 v[120:123], v6, s[12:15], s39 offen sc1
    s_add_u32 s39, s39, 16384
    buffer_load_dwordx4 v[124:127], v6, s[12:15], s39 offen sc1
    s_add_u32 s39, s39, 16384
    buffer_load_dwordx4 v[128:131], v6, s[12:15], s39 offen sc1
    s_add_u32 s39, s39, 16384
    buffer_load_dwordx4 v[132:135], v6, s[12:15], s39 offen sc1
    s_add_u32 s39, s39, 16384
    buffer_load_dwordx4 v[136:139], v6, s[12:15], s39 offen sc1
    s_add_u32 s39, s39, 16384
    buffer_load_dwordx4 v[140:143], v6, s[12:15], s39 offen sc1
    s_add_u32 s39, s39, 16384
    s_lshl_b32 s39, s27, 11
    s_lshl_b32 s3, s17, 7
    s_add_u32 s39, s39, s3
    buffer_load_dwordx2 v[144:145], v9, s[8:11], s39 offen
    s_lshl_b32 s39, s27, 3
    s_add_u32 s39, s39, 9453568
    buffer_load_dword v146, v7, s[12:15], s39 offen sc1
L_s_sk1:
    s_waitcnt vmcnt(0)
    s_cmp_ge_u32 s56, 128
    s_cbranch_scc1 L_s_sc0
    s_ashr_i32 s39, s24, 31
    s_not_b32 s39, s39
    s_or_b32 s39, s39, 0x80000000
    s_xor_b32 s39, s24, s39
    s_and_b32 s39, s39, 0xffff0000
    v_mov_b32 v86, s39
    v_mul_f32 v83, 0xbfb8aa3b, v86
    v_exp_f32 v83, v83
    s_nop 0
    v_add_f32 v83, 1.0, v83
    v_rcp_f32 v83, v83
    s_nop 0
    v_cvt_pk_bf16_f32 v83, v83, v83
    v_lshlrev_b32 v83, 16, v83
    v_pk_add_f32 v[24:25], v[24:25], v[28:29]
    v_pk_add_f32 v[26:27], v[26:27], v[30:31]
    v_pk_add_f32 v[24:25], v[24:25], v[32:33]
    v_pk_add_f32 v[26:27], v[26:27], v[34:35]
    v_pk_add_f32 v[24:25], v[24:25], v[36:37]
    v_pk_add_f32 v[26:27], v[26:27], v[38:39]
    v_pk_add_f32 v[24:25], v[24:25], v[40:41]
    v_pk_add_f32 v[26:27], v[26:27], v[42:43]
    v_pk_add_f32 v[24:25], v[24:25], v[44:45]
    v_pk_add_f32 v[26:27], v[26:27], v[46:47]
    v_pk_add_f32 v[24:25], v[24:25], v[48:49]
    v_pk_add_f32 v[26:27], v[26:27], v[50:51]
    v_pk_add_f32 v[24:25], v[24:25], v[52:53]
    v_pk_add_f32 v[26:27], v[26:27], v[54:55]
    v_pk_add_f32 v[24:25], v[24:25], v[56:57]
    v_pk_add_f32 v[26:27], v[26:27], v[58:59]
    v_pk_add_f32 v[24:25], v[24:25], v[60:61]
    v_pk_add_f32 v[26:27], v[26:27], v[62:63]
    v_pk_add_f32 v[24:25], v[24:25], v[64:65]
    v_pk_add_f32 v[26:27], v[26:27], v[66:67]
    v_pk_add_f32 v[24:25], v[24:25], v[68:69]
    v_pk_add_f32 v[26:27], v[26:27], v[70:71]
    v_pk_add_f32 v[24:25], v[24:25], v[72:73]
    v_pk_add_f32 v[26:27], v[26:27], v[74:75]
    v_pk_add_f32 v[24:25], v[24:25], v[76:77]
    v_pk_add_f32 v[26:27], v[26:27], v[78:79]
    v_mov_b32 v28, v24
    v_mov_b32 v29, v25
    v_mov_b32 v30, v26
    v_mov_b32 v31, v27
    s_nop 1
    v_permlane16_swap_b32 v24, v28
    v_permlane16_swap_b32 v25, v29
    v_permlane16_swap_b32 v26, v30
    v_permlane16_swap_b32 v27, v31
    s_nop 1
    v_add_f32 v24, v24, v28
    v_add_f32 v25, v25, v29
    v_add_f32 v26, v26, v30
    v_add_f32 v27, v27, v31
    v_mov_b32 v28, v24
    v_mov_b32 v29, v25
    v_mov_b32 v30, v26
    v_mov_b32 v31, v27
    s_nop 1
    v_permlane32_swap_b32 v24, v28
    v_permlane32_swap_b32 v25, v29
    v_permlane32_swap_b32 v26, v30
    v_permlane32_swap_b32 v27, v31
    s_nop 1
    v_add_f32 v24, v24, v28
    v_add_f32 v25, v25, v29
    v_add_f32 v26, v26, v30
    v_add_f32 v27, v27, v31
    v_sub_f32 v82, 1.0, v82
    v_cvt_pk_bf16_f32 v82, v82, v82
    v_lshlrev_b32 v82, 16, v82
    v_lshlrev_b32 v32, 16, v80
    v_and_b32 v33, s21, v80
    v_lshlrev_b32 v34, 16, v81
    v_and_b32 v35, s21, v81
    v_cvt_pk_bf16_f32 v24, v24, v24
    v_lshlrev_b32 v24, 16, v24
    v_mul_f32 v24, v24, v83
    v_cvt_pk_bf16_f32 v24, v24, v24
    v_lshlrev_b32 v24, 16, v24
    v_add_f32 v24, v24, v32
    v_cvt_pk_bf16_f32 v24, v24, v24
    v_lshlrev_b32 v24, 16, v24
    v_mul_f32 v24, v24, v82
    v_cvt_pk_bf16_f32 v24, v24, v24
    v_lshlrev_b32 v24, 16, v24
    v_mul_f32 v32, v32, v82
    v_cvt_pk_bf16_f32 v32, v32, v32
    v_lshlrev_b32 v32, 16, v32
    v_sub_f32 v24, v24, v32
    v_cvt_pk_bf16_f32 v25, v25, v25
    v_lshlrev_b32 v25, 16, v25
    v_mul_f32 v25, v25, v83
    v_cvt_pk_bf16_f32 v25, v25, v25
    v_lshlrev_b32 v25, 16, v25
    v_add_f32 v25, v25, v33
    v_cvt_pk_bf16_f32 v25, v25, v25
    v_lshlrev_b32 v25, 16, v25
    v_mul_f32 v25, v25, v82
    v_cvt_pk_bf16_f32 v25, v25, v25
    v_lshlrev_b32 v25, 16, v25
    v_mul_f32 v33, v33, v82
    v_cvt_pk_bf16_f32 v33, v33, v33
    v_lshlrev_b32 v33, 16, v33
    v_sub_f32 v25, v25, v33
    v_cvt_pk_bf16_f32 v26, v26, v26
    v_lshlrev_b32 v26, 16, v26
    v_mul_f32 v26, v26, v83
    v_cvt_pk_bf16_f32 v26, v26, v26
    v_lshlrev_b32 v26, 16, v26
    v_add_f32 v26, v26, v34
    v_cvt_pk_bf16_f32 v26, v26, v26
    v_lshlrev_b32 v26, 16, v26
    v_mul_f32 v26, v26, v82
    v_cvt_pk_bf16_f32 v26, v26, v26
    v_lshlrev_b32 v26, 16, v26
    v_mul_f32 v34, v34, v82
    v_cvt_pk_bf16_f32 v34, v34, v34
    v_lshlrev_b32 v34, 16, v34
    v_sub_f32 v26, v26, v34
    v_cvt_pk_bf16_f32 v27, v27, v27
    v_lshlrev_b32 v27, 16, v27
    v_mul_f32 v27, v27, v83
    v_cvt_pk_bf16_f32 v27, v27, v27
    v_lshlrev_b32 v27, 16, v27
    v_add_f32 v27, v27, v35
    v_cvt_pk_bf16_f32 v27, v27, v27
    v_lshlrev_b32 v27, 16, v27
    v_mul_f32 v27, v27, v82
    v_cvt_pk_bf16_f32 v27, v27, v27
    v_lshlrev_b32 v27, 16, v27
    v_mul_f32 v35, v35, v82
    v_cvt_pk_bf16_f32 v35, v35, v35
    v_lshlrev_b32 v35, 16, v35
    v_sub_f32 v27, v27, v35
    s_lshl_b32 s39, s18, 8
    s_add_u32 s39, s39, 75776
    v_lshl_add_u32 v84, v11, 4, s39
    ds_write_b128 v84, v[24:27]
    v_lshl_add_u32 v85, s18, 2, v20
    s_mov_b64 exec, 1
    ds_add_u32 v85, v21 offset:36
    s_mov_b64 exec, -1
L_s_sc0:
    s_cmp_ge_u32 s57, 128
    s_cbranch_scc1 L_s_sc1
    s_ashr_i32 s39, s25, 31
    s_not_b32 s39, s39
    s_or_b32 s39, s39, 0x80000000
    s_xor_b32 s39, s25, s39
    s_and_b32 s39, s39, 0xffff0000
    v_mov_b32 v150, s39
    v_mul_f32 v147, 0xbfb8aa3b, v150
    v_exp_f32 v147, v147
    s_nop 0
    v_add_f32 v147, 1.0, v147
    v_rcp_f32 v147, v147
    s_nop 0
    v_cvt_pk_bf16_f32 v147, v147, v147
    v_lshlrev_b32 v147, 16, v147
    v_pk_add_f32 v[88:89], v[88:89], v[92:93]
    v_pk_add_f32 v[90:91], v[90:91], v[94:95]
    v_pk_add_f32 v[88:89], v[88:89], v[96:97]
    v_pk_add_f32 v[90:91], v[90:91], v[98:99]
    v_pk_add_f32 v[88:89], v[88:89], v[100:101]
    v_pk_add_f32 v[90:91], v[90:91], v[102:103]
    v_pk_add_f32 v[88:89], v[88:89], v[104:105]
    v_pk_add_f32 v[90:91], v[90:91], v[106:107]
    v_pk_add_f32 v[88:89], v[88:89], v[108:109]
    v_pk_add_f32 v[90:91], v[90:91], v[110:111]
    v_pk_add_f32 v[88:89], v[88:89], v[112:113]
    v_pk_add_f32 v[90:91], v[90:91], v[114:115]
    v_pk_add_f32 v[88:89], v[88:89], v[116:117]
    v_pk_add_f32 v[90:91], v[90:91], v[118:119]
    v_pk_add_f32 v[88:89], v[88:89], v[120:121]
    v_pk_add_f32 v[90:91], v[90:91], v[122:123]
    v_pk_add_f32 v[88:89], v[88:89], v[124:125]
    v_pk_add_f32 v[90:91], v[90:91], v[126:127]
    v_pk_add_f32 v[88:89], v[88:89], v[128:129]
    v_pk_add_f32 v[90:91], v[90:91], v[130:131]
    v_pk_add_f32 v[88:89], v[88:89], v[132:133]
    v_pk_add_f32 v[90:91], v[90:91], v[134:135]
    v_pk_add_f32 v[88:89], v[88:89], v[136:137]
    v_pk_add_f32 v[90:91], v[90:91], v[138:139]
    v_pk_add_f32 v[88:89], v[88:89], v[140:141]
    v_pk_add_f32 v[90:91], v[90:91], v[142:143]
    v_mov_b32 v92, v88
    v_mov_b32 v93, v89
    v_mov_b32 v94, v90
    v_mov_b32 v95, v91
    s_nop 1
    v_permlane16_swap_b32 v88, v92
    v_permlane16_swap_b32 v89, v93
    v_permlane16_swap_b32 v90, v94
    v_permlane16_swap_b32 v91, v95
    s_nop 1
    v_add_f32 v88, v88, v92
    v_add_f32 v89, v89, v93
    v_add_f32 v90, v90, v94
    v_add_f32 v91, v91, v95
    v_mov_b32 v92, v88
    v_mov_b32 v93, v89
    v_mov_b32 v94, v90
    v_mov_b32 v95, v91
    s_nop 1
    v_permlane32_swap_b32 v88, v92
    v_permlane32_swap_b32 v89, v93
    v_permlane32_swap_b32 v90, v94
    v_permlane32_swap_b32 v91, v95
    s_nop 1
    v_add_f32 v88, v88, v92
    v_add_f32 v89, v89, v93
    v_add_f32 v90, v90, v94
    v_add_f32 v91, v91, v95
    v_sub_f32 v146, 1.0, v146
    v_cvt_pk_bf16_f32 v146, v146, v146
    v_lshlrev_b32 v146, 16, v146
    v_lshlrev_b32 v96, 16, v144
    v_and_b32 v97, s21, v144
    v_lshlrev_b32 v98, 16, v145
    v_and_b32 v99, s21, v145
    v_cvt_pk_bf16_f32 v88, v88, v88
    v_lshlrev_b32 v88, 16, v88
    v_mul_f32 v88, v88, v147
    v_cvt_pk_bf16_f32 v88, v88, v88
    v_lshlrev_b32 v88, 16, v88
    v_add_f32 v88, v88, v96
    v_cvt_pk_bf16_f32 v88, v88, v88
    v_lshlrev_b32 v88, 16, v88
    v_mul_f32 v88, v88, v146
    v_cvt_pk_bf16_f32 v88, v88, v88
    v_lshlrev_b32 v88, 16, v88
    v_mul_f32 v96, v96, v146
    v_cvt_pk_bf16_f32 v96, v96, v96
    v_lshlrev_b32 v96, 16, v96
    v_sub_f32 v88, v88, v96
    v_cvt_pk_bf16_f32 v89, v89, v89
    v_lshlrev_b32 v89, 16, v89
    v_mul_f32 v89, v89, v147
    v_cvt_pk_bf16_f32 v89, v89, v89
    v_lshlrev_b32 v89, 16, v89
    v_add_f32 v89, v89, v97
    v_cvt_pk_bf16_f32 v89, v89, v89
    v_lshlrev_b32 v89, 16, v89
    v_mul_f32 v89, v89, v146
    v_cvt_pk_bf16_f32 v89, v89, v89
    v_lshlrev_b32 v89, 16, v89
    v_mul_f32 v97, v97, v146
    v_cvt_pk_bf16_f32 v97, v97, v97
    v_lshlrev_b32 v97, 16, v97
    v_sub_f32 v89, v89, v97
    v_cvt_pk_bf16_f32 v90, v90, v90
    v_lshlrev_b32 v90, 16, v90
    v_mul_f32 v90, v90, v147
    v_cvt_pk_bf16_f32 v90, v90, v90
    v_lshlrev_b32 v90, 16, v90
    v_add_f32 v90, v90, v98
    v_cvt_pk_bf16_f32 v90, v90, v90
    v_lshlrev_b32 v90, 16, v90
    v_mul_f32 v90, v90, v146
    v_cvt_pk_bf16_f32 v90, v90, v90
    v_lshlrev_b32 v90, 16, v90
    v_mul_f32 v98, v98, v146
    v_cvt_pk_bf16_f32 v98, v98, v98
    v_lshlrev_b32 v98, 16, v98
    v_sub_f32 v90, v90, v98
    v_cvt_pk_bf16_f32 v91, v91, v91
    v_lshlrev_b32 v91, 16, v91
    v_mul_f32 v91, v91, v147
    v_cvt_pk_bf16_f32 v91, v91, v91
    v_lshlrev_b32 v91, 16, v91
    v_add_f32 v91, v91, v99
    v_cvt_pk_bf16_f32 v91, v91, v91
    v_lshlrev_b32 v91, 16, v91
    v_mul_f32 v91, v91, v146
    v_cvt_pk_bf16_f32 v91, v91, v91
    v_lshlrev_b32 v91, 16, v91
    v_mul_f32 v99, v99, v146
    v_cvt_pk_bf16_f32 v99, v99, v99
    v_lshlrev_b32 v99, 16, v99
    v_sub_f32 v91, v91, v99
    s_lshl_b32 s39, s18, 8
    s_add_u32 s39, s39, 76800
    v_lshl_add_u32 v148, v11, 4, s39
    ds_write_b128 v148, v[88:91]
    v_lshl_add_u32 v149, s18, 2, v20
    s_mov_b64 exec, 1
    ds_add_u32 v149, v21 offset:52
    s_mov_b64 exec, -1
L_s_sc1:
L_s_end:
    s_endpgm
L_exit:
    s_endpgm
L_gemm:
    s_add_u32 s94, s42, 9469952
    s_addc_u32 s95, s43, 0
    s_load_dword s93, s[94:95], 0
    s_lshr_b32 s20, s18, 1
    s_lshl_b32 s50, s3, 8
    s_lshl_b32 s39, s38, 3
    s_add_u32 s50, s50, s39
    s_lshl_b32 s50, s50, 11
    s_lshl_b32 s51, s18, 9
    s_add_u32 s50, s50, s51
    s_lshl_b32 s39, s18, 14
    s_add_u32 m0, s39, 98304
    v_and_b32 v4, 31, v0
    v_lshlrev_b32 v4, 4, v4
    v_bfe_u32 v5, v0, 5, 1
    v_lshl_add_u32 v5, v5, 11, v4
    v_add_u32 v4, s51, v4
    v_mov_b32 v6, s44
    v_mov_b32 v7, s45
    s_mov_b32 exec_lo, 0
    v_mov_b32 v6, s80
    v_mov_b32 v7, s81
    s_mov_b32 exec_lo, -1
    v_add_co_u32 v6, vcc, v6, v4
    s_mov_b32 s4, s40
    s_mov_b32 s5, s41
    s_mov_b32 s6, 4194304
    s_mov_b32 s7, 0x20000
    v_addc_co_u32 v7, vcc, 0, v7, vcc
    buffer_load_dwordx4 v5, s[4:7], s50 offen  lds
    s_add_u32 m0, m0, 1024
    s_add_u32 s50, s50, 4096
    buffer_load_dwordx4 v5, s[4:7], s50 offen  lds
    s_add_u32 m0, m0, 1024
    s_add_u32 s50, s50, 4096
    buffer_load_dwordx4 v5, s[4:7], s50 offen  lds
    s_add_u32 m0, m0, 1024
    s_add_u32 s50, s50, 4096
    buffer_load_dwordx4 v5, s[4:7], s50 offen  lds
    s_add_u32 m0, m0, 1024
    s_add_u32 s50, s50, 4096
    global_load_lds_dwordx4 v[6:7], off
    s_and_b32 s39, s3, 1
    s_lshl_b32 s50, s39, 9
    s_lshr_b32 s39, s3, 1
    s_lshl_b32 s39, s39, 7
    s_add_u32 s50, s50, s39
    s_lshl_b32 s39, s38, 2
    s_add_u32 s50, s50, s39
    s_add_u32 s50, s50, s18
    s_lshl_b32 s50, s50, 11
    v_and_b32 v4, 63, v0
    v_lshl_add_u32 v3, v4, 5, s50
    global_load_dword v10, v3, s[68:69]
    global_load_dword v11, v3, s[70:71]
    s_mov_b64 s[8:9], s[72:73]
    s_mov_b64 s[10:11], s[74:75]
    s_mov_b64 s[52:53], s[72:73]
    s_mov_b64 s[54:55], s[74:75]
    s_mov_b64 s[58:59], s[78:79]
    s_mov_b64 s[36:37], s[82:83]
    v_and_b32 v24, 63, v0
    s_and_b32 s19, s18, 1
    s_lshl_b32 s23, s18, 12
    v_lshrrev_b32 v25, 4, v24
    v_lshrrev_b32 v56, 3, v24
    v_and_b32 v57, 7, v24
    v_lshrrev_b32 v58, 1, v56
    v_xor_b32 v57, v57, v58
    v_lshlrev_b32 v57, 4, v57
    s_mov_b32 s12, s42
    s_mov_b32 s13, s43
    s_mov_b32 s14, 25165824
    s_mov_b32 s15, 0x20000
    s_lshl_b32 s38, s17, 14
    s_add_u32 s38, s38, 8388608
    s_add_u32 s24, s42, s38
    s_addc_u32 s25, s43, 0
    s_mov_b32 s26, 16384
    s_mov_b32 s27, 0x20000
    s_cmp_lt_u32 s18, 2
    s_cselect_b32 s28, s52, s54
    s_cselect_b32 s29, s53, s55
    s_sub_u32 s28, s28, 3072
    s_subb_u32 s29, s29, 0
    s_mov_b32 s30, 2100224
    s_mov_b32 s31, 0x20000
    s_mov_b32 s32, s36
    s_mov_b32 s33, s37
    s_mov_b32 s34, 8388608
    s_mov_b32 s35, 0x20000
    v_bfe_u32 v59, v24, 1, 3
    v_xor_b32 v59, v59, v25
    v_lshlrev_b32 v59, 4, v59
    v_lshl_add_u32 v59, v26, 7, v59
    s_lshl_b32 s38, s19, 13
    s_lshl_b32 s39, s20, 13
    v_xor_b32 v58, 0, v59
    v_add_u32 v16, s38, v58
    v_add_u32 v18, s39, v58
    v_add_u32 v20, 0x10000, v16
    v_add_u32 v22, 0x10000, v18
    v_xor_b32 v58, 64, v59
    v_add_u32 v17, s38, v58
    v_add_u32 v19, s39, v58
    v_add_u32 v21, 0x10000, v17
    v_add_u32 v23, 0x10000, v19
    v_and_b32 v58, 31, v24
    v_lshlrev_b32 v27, 4, v58
    s_sub_u32 s38, 15, s16
    s_lshl_b32 s38, s38, 10
    s_lshl_b32 s39, s20, 9
    s_add_u32 s92, s38, s39
    v_add_u32 v27, s92, v27
    s_cmp_eq_u32 s19, 1
    s_cselect_b64 s[98:99], -1, 0
    s_waitcnt lgkmcnt(0)
    s_mul_i32 s93, s93, 1664525
    s_add_u32 s93, s93, 1013904223
    s_lshl_b32 s38, s20, 8
    s_add_u32 s38, s38, 32768
    v_lshl_add_u32 v193, v26, 4, s38
    s_lshl_b32 s39, s19, 11
    v_lshl_add_u32 v192, v25, 9, v193
    v_add_u32 v192, s39, v192
    v_lshlrev_b32 v194, 10, v25
    v_lshl_add_u32 v194, v26, 4, v194
    s_add_u32 s38, s92, 1024
    v_add_u32 v194, s38, v194
    v_sub_u32 v58, s16, v25
    v_mov_b32 v59, s93
    v_cmp_lt_i32 vcc, 0, v58
    s_nop 1
    v_cndmask_b32 v198, 0, v59, vcc
    v_cmp_lt_i32 vcc, 4, v58
    s_nop 1
    v_cndmask_b32 v199, 0, v59, vcc
    v_cmp_lt_i32 vcc, 8, v58
    s_nop 1
    v_cndmask_b32 v200, 0, v59, vcc
    v_cmp_lt_i32 vcc, 12, v58
    s_nop 1
    v_cndmask_b32 v201, 0, v59, vcc
    s_mul_i32 s38, s18, 9216
    s_add_u32 s38, s38, 36864
    v_mul_u32_u24 v195, 144, v26
    v_lshl_add_u32 v195, v25, 5, v195
    v_add_u32 v195, s38, v195
    v_bfe_u32 v196, v24, 2, 2
    v_lshl_add_u32 v196, v25, 3, v196
    v_mul_u32_u24 v196, 144, v196
    v_and_b32 v58, 3, v24
    v_lshl_add_u32 v196, v58, 3, v196
    v_add_u32 v196, s38, v196
    v_lshlrev_b32 v197, 4, v24
    s_lshl_b32 s38, s17, 6
    s_lshl_b32 s39, s19, 5
    s_add_u32 s38, s38, s39
    v_add_u32 v58, s38, v56
    v_lshl_add_u32 v58, v58, 11, v57
    v_xor_b32 v59, 64, v58
    v_add_u32 v202, 3072, v58
    v_add_u32 v203, 18432, v59
    v_add_u32 v204, 33792, v58
    v_add_u32 v205, 49152, v59
    s_mov_b32 s55, 0
    s_and_b32 s54, s17, 8
    s_lshl_b32 s48, s16, 19
    s_lshl_b32 s39, s17, 15
    s_add_u32 s53, s48, s39
    s_lshl_b32 s39, s20, 11
    s_add_u32 s53, s53, s39
    s_lshl_b32 s39, s19, 14
    s_add_u32 s53, s53, s39
    s_lshl_b32 s51, s16, 7
    s_lshl_b32 s38, s18, 5
    s_add_u32 s51, s51, s38
    s_lshl_b32 s57, s51, 3
    s_add_u32 s57, s57, 9453568
    s_lshl_b32 s56, s51, 11
    s_lshl_b32 s39, s17, 7
    s_add_u32 s56, s56, s39
    v_lshlrev_b32 v220, 11, v25
    v_lshl_add_u32 v220, v26, 3, v220
    v_and_b32 v221, 31, v24
    v_lshlrev_b32 v221, 3, v221
    v_lshl_add_u32 v222, v26, 3, s39
    s_lshl_b32 s39, s18, 14
    s_add_u32 s39, s39, 98304
    v_and_b32 v4, 7, v24
    v_lshlrev_b32 v4, 9, v4
    v_bfe_u32 v5, v24, 3, 1
    v_lshl_add_u32 v4, v5, 6, v4
    v_lshl_add_u32 v4, v25, 4, v4
    v_add_u32 v4, s39, v4
    v_and_b32 v7, 1, v24
    v_lshlrev_b32 v5, 9, v7
    v_bfe_u32 v6, v24, 1, 1
    v_lshl_add_u32 v5, v6, 6, v5
    v_lshl_add_u32 v5, v25, 4, v5
    v_add_u32 v5, s39, v5
    v_lshrrev_b32 v6, 1, v25
    v_lshlrev_b32 v6, 6, v6
    v_lshl_add_u32 v6, v7, 5, v6
    v_and_b32 v7, 1, v25
    v_lshl_add_u32 v6, v7, 4, v6
    s_lshl_b32 s39, s18, 7
    s_add_u32 s39, s39, 163328
    v_add_u32 v6, s39, v6
    s_waitcnt vmcnt(7)
    v_lshlrev_b32 v224, 16, v224
    v_lshlrev_b32 v225, 16, v225
    v_lshlrev_b32 v226, 16, v226
    v_lshlrev_b32 v227, 16, v227
    v_lshlrev_b32 v228, 16, v228
    v_lshlrev_b32 v229, 16, v229
    v_mul_f32 v230, 1069066811, v228
    v_mul_f32 v231, 1069066811, v229
    v_exp_f32 v230, v230
    v_exp_f32 v231, v231
    s_nop 0
    v_cvt_pk_bf16_f32 v230, v230, v230
    v_lshlrev_b32 v230, 16, v230
    v_cvt_pk_bf16_f32 v231, v231, v231
    v_lshlrev_b32 v231, 16, v231
    v_pk_mul_f32 v[232:233], v[230:231], v[224:225] op_sel:[0,0] op_sel_hi:[1,1]
    v_pk_mul_f32 v[234:235], v[230:231], v[226:227] op_sel:[0,0] op_sel_hi:[1,1]
    v_mul_f32 v232, 1069066811, v232
    v_mul_f32 v234, 1042479491, v234
    v_mul_f32 v233, 1069066811, v233
    v_mul_f32 v235, 1042479491, v235
    v_exp_f32 v232, v232
    v_rndne_f32 v236, v234
    v_exp_f32 v233, v233
    v_rndne_f32 v237, v235
    v_sub_f32 v234, v234, v236
    v_sub_f32 v235, v235, v237
    v_cos_f32 v236, v234
    v_sin_f32 v238, v234
    v_cos_f32 v237, v235
    v_sin_f32 v239, v235
    v_pk_mul_f32 v[240:241], v[224:225], v[224:225] op_sel:[0,0] op_sel_hi:[1,1]
    v_pk_fma_f32 v[240:241], v[226:227], v[226:227], v[240:241] op_sel:[0,0,0] op_sel_hi:[1,1,1]
    v_pk_mul_f32 v[28:29], v[232:233], v[236:237] op_sel:[0,0] op_sel_hi:[1,1]
    v_pk_mul_f32 v[30:31], v[232:233], v[238:239] op_sel:[0,0] op_sel_hi:[1,1]
    v_rcp_f32 v240, v240
    v_rcp_f32 v241, v241
    v_add_f32 v230, -1.0, v28
    v_add_f32 v231, -1.0, v29
    v_pk_add_f32 v[240:241], v[240:241], v[240:241]
    v_pk_mul_f32 v[232:233], v[230:231], v[224:225] op_sel:[0,0] op_sel_hi:[1,1]
    v_pk_fma_f32 v[232:233], v[30:31], v[226:227], v[232:233] op_sel:[0,0,0] op_sel_hi:[1,1,1]
    v_pk_mul_f32 v[234:235], v[30:31], v[224:225] op_sel:[0,0] op_sel_hi:[1,1]
    v_pk_fma_f32 v[234:235], v[230:231], v[226:227], v[234:235] op_sel:[0,0,0] op_sel_hi:[1,1,1] neg_lo:[1,0,0] neg_hi:[1,0,0]
    v_pk_mul_f32 v[32:33], v[232:233], v[240:241] op_sel:[0,0] op_sel_hi:[1,1]
    v_pk_mul_f32 v[34:35], v[234:235], v[240:241] op_sel:[0,0] op_sel_hi:[1,1]
    v_pk_mul_f32 v[224:225], v[28:29], v[28:29] op_sel:[0,0] op_sel_hi:[1,1]
    v_pk_mul_f32 v[226:227], v[28:29], v[30:31] op_sel:[0,0] op_sel_hi:[1,1]
    v_pk_fma_f32 v[224:225], v[30:31], v[30:31], v[224:225] op_sel:[0,0,0] op_sel_hi:[1,1,1] neg_lo:[1,0,0] neg_hi:[1,0,0]
    v_pk_add_f32 v[226:227], v[226:227], v[226:227]
    v_pk_mul_f32 v[228:229], v[224:225], v[224:225] op_sel:[0,0] op_sel_hi:[1,1]
    v_pk_mul_f32 v[230:231], v[224:225], v[226:227] op_sel:[0,0] op_sel_hi:[1,1]
    v_pk_fma_f32 v[228:229], v[226:227], v[226:227], v[228:229] op_sel:[0,0,0] op_sel_hi:[1,1,1] neg_lo:[1,0,0] neg_hi:[1,0,0]
    v_pk_add_f32 v[230:231], v[230:231], v[230:231]
    v_pk_mul_f32 v[36:37], v[228:229], v[228:229] op_sel:[0,0] op_sel_hi:[1,1]
    v_pk_mul_f32 v[38:39], v[228:229], v[230:231] op_sel:[0,0] op_sel_hi:[1,1]
    v_pk_fma_f32 v[36:37], v[230:231], v[230:231], v[36:37] op_sel:[0,0,0] op_sel_hi:[1,1,1] neg_lo:[1,0,0] neg_hi:[1,0,0]
    v_pk_add_f32 v[38:39], v[38:39], v[38:39]
    v_pk_mul_f32 v[40:41], v[36:37], v[36:37] op_sel:[0,0] op_sel_hi:[1,1]
    v_pk_mul_f32 v[42:43], v[36:37], v[38:39] op_sel:[0,0] op_sel_hi:[1,1]
    v_pk_fma_f32 v[40:41], v[38:39], v[38:39], v[40:41] op_sel:[0,0,0] op_sel_hi:[1,1,1] neg_lo:[1,0,0] neg_hi:[1,0,0]
    v_pk_add_f32 v[42:43], v[42:43], v[42:43]
    v_pk_mul_f32 v[224:225], v[40:41], v[40:41] op_sel:[0,0] op_sel_hi:[1,1]
    v_pk_mul_f32 v[226:227], v[40:41], v[42:43] op_sel:[0,0] op_sel_hi:[1,1]
    v_pk_fma_f32 v[224:225], v[42:43], v[42:43], v[224:225] op_sel:[0,0,0] op_sel_hi:[1,1,1] neg_lo:[1,0,0] neg_hi:[1,0,0]
    v_pk_add_f32 v[226:227], v[226:227], v[226:227]
    v_pk_mul_f32 v[228:229], v[224:225], v[224:225] op_sel:[0,0] op_sel_hi:[1,1]
    v_pk_mul_f32 v[230:231], v[224:225], v[226:227] op_sel:[0,0] op_sel_hi:[1,1]
    v_pk_fma_f32 v[228:229], v[226:227], v[226:227], v[228:229] op_sel:[0,0,0] op_sel_hi:[1,1,1] neg_lo:[1,0,0] neg_hi:[1,0,0]
    v_pk_add_f32 v[230:231], v[230:231], v[230:231]
    v_and_b32 v240, 1, v25
    v_cmp_eq_u32 s[84:85], 1, v240
    v_cmp_lt_u32 s[86:87], 1, v25
    s_nop 0
    v_cndmask_b32 v232, 1.0, v40, s[84:85]
    v_cndmask_b32 v234, 0, v42, s[84:85]
    v_cndmask_b32 v233, 1.0, v41, s[84:85]
    v_cndmask_b32 v235, 0, v43, s[84:85]
    v_cndmask_b32 v236, 1.0, v224, s[86:87]
    v_cndmask_b32 v238, 0, v226, s[86:87]
    v_cndmask_b32 v237, 1.0, v225, s[86:87]
    v_cndmask_b32 v239, 0, v227, s[86:87]
    v_pk_mul_f32 v[242:243], v[232:233], v[236:237] op_sel:[0,0] op_sel_hi:[1,1]
    v_pk_mul_f32 v[244:245], v[232:233], v[238:239] op_sel:[0,0] op_sel_hi:[1,1]
    v_pk_fma_f32 v[242:243], v[234:235], v[238:239], v[242:243] op_sel:[0,0,0] op_sel_hi:[1,1,1] neg_lo:[1,0,0] neg_hi:[1,0,0]
    v_pk_fma_f32 v[244:245], v[234:235], v[236:237], v[244:245] op_sel:[0,0,0] op_sel_hi:[1,1,1]
    v_cndmask_b32 v232, 1.0, v228, s[98:99]
    v_cndmask_b32 v234, 0, v230, s[98:99]
    v_cndmask_b32 v233, 1.0, v229, s[98:99]
    v_cndmask_b32 v235, 0, v231, s[98:99]
    v_pk_mul_f32 v[52:53], v[242:243], v[232:233] op_sel:[0,0] op_sel_hi:[1,1]
    v_pk_mul_f32 v[54:55], v[242:243], v[234:235] op_sel:[0,0] op_sel_hi:[1,1]
    v_pk_fma_f32 v[52:53], v[244:245], v[234:235], v[52:53] op_sel:[0,0,0] op_sel_hi:[1,1,1] neg_lo:[1,0,0] neg_hi:[1,0,0]
    v_pk_fma_f32 v[54:55], v[244:245], v[232:233], v[54:55] op_sel:[0,0,0] op_sel_hi:[1,1,1]
    v_pk_mul_f32 v[224:225], v[228:229], v[228:229] op_sel:[0,0] op_sel_hi:[1,1]
    v_pk_mul_f32 v[226:227], v[228:229], v[230:231] op_sel:[0,0] op_sel_hi:[1,1]
    v_pk_fma_f32 v[224:225], v[230:231], v[230:231], v[224:225] op_sel:[0,0,0] op_sel_hi:[1,1,1] neg_lo:[1,0,0] neg_hi:[1,0,0]
    v_pk_add_f32 v[226:227], v[226:227], v[226:227]
    v_pk_mul_f32 v[228:229], v[224:225], v[224:225] op_sel:[0,0] op_sel_hi:[1,1]
    v_pk_mul_f32 v[230:231], v[224:225], v[226:227] op_sel:[0,0] op_sel_hi:[1,1]
    v_pk_fma_f32 v[228:229], v[226:227], v[226:227], v[228:229] op_sel:[0,0,0] op_sel_hi:[1,1,1] neg_lo:[1,0,0] neg_hi:[1,0,0]
    v_pk_add_f32 v[230:231], v[230:231], v[230:231]
    v_pk_mul_f32 v[44:45], v[228:229], v[228:229] op_sel:[0,0] op_sel_hi:[1,1]
    v_pk_mul_f32 v[46:47], v[228:229], v[230:231] op_sel:[0,0] op_sel_hi:[1,1]
    v_pk_fma_f32 v[44:45], v[230:231], v[230:231], v[44:45] op_sel:[0,0,0] op_sel_hi:[1,1,1] neg_lo:[1,0,0] neg_hi:[1,0,0]
    v_pk_add_f32 v[46:47], v[46:47], v[46:47]
    v_cndmask_b32 v232, 1.0, v224, s[84:85]
    v_cndmask_b32 v234, 0, v226, s[84:85]
    v_cndmask_b32 v233, 1.0, v225, s[84:85]
    v_cndmask_b32 v235, 0, v227, s[84:85]
    v_cndmask_b32 v236, 1.0, v228, s[86:87]
    v_cndmask_b32 v238, 0, v230, s[86:87]
    v_cndmask_b32 v237, 1.0, v229, s[86:87]
    v_cndmask_b32 v239, 0, v231, s[86:87]
    v_pk_mul_f32 v[48:49], v[232:233], v[236:237] op_sel:[0,0] op_sel_hi:[1,1]
    v_pk_mul_f32 v[50:51], v[232:233], v[238:239] op_sel:[0,0] op_sel_hi:[1,1]
    v_pk_fma_f32 v[48:49], v[234:235], v[238:239], v[48:49] op_sel:[0,0,0] op_sel_hi:[1,1,1] neg_lo:[1,0,0] neg_hi:[1,0,0]
    v_pk_fma_f32 v[50:51], v[234:235], v[236:237], v[50:51] op_sel:[0,0,0] op_sel_hi:[1,1,1]
    v_mov_b32 v224, v52
    v_mov_b32 v226, v54
    v_mul_f32 v225, v36, v52
    v_mul_f32 v227, v36, v54
    v_fma_f32 v225, -v38, v54, v225
    v_fma_f32 v227, v38, v52, v227
    v_pk_mul_f32 v[206:207], v[32:33], v[224:225] op_sel:[0,0] op_sel_hi:[0,1]
    v_pk_mul_f32 v[208:209], v[32:33], v[226:227] op_sel:[0,0] op_sel_hi:[0,1]
    v_pk_fma_f32 v[206:207], v[34:35], v[226:227], v[206:207] op_sel:[0,0,0] op_sel_hi:[0,1,1] neg_lo:[1,0,0] neg_hi:[1,0,0]
    v_pk_fma_f32 v[208:209], v[34:35], v[224:225], v[208:209] op_sel:[0,0,0] op_sel_hi:[0,1,1]
    v_mov_b32 v224, v53
    v_mov_b32 v226, v55
    v_mul_f32 v225, v37, v53
    v_mul_f32 v227, v37, v55
    v_fma_f32 v225, -v39, v55, v225
    v_fma_f32 v227, v39, v53, v227
    v_pk_mul_f32 v[210:211], v[32:33], v[224:225] op_sel:[1,0] op_sel_hi:[1,1]
    v_pk_mul_f32 v[212:213], v[32:33], v[226:227] op_sel:[1,0] op_sel_hi:[1,1]
    v_pk_fma_f32 v[210:211], v[34:35], v[226:227], v[210:211] op_sel:[1,0,0] op_sel_hi:[1,1,1] neg_lo:[1,0,0] neg_hi:[1,0,0]
    v_pk_fma_f32 v[212:213], v[34:35], v[224:225], v[212:213] op_sel:[1,0,0] op_sel_hi:[1,1,1]
    s_waitcnt vmcnt(2)
    ds_read_b128 v[224:227], v4 offset:0
    ds_read_b128 v[240:243], v5 offset:4096
    ds_read_b128 v[228:231], v4 offset:128
    ds_read_b128 v[244:247], v5 offset:4224
    ds_read_b128 v[232:235], v4 offset:256
    ds_read_b128 v[248:251], v5 offset:4352
    ds_read_b128 v[236:239], v4 offset:384
    ds_read_b128 v[252:255], v5 offset:4480
    s_waitcnt lgkmcnt(0)
    v_mfma_f32_16x16x32_bf16 v[12:15], v[224:227], v[240:243], 0
    v_mfma_f32_16x16x32_bf16 v[12:15], v[228:231], v[244:247], v[12:15]
    v_mfma_f32_16x16x32_bf16 v[12:15], v[232:235], v[248:251], v[12:15]
    v_mfma_f32_16x16x32_bf16 v[12:15], v[236:239], v[252:255], v[12:15]
    s_nop 7
    s_mov_b32 exec_lo, 0x00030003
    s_mov_b32 exec_hi, 0x000c000c
    ds_write_b128 v6, v[12:15]
    s_mov_b64 exec, -1
    s_waitcnt lgkmcnt(0)
    s_barrier
    ds_read_b128 v[128:131], v16 offset:0
    ds_read_b128 v[144:147], v18 offset:16384
    ds_read_b128 v[148:151], v18 offset:18432
    ds_read_b128 v[152:155], v18 offset:20480
    ds_read_b128 v[156:159], v18 offset:22528
    ds_read_b128 v[132:135], v16 offset:2048
    ds_read_b128 v[136:139], v16 offset:4096
    ds_read_b128 v[140:143], v16 offset:6144
    s_waitcnt lgkmcnt(0)
    v_mfma_f32_16x16x32_bf16 v[64:67], v[128:131], v[144:147], 0
    ds_read_b128 v[160:163], v17 offset:0
    v_mfma_f32_16x16x32_bf16 v[68:71], v[128:131], v[148:151], 0
    ds_read_b128 v[176:179], v19 offset:16384
    v_mfma_f32_16x16x32_bf16 v[72:75], v[128:131], v[152:155], 0
    v_mfma_f32_16x16x32_bf16 v[76:79], v[128:131], v[156:159], 0
    ds_read_b128 v[180:183], v19 offset:18432
    v_mfma_f32_16x16x32_bf16 v[80:83], v[132:135], v[144:147], 0
    ds_read_b128 v[184:187], v19 offset:20480
    v_mfma_f32_16x16x32_bf16 v[84:87], v[132:135], v[148:151], 0
    v_mfma_f32_16x16x32_bf16 v[88:91], v[132:135], v[152:155], 0
    ds_read_b128 v[188:191], v19 offset:22528
    v_mfma_f32_16x16x32_bf16 v[92:95], v[132:135], v[156:159], 0
    ds_read_b128 v[164:167], v17 offset:2048
    v_mfma_f32_16x16x32_bf16 v[96:99], v[136:139], v[144:147], 0
    v_mfma_f32_16x16x32_bf16 v[100:103], v[136:139], v[148:151], 0
    ds_read_b128 v[168:171], v17 offset:4096
    v_mfma_f32_16x16x32_bf16 v[104:107], v[136:139], v[152:155], 0
    ds_read_b128 v[172:175], v17 offset:6144
    v_mfma_f32_16x16x32_bf16 v[108:111], v[136:139], v[156:159], 0
    v_mfma_f32_16x16x32_bf16 v[112:115], v[140:143], v[144:147], 0
    v_mfma_f32_16x16x32_bf16 v[116:119], v[140:143], v[148:151], 0
    v_mfma_f32_16x16x32_bf16 v[120:123], v[140:143], v[152:155], 0
    v_mfma_f32_16x16x32_bf16 v[124:127], v[140:143], v[156:159], 0
    s_waitcnt lgkmcnt(0)
    s_barrier
    v_mfma_f32_16x16x32_bf16 v[64:67], v[160:163], v[176:179], v[64:67]
    ds_read_b128 v[128:131], v16 offset:32768
    v_mfma_f32_16x16x32_bf16 v[68:71], v[160:163], v[180:183], v[68:71]
    ds_read_b128 v[144:147], v18 offset:49152
    v_mfma_f32_16x16x32_bf16 v[72:75], v[160:163], v[184:187], v[72:75]
    v_mfma_f32_16x16x32_bf16 v[76:79], v[160:163], v[188:191], v[76:79]
    ds_read_b128 v[148:151], v18 offset:51200
    v_mfma_f32_16x16x32_bf16 v[80:83], v[164:167], v[176:179], v[80:83]
    ds_read_b128 v[152:155], v18 offset:53248
    v_mfma_f32_16x16x32_bf16 v[84:87], v[164:167], v[180:183], v[84:87]
    v_mfma_f32_16x16x32_bf16 v[88:91], v[164:167], v[184:187], v[88:91]
    ds_read_b128 v[156:159], v18 offset:55296
    v_mfma_f32_16x16x32_bf16 v[92:95], v[164:167], v[188:191], v[92:95]
    ds_read_b128 v[132:135], v16 offset:34816
    v_mfma_f32_16x16x32_bf16 v[96:99], v[168:171], v[176:179], v[96:99]
    v_mfma_f32_16x16x32_bf16 v[100:103], v[168:171], v[180:183], v[100:103]
    ds_read_b128 v[136:139], v16 offset:36864
    v_mfma_f32_16x16x32_bf16 v[104:107], v[168:171], v[184:187], v[104:107]
    ds_read_b128 v[140:143], v16 offset:38912
    v_mfma_f32_16x16x32_bf16 v[108:111], v[168:171], v[188:191], v[108:111]
    v_mfma_f32_16x16x32_bf16 v[112:115], v[172:175], v[176:179], v[112:115]
    v_mfma_f32_16x16x32_bf16 v[116:119], v[172:175], v[180:183], v[116:119]
    v_mfma_f32_16x16x32_bf16 v[120:123], v[172:175], v[184:187], v[120:123]
    v_mfma_f32_16x16x32_bf16 v[124:127], v[172:175], v[188:191], v[124:127]
    s_waitcnt lgkmcnt(0)
    v_mfma_f32_16x16x32_bf16 v[64:67], v[128:131], v[144:147], v[64:67]
    ds_read_b128 v[160:163], v17 offset:32768
    v_mfma_f32_16x16x32_bf16 v[68:71], v[128:131], v[148:151], v[68:71]
    ds_read_b128 v[176:179], v19 offset:49152
    v_mfma_f32_16x16x32_bf16 v[72:75], v[128:131], v[152:155], v[72:75]
    v_mfma_f32_16x16x32_bf16 v[76:79], v[128:131], v[156:159], v[76:79]
    ds_read_b128 v[180:183], v19 offset:51200
    v_mfma_f32_16x16x32_bf16 v[80:83], v[132:135], v[144:147], v[80:83]
    ds_read_b128 v[184:187], v19 offset:53248
    v_mfma_f32_16x16x32_bf16 v[84:87], v[132:135], v[148:151], v[84:87]
    v_mfma_f32_16x16x32_bf16 v[88:91], v[132:135], v[152:155], v[88:91]
    ds_read_b128 v[188:191], v19 offset:55296
    v_mfma_f32_16x16x32_bf16 v[92:95], v[132:135], v[156:159], v[92:95]
    ds_read_b128 v[164:167], v17 offset:34816
    v_mfma_f32_16x16x32_bf16 v[96:99], v[136:139], v[144:147], v[96:99]
    v_mfma_f32_16x16x32_bf16 v[100:103], v[136:139], v[148:151], v[100:103]
    ds_read_b128 v[168:171], v17 offset:36864
    v_mfma_f32_16x16x32_bf16 v[104:107], v[136:139], v[152:155], v[104:107]
    ds_read_b128 v[172:175], v17 offset:38912
    v_mfma_f32_16x16x32_bf16 v[108:111], v[136:139], v[156:159], v[108:111]
    v_mfma_f32_16x16x32_bf16 v[112:115], v[140:143], v[144:147], v[112:115]
    v_mfma_f32_16x16x32_bf16 v[116:119], v[140:143], v[148:151], v[116:119]
    v_mfma_f32_16x16x32_bf16 v[120:123], v[140:143], v[152:155], v[120:123]
    v_mfma_f32_16x16x32_bf16 v[124:127], v[140:143], v[156:159], v[124:127]
    s_waitcnt lgkmcnt(0)
    s_barrier
    v_mfma_f32_16x16x32_bf16 v[64:67], v[160:163], v[176:179], v[64:67]
    ds_read_b128 v[128:131], v20 offset:0
    v_mfma_f32_16x16x32_bf16 v[68:71], v[160:163], v[180:183], v[68:71]
    ds_read_b128 v[144:147], v22 offset:16384
    v_mfma_f32_16x16x32_bf16 v[72:75], v[160:163], v[184:187], v[72:75]
    v_mfma_f32_16x16x32_bf16 v[76:79], v[160:163], v[188:191], v[76:79]
    ds_read_b128 v[148:151], v22 offset:18432
    v_mfma_f32_16x16x32_bf16 v[80:83], v[164:167], v[176:179], v[80:83]
    ds_read_b128 v[152:155], v22 offset:20480
    v_mfma_f32_16x16x32_bf16 v[84:87], v[164:167], v[180:183], v[84:87]
    v_mfma_f32_16x16x32_bf16 v[88:91], v[164:167], v[184:187], v[88:91]
    ds_read_b128 v[156:159], v22 offset:22528
    v_mfma_f32_16x16x32_bf16 v[92:95], v[164:167], v[188:191], v[92:95]
    ds_read_b128 v[132:135], v20 offset:2048
    v_mfma_f32_16x16x32_bf16 v[96:99], v[168:171], v[176:179], v[96:99]
    v_mfma_f32_16x16x32_bf16 v[100:103], v[168:171], v[180:183], v[100:103]
    ds_read_b128 v[136:139], v20 offset:4096
    v_mfma_f32_16x16x32_bf16 v[104:107], v[168:171], v[184:187], v[104:107]
    ds_read_b128 v[140:143], v20 offset:6144
    v_mfma_f32_16x16x32_bf16 v[108:111], v[168:171], v[188:191], v[108:111]
    v_mfma_f32_16x16x32_bf16 v[112:115], v[172:175], v[176:179], v[112:115]
    v_mfma_f32_16x16x32_bf16 v[116:119], v[172:175], v[180:183], v[116:119]
    v_mfma_f32_16x16x32_bf16 v[120:123], v[172:175], v[184:187], v[120:123]
    v_mfma_f32_16x16x32_bf16 v[124:127], v[172:175], v[188:191], v[124:127]
    s_waitcnt lgkmcnt(0)
    v_mfma_f32_16x16x32_bf16 v[64:67], v[128:131], v[144:147], v[64:67]
    ds_read_b128 v[160:163], v21 offset:0
    v_mfma_f32_16x16x32_bf16 v[68:71], v[128:131], v[148:151], v[68:71]
    ds_read_b128 v[176:179], v23 offset:16384
    v_mfma_f32_16x16x32_bf16 v[72:75], v[128:131], v[152:155], v[72:75]
    v_mfma_f32_16x16x32_bf16 v[76:79], v[128:131], v[156:159], v[76:79]
    ds_read_b128 v[180:183], v23 offset:18432
    v_mfma_f32_16x16x32_bf16 v[80:83], v[132:135], v[144:147], v[80:83]
    ds_read_b128 v[184:187], v23 offset:20480
    v_mfma_f32_16x16x32_bf16 v[84:87], v[132:135], v[148:151], v[84:87]
    v_mfma_f32_16x16x32_bf16 v[88:91], v[132:135], v[152:155], v[88:91]
    ds_read_b128 v[188:191], v23 offset:22528
    v_mfma_f32_16x16x32_bf16 v[92:95], v[132:135], v[156:159], v[92:95]
    ds_read_b128 v[164:167], v21 offset:2048
    v_mfma_f32_16x16x32_bf16 v[96:99], v[136:139], v[144:147], v[96:99]
    v_mfma_f32_16x16x32_bf16 v[100:103], v[136:139], v[148:151], v[100:103]
    ds_read_b128 v[168:171], v21 offset:4096
    v_mfma_f32_16x16x32_bf16 v[104:107], v[136:139], v[152:155], v[104:107]
    ds_read_b128 v[172:175], v21 offset:6144
    v_mfma_f32_16x16x32_bf16 v[108:111], v[136:139], v[156:159], v[108:111]
    v_mfma_f32_16x16x32_bf16 v[112:115], v[140:143], v[144:147], v[112:115]
    v_mfma_f32_16x16x32_bf16 v[116:119], v[140:143], v[148:151], v[116:119]
    v_mfma_f32_16x16x32_bf16 v[120:123], v[140:143], v[152:155], v[120:123]
    v_mfma_f32_16x16x32_bf16 v[124:127], v[140:143], v[156:159], v[124:127]
    s_waitcnt lgkmcnt(0)
    s_barrier
    v_mfma_f32_16x16x32_bf16 v[64:67], v[160:163], v[176:179], v[64:67]
    ds_read_b128 v[128:131], v16 offset:0
    v_mfma_f32_16x16x32_bf16 v[68:71], v[160:163], v[180:183], v[68:71]
    ds_read_b128 v[144:147], v18 offset:16384
    v_mfma_f32_16x16x32_bf16 v[72:75], v[160:163], v[184:187], v[72:75]
    v_mfma_f32_16x16x32_bf16 v[76:79], v[160:163], v[188:191], v[76:79]
    ds_read_b128 v[148:151], v18 offset:18432
    v_mfma_f32_16x16x32_bf16 v[80:83], v[164:167], v[176:179], v[80:83]
    ds_read_b128 v[152:155], v18 offset:20480
    v_mfma_f32_16x16x32_bf16 v[84:87], v[164:167], v[180:183], v[84:87]
    v_mfma_f32_16x16x32_bf16 v[88:91], v[164:167], v[184:187], v[88:91]
    ds_read_b128 v[156:159], v18 offset:22528
    v_mfma_f32_16x16x32_bf16 v[92:95], v[164:167], v[188:191], v[92:95]
    ds_read_b128 v[132:135], v16 offset:2048
    v_mfma_f32_16x16x32_bf16 v[96:99], v[168:171], v[176:179], v[96:99]
    v_mfma_f32_16x16x32_bf16 v[100:103], v[168:171], v[180:183], v[100:103]
    ds_read_b128 v[136:139], v16 offset:4096
    v_mfma_f32_16x16x32_bf16 v[104:107], v[168:171], v[184:187], v[104:107]
    ds_read_b128 v[140:143], v16 offset:6144
    v_mfma_f32_16x16x32_bf16 v[108:111], v[168:171], v[188:191], v[108:111]
    v_mfma_f32_16x16x32_bf16 v[112:115], v[172:175], v[176:179], v[112:115]
    v_mfma_f32_16x16x32_bf16 v[116:119], v[172:175], v[180:183], v[116:119]
    v_mfma_f32_16x16x32_bf16 v[120:123], v[172:175], v[184:187], v[120:123]
    v_mfma_f32_16x16x32_bf16 v[124:127], v[172:175], v[188:191], v[124:127]
    s_waitcnt lgkmcnt(0)
    v_mfma_f32_16x16x32_bf16 v[64:67], v[128:131], v[144:147], v[64:67]
    ds_read_b128 v[160:163], v17 offset:0
    v_mfma_f32_16x16x32_bf16 v[68:71], v[128:131], v[148:151], v[68:71]
    ds_read_b128 v[176:179], v19 offset:16384
    v_mfma_f32_16x16x32_bf16 v[72:75], v[128:131], v[152:155], v[72:75]
    v_mfma_f32_16x16x32_bf16 v[76:79], v[128:131], v[156:159], v[76:79]
    ds_read_b128 v[180:183], v19 offset:18432
    v_mfma_f32_16x16x32_bf16 v[80:83], v[132:135], v[144:147], v[80:83]
    ds_read_b128 v[184:187], v19 offset:20480
    v_mfma_f32_16x16x32_bf16 v[84:87], v[132:135], v[148:151], v[84:87]
    v_mfma_f32_16x16x32_bf16 v[88:91], v[132:135], v[152:155], v[88:91]
    ds_read_b128 v[188:191], v19 offset:22528
    v_mfma_f32_16x16x32_bf16 v[92:95], v[132:135], v[156:159], v[92:95]
    ds_read_b128 v[164:167], v17 offset:2048
    v_mfma_f32_16x16x32_bf16 v[96:99], v[136:139], v[144:147], v[96:99]
    v_mfma_f32_16x16x32_bf16 v[100:103], v[136:139], v[148:151], v[100:103]
    ds_read_b128 v[168:171], v17 offset:4096
    v_mfma_f32_16x16x32_bf16 v[104:107], v[136:139], v[152:155], v[104:107]
    ds_read_b128 v[172:175], v17 offset:6144
    v_mfma_f32_16x16x32_bf16 v[108:111], v[136:139], v[156:159], v[108:111]
    v_mfma_f32_16x16x32_bf16 v[112:115], v[140:143], v[144:147], v[112:115]
    v_mfma_f32_16x16x32_bf16 v[116:119], v[140:143], v[148:151], v[116:119]
    v_mfma_f32_16x16x32_bf16 v[120:123], v[140:143], v[152:155], v[120:123]
    v_mfma_f32_16x16x32_bf16 v[124:127], v[140:143], v[156:159], v[124:127]
    s_waitcnt lgkmcnt(0)
    s_barrier
    v_mfma_f32_16x16x32_bf16 v[64:67], v[160:163], v[176:179], v[64:67]
    ds_read_b128 v[128:131], v16 offset:32768
    v_mfma_f32_16x16x32_bf16 v[68:71], v[160:163], v[180:183], v[68:71]
    ds_read_b128 v[144:147], v18 offset:49152
    v_mfma_f32_16x16x32_bf16 v[72:75], v[160:163], v[184:187], v[72:75]
    v_mfma_f32_16x16x32_bf16 v[76:79], v[160:163], v[188:191], v[76:79]
    ds_read_b128 v[148:151], v18 offset:51200
    v_mfma_f32_16x16x32_bf16 v[80:83], v[164:167], v[176:179], v[80:83]
    ds_read_b128 v[152:155], v18 offset:53248
    v_mfma_f32_16x16x32_bf16 v[84:87], v[164:167], v[180:183], v[84:87]
    v_mfma_f32_16x16x32_bf16 v[88:91], v[164:167], v[184:187], v[88:91]
    ds_read_b128 v[156:159], v18 offset:55296
    v_mfma_f32_16x16x32_bf16 v[92:95], v[164:167], v[188:191], v[92:95]
    ds_read_b128 v[132:135], v16 offset:34816
    v_mfma_f32_16x16x32_bf16 v[96:99], v[168:171], v[176:179], v[96:99]
    v_mfma_f32_16x16x32_bf16 v[100:103], v[168:171], v[180:183], v[100:103]
    ds_read_b128 v[136:139], v16 offset:36864
    v_mfma_f32_16x16x32_bf16 v[104:107], v[168:171], v[184:187], v[104:107]
    ds_read_b128 v[140:143], v16 offset:38912
    v_mfma_f32_16x16x32_bf16 v[108:111], v[168:171], v[188:191], v[108:111]
    v_mfma_f32_16x16x32_bf16 v[112:115], v[172:175], v[176:179], v[112:115]
    v_mfma_f32_16x16x32_bf16 v[116:119], v[172:175], v[180:183], v[116:119]
    v_mfma_f32_16x16x32_bf16 v[120:123], v[172:175], v[184:187], v[120:123]
    v_mfma_f32_16x16x32_bf16 v[124:127], v[172:175], v[188:191], v[124:127]
    s_waitcnt lgkmcnt(0)
    v_mfma_f32_16x16x32_bf16 v[64:67], v[128:131], v[144:147], v[64:67]
    ds_read_b128 v[160:163], v17 offset:32768
    v_mfma_f32_16x16x32_bf16 v[68:71], v[128:131], v[148:151], v[68:71]
    ds_read_b128 v[176:179], v19 offset:49152
    v_mfma_f32_16x16x32_bf16 v[72:75], v[128:131], v[152:155], v[72:75]
    v_mfma_f32_16x16x32_bf16 v[76:79], v[128:131], v[156:159], v[76:79]
    ds_read_b128 v[180:183], v19 offset:51200
    v_mfma_f32_16x16x32_bf16 v[80:83], v[132:135], v[144:147], v[80:83]
    ds_read_b128 v[184:187], v19 offset:53248
    v_mfma_f32_16x16x32_bf16 v[84:87], v[132:135], v[148:151], v[84:87]
    v_mfma_f32_16x16x32_bf16 v[88:91], v[132:135], v[152:155], v[88:91]
    ds_read_b128 v[188:191], v19 offset:55296
    v_mfma_f32_16x16x32_bf16 v[92:95], v[132:135], v[156:159], v[92:95]
    ds_read_b128 v[164:167], v17 offset:34816
    v_mfma_f32_16x16x32_bf16 v[96:99], v[136:139], v[144:147], v[96:99]
    v_mfma_f32_16x16x32_bf16 v[100:103], v[136:139], v[148:151], v[100:103]
    ds_read_b128 v[168:171], v17 offset:36864
    v_mfma_f32_16x16x32_bf16 v[104:107], v[136:139], v[152:155], v[104:107]
    ds_read_b128 v[172:175], v17 offset:38912
    v_mfma_f32_16x16x32_bf16 v[108:111], v[136:139], v[156:159], v[108:111]
    v_mfma_f32_16x16x32_bf16 v[112:115], v[140:143], v[144:147], v[112:115]
    v_mfma_f32_16x16x32_bf16 v[116:119], v[140:143], v[148:151], v[116:119]
    v_mfma_f32_16x16x32_bf16 v[120:123], v[140:143], v[152:155], v[120:123]
    v_mfma_f32_16x16x32_bf16 v[124:127], v[140:143], v[156:159], v[124:127]
    s_waitcnt lgkmcnt(0)
    s_barrier
    v_mfma_f32_16x16x32_bf16 v[64:67], v[160:163], v[176:179], v[64:67]
    ds_read_b128 v[128:131], v20 offset:0
    v_mfma_f32_16x16x32_bf16 v[68:71], v[160:163], v[180:183], v[68:71]
    ds_read_b128 v[144:147], v22 offset:16384
    v_mfma_f32_16x16x32_bf16 v[72:75], v[160:163], v[184:187], v[72:75]
    v_mfma_f32_16x16x32_bf16 v[76:79], v[160:163], v[188:191], v[76:79]
    ds_read_b128 v[148:151], v22 offset:18432
    v_mfma_f32_16x16x32_bf16 v[80:83], v[164:167], v[176:179], v[80:83]
    ds_read_b128 v[152:155], v22 offset:20480
    v_mfma_f32_16x16x32_bf16 v[84:87], v[164:167], v[180:183], v[84:87]
    v_mfma_f32_16x16x32_bf16 v[88:91], v[164:167], v[184:187], v[88:91]
    ds_read_b128 v[156:159], v22 offset:22528
    v_mfma_f32_16x16x32_bf16 v[92:95], v[164:167], v[188:191], v[92:95]
    ds_read_b128 v[132:135], v20 offset:2048
    v_mfma_f32_16x16x32_bf16 v[96:99], v[168:171], v[176:179], v[96:99]
    v_mfma_f32_16x16x32_bf16 v[100:103], v[168:171], v[180:183], v[100:103]
    ds_read_b128 v[136:139], v20 offset:4096
    v_mfma_f32_16x16x32_bf16 v[104:107], v[168:171], v[184:187], v[104:107]
    ds_read_b128 v[140:143], v20 offset:6144
    v_mfma_f32_16x16x32_bf16 v[108:111], v[168:171], v[188:191], v[108:111]
    v_mfma_f32_16x16x32_bf16 v[112:115], v[172:175], v[176:179], v[112:115]
    v_mfma_f32_16x16x32_bf16 v[116:119], v[172:175], v[180:183], v[116:119]
    v_mfma_f32_16x16x32_bf16 v[120:123], v[172:175], v[184:187], v[120:123]
    v_mfma_f32_16x16x32_bf16 v[124:127], v[172:175], v[188:191], v[124:127]
    s_waitcnt lgkmcnt(0)
    v_mfma_f32_16x16x32_bf16 v[64:67], v[128:131], v[144:147], v[64:67]
    ds_read_b128 v[160:163], v21 offset:0
    v_mfma_f32_16x16x32_bf16 v[68:71], v[128:131], v[148:151], v[68:71]
    ds_read_b128 v[176:179], v23 offset:16384
    v_mfma_f32_16x16x32_bf16 v[72:75], v[128:131], v[152:155], v[72:75]
    v_mfma_f32_16x16x32_bf16 v[76:79], v[128:131], v[156:159], v[76:79]
    ds_read_b128 v[180:183], v23 offset:18432
    v_mfma_f32_16x16x32_bf16 v[80:83], v[132:135], v[144:147], v[80:83]
    ds_read_b128 v[184:187], v23 offset:20480
    v_mfma_f32_16x16x32_bf16 v[84:87], v[132:135], v[148:151], v[84:87]
    v_mfma_f32_16x16x32_bf16 v[88:91], v[132:135], v[152:155], v[88:91]
    ds_read_b128 v[188:191], v23 offset:22528
    v_mfma_f32_16x16x32_bf16 v[92:95], v[132:135], v[156:159], v[92:95]
    ds_read_b128 v[164:167], v21 offset:2048
    v_mfma_f32_16x16x32_bf16 v[96:99], v[136:139], v[144:147], v[96:99]
    v_mfma_f32_16x16x32_bf16 v[100:103], v[136:139], v[148:151], v[100:103]
    ds_read_b128 v[168:171], v21 offset:4096
    v_mfma_f32_16x16x32_bf16 v[104:107], v[136:139], v[152:155], v[104:107]
    ds_read_b128 v[172:175], v21 offset:6144
    v_mfma_f32_16x16x32_bf16 v[108:111], v[136:139], v[156:159], v[108:111]
    v_mfma_f32_16x16x32_bf16 v[112:115], v[140:143], v[144:147], v[112:115]
    v_mfma_f32_16x16x32_bf16 v[116:119], v[140:143], v[148:151], v[116:119]
    v_mfma_f32_16x16x32_bf16 v[120:123], v[140:143], v[152:155], v[120:123]
    v_mfma_f32_16x16x32_bf16 v[124:127], v[140:143], v[156:159], v[124:127]
    s_waitcnt lgkmcnt(0)
    s_barrier
    v_mfma_f32_16x16x32_bf16 v[64:67], v[160:163], v[176:179], v[64:67]
    ds_read_b128 v[128:131], v16 offset:0
    v_mfma_f32_16x16x32_bf16 v[68:71], v[160:163], v[180:183], v[68:71]
    ds_read_b128 v[144:147], v18 offset:16384
    v_mfma_f32_16x16x32_bf16 v[72:75], v[160:163], v[184:187], v[72:75]
    v_mfma_f32_16x16x32_bf16 v[76:79], v[160:163], v[188:191], v[76:79]
    ds_read_b128 v[148:151], v18 offset:18432
    v_mfma_f32_16x16x32_bf16 v[80:83], v[164:167], v[176:179], v[80:83]
    ds_read_b128 v[152:155], v18 offset:20480
    v_mfma_f32_16x16x32_bf16 v[84:87], v[164:167], v[180:183], v[84:87]
    v_mfma_f32_16x16x32_bf16 v[88:91], v[164:167], v[184:187], v[88:91]
    ds_read_b128 v[156:159], v18 offset:22528
    v_mfma_f32_16x16x32_bf16 v[92:95], v[164:167], v[188:191], v[92:95]
    ds_read_b128 v[132:135], v16 offset:2048
    v_mfma_f32_16x16x32_bf16 v[96:99], v[168:171], v[176:179], v[96:99]
    v_mfma_f32_16x16x32_bf16 v[100:103], v[168:171], v[180:183], v[100:103]
    ds_read_b128 v[136:139], v16 offset:4096
    v_mfma_f32_16x16x32_bf16 v[104:107], v[168:171], v[184:187], v[104:107]
    ds_read_b128 v[140:143], v16 offset:6144
    v_mfma_f32_16x16x32_bf16 v[108:111], v[168:171], v[188:191], v[108:111]
    v_mfma_f32_16x16x32_bf16 v[112:115], v[172:175], v[176:179], v[112:115]
    v_mfma_f32_16x16x32_bf16 v[116:119], v[172:175], v[180:183], v[116:119]
    v_mfma_f32_16x16x32_bf16 v[120:123], v[172:175], v[184:187], v[120:123]
    v_mfma_f32_16x16x32_bf16 v[124:127], v[172:175], v[188:191], v[124:127]
    s_waitcnt lgkmcnt(0)
    v_mfma_f32_16x16x32_bf16 v[64:67], v[128:131], v[144:147], v[64:67]
    ds_read_b128 v[160:163], v17 offset:0
    v_mfma_f32_16x16x32_bf16 v[68:71], v[128:131], v[148:151], v[68:71]
    ds_read_b128 v[176:179], v19 offset:16384
    v_mfma_f32_16x16x32_bf16 v[72:75], v[128:131], v[152:155], v[72:75]
    v_mfma_f32_16x16x32_bf16 v[76:79], v[128:131], v[156:159], v[76:79]
    ds_read_b128 v[180:183], v19 offset:18432
    v_mfma_f32_16x16x32_bf16 v[80:83], v[132:135], v[144:147], v[80:83]
    ds_read_b128 v[184:187], v19 offset:20480
    v_mfma_f32_16x16x32_bf16 v[84:87], v[132:135], v[148:151], v[84:87]
    v_mfma_f32_16x16x32_bf16 v[88:91], v[132:135], v[152:155], v[88:91]
    ds_read_b128 v[188:191], v19 offset:22528
    v_mfma_f32_16x16x32_bf16 v[92:95], v[132:135], v[156:159], v[92:95]
    ds_read_b128 v[164:167], v17 offset:2048
    v_mfma_f32_16x16x32_bf16 v[96:99], v[136:139], v[144:147], v[96:99]
    v_mfma_f32_16x16x32_bf16 v[100:103], v[136:139], v[148:151], v[100:103]
    ds_read_b128 v[168:171], v17 offset:4096
    v_mfma_f32_16x16x32_bf16 v[104:107], v[136:139], v[152:155], v[104:107]
    ds_read_b128 v[172:175], v17 offset:6144
    v_mfma_f32_16x16x32_bf16 v[108:111], v[136:139], v[156:159], v[108:111]
    v_mfma_f32_16x16x32_bf16 v[112:115], v[140:143], v[144:147], v[112:115]
    v_mfma_f32_16x16x32_bf16 v[116:119], v[140:143], v[148:151], v[116:119]
    v_mfma_f32_16x16x32_bf16 v[120:123], v[140:143], v[152:155], v[120:123]
    v_mfma_f32_16x16x32_bf16 v[124:127], v[140:143], v[156:159], v[124:127]
    s_waitcnt lgkmcnt(0)
    s_barrier
    v_mfma_f32_16x16x32_bf16 v[64:67], v[160:163], v[176:179], v[64:67]
    ds_read_b128 v[128:131], v16 offset:32768
    v_mfma_f32_16x16x32_bf16 v[68:71], v[160:163], v[180:183], v[68:71]
    ds_read_b128 v[144:147], v18 offset:49152
    v_mfma_f32_16x16x32_bf16 v[72:75], v[160:163], v[184:187], v[72:75]
    v_mfma_f32_16x16x32_bf16 v[76:79], v[160:163], v[188:191], v[76:79]
    ds_read_b128 v[148:151], v18 offset:51200
    v_mfma_f32_16x16x32_bf16 v[80:83], v[164:167], v[176:179], v[80:83]
    ds_read_b128 v[152:155], v18 offset:53248
    v_mfma_f32_16x16x32_bf16 v[84:87], v[164:167], v[180:183], v[84:87]
    v_mfma_f32_16x16x32_bf16 v[88:91], v[164:167], v[184:187], v[88:91]
    ds_read_b128 v[156:159], v18 offset:55296
    v_mfma_f32_16x16x32_bf16 v[92:95], v[164:167], v[188:191], v[92:95]
    ds_read_b128 v[132:135], v16 offset:34816
    v_mfma_f32_16x16x32_bf16 v[96:99], v[168:171], v[176:179], v[96:99]
    v_mfma_f32_16x16x32_bf16 v[100:103], v[168:171], v[180:183], v[100:103]
    ds_read_b128 v[136:139], v16 offset:36864
    v_mfma_f32_16x16x32_bf16 v[104:107], v[168:171], v[184:187], v[104:107]
    ds_read_b128 v[140:143], v16 offset:38912
    v_mfma_f32_16x16x32_bf16 v[108:111], v[168:171], v[188:191], v[108:111]
    v_mfma_f32_16x16x32_bf16 v[112:115], v[172:175], v[176:179], v[112:115]
    v_mfma_f32_16x16x32_bf16 v[116:119], v[172:175], v[180:183], v[116:119]
    v_mfma_f32_16x16x32_bf16 v[120:123], v[172:175], v[184:187], v[120:123]
    v_mfma_f32_16x16x32_bf16 v[124:127], v[172:175], v[188:191], v[124:127]
    s_waitcnt lgkmcnt(0)
    v_mfma_f32_16x16x32_bf16 v[64:67], v[128:131], v[144:147], v[64:67]
    ds_read_b128 v[160:163], v17 offset:32768
    v_mfma_f32_16x16x32_bf16 v[68:71], v[128:131], v[148:151], v[68:71]
    ds_read_b128 v[176:179], v19 offset:49152
    v_mfma_f32_16x16x32_bf16 v[72:75], v[128:131], v[152:155], v[72:75]
    v_mfma_f32_16x16x32_bf16 v[76:79], v[128:131], v[156:159], v[76:79]
    ds_read_b128 v[180:183], v19 offset:51200
    v_mfma_f32_16x16x32_bf16 v[80:83], v[132:135], v[144:147], v[80:83]
    ds_read_b128 v[184:187], v19 offset:53248
    v_mfma_f32_16x16x32_bf16 v[84:87], v[132:135], v[148:151], v[84:87]
    v_mfma_f32_16x16x32_bf16 v[88:91], v[132:135], v[152:155], v[88:91]
    ds_read_b128 v[188:191], v19 offset:55296
    v_mfma_f32_16x16x32_bf16 v[92:95], v[132:135], v[156:159], v[92:95]
    ds_read_b128 v[164:167], v17 offset:34816
    v_mfma_f32_16x16x32_bf16 v[96:99], v[136:139], v[144:147], v[96:99]
    v_mfma_f32_16x16x32_bf16 v[100:103], v[136:139], v[148:151], v[100:103]
    ds_read_b128 v[168:171], v17 offset:36864
    v_mfma_f32_16x16x32_bf16 v[104:107], v[136:139], v[152:155], v[104:107]
    ds_read_b128 v[172:175], v17 offset:38912
    v_mfma_f32_16x16x32_bf16 v[108:111], v[136:139], v[156:159], v[108:111]
    v_mfma_f32_16x16x32_bf16 v[112:115], v[140:143], v[144:147], v[112:115]
    v_mfma_f32_16x16x32_bf16 v[116:119], v[140:143], v[148:151], v[116:119]
    v_mfma_f32_16x16x32_bf16 v[120:123], v[140:143], v[152:155], v[120:123]
    v_mfma_f32_16x16x32_bf16 v[124:127], v[140:143], v[156:159], v[124:127]
    s_waitcnt lgkmcnt(0)
    s_barrier
    v_mfma_f32_16x16x32_bf16 v[64:67], v[160:163], v[176:179], v[64:67]
    ds_read_b128 v[128:131], v20 offset:0
    v_mfma_f32_16x16x32_bf16 v[68:71], v[160:163], v[180:183], v[68:71]
    ds_read_b128 v[144:147], v22 offset:16384
    v_mfma_f32_16x16x32_bf16 v[72:75], v[160:163], v[184:187], v[72:75]
    v_mfma_f32_16x16x32_bf16 v[76:79], v[160:163], v[188:191], v[76:79]
    ds_read_b128 v[148:151], v22 offset:18432
    v_mfma_f32_16x16x32_bf16 v[80:83], v[164:167], v[176:179], v[80:83]
    ds_read_b128 v[152:155], v22 offset:20480
    v_mfma_f32_16x16x32_bf16 v[84:87], v[164:167], v[180:183], v[84:87]
    v_mfma_f32_16x16x32_bf16 v[88:91], v[164:167], v[184:187], v[88:91]
    ds_read_b128 v[156:159], v22 offset:22528
    v_mfma_f32_16x16x32_bf16 v[92:95], v[164:167], v[188:191], v[92:95]
    ds_read_b128 v[132:135], v20 offset:2048
    v_mfma_f32_16x16x32_bf16 v[96:99], v[168:171], v[176:179], v[96:99]
    v_mfma_f32_16x16x32_bf16 v[100:103], v[168:171], v[180:183], v[100:103]
    ds_read_b128 v[136:139], v20 offset:4096
    v_mfma_f32_16x16x32_bf16 v[104:107], v[168:171], v[184:187], v[104:107]
    ds_read_b128 v[140:143], v20 offset:6144
    v_mfma_f32_16x16x32_bf16 v[108:111], v[168:171], v[188:191], v[108:111]
    v_mfma_f32_16x16x32_bf16 v[112:115], v[172:175], v[176:179], v[112:115]
    v_mfma_f32_16x16x32_bf16 v[116:119], v[172:175], v[180:183], v[116:119]
    v_mfma_f32_16x16x32_bf16 v[120:123], v[172:175], v[184:187], v[120:123]
    v_mfma_f32_16x16x32_bf16 v[124:127], v[172:175], v[188:191], v[124:127]
    s_waitcnt lgkmcnt(0)
    v_mfma_f32_16x16x32_bf16 v[64:67], v[128:131], v[144:147], v[64:67]
    ds_read_b128 v[160:163], v21 offset:0
    v_mfma_f32_16x16x32_bf16 v[68:71], v[128:131], v[148:151], v[68:71]
    ds_read_b128 v[176:179], v23 offset:16384
    v_mfma_f32_16x16x32_bf16 v[72:75], v[128:131], v[152:155], v[72:75]
    v_mfma_f32_16x16x32_bf16 v[76:79], v[128:131], v[156:159], v[76:79]
    ds_read_b128 v[180:183], v23 offset:18432
    v_mfma_f32_16x16x32_bf16 v[80:83], v[132:135], v[144:147], v[80:83]
    ds_read_b128 v[184:187], v23 offset:20480
    v_mfma_f32_16x16x32_bf16 v[84:87], v[132:135], v[148:151], v[84:87]
    v_mfma_f32_16x16x32_bf16 v[88:91], v[132:135], v[152:155], v[88:91]
    ds_read_b128 v[188:191], v23 offset:22528
    v_mfma_f32_16x16x32_bf16 v[92:95], v[132:135], v[156:159], v[92:95]
    ds_read_b128 v[164:167], v21 offset:2048
    v_mfma_f32_16x16x32_bf16 v[96:99], v[136:139], v[144:147], v[96:99]
    v_mfma_f32_16x16x32_bf16 v[100:103], v[136:139], v[148:151], v[100:103]
    ds_read_b128 v[168:171], v21 offset:4096
    v_mfma_f32_16x16x32_bf16 v[104:107], v[136:139], v[152:155], v[104:107]
    ds_read_b128 v[172:175], v21 offset:6144
    v_mfma_f32_16x16x32_bf16 v[108:111], v[136:139], v[156:159], v[108:111]
    v_mfma_f32_16x16x32_bf16 v[112:115], v[140:143], v[144:147], v[112:115]
    v_mfma_f32_16x16x32_bf16 v[116:119], v[140:143], v[148:151], v[116:119]
    v_mfma_f32_16x16x32_bf16 v[120:123], v[140:143], v[152:155], v[120:123]
    v_mfma_f32_16x16x32_bf16 v[124:127], v[140:143], v[156:159], v[124:127]
    s_waitcnt lgkmcnt(0)
    s_barrier
    v_mfma_f32_16x16x32_bf16 v[64:67], v[160:163], v[176:179], v[64:67]
    ds_read_b128 v[128:131], v16 offset:0
    v_mfma_f32_16x16x32_bf16 v[68:71], v[160:163], v[180:183], v[68:71]
    ds_read_b128 v[144:147], v18 offset:16384
    v_mfma_f32_16x16x32_bf16 v[72:75], v[160:163], v[184:187], v[72:75]
    v_mfma_f32_16x16x32_bf16 v[76:79], v[160:163], v[188:191], v[76:79]
    ds_read_b128 v[148:151], v18 offset:18432
    v_mfma_f32_16x16x32_bf16 v[80:83], v[164:167], v[176:179], v[80:83]
    ds_read_b128 v[152:155], v18 offset:20480
    v_mfma_f32_16x16x32_bf16 v[84:87], v[164:167], v[180:183], v[84:87]
    v_mfma_f32_16x16x32_bf16 v[88:91], v[164:167], v[184:187], v[88:91]
    ds_read_b128 v[156:159], v18 offset:22528
    v_mfma_f32_16x16x32_bf16 v[92:95], v[164:167], v[188:191], v[92:95]
    ds_read_b128 v[132:135], v16 offset:2048
    v_mfma_f32_16x16x32_bf16 v[96:99], v[168:171], v[176:179], v[96:99]
    v_mfma_f32_16x16x32_bf16 v[100:103], v[168:171], v[180:183], v[100:103]
    ds_read_b128 v[136:139], v16 offset:4096
    v_mfma_f32_16x16x32_bf16 v[104:107], v[168:171], v[184:187], v[104:107]
    ds_read_b128 v[140:143], v16 offset:6144
    v_mfma_f32_16x16x32_bf16 v[108:111], v[168:171], v[188:191], v[108:111]
    v_mfma_f32_16x16x32_bf16 v[112:115], v[172:175], v[176:179], v[112:115]
    v_mfma_f32_16x16x32_bf16 v[116:119], v[172:175], v[180:183], v[116:119]
    v_mfma_f32_16x16x32_bf16 v[120:123], v[172:175], v[184:187], v[120:123]
    v_mfma_f32_16x16x32_bf16 v[124:127], v[172:175], v[188:191], v[124:127]
    s_waitcnt lgkmcnt(0)
    v_mfma_f32_16x16x32_bf16 v[64:67], v[128:131], v[144:147], v[64:67]
    ds_read_b128 v[160:163], v17 offset:0
    v_mfma_f32_16x16x32_bf16 v[68:71], v[128:131], v[148:151], v[68:71]
    ds_read_b128 v[176:179], v19 offset:16384
    v_mfma_f32_16x16x32_bf16 v[72:75], v[128:131], v[152:155], v[72:75]
    v_mfma_f32_16x16x32_bf16 v[76:79], v[128:131], v[156:159], v[76:79]
    ds_read_b128 v[180:183], v19 offset:18432
    v_mfma_f32_16x16x32_bf16 v[80:83], v[132:135], v[144:147], v[80:83]
    ds_read_b128 v[184:187], v19 offset:20480
    v_mfma_f32_16x16x32_bf16 v[84:87], v[132:135], v[148:151], v[84:87]
    v_mfma_f32_16x16x32_bf16 v[88:91], v[132:135], v[152:155], v[88:91]
    ds_read_b128 v[188:191], v19 offset:22528
    v_mfma_f32_16x16x32_bf16 v[92:95], v[132:135], v[156:159], v[92:95]
    ds_read_b128 v[164:167], v17 offset:2048
    v_mfma_f32_16x16x32_bf16 v[96:99], v[136:139], v[144:147], v[96:99]
    v_mfma_f32_16x16x32_bf16 v[100:103], v[136:139], v[148:151], v[100:103]
    ds_read_b128 v[168:171], v17 offset:4096
    v_mfma_f32_16x16x32_bf16 v[104:107], v[136:139], v[152:155], v[104:107]
    ds_read_b128 v[172:175], v17 offset:6144
    v_mfma_f32_16x16x32_bf16 v[108:111], v[136:139], v[156:159], v[108:111]
    v_mfma_f32_16x16x32_bf16 v[112:115], v[140:143], v[144:147], v[112:115]
    v_mfma_f32_16x16x32_bf16 v[116:119], v[140:143], v[148:151], v[116:119]
    v_mfma_f32_16x16x32_bf16 v[120:123], v[140:143], v[152:155], v[120:123]
    v_mfma_f32_16x16x32_bf16 v[124:127], v[140:143], v[156:159], v[124:127]
    s_waitcnt lgkmcnt(0)
    s_barrier
    v_mfma_f32_16x16x32_bf16 v[64:67], v[160:163], v[176:179], v[64:67]
    ds_read_b128 v[128:131], v16 offset:32768
    v_mfma_f32_16x16x32_bf16 v[68:71], v[160:163], v[180:183], v[68:71]
    ds_read_b128 v[144:147], v18 offset:49152
    v_mfma_f32_16x16x32_bf16 v[72:75], v[160:163], v[184:187], v[72:75]
    v_mfma_f32_16x16x32_bf16 v[76:79], v[160:163], v[188:191], v[76:79]
    ds_read_b128 v[148:151], v18 offset:51200
    v_mfma_f32_16x16x32_bf16 v[80:83], v[164:167], v[176:179], v[80:83]
    ds_read_b128 v[152:155], v18 offset:53248
    v_mfma_f32_16x16x32_bf16 v[84:87], v[164:167], v[180:183], v[84:87]
    v_mfma_f32_16x16x32_bf16 v[88:91], v[164:167], v[184:187], v[88:91]
    ds_read_b128 v[156:159], v18 offset:55296
    v_mfma_f32_16x16x32_bf16 v[92:95], v[164:167], v[188:191], v[92:95]
    ds_read_b128 v[132:135], v16 offset:34816
    v_mfma_f32_16x16x32_bf16 v[96:99], v[168:171], v[176:179], v[96:99]
    v_mfma_f32_16x16x32_bf16 v[100:103], v[168:171], v[180:183], v[100:103]
    ds_read_b128 v[136:139], v16 offset:36864
    v_mfma_f32_16x16x32_bf16 v[104:107], v[168:171], v[184:187], v[104:107]
    ds_read_b128 v[140:143], v16 offset:38912
    v_mfma_f32_16x16x32_bf16 v[108:111], v[168:171], v[188:191], v[108:111]
    v_mfma_f32_16x16x32_bf16 v[112:115], v[172:175], v[176:179], v[112:115]
    v_mfma_f32_16x16x32_bf16 v[116:119], v[172:175], v[180:183], v[116:119]
    v_mfma_f32_16x16x32_bf16 v[120:123], v[172:175], v[184:187], v[120:123]
    v_mfma_f32_16x16x32_bf16 v[124:127], v[172:175], v[188:191], v[124:127]
    s_waitcnt lgkmcnt(0)
    v_mfma_f32_16x16x32_bf16 v[64:67], v[128:131], v[144:147], v[64:67]
    ds_read_b128 v[160:163], v17 offset:32768
    v_mfma_f32_16x16x32_bf16 v[68:71], v[128:131], v[148:151], v[68:71]
    ds_read_b128 v[176:179], v19 offset:49152
    v_mfma_f32_16x16x32_bf16 v[72:75], v[128:131], v[152:155], v[72:75]
    v_mfma_f32_16x16x32_bf16 v[76:79], v[128:131], v[156:159], v[76:79]
    ds_read_b128 v[180:183], v19 offset:51200
    v_mfma_f32_16x16x32_bf16 v[80:83], v[132:135], v[144:147], v[80:83]
    ds_read_b128 v[184:187], v19 offset:53248
    v_mfma_f32_16x16x32_bf16 v[84:87], v[132:135], v[148:151], v[84:87]
    v_mfma_f32_16x16x32_bf16 v[88:91], v[132:135], v[152:155], v[88:91]
    ds_read_b128 v[188:191], v19 offset:55296
    v_mfma_f32_16x16x32_bf16 v[92:95], v[132:135], v[156:159], v[92:95]
    ds_read_b128 v[164:167], v17 offset:34816
    v_mfma_f32_16x16x32_bf16 v[96:99], v[136:139], v[144:147], v[96:99]
    v_mfma_f32_16x16x32_bf16 v[100:103], v[136:139], v[148:151], v[100:103]
    ds_read_b128 v[168:171], v17 offset:36864
    v_mfma_f32_16x16x32_bf16 v[104:107], v[136:139], v[152:155], v[104:107]
    ds_read_b128 v[172:175], v17 offset:38912
    v_mfma_f32_16x16x32_bf16 v[108:111], v[136:139], v[156:159], v[108:111]
    v_mfma_f32_16x16x32_bf16 v[112:115], v[140:143], v[144:147], v[112:115]
    v_mfma_f32_16x16x32_bf16 v[116:119], v[140:143], v[148:151], v[116:119]
    v_mfma_f32_16x16x32_bf16 v[120:123], v[140:143], v[152:155], v[120:123]
    v_mfma_f32_16x16x32_bf16 v[124:127], v[140:143], v[156:159], v[124:127]
    s_waitcnt lgkmcnt(0)
    s_barrier
    v_mfma_f32_16x16x32_bf16 v[64:67], v[160:163], v[176:179], v[64:67]
    ds_read_b128 v[128:131], v20 offset:0
    v_mfma_f32_16x16x32_bf16 v[68:71], v[160:163], v[180:183], v[68:71]
    ds_read_b128 v[144:147], v22 offset:16384
    v_mfma_f32_16x16x32_bf16 v[72:75], v[160:163], v[184:187], v[72:75]
    v_mfma_f32_16x16x32_bf16 v[76:79], v[160:163], v[188:191], v[76:79]
    ds_read_b128 v[148:151], v22 offset:18432
    v_mfma_f32_16x16x32_bf16 v[80:83], v[164:167], v[176:179], v[80:83]
    ds_read_b128 v[152:155], v22 offset:20480
    v_mfma_f32_16x16x32_bf16 v[84:87], v[164:167], v[180:183], v[84:87]
    v_mfma_f32_16x16x32_bf16 v[88:91], v[164:167], v[184:187], v[88:91]
    ds_read_b128 v[156:159], v22 offset:22528
    v_mfma_f32_16x16x32_bf16 v[92:95], v[164:167], v[188:191], v[92:95]
    ds_read_b128 v[132:135], v20 offset:2048
    v_mfma_f32_16x16x32_bf16 v[96:99], v[168:171], v[176:179], v[96:99]
    v_mfma_f32_16x16x32_bf16 v[100:103], v[168:171], v[180:183], v[100:103]
    ds_read_b128 v[136:139], v20 offset:4096
    v_mfma_f32_16x16x32_bf16 v[104:107], v[168:171], v[184:187], v[104:107]
    ds_read_b128 v[140:143], v20 offset:6144
    v_mfma_f32_16x16x32_bf16 v[108:111], v[168:171], v[188:191], v[108:111]
    v_mfma_f32_16x16x32_bf16 v[112:115], v[172:175], v[176:179], v[112:115]
    v_mfma_f32_16x16x32_bf16 v[116:119], v[172:175], v[180:183], v[116:119]
    v_mfma_f32_16x16x32_bf16 v[120:123], v[172:175], v[184:187], v[120:123]
    v_mfma_f32_16x16x32_bf16 v[124:127], v[172:175], v[188:191], v[124:127]
    s_waitcnt lgkmcnt(0)
    v_mfma_f32_16x16x32_bf16 v[64:67], v[128:131], v[144:147], v[64:67]
    ds_read_b128 v[160:163], v21 offset:0
    v_mfma_f32_16x16x32_bf16 v[68:71], v[128:131], v[148:151], v[68:71]
    ds_read_b128 v[176:179], v23 offset:16384
    v_mfma_f32_16x16x32_bf16 v[72:75], v[128:131], v[152:155], v[72:75]
    v_mfma_f32_16x16x32_bf16 v[76:79], v[128:131], v[156:159], v[76:79]
    ds_read_b128 v[180:183], v23 offset:18432
    v_mfma_f32_16x16x32_bf16 v[80:83], v[132:135], v[144:147], v[80:83]
    ds_read_b128 v[184:187], v23 offset:20480
    v_mfma_f32_16x16x32_bf16 v[84:87], v[132:135], v[148:151], v[84:87]
    v_mfma_f32_16x16x32_bf16 v[88:91], v[132:135], v[152:155], v[88:91]
    ds_read_b128 v[188:191], v23 offset:22528
    v_mfma_f32_16x16x32_bf16 v[92:95], v[132:135], v[156:159], v[92:95]
    ds_read_b128 v[164:167], v21 offset:2048
    v_mfma_f32_16x16x32_bf16 v[96:99], v[136:139], v[144:147], v[96:99]
    v_mfma_f32_16x16x32_bf16 v[100:103], v[136:139], v[148:151], v[100:103]
    ds_read_b128 v[168:171], v21 offset:4096
    v_mfma_f32_16x16x32_bf16 v[104:107], v[136:139], v[152:155], v[104:107]
    ds_read_b128 v[172:175], v21 offset:6144
    v_mfma_f32_16x16x32_bf16 v[108:111], v[136:139], v[156:159], v[108:111]
    v_mfma_f32_16x16x32_bf16 v[112:115], v[140:143], v[144:147], v[112:115]
    v_mfma_f32_16x16x32_bf16 v[116:119], v[140:143], v[148:151], v[116:119]
    v_mfma_f32_16x16x32_bf16 v[120:123], v[140:143], v[152:155], v[120:123]
    v_mfma_f32_16x16x32_bf16 v[124:127], v[140:143], v[156:159], v[124:127]
    s_waitcnt lgkmcnt(0)
    s_barrier
    v_mfma_f32_16x16x32_bf16 v[64:67], v[160:163], v[176:179], v[64:67]
    ds_read_b128 v[128:131], v16 offset:0
    v_mfma_f32_16x16x32_bf16 v[68:71], v[160:163], v[180:183], v[68:71]
    ds_read_b128 v[144:147], v18 offset:16384
    v_mfma_f32_16x16x32_bf16 v[72:75], v[160:163], v[184:187], v[72:75]
    v_mfma_f32_16x16x32_bf16 v[76:79], v[160:163], v[188:191], v[76:79]
    ds_read_b128 v[148:151], v18 offset:18432
    v_mfma_f32_16x16x32_bf16 v[80:83], v[164:167], v[176:179], v[80:83]
    ds_read_b128 v[152:155], v18 offset:20480
    v_mfma_f32_16x16x32_bf16 v[84:87], v[164:167], v[180:183], v[84:87]
    v_mfma_f32_16x16x32_bf16 v[88:91], v[164:167], v[184:187], v[88:91]
    ds_read_b128 v[156:159], v18 offset:22528
    v_mfma_f32_16x16x32_bf16 v[92:95], v[164:167], v[188:191], v[92:95]
    ds_read_b128 v[132:135], v16 offset:2048
    v_mfma_f32_16x16x32_bf16 v[96:99], v[168:171], v[176:179], v[96:99]
    v_mfma_f32_16x16x32_bf16 v[100:103], v[168:171], v[180:183], v[100:103]
    ds_read_b128 v[136:139], v16 offset:4096
    v_mfma_f32_16x16x32_bf16 v[104:107], v[168:171], v[184:187], v[104:107]
    ds_read_b128 v[140:143], v16 offset:6144
    v_mfma_f32_16x16x32_bf16 v[108:111], v[168:171], v[188:191], v[108:111]
    v_mfma_f32_16x16x32_bf16 v[112:115], v[172:175], v[176:179], v[112:115]
    v_mfma_f32_16x16x32_bf16 v[116:119], v[172:175], v[180:183], v[116:119]
    v_mfma_f32_16x16x32_bf16 v[120:123], v[172:175], v[184:187], v[120:123]
    v_mfma_f32_16x16x32_bf16 v[124:127], v[172:175], v[188:191], v[124:127]
    s_waitcnt lgkmcnt(0)
    v_mfma_f32_16x16x32_bf16 v[64:67], v[128:131], v[144:147], v[64:67]
    ds_read_b128 v[160:163], v17 offset:0
    v_mfma_f32_16x16x32_bf16 v[68:71], v[128:131], v[148:151], v[68:71]
    ds_read_b128 v[176:179], v19 offset:16384
    v_mfma_f32_16x16x32_bf16 v[72:75], v[128:131], v[152:155], v[72:75]
    v_mfma_f32_16x16x32_bf16 v[76:79], v[128:131], v[156:159], v[76:79]
    ds_read_b128 v[180:183], v19 offset:18432
    v_mfma_f32_16x16x32_bf16 v[80:83], v[132:135], v[144:147], v[80:83]
    ds_read_b128 v[184:187], v19 offset:20480
    v_mfma_f32_16x16x32_bf16 v[84:87], v[132:135], v[148:151], v[84:87]
    v_mfma_f32_16x16x32_bf16 v[88:91], v[132:135], v[152:155], v[88:91]
    ds_read_b128 v[188:191], v19 offset:22528
    v_mfma_f32_16x16x32_bf16 v[92:95], v[132:135], v[156:159], v[92:95]
    ds_read_b128 v[164:167], v17 offset:2048
    v_mfma_f32_16x16x32_bf16 v[96:99], v[136:139], v[144:147], v[96:99]
    v_mfma_f32_16x16x32_bf16 v[100:103], v[136:139], v[148:151], v[100:103]
    ds_read_b128 v[168:171], v17 offset:4096
    v_mfma_f32_16x16x32_bf16 v[104:107], v[136:139], v[152:155], v[104:107]
    ds_read_b128 v[172:175], v17 offset:6144
    v_mfma_f32_16x16x32_bf16 v[108:111], v[136:139], v[156:159], v[108:111]
    v_mfma_f32_16x16x32_bf16 v[112:115], v[140:143], v[144:147], v[112:115]
    v_mfma_f32_16x16x32_bf16 v[116:119], v[140:143], v[148:151], v[116:119]
    v_mfma_f32_16x16x32_bf16 v[120:123], v[140:143], v[152:155], v[120:123]
    v_mfma_f32_16x16x32_bf16 v[124:127], v[140:143], v[156:159], v[124:127]
    s_waitcnt lgkmcnt(0)
    s_barrier
    v_mfma_f32_16x16x32_bf16 v[64:67], v[160:163], v[176:179], v[64:67]
    ds_read_b128 v[128:131], v16 offset:32768
    v_mfma_f32_16x16x32_bf16 v[68:71], v[160:163], v[180:183], v[68:71]
    ds_read_b128 v[144:147], v18 offset:49152
    v_mfma_f32_16x16x32_bf16 v[72:75], v[160:163], v[184:187], v[72:75]
    v_mfma_f32_16x16x32_bf16 v[76:79], v[160:163], v[188:191], v[76:79]
    ds_read_b128 v[148:151], v18 offset:51200
    v_mfma_f32_16x16x32_bf16 v[80:83], v[164:167], v[176:179], v[80:83]
    ds_read_b128 v[152:155], v18 offset:53248
    v_mfma_f32_16x16x32_bf16 v[84:87], v[164:167], v[180:183], v[84:87]
    v_mfma_f32_16x16x32_bf16 v[88:91], v[164:167], v[184:187], v[88:91]
    ds_read_b128 v[156:159], v18 offset:55296
    v_mfma_f32_16x16x32_bf16 v[92:95], v[164:167], v[188:191], v[92:95]
    ds_read_b128 v[132:135], v16 offset:34816
    v_mfma_f32_16x16x32_bf16 v[96:99], v[168:171], v[176:179], v[96:99]
    v_mfma_f32_16x16x32_bf16 v[100:103], v[168:171], v[180:183], v[100:103]
    ds_read_b128 v[136:139], v16 offset:36864
    v_mfma_f32_16x16x32_bf16 v[104:107], v[168:171], v[184:187], v[104:107]
    ds_read_b128 v[140:143], v16 offset:38912
    v_mfma_f32_16x16x32_bf16 v[108:111], v[168:171], v[188:191], v[108:111]
    v_mfma_f32_16x16x32_bf16 v[112:115], v[172:175], v[176:179], v[112:115]
    v_mfma_f32_16x16x32_bf16 v[116:119], v[172:175], v[180:183], v[116:119]
    v_mfma_f32_16x16x32_bf16 v[120:123], v[172:175], v[184:187], v[120:123]
    v_mfma_f32_16x16x32_bf16 v[124:127], v[172:175], v[188:191], v[124:127]
    s_waitcnt lgkmcnt(0)
    v_mfma_f32_16x16x32_bf16 v[64:67], v[128:131], v[144:147], v[64:67]
    ds_read_b128 v[160:163], v17 offset:32768
    v_mfma_f32_16x16x32_bf16 v[68:71], v[128:131], v[148:151], v[68:71]
    ds_read_b128 v[176:179], v19 offset:49152
    v_mfma_f32_16x16x32_bf16 v[72:75], v[128:131], v[152:155], v[72:75]
    v_mfma_f32_16x16x32_bf16 v[76:79], v[128:131], v[156:159], v[76:79]
    ds_read_b128 v[180:183], v19 offset:51200
    v_mfma_f32_16x16x32_bf16 v[80:83], v[132:135], v[144:147], v[80:83]
    ds_read_b128 v[184:187], v19 offset:53248
    v_mfma_f32_16x16x32_bf16 v[84:87], v[132:135], v[148:151], v[84:87]
    v_mfma_f32_16x16x32_bf16 v[88:91], v[132:135], v[152:155], v[88:91]
    ds_read_b128 v[188:191], v19 offset:55296
    v_mfma_f32_16x16x32_bf16 v[92:95], v[132:135], v[156:159], v[92:95]
    ds_read_b128 v[164:167], v17 offset:34816
    v_mfma_f32_16x16x32_bf16 v[96:99], v[136:139], v[144:147], v[96:99]
    v_mfma_f32_16x16x32_bf16 v[100:103], v[136:139], v[148:151], v[100:103]
    ds_read_b128 v[168:171], v17 offset:36864
    v_mfma_f32_16x16x32_bf16 v[104:107], v[136:139], v[152:155], v[104:107]
    ds_read_b128 v[172:175], v17 offset:38912
    v_mfma_f32_16x16x32_bf16 v[108:111], v[136:139], v[156:159], v[108:111]
    v_mfma_f32_16x16x32_bf16 v[112:115], v[140:143], v[144:147], v[112:115]
    v_mfma_f32_16x16x32_bf16 v[116:119], v[140:143], v[148:151], v[116:119]
    v_mfma_f32_16x16x32_bf16 v[120:123], v[140:143], v[152:155], v[120:123]
    v_mfma_f32_16x16x32_bf16 v[124:127], v[140:143], v[156:159], v[124:127]
    s_waitcnt lgkmcnt(0)
    s_barrier
    v_mfma_f32_16x16x32_bf16 v[64:67], v[160:163], v[176:179], v[64:67]
    ds_read_b128 v[128:131], v20 offset:0
    v_mfma_f32_16x16x32_bf16 v[68:71], v[160:163], v[180:183], v[68:71]
    ds_read_b128 v[144:147], v22 offset:16384
    v_mfma_f32_16x16x32_bf16 v[72:75], v[160:163], v[184:187], v[72:75]
    v_mfma_f32_16x16x32_bf16 v[76:79], v[160:163], v[188:191], v[76:79]
    ds_read_b128 v[148:151], v22 offset:18432
    v_mfma_f32_16x16x32_bf16 v[80:83], v[164:167], v[176:179], v[80:83]
    ds_read_b128 v[152:155], v22 offset:20480
    v_mfma_f32_16x16x32_bf16 v[84:87], v[164:167], v[180:183], v[84:87]
    v_mfma_f32_16x16x32_bf16 v[88:91], v[164:167], v[184:187], v[88:91]
    ds_read_b128 v[156:159], v22 offset:22528
    v_mfma_f32_16x16x32_bf16 v[92:95], v[164:167], v[188:191], v[92:95]
    ds_read_b128 v[132:135], v20 offset:2048
    v_mfma_f32_16x16x32_bf16 v[96:99], v[168:171], v[176:179], v[96:99]
    v_mfma_f32_16x16x32_bf16 v[100:103], v[168:171], v[180:183], v[100:103]
    ds_read_b128 v[136:139], v20 offset:4096
    v_mfma_f32_16x16x32_bf16 v[104:107], v[168:171], v[184:187], v[104:107]
    ds_read_b128 v[140:143], v20 offset:6144
    v_mfma_f32_16x16x32_bf16 v[108:111], v[168:171], v[188:191], v[108:111]
    v_mfma_f32_16x16x32_bf16 v[112:115], v[172:175], v[176:179], v[112:115]
    v_mfma_f32_16x16x32_bf16 v[116:119], v[172:175], v[180:183], v[116:119]
    v_mfma_f32_16x16x32_bf16 v[120:123], v[172:175], v[184:187], v[120:123]
    v_mfma_f32_16x16x32_bf16 v[124:127], v[172:175], v[188:191], v[124:127]
    s_waitcnt lgkmcnt(0)
    v_mfma_f32_16x16x32_bf16 v[64:67], v[128:131], v[144:147], v[64:67]
    ds_read_b128 v[160:163], v21 offset:0
    v_mfma_f32_16x16x32_bf16 v[68:71], v[128:131], v[148:151], v[68:71]
    ds_read_b128 v[176:179], v23 offset:16384
    v_mfma_f32_16x16x32_bf16 v[72:75], v[128:131], v[152:155], v[72:75]
    v_mfma_f32_16x16x32_bf16 v[76:79], v[128:131], v[156:159], v[76:79]
    ds_read_b128 v[180:183], v23 offset:18432
    v_mfma_f32_16x16x32_bf16 v[80:83], v[132:135], v[144:147], v[80:83]
    ds_read_b128 v[184:187], v23 offset:20480
    v_mfma_f32_16x16x32_bf16 v[84:87], v[132:135], v[148:151], v[84:87]
    v_mfma_f32_16x16x32_bf16 v[88:91], v[132:135], v[152:155], v[88:91]
    ds_read_b128 v[188:191], v23 offset:22528
    v_mfma_f32_16x16x32_bf16 v[92:95], v[132:135], v[156:159], v[92:95]
    ds_read_b128 v[164:167], v21 offset:2048
    v_mfma_f32_16x16x32_bf16 v[96:99], v[136:139], v[144:147], v[96:99]
    v_mfma_f32_16x16x32_bf16 v[100:103], v[136:139], v[148:151], v[100:103]
    ds_read_b128 v[168:171], v21 offset:4096
    v_mfma_f32_16x16x32_bf16 v[104:107], v[136:139], v[152:155], v[104:107]
    ds_read_b128 v[172:175], v21 offset:6144
    v_mfma_f32_16x16x32_bf16 v[108:111], v[136:139], v[156:159], v[108:111]
    v_mfma_f32_16x16x32_bf16 v[112:115], v[140:143], v[144:147], v[112:115]
    v_mfma_f32_16x16x32_bf16 v[116:119], v[140:143], v[148:151], v[116:119]
    v_mfma_f32_16x16x32_bf16 v[120:123], v[140:143], v[152:155], v[120:123]
    v_mfma_f32_16x16x32_bf16 v[124:127], v[140:143], v[156:159], v[124:127]
    s_waitcnt lgkmcnt(0)
    s_barrier
    v_mfma_f32_16x16x32_bf16 v[64:67], v[160:163], v[176:179], v[64:67]
    ds_read_b128 v[128:131], v16 offset:0
    v_mfma_f32_16x16x32_bf16 v[68:71], v[160:163], v[180:183], v[68:71]
    ds_read_b128 v[144:147], v18 offset:16384
    v_mfma_f32_16x16x32_bf16 v[72:75], v[160:163], v[184:187], v[72:75]
    v_mfma_f32_16x16x32_bf16 v[76:79], v[160:163], v[188:191], v[76:79]
    ds_read_b128 v[148:151], v18 offset:18432
    v_mfma_f32_16x16x32_bf16 v[80:83], v[164:167], v[176:179], v[80:83]
    ds_read_b128 v[152:155], v18 offset:20480
    v_mfma_f32_16x16x32_bf16 v[84:87], v[164:167], v[180:183], v[84:87]
    v_mfma_f32_16x16x32_bf16 v[88:91], v[164:167], v[184:187], v[88:91]
    ds_read_b128 v[156:159], v18 offset:22528
    v_mfma_f32_16x16x32_bf16 v[92:95], v[164:167], v[188:191], v[92:95]
    ds_read_b128 v[132:135], v16 offset:2048
    v_mfma_f32_16x16x32_bf16 v[96:99], v[168:171], v[176:179], v[96:99]
    v_mfma_f32_16x16x32_bf16 v[100:103], v[168:171], v[180:183], v[100:103]
    ds_read_b128 v[136:139], v16 offset:4096
    v_mfma_f32_16x16x32_bf16 v[104:107], v[168:171], v[184:187], v[104:107]
    ds_read_b128 v[140:143], v16 offset:6144
    v_mfma_f32_16x16x32_bf16 v[108:111], v[168:171], v[188:191], v[108:111]
    v_mfma_f32_16x16x32_bf16 v[112:115], v[172:175], v[176:179], v[112:115]
    v_mfma_f32_16x16x32_bf16 v[116:119], v[172:175], v[180:183], v[116:119]
    v_mfma_f32_16x16x32_bf16 v[120:123], v[172:175], v[184:187], v[120:123]
    v_mfma_f32_16x16x32_bf16 v[124:127], v[172:175], v[188:191], v[124:127]
    s_waitcnt lgkmcnt(0)
    v_mfma_f32_16x16x32_bf16 v[64:67], v[128:131], v[144:147], v[64:67]
    ds_read_b128 v[160:163], v17 offset:0
    v_mfma_f32_16x16x32_bf16 v[68:71], v[128:131], v[148:151], v[68:71]
    ds_read_b128 v[176:179], v19 offset:16384
    v_mfma_f32_16x16x32_bf16 v[72:75], v[128:131], v[152:155], v[72:75]
    v_mfma_f32_16x16x32_bf16 v[76:79], v[128:131], v[156:159], v[76:79]
    ds_read_b128 v[180:183], v19 offset:18432
    v_mfma_f32_16x16x32_bf16 v[80:83], v[132:135], v[144:147], v[80:83]
    ds_read_b128 v[184:187], v19 offset:20480
    v_mfma_f32_16x16x32_bf16 v[84:87], v[132:135], v[148:151], v[84:87]
    v_mfma_f32_16x16x32_bf16 v[88:91], v[132:135], v[152:155], v[88:91]
    ds_read_b128 v[188:191], v19 offset:22528
    v_mfma_f32_16x16x32_bf16 v[92:95], v[132:135], v[156:159], v[92:95]
    ds_read_b128 v[164:167], v17 offset:2048
    v_mfma_f32_16x16x32_bf16 v[96:99], v[136:139], v[144:147], v[96:99]
    v_mfma_f32_16x16x32_bf16 v[100:103], v[136:139], v[148:151], v[100:103]
    ds_read_b128 v[168:171], v17 offset:4096
    v_mfma_f32_16x16x32_bf16 v[104:107], v[136:139], v[152:155], v[104:107]
    ds_read_b128 v[172:175], v17 offset:6144
    v_mfma_f32_16x16x32_bf16 v[108:111], v[136:139], v[156:159], v[108:111]
    v_mfma_f32_16x16x32_bf16 v[112:115], v[140:143], v[144:147], v[112:115]
    v_mfma_f32_16x16x32_bf16 v[116:119], v[140:143], v[148:151], v[116:119]
    v_mfma_f32_16x16x32_bf16 v[120:123], v[140:143], v[152:155], v[120:123]
    v_mfma_f32_16x16x32_bf16 v[124:127], v[140:143], v[156:159], v[124:127]
    s_waitcnt lgkmcnt(0) vmcnt(0)
    v_mfma_f32_16x16x32_bf16 v[64:67], v[160:163], v[176:179], v[64:67]
    v_mfma_f32_16x16x32_bf16 v[68:71], v[160:163], v[180:183], v[68:71]
    v_mfma_f32_16x16x32_bf16 v[72:75], v[160:163], v[184:187], v[72:75]
    v_mfma_f32_16x16x32_bf16 v[76:79], v[160:163], v[188:191], v[76:79]
    v_mfma_f32_16x16x32_bf16 v[80:83], v[164:167], v[176:179], v[80:83]
    v_mfma_f32_16x16x32_bf16 v[84:87], v[164:167], v[180:183], v[84:87]
    v_mfma_f32_16x16x32_bf16 v[88:91], v[164:167], v[184:187], v[88:91]
    v_mfma_f32_16x16x32_bf16 v[92:95], v[164:167], v[188:191], v[92:95]
    v_mfma_f32_16x16x32_bf16 v[96:99], v[168:171], v[176:179], v[96:99]
    v_mfma_f32_16x16x32_bf16 v[100:103], v[168:171], v[180:183], v[100:103]
    v_mfma_f32_16x16x32_bf16 v[104:107], v[168:171], v[184:187], v[104:107]
    v_mfma_f32_16x16x32_bf16 v[108:111], v[168:171], v[188:191], v[108:111]
    v_mfma_f32_16x16x32_bf16 v[112:115], v[172:175], v[176:179], v[112:115]
    v_mfma_f32_16x16x32_bf16 v[116:119], v[172:175], v[180:183], v[116:119]
    v_mfma_f32_16x16x32_bf16 v[120:123], v[172:175], v[184:187], v[120:123]
    v_mfma_f32_16x16x32_bf16 v[124:127], v[172:175], v[188:191], v[124:127]
    s_mov_b32 s44, 0
    s_mov_b32 s45, 4096
    s_mov_b32 s46, 8192
    s_mov_b32 s47, 12288
    v_mov_b32 v61, s93
    v_mov_b32 v63, s93
    v_and_b32 v216, 31, v24
    v_lshlrev_b32 v216, 2, v216
    v_add_u32 v216, 73728, v216
    v_mov_b32 v218, 0
    ds_write_b32 v216, v218
    v_pk_fma_f32 v[16:17], v[30:31], v[72:73], v[66:67] op_sel:[0,0,0] op_sel_hi:[0,1,1] neg_lo:[1,0,0] neg_hi:[1,0,0]
    v_pk_fma_f32 v[18:19], v[30:31], v[64:65], v[74:75] op_sel:[0,0,0] op_sel_hi:[0,1,1]
    v_pk_fma_f32 v[8:9], v[28:29], v[64:65], v[16:17] op_sel:[0,0,0] op_sel_hi:[0,1,1]
    v_pk_fma_f32 v[10:11], v[28:29], v[72:73], v[18:19] op_sel:[0,0,0] op_sel_hi:[0,1,1]
    v_pk_fma_f32 v[20:21], v[30:31], v[76:77], v[70:71] op_sel:[1,0,0] op_sel_hi:[1,1,1] neg_lo:[1,0,0] neg_hi:[1,0,0]
    v_pk_fma_f32 v[22:23], v[30:31], v[68:69], v[78:79] op_sel:[1,0,0] op_sel_hi:[1,1,1]
    v_pk_fma_f32 v[12:13], v[28:29], v[68:69], v[20:21] op_sel:[1,0,0] op_sel_hi:[1,1,1]
    v_pk_fma_f32 v[14:15], v[28:29], v[76:77], v[22:23] op_sel:[1,0,0] op_sel_hi:[1,1,1]
    v_pk_fma_f32 v[16:17], v[30:31], v[10:11], v[80:81] op_sel:[0,0,0] op_sel_hi:[0,1,1] neg_lo:[1,0,0] neg_hi:[1,0,0]
    v_pk_fma_f32 v[18:19], v[30:31], v[8:9], v[88:89] op_sel:[0,0,0] op_sel_hi:[0,1,1]
    v_pk_fma_f32 v[8:9], v[28:29], v[8:9], v[16:17] op_sel:[0,0,0] op_sel_hi:[0,1,1]
    v_pk_fma_f32 v[10:11], v[28:29], v[10:11], v[18:19] op_sel:[0,0,0] op_sel_hi:[0,1,1]
    v_pk_fma_f32 v[20:21], v[30:31], v[14:15], v[84:85] op_sel:[1,0,0] op_sel_hi:[1,1,1] neg_lo:[1,0,0] neg_hi:[1,0,0]
    v_pk_fma_f32 v[22:23], v[30:31], v[12:13], v[92:93] op_sel:[1,0,0] op_sel_hi:[1,1,1]
    v_pk_fma_f32 v[12:13], v[28:29], v[12:13], v[20:21] op_sel:[1,0,0] op_sel_hi:[1,1,1]
    v_pk_fma_f32 v[14:15], v[28:29], v[14:15], v[22:23] op_sel:[1,0,0] op_sel_hi:[1,1,1]
    v_pk_fma_f32 v[16:17], v[30:31], v[10:11], v[82:83] op_sel:[0,0,0] op_sel_hi:[0,1,1] neg_lo:[1,0,0] neg_hi:[1,0,0]
    v_pk_fma_f32 v[18:19], v[30:31], v[8:9], v[90:91] op_sel:[0,0,0] op_sel_hi:[0,1,1]
    v_pk_fma_f32 v[8:9], v[28:29], v[8:9], v[16:17] op_sel:[0,0,0] op_sel_hi:[0,1,1]
    v_pk_fma_f32 v[10:11], v[28:29], v[10:11], v[18:19] op_sel:[0,0,0] op_sel_hi:[0,1,1]
    v_pk_fma_f32 v[20:21], v[30:31], v[14:15], v[86:87] op_sel:[1,0,0] op_sel_hi:[1,1,1] neg_lo:[1,0,0] neg_hi:[1,0,0]
    v_pk_fma_f32 v[22:23], v[30:31], v[12:13], v[94:95] op_sel:[1,0,0] op_sel_hi:[1,1,1]
    v_pk_fma_f32 v[12:13], v[28:29], v[12:13], v[20:21] op_sel:[1,0,0] op_sel_hi:[1,1,1]
    v_pk_fma_f32 v[14:15], v[28:29], v[14:15], v[22:23] op_sel:[1,0,0] op_sel_hi:[1,1,1]
    v_pk_fma_f32 v[16:17], v[30:31], v[10:11], v[96:97] op_sel:[0,0,0] op_sel_hi:[0,1,1] neg_lo:[1,0,0] neg_hi:[1,0,0]
    v_pk_fma_f32 v[18:19], v[30:31], v[8:9], v[104:105] op_sel:[0,0,0] op_sel_hi:[0,1,1]
    v_pk_fma_f32 v[8:9], v[28:29], v[8:9], v[16:17] op_sel:[0,0,0] op_sel_hi:[0,1,1]
    v_pk_fma_f32 v[10:11], v[28:29], v[10:11], v[18:19] op_sel:[0,0,0] op_sel_hi:[0,1,1]
    v_pk_fma_f32 v[20:21], v[30:31], v[14:15], v[100:101] op_sel:[1,0,0] op_sel_hi:[1,1,1] neg_lo:[1,0,0] neg_hi:[1,0,0]
    v_pk_fma_f32 v[22:23], v[30:31], v[12:13], v[108:109] op_sel:[1,0,0] op_sel_hi:[1,1,1]
    v_pk_fma_f32 v[12:13], v[28:29], v[12:13], v[20:21] op_sel:[1,0,0] op_sel_hi:[1,1,1]
    v_pk_fma_f32 v[14:15], v[28:29], v[14:15], v[22:23] op_sel:[1,0,0] op_sel_hi:[1,1,1]
    v_pk_fma_f32 v[16:17], v[30:31], v[10:11], v[98:99] op_sel:[0,0,0] op_sel_hi:[0,1,1] neg_lo:[1,0,0] neg_hi:[1,0,0]
    v_pk_fma_f32 v[18:19], v[30:31], v[8:9], v[106:107] op_sel:[0,0,0] op_sel_hi:[0,1,1]
    v_pk_fma_f32 v[8:9], v[28:29], v[8:9], v[16:17] op_sel:[0,0,0] op_sel_hi:[0,1,1]
    v_pk_fma_f32 v[10:11], v[28:29], v[10:11], v[18:19] op_sel:[0,0,0] op_sel_hi:[0,1,1]
    v_pk_fma_f32 v[20:21], v[30:31], v[14:15], v[102:103] op_sel:[1,0,0] op_sel_hi:[1,1,1] neg_lo:[1,0,0] neg_hi:[1,0,0]
    v_pk_fma_f32 v[22:23], v[30:31], v[12:13], v[110:111] op_sel:[1,0,0] op_sel_hi:[1,1,1]
    v_pk_fma_f32 v[12:13], v[28:29], v[12:13], v[20:21] op_sel:[1,0,0] op_sel_hi:[1,1,1]
    v_pk_fma_f32 v[14:15], v[28:29], v[14:15], v[22:23] op_sel:[1,0,0] op_sel_hi:[1,1,1]
    v_pk_fma_f32 v[16:17], v[30:31], v[10:11], v[112:113] op_sel:[0,0,0] op_sel_hi:[0,1,1] neg_lo:[1,0,0] neg_hi:[1,0,0]
    v_pk_fma_f32 v[18:19], v[30:31], v[8:9], v[120:121] op_sel:[0,0,0] op_sel_hi:[0,1,1]
    v_pk_fma_f32 v[8:9], v[28:29], v[8:9], v[16:17] op_sel:[0,0,0] op_sel_hi:[0,1,1]
    v_pk_fma_f32 v[10:11], v[28:29], v[10:11], v[18:19] op_sel:[0,0,0] op_sel_hi:[0,1,1]
    v_pk_fma_f32 v[20:21], v[30:31], v[14:15], v[116:117] op_sel:[1,0,0] op_sel_hi:[1,1,1] neg_lo:[1,0,0] neg_hi:[1,0,0]
    v_pk_fma_f32 v[22:23], v[30:31], v[12:13], v[124:125] op_sel:[1,0,0] op_sel_hi:[1,1,1]
    v_pk_fma_f32 v[12:13], v[28:29], v[12:13], v[20:21] op_sel:[1,0,0] op_sel_hi:[1,1,1]
    v_pk_fma_f32 v[14:15], v[28:29], v[14:15], v[22:23] op_sel:[1,0,0] op_sel_hi:[1,1,1]
    v_pk_fma_f32 v[16:17], v[30:31], v[10:11], v[114:115] op_sel:[0,0,0] op_sel_hi:[0,1,1] neg_lo:[1,0,0] neg_hi:[1,0,0]
    v_pk_fma_f32 v[18:19], v[30:31], v[8:9], v[122:123] op_sel:[0,0,0] op_sel_hi:[0,1,1]
    v_pk_fma_f32 v[8:9], v[28:29], v[8:9], v[16:17] op_sel:[0,0,0] op_sel_hi:[0,1,1]
    v_pk_fma_f32 v[10:11], v[28:29], v[10:11], v[18:19] op_sel:[0,0,0] op_sel_hi:[0,1,1]
    v_pk_fma_f32 v[20:21], v[30:31], v[14:15], v[118:119] op_sel:[1,0,0] op_sel_hi:[1,1,1] neg_lo:[1,0,0] neg_hi:[1,0,0]
    v_pk_fma_f32 v[22:23], v[30:31], v[12:13], v[126:127] op_sel:[1,0,0] op_sel_hi:[1,1,1]
    v_pk_fma_f32 v[12:13], v[28:29], v[12:13], v[20:21] op_sel:[1,0,0] op_sel_hi:[1,1,1]
    v_pk_fma_f32 v[14:15], v[28:29], v[14:15], v[22:23] op_sel:[1,0,0] op_sel_hi:[1,1,1]
    v_fma_f32 v56, -v38, v10, v9
    v_fma_f32 v58, v38, v8, v11
    v_fma_f32 v57, -v39, v14, v13
    v_fma_f32 v59, v39, v12, v15
    v_fma_f32 v56, v36, v8, v56
    v_fma_f32 v58, v36, v10, v58
    v_fma_f32 v57, v37, v12, v57
    v_fma_f32 v59, v37, v14, v59
    ds_write_b128 v192, v[56:59]
    s_waitcnt lgkmcnt(0)
    s_barrier
    ds_read_b128 v[160:163], v193 offset:0
    ds_read_b128 v[164:167], v193 offset:512
    ds_read_b128 v[168:171], v193 offset:1024
    ds_read_b128 v[172:175], v193 offset:1536
    ds_read_b128 v[176:179], v193 offset:2048
    ds_read_b128 v[180:183], v193 offset:2560
    ds_read_b128 v[184:187], v193 offset:3072
    ds_read_b128 v[188:191], v193 offset:3584
    s_waitcnt lgkmcnt(6)
    v_pk_fma_f32 v[164:165], v[42:43], v[162:163], v[164:165] op_sel:[0,0,0] op_sel_hi:[1,1,1] neg_lo:[1,0,0] neg_hi:[1,0,0]
    v_pk_fma_f32 v[166:167], v[42:43], v[160:161], v[166:167] op_sel:[0,0,0] op_sel_hi:[1,1,1]
    v_pk_fma_f32 v[164:165], v[40:41], v[160:161], v[164:165] op_sel:[0,0,0] op_sel_hi:[1,1,1]
    v_pk_fma_f32 v[166:167], v[40:41], v[162:163], v[166:167] op_sel:[0,0,0] op_sel_hi:[1,1,1]
    s_waitcnt lgkmcnt(5)
    v_pk_fma_f32 v[168:169], v[42:43], v[166:167], v[168:169] op_sel:[0,0,0] op_sel_hi:[1,1,1] neg_lo:[1,0,0] neg_hi:[1,0,0]
    v_pk_fma_f32 v[170:171], v[42:43], v[164:165], v[170:171] op_sel:[0,0,0] op_sel_hi:[1,1,1]
    v_pk_fma_f32 v[168:169], v[40:41], v[164:165], v[168:169] op_sel:[0,0,0] op_sel_hi:[1,1,1]
    v_pk_fma_f32 v[170:171], v[40:41], v[166:167], v[170:171] op_sel:[0,0,0] op_sel_hi:[1,1,1]
    s_waitcnt lgkmcnt(4)
    v_pk_fma_f32 v[172:173], v[42:43], v[170:171], v[172:173] op_sel:[0,0,0] op_sel_hi:[1,1,1] neg_lo:[1,0,0] neg_hi:[1,0,0]
    v_pk_fma_f32 v[174:175], v[42:43], v[168:169], v[174:175] op_sel:[0,0,0] op_sel_hi:[1,1,1]
    v_pk_fma_f32 v[172:173], v[40:41], v[168:169], v[172:173] op_sel:[0,0,0] op_sel_hi:[1,1,1]
    v_pk_fma_f32 v[174:175], v[40:41], v[170:171], v[174:175] op_sel:[0,0,0] op_sel_hi:[1,1,1]
    s_waitcnt lgkmcnt(3)
    v_pk_fma_f32 v[176:177], v[42:43], v[174:175], v[176:177] op_sel:[0,0,0] op_sel_hi:[1,1,1] neg_lo:[1,0,0] neg_hi:[1,0,0]
    v_pk_fma_f32 v[178:179], v[42:43], v[172:173], v[178:179] op_sel:[0,0,0] op_sel_hi:[1,1,1]
    v_pk_fma_f32 v[176:177], v[40:41], v[172:173], v[176:177] op_sel:[0,0,0] op_sel_hi:[1,1,1]
    v_pk_fma_f32 v[178:179], v[40:41], v[174:175], v[178:179] op_sel:[0,0,0] op_sel_hi:[1,1,1]
    s_waitcnt lgkmcnt(2)
    v_pk_fma_f32 v[180:181], v[42:43], v[178:179], v[180:181] op_sel:[0,0,0] op_sel_hi:[1,1,1] neg_lo:[1,0,0] neg_hi:[1,0,0]
    v_pk_fma_f32 v[182:183], v[42:43], v[176:177], v[182:183] op_sel:[0,0,0] op_sel_hi:[1,1,1]
    v_pk_fma_f32 v[180:181], v[40:41], v[176:177], v[180:181] op_sel:[0,0,0] op_sel_hi:[1,1,1]
    v_pk_fma_f32 v[182:183], v[40:41], v[178:179], v[182:183] op_sel:[0,0,0] op_sel_hi:[1,1,1]
    s_waitcnt lgkmcnt(1)
    v_pk_fma_f32 v[184:185], v[42:43], v[182:183], v[184:185] op_sel:[0,0,0] op_sel_hi:[1,1,1] neg_lo:[1,0,0] neg_hi:[1,0,0]
    v_pk_fma_f32 v[186:187], v[42:43], v[180:181], v[186:187] op_sel:[0,0,0] op_sel_hi:[1,1,1]
    v_pk_fma_f32 v[184:185], v[40:41], v[180:181], v[184:185] op_sel:[0,0,0] op_sel_hi:[1,1,1]
    v_pk_fma_f32 v[186:187], v[40:41], v[182:183], v[186:187] op_sel:[0,0,0] op_sel_hi:[1,1,1]
    s_waitcnt lgkmcnt(0)
    v_pk_fma_f32 v[188:189], v[42:43], v[186:187], v[188:189] op_sel:[0,0,0] op_sel_hi:[1,1,1] neg_lo:[1,0,0] neg_hi:[1,0,0]
    v_pk_fma_f32 v[190:191], v[42:43], v[184:185], v[190:191] op_sel:[0,0,0] op_sel_hi:[1,1,1]
    v_pk_fma_f32 v[188:189], v[40:41], v[184:185], v[188:189] op_sel:[0,0,0] op_sel_hi:[1,1,1]
    v_pk_fma_f32 v[190:191], v[40:41], v[186:187], v[190:191] op_sel:[0,0,0] op_sel_hi:[1,1,1]
    v_cndmask_b32 v60, v188, v189, s[84:85]
    v_cndmask_b32 v62, v190, v191, s[84:85]
    s_cmp_lg_u32 s19, 0
    s_cbranch_scc1 L_nopub
    s_mov_b32 exec_hi, 0
    buffer_store_dwordx4 v[60:63], v27, s[24:27], 0 offen sc1
    s_mov_b32 exec_hi, -1
L_nopub:
    v_cndmask_b32 v16, 0, v172, s[98:99]
    v_cndmask_b32 v17, v160, v176, s[98:99]
    v_cndmask_b32 v18, v164, v180, s[98:99]
    v_cndmask_b32 v19, v168, v184, s[98:99]
    v_cndmask_b32 v16, v16, v17, s[84:85]
    v_cndmask_b32 v18, v18, v19, s[84:85]
    v_cndmask_b32 v216, v16, v18, s[86:87]
    v_cndmask_b32 v16, 0, v173, s[98:99]
    v_cndmask_b32 v17, v161, v177, s[98:99]
    v_cndmask_b32 v18, v165, v181, s[98:99]
    v_cndmask_b32 v19, v169, v185, s[98:99]
    v_cndmask_b32 v16, v16, v17, s[84:85]
    v_cndmask_b32 v18, v18, v19, s[84:85]
    v_cndmask_b32 v217, v16, v18, s[86:87]
    v_cndmask_b32 v16, 0, v174, s[98:99]
    v_cndmask_b32 v17, v162, v178, s[98:99]
    v_cndmask_b32 v18, v166, v182, s[98:99]
    v_cndmask_b32 v19, v170, v186, s[98:99]
    v_cndmask_b32 v16, v16, v17, s[84:85]
    v_cndmask_b32 v18, v18, v19, s[84:85]
    v_cndmask_b32 v218, v16, v18, s[86:87]
    v_cndmask_b32 v16, 0, v175, s[98:99]
    v_cndmask_b32 v17, v163, v179, s[98:99]
    v_cndmask_b32 v18, v167, v183, s[98:99]
    v_cndmask_b32 v19, v171, v187, s[98:99]
    v_cndmask_b32 v16, v16, v17, s[84:85]
    v_cndmask_b32 v18, v18, v19, s[84:85]
    v_cndmask_b32 v219, v16, v18, s[86:87]
    v_mov_b32 v16, v216
    v_mov_b32 v18, v218
    v_fma_f32 v17, -v38, v218, v8
    v_fma_f32 v19, v38, v216, v10
    v_fma_f32 v17, v36, v216, v17
    v_fma_f32 v19, v36, v218, v19
    v_pk_mul_f32 v[56:57], v[32:33], v[16:17] op_sel:[0,0] op_sel_hi:[0,1]
    v_pk_mul_f32 v[58:59], v[32:33], v[18:19] op_sel:[0,0] op_sel_hi:[0,1]
    v_pk_fma_f32 v[56:57], v[34:35], v[18:19], v[56:57] op_sel:[0,0,0] op_sel_hi:[0,1,1] neg_lo:[1,0,0] neg_hi:[1,0,0]
    v_pk_fma_f32 v[58:59], v[34:35], v[16:17], v[58:59] op_sel:[0,0,0] op_sel_hi:[0,1,1]
    v_mov_b32 v16, v217
    v_mov_b32 v18, v219
    v_fma_f32 v17, -v39, v219, v12
    v_fma_f32 v19, v39, v217, v14
    v_fma_f32 v17, v37, v217, v17
    v_fma_f32 v19, v37, v219, v19
    v_pk_mul_f32 v[60:61], v[32:33], v[16:17] op_sel:[1,0] op_sel_hi:[1,1]
    v_pk_mul_f32 v[62:63], v[32:33], v[18:19] op_sel:[1,0] op_sel_hi:[1,1]
    v_pk_fma_f32 v[60:61], v[34:35], v[18:19], v[60:61] op_sel:[1,0,0] op_sel_hi:[1,1,1] neg_lo:[1,0,0] neg_hi:[1,0,0]
    v_pk_fma_f32 v[62:63], v[34:35], v[16:17], v[62:63] op_sel:[1,0,0] op_sel_hi:[1,1,1]
    v_pk_mul_f32 v[128:129], v[32:33], v[72:73] op_sel:[0,0] op_sel_hi:[0,1]
    v_pk_fma_f32 v[128:129], v[34:35], v[64:65], v[128:129] op_sel:[0,0,0] op_sel_hi:[0,1,1]
    v_pk_mul_f32 v[64:65], v[32:33], v[64:65] op_sel:[0,0] op_sel_hi:[0,1]
    v_pk_fma_f32 v[64:65], v[34:35], v[72:73], v[64:65] op_sel:[0,0,0] op_sel_hi:[0,1,1] neg_lo:[1,0,0] neg_hi:[1,0,0]
    v_pk_mul_f32 v[144:145], v[32:33], v[76:77] op_sel:[1,0] op_sel_hi:[1,1]
    v_pk_fma_f32 v[144:145], v[34:35], v[68:69], v[144:145] op_sel:[1,0,0] op_sel_hi:[1,1,1]
    v_pk_mul_f32 v[68:69], v[32:33], v[68:69] op_sel:[1,0] op_sel_hi:[1,1]
    v_pk_fma_f32 v[68:69], v[34:35], v[76:77], v[68:69] op_sel:[1,0,0] op_sel_hi:[1,1,1] neg_lo:[1,0,0] neg_hi:[1,0,0]
    v_pk_mul_f32 v[130:131], v[32:33], v[74:75] op_sel:[0,0] op_sel_hi:[0,1]
    v_pk_fma_f32 v[130:131], v[34:35], v[66:67], v[130:131] op_sel:[0,0,0] op_sel_hi:[0,1,1]
    v_pk_mul_f32 v[66:67], v[32:33], v[66:67] op_sel:[0,0] op_sel_hi:[0,1]
    v_pk_fma_f32 v[66:67], v[34:35], v[74:75], v[66:67] op_sel:[0,0,0] op_sel_hi:[0,1,1] neg_lo:[1,0,0] neg_hi:[1,0,0]
    v_pk_mul_f32 v[146:147], v[32:33], v[78:79] op_sel:[1,0] op_sel_hi:[1,1]
    v_pk_fma_f32 v[146:147], v[34:35], v[70:71], v[146:147] op_sel:[1,0,0] op_sel_hi:[1,1,1]
    v_pk_mul_f32 v[70:71], v[32:33], v[70:71] op_sel:[1,0] op_sel_hi:[1,1]
    v_pk_fma_f32 v[70:71], v[34:35], v[78:79], v[70:71] op_sel:[1,0,0] op_sel_hi:[1,1,1] neg_lo:[1,0,0] neg_hi:[1,0,0]
    v_pk_mul_f32 v[132:133], v[32:33], v[88:89] op_sel:[0,0] op_sel_hi:[0,1]
    v_pk_fma_f32 v[132:133], v[34:35], v[80:81], v[132:133] op_sel:[0,0,0] op_sel_hi:[0,1,1]
    v_pk_mul_f32 v[80:81], v[32:33], v[80:81] op_sel:[0,0] op_sel_hi:[0,1]
    v_pk_fma_f32 v[80:81], v[34:35], v[88:89], v[80:81] op_sel:[0,0,0] op_sel_hi:[0,1,1] neg_lo:[1,0,0] neg_hi:[1,0,0]
    v_pk_mul_f32 v[148:149], v[32:33], v[92:93] op_sel:[1,0] op_sel_hi:[1,1]
    v_pk_fma_f32 v[148:149], v[34:35], v[84:85], v[148:149] op_sel:[1,0,0] op_sel_hi:[1,1,1]
    v_pk_mul_f32 v[84:85], v[32:33], v[84:85] op_sel:[1,0] op_sel_hi:[1,1]
    v_pk_fma_f32 v[84:85], v[34:35], v[92:93], v[84:85] op_sel:[1,0,0] op_sel_hi:[1,1,1] neg_lo:[1,0,0] neg_hi:[1,0,0]
    v_pk_mul_f32 v[134:135], v[32:33], v[90:91] op_sel:[0,0] op_sel_hi:[0,1]
    v_pk_fma_f32 v[134:135], v[34:35], v[82:83], v[134:135] op_sel:[0,0,0] op_sel_hi:[0,1,1]
    v_pk_mul_f32 v[82:83], v[32:33], v[82:83] op_sel:[0,0] op_sel_hi:[0,1]
    v_pk_fma_f32 v[82:83], v[34:35], v[90:91], v[82:83] op_sel:[0,0,0] op_sel_hi:[0,1,1] neg_lo:[1,0,0] neg_hi:[1,0,0]
    v_pk_mul_f32 v[150:151], v[32:33], v[94:95] op_sel:[1,0] op_sel_hi:[1,1]
    v_pk_fma_f32 v[150:151], v[34:35], v[86:87], v[150:151] op_sel:[1,0,0] op_sel_hi:[1,1,1]
    v_pk_mul_f32 v[86:87], v[32:33], v[86:87] op_sel:[1,0] op_sel_hi:[1,1]
    v_pk_fma_f32 v[86:87], v[34:35], v[94:95], v[86:87] op_sel:[1,0,0] op_sel_hi:[1,1,1] neg_lo:[1,0,0] neg_hi:[1,0,0]
    v_pk_mul_f32 v[136:137], v[32:33], v[104:105] op_sel:[0,0] op_sel_hi:[0,1]
    v_pk_fma_f32 v[136:137], v[34:35], v[96:97], v[136:137] op_sel:[0,0,0] op_sel_hi:[0,1,1]
    v_pk_mul_f32 v[96:97], v[32:33], v[96:97] op_sel:[0,0] op_sel_hi:[0,1]
    v_pk_fma_f32 v[96:97], v[34:35], v[104:105], v[96:97] op_sel:[0,0,0] op_sel_hi:[0,1,1] neg_lo:[1,0,0] neg_hi:[1,0,0]
    v_pk_mul_f32 v[152:153], v[32:33], v[108:109] op_sel:[1,0] op_sel_hi:[1,1]
    v_pk_fma_f32 v[152:153], v[34:35], v[100:101], v[152:153] op_sel:[1,0,0] op_sel_hi:[1,1,1]
    v_pk_mul_f32 v[100:101], v[32:33], v[100:101] op_sel:[1,0] op_sel_hi:[1,1]
    v_pk_fma_f32 v[100:101], v[34:35], v[108:109], v[100:101] op_sel:[1,0,0] op_sel_hi:[1,1,1] neg_lo:[1,0,0] neg_hi:[1,0,0]
    v_pk_mul_f32 v[138:139], v[32:33], v[106:107] op_sel:[0,0] op_sel_hi:[0,1]
    v_pk_fma_f32 v[138:139], v[34:35], v[98:99], v[138:139] op_sel:[0,0,0] op_sel_hi:[0,1,1]
    v_pk_mul_f32 v[98:99], v[32:33], v[98:99] op_sel:[0,0] op_sel_hi:[0,1]
    v_pk_fma_f32 v[98:99], v[34:35], v[106:107], v[98:99] op_sel:[0,0,0] op_sel_hi:[0,1,1] neg_lo:[1,0,0] neg_hi:[1,0,0]
    v_pk_mul_f32 v[154:155], v[32:33], v[110:111] op_sel:[1,0] op_sel_hi:[1,1]
    v_pk_fma_f32 v[154:155], v[34:35], v[102:103], v[154:155] op_sel:[1,0,0] op_sel_hi:[1,1,1]
    v_pk_mul_f32 v[102:103], v[32:33], v[102:103] op_sel:[1,0] op_sel_hi:[1,1]
    v_pk_fma_f32 v[102:103], v[34:35], v[110:111], v[102:103] op_sel:[1,0,0] op_sel_hi:[1,1,1] neg_lo:[1,0,0] neg_hi:[1,0,0]
    v_pk_mul_f32 v[140:141], v[32:33], v[120:121] op_sel:[0,0] op_sel_hi:[0,1]
    v_pk_fma_f32 v[140:141], v[34:35], v[112:113], v[140:141] op_sel:[0,0,0] op_sel_hi:[0,1,1]
    v_pk_mul_f32 v[112:113], v[32:33], v[112:113] op_sel:[0,0] op_sel_hi:[0,1]
    v_pk_fma_f32 v[112:113], v[34:35], v[120:121], v[112:113] op_sel:[0,0,0] op_sel_hi:[0,1,1] neg_lo:[1,0,0] neg_hi:[1,0,0]
    v_pk_mul_f32 v[156:157], v[32:33], v[124:125] op_sel:[1,0] op_sel_hi:[1,1]
    v_pk_fma_f32 v[156:157], v[34:35], v[116:117], v[156:157] op_sel:[1,0,0] op_sel_hi:[1,1,1]
    v_pk_mul_f32 v[116:117], v[32:33], v[116:117] op_sel:[1,0] op_sel_hi:[1,1]
    v_pk_fma_f32 v[116:117], v[34:35], v[124:125], v[116:117] op_sel:[1,0,0] op_sel_hi:[1,1,1] neg_lo:[1,0,0] neg_hi:[1,0,0]
    v_pk_mul_f32 v[142:143], v[32:33], v[122:123] op_sel:[0,0] op_sel_hi:[0,1]
    v_pk_fma_f32 v[142:143], v[34:35], v[114:115], v[142:143] op_sel:[0,0,0] op_sel_hi:[0,1,1]
    v_pk_mul_f32 v[114:115], v[32:33], v[114:115] op_sel:[0,0] op_sel_hi:[0,1]
    v_pk_fma_f32 v[114:115], v[34:35], v[122:123], v[114:115] op_sel:[0,0,0] op_sel_hi:[0,1,1] neg_lo:[1,0,0] neg_hi:[1,0,0]
    v_pk_mul_f32 v[158:159], v[32:33], v[126:127] op_sel:[1,0] op_sel_hi:[1,1]
    v_pk_fma_f32 v[158:159], v[34:35], v[118:119], v[158:159] op_sel:[1,0,0] op_sel_hi:[1,1,1]
    v_pk_mul_f32 v[118:119], v[32:33], v[118:119] op_sel:[1,0] op_sel_hi:[1,1]
    v_pk_fma_f32 v[118:119], v[34:35], v[126:127], v[118:119] op_sel:[1,0,0] op_sel_hi:[1,1,1] neg_lo:[1,0,0] neg_hi:[1,0,0]
    buffer_load_dwordx4 v[160:163], v194, s[24:27], s44 offen offset:0 sc1
    buffer_load_dwordx4 v[164:167], v194, s[24:27], s45 offen offset:0 sc1
    buffer_load_dwordx4 v[168:171], v194, s[24:27], s46 offen offset:0 sc1
    buffer_load_dwordx4 v[172:175], v194, s[24:27], s47 offen offset:0 sc1
    buffer_load_dwordx4 v[176:179], v194, s[24:27], s44 offen offset:256 sc1
    buffer_load_dwordx4 v[180:183], v194, s[24:27], s45 offen offset:256 sc1
    buffer_load_dwordx4 v[184:187], v194, s[24:27], s46 offen offset:256 sc1
    buffer_load_dwordx4 v[188:191], v194, s[24:27], s47 offen offset:256 sc1
    buffer_load_dwordx2 v[240:241], v221, s[12:15], s57 offen sc1
    global_load_dwordx2 v[242:243], v222, s[58:59]
    buffer_load_dwordx2 v[224:225], v220, s[4:7], s56 offen
    s_add_u32 s56, s56, 8192
    buffer_load_dwordx2 v[226:227], v220, s[4:7], s56 offen
    s_add_u32 s56, s56, 8192
    buffer_load_dwordx2 v[228:229], v220, s[4:7], s56 offen
    s_add_u32 s56, s56, 8192
    buffer_load_dwordx2 v[230:231], v220, s[4:7], s56 offen
    s_add_u32 s56, s56, 8192
    buffer_load_dwordx2 v[232:233], v220, s[4:7], s56 offen
    s_add_u32 s56, s56, 8192
    buffer_load_dwordx2 v[234:235], v220, s[4:7], s56 offen
    s_add_u32 s56, s56, 8192
    buffer_load_dwordx2 v[236:237], v220, s[4:7], s56 offen
    s_add_u32 s56, s56, 8192
    buffer_load_dwordx2 v[238:239], v220, s[4:7], s56 offen
    s_add_u32 s56, s56, 8192
    s_waitcnt vmcnt(10)
L_poll:
    v_xor_b32 v161, v161, v198
    v_xor_b32 v163, v163, v198
    v_xor_b32 v165, v165, v199
    v_xor_b32 v167, v167, v199
    v_xor_b32 v169, v169, v200
    v_xor_b32 v171, v171, v200
    v_xor_b32 v173, v173, v201
    v_xor_b32 v175, v175, v201
    v_xor_b32 v177, v177, v198
    v_xor_b32 v179, v179, v198
    v_xor_b32 v181, v181, v199
    v_xor_b32 v183, v183, v199
    v_xor_b32 v185, v185, v200
    v_xor_b32 v187, v187, v200
    v_xor_b32 v189, v189, v201
    v_xor_b32 v191, v191, v201
    v_or3_b32 v214, v161, v163, v165
    v_or3_b32 v214, v214, v167, v169
    v_or3_b32 v214, v214, v171, v173
    v_or3_b32 v214, v214, v175, v177
    v_or3_b32 v214, v214, v179, v181
    v_or3_b32 v214, v214, v183, v185
    v_or3_b32 v214, v214, v187, v189
    v_or_b32 v214, v214, v191
    v_cmp_ne_u32 vcc, 0, v214
    s_nop 1
    s_cmp_eq_u64 vcc, 0
    s_cbranch_scc1 L_got
    s_sub_u32 s96, s96, 1
    s_cbranch_scc1 L_got
    s_sleep 2
    buffer_load_dwordx4 v[160:163], v194, s[24:27], s44 offen offset:0 sc1
    buffer_load_dwordx4 v[164:167], v194, s[24:27], s45 offen offset:0 sc1
    buffer_load_dwordx4 v[168:171], v194, s[24:27], s46 offen offset:0 sc1
    buffer_load_dwordx4 v[172:175], v194, s[24:27], s47 offen offset:0 sc1
    buffer_load_dwordx4 v[176:179], v194, s[24:27], s44 offen offset:256 sc1
    buffer_load_dwordx4 v[180:183], v194, s[24:27], s45 offen offset:256 sc1
    buffer_load_dwordx4 v[184:187], v194, s[24:27], s46 offen offset:256 sc1
    buffer_load_dwordx4 v[188:191], v194, s[24:27], s47 offen offset:256 sc1
    s_waitcnt vmcnt(0)
    s_branch L_poll
L_got:
    v_mov_b32 v6, 73728
    v_mov_b32 v7, 1
    s_mov_b64 exec, 1
    ds_add_u32 v6, v7 offset:76
    s_mov_b64 exec, -1
    v_fma_f32 v168, -v46, v174, v168
    v_fma_f32 v170, v46, v172, v170
    v_fma_f32 v168, v44, v172, v168
    v_fma_f32 v170, v44, v174, v170
    v_fma_f32 v184, -v47, v190, v184
    v_fma_f32 v186, v47, v188, v186
    v_fma_f32 v184, v45, v188, v184
    v_fma_f32 v186, v45, v190, v186
    v_fma_f32 v164, -v46, v170, v164
    v_fma_f32 v166, v46, v168, v166
    v_fma_f32 v164, v44, v168, v164
    v_fma_f32 v166, v44, v170, v166
    v_fma_f32 v180, -v47, v186, v180
    v_fma_f32 v182, v47, v184, v182
    v_fma_f32 v180, v45, v184, v180
    v_fma_f32 v182, v45, v186, v182
    v_fma_f32 v160, -v46, v166, v160
    v_fma_f32 v162, v46, v164, v162
    v_fma_f32 v160, v44, v164, v160
    v_fma_f32 v162, v44, v166, v162
    v_fma_f32 v176, -v47, v182, v176
    v_fma_f32 v178, v47, v180, v178
    v_fma_f32 v176, v45, v180, v176
    v_fma_f32 v178, v45, v182, v178
    v_mul_f32 v16, v48, v160
    v_mul_f32 v17, v48, v162
    v_fma_f32 v16, -v50, v162, v16
    v_fma_f32 v17, v50, v160, v17
    v_mul_f32 v18, v49, v176
    v_mul_f32 v19, v49, v178
    v_fma_f32 v18, -v51, v178, v18
    v_fma_f32 v19, v51, v176, v19
    v_mov_b32 v20, v16
    v_mov_b32 v21, v17
    v_mov_b32 v22, v18
    v_mov_b32 v23, v19
    s_nop 1
    v_permlane16_swap_b32 v16, v20
    v_permlane16_swap_b32 v17, v21
    v_permlane16_swap_b32 v18, v22
    v_permlane16_swap_b32 v19, v23
    s_nop 1
    v_add_f32 v16, v16, v20
    v_add_f32 v17, v17, v21
    v_add_f32 v18, v18, v22
    v_add_f32 v19, v19, v23
    v_mov_b32 v20, v16
    v_mov_b32 v21, v17
    v_mov_b32 v22, v18
    v_mov_b32 v23, v19
    s_nop 1
    v_permlane32_swap_b32 v16, v20
    v_permlane32_swap_b32 v17, v21
    v_permlane32_swap_b32 v18, v22
    v_permlane32_swap_b32 v19, v23
    s_nop 1
    v_add_f32 v16, v16, v20
    v_add_f32 v17, v17, v21
    v_add_f32 v18, v18, v22
    v_add_f32 v19, v19, v23
    v_pk_fma_f32 v[56:57], v[16:17], v[206:207], v[56:57] op_sel:[0,0,0] op_sel_hi:[0,1,1]
    v_pk_fma_f32 v[58:59], v[16:17], v[208:209], v[58:59] op_sel:[0,0,0] op_sel_hi:[0,1,1]
    v_pk_fma_f32 v[56:57], v[16:17], v[208:209], v[56:57] op_sel:[1,0,0] op_sel_hi:[1,1,1] neg_lo:[1,0,0] neg_hi:[1,0,0]
    v_pk_fma_f32 v[58:59], v[16:17], v[206:207], v[58:59] op_sel:[1,0,0] op_sel_hi:[1,1,1]
    v_pk_fma_f32 v[60:61], v[18:19], v[210:211], v[60:61] op_sel:[0,0,0] op_sel_hi:[0,1,1]
    v_pk_fma_f32 v[62:63], v[18:19], v[212:213], v[62:63] op_sel:[0,0,0] op_sel_hi:[0,1,1]
    v_pk_fma_f32 v[60:61], v[18:19], v[212:213], v[60:61] op_sel:[1,0,0] op_sel_hi:[1,1,1] neg_lo:[1,0,0] neg_hi:[1,0,0]
    v_pk_fma_f32 v[62:63], v[18:19], v[210:211], v[62:63] op_sel:[1,0,0] op_sel_hi:[1,1,1]
    v_pk_fma_f32 v[64:65], v[30:31], v[58:59], v[64:65] op_sel:[0,0,0] op_sel_hi:[0,1,1] neg_lo:[1,0,0] neg_hi:[1,0,0]
    v_pk_fma_f32 v[128:129], v[30:31], v[56:57], v[128:129] op_sel:[0,0,0] op_sel_hi:[0,1,1]
    v_pk_fma_f32 v[64:65], v[28:29], v[56:57], v[64:65] op_sel:[0,0,0] op_sel_hi:[0,1,1]
    v_pk_fma_f32 v[128:129], v[28:29], v[58:59], v[128:129] op_sel:[0,0,0] op_sel_hi:[0,1,1]
    v_pk_fma_f32 v[68:69], v[30:31], v[62:63], v[68:69] op_sel:[1,0,0] op_sel_hi:[1,1,1] neg_lo:[1,0,0] neg_hi:[1,0,0]
    v_pk_fma_f32 v[144:145], v[30:31], v[60:61], v[144:145] op_sel:[1,0,0] op_sel_hi:[1,1,1]
    v_pk_fma_f32 v[68:69], v[28:29], v[60:61], v[68:69] op_sel:[1,0,0] op_sel_hi:[1,1,1]
    v_pk_fma_f32 v[144:145], v[28:29], v[62:63], v[144:145] op_sel:[1,0,0] op_sel_hi:[1,1,1]
    v_pk_fma_f32 v[66:67], v[30:31], v[128:129], v[66:67] op_sel:[0,0,0] op_sel_hi:[0,1,1] neg_lo:[1,0,0] neg_hi:[1,0,0]
    v_pk_fma_f32 v[130:131], v[30:31], v[64:65], v[130:131] op_sel:[0,0,0] op_sel_hi:[0,1,1]
    v_pk_fma_f32 v[66:67], v[28:29], v[64:65], v[66:67] op_sel:[0,0,0] op_sel_hi:[0,1,1]
    v_pk_fma_f32 v[130:131], v[28:29], v[128:129], v[130:131] op_sel:[0,0,0] op_sel_hi:[0,1,1]
    v_pk_fma_f32 v[70:71], v[30:31], v[144:145], v[70:71] op_sel:[1,0,0] op_sel_hi:[1,1,1] neg_lo:[1,0,0] neg_hi:[1,0,0]
    v_pk_fma_f32 v[146:147], v[30:31], v[68:69], v[146:147] op_sel:[1,0,0] op_sel_hi:[1,1,1]
    v_pk_fma_f32 v[70:71], v[28:29], v[68:69], v[70:71] op_sel:[1,0,0] op_sel_hi:[1,1,1]
    v_pk_fma_f32 v[146:147], v[28:29], v[144:145], v[146:147] op_sel:[1,0,0] op_sel_hi:[1,1,1]
    v_cvt_pk_bf16_f32 v160, v64, v66
    v_cvt_pk_bf16_f32 v168, -v128, -v130
    v_cvt_pk_bf16_f32 v164, v65, v67
    v_cvt_pk_bf16_f32 v172, -v129, -v131
    v_cvt_pk_bf16_f32 v176, v68, v70
    v_cvt_pk_bf16_f32 v184, -v144, -v146
    v_cvt_pk_bf16_f32 v180, v69, v71
    v_cvt_pk_bf16_f32 v188, -v145, -v147
    v_pk_fma_f32 v[80:81], v[30:31], v[130:131], v[80:81] op_sel:[0,0,0] op_sel_hi:[0,1,1] neg_lo:[1,0,0] neg_hi:[1,0,0]
    v_pk_fma_f32 v[132:133], v[30:31], v[66:67], v[132:133] op_sel:[0,0,0] op_sel_hi:[0,1,1]
    v_pk_fma_f32 v[80:81], v[28:29], v[66:67], v[80:81] op_sel:[0,0,0] op_sel_hi:[0,1,1]
    v_pk_fma_f32 v[132:133], v[28:29], v[130:131], v[132:133] op_sel:[0,0,0] op_sel_hi:[0,1,1]
    v_pk_fma_f32 v[84:85], v[30:31], v[146:147], v[84:85] op_sel:[1,0,0] op_sel_hi:[1,1,1] neg_lo:[1,0,0] neg_hi:[1,0,0]
    v_pk_fma_f32 v[148:149], v[30:31], v[70:71], v[148:149] op_sel:[1,0,0] op_sel_hi:[1,1,1]
    v_pk_fma_f32 v[84:85], v[28:29], v[70:71], v[84:85] op_sel:[1,0,0] op_sel_hi:[1,1,1]
    v_pk_fma_f32 v[148:149], v[28:29], v[146:147], v[148:149] op_sel:[1,0,0] op_sel_hi:[1,1,1]
    v_pk_fma_f32 v[82:83], v[30:31], v[132:133], v[82:83] op_sel:[0,0,0] op_sel_hi:[0,1,1] neg_lo:[1,0,0] neg_hi:[1,0,0]
    v_pk_fma_f32 v[134:135], v[30:31], v[80:81], v[134:135] op_sel:[0,0,0] op_sel_hi:[0,1,1]
    v_pk_fma_f32 v[82:83], v[28:29], v[80:81], v[82:83] op_sel:[0,0,0] op_sel_hi:[0,1,1]
    v_pk_fma_f32 v[134:135], v[28:29], v[132:133], v[134:135] op_sel:[0,0,0] op_sel_hi:[0,1,1]
    v_pk_fma_f32 v[86:87], v[30:31], v[148:149], v[86:87] op_sel:[1,0,0] op_sel_hi:[1,1,1] neg_lo:[1,0,0] neg_hi:[1,0,0]
    v_pk_fma_f32 v[150:151], v[30:31], v[84:85], v[150:151] op_sel:[1,0,0] op_sel_hi:[1,1,1]
    v_pk_fma_f32 v[86:87], v[28:29], v[84:85], v[86:87] op_sel:[1,0,0] op_sel_hi:[1,1,1]
    v_pk_fma_f32 v[150:151], v[28:29], v[148:149], v[150:151] op_sel:[1,0,0] op_sel_hi:[1,1,1]
    v_cvt_pk_bf16_f32 v161, v80, v82
    v_cvt_pk_bf16_f32 v169, -v132, -v134
    v_cvt_pk_bf16_f32 v165, v81, v83
    v_cvt_pk_bf16_f32 v173, -v133, -v135
    v_cvt_pk_bf16_f32 v177, v84, v86
    v_cvt_pk_bf16_f32 v185, -v148, -v150
    v_cvt_pk_bf16_f32 v181, v85, v87
    v_cvt_pk_bf16_f32 v189, -v149, -v151
    v_pk_fma_f32 v[96:97], v[30:31], v[134:135], v[96:97] op_sel:[0,0,0] op_sel_hi:[0,1,1] neg_lo:[1,0,0] neg_hi:[1,0,0]
    v_pk_fma_f32 v[136:137], v[30:31], v[82:83], v[136:137] op_sel:[0,0,0] op_sel_hi:[0,1,1]
    v_pk_fma_f32 v[96:97], v[28:29], v[82:83], v[96:97] op_sel:[0,0,0] op_sel_hi:[0,1,1]
    v_pk_fma_f32 v[136:137], v[28:29], v[134:135], v[136:137] op_sel:[0,0,0] op_sel_hi:[0,1,1]
    v_pk_fma_f32 v[100:101], v[30:31], v[150:151], v[100:101] op_sel:[1,0,0] op_sel_hi:[1,1,1] neg_lo:[1,0,0] neg_hi:[1,0,0]
    v_pk_fma_f32 v[152:153], v[30:31], v[86:87], v[152:153] op_sel:[1,0,0] op_sel_hi:[1,1,1]
    v_pk_fma_f32 v[100:101], v[28:29], v[86:87], v[100:101] op_sel:[1,0,0] op_sel_hi:[1,1,1]
    v_pk_fma_f32 v[152:153], v[28:29], v[150:151], v[152:153] op_sel:[1,0,0] op_sel_hi:[1,1,1]
    v_pk_fma_f32 v[98:99], v[30:31], v[136:137], v[98:99] op_sel:[0,0,0] op_sel_hi:[0,1,1] neg_lo:[1,0,0] neg_hi:[1,0,0]
    v_pk_fma_f32 v[138:139], v[30:31], v[96:97], v[138:139] op_sel:[0,0,0] op_sel_hi:[0,1,1]
    v_pk_fma_f32 v[98:99], v[28:29], v[96:97], v[98:99] op_sel:[0,0,0] op_sel_hi:[0,1,1]
    v_pk_fma_f32 v[138:139], v[28:29], v[136:137], v[138:139] op_sel:[0,0,0] op_sel_hi:[0,1,1]
    v_pk_fma_f32 v[102:103], v[30:31], v[152:153], v[102:103] op_sel:[1,0,0] op_sel_hi:[1,1,1] neg_lo:[1,0,0] neg_hi:[1,0,0]
    v_pk_fma_f32 v[154:155], v[30:31], v[100:101], v[154:155] op_sel:[1,0,0] op_sel_hi:[1,1,1]
    v_pk_fma_f32 v[102:103], v[28:29], v[100:101], v[102:103] op_sel:[1,0,0] op_sel_hi:[1,1,1]
    v_pk_fma_f32 v[154:155], v[28:29], v[152:153], v[154:155] op_sel:[1,0,0] op_sel_hi:[1,1,1]
    v_cvt_pk_bf16_f32 v162, v96, v98
    v_cvt_pk_bf16_f32 v170, -v136, -v138
    v_cvt_pk_bf16_f32 v166, v97, v99
    v_cvt_pk_bf16_f32 v174, -v137, -v139
    v_cvt_pk_bf16_f32 v178, v100, v102
    v_cvt_pk_bf16_f32 v186, -v152, -v154
    v_cvt_pk_bf16_f32 v182, v101, v103
    v_cvt_pk_bf16_f32 v190, -v153, -v155
    v_pk_fma_f32 v[112:113], v[30:31], v[138:139], v[112:113] op_sel:[0,0,0] op_sel_hi:[0,1,1] neg_lo:[1,0,0] neg_hi:[1,0,0]
    v_pk_fma_f32 v[140:141], v[30:31], v[98:99], v[140:141] op_sel:[0,0,0] op_sel_hi:[0,1,1]
    v_pk_fma_f32 v[112:113], v[28:29], v[98:99], v[112:113] op_sel:[0,0,0] op_sel_hi:[0,1,1]
    v_pk_fma_f32 v[140:141], v[28:29], v[138:139], v[140:141] op_sel:[0,0,0] op_sel_hi:[0,1,1]
    v_pk_fma_f32 v[116:117], v[30:31], v[154:155], v[116:117] op_sel:[1,0,0] op_sel_hi:[1,1,1] neg_lo:[1,0,0] neg_hi:[1,0,0]
    v_pk_fma_f32 v[156:157], v[30:31], v[102:103], v[156:157] op_sel:[1,0,0] op_sel_hi:[1,1,1]
    v_pk_fma_f32 v[116:117], v[28:29], v[102:103], v[116:117] op_sel:[1,0,0] op_sel_hi:[1,1,1]
    v_pk_fma_f32 v[156:157], v[28:29], v[154:155], v[156:157] op_sel:[1,0,0] op_sel_hi:[1,1,1]
    v_pk_fma_f32 v[114:115], v[30:31], v[140:141], v[114:115] op_sel:[0,0,0] op_sel_hi:[0,1,1] neg_lo:[1,0,0] neg_hi:[1,0,0]
    v_pk_fma_f32 v[142:143], v[30:31], v[112:113], v[142:143] op_sel:[0,0,0] op_sel_hi:[0,1,1]
    v_pk_fma_f32 v[114:115], v[28:29], v[112:113], v[114:115] op_sel:[0,0,0] op_sel_hi:[0,1,1]
    v_pk_fma_f32 v[142:143], v[28:29], v[140:141], v[142:143] op_sel:[0,0,0] op_sel_hi:[0,1,1]
    v_pk_fma_f32 v[118:119], v[30:31], v[156:157], v[118:119] op_sel:[1,0,0] op_sel_hi:[1,1,1] neg_lo:[1,0,0] neg_hi:[1,0,0]
    v_pk_fma_f32 v[158:159], v[30:31], v[116:117], v[158:159] op_sel:[1,0,0] op_sel_hi:[1,1,1]
    v_pk_fma_f32 v[118:119], v[28:29], v[116:117], v[118:119] op_sel:[1,0,0] op_sel_hi:[1,1,1]
    v_pk_fma_f32 v[158:159], v[28:29], v[156:157], v[158:159] op_sel:[1,0,0] op_sel_hi:[1,1,1]
    v_cvt_pk_bf16_f32 v163, v112, v114
    v_cvt_pk_bf16_f32 v171, -v140, -v142
    v_cvt_pk_bf16_f32 v167, v113, v115
    v_cvt_pk_bf16_f32 v175, -v141, -v143
    v_cvt_pk_bf16_f32 v179, v116, v118
    v_cvt_pk_bf16_f32 v187, -v156, -v158
    v_cvt_pk_bf16_f32 v183, v117, v119
    v_cvt_pk_bf16_f32 v191, -v157, -v159
    ds_write_b128 v195, v[160:163] offset:0
    ds_write_b128 v195, v[164:167] offset:16
    ds_write_b128 v195, v[176:179] offset:2304
    ds_write_b128 v195, v[180:183] offset:2320
    ds_write_b128 v195, v[168:171] offset:4608
    ds_write_b128 v195, v[172:175] offset:4624
    ds_write_b128 v195, v[184:187] offset:6912
    ds_write_b128 v195, v[188:191] offset:6928
    s_waitcnt lgkmcnt(4)
    ds_read_b64_tr_b16 v[128:129], v196 offset:0
    ds_read_b64_tr_b16 v[130:131], v196 offset:576
    ds_read_b64_tr_b16 v[132:133], v196 offset:32
    ds_read_b64_tr_b16 v[134:135], v196 offset:608
    ds_read_b64_tr_b16 v[136:137], v196 offset:64
    ds_read_b64_tr_b16 v[138:139], v196 offset:640
    ds_read_b64_tr_b16 v[140:141], v196 offset:96
    ds_read_b64_tr_b16 v[142:143], v196 offset:672
    s_waitcnt lgkmcnt(8)
    ds_read_b64_tr_b16 v[144:145], v196 offset:4608
    ds_read_b64_tr_b16 v[146:147], v196 offset:5184
    ds_read_b64_tr_b16 v[148:149], v196 offset:4640
    ds_read_b64_tr_b16 v[150:151], v196 offset:5216
    ds_read_b64_tr_b16 v[152:153], v196 offset:4672
    ds_read_b64_tr_b16 v[154:155], v196 offset:5248
    ds_read_b64_tr_b16 v[156:157], v196 offset:4704
    ds_read_b64_tr_b16 v[158:159], v196 offset:5280
    s_add_u32 s39, s53, 0
    s_waitcnt lgkmcnt(14)
    buffer_store_dwordx4 v[128:131], v197, s[12:15], s39 offen offset:0 sc1
    s_waitcnt lgkmcnt(12)
    buffer_store_dwordx4 v[132:135], v197, s[12:15], s39 offen offset:1024 sc1
    s_add_u32 s39, s53, 8192
    s_waitcnt lgkmcnt(10)
    buffer_store_dwordx4 v[136:139], v197, s[12:15], s39 offen offset:0 sc1
    s_waitcnt lgkmcnt(8)
    buffer_store_dwordx4 v[140:143], v197, s[12:15], s39 offen offset:1024 sc1
    s_add_u32 s39, s53, 4096
    s_waitcnt lgkmcnt(6)
    buffer_store_dwordx4 v[144:147], v197, s[12:15], s39 offen offset:0 sc1
    s_waitcnt lgkmcnt(4)
    buffer_store_dwordx4 v[148:151], v197, s[12:15], s39 offen offset:1024 sc1
    s_add_u32 s39, s53, 12288
    s_waitcnt lgkmcnt(2)
    buffer_store_dwordx4 v[152:155], v197, s[12:15], s39 offen offset:0 sc1
    s_waitcnt lgkmcnt(0)
    buffer_store_dwordx4 v[156:159], v197, s[12:15], s39 offen offset:1024 sc1
    s_waitcnt vmcnt(8)
L_gchk:
    v_cmp_ne_u32 vcc, s93, v241
    s_nop 1
    s_cmp_eq_u64 vcc, 0
    s_cbranch_scc1 L_gok
    s_sub_u32 s96, s96, 1
    s_cbranch_scc1 L_gok
    buffer_load_dwordx2 v[240:241], v221, s[12:15], s57 offen sc1
    s_waitcnt vmcnt(0)
    s_branch L_gchk
L_gok:
    v_lshlrev_b32 v6, 2, v25
    v_lshlrev_b32 v7, 2, v26
    ds_bpermute_b32 v244, v6, v240 offset:0
    ds_bpermute_b32 v245, v6, v240 offset:16
    ds_bpermute_b32 v246, v6, v240 offset:32
    ds_bpermute_b32 v247, v6, v240 offset:48
    ds_bpermute_b32 v248, v6, v240 offset:64
    ds_bpermute_b32 v249, v6, v240 offset:80
    ds_bpermute_b32 v250, v6, v240 offset:96
    ds_bpermute_b32 v251, v6, v240 offset:112
    ds_bpermute_b32 v4, v7, v240 offset:0
    ds_bpermute_b32 v5, v7, v240 offset:64
    s_mov_b32 s10, 0xffff0000
    s_add_u32 m0, s23, 81920
    s_add_u32 s21, s55, 0
    s_and_b32 s21, s21, 7
    s_or_b32 s21, s21, s54
    s_lshl_b32 s21, s21, 7
    buffer_load_dwordx4 v202, s[28:31], s21 offen offset:0  lds
    v_lshlrev_b32 v252, 16, v242
    v_and_b32 v253, s10, v242
    v_lshlrev_b32 v254, 16, v243
    v_and_b32 v255, s10, v243
    s_waitcnt lgkmcnt(0)
    v_sub_f32 v12, 1.0, v244
    v_cvt_pk_bf16_f32 v12, v12, v12
    v_lshlrev_b32 v12, 16, v12
    v_lshlrev_b32 v8, 16, v224
    v_and_b32 v9, s10, v224
    v_mul_f32 v10, v8, v252
    v_mul_f32 v11, v9, v253
    buffer_load_dwordx4 v203, s[28:31], s21 offen offset:1024  lds
    v_cvt_pk_bf16_f32 v10, v10, v11
    v_mul_f32 v8, v8, v12
    v_mul_f32 v9, v9, v12
    v_cvt_pk_bf16_f32 v8, v8, v9
    v_and_b32 v11, s10, v10
    v_lshlrev_b32 v10, 16, v10
    v_and_b32 v9, s10, v8
    v_lshlrev_b32 v8, 16, v8
    v_fma_f32 v72, v244, v10, v8
    v_fma_f32 v73, v244, v11, v9
    v_lshlrev_b32 v8, 16, v225
    v_and_b32 v9, s10, v225
    buffer_load_dwordx4 v204, s[28:31], s21 offen offset:2048  lds
    v_mul_f32 v10, v8, v254
    v_mul_f32 v11, v9, v255
    v_cvt_pk_bf16_f32 v10, v10, v11
    v_mul_f32 v8, v8, v12
    v_mul_f32 v9, v9, v12
    v_cvt_pk_bf16_f32 v8, v8, v9
    v_and_b32 v11, s10, v10
    v_lshlrev_b32 v10, 16, v10
    v_and_b32 v9, s10, v8
    v_lshlrev_b32 v8, 16, v8
    v_fma_f32 v74, v244, v10, v8
    v_fma_f32 v75, v244, v11, v9
    buffer_load_dwordx4 v205, s[28:31], s21 offen offset:3072  lds
    v_sub_f32 v12, 1.0, v245
    v_cvt_pk_bf16_f32 v12, v12, v12
    v_lshlrev_b32 v12, 16, v12
    v_lshlrev_b32 v8, 16, v226
    v_and_b32 v9, s10, v226
    v_mul_f32 v10, v8, v252
    v_mul_f32 v11, v9, v253
    v_cvt_pk_bf16_f32 v10, v10, v11
    v_mul_f32 v8, v8, v12
    v_mul_f32 v9, v9, v12
    v_cvt_pk_bf16_f32 v8, v8, v9
    v_and_b32 v11, s10, v10
    s_add_u32 m0, s23, 0
    s_add_u32 s21, s55, 1
    s_and_b32 s21, s21, 7
    s_or_b32 s21, s21, s54
    s_lshl_b32 s21, s21, 7
    buffer_load_dwordx4 v202, s[28:31], s21 offen offset:0  lds
    v_lshlrev_b32 v10, 16, v10
    v_and_b32 v9, s10, v8
    v_lshlrev_b32 v8, 16, v8
    v_fma_f32 v76, v245, v10, v8
    v_fma_f32 v77, v245, v11, v9
    v_lshlrev_b32 v8, 16, v227
    v_and_b32 v9, s10, v227
    v_mul_f32 v10, v8, v254
    v_mul_f32 v11, v9, v255
    v_cvt_pk_bf16_f32 v10, v10, v11
    v_mul_f32 v8, v8, v12
    v_mul_f32 v9, v9, v12
    buffer_load_dwordx4 v203, s[28:31], s21 offen offset:1024  lds
    v_cvt_pk_bf16_f32 v8, v8, v9
    v_and_b32 v11, s10, v10
    v_lshlrev_b32 v10, 16, v10
    v_and_b32 v9, s10, v8
    v_lshlrev_b32 v8, 16, v8
    v_fma_f32 v78, v245, v10, v8
    v_fma_f32 v79, v245, v11, v9
    v_sub_f32 v12, 1.0, v246
    v_cvt_pk_bf16_f32 v12, v12, v12
    v_lshlrev_b32 v12, 16, v12
    v_lshlrev_b32 v8, 16, v228
    v_and_b32 v9, s10, v228
    buffer_load_dwordx4 v204, s[28:31], s21 offen offset:2048  lds
    v_mul_f32 v10, v8, v252
    v_mul_f32 v11, v9, v253
    v_cvt_pk_bf16_f32 v10, v10, v11
    v_mul_f32 v8, v8, v12
    v_mul_f32 v9, v9, v12
    v_cvt_pk_bf16_f32 v8, v8, v9
    v_and_b32 v11, s10, v10
    v_lshlrev_b32 v10, 16, v10
    v_and_b32 v9, s10, v8
    v_lshlrev_b32 v8, 16, v8
    v_fma_f32 v88, v246, v10, v8
    v_fma_f32 v89, v246, v11, v9
    buffer_load_dwordx4 v205, s[28:31], s21 offen offset:3072  lds
    v_lshlrev_b32 v8, 16, v229
    v_and_b32 v9, s10, v229
    v_mul_f32 v10, v8, v254
    v_mul_f32 v11, v9, v255
    v_cvt_pk_bf16_f32 v10, v10, v11
    v_mul_f32 v8, v8, v12
    v_mul_f32 v9, v9, v12
    v_cvt_pk_bf16_f32 v8, v8, v9
    v_and_b32 v11, s10, v10
    v_lshlrev_b32 v10, 16, v10
    v_and_b32 v9, s10, v8
    v_lshlrev_b32 v8, 16, v8
    s_add_u32 m0, s23, 16384
    s_add_u32 s21, s55, 2
    s_and_b32 s21, s21, 7
    s_or_b32 s21, s21, s54
    s_lshl_b32 s21, s21, 7
    buffer_load_dwordx4 v202, s[28:31], s21 offen offset:0  lds
    v_fma_f32 v90, v246, v10, v8
    v_fma_f32 v91, v246, v11, v9
    v_sub_f32 v12, 1.0, v247
    v_cvt_pk_bf16_f32 v12, v12, v12
    v_lshlrev_b32 v12, 16, v12
    v_lshlrev_b32 v8, 16, v230
    v_and_b32 v9, s10, v230
    v_mul_f32 v10, v8, v252
    v_mul_f32 v11, v9, v253
    v_cvt_pk_bf16_f32 v10, v10, v11
    v_mul_f32 v8, v8, v12
    v_mul_f32 v9, v9, v12
    buffer_load_dwordx4 v203, s[28:31], s21 offen offset:1024  lds
    v_cvt_pk_bf16_f32 v8, v8, v9
    v_and_b32 v11, s10, v10
    v_lshlrev_b32 v10, 16, v10
    v_and_b32 v9, s10, v8
    v_lshlrev_b32 v8, 16, v8
    v_fma_f32 v92, v247, v10, v8
    v_fma_f32 v93, v247, v11, v9
    v_lshlrev_b32 v8, 16, v231
    v_and_b32 v9, s10, v231
    v_mul_f32 v10, v8, v254
    v_mul_f32 v11, v9, v255
    v_cvt_pk_bf16_f32 v10, v10, v11
    buffer_load_dwordx4 v204, s[28:31], s21 offen offset:2048  lds
    v_mul_f32 v8, v8, v12
    v_mul_f32 v9, v9, v12
    v_cvt_pk_bf16_f32 v8, v8, v9
    v_and_b32 v11, s10, v10
    v_lshlrev_b32 v10, 16, v10
    v_and_b32 v9, s10, v8
    v_lshlrev_b32 v8, 16, v8
    v_fma_f32 v94, v247, v10, v8
    v_fma_f32 v95, v247, v11, v9
    v_sub_f32 v12, 1.0, v248
    v_cvt_pk_bf16_f32 v12, v12, v12
    v_lshlrev_b32 v12, 16, v12
    buffer_load_dwordx4 v205, s[28:31], s21 offen offset:3072  lds
    v_lshlrev_b32 v8, 16, v232
    v_and_b32 v9, s10, v232
    v_mul_f32 v10, v8, v252
    v_mul_f32 v11, v9, v253
    v_cvt_pk_bf16_f32 v10, v10, v11
    v_mul_f32 v8, v8, v12
    v_mul_f32 v9, v9, v12
    v_cvt_pk_bf16_f32 v8, v8, v9
    v_and_b32 v11, s10, v10
    v_lshlrev_b32 v10, 16, v10
    v_and_b32 v9, s10, v8
    v_lshlrev_b32 v8, 16, v8
    v_fma_f32 v104, v248, v10, v8
    v_fma_f32 v105, v248, v11, v9
    v_lshlrev_b32 v8, 16, v233
    v_and_b32 v9, s10, v233
    v_mul_f32 v10, v8, v254
    v_mul_f32 v11, v9, v255
    v_cvt_pk_bf16_f32 v10, v10, v11
    v_mul_f32 v8, v8, v12
    v_mul_f32 v9, v9, v12
    v_cvt_pk_bf16_f32 v8, v8, v9
    v_and_b32 v11, s10, v10
    v_lshlrev_b32 v10, 16, v10
    v_and_b32 v9, s10, v8
    v_lshlrev_b32 v8, 16, v8
    v_fma_f32 v106, v248, v10, v8
    v_fma_f32 v107, v248, v11, v9
    v_sub_f32 v12, 1.0, v249
    v_cvt_pk_bf16_f32 v12, v12, v12
    v_lshlrev_b32 v12, 16, v12
    v_lshlrev_b32 v8, 16, v234
    v_and_b32 v9, s10, v234
    v_mul_f32 v10, v8, v252
    v_mul_f32 v11, v9, v253
    v_cvt_pk_bf16_f32 v10, v10, v11
    v_mul_f32 v8, v8, v12
    v_mul_f32 v9, v9, v12
    v_cvt_pk_bf16_f32 v8, v8, v9
    v_and_b32 v11, s10, v10
    v_lshlrev_b32 v10, 16, v10
    v_and_b32 v9, s10, v8
    v_lshlrev_b32 v8, 16, v8
    v_fma_f32 v108, v249, v10, v8
    v_fma_f32 v109, v249, v11, v9
    v_lshlrev_b32 v8, 16, v235
    v_and_b32 v9, s10, v235
    v_mul_f32 v10, v8, v254
    v_mul_f32 v11, v9, v255
    v_cvt_pk_bf16_f32 v10, v10, v11
    v_mul_f32 v8, v8, v12
    v_mul_f32 v9, v9, v12
    v_cvt_pk_bf16_f32 v8, v8, v9
    v_and_b32 v11, s10, v10
    v_lshlrev_b32 v10, 16, v10
    v_and_b32 v9, s10, v8
    v_lshlrev_b32 v8, 16, v8
    v_fma_f32 v110, v249, v10, v8
    v_fma_f32 v111, v249, v11, v9
    v_sub_f32 v12, 1.0, v250
    v_cvt_pk_bf16_f32 v12, v12, v12
    v_lshlrev_b32 v12, 16, v12
    v_lshlrev_b32 v8, 16, v236
    v_and_b32 v9, s10, v236
    v_mul_f32 v10, v8, v252
    v_mul_f32 v11, v9, v253
    v_cvt_pk_bf16_f32 v10, v10, v11
    v_mul_f32 v8, v8, v12
    v_mul_f32 v9, v9, v12
    v_cvt_pk_bf16_f32 v8, v8, v9
    v_and_b32 v11, s10, v10
    v_lshlrev_b32 v10, 16, v10
    v_and_b32 v9, s10, v8
    v_lshlrev_b32 v8, 16, v8
    v_fma_f32 v120, v250, v10, v8
    v_fma_f32 v121, v250, v11, v9
    v_lshlrev_b32 v8, 16, v237
    v_and_b32 v9, s10, v237
    v_mul_f32 v10, v8, v254
    v_mul_f32 v11, v9, v255
    v_cvt_pk_bf16_f32 v10, v10, v11
    v_mul_f32 v8, v8, v12
    v_mul_f32 v9, v9, v12
    v_cvt_pk_bf16_f32 v8, v8, v9
    v_and_b32 v11, s10, v10
    v_lshlrev_b32 v10, 16, v10
    v_and_b32 v9, s10, v8
    v_lshlrev_b32 v8, 16, v8
    v_fma_f32 v122, v250, v10, v8
    v_fma_f32 v123, v250, v11, v9
    v_sub_f32 v12, 1.0, v251
    v_cvt_pk_bf16_f32 v12, v12, v12
    v_lshlrev_b32 v12, 16, v12
    v_lshlrev_b32 v8, 16, v238
    v_and_b32 v9, s10, v238
    v_mul_f32 v10, v8, v252
    v_mul_f32 v11, v9, v253
    v_cvt_pk_bf16_f32 v10, v10, v11
    v_mul_f32 v8, v8, v12
    v_mul_f32 v9, v9, v12
    v_cvt_pk_bf16_f32 v8, v8, v9
    v_and_b32 v11, s10, v10
    v_lshlrev_b32 v10, 16, v10
    v_and_b32 v9, s10, v8
    v_lshlrev_b32 v8, 16, v8
    v_fma_f32 v124, v251, v10, v8
    v_fma_f32 v125, v251, v11, v9
    v_lshlrev_b32 v8, 16, v239
    v_and_b32 v9, s10, v239
    v_mul_f32 v10, v8, v254
    v_mul_f32 v11, v9, v255
    v_cvt_pk_bf16_f32 v10, v10, v11
    v_mul_f32 v8, v8, v12
    v_mul_f32 v9, v9, v12
    v_cvt_pk_bf16_f32 v8, v8, v9
    v_and_b32 v11, s10, v10
    v_lshlrev_b32 v10, 16, v10
    v_and_b32 v9, s10, v8
    v_lshlrev_b32 v8, 16, v8
    v_fma_f32 v126, v251, v10, v8
    v_fma_f32 v127, v251, v11, v9
    v_mov_b32 v16, v202
    v_mov_b32 v17, v203
    v_mov_b32 v18, v204
    v_mov_b32 v19, v205
    v_mov_b32 v28, v197
    v_add_u32 v29, 4096, v197
    s_lshl_b32 s38, s18, 13
    s_add_u32 s50, s48, s38
    v_mov_b32 v32, 73728
    v_mov_b32 v33, 1
    v_bfe_u32 v59, v24, 1, 3
    v_xor_b32 v59, v59, v25
    v_lshlrev_b32 v59, 4, v59
    v_lshl_add_u32 v59, v26, 7, v59
    v_xor_b32 v20, 0, v59
    v_add_u32 v22, 0x10000, v20
    v_xor_b32 v21, 64, v59
    v_add_u32 v23, 0x10000, v21
    v_xor_b32 v30, s54, v26
    v_lshlrev_b32 v30, 8, v30
    v_mov_b32 v58, s93
    v_lshlrev_b32 v59, 2, v24
    s_lshl_b32 s52, s16, 12
    s_add_u32 s52, s52, 9502720
    s_lshl_b32 s46, s17, 8
    s_add_u32 s46, s46, s52
    s_waitcnt vmcnt(12)
    v_mov_b32 v57, 1
    s_mov_b64 exec, 1
    ds_add_rtn_u32 v57, v32, v57 offset:12
    s_mov_b64 exec, -1
    s_waitcnt lgkmcnt(0)
    v_readfirstlane_b32 s39, v57
    s_nop 1
    s_cmp_lg_u32 s39, 3
    s_cbranch_scc1 L_nohf
    s_mov_b32 exec_hi, 0
    buffer_store_dword v58, v59, s[12:15], s46 offen sc1
    s_mov_b32 exec_hi, -1
L_nohf:
L_hpoll:
    s_mov_b64 exec, 255
    buffer_load_dword v31, v30, s[12:15], s52 offen sc1
    s_mov_b64 exec, -1
    s_waitcnt vmcnt(0)
    v_cmp_ne_u32 vcc, s93, v31
    s_nop 1
    s_and_b32 s38, vcc_lo, 255
    s_cbranch_scc0 L_hgo
    s_sub_u32 s96, s96, 1
    s_cbranch_scc1 L_hgo
    s_sleep 2
    s_branch L_hpoll
L_hgo:
    s_mov_b64 exec, 1
    ds_add_u32 v32, v33 offset:72
    s_mov_b64 exec, -1
    s_add_u32 s49, s55, 0
    s_and_b32 s49, s49, 7
    s_or_b32 s49, s49, s54
    s_lshl_b32 s49, s49, 15
    s_add_u32 s49, s49, s50
    buffer_load_dwordx4 v[160:163], v28, s[12:15], s49 offen offset:0 sc1
    buffer_load_dwordx4 v[164:167], v28, s[12:15], s49 offen offset:1024 sc1
    buffer_load_dwordx4 v[168:171], v28, s[12:15], s49 offen offset:2048 sc1
    buffer_load_dwordx4 v[172:175], v28, s[12:15], s49 offen offset:3072 sc1
L_sync0:
    ds_read_b32 v34, v32 offset:72
    s_waitcnt lgkmcnt(0)
    v_readfirstlane_b32 s38, v34
    s_nop 1
    s_cmp_ge_u32 s38, 4
    s_cbranch_scc1 L_sync0_ok
    s_sub_u32 s96, s96, 1
    s_cbranch_scc1 L_sync0_ok
    s_sleep 1
    s_branch L_sync0
L_sync0_ok:
    ds_read_b128 v[224:227], v22 offset:16384
    ds_read_b128 v[228:231], v22 offset:18432
    ds_read_b128 v[232:235], v22 offset:20480
    ds_read_b128 v[236:239], v22 offset:22528
    buffer_load_dwordx4 v[176:179], v29, s[12:15], s49 offen offset:0 sc1
    buffer_load_dwordx4 v[180:183], v29, s[12:15], s49 offen offset:1024 sc1
    buffer_load_dwordx4 v[184:187], v29, s[12:15], s49 offen offset:2048 sc1
    buffer_load_dwordx4 v[188:191], v29, s[12:15], s49 offen offset:3072 sc1
    s_add_u32 s49, s55, 1
    s_and_b32 s49, s49, 7
    s_or_b32 s49, s49, s54
    s_lshl_b32 s49, s49, 15
    s_add_u32 s49, s49, s50
    buffer_load_dwordx4 v[192:195], v28, s[12:15], s49 offen offset:0 sc1
    buffer_load_dwordx4 v[196:199], v28, s[12:15], s49 offen offset:1024 sc1
    buffer_load_dwordx4 v[200:203], v28, s[12:15], s49 offen offset:2048 sc1
    buffer_load_dwordx4 v[204:207], v28, s[12:15], s49 offen offset:3072 sc1
    buffer_load_dwordx4 v[208:211], v29, s[12:15], s49 offen offset:0 sc1
    buffer_load_dwordx4 v[212:215], v29, s[12:15], s49 offen offset:1024 sc1
    buffer_load_dwordx4 v[216:219], v29, s[12:15], s49 offen offset:2048 sc1
    buffer_load_dwordx4 v[220:223], v29, s[12:15], s49 offen offset:3072 sc1
    ds_read_b128 v[240:243], v23 offset:16384
    ds_read_b128 v[244:247], v23 offset:18432
    ds_read_b128 v[248:251], v23 offset:20480
    ds_read_b128 v[252:255], v23 offset:22528
    s_waitcnt vmcnt(14) lgkmcnt(4)
    v_mfma_f32_16x16x32_bf16 v[128:131], v[224:227], v[160:163], 0
    v_mfma_f32_16x16x32_bf16 v[132:135], v[228:231], v[160:163], 0
    v_mfma_f32_16x16x32_bf16 v[136:139], v[232:235], v[160:163], 0
    v_mfma_f32_16x16x32_bf16 v[140:143], v[236:239], v[160:163], 0
    s_add_u32 s49, s55, 2
    s_and_b32 s49, s49, 7
    s_or_b32 s49, s49, s54
    s_lshl_b32 s49, s49, 15
    s_add_u32 s49, s49, s50
    buffer_load_dwordx4 v[160:163], v28, s[12:15], s49 offen offset:0 sc1
    s_add_u32 m0, s23, 32768
    s_add_u32 s21, s55, 3
    s_and_b32 s21, s21, 7
    s_or_b32 s21, s21, s54
    s_lshl_b32 s21, s21, 7
    buffer_load_dwordx4 v16, s[28:31], s21 offen offset:0  lds
    v_mfma_f32_16x16x32_bf16 v[144:147], v[224:227], v[164:167], 0
    v_mfma_f32_16x16x32_bf16 v[148:151], v[228:231], v[164:167], 0
    v_mfma_f32_16x16x32_bf16 v[152:155], v[232:235], v[164:167], 0
    v_mfma_f32_16x16x32_bf16 v[156:159], v[236:239], v[164:167], 0
    buffer_load_dwordx4 v[164:167], v28, s[12:15], s49 offen offset:1024 sc1
    ds_read_b128 v[224:227], v22 offset:24576
    ds_read_b128 v[228:231], v22 offset:26624
    ds_read_b128 v[232:235], v22 offset:28672
    ds_read_b128 v[236:239], v22 offset:30720
    s_waitcnt vmcnt(15) lgkmcnt(4)
    s_mov_b64 exec, 1
    ds_add_u32 v32, v33 offset:16
    s_mov_b64 exec, -1
    v_mfma_f32_16x16x32_bf16 v[128:131], v[240:243], v[168:171], v[128:131]
    v_mfma_f32_16x16x32_bf16 v[132:135], v[244:247], v[168:171], v[132:135]
    v_mfma_f32_16x16x32_bf16 v[136:139], v[248:251], v[168:171], v[136:139]
    v_mfma_f32_16x16x32_bf16 v[140:143], v[252:255], v[168:171], v[140:143]
    buffer_load_dwordx4 v[168:171], v28, s[12:15], s49 offen offset:2048 sc1
    buffer_load_dwordx4 v17, s[28:31], s21 offen offset:1024  lds
    v_mfma_f32_16x16x32_bf16 v[144:147], v[240:243], v[172:175], v[144:147]
    v_mfma_f32_16x16x32_bf16 v[148:151], v[244:247], v[172:175], v[148:151]
    v_mfma_f32_16x16x32_bf16 v[152:155], v[248:251], v[172:175], v[152:155]
    v_mfma_f32_16x16x32_bf16 v[156:159], v[252:255], v[172:175], v[156:159]
    buffer_load_dwordx4 v[172:175], v28, s[12:15], s49 offen offset:3072 sc1
    ds_read_b128 v[240:243], v23 offset:24576
    ds_read_b128 v[244:247], v23 offset:26624
    ds_read_b128 v[248:251], v23 offset:28672
    ds_read_b128 v[252:255], v23 offset:30720
    s_waitcnt vmcnt(16) lgkmcnt(4)
    v_mfma_f32_16x16x32_bf16 v[128:131], v[224:227], v[176:179], v[128:131]
    v_mfma_f32_16x16x32_bf16 v[132:135], v[228:231], v[176:179], v[132:135]
    v_mfma_f32_16x16x32_bf16 v[136:139], v[232:235], v[176:179], v[136:139]
    v_mfma_f32_16x16x32_bf16 v[140:143], v[236:239], v[176:179], v[140:143]
    ds_read_b32 v34, v32 offset:16
    buffer_load_dwordx4 v[176:179], v29, s[12:15], s49 offen offset:0 sc1
    buffer_load_dwordx4 v18, s[28:31], s21 offen offset:2048  lds
    v_mfma_f32_16x16x32_bf16 v[144:147], v[224:227], v[180:183], v[144:147]
    v_mfma_f32_16x16x32_bf16 v[148:151], v[228:231], v[180:183], v[148:151]
    v_mfma_f32_16x16x32_bf16 v[152:155], v[232:235], v[180:183], v[152:155]
    v_mfma_f32_16x16x32_bf16 v[156:159], v[236:239], v[180:183], v[156:159]
    buffer_load_dwordx4 v[180:183], v29, s[12:15], s49 offen offset:1024 sc1
    s_waitcnt lgkmcnt(0)
    v_readfirstlane_b32 s38, v34
    s_nop 1
    s_cmp_ge_u32 s38, 4
    s_cbranch_scc1 L_st0_ok
L_st0:
    ds_read_b32 v34, v32 offset:16
    s_waitcnt lgkmcnt(0)
    v_readfirstlane_b32 s38, v34
    s_nop 1
    s_cmp_ge_u32 s38, 4
    s_cbranch_scc1 L_st0_ok
    s_sub_u32 s96, s96, 1
    s_cbranch_scc1 L_st0_ok
    s_sleep 0
    s_branch L_st0
L_st0_ok:
    ds_read_b128 v[224:227], v20 offset:0
    ds_read_b128 v[228:231], v20 offset:2048
    ds_read_b128 v[232:235], v20 offset:4096
    ds_read_b128 v[236:239], v20 offset:6144
    s_waitcnt vmcnt(17)
    v_mfma_f32_16x16x32_bf16 v[128:131], v[240:243], v[184:187], v[128:131]
    v_mfma_f32_16x16x32_bf16 v[132:135], v[244:247], v[184:187], v[132:135]
    v_mfma_f32_16x16x32_bf16 v[136:139], v[248:251], v[184:187], v[136:139]
    v_mfma_f32_16x16x32_bf16 v[140:143], v[252:255], v[184:187], v[140:143]
    buffer_load_dwordx4 v[184:187], v29, s[12:15], s49 offen offset:2048 sc1
    buffer_load_dwordx4 v19, s[28:31], s21 offen offset:3072  lds
    v_mfma_f32_16x16x32_bf16 v[144:147], v[240:243], v[188:191], v[144:147]
    v_mfma_f32_16x16x32_bf16 v[148:151], v[244:247], v[188:191], v[148:151]
    v_mfma_f32_16x16x32_bf16 v[152:155], v[248:251], v[188:191], v[152:155]
    v_mfma_f32_16x16x32_bf16 v[156:159], v[252:255], v[188:191], v[156:159]
    buffer_load_dwordx4 v[188:191], v29, s[12:15], s49 offen offset:3072 sc1
    ds_read_b128 v[240:243], v21 offset:0
    ds_read_b128 v[244:247], v21 offset:2048
    ds_read_b128 v[248:251], v21 offset:4096
    ds_read_b128 v[252:255], v21 offset:6144
    s_waitcnt vmcnt(18) lgkmcnt(4)
    v_mfma_f32_16x16x32_bf16 v[128:131], v[224:227], v[192:195], v[128:131]
    v_mfma_f32_16x16x32_bf16 v[132:135], v[228:231], v[192:195], v[132:135]
    v_mfma_f32_16x16x32_bf16 v[136:139], v[232:235], v[192:195], v[136:139]
    v_mfma_f32_16x16x32_bf16 v[140:143], v[236:239], v[192:195], v[140:143]
    s_add_u32 s49, s55, 3
    s_and_b32 s49, s49, 7
    s_or_b32 s49, s49, s54
    s_lshl_b32 s49, s49, 15
    s_add_u32 s49, s49, s50
    buffer_load_dwordx4 v[192:195], v28, s[12:15], s49 offen offset:0 sc1
    s_add_u32 m0, s23, 49152
    s_add_u32 s21, s55, 4
    s_and_b32 s21, s21, 7
    s_or_b32 s21, s21, s54
    s_lshl_b32 s21, s21, 7
    buffer_load_dwordx4 v16, s[28:31], s21 offen offset:0  lds
    v_mfma_f32_16x16x32_bf16 v[144:147], v[224:227], v[196:199], v[144:147]
    v_mfma_f32_16x16x32_bf16 v[148:151], v[228:231], v[196:199], v[148:151]
    v_mfma_f32_16x16x32_bf16 v[152:155], v[232:235], v[196:199], v[152:155]
    v_mfma_f32_16x16x32_bf16 v[156:159], v[236:239], v[196:199], v[156:159]
    buffer_load_dwordx4 v[196:199], v28, s[12:15], s49 offen offset:1024 sc1
    ds_read_b128 v[224:227], v20 offset:8192
    ds_read_b128 v[228:231], v20 offset:10240
    ds_read_b128 v[232:235], v20 offset:12288
    ds_read_b128 v[236:239], v20 offset:14336
    s_waitcnt vmcnt(19) lgkmcnt(4)
    s_mov_b64 exec, 1
    ds_add_u32 v32, v33 offset:16
    s_mov_b64 exec, -1
    v_mfma_f32_16x16x32_bf16 v[128:131], v[240:243], v[200:203], v[128:131]
    v_mfma_f32_16x16x32_bf16 v[132:135], v[244:247], v[200:203], v[132:135]
    v_mfma_f32_16x16x32_bf16 v[136:139], v[248:251], v[200:203], v[136:139]
    v_mfma_f32_16x16x32_bf16 v[140:143], v[252:255], v[200:203], v[140:143]
    buffer_load_dwordx4 v[200:203], v28, s[12:15], s49 offen offset:2048 sc1
    buffer_load_dwordx4 v17, s[28:31], s21 offen offset:1024  lds
    v_mfma_f32_16x16x32_bf16 v[144:147], v[240:243], v[204:207], v[144:147]
    v_mfma_f32_16x16x32_bf16 v[148:151], v[244:247], v[204:207], v[148:151]
    v_mfma_f32_16x16x32_bf16 v[152:155], v[248:251], v[204:207], v[152:155]
    v_mfma_f32_16x16x32_bf16 v[156:159], v[252:255], v[204:207], v[156:159]
    buffer_load_dwordx4 v[204:207], v28, s[12:15], s49 offen offset:3072 sc1
    ds_read_b128 v[240:243], v21 offset:8192
    ds_read_b128 v[244:247], v21 offset:10240
    ds_read_b128 v[248:251], v21 offset:12288
    ds_read_b128 v[252:255], v21 offset:14336
    s_waitcnt vmcnt(20) lgkmcnt(4)
    v_mfma_f32_16x16x32_bf16 v[128:131], v[224:227], v[208:211], v[128:131]
    v_mfma_f32_16x16x32_bf16 v[132:135], v[228:231], v[208:211], v[132:135]
    v_mfma_f32_16x16x32_bf16 v[136:139], v[232:235], v[208:211], v[136:139]
    v_mfma_f32_16x16x32_bf16 v[140:143], v[236:239], v[208:211], v[140:143]
    ds_read_b32 v34, v32 offset:16
    buffer_load_dwordx4 v[208:211], v29, s[12:15], s49 offen offset:0 sc1
    buffer_load_dwordx4 v18, s[28:31], s21 offen offset:2048  lds
    v_mfma_f32_16x16x32_bf16 v[144:147], v[224:227], v[212:215], v[144:147]
    v_mfma_f32_16x16x32_bf16 v[148:151], v[228:231], v[212:215], v[148:151]
    v_mfma_f32_16x16x32_bf16 v[152:155], v[232:235], v[212:215], v[152:155]
    v_mfma_f32_16x16x32_bf16 v[156:159], v[236:239], v[212:215], v[156:159]
    buffer_load_dwordx4 v[212:215], v29, s[12:15], s49 offen offset:1024 sc1
    s_waitcnt lgkmcnt(0)
    v_readfirstlane_b32 s38, v34
    s_nop 1
    s_cmp_ge_u32 s38, 8
    s_cbranch_scc1 L_st1_ok
L_st1:
    ds_read_b32 v34, v32 offset:16
    s_waitcnt lgkmcnt(0)
    v_readfirstlane_b32 s38, v34
    s_nop 1
    s_cmp_ge_u32 s38, 8
    s_cbranch_scc1 L_st1_ok
    s_sub_u32 s96, s96, 1
    s_cbranch_scc1 L_st1_ok
    s_sleep 0
    s_branch L_st1
L_st1_ok:
    ds_read_b128 v[224:227], v20 offset:16384
    ds_read_b128 v[228:231], v20 offset:18432
    ds_read_b128 v[232:235], v20 offset:20480
    ds_read_b128 v[236:239], v20 offset:22528
    s_waitcnt vmcnt(21)
    v_mfma_f32_16x16x32_bf16 v[128:131], v[240:243], v[216:219], v[128:131]
    v_mfma_f32_16x16x32_bf16 v[132:135], v[244:247], v[216:219], v[132:135]
    v_mfma_f32_16x16x32_bf16 v[136:139], v[248:251], v[216:219], v[136:139]
    v_mfma_f32_16x16x32_bf16 v[140:143], v[252:255], v[216:219], v[140:143]
    buffer_load_dwordx4 v[216:219], v29, s[12:15], s49 offen offset:2048 sc1
    buffer_load_dwordx4 v19, s[28:31], s21 offen offset:3072  lds
    v_mfma_f32_16x16x32_bf16 v[144:147], v[240:243], v[220:223], v[144:147]
    v_mfma_f32_16x16x32_bf16 v[148:151], v[244:247], v[220:223], v[148:151]
    v_mfma_f32_16x16x32_bf16 v[152:155], v[248:251], v[220:223], v[152:155]
    v_mfma_f32_16x16x32_bf16 v[156:159], v[252:255], v[220:223], v[156:159]
    buffer_load_dwordx4 v[220:223], v29, s[12:15], s49 offen offset:3072 sc1
    ds_read_b128 v[240:243], v21 offset:16384
    ds_read_b128 v[244:247], v21 offset:18432
    ds_read_b128 v[248:251], v21 offset:20480
    ds_read_b128 v[252:255], v21 offset:22528
    s_waitcnt vmcnt(21) lgkmcnt(4)
    v_mfma_f32_16x16x32_bf16 v[128:131], v[224:227], v[160:163], v[128:131]
    v_mfma_f32_16x16x32_bf16 v[132:135], v[228:231], v[160:163], v[132:135]
    v_mfma_f32_16x16x32_bf16 v[136:139], v[232:235], v[160:163], v[136:139]
    v_mfma_f32_16x16x32_bf16 v[140:143], v[236:239], v[160:163], v[140:143]
    s_add_u32 s49, s55, 4
    s_and_b32 s49, s49, 7
    s_or_b32 s49, s49, s54
    s_lshl_b32 s49, s49, 15
    s_add_u32 s49, s49, s50
    buffer_load_dwordx4 v[160:163], v28, s[12:15], s49 offen offset:0 sc1
    s_add_u32 m0, s23, 81920
    s_add_u32 s21, s55, 5
    s_and_b32 s21, s21, 7
    s_or_b32 s21, s21, s54
    s_lshl_b32 s21, s21, 7
    buffer_load_dwordx4 v16, s[28:31], s21 offen offset:0  lds
    v_mfma_f32_16x16x32_bf16 v[144:147], v[224:227], v[164:167], v[144:147]
    v_mfma_f32_16x16x32_bf16 v[148:151], v[228:231], v[164:167], v[148:151]
    v_mfma_f32_16x16x32_bf16 v[152:155], v[232:235], v[164:167], v[152:155]
    v_mfma_f32_16x16x32_bf16 v[156:159], v[236:239], v[164:167], v[156:159]
    buffer_load_dwordx4 v[164:167], v28, s[12:15], s49 offen offset:1024 sc1
    ds_read_b128 v[224:227], v20 offset:24576
    ds_read_b128 v[228:231], v20 offset:26624
    ds_read_b128 v[232:235], v20 offset:28672
    ds_read_b128 v[236:239], v20 offset:30720
    s_waitcnt vmcnt(16) lgkmcnt(4)
    s_mov_b64 exec, 1
    ds_add_u32 v32, v33 offset:16
    s_mov_b64 exec, -1
    v_mfma_f32_16x16x32_bf16 v[128:131], v[240:243], v[168:171], v[128:131]
    v_mfma_f32_16x16x32_bf16 v[132:135], v[244:247], v[168:171], v[132:135]
    v_mfma_f32_16x16x32_bf16 v[136:139], v[248:251], v[168:171], v[136:139]
    v_mfma_f32_16x16x32_bf16 v[140:143], v[252:255], v[168:171], v[140:143]
    buffer_load_dwordx4 v[168:171], v28, s[12:15], s49 offen offset:2048 sc1
    buffer_load_dwordx4 v17, s[28:31], s21 offen offset:1024  lds
    v_mfma_f32_16x16x32_bf16 v[144:147], v[240:243], v[172:175], v[144:147]
    v_mfma_f32_16x16x32_bf16 v[148:151], v[244:247], v[172:175], v[148:151]
    v_mfma_f32_16x16x32_bf16 v[152:155], v[248:251], v[172:175], v[152:155]
    v_mfma_f32_16x16x32_bf16 v[156:159], v[252:255], v[172:175], v[156:159]
    buffer_load_dwordx4 v[172:175], v28, s[12:15], s49 offen offset:3072 sc1
    ds_read_b128 v[240:243], v21 offset:24576
    ds_read_b128 v[244:247], v21 offset:26624
    ds_read_b128 v[248:251], v21 offset:28672
    ds_read_b128 v[252:255], v21 offset:30720
    s_waitcnt vmcnt(21) lgkmcnt(4)
    v_mfma_f32_16x16x32_bf16 v[128:131], v[224:227], v[176:179], v[128:131]
    v_mfma_f32_16x16x32_bf16 v[132:135], v[228:231], v[176:179], v[132:135]
    v_mfma_f32_16x16x32_bf16 v[136:139], v[232:235], v[176:179], v[136:139]
    v_mfma_f32_16x16x32_bf16 v[140:143], v[236:239], v[176:179], v[140:143]
    ds_read_b32 v34, v32 offset:16
    buffer_load_dwordx4 v[176:179], v29, s[12:15], s49 offen offset:0 sc1
    buffer_load_dwordx4 v18, s[28:31], s21 offen offset:2048  lds
    v_mfma_f32_16x16x32_bf16 v[144:147], v[224:227], v[180:183], v[144:147]
    v_mfma_f32_16x16x32_bf16 v[148:151], v[228:231], v[180:183], v[148:151]
    v_mfma_f32_16x16x32_bf16 v[152:155], v[232:235], v[180:183], v[152:155]
    v_mfma_f32_16x16x32_bf16 v[156:159], v[236:239], v[180:183], v[156:159]
    buffer_load_dwordx4 v[180:183], v29, s[12:15], s49 offen offset:1024 sc1
    s_waitcnt lgkmcnt(0)
    v_readfirstlane_b32 s38, v34
    s_nop 1
    s_cmp_ge_u32 s38, 12
    s_cbranch_scc1 L_st2_ok
L_st2:
    ds_read_b32 v34, v32 offset:16
    s_waitcnt lgkmcnt(0)
    v_readfirstlane_b32 s38, v34
    s_nop 1
    s_cmp_ge_u32 s38, 12
    s_cbranch_scc1 L_st2_ok
    s_sub_u32 s96, s96, 1
    s_cbranch_scc1 L_st2_ok
    s_sleep 0
    s_branch L_st2
L_st2_ok:
    ds_read_b128 v[224:227], v20 offset:32768
    ds_read_b128 v[228:231], v20 offset:34816
    ds_read_b128 v[232:235], v20 offset:36864
    ds_read_b128 v[236:239], v20 offset:38912
    s_waitcnt vmcnt(21)
    v_mfma_f32_16x16x32_bf16 v[128:131], v[240:243], v[184:187], v[128:131]
    v_mfma_f32_16x16x32_bf16 v[132:135], v[244:247], v[184:187], v[132:135]
    v_mfma_f32_16x16x32_bf16 v[136:139], v[248:251], v[184:187], v[136:139]
    v_mfma_f32_16x16x32_bf16 v[140:143], v[252:255], v[184:187], v[140:143]
    buffer_load_dwordx4 v[184:187], v29, s[12:15], s49 offen offset:2048 sc1
    buffer_load_dwordx4 v19, s[28:31], s21 offen offset:3072  lds
    v_mfma_f32_16x16x32_bf16 v[144:147], v[240:243], v[188:191], v[144:147]
    v_mfma_f32_16x16x32_bf16 v[148:151], v[244:247], v[188:191], v[148:151]
    v_mfma_f32_16x16x32_bf16 v[152:155], v[248:251], v[188:191], v[152:155]
    v_mfma_f32_16x16x32_bf16 v[156:159], v[252:255], v[188:191], v[156:159]
    buffer_load_dwordx4 v[188:191], v29, s[12:15], s49 offen offset:3072 sc1
    ds_read_b128 v[240:243], v21 offset:32768
    ds_read_b128 v[244:247], v21 offset:34816
    ds_read_b128 v[248:251], v21 offset:36864
    ds_read_b128 v[252:255], v21 offset:38912
    s_waitcnt vmcnt(21) lgkmcnt(4)
    v_mfma_f32_16x16x32_bf16 v[128:131], v[224:227], v[192:195], v[128:131]
    v_mfma_f32_16x16x32_bf16 v[132:135], v[228:231], v[192:195], v[132:135]
    v_mfma_f32_16x16x32_bf16 v[136:139], v[232:235], v[192:195], v[136:139]
    v_mfma_f32_16x16x32_bf16 v[140:143], v[236:239], v[192:195], v[140:143]
    s_add_u32 s49, s55, 5
    s_and_b32 s49, s49, 7
    s_or_b32 s49, s49, s54
    s_lshl_b32 s49, s49, 15
    s_add_u32 s49, s49, s50
    buffer_load_dwordx4 v[192:195], v28, s[12:15], s49 offen offset:0 sc1
    s_add_u32 m0, s23, 0
    s_add_u32 s21, s55, 6
    s_and_b32 s21, s21, 7
    s_or_b32 s21, s21, s54
    s_lshl_b32 s21, s21, 7
    buffer_load_dwordx4 v16, s[28:31], s21 offen offset:0  lds
    v_mfma_f32_16x16x32_bf16 v[144:147], v[224:227], v[196:199], v[144:147]
    v_mfma_f32_16x16x32_bf16 v[148:151], v[228:231], v[196:199], v[148:151]
    v_mfma_f32_16x16x32_bf16 v[152:155], v[232:235], v[196:199], v[152:155]
    v_mfma_f32_16x16x32_bf16 v[156:159], v[236:239], v[196:199], v[156:159]
    buffer_load_dwordx4 v[196:199], v28, s[12:15], s49 offen offset:1024 sc1
    ds_read_b128 v[224:227], v20 offset:40960
    ds_read_b128 v[228:231], v20 offset:43008
    ds_read_b128 v[232:235], v20 offset:45056
    ds_read_b128 v[236:239], v20 offset:47104
    s_waitcnt vmcnt(16) lgkmcnt(4)
    s_mov_b64 exec, 1
    ds_add_u32 v32, v33 offset:16
    s_mov_b64 exec, -1
    v_mfma_f32_16x16x32_bf16 v[128:131], v[240:243], v[200:203], v[128:131]
    v_mfma_f32_16x16x32_bf16 v[132:135], v[244:247], v[200:203], v[132:135]
    v_mfma_f32_16x16x32_bf16 v[136:139], v[248:251], v[200:203], v[136:139]
    v_mfma_f32_16x16x32_bf16 v[140:143], v[252:255], v[200:203], v[140:143]
    buffer_load_dwordx4 v[200:203], v28, s[12:15], s49 offen offset:2048 sc1
    buffer_load_dwordx4 v17, s[28:31], s21 offen offset:1024  lds
    v_mfma_f32_16x16x32_bf16 v[144:147], v[240:243], v[204:207], v[144:147]
    v_mfma_f32_16x16x32_bf16 v[148:151], v[244:247], v[204:207], v[148:151]
    v_mfma_f32_16x16x32_bf16 v[152:155], v[248:251], v[204:207], v[152:155]
    v_mfma_f32_16x16x32_bf16 v[156:159], v[252:255], v[204:207], v[156:159]
    buffer_load_dwordx4 v[204:207], v28, s[12:15], s49 offen offset:3072 sc1
    ds_read_b128 v[240:243], v21 offset:40960
    ds_read_b128 v[244:247], v21 offset:43008
    ds_read_b128 v[248:251], v21 offset:45056
    ds_read_b128 v[252:255], v21 offset:47104
    s_waitcnt vmcnt(21) lgkmcnt(4)
    v_mfma_f32_16x16x32_bf16 v[128:131], v[224:227], v[208:211], v[128:131]
    v_mfma_f32_16x16x32_bf16 v[132:135], v[228:231], v[208:211], v[132:135]
    v_mfma_f32_16x16x32_bf16 v[136:139], v[232:235], v[208:211], v[136:139]
    v_mfma_f32_16x16x32_bf16 v[140:143], v[236:239], v[208:211], v[140:143]
    ds_read_b32 v34, v32 offset:16
    buffer_load_dwordx4 v[208:211], v29, s[12:15], s49 offen offset:0 sc1
    buffer_load_dwordx4 v18, s[28:31], s21 offen offset:2048  lds
    v_mfma_f32_16x16x32_bf16 v[144:147], v[224:227], v[212:215], v[144:147]
    v_mfma_f32_16x16x32_bf16 v[148:151], v[228:231], v[212:215], v[148:151]
    v_mfma_f32_16x16x32_bf16 v[152:155], v[232:235], v[212:215], v[152:155]
    v_mfma_f32_16x16x32_bf16 v[156:159], v[236:239], v[212:215], v[156:159]
    buffer_load_dwordx4 v[212:215], v29, s[12:15], s49 offen offset:1024 sc1
    s_waitcnt lgkmcnt(0)
    v_readfirstlane_b32 s38, v34
    s_nop 1
    s_cmp_ge_u32 s38, 16
    s_cbranch_scc1 L_st3_ok
L_st3:
    ds_read_b32 v34, v32 offset:16
    s_waitcnt lgkmcnt(0)
    v_readfirstlane_b32 s38, v34
    s_nop 1
    s_cmp_ge_u32 s38, 16
    s_cbranch_scc1 L_st3_ok
    s_sub_u32 s96, s96, 1
    s_cbranch_scc1 L_st3_ok
    s_sleep 0
    s_branch L_st3
L_st3_ok:
    ds_read_b128 v[224:227], v20 offset:49152
    ds_read_b128 v[228:231], v20 offset:51200
    ds_read_b128 v[232:235], v20 offset:53248
    ds_read_b128 v[236:239], v20 offset:55296
    s_waitcnt vmcnt(21)
    v_mfma_f32_16x16x32_bf16 v[128:131], v[240:243], v[216:219], v[128:131]
    v_mfma_f32_16x16x32_bf16 v[132:135], v[244:247], v[216:219], v[132:135]
    v_mfma_f32_16x16x32_bf16 v[136:139], v[248:251], v[216:219], v[136:139]
    v_mfma_f32_16x16x32_bf16 v[140:143], v[252:255], v[216:219], v[140:143]
    buffer_load_dwordx4 v[216:219], v29, s[12:15], s49 offen offset:2048 sc1
    buffer_load_dwordx4 v19, s[28:31], s21 offen offset:3072  lds
    v_mfma_f32_16x16x32_bf16 v[144:147], v[240:243], v[220:223], v[144:147]
    v_mfma_f32_16x16x32_bf16 v[148:151], v[244:247], v[220:223], v[148:151]
    v_mfma_f32_16x16x32_bf16 v[152:155], v[248:251], v[220:223], v[152:155]
    v_mfma_f32_16x16x32_bf16 v[156:159], v[252:255], v[220:223], v[156:159]
    buffer_load_dwordx4 v[220:223], v29, s[12:15], s49 offen offset:3072 sc1
    ds_read_b128 v[240:243], v21 offset:49152
    ds_read_b128 v[244:247], v21 offset:51200
    ds_read_b128 v[248:251], v21 offset:53248
    ds_read_b128 v[252:255], v21 offset:55296
    s_waitcnt vmcnt(21) lgkmcnt(4)
    v_mfma_f32_16x16x32_bf16 v[128:131], v[224:227], v[160:163], v[128:131]
    v_mfma_f32_16x16x32_bf16 v[132:135], v[228:231], v[160:163], v[132:135]
    v_mfma_f32_16x16x32_bf16 v[136:139], v[232:235], v[160:163], v[136:139]
    v_mfma_f32_16x16x32_bf16 v[140:143], v[236:239], v[160:163], v[140:143]
    s_add_u32 s49, s55, 6
    s_and_b32 s49, s49, 7
    s_or_b32 s49, s49, s54
    s_lshl_b32 s49, s49, 15
    s_add_u32 s49, s49, s50
    buffer_load_dwordx4 v[160:163], v28, s[12:15], s49 offen offset:0 sc1
    s_add_u32 m0, s23, 16384
    s_add_u32 s21, s55, 7
    s_and_b32 s21, s21, 7
    s_or_b32 s21, s21, s54
    s_lshl_b32 s21, s21, 7
    buffer_load_dwordx4 v16, s[28:31], s21 offen offset:0  lds
    v_mfma_f32_16x16x32_bf16 v[144:147], v[224:227], v[164:167], v[144:147]
    v_mfma_f32_16x16x32_bf16 v[148:151], v[228:231], v[164:167], v[148:151]
    v_mfma_f32_16x16x32_bf16 v[152:155], v[232:235], v[164:167], v[152:155]
    v_mfma_f32_16x16x32_bf16 v[156:159], v[236:239], v[164:167], v[156:159]
    buffer_load_dwordx4 v[164:167], v28, s[12:15], s49 offen offset:1024 sc1
    ds_read_b128 v[224:227], v20 offset:57344
    ds_read_b128 v[228:231], v20 offset:59392
    ds_read_b128 v[232:235], v20 offset:61440
    ds_read_b128 v[236:239], v20 offset:63488
    s_waitcnt vmcnt(16) lgkmcnt(4)
    s_mov_b64 exec, 1
    ds_add_u32 v32, v33 offset:16
    s_mov_b64 exec, -1
    v_mfma_f32_16x16x32_bf16 v[128:131], v[240:243], v[168:171], v[128:131]
    v_mfma_f32_16x16x32_bf16 v[132:135], v[244:247], v[168:171], v[132:135]
    v_mfma_f32_16x16x32_bf16 v[136:139], v[248:251], v[168:171], v[136:139]
    v_mfma_f32_16x16x32_bf16 v[140:143], v[252:255], v[168:171], v[140:143]
    buffer_load_dwordx4 v[168:171], v28, s[12:15], s49 offen offset:2048 sc1
    buffer_load_dwordx4 v17, s[28:31], s21 offen offset:1024  lds
    v_mfma_f32_16x16x32_bf16 v[144:147], v[240:243], v[172:175], v[144:147]
    v_mfma_f32_16x16x32_bf16 v[148:151], v[244:247], v[172:175], v[148:151]
    v_mfma_f32_16x16x32_bf16 v[152:155], v[248:251], v[172:175], v[152:155]
    v_mfma_f32_16x16x32_bf16 v[156:159], v[252:255], v[172:175], v[156:159]
    buffer_load_dwordx4 v[172:175], v28, s[12:15], s49 offen offset:3072 sc1
    ds_read_b128 v[240:243], v21 offset:57344
    ds_read_b128 v[244:247], v21 offset:59392
    ds_read_b128 v[248:251], v21 offset:61440
    ds_read_b128 v[252:255], v21 offset:63488
    s_waitcnt vmcnt(21) lgkmcnt(4)
    v_mfma_f32_16x16x32_bf16 v[128:131], v[224:227], v[176:179], v[128:131]
    v_mfma_f32_16x16x32_bf16 v[132:135], v[228:231], v[176:179], v[132:135]
    v_mfma_f32_16x16x32_bf16 v[136:139], v[232:235], v[176:179], v[136:139]
    v_mfma_f32_16x16x32_bf16 v[140:143], v[236:239], v[176:179], v[140:143]
    ds_read_b32 v34, v32 offset:16
    buffer_load_dwordx4 v[176:179], v29, s[12:15], s49 offen offset:0 sc1
    buffer_load_dwordx4 v18, s[28:31], s21 offen offset:2048  lds
    v_mfma_f32_16x16x32_bf16 v[144:147], v[224:227], v[180:183], v[144:147]
    v_mfma_f32_16x16x32_bf16 v[148:151], v[228:231], v[180:183], v[148:151]
    v_mfma_f32_16x16x32_bf16 v[152:155], v[232:235], v[180:183], v[152:155]
    v_mfma_f32_16x16x32_bf16 v[156:159], v[236:239], v[180:183], v[156:159]
    buffer_load_dwordx4 v[180:183], v29, s[12:15], s49 offen offset:1024 sc1
    s_waitcnt lgkmcnt(0)
    v_readfirstlane_b32 s38, v34
    s_nop 1
    s_cmp_ge_u32 s38, 20
    s_cbranch_scc1 L_st4_ok
L_st4:
    ds_read_b32 v34, v32 offset:16
    s_waitcnt lgkmcnt(0)
    v_readfirstlane_b32 s38, v34
    s_nop 1
    s_cmp_ge_u32 s38, 20
    s_cbranch_scc1 L_st4_ok
    s_sub_u32 s96, s96, 1
    s_cbranch_scc1 L_st4_ok
    s_sleep 0
    s_branch L_st4
L_st4_ok:
    ds_read_b128 v[224:227], v22 offset:16384
    ds_read_b128 v[228:231], v22 offset:18432
    ds_read_b128 v[232:235], v22 offset:20480
    ds_read_b128 v[236:239], v22 offset:22528
    s_waitcnt vmcnt(21)
    v_mfma_f32_16x16x32_bf16 v[128:131], v[240:243], v[184:187], v[128:131]
    v_mfma_f32_16x16x32_bf16 v[132:135], v[244:247], v[184:187], v[132:135]
    v_mfma_f32_16x16x32_bf16 v[136:139], v[248:251], v[184:187], v[136:139]
    v_mfma_f32_16x16x32_bf16 v[140:143], v[252:255], v[184:187], v[140:143]
    buffer_load_dwordx4 v[184:187], v29, s[12:15], s49 offen offset:2048 sc1
    buffer_load_dwordx4 v19, s[28:31], s21 offen offset:3072  lds
    v_mfma_f32_16x16x32_bf16 v[144:147], v[240:243], v[188:191], v[144:147]
    v_mfma_f32_16x16x32_bf16 v[148:151], v[244:247], v[188:191], v[148:151]
    v_mfma_f32_16x16x32_bf16 v[152:155], v[248:251], v[188:191], v[152:155]
    v_mfma_f32_16x16x32_bf16 v[156:159], v[252:255], v[188:191], v[156:159]
    buffer_load_dwordx4 v[188:191], v29, s[12:15], s49 offen offset:3072 sc1
    ds_read_b128 v[240:243], v23 offset:16384
    ds_read_b128 v[244:247], v23 offset:18432
    ds_read_b128 v[248:251], v23 offset:20480
    ds_read_b128 v[252:255], v23 offset:22528
    s_waitcnt vmcnt(21) lgkmcnt(4)
    v_mfma_f32_16x16x32_bf16 v[128:131], v[224:227], v[192:195], v[128:131]
    v_mfma_f32_16x16x32_bf16 v[132:135], v[228:231], v[192:195], v[132:135]
    v_mfma_f32_16x16x32_bf16 v[136:139], v[232:235], v[192:195], v[136:139]
    v_mfma_f32_16x16x32_bf16 v[140:143], v[236:239], v[192:195], v[140:143]
    s_add_u32 s49, s55, 7
    s_and_b32 s49, s49, 7
    s_or_b32 s49, s49, s54
    s_lshl_b32 s49, s49, 15
    s_add_u32 s49, s49, s50
    buffer_load_dwordx4 v[192:195], v28, s[12:15], s49 offen offset:0 sc1
    s_add_u32 m0, s23, 32768
    s_add_u32 s21, s55, 0
    s_and_b32 s21, s21, 7
    s_or_b32 s21, s21, s54
    s_xor_b32 s21, s21, 8
    s_lshl_b32 s21, s21, 7
    buffer_load_dwordx4 v16, s[28:31], s21 offen offset:0  lds
    v_mfma_f32_16x16x32_bf16 v[144:147], v[224:227], v[196:199], v[144:147]
    v_mfma_f32_16x16x32_bf16 v[148:151], v[228:231], v[196:199], v[148:151]
    v_mfma_f32_16x16x32_bf16 v[152:155], v[232:235], v[196:199], v[152:155]
    v_mfma_f32_16x16x32_bf16 v[156:159], v[236:239], v[196:199], v[156:159]
    buffer_load_dwordx4 v[196:199], v28, s[12:15], s49 offen offset:1024 sc1
    s_mov_b64 exec, 0xff00
    buffer_load_dword v31, v30, s[12:15], s52 offen sc1
    s_mov_b64 exec, -1
    ds_read_b128 v[224:227], v22 offset:24576
    ds_read_b128 v[228:231], v22 offset:26624
    ds_read_b128 v[232:235], v22 offset:28672
    ds_read_b128 v[236:239], v22 offset:30720
    s_waitcnt vmcnt(17) lgkmcnt(4)
    s_mov_b64 exec, 1
    ds_add_u32 v32, v33 offset:16
    s_mov_b64 exec, -1
    v_mfma_f32_16x16x32_bf16 v[128:131], v[240:243], v[200:203], v[128:131]
    v_mfma_f32_16x16x32_bf16 v[132:135], v[244:247], v[200:203], v[132:135]
    v_mfma_f32_16x16x32_bf16 v[136:139], v[248:251], v[200:203], v[136:139]
    v_mfma_f32_16x16x32_bf16 v[140:143], v[252:255], v[200:203], v[140:143]
    buffer_load_dwordx4 v[200:203], v28, s[12:15], s49 offen offset:2048 sc1
    buffer_load_dwordx4 v17, s[28:31], s21 offen offset:1024  lds
    v_mfma_f32_16x16x32_bf16 v[144:147], v[240:243], v[204:207], v[144:147]
    v_mfma_f32_16x16x32_bf16 v[148:151], v[244:247], v[204:207], v[148:151]
    v_mfma_f32_16x16x32_bf16 v[152:155], v[248:251], v[204:207], v[152:155]
    v_mfma_f32_16x16x32_bf16 v[156:159], v[252:255], v[204:207], v[156:159]
    buffer_load_dwordx4 v[204:207], v28, s[12:15], s49 offen offset:3072 sc1
    ds_read_b128 v[240:243], v23 offset:24576
    ds_read_b128 v[244:247], v23 offset:26624
    ds_read_b128 v[248:251], v23 offset:28672
    ds_read_b128 v[252:255], v23 offset:30720
    s_waitcnt vmcnt(22) lgkmcnt(4)
    v_mfma_f32_16x16x32_bf16 v[128:131], v[224:227], v[208:211], v[128:131]
    v_mfma_f32_16x16x32_bf16 v[132:135], v[228:231], v[208:211], v[132:135]
    v_mfma_f32_16x16x32_bf16 v[136:139], v[232:235], v[208:211], v[136:139]
    v_mfma_f32_16x16x32_bf16 v[140:143], v[236:239], v[208:211], v[140:143]
    ds_read_b32 v34, v32 offset:16
    buffer_load_dwordx4 v[208:211], v29, s[12:15], s49 offen offset:0 sc1
    buffer_load_dwordx4 v18, s[28:31], s21 offen offset:2048  lds
    v_mfma_f32_16x16x32_bf16 v[144:147], v[224:227], v[212:215], v[144:147]
    v_mfma_f32_16x16x32_bf16 v[148:151], v[228:231], v[212:215], v[148:151]
    v_mfma_f32_16x16x32_bf16 v[152:155], v[232:235], v[212:215], v[152:155]
    v_mfma_f32_16x16x32_bf16 v[156:159], v[236:239], v[212:215], v[156:159]
    buffer_load_dwordx4 v[212:215], v29, s[12:15], s49 offen offset:1024 sc1
    s_waitcnt lgkmcnt(0)
    v_readfirstlane_b32 s38, v34
    s_nop 1
    s_cmp_ge_u32 s38, 24
    s_cbranch_scc1 L_st5_ok
L_st5:
    ds_read_b32 v34, v32 offset:16
    s_waitcnt lgkmcnt(0)
    v_readfirstlane_b32 s38, v34
    s_nop 1
    s_cmp_ge_u32 s38, 24
    s_cbranch_scc1 L_st5_ok
    s_sub_u32 s96, s96, 1
    s_cbranch_scc1 L_st5_ok
    s_sleep 0
    s_branch L_st5
L_st5_ok:
    ds_read_b128 v[224:227], v20 offset:0
    ds_read_b128 v[228:231], v20 offset:2048
    ds_read_b128 v[232:235], v20 offset:4096
    ds_read_b128 v[236:239], v20 offset:6144
    s_waitcnt vmcnt(22)
    v_mfma_f32_16x16x32_bf16 v[128:131], v[240:243], v[216:219], v[128:131]
    v_mfma_f32_16x16x32_bf16 v[132:135], v[244:247], v[216:219], v[132:135]
    v_mfma_f32_16x16x32_bf16 v[136:139], v[248:251], v[216:219], v[136:139]
    v_mfma_f32_16x16x32_bf16 v[140:143], v[252:255], v[216:219], v[140:143]
    buffer_load_dwordx4 v[216:219], v29, s[12:15], s49 offen offset:2048 sc1
    buffer_load_dwordx4 v19, s[28:31], s21 offen offset:3072  lds
    v_mfma_f32_16x16x32_bf16 v[144:147], v[240:243], v[220:223], v[144:147]
    v_mfma_f32_16x16x32_bf16 v[148:151], v[244:247], v[220:223], v[148:151]
    v_mfma_f32_16x16x32_bf16 v[152:155], v[248:251], v[220:223], v[152:155]
    v_mfma_f32_16x16x32_bf16 v[156:159], v[252:255], v[220:223], v[156:159]
    buffer_load_dwordx4 v[220:223], v29, s[12:15], s49 offen offset:3072 sc1
    s_waitcnt vmcnt(9)
L_h2poll:
    v_cmp_ne_u32 vcc, s93, v31
    s_nop 1
    s_and_b32 s38, vcc_lo, 0xff00
    s_cbranch_scc0 L_h2go
    s_sub_u32 s96, s96, 1
    s_cbranch_scc1 L_h2go
    s_sleep 2
    s_mov_b64 exec, 0xff00
    buffer_load_dword v31, v30, s[12:15], s52 offen sc1
    s_mov_b64 exec, -1
    s_waitcnt vmcnt(0)
    s_branch L_h2poll
L_h2go:
    ds_read_b128 v[240:243], v21 offset:0
    ds_read_b128 v[244:247], v21 offset:2048
    ds_read_b128 v[248:251], v21 offset:4096
    ds_read_b128 v[252:255], v21 offset:6144
    s_waitcnt vmcnt(22) lgkmcnt(4)
    v_mfma_f32_16x16x32_bf16 v[128:131], v[224:227], v[160:163], v[128:131]
    v_mfma_f32_16x16x32_bf16 v[132:135], v[228:231], v[160:163], v[132:135]
    v_mfma_f32_16x16x32_bf16 v[136:139], v[232:235], v[160:163], v[136:139]
    v_mfma_f32_16x16x32_bf16 v[140:143], v[236:239], v[160:163], v[140:143]
    s_add_u32 s49, s55, 0
    s_and_b32 s49, s49, 7
    s_or_b32 s49, s49, s54
    s_xor_b32 s49, s49, 8
    s_lshl_b32 s49, s49, 15
    s_add_u32 s49, s49, s50
    buffer_load_dwordx4 v[160:163], v28, s[12:15], s49 offen offset:0 sc1
    s_add_u32 m0, s23, 49152
    s_add_u32 s21, s55, 1
    s_and_b32 s21, s21, 7
    s_or_b32 s21, s21, s54
    s_xor_b32 s21, s21, 8
    s_lshl_b32 s21, s21, 7
    buffer_load_dwordx4 v16, s[28:31], s21 offen offset:0  lds
    v_mfma_f32_16x16x32_bf16 v[144:147], v[224:227], v[164:167], v[144:147]
    v_mfma_f32_16x16x32_bf16 v[148:151], v[228:231], v[164:167], v[148:151]
    v_mfma_f32_16x16x32_bf16 v[152:155], v[232:235], v[164:167], v[152:155]
    v_mfma_f32_16x16x32_bf16 v[156:159], v[236:239], v[164:167], v[156:159]
    buffer_load_dwordx4 v[164:167], v28, s[12:15], s49 offen offset:1024 sc1
    ds_read_b128 v[224:227], v20 offset:8192
    ds_read_b128 v[228:231], v20 offset:10240
    ds_read_b128 v[232:235], v20 offset:12288
    ds_read_b128 v[236:239], v20 offset:14336
    s_waitcnt vmcnt(17) lgkmcnt(4)
    s_mov_b64 exec, 1
    ds_add_u32 v32, v33 offset:16
    s_mov_b64 exec, -1
    v_mfma_f32_16x16x32_bf16 v[128:131], v[240:243], v[168:171], v[128:131]
    v_mfma_f32_16x16x32_bf16 v[132:135], v[244:247], v[168:171], v[132:135]
    v_mfma_f32_16x16x32_bf16 v[136:139], v[248:251], v[168:171], v[136:139]
    v_mfma_f32_16x16x32_bf16 v[140:143], v[252:255], v[168:171], v[140:143]
    buffer_load_dwordx4 v[168:171], v28, s[12:15], s49 offen offset:2048 sc1
    buffer_load_dwordx4 v17, s[28:31], s21 offen offset:1024  lds
    v_mfma_f32_16x16x32_bf16 v[144:147], v[240:243], v[172:175], v[144:147]
    v_mfma_f32_16x16x32_bf16 v[148:151], v[244:247], v[172:175], v[148:151]
    v_mfma_f32_16x16x32_bf16 v[152:155], v[248:251], v[172:175], v[152:155]
    v_mfma_f32_16x16x32_bf16 v[156:159], v[252:255], v[172:175], v[156:159]
    buffer_load_dwordx4 v[172:175], v28, s[12:15], s49 offen offset:3072 sc1
    ds_read_b128 v[240:243], v21 offset:8192
    ds_read_b128 v[244:247], v21 offset:10240
    ds_read_b128 v[248:251], v21 offset:12288
    ds_read_b128 v[252:255], v21 offset:14336
    s_waitcnt vmcnt(22) lgkmcnt(4)
    v_mfma_f32_16x16x32_bf16 v[128:131], v[224:227], v[176:179], v[128:131]
    v_mfma_f32_16x16x32_bf16 v[132:135], v[228:231], v[176:179], v[132:135]
    v_mfma_f32_16x16x32_bf16 v[136:139], v[232:235], v[176:179], v[136:139]
    v_mfma_f32_16x16x32_bf16 v[140:143], v[236:239], v[176:179], v[140:143]
    ds_read_b32 v34, v32 offset:16
    buffer_load_dwordx4 v[176:179], v29, s[12:15], s49 offen offset:0 sc1
    buffer_load_dwordx4 v18, s[28:31], s21 offen offset:2048  lds
    v_mfma_f32_16x16x32_bf16 v[144:147], v[224:227], v[180:183], v[144:147]
    v_mfma_f32_16x16x32_bf16 v[148:151], v[228:231], v[180:183], v[148:151]
    v_mfma_f32_16x16x32_bf16 v[152:155], v[232:235], v[180:183], v[152:155]
    v_mfma_f32_16x16x32_bf16 v[156:159], v[236:239], v[180:183], v[156:159]
    buffer_load_dwordx4 v[180:183], v29, s[12:15], s49 offen offset:1024 sc1
    s_waitcnt lgkmcnt(0)
    v_readfirstlane_b32 s38, v34
    s_nop 1
    s_cmp_ge_u32 s38, 28
    s_cbranch_scc1 L_st6_ok
L_st6:
    ds_read_b32 v34, v32 offset:16
    s_waitcnt lgkmcnt(0)
    v_readfirstlane_b32 s38, v34
    s_nop 1
    s_cmp_ge_u32 s38, 28
    s_cbranch_scc1 L_st6_ok
    s_sub_u32 s96, s96, 1
    s_cbranch_scc1 L_st6_ok
    s_sleep 0
    s_branch L_st6
L_st6_ok:
    ds_read_b128 v[224:227], v20 offset:16384
    ds_read_b128 v[228:231], v20 offset:18432
    ds_read_b128 v[232:235], v20 offset:20480
    ds_read_b128 v[236:239], v20 offset:22528
    s_waitcnt vmcnt(22)
    v_mfma_f32_16x16x32_bf16 v[128:131], v[240:243], v[184:187], v[128:131]
    v_mfma_f32_16x16x32_bf16 v[132:135], v[244:247], v[184:187], v[132:135]
    v_mfma_f32_16x16x32_bf16 v[136:139], v[248:251], v[184:187], v[136:139]
    v_mfma_f32_16x16x32_bf16 v[140:143], v[252:255], v[184:187], v[140:143]
    buffer_load_dwordx4 v[184:187], v29, s[12:15], s49 offen offset:2048 sc1
    buffer_load_dwordx4 v19, s[28:31], s21 offen offset:3072  lds
    v_mfma_f32_16x16x32_bf16 v[144:147], v[240:243], v[188:191], v[144:147]
    v_mfma_f32_16x16x32_bf16 v[148:151], v[244:247], v[188:191], v[148:151]
    v_mfma_f32_16x16x32_bf16 v[152:155], v[248:251], v[188:191], v[152:155]
    v_mfma_f32_16x16x32_bf16 v[156:159], v[252:255], v[188:191], v[156:159]
    buffer_load_dwordx4 v[188:191], v29, s[12:15], s49 offen offset:3072 sc1
    ds_read_b128 v[240:243], v21 offset:16384
    ds_read_b128 v[244:247], v21 offset:18432
    ds_read_b128 v[248:251], v21 offset:20480
    ds_read_b128 v[252:255], v21 offset:22528
    s_waitcnt vmcnt(22) lgkmcnt(4)
    v_mfma_f32_16x16x32_bf16 v[128:131], v[224:227], v[192:195], v[128:131]
    v_mfma_f32_16x16x32_bf16 v[132:135], v[228:231], v[192:195], v[132:135]
    v_mfma_f32_16x16x32_bf16 v[136:139], v[232:235], v[192:195], v[136:139]
    v_mfma_f32_16x16x32_bf16 v[140:143], v[236:239], v[192:195], v[140:143]
    s_add_u32 s49, s55, 1
    s_and_b32 s49, s49, 7
    s_or_b32 s49, s49, s54
    s_xor_b32 s49, s49, 8
    s_lshl_b32 s49, s49, 15
    s_add_u32 s49, s49, s50
    buffer_load_dwordx4 v[192:195], v28, s[12:15], s49 offen offset:0 sc1
    s_add_u32 m0, s23, 81920
    s_add_u32 s21, s55, 2
    s_and_b32 s21, s21, 7
    s_or_b32 s21, s21, s54
    s_xor_b32 s21, s21, 8
    s_lshl_b32 s21, s21, 7
    buffer_load_dwordx4 v16, s[28:31], s21 offen offset:0  lds
    v_mfma_f32_16x16x32_bf16 v[144:147], v[224:227], v[196:199], v[144:147]
    v_mfma_f32_16x16x32_bf16 v[148:151], v[228:231], v[196:199], v[148:151]
    v_mfma_f32_16x16x32_bf16 v[152:155], v[232:235], v[196:199], v[152:155]
    v_mfma_f32_16x16x32_bf16 v[156:159], v[236:239], v[196:199], v[156:159]
    buffer_load_dwordx4 v[196:199], v28, s[12:15], s49 offen offset:1024 sc1
    ds_read_b128 v[224:227], v20 offset:24576
    ds_read_b128 v[228:231], v20 offset:26624
    ds_read_b128 v[232:235], v20 offset:28672
    ds_read_b128 v[236:239], v20 offset:30720
    s_waitcnt vmcnt(16) lgkmcnt(4)
    s_mov_b64 exec, 1
    ds_add_u32 v32, v33 offset:16
    s_mov_b64 exec, -1
    v_mfma_f32_16x16x32_bf16 v[128:131], v[240:243], v[200:203], v[128:131]
    v_mfma_f32_16x16x32_bf16 v[132:135], v[244:247], v[200:203], v[132:135]
    v_mfma_f32_16x16x32_bf16 v[136:139], v[248:251], v[200:203], v[136:139]
    v_mfma_f32_16x16x32_bf16 v[140:143], v[252:255], v[200:203], v[140:143]
    buffer_load_dwordx4 v[200:203], v28, s[12:15], s49 offen offset:2048 sc1
    buffer_load_dwordx4 v17, s[28:31], s21 offen offset:1024  lds
    v_mfma_f32_16x16x32_bf16 v[144:147], v[240:243], v[204:207], v[144:147]
    v_mfma_f32_16x16x32_bf16 v[148:151], v[244:247], v[204:207], v[148:151]
    v_mfma_f32_16x16x32_bf16 v[152:155], v[248:251], v[204:207], v[152:155]
    v_mfma_f32_16x16x32_bf16 v[156:159], v[252:255], v[204:207], v[156:159]
    buffer_load_dwordx4 v[204:207], v28, s[12:15], s49 offen offset:3072 sc1
    ds_read_b128 v[240:243], v21 offset:24576
    ds_read_b128 v[244:247], v21 offset:26624
    ds_read_b128 v[248:251], v21 offset:28672
    ds_read_b128 v[252:255], v21 offset:30720
    s_waitcnt vmcnt(21) lgkmcnt(4)
    v_mfma_f32_16x16x32_bf16 v[128:131], v[224:227], v[208:211], v[128:131]
    v_mfma_f32_16x16x32_bf16 v[132:135], v[228:231], v[208:211], v[132:135]
    v_mfma_f32_16x16x32_bf16 v[136:139], v[232:235], v[208:211], v[136:139]
    v_mfma_f32_16x16x32_bf16 v[140:143], v[236:239], v[208:211], v[140:143]
    ds_read_b32 v34, v32 offset:16
    buffer_load_dwordx4 v[208:211], v29, s[12:15], s49 offen offset:0 sc1
    buffer_load_dwordx4 v18, s[28:31], s21 offen offset:2048  lds
    v_mfma_f32_16x16x32_bf16 v[144:147], v[224:227], v[212:215], v[144:147]
    v_mfma_f32_16x16x32_bf16 v[148:151], v[228:231], v[212:215], v[148:151]
    v_mfma_f32_16x16x32_bf16 v[152:155], v[232:235], v[212:215], v[152:155]
    v_mfma_f32_16x16x32_bf16 v[156:159], v[236:239], v[212:215], v[156:159]
    buffer_load_dwordx4 v[212:215], v29, s[12:15], s49 offen offset:1024 sc1
    s_waitcnt lgkmcnt(0)
    v_readfirstlane_b32 s38, v34
    s_nop 1
    s_cmp_ge_u32 s38, 32
    s_cbranch_scc1 L_st7_ok
L_st7:
    ds_read_b32 v34, v32 offset:16
    s_waitcnt lgkmcnt(0)
    v_readfirstlane_b32 s38, v34
    s_nop 1
    s_cmp_ge_u32 s38, 32
    s_cbranch_scc1 L_st7_ok
    s_sub_u32 s96, s96, 1
    s_cbranch_scc1 L_st7_ok
    s_sleep 0
    s_branch L_st7
L_st7_ok:
    ds_read_b128 v[224:227], v20 offset:32768
    ds_read_b128 v[228:231], v20 offset:34816
    ds_read_b128 v[232:235], v20 offset:36864
    ds_read_b128 v[236:239], v20 offset:38912
    s_waitcnt vmcnt(21)
    v_mfma_f32_16x16x32_bf16 v[128:131], v[240:243], v[216:219], v[128:131]
    v_mfma_f32_16x16x32_bf16 v[132:135], v[244:247], v[216:219], v[132:135]
    v_mfma_f32_16x16x32_bf16 v[136:139], v[248:251], v[216:219], v[136:139]
    v_mfma_f32_16x16x32_bf16 v[140:143], v[252:255], v[216:219], v[140:143]
    buffer_load_dwordx4 v[216:219], v29, s[12:15], s49 offen offset:2048 sc1
    buffer_load_dwordx4 v19, s[28:31], s21 offen offset:3072  lds
    v_mfma_f32_16x16x32_bf16 v[144:147], v[240:243], v[220:223], v[144:147]
    v_mfma_f32_16x16x32_bf16 v[148:151], v[244:247], v[220:223], v[148:151]
    v_mfma_f32_16x16x32_bf16 v[152:155], v[248:251], v[220:223], v[152:155]
    v_mfma_f32_16x16x32_bf16 v[156:159], v[252:255], v[220:223], v[156:159]
    buffer_load_dwordx4 v[220:223], v29, s[12:15], s49 offen offset:3072 sc1
    ds_read_b128 v[240:243], v21 offset:32768
    ds_read_b128 v[244:247], v21 offset:34816
    ds_read_b128 v[248:251], v21 offset:36864
    ds_read_b128 v[252:255], v21 offset:38912
    s_waitcnt vmcnt(21) lgkmcnt(4)
    v_mfma_f32_16x16x32_bf16 v[128:131], v[224:227], v[160:163], v[128:131]
    v_mfma_f32_16x16x32_bf16 v[132:135], v[228:231], v[160:163], v[132:135]
    v_mfma_f32_16x16x32_bf16 v[136:139], v[232:235], v[160:163], v[136:139]
    v_mfma_f32_16x16x32_bf16 v[140:143], v[236:239], v[160:163], v[140:143]
    s_add_u32 s49, s55, 2
    s_and_b32 s49, s49, 7
    s_or_b32 s49, s49, s54
    s_xor_b32 s49, s49, 8
    s_lshl_b32 s49, s49, 15
    s_add_u32 s49, s49, s50
    buffer_load_dwordx4 v[160:163], v28, s[12:15], s49 offen offset:0 sc1
    s_add_u32 m0, s23, 0
    s_add_u32 s21, s55, 3
    s_and_b32 s21, s21, 7
    s_or_b32 s21, s21, s54
    s_xor_b32 s21, s21, 8
    s_lshl_b32 s21, s21, 7
    buffer_load_dwordx4 v16, s[28:31], s21 offen offset:0  lds
    v_mfma_f32_16x16x32_bf16 v[144:147], v[224:227], v[164:167], v[144:147]
    v_mfma_f32_16x16x32_bf16 v[148:151], v[228:231], v[164:167], v[148:151]
    v_mfma_f32_16x16x32_bf16 v[152:155], v[232:235], v[164:167], v[152:155]
    v_mfma_f32_16x16x32_bf16 v[156:159], v[236:239], v[164:167], v[156:159]
    buffer_load_dwordx4 v[164:167], v28, s[12:15], s49 offen offset:1024 sc1
    ds_read_b128 v[224:227], v20 offset:40960
    ds_read_b128 v[228:231], v20 offset:43008
    ds_read_b128 v[232:235], v20 offset:45056
    ds_read_b128 v[236:239], v20 offset:47104
    s_waitcnt vmcnt(16) lgkmcnt(4)
    s_mov_b64 exec, 1
    ds_add_u32 v32, v33 offset:16
    s_mov_b64 exec, -1
    v_mfma_f32_16x16x32_bf16 v[128:131], v[240:243], v[168:171], v[128:131]
    v_mfma_f32_16x16x32_bf16 v[132:135], v[244:247], v[168:171], v[132:135]
    v_mfma_f32_16x16x32_bf16 v[136:139], v[248:251], v[168:171], v[136:139]
    v_mfma_f32_16x16x32_bf16 v[140:143], v[252:255], v[168:171], v[140:143]
    buffer_load_dwordx4 v[168:171], v28, s[12:15], s49 offen offset:2048 sc1
    buffer_load_dwordx4 v17, s[28:31], s21 offen offset:1024  lds
    v_mfma_f32_16x16x32_bf16 v[144:147], v[240:243], v[172:175], v[144:147]
    v_mfma_f32_16x16x32_bf16 v[148:151], v[244:247], v[172:175], v[148:151]
    v_mfma_f32_16x16x32_bf16 v[152:155], v[248:251], v[172:175], v[152:155]
    v_mfma_f32_16x16x32_bf16 v[156:159], v[252:255], v[172:175], v[156:159]
    buffer_load_dwordx4 v[172:175], v28, s[12:15], s49 offen offset:3072 sc1
    ds_read_b128 v[240:243], v21 offset:40960
    ds_read_b128 v[244:247], v21 offset:43008
    ds_read_b128 v[248:251], v21 offset:45056
    ds_read_b128 v[252:255], v21 offset:47104
    s_waitcnt vmcnt(21) lgkmcnt(4)
    v_mfma_f32_16x16x32_bf16 v[128:131], v[224:227], v[176:179], v[128:131]
    v_mfma_f32_16x16x32_bf16 v[132:135], v[228:231], v[176:179], v[132:135]
    v_mfma_f32_16x16x32_bf16 v[136:139], v[232:235], v[176:179], v[136:139]
    v_mfma_f32_16x16x32_bf16 v[140:143], v[236:239], v[176:179], v[140:143]
    ds_read_b32 v34, v32 offset:16
    buffer_load_dwordx4 v[176:179], v29, s[12:15], s49 offen offset:0 sc1
    buffer_load_dwordx4 v18, s[28:31], s21 offen offset:2048  lds
    v_mfma_f32_16x16x32_bf16 v[144:147], v[224:227], v[180:183], v[144:147]
    v_mfma_f32_16x16x32_bf16 v[148:151], v[228:231], v[180:183], v[148:151]
    v_mfma_f32_16x16x32_bf16 v[152:155], v[232:235], v[180:183], v[152:155]
    v_mfma_f32_16x16x32_bf16 v[156:159], v[236:239], v[180:183], v[156:159]
    buffer_load_dwordx4 v[180:183], v29, s[12:15], s49 offen offset:1024 sc1
    s_waitcnt lgkmcnt(0)
    v_readfirstlane_b32 s38, v34
    s_nop 1
    s_cmp_ge_u32 s38, 36
    s_cbranch_scc1 L_st8_ok
L_st8:
    ds_read_b32 v34, v32 offset:16
    s_waitcnt lgkmcnt(0)
    v_readfirstlane_b32 s38, v34
    s_nop 1
    s_cmp_ge_u32 s38, 36
    s_cbranch_scc1 L_st8_ok
    s_sub_u32 s96, s96, 1
    s_cbranch_scc1 L_st8_ok
    s_sleep 0
    s_branch L_st8
L_st8_ok:
    ds_read_b128 v[224:227], v20 offset:49152
    ds_read_b128 v[228:231], v20 offset:51200
    ds_read_b128 v[232:235], v20 offset:53248
    ds_read_b128 v[236:239], v20 offset:55296
    s_waitcnt vmcnt(21)
    v_mfma_f32_16x16x32_bf16 v[128:131], v[240:243], v[184:187], v[128:131]
    v_mfma_f32_16x16x32_bf16 v[132:135], v[244:247], v[184:187], v[132:135]
    v_mfma_f32_16x16x32_bf16 v[136:139], v[248:251], v[184:187], v[136:139]
    v_mfma_f32_16x16x32_bf16 v[140:143], v[252:255], v[184:187], v[140:143]
    buffer_load_dwordx4 v[184:187], v29, s[12:15], s49 offen offset:2048 sc1
    buffer_load_dwordx4 v19, s[28:31], s21 offen offset:3072  lds
    v_mfma_f32_16x16x32_bf16 v[144:147], v[240:243], v[188:191], v[144:147]
    v_mfma_f32_16x16x32_bf16 v[148:151], v[244:247], v[188:191], v[148:151]
    v_mfma_f32_16x16x32_bf16 v[152:155], v[248:251], v[188:191], v[152:155]
    v_mfma_f32_16x16x32_bf16 v[156:159], v[252:255], v[188:191], v[156:159]
    buffer_load_dwordx4 v[188:191], v29, s[12:15], s49 offen offset:3072 sc1
    ds_read_b128 v[240:243], v21 offset:49152
    ds_read_b128 v[244:247], v21 offset:51200
    ds_read_b128 v[248:251], v21 offset:53248
    ds_read_b128 v[252:255], v21 offset:55296
    s_waitcnt vmcnt(21) lgkmcnt(4)
    v_mfma_f32_16x16x32_bf16 v[128:131], v[224:227], v[192:195], v[128:131]
    v_mfma_f32_16x16x32_bf16 v[132:135], v[228:231], v[192:195], v[132:135]
    v_mfma_f32_16x16x32_bf16 v[136:139], v[232:235], v[192:195], v[136:139]
    v_mfma_f32_16x16x32_bf16 v[140:143], v[236:239], v[192:195], v[140:143]
    s_add_u32 s49, s55, 3
    s_and_b32 s49, s49, 7
    s_or_b32 s49, s49, s54
    s_xor_b32 s49, s49, 8
    s_lshl_b32 s49, s49, 15
    s_add_u32 s49, s49, s50
    buffer_load_dwordx4 v[192:195], v28, s[12:15], s49 offen offset:0 sc1
    s_add_u32 m0, s23, 16384
    s_add_u32 s21, s55, 4
    s_and_b32 s21, s21, 7
    s_or_b32 s21, s21, s54
    s_xor_b32 s21, s21, 8
    s_lshl_b32 s21, s21, 7
    buffer_load_dwordx4 v16, s[28:31], s21 offen offset:0  lds
    v_mfma_f32_16x16x32_bf16 v[144:147], v[224:227], v[196:199], v[144:147]
    v_mfma_f32_16x16x32_bf16 v[148:151], v[228:231], v[196:199], v[148:151]
    v_mfma_f32_16x16x32_bf16 v[152:155], v[232:235], v[196:199], v[152:155]
    v_mfma_f32_16x16x32_bf16 v[156:159], v[236:239], v[196:199], v[156:159]
    buffer_load_dwordx4 v[196:199], v28, s[12:15], s49 offen offset:1024 sc1
    ds_read_b128 v[224:227], v20 offset:57344
    ds_read_b128 v[228:231], v20 offset:59392
    ds_read_b128 v[232:235], v20 offset:61440
    ds_read_b128 v[236:239], v20 offset:63488
    s_waitcnt vmcnt(16) lgkmcnt(4)
    s_mov_b64 exec, 1
    ds_add_u32 v32, v33 offset:16
    s_mov_b64 exec, -1
    v_mfma_f32_16x16x32_bf16 v[128:131], v[240:243], v[200:203], v[128:131]
    v_mfma_f32_16x16x32_bf16 v[132:135], v[244:247], v[200:203], v[132:135]
    v_mfma_f32_16x16x32_bf16 v[136:139], v[248:251], v[200:203], v[136:139]
    v_mfma_f32_16x16x32_bf16 v[140:143], v[252:255], v[200:203], v[140:143]
    buffer_load_dwordx4 v[200:203], v28, s[12:15], s49 offen offset:2048 sc1
    buffer_load_dwordx4 v17, s[28:31], s21 offen offset:1024  lds
    v_mfma_f32_16x16x32_bf16 v[144:147], v[240:243], v[204:207], v[144:147]
    v_mfma_f32_16x16x32_bf16 v[148:151], v[244:247], v[204:207], v[148:151]
    v_mfma_f32_16x16x32_bf16 v[152:155], v[248:251], v[204:207], v[152:155]
    v_mfma_f32_16x16x32_bf16 v[156:159], v[252:255], v[204:207], v[156:159]
    buffer_load_dwordx4 v[204:207], v28, s[12:15], s49 offen offset:3072 sc1
    ds_read_b128 v[240:243], v21 offset:57344
    ds_read_b128 v[244:247], v21 offset:59392
    ds_read_b128 v[248:251], v21 offset:61440
    ds_read_b128 v[252:255], v21 offset:63488
    s_waitcnt vmcnt(21) lgkmcnt(4)
    v_mfma_f32_16x16x32_bf16 v[128:131], v[224:227], v[208:211], v[128:131]
    v_mfma_f32_16x16x32_bf16 v[132:135], v[228:231], v[208:211], v[132:135]
    v_mfma_f32_16x16x32_bf16 v[136:139], v[232:235], v[208:211], v[136:139]
    v_mfma_f32_16x16x32_bf16 v[140:143], v[236:239], v[208:211], v[140:143]
    ds_read_b32 v34, v32 offset:16
    buffer_load_dwordx4 v[208:211], v29, s[12:15], s49 offen offset:0 sc1
    buffer_load_dwordx4 v18, s[28:31], s21 offen offset:2048  lds
    v_mfma_f32_16x16x32_bf16 v[144:147], v[224:227], v[212:215], v[144:147]
    v_mfma_f32_16x16x32_bf16 v[148:151], v[228:231], v[212:215], v[148:151]
    v_mfma_f32_16x16x32_bf16 v[152:155], v[232:235], v[212:215], v[152:155]
    v_mfma_f32_16x16x32_bf16 v[156:159], v[236:239], v[212:215], v[156:159]
    buffer_load_dwordx4 v[212:215], v29, s[12:15], s49 offen offset:1024 sc1
    s_waitcnt lgkmcnt(0)
    v_readfirstlane_b32 s38, v34
    s_nop 1
    s_cmp_ge_u32 s38, 40
    s_cbranch_scc1 L_st9_ok
L_st9:
    ds_read_b32 v34, v32 offset:16
    s_waitcnt lgkmcnt(0)
    v_readfirstlane_b32 s38, v34
    s_nop 1
    s_cmp_ge_u32 s38, 40
    s_cbranch_scc1 L_st9_ok
    s_sub_u32 s96, s96, 1
    s_cbranch_scc1 L_st9_ok
    s_sleep 0
    s_branch L_st9
L_st9_ok:
    ds_read_b128 v[224:227], v22 offset:16384
    ds_read_b128 v[228:231], v22 offset:18432
    ds_read_b128 v[232:235], v22 offset:20480
    ds_read_b128 v[236:239], v22 offset:22528
    s_waitcnt vmcnt(21)
    v_mfma_f32_16x16x32_bf16 v[128:131], v[240:243], v[216:219], v[128:131]
    v_mfma_f32_16x16x32_bf16 v[132:135], v[244:247], v[216:219], v[132:135]
    v_mfma_f32_16x16x32_bf16 v[136:139], v[248:251], v[216:219], v[136:139]
    v_mfma_f32_16x16x32_bf16 v[140:143], v[252:255], v[216:219], v[140:143]
    buffer_load_dwordx4 v[216:219], v29, s[12:15], s49 offen offset:2048 sc1
    buffer_load_dwordx4 v19, s[28:31], s21 offen offset:3072  lds
    v_mfma_f32_16x16x32_bf16 v[144:147], v[240:243], v[220:223], v[144:147]
    v_mfma_f32_16x16x32_bf16 v[148:151], v[244:247], v[220:223], v[148:151]
    v_mfma_f32_16x16x32_bf16 v[152:155], v[248:251], v[220:223], v[152:155]
    v_mfma_f32_16x16x32_bf16 v[156:159], v[252:255], v[220:223], v[156:159]
    buffer_load_dwordx4 v[220:223], v29, s[12:15], s49 offen offset:3072 sc1
    ds_read_b128 v[240:243], v23 offset:16384
    ds_read_b128 v[244:247], v23 offset:18432
    ds_read_b128 v[248:251], v23 offset:20480
    ds_read_b128 v[252:255], v23 offset:22528
    s_waitcnt vmcnt(21) lgkmcnt(4)
    v_mfma_f32_16x16x32_bf16 v[128:131], v[224:227], v[160:163], v[128:131]
    v_mfma_f32_16x16x32_bf16 v[132:135], v[228:231], v[160:163], v[132:135]
    v_mfma_f32_16x16x32_bf16 v[136:139], v[232:235], v[160:163], v[136:139]
    v_mfma_f32_16x16x32_bf16 v[140:143], v[236:239], v[160:163], v[140:143]
    s_add_u32 s49, s55, 4
    s_and_b32 s49, s49, 7
    s_or_b32 s49, s49, s54
    s_xor_b32 s49, s49, 8
    s_lshl_b32 s49, s49, 15
    s_add_u32 s49, s49, s50
    buffer_load_dwordx4 v[160:163], v28, s[12:15], s49 offen offset:0 sc1
    s_add_u32 m0, s23, 32768
    s_add_u32 s21, s55, 5
    s_and_b32 s21, s21, 7
    s_or_b32 s21, s21, s54
    s_xor_b32 s21, s21, 8
    s_lshl_b32 s21, s21, 7
    buffer_load_dwordx4 v16, s[28:31], s21 offen offset:0  lds
    v_mfma_f32_16x16x32_bf16 v[144:147], v[224:227], v[164:167], v[144:147]
    v_mfma_f32_16x16x32_bf16 v[148:151], v[228:231], v[164:167], v[148:151]
    v_mfma_f32_16x16x32_bf16 v[152:155], v[232:235], v[164:167], v[152:155]
    v_mfma_f32_16x16x32_bf16 v[156:159], v[236:239], v[164:167], v[156:159]
    buffer_load_dwordx4 v[164:167], v28, s[12:15], s49 offen offset:1024 sc1
    ds_read_b128 v[224:227], v22 offset:24576
    ds_read_b128 v[228:231], v22 offset:26624
    ds_read_b128 v[232:235], v22 offset:28672
    ds_read_b128 v[236:239], v22 offset:30720
    s_waitcnt vmcnt(16) lgkmcnt(4)
    s_mov_b64 exec, 1
    ds_add_u32 v32, v33 offset:16
    s_mov_b64 exec, -1
    v_mfma_f32_16x16x32_bf16 v[128:131], v[240:243], v[168:171], v[128:131]
    v_mfma_f32_16x16x32_bf16 v[132:135], v[244:247], v[168:171], v[132:135]
    v_mfma_f32_16x16x32_bf16 v[136:139], v[248:251], v[168:171], v[136:139]
    v_mfma_f32_16x16x32_bf16 v[140:143], v[252:255], v[168:171], v[140:143]
    buffer_load_dwordx4 v[168:171], v28, s[12:15], s49 offen offset:2048 sc1
    buffer_load_dwordx4 v17, s[28:31], s21 offen offset:1024  lds
    v_mfma_f32_16x16x32_bf16 v[144:147], v[240:243], v[172:175], v[144:147]
    v_mfma_f32_16x16x32_bf16 v[148:151], v[244:247], v[172:175], v[148:151]
    v_mfma_f32_16x16x32_bf16 v[152:155], v[248:251], v[172:175], v[152:155]
    v_mfma_f32_16x16x32_bf16 v[156:159], v[252:255], v[172:175], v[156:159]
    buffer_load_dwordx4 v[172:175], v28, s[12:15], s49 offen offset:3072 sc1
    ds_read_b128 v[240:243], v23 offset:24576
    ds_read_b128 v[244:247], v23 offset:26624
    ds_read_b128 v[248:251], v23 offset:28672
    ds_read_b128 v[252:255], v23 offset:30720
    s_waitcnt vmcnt(21) lgkmcnt(4)
    v_mfma_f32_16x16x32_bf16 v[128:131], v[224:227], v[176:179], v[128:131]
    v_mfma_f32_16x16x32_bf16 v[132:135], v[228:231], v[176:179], v[132:135]
    v_mfma_f32_16x16x32_bf16 v[136:139], v[232:235], v[176:179], v[136:139]
    v_mfma_f32_16x16x32_bf16 v[140:143], v[236:239], v[176:179], v[140:143]
    ds_read_b32 v34, v32 offset:16
    buffer_load_dwordx4 v[176:179], v29, s[12:15], s49 offen offset:0 sc1
    buffer_load_dwordx4 v18, s[28:31], s21 offen offset:2048  lds
    v_mfma_f32_16x16x32_bf16 v[144:147], v[224:227], v[180:183], v[144:147]
    v_mfma_f32_16x16x32_bf16 v[148:151], v[228:231], v[180:183], v[148:151]
    v_mfma_f32_16x16x32_bf16 v[152:155], v[232:235], v[180:183], v[152:155]
    v_mfma_f32_16x16x32_bf16 v[156:159], v[236:239], v[180:183], v[156:159]
    buffer_load_dwordx4 v[180:183], v29, s[12:15], s49 offen offset:1024 sc1
    s_waitcnt lgkmcnt(0)
    v_readfirstlane_b32 s38, v34
    s_nop 1
    s_cmp_ge_u32 s38, 44
    s_cbranch_scc1 L_st10_ok
L_st10:
    ds_read_b32 v34, v32 offset:16
    s_waitcnt lgkmcnt(0)
    v_readfirstlane_b32 s38, v34
    s_nop 1
    s_cmp_ge_u32 s38, 44
    s_cbranch_scc1 L_st10_ok
    s_sub_u32 s96, s96, 1
    s_cbranch_scc1 L_st10_ok
    s_sleep 0
    s_branch L_st10
L_st10_ok:
    ds_read_b128 v[224:227], v20 offset:0
    ds_read_b128 v[228:231], v20 offset:2048
    ds_read_b128 v[232:235], v20 offset:4096
    ds_read_b128 v[236:239], v20 offset:6144
    s_waitcnt vmcnt(21)
    v_mfma_f32_16x16x32_bf16 v[128:131], v[240:243], v[184:187], v[128:131]
    v_mfma_f32_16x16x32_bf16 v[132:135], v[244:247], v[184:187], v[132:135]
    v_mfma_f32_16x16x32_bf16 v[136:139], v[248:251], v[184:187], v[136:139]
    v_mfma_f32_16x16x32_bf16 v[140:143], v[252:255], v[184:187], v[140:143]
    buffer_load_dwordx4 v[184:187], v29, s[12:15], s49 offen offset:2048 sc1
    buffer_load_dwordx4 v19, s[28:31], s21 offen offset:3072  lds
    v_mfma_f32_16x16x32_bf16 v[144:147], v[240:243], v[188:191], v[144:147]
    v_mfma_f32_16x16x32_bf16 v[148:151], v[244:247], v[188:191], v[148:151]
    v_mfma_f32_16x16x32_bf16 v[152:155], v[248:251], v[188:191], v[152:155]
    v_mfma_f32_16x16x32_bf16 v[156:159], v[252:255], v[188:191], v[156:159]
    buffer_load_dwordx4 v[188:191], v29, s[12:15], s49 offen offset:3072 sc1
    ds_read_b128 v[240:243], v21 offset:0
    ds_read_b128 v[244:247], v21 offset:2048
    ds_read_b128 v[248:251], v21 offset:4096
    ds_read_b128 v[252:255], v21 offset:6144
    s_waitcnt vmcnt(21) lgkmcnt(4)
    v_mfma_f32_16x16x32_bf16 v[128:131], v[224:227], v[192:195], v[128:131]
    v_mfma_f32_16x16x32_bf16 v[132:135], v[228:231], v[192:195], v[132:135]
    v_mfma_f32_16x16x32_bf16 v[136:139], v[232:235], v[192:195], v[136:139]
    v_mfma_f32_16x16x32_bf16 v[140:143], v[236:239], v[192:195], v[140:143]
    s_add_u32 s49, s55, 5
    s_and_b32 s49, s49, 7
    s_or_b32 s49, s49, s54
    s_xor_b32 s49, s49, 8
    s_lshl_b32 s49, s49, 15
    s_add_u32 s49, s49, s50
    buffer_load_dwordx4 v[192:195], v28, s[12:15], s49 offen offset:0 sc1
    s_add_u32 m0, s23, 49152
    s_add_u32 s21, s55, 6
    s_and_b32 s21, s21, 7
    s_or_b32 s21, s21, s54
    s_xor_b32 s21, s21, 8
    s_lshl_b32 s21, s21, 7
    buffer_load_dwordx4 v16, s[28:31], s21 offen offset:0  lds
    v_mfma_f32_16x16x32_bf16 v[144:147], v[224:227], v[196:199], v[144:147]
    v_mfma_f32_16x16x32_bf16 v[148:151], v[228:231], v[196:199], v[148:151]
    v_mfma_f32_16x16x32_bf16 v[152:155], v[232:235], v[196:199], v[152:155]
    v_mfma_f32_16x16x32_bf16 v[156:159], v[236:239], v[196:199], v[156:159]
    buffer_load_dwordx4 v[196:199], v28, s[12:15], s49 offen offset:1024 sc1
    ds_read_b128 v[224:227], v20 offset:8192
    ds_read_b128 v[228:231], v20 offset:10240
    ds_read_b128 v[232:235], v20 offset:12288
    ds_read_b128 v[236:239], v20 offset:14336
    s_waitcnt vmcnt(16) lgkmcnt(4)
    s_mov_b64 exec, 1
    ds_add_u32 v32, v33 offset:16
    s_mov_b64 exec, -1
    v_mfma_f32_16x16x32_bf16 v[128:131], v[240:243], v[200:203], v[128:131]
    v_mfma_f32_16x16x32_bf16 v[132:135], v[244:247], v[200:203], v[132:135]
    v_mfma_f32_16x16x32_bf16 v[136:139], v[248:251], v[200:203], v[136:139]
    v_mfma_f32_16x16x32_bf16 v[140:143], v[252:255], v[200:203], v[140:143]
    buffer_load_dwordx4 v[200:203], v28, s[12:15], s49 offen offset:2048 sc1
    buffer_load_dwordx4 v17, s[28:31], s21 offen offset:1024  lds
    v_mfma_f32_16x16x32_bf16 v[144:147], v[240:243], v[204:207], v[144:147]
    v_mfma_f32_16x16x32_bf16 v[148:151], v[244:247], v[204:207], v[148:151]
    v_mfma_f32_16x16x32_bf16 v[152:155], v[248:251], v[204:207], v[152:155]
    v_mfma_f32_16x16x32_bf16 v[156:159], v[252:255], v[204:207], v[156:159]
    buffer_load_dwordx4 v[204:207], v28, s[12:15], s49 offen offset:3072 sc1
    ds_read_b128 v[240:243], v21 offset:8192
    ds_read_b128 v[244:247], v21 offset:10240
    ds_read_b128 v[248:251], v21 offset:12288
    ds_read_b128 v[252:255], v21 offset:14336
    s_waitcnt vmcnt(21) lgkmcnt(4)
    v_mfma_f32_16x16x32_bf16 v[128:131], v[224:227], v[208:211], v[128:131]
    v_mfma_f32_16x16x32_bf16 v[132:135], v[228:231], v[208:211], v[132:135]
    v_mfma_f32_16x16x32_bf16 v[136:139], v[232:235], v[208:211], v[136:139]
    v_mfma_f32_16x16x32_bf16 v[140:143], v[236:239], v[208:211], v[140:143]
    ds_read_b32 v34, v32 offset:16
    buffer_load_dwordx4 v[208:211], v29, s[12:15], s49 offen offset:0 sc1
    buffer_load_dwordx4 v18, s[28:31], s21 offen offset:2048  lds
    v_mfma_f32_16x16x32_bf16 v[144:147], v[224:227], v[212:215], v[144:147]
    v_mfma_f32_16x16x32_bf16 v[148:151], v[228:231], v[212:215], v[148:151]
    v_mfma_f32_16x16x32_bf16 v[152:155], v[232:235], v[212:215], v[152:155]
    v_mfma_f32_16x16x32_bf16 v[156:159], v[236:239], v[212:215], v[156:159]
    buffer_load_dwordx4 v[212:215], v29, s[12:15], s49 offen offset:1024 sc1
    s_waitcnt lgkmcnt(0)
    v_readfirstlane_b32 s38, v34
    s_nop 1
    s_cmp_ge_u32 s38, 48
    s_cbranch_scc1 L_st11_ok
L_st11:
    ds_read_b32 v34, v32 offset:16
    s_waitcnt lgkmcnt(0)
    v_readfirstlane_b32 s38, v34
    s_nop 1
    s_cmp_ge_u32 s38, 48
    s_cbranch_scc1 L_st11_ok
    s_sub_u32 s96, s96, 1
    s_cbranch_scc1 L_st11_ok
    s_sleep 0
    s_branch L_st11
L_st11_ok:
    ds_read_b128 v[224:227], v20 offset:16384
    ds_read_b128 v[228:231], v20 offset:18432
    ds_read_b128 v[232:235], v20 offset:20480
    ds_read_b128 v[236:239], v20 offset:22528
    s_waitcnt vmcnt(21)
    v_mfma_f32_16x16x32_bf16 v[128:131], v[240:243], v[216:219], v[128:131]
    v_mfma_f32_16x16x32_bf16 v[132:135], v[244:247], v[216:219], v[132:135]
    v_mfma_f32_16x16x32_bf16 v[136:139], v[248:251], v[216:219], v[136:139]
    v_mfma_f32_16x16x32_bf16 v[140:143], v[252:255], v[216:219], v[140:143]
    buffer_load_dwordx4 v[216:219], v29, s[12:15], s49 offen offset:2048 sc1
    buffer_load_dwordx4 v19, s[28:31], s21 offen offset:3072  lds
    v_mfma_f32_16x16x32_bf16 v[144:147], v[240:243], v[220:223], v[144:147]
    v_mfma_f32_16x16x32_bf16 v[148:151], v[244:247], v[220:223], v[148:151]
    v_mfma_f32_16x16x32_bf16 v[152:155], v[248:251], v[220:223], v[152:155]
    v_mfma_f32_16x16x32_bf16 v[156:159], v[252:255], v[220:223], v[156:159]
    buffer_load_dwordx4 v[220:223], v29, s[12:15], s49 offen offset:3072 sc1
    ds_read_b128 v[240:243], v21 offset:16384
    ds_read_b128 v[244:247], v21 offset:18432
    ds_read_b128 v[248:251], v21 offset:20480
    ds_read_b128 v[252:255], v21 offset:22528
    s_waitcnt vmcnt(21) lgkmcnt(4)
    v_mfma_f32_16x16x32_bf16 v[128:131], v[224:227], v[160:163], v[128:131]
    v_mfma_f32_16x16x32_bf16 v[132:135], v[228:231], v[160:163], v[132:135]
    v_mfma_f32_16x16x32_bf16 v[136:139], v[232:235], v[160:163], v[136:139]
    v_mfma_f32_16x16x32_bf16 v[140:143], v[236:239], v[160:163], v[140:143]
    s_add_u32 s49, s55, 6
    s_and_b32 s49, s49, 7
    s_or_b32 s49, s49, s54
    s_xor_b32 s49, s49, 8
    s_lshl_b32 s49, s49, 15
    s_add_u32 s49, s49, s50
    buffer_load_dwordx4 v[160:163], v28, s[12:15], s49 offen offset:0 sc1
    s_add_u32 m0, s23, 81920
    s_add_u32 s21, s55, 7
    s_and_b32 s21, s21, 7
    s_or_b32 s21, s21, s54
    s_xor_b32 s21, s21, 8
    s_lshl_b32 s21, s21, 7
    buffer_load_dwordx4 v16, s[28:31], s21 offen offset:0  lds
    v_mfma_f32_16x16x32_bf16 v[144:147], v[224:227], v[164:167], v[144:147]
    v_mfma_f32_16x16x32_bf16 v[148:151], v[228:231], v[164:167], v[148:151]
    v_mfma_f32_16x16x32_bf16 v[152:155], v[232:235], v[164:167], v[152:155]
    v_mfma_f32_16x16x32_bf16 v[156:159], v[236:239], v[164:167], v[156:159]
    buffer_load_dwordx4 v[164:167], v28, s[12:15], s49 offen offset:1024 sc1
    ds_read_b128 v[224:227], v20 offset:24576
    ds_read_b128 v[228:231], v20 offset:26624
    ds_read_b128 v[232:235], v20 offset:28672
    ds_read_b128 v[236:239], v20 offset:30720
    s_waitcnt vmcnt(16) lgkmcnt(4)
    s_mov_b64 exec, 1
    ds_add_u32 v32, v33 offset:16
    s_mov_b64 exec, -1
    v_mfma_f32_16x16x32_bf16 v[128:131], v[240:243], v[168:171], v[128:131]
    v_mfma_f32_16x16x32_bf16 v[132:135], v[244:247], v[168:171], v[132:135]
    v_mfma_f32_16x16x32_bf16 v[136:139], v[248:251], v[168:171], v[136:139]
    v_mfma_f32_16x16x32_bf16 v[140:143], v[252:255], v[168:171], v[140:143]
    buffer_load_dwordx4 v[168:171], v28, s[12:15], s49 offen offset:2048 sc1
    buffer_load_dwordx4 v17, s[28:31], s21 offen offset:1024  lds
    v_mfma_f32_16x16x32_bf16 v[144:147], v[240:243], v[172:175], v[144:147]
    v_mfma_f32_16x16x32_bf16 v[148:151], v[244:247], v[172:175], v[148:151]
    v_mfma_f32_16x16x32_bf16 v[152:155], v[248:251], v[172:175], v[152:155]
    v_mfma_f32_16x16x32_bf16 v[156:159], v[252:255], v[172:175], v[156:159]
    buffer_load_dwordx4 v[172:175], v28, s[12:15], s49 offen offset:3072 sc1
    ds_read_b128 v[240:243], v21 offset:24576
    ds_read_b128 v[244:247], v21 offset:26624
    ds_read_b128 v[248:251], v21 offset:28672
    ds_read_b128 v[252:255], v21 offset:30720
    s_waitcnt vmcnt(21) lgkmcnt(4)
    v_mfma_f32_16x16x32_bf16 v[128:131], v[224:227], v[176:179], v[128:131]
    v_mfma_f32_16x16x32_bf16 v[132:135], v[228:231], v[176:179], v[132:135]
    v_mfma_f32_16x16x32_bf16 v[136:139], v[232:235], v[176:179], v[136:139]
    v_mfma_f32_16x16x32_bf16 v[140:143], v[236:239], v[176:179], v[140:143]
    ds_read_b32 v34, v32 offset:16
    buffer_load_dwordx4 v[176:179], v29, s[12:15], s49 offen offset:0 sc1
    buffer_load_dwordx4 v18, s[28:31], s21 offen offset:2048  lds
    v_mfma_f32_16x16x32_bf16 v[144:147], v[224:227], v[180:183], v[144:147]
    v_mfma_f32_16x16x32_bf16 v[148:151], v[228:231], v[180:183], v[148:151]
    v_mfma_f32_16x16x32_bf16 v[152:155], v[232:235], v[180:183], v[152:155]
    v_mfma_f32_16x16x32_bf16 v[156:159], v[236:239], v[180:183], v[156:159]
    buffer_load_dwordx4 v[180:183], v29, s[12:15], s49 offen offset:1024 sc1
    s_waitcnt lgkmcnt(0)
    v_readfirstlane_b32 s38, v34
    s_nop 1
    s_cmp_ge_u32 s38, 52
    s_cbranch_scc1 L_st12_ok
L_st12:
    ds_read_b32 v34, v32 offset:16
    s_waitcnt lgkmcnt(0)
    v_readfirstlane_b32 s38, v34
    s_nop 1
    s_cmp_ge_u32 s38, 52
    s_cbranch_scc1 L_st12_ok
    s_sub_u32 s96, s96, 1
    s_cbranch_scc1 L_st12_ok
    s_sleep 0
    s_branch L_st12
L_st12_ok:
    ds_read_b128 v[224:227], v20 offset:32768
    ds_read_b128 v[228:231], v20 offset:34816
    ds_read_b128 v[232:235], v20 offset:36864
    ds_read_b128 v[236:239], v20 offset:38912
    s_waitcnt vmcnt(21)
    v_mfma_f32_16x16x32_bf16 v[128:131], v[240:243], v[184:187], v[128:131]
    v_mfma_f32_16x16x32_bf16 v[132:135], v[244:247], v[184:187], v[132:135]
    v_mfma_f32_16x16x32_bf16 v[136:139], v[248:251], v[184:187], v[136:139]
    v_mfma_f32_16x16x32_bf16 v[140:143], v[252:255], v[184:187], v[140:143]
    buffer_load_dwordx4 v[184:187], v29, s[12:15], s49 offen offset:2048 sc1
    buffer_load_dwordx4 v19, s[28:31], s21 offen offset:3072  lds
    v_mfma_f32_16x16x32_bf16 v[144:147], v[240:243], v[188:191], v[144:147]
    v_mfma_f32_16x16x32_bf16 v[148:151], v[244:247], v[188:191], v[148:151]
    v_mfma_f32_16x16x32_bf16 v[152:155], v[248:251], v[188:191], v[152:155]
    v_mfma_f32_16x16x32_bf16 v[156:159], v[252:255], v[188:191], v[156:159]
    buffer_load_dwordx4 v[188:191], v29, s[12:15], s49 offen offset:3072 sc1
    ds_read_b128 v[240:243], v21 offset:32768
    ds_read_b128 v[244:247], v21 offset:34816
    ds_read_b128 v[248:251], v21 offset:36864
    ds_read_b128 v[252:255], v21 offset:38912
    s_waitcnt vmcnt(21) lgkmcnt(4)
    v_mfma_f32_16x16x32_bf16 v[128:131], v[224:227], v[192:195], v[128:131]
    v_mfma_f32_16x16x32_bf16 v[132:135], v[228:231], v[192:195], v[132:135]
    v_mfma_f32_16x16x32_bf16 v[136:139], v[232:235], v[192:195], v[136:139]
    v_mfma_f32_16x16x32_bf16 v[140:143], v[236:239], v[192:195], v[140:143]
    s_add_u32 s49, s55, 7
    s_and_b32 s49, s49, 7
    s_or_b32 s49, s49, s54
    s_xor_b32 s49, s49, 8
    s_lshl_b32 s49, s49, 15
    s_add_u32 s49, s49, s50
    buffer_load_dwordx4 v[192:195], v28, s[12:15], s49 offen offset:0 sc1
    v_mfma_f32_16x16x32_bf16 v[144:147], v[224:227], v[196:199], v[144:147]
    v_mfma_f32_16x16x32_bf16 v[148:151], v[228:231], v[196:199], v[148:151]
    v_mfma_f32_16x16x32_bf16 v[152:155], v[232:235], v[196:199], v[152:155]
    v_mfma_f32_16x16x32_bf16 v[156:159], v[236:239], v[196:199], v[156:159]
    buffer_load_dwordx4 v[196:199], v28, s[12:15], s49 offen offset:1024 sc1
    ds_read_b128 v[224:227], v20 offset:40960
    ds_read_b128 v[228:231], v20 offset:43008
    ds_read_b128 v[232:235], v20 offset:45056
    ds_read_b128 v[236:239], v20 offset:47104
    s_waitcnt vmcnt(15) lgkmcnt(4)
    s_mov_b64 exec, 1
    ds_add_u32 v32, v33 offset:16
    s_mov_b64 exec, -1
    v_mfma_f32_16x16x32_bf16 v[128:131], v[240:243], v[200:203], v[128:131]
    v_mfma_f32_16x16x32_bf16 v[132:135], v[244:247], v[200:203], v[132:135]
    v_mfma_f32_16x16x32_bf16 v[136:139], v[248:251], v[200:203], v[136:139]
    v_mfma_f32_16x16x32_bf16 v[140:143], v[252:255], v[200:203], v[140:143]
    buffer_load_dwordx4 v[200:203], v28, s[12:15], s49 offen offset:2048 sc1
    v_mfma_f32_16x16x32_bf16 v[144:147], v[240:243], v[204:207], v[144:147]
    v_mfma_f32_16x16x32_bf16 v[148:151], v[244:247], v[204:207], v[148:151]
    v_mfma_f32_16x16x32_bf16 v[152:155], v[248:251], v[204:207], v[152:155]
    v_mfma_f32_16x16x32_bf16 v[156:159], v[252:255], v[204:207], v[156:159]
    buffer_load_dwordx4 v[204:207], v28, s[12:15], s49 offen offset:3072 sc1
    ds_read_b128 v[240:243], v21 offset:40960
    ds_read_b128 v[244:247], v21 offset:43008
    ds_read_b128 v[248:251], v21 offset:45056
    ds_read_b128 v[252:255], v21 offset:47104
    s_waitcnt vmcnt(19) lgkmcnt(4)
    v_mfma_f32_16x16x32_bf16 v[128:131], v[224:227], v[208:211], v[128:131]
    v_mfma_f32_16x16x32_bf16 v[132:135], v[228:231], v[208:211], v[132:135]
    v_mfma_f32_16x16x32_bf16 v[136:139], v[232:235], v[208:211], v[136:139]
    v_mfma_f32_16x16x32_bf16 v[140:143], v[236:239], v[208:211], v[140:143]
    ds_read_b32 v34, v32 offset:16
    buffer_load_dwordx4 v[208:211], v29, s[12:15], s49 offen offset:0 sc1
    v_mfma_f32_16x16x32_bf16 v[144:147], v[224:227], v[212:215], v[144:147]
    v_mfma_f32_16x16x32_bf16 v[148:151], v[228:231], v[212:215], v[148:151]
    v_mfma_f32_16x16x32_bf16 v[152:155], v[232:235], v[212:215], v[152:155]
    v_mfma_f32_16x16x32_bf16 v[156:159], v[236:239], v[212:215], v[156:159]
    buffer_load_dwordx4 v[212:215], v29, s[12:15], s49 offen offset:1024 sc1
    s_waitcnt lgkmcnt(0)
    v_readfirstlane_b32 s38, v34
    s_nop 1
    s_cmp_ge_u32 s38, 56
    s_cbranch_scc1 L_st13_ok
L_st13:
    ds_read_b32 v34, v32 offset:16
    s_waitcnt lgkmcnt(0)
    v_readfirstlane_b32 s38, v34
    s_nop 1
    s_cmp_ge_u32 s38, 56
    s_cbranch_scc1 L_st13_ok
    s_sub_u32 s96, s96, 1
    s_cbranch_scc1 L_st13_ok
    s_sleep 0
    s_branch L_st13
L_st13_ok:
    ds_read_b128 v[224:227], v20 offset:49152
    ds_read_b128 v[228:231], v20 offset:51200
    ds_read_b128 v[232:235], v20 offset:53248
    ds_read_b128 v[236:239], v20 offset:55296
    s_waitcnt vmcnt(18)
    v_mfma_f32_16x16x32_bf16 v[128:131], v[240:243], v[216:219], v[128:131]
    v_mfma_f32_16x16x32_bf16 v[132:135], v[244:247], v[216:219], v[132:135]
    v_mfma_f32_16x16x32_bf16 v[136:139], v[248:251], v[216:219], v[136:139]
    v_mfma_f32_16x16x32_bf16 v[140:143], v[252:255], v[216:219], v[140:143]
    buffer_load_dwordx4 v[216:219], v29, s[12:15], s49 offen offset:2048 sc1
    v_mfma_f32_16x16x32_bf16 v[144:147], v[240:243], v[220:223], v[144:147]
    v_mfma_f32_16x16x32_bf16 v[148:151], v[244:247], v[220:223], v[148:151]
    v_mfma_f32_16x16x32_bf16 v[152:155], v[248:251], v[220:223], v[152:155]
    v_mfma_f32_16x16x32_bf16 v[156:159], v[252:255], v[220:223], v[156:159]
    buffer_load_dwordx4 v[220:223], v29, s[12:15], s49 offen offset:3072 sc1
    ds_read_b128 v[240:243], v21 offset:49152
    ds_read_b128 v[244:247], v21 offset:51200
    ds_read_b128 v[248:251], v21 offset:53248
    ds_read_b128 v[252:255], v21 offset:55296
    s_waitcnt vmcnt(17) lgkmcnt(4)
    v_mfma_f32_16x16x32_bf16 v[128:131], v[224:227], v[160:163], v[128:131]
    v_mfma_f32_16x16x32_bf16 v[132:135], v[228:231], v[160:163], v[132:135]
    v_mfma_f32_16x16x32_bf16 v[136:139], v[232:235], v[160:163], v[136:139]
    v_mfma_f32_16x16x32_bf16 v[140:143], v[236:239], v[160:163], v[140:143]
    v_mfma_f32_16x16x32_bf16 v[144:147], v[224:227], v[164:167], v[144:147]
    v_mfma_f32_16x16x32_bf16 v[148:151], v[228:231], v[164:167], v[148:151]
    v_mfma_f32_16x16x32_bf16 v[152:155], v[232:235], v[164:167], v[152:155]
    v_mfma_f32_16x16x32_bf16 v[156:159], v[236:239], v[164:167], v[156:159]
    ds_read_b128 v[224:227], v20 offset:57344
    ds_read_b128 v[228:231], v20 offset:59392
    ds_read_b128 v[232:235], v20 offset:61440
    ds_read_b128 v[236:239], v20 offset:63488
    s_waitcnt vmcnt(9) lgkmcnt(4)
    s_mov_b64 exec, 1
    ds_add_u32 v32, v33 offset:16
    s_mov_b64 exec, -1
    v_mfma_f32_16x16x32_bf16 v[128:131], v[240:243], v[168:171], v[128:131]
    v_mfma_f32_16x16x32_bf16 v[132:135], v[244:247], v[168:171], v[132:135]
    v_mfma_f32_16x16x32_bf16 v[136:139], v[248:251], v[168:171], v[136:139]
    v_mfma_f32_16x16x32_bf16 v[140:143], v[252:255], v[168:171], v[140:143]
    v_mfma_f32_16x16x32_bf16 v[144:147], v[240:243], v[172:175], v[144:147]
    v_mfma_f32_16x16x32_bf16 v[148:151], v[244:247], v[172:175], v[148:151]
    v_mfma_f32_16x16x32_bf16 v[152:155], v[248:251], v[172:175], v[152:155]
    v_mfma_f32_16x16x32_bf16 v[156:159], v[252:255], v[172:175], v[156:159]
    ds_read_b128 v[240:243], v21 offset:57344
    ds_read_b128 v[244:247], v21 offset:59392
    ds_read_b128 v[248:251], v21 offset:61440
    ds_read_b128 v[252:255], v21 offset:63488
    s_waitcnt vmcnt(11) lgkmcnt(4)
    v_mfma_f32_16x16x32_bf16 v[128:131], v[224:227], v[176:179], v[128:131]
    v_mfma_f32_16x16x32_bf16 v[132:135], v[228:231], v[176:179], v[132:135]
    v_mfma_f32_16x16x32_bf16 v[136:139], v[232:235], v[176:179], v[136:139]
    v_mfma_f32_16x16x32_bf16 v[140:143], v[236:239], v[176:179], v[140:143]
    ds_read_b32 v34, v32 offset:16
    v_mfma_f32_16x16x32_bf16 v[144:147], v[224:227], v[180:183], v[144:147]
    v_mfma_f32_16x16x32_bf16 v[148:151], v[228:231], v[180:183], v[148:151]
    v_mfma_f32_16x16x32_bf16 v[152:155], v[232:235], v[180:183], v[152:155]
    v_mfma_f32_16x16x32_bf16 v[156:159], v[236:239], v[180:183], v[156:159]
    s_waitcnt lgkmcnt(0)
    v_readfirstlane_b32 s38, v34
    s_nop 1
    s_cmp_ge_u32 s38, 60
    s_cbranch_scc1 L_st14_ok
L_st14:
    ds_read_b32 v34, v32 offset:16
    s_waitcnt lgkmcnt(0)
    v_readfirstlane_b32 s38, v34
    s_nop 1
    s_cmp_ge_u32 s38, 60
    s_cbranch_scc1 L_st14_ok
    s_sub_u32 s96, s96, 1
    s_cbranch_scc1 L_st14_ok
    s_sleep 0
    s_branch L_st14
L_st14_ok:
    ds_read_b128 v[224:227], v22 offset:16384
    ds_read_b128 v[228:231], v22 offset:18432
    ds_read_b128 v[232:235], v22 offset:20480
    ds_read_b128 v[236:239], v22 offset:22528
    s_waitcnt vmcnt(8)
    v_mfma_f32_16x16x32_bf16 v[128:131], v[240:243], v[184:187], v[128:131]
    v_mfma_f32_16x16x32_bf16 v[132:135], v[244:247], v[184:187], v[132:135]
    v_mfma_f32_16x16x32_bf16 v[136:139], v[248:251], v[184:187], v[136:139]
    v_mfma_f32_16x16x32_bf16 v[140:143], v[252:255], v[184:187], v[140:143]
    v_mfma_f32_16x16x32_bf16 v[144:147], v[240:243], v[188:191], v[144:147]
    v_mfma_f32_16x16x32_bf16 v[148:151], v[244:247], v[188:191], v[148:151]
    v_mfma_f32_16x16x32_bf16 v[152:155], v[248:251], v[188:191], v[152:155]
    v_mfma_f32_16x16x32_bf16 v[156:159], v[252:255], v[188:191], v[156:159]
    ds_read_b128 v[240:243], v23 offset:16384
    ds_read_b128 v[244:247], v23 offset:18432
    ds_read_b128 v[248:251], v23 offset:20480
    ds_read_b128 v[252:255], v23 offset:22528
    s_waitcnt vmcnt(6) lgkmcnt(4)
    v_mfma_f32_16x16x32_bf16 v[128:131], v[224:227], v[192:195], v[128:131]
    v_mfma_f32_16x16x32_bf16 v[132:135], v[228:231], v[192:195], v[132:135]
    v_mfma_f32_16x16x32_bf16 v[136:139], v[232:235], v[192:195], v[136:139]
    v_mfma_f32_16x16x32_bf16 v[140:143], v[236:239], v[192:195], v[140:143]
    v_mfma_f32_16x16x32_bf16 v[144:147], v[224:227], v[196:199], v[144:147]
    v_mfma_f32_16x16x32_bf16 v[148:151], v[228:231], v[196:199], v[148:151]
    v_mfma_f32_16x16x32_bf16 v[152:155], v[232:235], v[196:199], v[152:155]
    v_mfma_f32_16x16x32_bf16 v[156:159], v[236:239], v[196:199], v[156:159]
    ds_read_b128 v[224:227], v22 offset:24576
    ds_read_b128 v[228:231], v22 offset:26624
    ds_read_b128 v[232:235], v22 offset:28672
    ds_read_b128 v[236:239], v22 offset:30720
    s_waitcnt vmcnt(4) lgkmcnt(4)
    v_mfma_f32_16x16x32_bf16 v[128:131], v[240:243], v[200:203], v[128:131]
    v_mfma_f32_16x16x32_bf16 v[132:135], v[244:247], v[200:203], v[132:135]
    v_mfma_f32_16x16x32_bf16 v[136:139], v[248:251], v[200:203], v[136:139]
    v_mfma_f32_16x16x32_bf16 v[140:143], v[252:255], v[200:203], v[140:143]
    v_mfma_f32_16x16x32_bf16 v[144:147], v[240:243], v[204:207], v[144:147]
    v_mfma_f32_16x16x32_bf16 v[148:151], v[244:247], v[204:207], v[148:151]
    v_mfma_f32_16x16x32_bf16 v[152:155], v[248:251], v[204:207], v[152:155]
    v_mfma_f32_16x16x32_bf16 v[156:159], v[252:255], v[204:207], v[156:159]
    ds_read_b128 v[240:243], v23 offset:24576
    ds_read_b128 v[244:247], v23 offset:26624
    ds_read_b128 v[248:251], v23 offset:28672
    ds_read_b128 v[252:255], v23 offset:30720
    s_waitcnt vmcnt(2) lgkmcnt(4)
    v_mfma_f32_16x16x32_bf16 v[128:131], v[224:227], v[208:211], v[128:131]
    v_mfma_f32_16x16x32_bf16 v[132:135], v[228:231], v[208:211], v[132:135]
    v_mfma_f32_16x16x32_bf16 v[136:139], v[232:235], v[208:211], v[136:139]
    v_mfma_f32_16x16x32_bf16 v[140:143], v[236:239], v[208:211], v[140:143]
    v_mfma_f32_16x16x32_bf16 v[144:147], v[224:227], v[212:215], v[144:147]
    v_mfma_f32_16x16x32_bf16 v[148:151], v[228:231], v[212:215], v[148:151]
    v_mfma_f32_16x16x32_bf16 v[152:155], v[232:235], v[212:215], v[152:155]
    v_mfma_f32_16x16x32_bf16 v[156:159], v[236:239], v[212:215], v[156:159]
    s_waitcnt vmcnt(0) lgkmcnt(0)
    v_mfma_f32_16x16x32_bf16 v[128:131], v[240:243], v[216:219], v[128:131]
    v_mfma_f32_16x16x32_bf16 v[132:135], v[244:247], v[216:219], v[132:135]
    v_mfma_f32_16x16x32_bf16 v[136:139], v[248:251], v[216:219], v[136:139]
    v_mfma_f32_16x16x32_bf16 v[140:143], v[252:255], v[216:219], v[140:143]
    v_mfma_f32_16x16x32_bf16 v[144:147], v[240:243], v[220:223], v[144:147]
    v_mfma_f32_16x16x32_bf16 v[148:151], v[244:247], v[220:223], v[148:151]
    v_mfma_f32_16x16x32_bf16 v[152:155], v[248:251], v[220:223], v[152:155]
    v_mfma_f32_16x16x32_bf16 v[156:159], v[252:255], v[220:223], v[156:159]
    s_mul_i32 s38, s18, 8704
    s_add_u32 s56, s38, 0
    v_mul_u32_u24 v56, 272, v26
    v_lshl_add_u32 v56, v25, 4, v56
    v_add_u32 v56, s56, v56
    v_mul_u32_u24 v57, 272, v25
    v_lshl_add_u32 v57, v26, 4, v57
    v_add_u32 v57, s56, v57
    v_lshlrev_b32 v58, 12, v25
    v_lshl_add_u32 v58, v26, 4, v58
    v_lshlrev_b32 v59, 2, v24
    v_add_u32 v59, 73984, v59
L_topw:
    ds_read_b32 v34, v32 offset:32
    s_waitcnt lgkmcnt(0)
    v_readfirstlane_b32 s38, v34
    s_nop 1
    s_cmp_ge_u32 s38, 1
    s_cbranch_scc1 L_topw_ok
    s_sub_u32 s96, s96, 1
    s_cbranch_scc1 L_topw_ok
    s_sleep 1
    s_branch L_topw
L_topw_ok:
    ds_read_b32 v60, v59
    v_pk_mul_f32 v[128:129], v[4:5], v[128:129] op_sel:[0,0] op_sel_hi:[0,1]
    v_pk_mul_f32 v[130:131], v[4:5], v[130:131] op_sel:[0,0] op_sel_hi:[0,1]
    ds_write_b128 v56, v[128:131] offset:0
    v_pk_mul_f32 v[132:133], v[4:5], v[132:133] op_sel:[0,0] op_sel_hi:[0,1]
    v_pk_mul_f32 v[134:135], v[4:5], v[134:135] op_sel:[0,0] op_sel_hi:[0,1]
    ds_write_b128 v56, v[132:135] offset:64
    v_pk_mul_f32 v[136:137], v[4:5], v[136:137] op_sel:[0,0] op_sel_hi:[0,1]
    v_pk_mul_f32 v[138:139], v[4:5], v[138:139] op_sel:[0,0] op_sel_hi:[0,1]
    ds_write_b128 v56, v[136:139] offset:128
    v_pk_mul_f32 v[140:141], v[4:5], v[140:141] op_sel:[0,0] op_sel_hi:[0,1]
    v_pk_mul_f32 v[142:143], v[4:5], v[142:143] op_sel:[0,0] op_sel_hi:[0,1]
    ds_write_b128 v56, v[140:143] offset:192
    v_pk_mul_f32 v[144:145], v[4:5], v[144:145] op_sel:[1,0] op_sel_hi:[1,1]
    v_pk_mul_f32 v[146:147], v[4:5], v[146:147] op_sel:[1,0] op_sel_hi:[1,1]
    ds_write_b128 v56, v[144:147] offset:4352
    v_pk_mul_f32 v[148:149], v[4:5], v[148:149] op_sel:[1,0] op_sel_hi:[1,1]
    v_pk_mul_f32 v[150:151], v[4:5], v[150:151] op_sel:[1,0] op_sel_hi:[1,1]
    ds_write_b128 v56, v[148:151] offset:4416
    v_pk_mul_f32 v[152:153], v[4:5], v[152:153] op_sel:[1,0] op_sel_hi:[1,1]
    v_pk_mul_f32 v[154:155], v[4:5], v[154:155] op_sel:[1,0] op_sel_hi:[1,1]
    ds_write_b128 v56, v[152:155] offset:4480
    v_pk_mul_f32 v[156:157], v[4:5], v[156:157] op_sel:[1,0] op_sel_hi:[1,1]
    v_pk_mul_f32 v[158:159], v[4:5], v[158:159] op_sel:[1,0] op_sel_hi:[1,1]
    ds_write_b128 v56, v[156:159] offset:4544
    s_waitcnt lgkmcnt(8)
    v_and_b32 v60, 0x7ff, v60
    s_sub_u32 s38, 2047, s51
    v_sub_u32 v60, s38, v60
    v_cmp_gt_u32 vcc, 32, v60
    s_nop 1
    s_and_b32 s57, vcc_lo, 0xff
L_fix:
    s_cmp_eq_u32 s57, 0
    s_cbranch_scc1 L_fixd
    s_ff1_i32_b32 s38, s57
    s_bitset0_b32 s57, s38
    v_readlane_b32 s39, v60, s38
    s_mov_b32 s49, s38
    v_lshl_add_u32 v170, s49, 2, v32
L_dfw:
    ds_read_b32 v34, v170 offset:36
    s_waitcnt lgkmcnt(0)
    v_readfirstlane_b32 s38, v34
    s_nop 1
    s_cmp_ge_u32 s38, 1
    s_cbranch_scc1 L_dfw_ok
    s_sub_u32 s96, s96, 1
    s_cbranch_scc1 L_dfw_ok
    s_sleep 2
    s_branch L_dfw
L_dfw_ok:
    s_lshl_b32 s38, s49, 8
    s_add_u32 s38, s38, 75776
    v_lshl_add_u32 v169, v26, 4, s38
    s_mul_i32 s39, s39, 272
    s_add_u32 s39, s39, s56
    v_lshl_add_u32 v168, v26, 4, s39
    ds_read_b128 v[160:163], v168
    ds_read_b128 v[164:167], v169
    s_waitcnt lgkmcnt(0)
    v_pk_add_f32 v[160:161], v[160:161], v[164:165]
    v_pk_add_f32 v[162:163], v[162:163], v[166:167]
    ds_write_b128 v168, v[160:163]
    s_waitcnt lgkmcnt(0)
    s_branch L_fix
L_fixd:
    ds_read_b128 v[128:131], v57 offset:0
    ds_read_b128 v[132:135], v57 offset:1088
    ds_read_b128 v[136:139], v57 offset:2176
    ds_read_b128 v[140:143], v57 offset:3264
    ds_read_b128 v[144:147], v57 offset:4352
    ds_read_b128 v[148:151], v57 offset:5440
    ds_read_b128 v[152:155], v57 offset:6528
    ds_read_b128 v[156:159], v57 offset:7616
    s_lshl_b32 s38, s51, 12
    s_lshl_b32 s39, s17, 8
    s_add_u32 s38, s38, s39
    s_waitcnt lgkmcnt(7)
    v_pk_add_f32 v[128:129], v[128:129], v[72:73]
    v_pk_add_f32 v[130:131], v[130:131], v[74:75]
    buffer_store_dwordx4 v[128:131], v58, s[32:35], s38 offen sc1
    s_add_u32 s38, s38, 16384
    s_waitcnt lgkmcnt(6)
    v_pk_add_f32 v[132:133], v[132:133], v[76:77]
    v_pk_add_f32 v[134:135], v[134:135], v[78:79]
    buffer_store_dwordx4 v[132:135], v58, s[32:35], s38 offen sc1
    s_add_u32 s38, s38, 16384
    s_waitcnt lgkmcnt(5)
    v_pk_add_f32 v[136:137], v[136:137], v[88:89]
    v_pk_add_f32 v[138:139], v[138:139], v[90:91]
    buffer_store_dwordx4 v[136:139], v58, s[32:35], s38 offen sc1
    s_add_u32 s38, s38, 16384
    s_waitcnt lgkmcnt(4)
    v_pk_add_f32 v[140:141], v[140:141], v[92:93]
    v_pk_add_f32 v[142:143], v[142:143], v[94:95]
    buffer_store_dwordx4 v[140:143], v58, s[32:35], s38 offen sc1
    s_add_u32 s38, s38, 16384
    s_waitcnt lgkmcnt(3)
    v_pk_add_f32 v[144:145], v[144:145], v[104:105]
    v_pk_add_f32 v[146:147], v[146:147], v[106:107]
    buffer_store_dwordx4 v[144:147], v58, s[32:35], s38 offen sc1
    s_add_u32 s38, s38, 16384
    s_waitcnt lgkmcnt(2)
    v_pk_add_f32 v[148:149], v[148:149], v[108:109]
    v_pk_add_f32 v[150:151], v[150:151], v[110:111]
    buffer_store_dwordx4 v[148:151], v58, s[32:35], s38 offen sc1
    s_add_u32 s38, s38, 16384
    s_waitcnt lgkmcnt(1)
    v_pk_add_f32 v[152:153], v[152:153], v[120:121]
    v_pk_add_f32 v[154:155], v[154:155], v[122:123]
    buffer_store_dwordx4 v[152:155], v58, s[32:35], s38 offen sc1
    s_add_u32 s38, s38, 16384
    s_waitcnt lgkmcnt(0)
    v_pk_add_f32 v[156:157], v[156:157], v[124:125]
    v_pk_add_f32 v[158:159], v[158:159], v[126:127]
    buffer_store_dwordx4 v[156:159], v58, s[32:35], s38 offen sc1
    s_add_u32 s38, s38, 16384
    s_endpgm
L_code_end:
.section .rodata,"a"
.p2align 6
.amdhsa_kernel gated_mix__ssm_conv_s5__moe_arch_mod__prompt_kernel
  .amdhsa_next_free_vgpr 256
  .amdhsa_next_free_sgpr 100
  .amdhsa_accum_offset 256
  .amdhsa_group_segment_fixed_size 0
  .amdhsa_kernarg_size 144
  .amdhsa_user_sgpr_count 2
  .amdhsa_user_sgpr_kernarg_segment_ptr 1
  .amdhsa_system_sgpr_workgroup_id_x 1
  .amdhsa_float_denorm_mode_32 3
.end_amdhsa_kernel
```

```asm
; @launch grid=(256,1,1) block=(512,1,1) lds=163840
.amdgcn_target "amdgcn-amd-amdhsa--gfx950"
.text
.globl gated_mix__ssm_conv_s5__moe_arch_mod__prompt_kernel
.p2align 8
.type gated_mix__ssm_conv_s5__moe_arch_mod__prompt_kernel,@function
gated_mix__ssm_conv_s5__moe_arch_mod__prompt_kernel:
L_code_start:
    s_getpc_b64 s[32:33]
    s_load_dwordx2 s[40:41], s[0:1], 0
    s_load_dwordx16 s[64:79], s[0:1], 8
    s_load_dwordx8 s[44:51], s[0:1], 80
    s_load_dwordx4 s[80:83], s[0:1], 112
    s_load_dwordx2 s[42:43], s[0:1], 136
    v_lshrrev_b32 v1, 6, v0
    s_cmp_ge_u32 s2, 256
    s_cbranch_scc1 L_exit
    s_sub_u32 s32, s32, 4
    s_subb_u32 s33, s33, 0
    s_mov_b32 s34, L_code_end-L_code_start
    s_mov_b32 s35, 0x20000
    s_lshr_b32 s59, s2, 3
    s_lshl_b32 s59, s59, 11
    v_lshlrev_b32 v2, 2, v0
    buffer_load_dword v9, v2, s[32:35], s59 offen
    v_readfirstlane_b32 s18, v1
    s_mov_b32 s96, 1048576
    s_and_b32 s3, s2, 7
    s_lshr_b32 s39, s3, 2
    s_lshl_b32 s39, s39, 1
    s_xor_b32 s3, s3, s39
    s_lshr_b32 s38, s2, 3
    s_lshr_b32 s16, s3, 1
    s_lshl_b32 s16, s16, 2
    s_and_b32 s39, s38, 3
    s_add_u32 s16, s16, s39
    s_and_b32 s17, s3, 1
    s_lshl_b32 s17, s17, 3
    s_lshr_b32 s39, s38, 2
    s_add_u32 s17, s17, s39
    s_cmp_ge_u32 s18, 4
    s_cbranch_scc1 L_side
    v_and_b32 v26, 15, v0
    v_bfe_u32 v4, v0, 7, 1
    v_lshl_add_u32 v4, v4, 5, v26
    s_lshl_b32 s39, s17, 6
    v_add_lshl_u32 v255, s39, v4, 1
    s_waitcnt lgkmcnt(0)
    global_load_ushort v224, v255, s[64:65] offset:0
    global_load_ushort v226, v255, s[66:67] offset:0
    global_load_ushort v228, v255, s[76:77] offset:0
    global_load_ushort v225, v255, s[64:65] offset:32
    global_load_ushort v227, v255, s[66:67] offset:32
    global_load_ushort v229, v255, s[76:77] offset:32
    s_branch L_gemm
L_side:
    s_sub_u32 s18, s18, 4
    v_and_b32 v2, 63, v0
    s_lshl_b32 s19, s3, 8
    s_lshl_b32 s39, s38, 3
    s_add_u32 s19, s19, s39
    s_mov_b32 s56, 0
    s_lshl_b32 s58, s18, 12
    v_lshrrev_b32 v4, 3, v2
    v_and_b32 v5, 7, v2
    v_lshrrev_b32 v6, 4, v2
    v_xor_b32 v5, v5, v6
    v_lshlrev_b32 v5, 4, v5
    v_lshrrev_b32 v7, 1, v2
    v_and_b32 v7, 16, v7
    v_and_or_b32 v7, v2, 8, v7
    v_and_or_b32 v6, v6, 1, v7
    s_lshr_b32 s20, s18, 1
    s_and_b32 s21, s18, 1
    s_lshl_b32 s38, s20, 6
    s_lshl_b32 s39, s21, 2
    s_add_u32 s38, s38, s39
    s_lshl_b32 s39, s16, 7
    s_add_u32 s38, s38, s39
    v_add_u32 v6, s38, v6
    v_lshl_add_u32 v6, v6, 11, v5
    v_xor_b32 v7, 64, v6
    v_add_u32 v100, 3072, v6
    v_add_u32 v101, 67584, v7
    v_add_u32 v102, 5120, v6
    v_add_u32 v103, 69632, v7
    s_lshl_b32 s38, s17, 6
    s_lshl_b32 s39, s20, 5
    s_add_u32 s38, s38, s39
    v_add_u32 v6, s38, v4
    v_lshl_add_u32 v6, v6, 11, v5
    v_xor_b32 v7, 64, v6
    v_add_u32 v104, 3072, v6
    v_add_u32 v105, 18432, v7
    v_add_u32 v106, 33792, v6
    v_add_u32 v107, 49152, v7
    s_waitcnt lgkmcnt(0)
    s_sub_u32 s8, s40, 3072
    s_subb_u32 s9, s41, 0
    s_mov_b32 s10, 4197376
    s_mov_b32 s11, 0x20000
    s_add_u32 m0, s58, 0
    s_add_u32 s57, s56, 0
    s_and_b32 s57, s57, 2047
    buffer_load_dwordx4 v100, s[8:11], s57 offen offset:0  lds
    buffer_load_dwordx4 v101, s[8:11], s57 offen offset:1024  lds
    buffer_load_dwordx4 v102, s[8:11], s57 offen offset:2048  lds
    buffer_load_dwordx4 v103, s[8:11], s57 offen offset:3072  lds
    s_cmp_eq_u32 s21, 0
    s_cselect_b32 s24, s68, s70
    s_cselect_b32 s25, s69, s71
    s_sub_u32 s24, s24, 3072
    s_subb_u32 s25, s25, 0
    s_mov_b32 s26, 2100224
    s_mov_b32 s27, 0x20000
    s_add_u32 m0, s58, 16384
    s_nop 0
    buffer_load_dwordx4 v104, s[24:27], s57 offen offset:0  lds
    buffer_load_dwordx4 v105, s[24:27], s57 offen offset:1024  lds
    buffer_load_dwordx4 v106, s[24:27], s57 offen offset:2048  lds
    buffer_load_dwordx4 v107, s[24:27], s57 offen offset:3072  lds
    s_add_u32 s94, s42, 9469952
    s_addc_u32 s95, s43, 0
    s_load_dword s93, s[94:95], 0
    s_mov_b32 s12, s42
    s_mov_b32 s13, s43
    s_mov_b32 s14, 25165824
    s_mov_b32 s15, 0x20000
    s_mov_b32 s21, 0xffff0000
    v_and_b32 v11, 15, v2
    s_bfe_u32 s38, s2, 0x30003
    s_min_u32 s39, s38, 6
    s_and_b32 s36, s38, 1
    s_cmp_eq_u32 s18, 0
    s_cselect_b64 s[98:99], s[82:83], s[46:47]
    s_cselect_b64 s[100:101], s[42:43], s[48:49]
    s_cselect_b32 s39, s38, s39
    s_mov_b32 s37, s39
    s_cmp_eq_u32 s18, 2
    s_cselect_b64 s[98:99], s[50:51], s[98:99]
    s_cselect_b64 s[100:101], s[42:43], s[100:101]
    s_cselect_b32 s38, 8, 0
    s_add_u32 s37, s37, s38
    s_cmp_eq_u32 s18, 3
    s_cselect_b64 s[98:99], s[72:73], s[98:99]
    s_cselect_b64 s[100:101], s[74:75], s[100:101]
    s_cselect_b32 s39, s36, s39
    s_cselect_b32 s37, s36, s37
    s_lshl_b32 s39, s39, 20
    s_lshl_b32 s37, s37, 20
    s_load_dword s97, s[98:99], s39
    s_load_dword s97, s[100:101], s37
    s_add_u32 m0, s58, 32768
    s_add_u32 s57, s56, 128
    s_and_b32 s57, s57, 2047
    buffer_load_dwordx4 v100, s[8:11], s57 offen offset:0  lds
    buffer_load_dwordx4 v101, s[8:11], s57 offen offset:1024  lds
    buffer_load_dwordx4 v102, s[8:11], s57 offen offset:2048  lds
    buffer_load_dwordx4 v103, s[8:11], s57 offen offset:3072  lds
    s_add_u32 m0, s58, 49152
    s_nop 0
    buffer_load_dwordx4 v104, s[24:27], s57 offen offset:0  lds
    buffer_load_dwordx4 v105, s[24:27], s57 offen offset:1024  lds
    buffer_load_dwordx4 v106, s[24:27], s57 offen offset:2048  lds
    buffer_load_dwordx4 v107, s[24:27], s57 offen offset:3072  lds
    v_lshlrev_b32 v3, 4, v2
    s_mul_hi_u32 s23, s2, 76695845
    s_mul_i32 s38, s23, 56
    s_sub_u32 s22, s2, s38
    v_lshrrev_b32 v5, 3, v2
    v_and_b32 v8, 7, v2
    v_and_b32 v12, 3, v5
    v_lshlrev_b32 v12, 1, v12
    v_xor_b32 v8, v8, v12
    v_mul_u32_u24 v4, 7168, v5
    v_lshl_add_u32 v4, v8, 4, v4
    s_lshl_b32 s38, s18, 6
    s_lshl_b32 s39, s23, 8
    s_add_u32 s44, s38, s39
    s_mul_i32 s45, s44, 7168
    s_lshl_b32 s39, s22, 7
    s_add_u32 s45, s45, s39
    s_lshl_b32 s92, s18, 14
    s_add_u32 s92, s92, 98304
    s_mov_b32 s52, s46
    s_mov_b32 s53, s47
    s_mov_b32 s54, 7340032
    s_mov_b32 s55, 0x20000
    s_mov_b32 s28, s48
    s_mov_b32 s29, s49
    s_mov_b32 s30, 7340032
    s_mov_b32 s31, 0x20000
    s_mov_b32 s46, s92
    s_cmp_ge_u32 s2, 224
    s_cselect_b32 s54, 0, s54
    s_cselect_b32 s30, 0, s30
    s_and_b32 s39, s3, 1
    s_lshl_b32 s36, s39, 9
    s_lshr_b32 s39, s3, 1
    s_lshl_b32 s39, s39, 7
    s_add_u32 s36, s36, s39
    s_lshr_b32 s39, s2, 3
    s_lshl_b32 s39, s39, 2
    s_add_u32 s36, s36, s39
    s_add_u32 s36, s36, s18
    s_lshl_b32 s36, s36, 11
    s_add_u32 s84, s72, s36
    s_addc_u32 s85, s73, 0
    s_add_u32 s86, s74, s36
    s_addc_u32 s87, s75, 0
    s_lshr_b32 s37, s2, 3
    s_mul_i32 s37, s37, 3
    s_lshr_b32 s37, s37, 5
    s_mul_i32 s37, s37, 3
    s_add_u32 s37, s37, 4
    v_lshlrev_b32 v5, 11, v5
    v_lshl_add_u32 v5, v8, 4, v5
    s_lshl_b32 s47, s22, 17
    s_lshl_b32 s39, s23, 9
    s_add_u32 s47, s47, s39
    s_lshl_b32 s39, s18, 7
    s_add_u32 s47, s47, s39
    s_mov_b32 s4, s50
    s_mov_b32 s5, s51
    s_mov_b32 s6, 7340032
    s_mov_b32 s7, 0x20000
    s_cmp_ge_u32 s2, 224
    s_cselect_b32 s6, 0, s6
    v_lshrrev_b32 v10, 4, v2
    v_mov_b32 v23, 1
    s_waitcnt vmcnt(8) lgkmcnt(0)
    s_barrier
    s_mul_i32 s93, s93, 1664525
    s_add_u32 s93, s93, 1013904223
    s_add_u32 m0, s58, 65536
    s_add_u32 s57, s56, 256
    s_and_b32 s57, s57, 2047
    buffer_load_dwordx4 v100, s[8:11], s57 offen offset:0  lds
    buffer_load_dwordx4 v101, s[8:11], s57 offen offset:1024  lds
    buffer_load_dwordx4 v102, s[8:11], s57 offen offset:2048  lds
    buffer_load_dwordx4 v103, s[8:11], s57 offen offset:3072  lds
    s_add_u32 m0, s58, 81920
    s_nop 0
    buffer_load_dwordx4 v104, s[24:27], s57 offen offset:0  lds
    buffer_load_dwordx4 v105, s[24:27], s57 offen offset:1024  lds
    buffer_load_dwordx4 v106, s[24:27], s57 offen offset:2048  lds
    buffer_load_dwordx4 v107, s[24:27], s57 offen offset:3072  lds
    s_cmp_lg_u32 s18, 0
    s_cbranch_scc1 L_s_nk0
    v_lshlrev_b32 v6, 2, v11
    v_add_u32 v6, 163328, v6
    ds_read_b32 v24, v6 offset:0
    ds_read_b32 v25, v6 offset:64
    ds_read_b32 v26, v6 offset:128
    ds_read_b32 v27, v6 offset:192
    ds_read_b32 v28, v6 offset:256
    ds_read_b32 v29, v6 offset:320
    ds_read_b32 v30, v6 offset:384
    ds_read_b32 v31, v6 offset:448
L_s_nk0:
    s_waitcnt vmcnt(8)
    s_barrier
    s_add_u32 m0, s58, 0
    s_add_u32 s57, s56, 384
    s_and_b32 s57, s57, 2047
    buffer_load_dwordx4 v100, s[8:11], s57 offen offset:0  lds
    buffer_load_dwordx4 v101, s[8:11], s57 offen offset:1024  lds
    buffer_load_dwordx4 v102, s[8:11], s57 offen offset:2048  lds
    buffer_load_dwordx4 v103, s[8:11], s57 offen offset:3072  lds
    s_add_u32 m0, s58, 16384
    s_nop 0
    buffer_load_dwordx4 v104, s[24:27], s57 offen offset:0  lds
    buffer_load_dwordx4 v105, s[24:27], s57 offen offset:1024  lds
    buffer_load_dwordx4 v106, s[24:27], s57 offen offset:2048  lds
    buffer_load_dwordx4 v107, s[24:27], s57 offen offset:3072  lds
    s_cmp_lg_u32 s18, 0
    s_cbranch_scc1 L_s_nk1
    v_and_b32 v7, 7, v2
    s_sub_u32 s38, 2047, s19
    v_sub_u32 v21, s38, v7
    v_lshlrev_b32 v7, 3, v7
    v_bfe_u32 v20, v2, 3, 1
    v_lshl_add_u32 v7, v20, 14, v7
    s_waitcnt lgkmcnt(0)
    v_pk_add_f32 v[24:25], v[24:25], v[26:27]
    v_pk_add_f32 v[28:29], v[28:29], v[30:31]
    v_pk_add_f32 v[24:25], v[24:25], v[28:29]
    v_add_f32 v24, v24, v25
L_s_nk1:
    s_load_dword s36, s[84:85], 0
    s_load_dword s36, s[84:85], 64
    s_load_dword s36, s[86:87], 0
    s_load_dword s36, s[86:87], 64
    s_add_u32 s84, s84, 128
    s_addc_u32 s85, s85, 0
    s_add_u32 s86, s86, 128
    s_addc_u32 s87, s87, 0
    s_waitcnt vmcnt(8)
    s_barrier
    s_add_u32 m0, s58, 32768
    s_add_u32 s57, s56, 512
    s_and_b32 s57, s57, 2047
    buffer_load_dwordx4 v100, s[8:11], s57 offen offset:0  lds
    buffer_load_dwordx4 v101, s[8:11], s57 offen offset:1024  lds
    buffer_load_dwordx4 v102, s[8:11], s57 offen offset:2048  lds
    buffer_load_dwordx4 v103, s[8:11], s57 offen offset:3072  lds
    s_add_u32 m0, s58, 49152
    s_nop 0
    buffer_load_dwordx4 v104, s[24:27], s57 offen offset:0  lds
    buffer_load_dwordx4 v105, s[24:27], s57 offen offset:1024  lds
    buffer_load_dwordx4 v106, s[24:27], s57 offen offset:2048  lds
    buffer_load_dwordx4 v107, s[24:27], s57 offen offset:3072  lds
    s_cmp_lg_u32 s18, 0
    s_cbranch_scc1 L_s_nk2
    v_cvt_pk_bf16_f32 v24, v24, v24
    v_lshlrev_b32 v24, 16, v24
    v_mul_f32 v26, 0xbfb8aa3b, v24
    v_exp_f32 v26, v26
    s_nop 0
    v_add_f32 v26, 1.0, v26
    v_rcp_f32 v26, v26
    s_nop 0
    v_cvt_pk_bf16_f32 v26, v26, v26
    v_lshlrev_b32 v26, 16, v26
    v_cmp_eq_u32 vcc, 1, v20
L_s_nk2:
    s_load_dword s36, s[84:85], 0
    s_load_dword s36, s[84:85], 64
    s_load_dword s36, s[86:87], 0
    s_load_dword s36, s[86:87], 64
    s_add_u32 s84, s84, 128
    s_addc_u32 s85, s85, 0
    s_add_u32 s86, s86, 128
    s_addc_u32 s87, s87, 0
    s_waitcnt vmcnt(8)
    s_barrier
    s_add_u32 m0, s58, 65536
    s_add_u32 s57, s56, 640
    s_and_b32 s57, s57, 2047
    buffer_load_dwordx4 v100, s[8:11], s57 offen offset:0  lds
    buffer_load_dwordx4 v101, s[8:11], s57 offen offset:1024  lds
    buffer_load_dwordx4 v102, s[8:11], s57 offen offset:2048  lds
    buffer_load_dwordx4 v103, s[8:11], s57 offen offset:3072  lds
    s_add_u32 m0, s58, 81920
    s_nop 0
    buffer_load_dwordx4 v104, s[24:27], s57 offen offset:0  lds
    buffer_load_dwordx4 v105, s[24:27], s57 offen offset:1024  lds
    buffer_load_dwordx4 v106, s[24:27], s57 offen offset:2048  lds
    buffer_load_dwordx4 v107, s[24:27], s57 offen offset:3072  lds
    s_cmp_lg_u32 s18, 0
    s_cbranch_scc1 L_s_nk3
    v_ashrrev_i32 v25, 31, v24
    v_or_b32 v25, 0x80000000, v25
    v_xor_b32 v24, v24, v25
    v_and_or_b32 v24, v24, s21, v21
    v_cndmask_b32 v24, v24, v26, vcc
    v_mov_b32 v25, s93
    s_lshl_b32 s38, s19, 3
    s_add_u32 s38, s38, 9437184
    s_mov_b64 exec, 0xffff
    buffer_store_dwordx2 v[24:25], v7, s[12:15], s38 offen sc1
    s_mov_b64 exec, -1
L_s_nk3:
    s_load_dword s36, s[84:85], 0
    s_load_dword s36, s[84:85], 64
    s_load_dword s36, s[86:87], 0
    s_load_dword s36, s[86:87], 64
    s_add_u32 s84, s84, 128
    s_addc_u32 s85, s85, 0
    s_add_u32 s86, s86, 128
    s_addc_u32 s87, s87, 0
    s_mov_b32 s20, 4
    s_mov_b32 s19, 0
L_s_loop:
    s_waitcnt vmcnt(8)
    s_barrier
    s_lshl_b32 s94, s18, 12
    s_add_u32 s94, s94, 9437184
    s_cmp_lg_u32 s20, 12
    s_cbranch_scc1 L_s_nokl
    buffer_load_dwordx4 v[80:83], v3, s[12:15], s94 offen offset:0 sc1
    buffer_load_dwordx4 v[84:87], v3, s[12:15], s94 offen offset:1024 sc1
    buffer_load_dwordx4 v[88:91], v3, s[12:15], s94 offen offset:2048 sc1
    buffer_load_dwordx4 v[92:95], v3, s[12:15], s94 offen offset:3072 sc1
L_s_nokl:
    s_add_u32 m0, s58, s19
    s_add_u32 s57, s57, 128
    s_and_b32 s57, s57, 2047
    buffer_load_dwordx4 v100, s[8:11], s57 offen offset:0 lds
    buffer_load_dwordx4 v101, s[8:11], s57 offen offset:1024 lds
    buffer_load_dwordx4 v102, s[8:11], s57 offen offset:2048 lds
    buffer_load_dwordx4 v103, s[8:11], s57 offen offset:3072 lds
    s_add_u32 m0, m0, 16384
    s_add_u32 s19, s19, 32768
    buffer_load_dwordx4 v104, s[24:27], s57 offen offset:0 lds
    buffer_load_dwordx4 v105, s[24:27], s57 offen offset:1024 lds
    buffer_load_dwordx4 v106, s[24:27], s57 offen offset:2048 lds
    buffer_load_dwordx4 v107, s[24:27], s57 offen offset:3072 lds
    s_cmp_eq_u32 s19, 98304
    s_cselect_b32 s19, 0, s19
    s_cmp_lg_u32 s20, s37
    s_cbranch_scc1 L_s_noburst
    s_add_u32 m0, s46, 0
    s_add_u32 s39, s45, 0
    buffer_load_dwordx4 v4, s[52:55], s39 offen nt lds
    s_add_u32 m0, s46, 1024
    s_add_u32 s39, s45, 57344
    buffer_load_dwordx4 v4, s[52:55], s39 offen nt lds
    s_add_u32 m0, s46, 2048
    s_add_u32 s39, s45, 114688
    buffer_load_dwordx4 v4, s[52:55], s39 offen nt lds
    s_add_u32 m0, s46, 3072
    s_add_u32 s39, s45, 172032
    buffer_load_dwordx4 v4, s[52:55], s39 offen nt lds
    s_add_u32 m0, s46, 4096
    s_add_u32 s39, s45, 229376
    buffer_load_dwordx4 v4, s[52:55], s39 offen nt lds
    s_add_u32 m0, s46, 5120
    s_add_u32 s39, s45, 286720
    buffer_load_dwordx4 v4, s[52:55], s39 offen nt lds
    s_add_u32 m0, s46, 6144
    s_add_u32 s39, s45, 344064
    buffer_load_dwordx4 v4, s[52:55], s39 offen nt lds
    s_add_u32 m0, s46, 7168
    s_add_u32 s39, s45, 401408
    buffer_load_dwordx4 v4, s[52:55], s39 offen nt lds
    s_add_u32 m0, s46, 8192
    s_add_u32 s39, s45, 0
    buffer_load_dwordx4 v4, s[28:31], s39 offen nt lds
    s_add_u32 m0, s46, 9216
    s_add_u32 s39, s45, 57344
    buffer_load_dwordx4 v4, s[28:31], s39 offen nt lds
    s_add_u32 m0, s46, 10240
    s_add_u32 s39, s45, 114688
    buffer_load_dwordx4 v4, s[28:31], s39 offen nt lds
    s_add_u32 m0, s46, 11264
    s_add_u32 s39, s45, 172032
    buffer_load_dwordx4 v4, s[28:31], s39 offen nt lds
    s_add_u32 m0, s46, 12288
    s_add_u32 s39, s45, 229376
    buffer_load_dwordx4 v4, s[28:31], s39 offen nt lds
    s_add_u32 m0, s46, 13312
    s_add_u32 s39, s45, 286720
    buffer_load_dwordx4 v4, s[28:31], s39 offen nt lds
    s_add_u32 m0, s46, 14336
    s_add_u32 s39, s45, 344064
    buffer_load_dwordx4 v4, s[28:31], s39 offen nt lds
    s_add_u32 m0, s46, 15360
    s_add_u32 s39, s45, 401408
    buffer_load_dwordx4 v4, s[28:31], s39 offen nt lds
    v_lshlrev_b32 v9, 5, v2
L_s_noburst:
    s_load_dword s36, s[84:85], 0
    s_load_dword s36, s[84:85], 64
    s_load_dword s36, s[86:87], 0
    s_load_dword s36, s[86:87], 64
    s_add_u32 s84, s84, 128
    s_addc_u32 s85, s85, 0
    s_add_u32 s86, s86, 128
    s_addc_u32 s87, s87, 0
    s_add_u32 s20, s20, 1
    s_cmp_lt_u32 s20, 14
    s_cbranch_scc1 L_s_loop
    s_load_dword s36, s[84:85], 0
    s_load_dword s36, s[84:85], 64
    s_load_dword s36, s[86:87], 0
    s_load_dword s36, s[86:87], 64
    s_add_u32 s84, s84, 128
    s_addc_u32 s85, s85, 0
    s_add_u32 s86, s86, 128
    s_addc_u32 s87, s87, 0
    s_waitcnt vmcnt(8)
    s_barrier
    buffer_load_dwordx4 v[200:203], v5, s[4:7], s47 offen nt
    s_add_u32 s47, s47, 16384
    buffer_load_dwordx4 v[204:207], v5, s[4:7], s47 offen nt
    s_add_u32 s47, s47, 16384
    buffer_load_dwordx4 v[208:211], v5, s[4:7], s47 offen nt
    s_add_u32 s47, s47, 16384
    buffer_load_dwordx4 v[212:215], v5, s[4:7], s47 offen nt
    s_add_u32 s47, s47, 16384
    buffer_load_dwordx4 v[216:219], v5, s[4:7], s47 offen nt
    s_add_u32 s47, s47, 16384
    buffer_load_dwordx4 v[220:223], v5, s[4:7], s47 offen nt
    s_add_u32 s47, s47, 16384
    buffer_load_dwordx4 v[224:227], v5, s[4:7], s47 offen nt
    s_add_u32 s47, s47, 16384
    buffer_load_dwordx4 v[228:231], v5, s[4:7], s47 offen nt
    s_add_u32 s47, s47, 16384
    v_bfe_u32 v12, v2, 2, 2
    v_lshl_add_u32 v13, v10, 3, v12
    v_lshlrev_b32 v13, 7, v13
    v_and_b32 v14, 3, v2
    v_lshl_add_u32 v13, v14, 3, v13
    v_add_u32 v13, s46, v13
    v_xor_b32 v14, 0, v12
    v_lshl_add_u32 v16, v14, 5, v13
    v_xor_b32 v14, 1, v12
    v_lshl_add_u32 v17, v14, 5, v13
    v_xor_b32 v14, 2, v12
    v_lshl_add_u32 v18, v14, 5, v13
    v_xor_b32 v14, 3, v12
    v_lshl_add_u32 v19, v14, 5, v13
    s_mov_b32 s8, s40
    s_mov_b32 s9, s41
    s_mov_b32 s10, 4194304
    s_mov_b32 s11, 0x20000
    v_mov_b32 v22, 73728
    s_waitcnt vmcnt(8)
    s_barrier
    s_load_dword s36, s[84:85], 0
    s_load_dword s36, s[84:85], 64
    s_load_dword s36, s[86:87], 0
    s_load_dword s36, s[86:87], 64
    s_add_u32 s84, s84, 128
    s_addc_u32 s85, s85, 0
    s_add_u32 s86, s86, 128
    s_addc_u32 s87, s87, 0
    s_load_dword s36, s[84:85], 0
    s_load_dword s36, s[84:85], 64
    s_load_dword s36, s[86:87], 0
    s_load_dword s36, s[86:87], 64
    s_add_u32 s84, s84, 128
    s_addc_u32 s85, s85, 0
    s_add_u32 s86, s86, 128
    s_addc_u32 s87, s87, 0
    s_barrier
    v_mov_b32 v8, 0
    s_mov_b32 s95, -1
L_s_poll:
    v_xor_b32 v81, s93, v81
    v_xor_b32 v83, s93, v83
    v_xor_b32 v85, s93, v85
    v_xor_b32 v87, s93, v87
    v_xor_b32 v89, s93, v89
    v_xor_b32 v91, s93, v91
    v_xor_b32 v93, s93, v93
    v_xor_b32 v95, s93, v95
    v_or3_b32 v9, v81, v83, v85
    v_or3_b32 v9, v9, v87, v89
    v_or3_b32 v9, v9, v91, v93
    v_or_b32 v9, v9, v95
    v_cmp_ne_u32 vcc, 0, v9
    s_nop 1
    s_cmp_eq_u64 vcc, 0
    s_cbranch_scc1 L_s_go
    s_sub_u32 s96, s96, 1
    s_cbranch_scc1 L_s_go
    buffer_load_dwordx4 v[80:83], v3, s[12:15], s94 offen offset:0 sc1
    buffer_load_dwordx4 v[84:87], v3, s[12:15], s94 offen offset:1024 sc1
    buffer_load_dwordx4 v[88:91], v3, s[12:15], s94 offen offset:2048 sc1
    buffer_load_dwordx4 v[92:95], v3, s[12:15], s94 offen offset:3072 sc1
    s_waitcnt vmcnt(0)
    s_branch L_s_poll
L_s_go:
    v_sub_u32 v72, s95, v80
    v_sub_u32 v73, s95, v82
    v_sub_u32 v74, s95, v84
    v_sub_u32 v75, s95, v86
    v_sub_u32 v76, s95, v88
    v_sub_u32 v77, s95, v90
    v_sub_u32 v78, s95, v92
    v_sub_u32 v79, s95, v94
    v_min3_u32 v9, v72, v73, v74
    v_min3_u32 v15, v75, v76, v77
    v_min3_u32 v9, v9, v78, v79
    v_min_u32 v9, v9, v15
    s_nop 1
    v_min_u32_dpp v9, v9, v9 row_ror:8 row_mask:0xf bank_mask:0xf
    s_nop 1
    v_min_u32_dpp v9, v9, v9 row_ror:4 row_mask:0xf bank_mask:0xf
    s_nop 1
    v_min_u32_dpp v9, v9, v9 row_ror:2 row_mask:0xf bank_mask:0xf
    s_nop 1
    v_min_u32_dpp v9, v9, v9 row_ror:1 row_mask:0xf bank_mask:0xf
    s_nop 0
    v_readlane_b32 s48, v9, 0
    v_readlane_b32 s49, v9, 16
    v_readlane_b32 s50, v9, 32
    v_readlane_b32 s51, v9, 48
    s_nop 0
    s_min_u32 s48, s48, s49
    s_min_u32 s50, s50, s51
    s_min_u32 s48, s48, s50
    s_sub_u32 s95, s95, s48
    v_writelane_b32 v8, s95, 0
    s_sub_u32 s95, s95, 1
    v_sub_u32 v72, s95, v80
    v_sub_u32 v73, s95, v82
    v_sub_u32 v74, s95, v84
    v_sub_u32 v75, s95, v86
    v_sub_u32 v76, s95, v88
    v_sub_u32 v77, s95, v90
    v_sub_u32 v78, s95, v92
    v_sub_u32 v79, s95, v94
    v_min3_u32 v9, v72, v73, v74
    v_min3_u32 v15, v75, v76, v77
    v_min3_u32 v9, v9, v78, v79
    v_min_u32 v9, v9, v15
    s_nop 1
    v_min_u32_dpp v9, v9, v9 row_ror:8 row_mask:0xf bank_mask:0xf
    s_nop 1
    v_min_u32_dpp v9, v9, v9 row_ror:4 row_mask:0xf bank_mask:0xf
    s_nop 1
    v_min_u32_dpp v9, v9, v9 row_ror:2 row_mask:0xf bank_mask:0xf
    s_nop 1
    v_min_u32_dpp v9, v9, v9 row_ror:1 row_mask:0xf bank_mask:0xf
    s_nop 0
    v_readlane_b32 s48, v9, 0
    v_readlane_b32 s49, v9, 16
    v_readlane_b32 s50, v9, 32
    v_readlane_b32 s51, v9, 48
    s_nop 0
    s_min_u32 s48, s48, s49
    s_min_u32 s50, s50, s51
    s_min_u32 s48, s48, s50
    s_sub_u32 s95, s95, s48
    v_writelane_b32 v8, s95, 1
    s_sub_u32 s95, s95, 1
    v_sub_u32 v72, s95, v80
    v_sub_u32 v73, s95, v82
    v_sub_u32 v74, s95, v84
    v_sub_u32 v75, s95, v86
    v_sub_u32 v76, s95, v88
    v_sub_u32 v77, s95, v90
    v_sub_u32 v78, s95, v92
    v_sub_u32 v79, s95, v94
    v_min3_u32 v9, v72, v73, v74
    v_min3_u32 v15, v75, v76, v77
    v_min3_u32 v9, v9, v78, v79
    v_min_u32 v9, v9, v15
    s_nop 1
    v_min_u32_dpp v9, v9, v9 row_ror:8 row_mask:0xf bank_mask:0xf
    s_nop 1
    v_min_u32_dpp v9, v9, v9 row_ror:4 row_mask:0xf bank_mask:0xf
    s_nop 1
    v_min_u32_dpp v9, v9, v9 row_ror:2 row_mask:0xf bank_mask:0xf
    s_nop 1
    v_min_u32_dpp v9, v9, v9 row_ror:1 row_mask:0xf bank_mask:0xf
    s_nop 0
    v_readlane_b32 s48, v9, 0
    v_readlane_b32 s49, v9, 16
    v_readlane_b32 s50, v9, 32
    v_readlane_b32 s51, v9, 48
    s_nop 0
    s_min_u32 s48, s48, s49
    s_min_u32 s50, s50, s51
    s_min_u32 s48, s48, s50
    s_sub_u32 s95, s95, s48
    v_writelane_b32 v8, s95, 2
    s_sub_u32 s95, s95, 1
    v_sub_u32 v72, s95, v80
    v_sub_u32 v73, s95, v82
    v_sub_u32 v74, s95, v84
    v_sub_u32 v75, s95, v86
    v_sub_u32 v76, s95, v88
    v_sub_u32 v77, s95, v90
    v_sub_u32 v78, s95, v92
    v_sub_u32 v79, s95, v94
    v_min3_u32 v9, v72, v73, v74
    v_min3_u32 v15, v75, v76, v77
    v_min3_u32 v9, v9, v78, v79
    v_min_u32 v9, v9, v15
    s_nop 1
    v_min_u32_dpp v9, v9, v9 row_ror:8 row_mask:0xf bank_mask:0xf
    s_nop 1
    v_min_u32_dpp v9, v9, v9 row_ror:4 row_mask:0xf bank_mask:0xf
    s_nop 1
    v_min_u32_dpp v9, v9, v9 row_ror:2 row_mask:0xf bank_mask:0xf
    s_nop 1
    v_min_u32_dpp v9, v9, v9 row_ror:1 row_mask:0xf bank_mask:0xf
    s_nop 0
    v_readlane_b32 s48, v9, 0
    v_readlane_b32 s49, v9, 16
    v_readlane_b32 s50, v9, 32
    v_readlane_b32 s51, v9, 48
    s_nop 0
    s_min_u32 s48, s48, s49
    s_min_u32 s50, s50, s51
    s_min_u32 s48, s48, s50
    s_sub_u32 s95, s95, s48
    v_writelane_b32 v8, s95, 3
    s_sub_u32 s95, s95, 1
    v_sub_u32 v72, s95, v80
    v_sub_u32 v73, s95, v82
    v_sub_u32 v74, s95, v84
    v_sub_u32 v75, s95, v86
    v_sub_u32 v76, s95, v88
    v_sub_u32 v77, s95, v90
    v_sub_u32 v78, s95, v92
    v_sub_u32 v79, s95, v94
    v_min3_u32 v9, v72, v73, v74
    v_min3_u32 v15, v75, v76, v77
    v_min3_u32 v9, v9, v78, v79
    v_min_u32 v9, v9, v15
    s_nop 1
    v_min_u32_dpp v9, v9, v9 row_ror:8 row_mask:0xf bank_mask:0xf
    s_nop 1
    v_min_u32_dpp v9, v9, v9 row_ror:4 row_mask:0xf bank_mask:0xf
    s_nop 1
    v_min_u32_dpp v9, v9, v9 row_ror:2 row_mask:0xf bank_mask:0xf
    s_nop 1
    v_min_u32_dpp v9, v9, v9 row_ror:1 row_mask:0xf bank_mask:0xf
    s_nop 0
    v_readlane_b32 s48, v9, 0
    v_readlane_b32 s49, v9, 16
    v_readlane_b32 s50, v9, 32
    v_readlane_b32 s51, v9, 48
    s_nop 0
    s_min_u32 s48, s48, s49
    s_min_u32 s50, s50, s51
    s_min_u32 s48, s48, s50
    s_sub_u32 s95, s95, s48
    v_writelane_b32 v8, s95, 4
    s_sub_u32 s95, s95, 1
    v_sub_u32 v72, s95, v80
    v_sub_u32 v73, s95, v82
    v_sub_u32 v74, s95, v84
    v_sub_u32 v75, s95, v86
    v_sub_u32 v76, s95, v88
    v_sub_u32 v77, s95, v90
    v_sub_u32 v78, s95, v92
    v_sub_u32 v79, s95, v94
    v_min3_u32 v9, v72, v73, v74
    v_min3_u32 v15, v75, v76, v77
    v_min3_u32 v9, v9, v78, v79
    v_min_u32 v9, v9, v15
    s_nop 1
    v_min_u32_dpp v9, v9, v9 row_ror:8 row_mask:0xf bank_mask:0xf
    s_nop 1
    v_min_u32_dpp v9, v9, v9 row_ror:4 row_mask:0xf bank_mask:0xf
    s_nop 1
    v_min_u32_dpp v9, v9, v9 row_ror:2 row_mask:0xf bank_mask:0xf
    s_nop 1
    v_min_u32_dpp v9, v9, v9 row_ror:1 row_mask:0xf bank_mask:0xf
    s_nop 0
    v_readlane_b32 s48, v9, 0
    v_readlane_b32 s49, v9, 16
    v_readlane_b32 s50, v9, 32
    v_readlane_b32 s51, v9, 48
    s_nop 0
    s_min_u32 s48, s48, s49
    s_min_u32 s50, s50, s51
    s_min_u32 s48, s48, s50
    s_sub_u32 s95, s95, s48
    v_writelane_b32 v8, s95, 5
    s_sub_u32 s95, s95, 1
    v_sub_u32 v72, s95, v80
    v_sub_u32 v73, s95, v82
    v_sub_u32 v74, s95, v84
    v_sub_u32 v75, s95, v86
    v_sub_u32 v76, s95, v88
    v_sub_u32 v77, s95, v90
    v_sub_u32 v78, s95, v92
    v_sub_u32 v79, s95, v94
    v_min3_u32 v9, v72, v73, v74
    v_min3_u32 v15, v75, v76, v77
    v_min3_u32 v9, v9, v78, v79
    v_min_u32 v9, v9, v15
    s_nop 1
    v_min_u32_dpp v9, v9, v9 row_ror:8 row_mask:0xf bank_mask:0xf
    s_nop 1
    v_min_u32_dpp v9, v9, v9 row_ror:4 row_mask:0xf bank_mask:0xf
    s_nop 1
    v_min_u32_dpp v9, v9, v9 row_ror:2 row_mask:0xf bank_mask:0xf
    s_nop 1
    v_min_u32_dpp v9, v9, v9 row_ror:1 row_mask:0xf bank_mask:0xf
    s_nop 0
    v_readlane_b32 s48, v9, 0
    v_readlane_b32 s49, v9, 16
    v_readlane_b32 s50, v9, 32
    v_readlane_b32 s51, v9, 48
    s_nop 0
    s_min_u32 s48, s48, s49
    s_min_u32 s50, s50, s51
    s_min_u32 s48, s48, s50
    s_sub_u32 s95, s95, s48
    v_writelane_b32 v8, s95, 6
    s_sub_u32 s95, s95, 1
    v_sub_u32 v72, s95, v80
    v_sub_u32 v73, s95, v82
    v_sub_u32 v74, s95, v84
    v_sub_u32 v75, s95, v86
    v_sub_u32 v76, s95, v88
    v_sub_u32 v77, s95, v90
    v_sub_u32 v78, s95, v92
    v_sub_u32 v79, s95, v94
    v_min3_u32 v9, v72, v73, v74
    v_min3_u32 v15, v75, v76, v77
    v_min3_u32 v9, v9, v78, v79
    v_min_u32 v9, v9, v15
    s_nop 1
    v_min_u32_dpp v9, v9, v9 row_ror:8 row_mask:0xf bank_mask:0xf
    s_nop 1
    v_min_u32_dpp v9, v9, v9 row_ror:4 row_mask:0xf bank_mask:0xf
    s_nop 1
    v_min_u32_dpp v9, v9, v9 row_ror:2 row_mask:0xf bank_mask:0xf
    s_nop 1
    v_min_u32_dpp v9, v9, v9 row_ror:1 row_mask:0xf bank_mask:0xf
    s_nop 0
    v_readlane_b32 s48, v9, 0
    v_readlane_b32 s49, v9, 16
    v_readlane_b32 s50, v9, 32
    v_readlane_b32 s51, v9, 48
    s_nop 0
    s_min_u32 s48, s48, s49
    s_min_u32 s50, s50, s51
    s_min_u32 s48, s48, s50
    s_sub_u32 s95, s95, s48
    v_writelane_b32 v8, s95, 7
    s_sub_u32 s95, s95, 1
    s_lshl_b32 s38, s18, 5
    s_add_u32 s38, s38, 73856
    v_lshl_add_u32 v9, v2, 2, s38
    v_mov_b32 v15, 73856
    s_mov_b64 exec, 0xff
    ds_write_b32 v9, v8
    s_mov_b64 exec, 1
    ds_add_u32 v22, v23 offset:8
    s_mov_b64 exec, -1
L_s_cw:
    ds_read_b32 v14, v22 offset:8
    s_waitcnt lgkmcnt(0)
    v_readfirstlane_b32 s38, v14
    s_nop 1
    s_cmp_ge_u32 s38, 4
    s_cbranch_scc1 L_s_cw_ok
    s_sub_u32 s96, s96, 1
    s_cbranch_scc1 L_s_cw_ok
    s_sleep 0
    s_branch L_s_cw
L_s_cw_ok:
    v_and_b32 v9, 31, v2
    v_lshl_add_u32 v9, v9, 2, v15
    ds_read_b32 v14, v9
    ds_read_b128 v[64:67], v15 offset:0
    ds_read_b128 v[68:71], v15 offset:16
    ds_read_b128 v[72:75], v15 offset:32
    ds_read_b128 v[76:79], v15 offset:48
    ds_read_b128 v[80:83], v15 offset:64
    ds_read_b128 v[84:87], v15 offset:80
    ds_read_b128 v[88:91], v15 offset:96
    ds_read_b128 v[92:95], v15 offset:112
    v_mov_b32 v12, 0
    s_waitcnt lgkmcnt(0)
    v_cmp_gt_u32 s[48:49], v64, v14
    v_cmp_gt_u32 s[50:51], v65, v14
    s_nop 0
    v_addc_co_u32 v12, vcc, 0, v12, s[48:49]
    v_addc_co_u32 v12, vcc, 0, v12, s[50:51]
    v_cmp_gt_u32 s[48:49], v66, v14
    v_cmp_gt_u32 s[50:51], v67, v14
    s_nop 0
    v_addc_co_u32 v12, vcc, 0, v12, s[48:49]
    v_addc_co_u32 v12, vcc, 0, v12, s[50:51]
    v_cmp_gt_u32 s[48:49], v68, v14
    v_cmp_gt_u32 s[50:51], v69, v14
    s_nop 0
    v_addc_co_u32 v12, vcc, 0, v12, s[48:49]
    v_addc_co_u32 v12, vcc, 0, v12, s[50:51]
    v_cmp_gt_u32 s[48:49], v70, v14
    v_cmp_gt_u32 s[50:51], v71, v14
    s_nop 0
    v_addc_co_u32 v12, vcc, 0, v12, s[48:49]
    v_addc_co_u32 v12, vcc, 0, v12, s[50:51]
    v_cmp_gt_u32 s[48:49], v72, v14
    v_cmp_gt_u32 s[50:51], v73, v14
    s_nop 0
    v_addc_co_u32 v12, vcc, 0, v12, s[48:49]
    v_addc_co_u32 v12, vcc, 0, v12, s[50:51]
    v_cmp_gt_u32 s[48:49], v74, v14
    v_cmp_gt_u32 s[50:51], v75, v14
    s_nop 0
    v_addc_co_u32 v12, vcc, 0, v12, s[48:49]
    v_addc_co_u32 v12, vcc, 0, v12, s[50:51]
    v_cmp_gt_u32 s[48:49], v76, v14
    v_cmp_gt_u32 s[50:51], v77, v14
    s_nop 0
    v_addc_co_u32 v12, vcc, 0, v12, s[48:49]
    v_addc_co_u32 v12, vcc, 0, v12, s[50:51]
    v_cmp_gt_u32 s[48:49], v78, v14
    v_cmp_gt_u32 s[50:51], v79, v14
    s_nop 0
    v_addc_co_u32 v12, vcc, 0, v12, s[48:49]
    v_addc_co_u32 v12, vcc, 0, v12, s[50:51]
    v_cmp_gt_u32 s[48:49], v80, v14
    v_cmp_gt_u32 s[50:51], v81, v14
    s_nop 0
    v_addc_co_u32 v12, vcc, 0, v12, s[48:49]
    v_addc_co_u32 v12, vcc, 0, v12, s[50:51]
    v_cmp_gt_u32 s[48:49], v82, v14
    v_cmp_gt_u32 s[50:51], v83, v14
    s_nop 0
    v_addc_co_u32 v12, vcc, 0, v12, s[48:49]
    v_addc_co_u32 v12, vcc, 0, v12, s[50:51]
    v_cmp_gt_u32 s[48:49], v84, v14
    v_cmp_gt_u32 s[50:51], v85, v14
    s_nop 0
    v_addc_co_u32 v12, vcc, 0, v12, s[48:49]
    v_addc_co_u32 v12, vcc, 0, v12, s[50:51]
    v_cmp_gt_u32 s[48:49], v86, v14
    v_cmp_gt_u32 s[50:51], v87, v14
    s_nop 0
    v_addc_co_u32 v12, vcc, 0, v12, s[48:49]
    v_addc_co_u32 v12, vcc, 0, v12, s[50:51]
    v_cmp_gt_u32 s[48:49], v88, v14
    v_cmp_gt_u32 s[50:51], v89, v14
    s_nop 0
    v_addc_co_u32 v12, vcc, 0, v12, s[48:49]
    v_addc_co_u32 v12, vcc, 0, v12, s[50:51]
    v_cmp_gt_u32 s[48:49], v90, v14
    v_cmp_gt_u32 s[50:51], v91, v14
    s_nop 0
    v_addc_co_u32 v12, vcc, 0, v12, s[48:49]
    v_addc_co_u32 v12, vcc, 0, v12, s[50:51]
    v_cmp_gt_u32 s[48:49], v92, v14
    v_cmp_gt_u32 s[50:51], v93, v14
    s_nop 0
    v_addc_co_u32 v12, vcc, 0, v12, s[48:49]
    v_addc_co_u32 v12, vcc, 0, v12, s[50:51]
    v_cmp_gt_u32 s[48:49], v94, v14
    v_cmp_gt_u32 s[50:51], v95, v14
    s_nop 0
    v_addc_co_u32 v12, vcc, 0, v12, s[48:49]
    v_addc_co_u32 v12, vcc, 0, v12, s[50:51]
    v_lshlrev_b32 v12, 2, v12
    s_mov_b32 exec_hi, 0
    ds_permute_b32 v13, v12, v14
    s_mov_b64 exec, -1
    v_and_b32 v12, 7, v2
    v_lshlrev_b32 v12, 2, v12
    s_waitcnt lgkmcnt(0)
    ds_bpermute_b32 v8, v12, v13
    s_lshl_b32 s38, s44, 1
    s_and_b32 s38, s38, 2047
    s_waitcnt lgkmcnt(0)
    v_not_b32 v9, v8
    v_and_b32 v9, 0x7ff, v9
    v_lshlrev_b32 v9, 11, v9
    v_lshl_add_u32 v9, v10, 4, v9
    buffer_load_dwordx4 v[56:59], v9, s[8:11], s38 offen offset:0
    buffer_load_dwordx4 v[60:63], v9, s[8:11], s38 offen offset:64
    v_lshlrev_b32 v9, 2, v2
    v_add_u32 v9, 73984, v9
    s_mov_b64 exec, 0xff
    ds_write_b32 v9, v8
    s_mov_b64 exec, 1
    ds_add_u32 v22, v23 offset:32
    s_mov_b64 exec, -1
    s_or_b32 s38, s2, s18
    s_cbranch_scc1 L_s_noep
    s_mov_b64 exec, 1
    s_mov_b32 s38, 9469952
    v_mov_b32 v13, s93
    v_mov_b32 v9, 0
    buffer_store_dword v13, v9, s[12:15], s38 offen
    s_mov_b64 exec, -1
L_s_noep:
    s_cmp_ge_u32 s2, 224
    s_cbranch_scc1 L_s_cons
    s_waitcnt vmcnt(0)
    s_setprio 2
    ds_read_b64_tr_b16 v[100:101], v16 offset:0
    ds_read_b64_tr_b16 v[102:103], v16 offset:512
    ds_read_b64_tr_b16 v[104:105], v16 offset:4096
    ds_read_b64_tr_b16 v[106:107], v16 offset:4608
    ds_read_b64_tr_b16 v[108:109], v17 offset:0
    ds_read_b64_tr_b16 v[110:111], v17 offset:512
    ds_read_b64_tr_b16 v[112:113], v17 offset:4096
    ds_read_b64_tr_b16 v[114:115], v17 offset:4608
    ds_read_b64_tr_b16 v[116:117], v18 offset:0
    ds_read_b64_tr_b16 v[118:119], v18 offset:512
    ds_read_b64_tr_b16 v[120:121], v18 offset:4096
    ds_read_b64_tr_b16 v[122:123], v18 offset:4608
    ds_read_b64_tr_b16 v[124:125], v19 offset:0
    ds_read_b64_tr_b16 v[126:127], v19 offset:512
    ds_read_b64_tr_b16 v[128:129], v19 offset:4096
    ds_read_b64_tr_b16 v[130:131], v19 offset:4608
    s_waitcnt lgkmcnt(0)
    ds_read_b64_tr_b16 v[132:133], v16 offset:8192
    ds_read_b64_tr_b16 v[134:135], v16 offset:8704
    ds_read_b64_tr_b16 v[136:137], v16 offset:12288
    ds_read_b64_tr_b16 v[138:139], v16 offset:12800
    ds_read_b64_tr_b16 v[140:141], v17 offset:8192
    ds_read_b64_tr_b16 v[142:143], v17 offset:8704
    ds_read_b64_tr_b16 v[144:145], v17 offset:12288
    ds_read_b64_tr_b16 v[146:147], v17 offset:12800
    ds_read_b64_tr_b16 v[148:149], v18 offset:8192
    ds_read_b64_tr_b16 v[150:151], v18 offset:8704
    ds_read_b64_tr_b16 v[152:153], v18 offset:12288
    ds_read_b64_tr_b16 v[154:155], v18 offset:12800
    ds_read_b64_tr_b16 v[156:157], v19 offset:8192
    ds_read_b64_tr_b16 v[158:159], v19 offset:8704
    ds_read_b64_tr_b16 v[160:161], v19 offset:12288
    ds_read_b64_tr_b16 v[162:163], v19 offset:12800
    s_waitcnt lgkmcnt(0)
    v_mfma_f32_16x16x32_bf16 v[24:27], v[100:103], v[56:59], 0
    v_mfma_f32_16x16x32_bf16 v[28:31], v[108:111], v[56:59], 0
    v_mfma_f32_16x16x32_bf16 v[32:35], v[116:119], v[56:59], 0
    v_mfma_f32_16x16x32_bf16 v[36:39], v[124:127], v[56:59], 0
    v_mfma_f32_16x16x32_bf16 v[40:43], v[132:135], v[56:59], 0
    v_mfma_f32_16x16x32_bf16 v[44:47], v[140:143], v[56:59], 0
    v_mfma_f32_16x16x32_bf16 v[48:51], v[148:151], v[56:59], 0
    v_mfma_f32_16x16x32_bf16 v[52:55], v[156:159], v[56:59], 0
    v_mfma_f32_16x16x32_bf16 v[24:27], v[104:107], v[60:63], v[24:27]
    v_mfma_f32_16x16x32_bf16 v[28:31], v[112:115], v[60:63], v[28:31]
    v_mfma_f32_16x16x32_bf16 v[32:35], v[120:123], v[60:63], v[32:35]
    v_mfma_f32_16x16x32_bf16 v[36:39], v[128:131], v[60:63], v[36:39]
    v_mfma_f32_16x16x32_bf16 v[40:43], v[136:139], v[60:63], v[40:43]
    v_mfma_f32_16x16x32_bf16 v[44:47], v[144:147], v[60:63], v[44:47]
    v_mfma_f32_16x16x32_bf16 v[48:51], v[152:155], v[60:63], v[48:51]
    v_mfma_f32_16x16x32_bf16 v[52:55], v[160:163], v[60:63], v[52:55]
    v_add_u32 v13, s46, v3
    s_nop 7
    ds_write_b128 v13, v[24:27] offset:0
    ds_write_b128 v13, v[28:31] offset:1024
    ds_write_b128 v13, v[32:35] offset:2048
    ds_write_b128 v13, v[36:39] offset:3072
    ds_write_b128 v13, v[40:43] offset:4096
    ds_write_b128 v13, v[44:47] offset:5120
    ds_write_b128 v13, v[48:51] offset:6144
    ds_write_b128 v13, v[52:55] offset:7168
    s_mov_b64 exec, 1
    ds_add_u32 v22, v23 offset:0
    s_mov_b64 exec, -1
    v_and_b32 v14, 8, v2
    v_lshl_add_u32 v13, v14, 7, v3
    s_lshl_b32 s38, s18, 11
    s_add_u32 s38, s38, 98304
    v_add_u32 v13, s38, v13
    v_and_b32 v12, 7, v2
    v_mul_u32_u24 v12, 14336, v12
    v_lshl_add_u32 v12, v10, 4, v12
    v_lshl_add_u32 v12, v14, 3, v12
    s_mul_i32 s56, s23, 229376
    s_lshl_b32 s39, s22, 8
    s_add_u32 s56, s56, s39
    s_lshr_b32 s39, s18, 1
    s_mul_i32 s39, s39, 114688
    s_add_u32 s56, s56, s39
    s_and_b32 s39, s18, 1
    s_lshl_b32 s39, s39, 7
    s_add_u32 s56, s56, s39
    s_add_u32 s56, s56, 10485760
L_s_guw:
    ds_read_b32 v15, v22 offset:0
    s_waitcnt lgkmcnt(0)
    v_readfirstlane_b32 s38, v15
    s_nop 1
    s_cmp_ge_u32 s38, 4
    s_cbranch_scc1 L_s_guw_ok
    s_sub_u32 s96, s96, 1
    s_cbranch_scc1 L_s_guw_ok
    s_sleep 0
    s_branch L_s_guw
L_s_guw_ok:
    ds_read_b128 v[64:67], v13 offset:0
    ds_read_b128 v[68:71], v13 offset:16384
    ds_read_b128 v[72:75], v13 offset:32768
    ds_read_b128 v[76:79], v13 offset:49152
    s_lshl_b32 s58, s22, 10
    s_lshl_b32 s39, s23, 8
    s_add_u32 s58, s58, s39
    s_add_u32 s58, s58, 9568256
    s_waitcnt lgkmcnt(0)
    v_pk_add_f32 v[64:65], v[64:65], v[68:69]
    v_pk_add_f32 v[72:73], v[72:73], v[76:77]
    v_pk_add_f32 v[64:65], v[64:65], v[72:73]
    v_pk_add_f32 v[66:67], v[66:67], v[70:71]
    v_pk_add_f32 v[74:75], v[74:75], v[78:79]
    v_pk_add_f32 v[66:67], v[66:67], v[74:75]
    buffer_store_dwordx4 v[64:67], v12, s[12:15], s56 offen sc1
    v_mov_b32 v13, s93
    v_lshlrev_b32 v14, 2, v2
    s_waitcnt vmcnt(0)
    v_mov_b32 v15, 1
    s_mov_b64 exec, 1
    ds_add_rtn_u32 v15, v22, v15 offset:28
    s_mov_b64 exec, -1
    s_waitcnt lgkmcnt(0)
    v_readfirstlane_b32 s39, v15
    s_nop 1
    s_cmp_lg_u32 s39, 3
    s_cbranch_scc1 L_s_nogf
    s_mov_b32 exec_hi, 0
    buffer_store_dword v13, v14, s[12:15], s58 offen sc1
    s_mov_b32 exec_hi, -1
L_s_nogf:
    v_add_u32 v13, s46, v3
    ds_write_b128 v13, v[200:203] offset:8192
    ds_write_b128 v13, v[204:207] offset:9216
    ds_write_b128 v13, v[208:211] offset:10240
    ds_write_b128 v13, v[212:215] offset:11264
    ds_write_b128 v13, v[216:219] offset:12288
    ds_write_b128 v13, v[220:223] offset:13312
    ds_write_b128 v13, v[224:227] offset:14336
    ds_write_b128 v13, v[228:231] offset:15360
    s_lshl_b32 s56, s22, 10
    s_add_u32 s56, s56, 9568256
    v_and_b32 v13, 3, v2
    v_lshlrev_b32 v13, 8, v13
    v_lshrrev_b32 v6, 5, v2
    v_lshl_add_u32 v6, s18, 1, v6
    v_and_b32 v7, 1, v10
    v_lshl_add_u32 v9, v7, 3, v6
    v_mul_u32_u24 v9, 14336, v9
    v_lshl_add_u32 v9, v11, 4, v9
    s_cmp_lg_u32 s18, 0
    s_cbranch_scc1 L_s_gw
L_s_gpoll:
    s_mov_b64 exec, 0xf
    buffer_load_dword v14, v13, s[12:15], s56 offen sc1
    s_waitcnt vmcnt(0)
    v_cmp_ne_u32 vcc, s93, v14
    s_mov_b64 exec, -1
    s_nop 0
    s_cmp_eq_u64 vcc, 0
    s_cbranch_scc1 L_s_ggo
    s_sub_u32 s96, s96, 1
    s_cbranch_scc1 L_s_ggo
    s_sleep 6
    s_branch L_s_gpoll
L_s_ggo:
    s_mov_b64 exec, 1
    ds_add_u32 v22, v23 offset:68
    s_mov_b64 exec, -1
L_s_gw:
    ds_read_b32 v15, v22 offset:68
    s_waitcnt lgkmcnt(0)
    v_readfirstlane_b32 s38, v15
    s_nop 1
    s_cmp_ge_u32 s38, 1
    s_cbranch_scc1 L_s_gw_ok
    s_sub_u32 s96, s96, 1
    s_cbranch_scc1 L_s_gw_ok
    s_sleep 2
    s_branch L_s_gw
L_s_gw_ok:
    s_lshl_b32 s38, s22, 8
    s_add_u32 s38, s38, 10485760
    buffer_load_dwordx4 v[24:27], v9, s[12:15], s38 offen sc1
    s_add_u32 s38, s38, 229376
    buffer_load_dwordx4 v[28:31], v9, s[12:15], s38 offen sc1
    s_add_u32 s38, s38, 229376
    buffer_load_dwordx4 v[32:35], v9, s[12:15], s38 offen sc1
    s_add_u32 s38, s38, 229376
    buffer_load_dwordx4 v[36:39], v9, s[12:15], s38 offen sc1
    s_add_u32 s38, s38, 229376
    ds_read_b64_tr_b16 v[64:65], v16 offset:8192
    ds_read_b64_tr_b16 v[66:67], v16 offset:8704
    ds_read_b64_tr_b16 v[68:69], v16 offset:12288
    ds_read_b64_tr_b16 v[70:71], v16 offset:12800
    ds_read_b64_tr_b16 v[72:73], v17 offset:8192
    ds_read_b64_tr_b16 v[74:75], v17 offset:8704
    ds_read_b64_tr_b16 v[76:77], v17 offset:12288
    ds_read_b64_tr_b16 v[78:79], v17 offset:12800
    ds_read_b64_tr_b16 v[80:81], v18 offset:8192
    ds_read_b64_tr_b16 v[82:83], v18 offset:8704
    ds_read_b64_tr_b16 v[84:85], v18 offset:12288
    ds_read_b64_tr_b16 v[86:87], v18 offset:12800
    ds_read_b64_tr_b16 v[88:89], v19 offset:8192
    ds_read_b64_tr_b16 v[90:91], v19 offset:8704
    ds_read_b64_tr_b16 v[92:93], v19 offset:12288
    ds_read_b64_tr_b16 v[94:95], v19 offset:12800
    s_waitcnt vmcnt(0)
    v_pk_add_f32 v[24:25], v[24:25], v[28:29]
    v_pk_add_f32 v[32:33], v[32:33], v[36:37]
    v_pk_add_f32 v[24:25], v[24:25], v[32:33]
    v_pk_add_f32 v[26:27], v[26:27], v[30:31]
    v_pk_add_f32 v[34:35], v[34:35], v[38:39]
    v_pk_add_f32 v[26:27], v[26:27], v[34:35]
    v_cvt_pk_bf16_f32 v24, v24, v24
    v_lshlrev_b32 v24, 16, v24
    v_mov_b32 v28, v24
    v_cvt_pk_bf16_f32 v25, v25, v25
    v_lshlrev_b32 v25, 16, v25
    v_mov_b32 v29, v25
    v_cvt_pk_bf16_f32 v26, v26, v26
    v_lshlrev_b32 v26, 16, v26
    v_mov_b32 v30, v26
    v_cvt_pk_bf16_f32 v27, v27, v27
    v_lshlrev_b32 v27, 16, v27
    v_mov_b32 v31, v27
    s_nop 1
    v_permlane16_swap_b32 v24, v28
    v_permlane16_swap_b32 v25, v29
    v_permlane16_swap_b32 v26, v30
    v_permlane16_swap_b32 v27, v31
    s_nop 1
    v_mul_f32 v40, 0xbfb8aa3b, v24
    v_exp_f32 v40, v40
    s_nop 0
    v_add_f32 v40, 1.0, v40
    v_rcp_f32 v40, v40
    s_nop 0
    v_mul_f32 v40, v40, v24
    v_cvt_pk_bf16_f32 v40, v40, v40
    v_lshlrev_b32 v40, 16, v40
    v_mul_f32 v40, v40, v28
    v_mul_f32 v41, 0xbfb8aa3b, v25
    v_exp_f32 v41, v41
    s_nop 0
    v_add_f32 v41, 1.0, v41
    v_rcp_f32 v41, v41
    s_nop 0
    v_mul_f32 v41, v41, v25
    v_cvt_pk_bf16_f32 v41, v41, v41
    v_lshlrev_b32 v41, 16, v41
    v_mul_f32 v41, v41, v29
    v_mul_f32 v42, 0xbfb8aa3b, v26
    v_exp_f32 v42, v42
    s_nop 0
    v_add_f32 v42, 1.0, v42
    v_rcp_f32 v42, v42
    s_nop 0
    v_mul_f32 v42, v42, v26
    v_cvt_pk_bf16_f32 v42, v42, v42
    v_lshlrev_b32 v42, 16, v42
    v_mul_f32 v42, v42, v30
    v_mul_f32 v43, 0xbfb8aa3b, v27
    v_exp_f32 v43, v43
    s_nop 0
    v_add_f32 v43, 1.0, v43
    v_rcp_f32 v43, v43
    s_nop 0
    v_mul_f32 v43, v43, v27
    v_cvt_pk_bf16_f32 v43, v43, v43
    v_lshlrev_b32 v43, 16, v43
    v_mul_f32 v43, v43, v31
    v_cvt_pk_bf16_f32 v40, v40, v41
    v_cvt_pk_bf16_f32 v41, v42, v43
    v_mul_u32_u24 v9, 144, v6
    v_lshl_add_u32 v9, v11, 3, v9
    v_add_u32 v9, 74240, v9
    ds_write_b64 v9, v[40:41]
    s_mov_b64 exec, 1
    ds_add_u32 v22, v23 offset:20
    s_mov_b64 exec, -1
    v_and_b32 v9, 7, v2
    v_mul_u32_u24 v9, 144, v9
    v_lshl_add_u32 v9, v10, 4, v9
    v_add_u32 v9, 74240, v9
L_s_aw:
    ds_read_b32 v15, v22 offset:20
    s_waitcnt lgkmcnt(0)
    v_readfirstlane_b32 s38, v15
    s_nop 1
    s_cmp_ge_u32 s38, 4
    s_cbranch_scc1 L_s_aw_ok
    s_sub_u32 s96, s96, 1
    s_cbranch_scc1 L_s_aw_ok
    s_sleep 1
    s_branch L_s_aw
L_s_aw_ok:
    ds_read_b128 v[40:43], v9
    ds_read_b128 v[44:47], v9 offset:64
    s_mov_b32 s38, 229376
    v_and_b32 v15, 7, v2
    v_mul_lo_u32 v15, v15, s38
    v_lshl_add_u32 v15, v10, 4, v15
    v_and_b32 v14, 8, v2
    v_lshl_add_u32 v15, v14, 3, v15
    s_lshl_b32 s38, s22, 12
    s_lshl_b32 s39, s23, 10
    s_add_u32 s38, s38, s39
    s_lshl_b32 s39, s18, 8
    s_add_u32 s38, s38, s39
    s_add_u32 s38, s38, 13631488
    v_cmp_eq_u32 vcc, 8, v14
    s_waitcnt lgkmcnt(0)
    v_mfma_f32_16x16x32_bf16 v[48:51], v[64:67], v[40:43], 0
    v_mfma_f32_16x16x32_bf16 v[52:55], v[72:75], v[40:43], 0
    v_mfma_f32_16x16x32_bf16 v[56:59], v[80:83], v[40:43], 0
    v_mfma_f32_16x16x32_bf16 v[60:63], v[88:91], v[40:43], 0
    v_mfma_f32_16x16x32_bf16 v[48:51], v[68:71], v[44:47], v[48:51]
    v_mfma_f32_16x16x32_bf16 v[52:55], v[76:79], v[44:47], v[52:55]
    v_mfma_f32_16x16x32_bf16 v[56:59], v[84:87], v[44:47], v[56:59]
    v_mfma_f32_16x16x32_bf16 v[60:63], v[92:95], v[44:47], v[60:63]
    s_nop 7
    v_cndmask_b32 v48, v48, v52, vcc
    v_cndmask_b32 v49, v49, v53, vcc
    v_cndmask_b32 v50, v50, v54, vcc
    v_cndmask_b32 v51, v51, v55, vcc
    buffer_store_dwordx4 v[48:51], v15, s[12:15], s38 offen offset:0 sc1
    v_cndmask_b32 v56, v56, v60, vcc
    v_cndmask_b32 v57, v57, v61, vcc
    v_cndmask_b32 v58, v58, v62, vcc
    v_cndmask_b32 v59, v59, v63, vcc
    buffer_store_dwordx4 v[56:59], v15, s[12:15], s38 offen offset:128 sc1
    s_lshl_b32 s58, s23, 14
    s_lshl_b32 s39, s22, 8
    s_add_u32 s58, s58, s39
    s_add_u32 s58, s58, 9633792
    v_mov_b32 v13, s93
    v_lshlrev_b32 v14, 2, v2
    s_waitcnt vmcnt(0)
    v_mov_b32 v15, 1
    s_mov_b64 exec, 1
    ds_add_rtn_u32 v15, v22, v15 offset:24
    s_mov_b64 exec, -1
    s_waitcnt lgkmcnt(0)
    v_readfirstlane_b32 s39, v15
    s_nop 1
    s_cmp_lg_u32 s39, 3
    s_cbranch_scc1 L_s_cons
    s_mov_b32 exec_hi, 0
    buffer_store_dword v13, v14, s[12:15], s58 offen sc1
    s_mov_b32 exec_hi, -1
L_s_cons:
    s_add_u32 s38, s18, 4
    v_readlane_b32 s24, v8, s18
    v_readlane_b32 s25, v8, s38
    s_lshl_b32 s45, s16, 7
    s_and_b32 s26, s24, 0x7ff
    s_sub_u32 s26, 2047, s26
    s_sub_u32 s56, s26, s45
    s_and_b32 s27, s25, 0x7ff
    s_sub_u32 s27, 2047, s27
    s_sub_u32 s57, s27, s45
    s_waitcnt lgkmcnt(0)
    s_min_u32 s38, s56, s57
    s_cmp_ge_u32 s38, 128
    s_cbranch_scc1 L_s_end
L_s_pw:
    ds_read_b32 v15, v22 offset:16
    s_waitcnt lgkmcnt(0)
    v_readfirstlane_b32 s38, v15
    s_nop 1
    s_cmp_ge_u32 s38, 24
    s_cbranch_scc1 L_s_pw_ok
    s_sub_u32 s96, s96, 1
    s_cbranch_scc1 L_s_pw_ok
    s_sleep 8
    s_branch L_s_pw
L_s_pw_ok:
    s_lshr_b32 s58, s17, 2
    s_lshl_b32 s58, s58, 14
    s_add_u32 s58, s58, 9633792
    v_min_u32 v4, 55, v2
    v_lshlrev_b32 v4, 8, v4
    v_lshlrev_b32 v6, 12, v10
    v_lshl_add_u32 v6, v11, 4, v6
    v_lshlrev_b32 v9, 3, v11
    v_mov_b32 v7, 0
L_s_ypoll:
    buffer_load_dword v5, v4, s[12:15], s58 offen sc1
    s_waitcnt vmcnt(0)
    v_cmp_ne_u32 vcc, s93, v5
    s_nop 1
    s_cmp_eq_u64 vcc, 0
    s_cbranch_scc1 L_s_ygo
    s_sub_u32 s96, s96, 1
    s_cbranch_scc1 L_s_ygo
    s_sleep 6
    s_branch L_s_ypoll
L_s_ygo:
    s_cmp_ge_u32 s56, 128
    s_cbranch_scc1 L_s_sk0
    s_add_u32 s39, s18, 0
    s_mul_i32 s39, s39, 229376
    s_lshl_b32 s3, s17, 8
    s_add_u32 s39, s39, s3
    s_add_u32 s39, s39, 13631488
    buffer_load_dwordx4 v[24:27], v6, s[12:15], s39 offen sc1
    s_add_u32 s39, s39, 16384
    buffer_load_dwordx4 v[28:31], v6, s[12:15], s39 offen sc1
    s_add_u32 s39, s39, 16384
    buffer_load_dwordx4 v[32:35], v6, s[12:15], s39 offen sc1
    s_add_u32 s39, s39, 16384
    buffer_load_dwordx4 v[36:39], v6, s[12:15], s39 offen sc1
    s_add_u32 s39, s39, 16384
    buffer_load_dwordx4 v[40:43], v6, s[12:15], s39 offen sc1
    s_add_u32 s39, s39, 16384
    buffer_load_dwordx4 v[44:47], v6, s[12:15], s39 offen sc1
    s_add_u32 s39, s39, 16384
    buffer_load_dwordx4 v[48:51], v6, s[12:15], s39 offen sc1
    s_add_u32 s39, s39, 16384
    buffer_load_dwordx4 v[52:55], v6, s[12:15], s39 offen sc1
    s_add_u32 s39, s39, 16384
    buffer_load_dwordx4 v[56:59], v6, s[12:15], s39 offen sc1
    s_add_u32 s39, s39, 16384
    buffer_load_dwordx4 v[60:63], v6, s[12:15], s39 offen sc1
    s_add_u32 s39, s39, 16384
    buffer_load_dwordx4 v[64:67], v6, s[12:15], s39 offen sc1
    s_add_u32 s39, s39, 16384
    buffer_load_dwordx4 v[68:71], v6, s[12:15], s39 offen sc1
    s_add_u32 s39, s39, 16384
    buffer_load_dwordx4 v[72:75], v6, s[12:15], s39 offen sc1
    s_add_u32 s39, s39, 16384
    buffer_load_dwordx4 v[76:79], v6, s[12:15], s39 offen sc1
    s_add_u32 s39, s39, 16384
    s_lshl_b32 s39, s26, 11
    s_lshl_b32 s3, s17, 7
    s_add_u32 s39, s39, s3
    buffer_load_dwordx2 v[80:81], v9, s[8:11], s39 offen
    s_lshl_b32 s39, s26, 3
    s_add_u32 s39, s39, 9453568
    buffer_load_dword v82, v7, s[12:15], s39 offen sc1
L_s_sk0:
    s_cmp_ge_u32 s57, 128
    s_cbranch_scc1 L_s_sk1
    s_add_u32 s39, s18, 4
    s_mul_i32 s39, s39, 229376
    s_lshl_b32 s3, s17, 8
    s_add_u32 s39, s39, s3
    s_add_u32 s39, s39, 13631488
    buffer_load_dwordx4 v[88:91], v6, s[12:15], s39 offen sc1
    s_add_u32 s39, s39, 16384
    buffer_load_dwordx4 v[92:95], v6, s[12:15], s39 offen sc1
    s_add_u32 s39, s39, 16384
    buffer_load_dwordx4 v[96:99], v6, s[12:15], s39 offen sc1
    s_add_u32 s39, s39, 16384
    buffer_load_dwordx4 v[100:103], v6, s[12:15], s39 offen sc1
    s_add_u32 s39, s39, 16384
    buffer_load_dwordx4 v[104:107], v6, s[12:15], s39 offen sc1
    s_add_u32 s39, s39, 16384
    buffer_load_dwordx4 v[108:111], v6, s[12:15], s39 offen sc1
    s_add_u32 s39, s39, 16384
    buffer_load_dwordx4 v[112:115], v6, s[12:15], s39 offen sc1
    s_add_u32 s39, s39, 16384
    buffer_load_dwordx4 v[116:119], v6, s[12:15], s39 offen sc1
    s_add_u32 s39, s39, 16384
    buffer_load_dwordx4 v[120:123], v6, s[12:15], s39 offen sc1
    s_add_u32 s39, s39, 16384
    buffer_load_dwordx4 v[124:127], v6, s[12:15], s39 offen sc1
    s_add_u32 s39, s39, 16384
    buffer_load_dwordx4 v[128:131], v6, s[12:15], s39 offen sc1
    s_add_u32 s39, s39, 16384
    buffer_load_dwordx4 v[132:135], v6, s[12:15], s39 offen sc1
    s_add_u32 s39, s39, 16384
    buffer_load_dwordx4 v[136:139], v6, s[12:15], s39 offen sc1
    s_add_u32 s39, s39, 16384
    buffer_load_dwordx4 v[140:143], v6, s[12:15], s39 offen sc1
    s_add_u32 s39, s39, 16384
    s_lshl_b32 s39, s27, 11
    s_lshl_b32 s3, s17, 7
    s_add_u32 s39, s39, s3
    buffer_load_dwordx2 v[144:145], v9, s[8:11], s39 offen
    s_lshl_b32 s39, s27, 3
    s_add_u32 s39, s39, 9453568
    buffer_load_dword v146, v7, s[12:15], s39 offen sc1
L_s_sk1:
    s_waitcnt vmcnt(0)
    s_cmp_ge_u32 s56, 128
    s_cbranch_scc1 L_s_sc0
    s_ashr_i32 s39, s24, 31
    s_not_b32 s39, s39
    s_or_b32 s39, s39, 0x80000000
    s_xor_b32 s39, s24, s39
    s_and_b32 s39, s39, 0xffff0000
    v_mov_b32 v86, s39
    v_mul_f32 v83, 0xbfb8aa3b, v86
    v_exp_f32 v83, v83
    s_nop 0
    v_add_f32 v83, 1.0, v83
    v_rcp_f32 v83, v83
    s_nop 0
    v_cvt_pk_bf16_f32 v83, v83, v83
    v_lshlrev_b32 v83, 16, v83
    v_pk_add_f32 v[24:25], v[24:25], v[28:29]
    v_pk_add_f32 v[26:27], v[26:27], v[30:31]
    v_pk_add_f32 v[24:25], v[24:25], v[32:33]
    v_pk_add_f32 v[26:27], v[26:27], v[34:35]
    v_pk_add_f32 v[24:25], v[24:25], v[36:37]
    v_pk_add_f32 v[26:27], v[26:27], v[38:39]
    v_pk_add_f32 v[24:25], v[24:25], v[40:41]
    v_pk_add_f32 v[26:27], v[26:27], v[42:43]
    v_pk_add_f32 v[24:25], v[24:25], v[44:45]
    v_pk_add_f32 v[26:27], v[26:27], v[46:47]
    v_pk_add_f32 v[24:25], v[24:25], v[48:49]
    v_pk_add_f32 v[26:27], v[26:27], v[50:51]
    v_pk_add_f32 v[24:25], v[24:25], v[52:53]
    v_pk_add_f32 v[26:27], v[26:27], v[54:55]
    v_pk_add_f32 v[24:25], v[24:25], v[56:57]
    v_pk_add_f32 v[26:27], v[26:27], v[58:59]
    v_pk_add_f32 v[24:25], v[24:25], v[60:61]
    v_pk_add_f32 v[26:27], v[26:27], v[62:63]
    v_pk_add_f32 v[24:25], v[24:25], v[64:65]
    v_pk_add_f32 v[26:27], v[26:27], v[66:67]
    v_pk_add_f32 v[24:25], v[24:25], v[68:69]
    v_pk_add_f32 v[26:27], v[26:27], v[70:71]
    v_pk_add_f32 v[24:25], v[24:25], v[72:73]
    v_pk_add_f32 v[26:27], v[26:27], v[74:75]
    v_pk_add_f32 v[24:25], v[24:25], v[76:77]
    v_pk_add_f32 v[26:27], v[26:27], v[78:79]
    v_mov_b32 v28, v24
    v_mov_b32 v29, v25
    v_mov_b32 v30, v26
    v_mov_b32 v31, v27
    s_nop 1
    v_permlane16_swap_b32 v24, v28
    v_permlane16_swap_b32 v25, v29
    v_permlane16_swap_b32 v26, v30
    v_permlane16_swap_b32 v27, v31
    s_nop 1
    v_add_f32 v24, v24, v28
    v_add_f32 v25, v25, v29
    v_add_f32 v26, v26, v30
    v_add_f32 v27, v27, v31
    v_mov_b32 v28, v24
    v_mov_b32 v29, v25
    v_mov_b32 v30, v26
    v_mov_b32 v31, v27
    s_nop 1
    v_permlane32_swap_b32 v24, v28
    v_permlane32_swap_b32 v25, v29
    v_permlane32_swap_b32 v26, v30
    v_permlane32_swap_b32 v27, v31
    s_nop 1
    v_add_f32 v24, v24, v28
    v_add_f32 v25, v25, v29
    v_add_f32 v26, v26, v30
    v_add_f32 v27, v27, v31
    v_sub_f32 v82, 1.0, v82
    v_cvt_pk_bf16_f32 v82, v82, v82
    v_lshlrev_b32 v82, 16, v82
    v_lshlrev_b32 v32, 16, v80
    v_and_b32 v33, s21, v80
    v_lshlrev_b32 v34, 16, v81
    v_and_b32 v35, s21, v81
    v_cvt_pk_bf16_f32 v24, v24, v24
    v_lshlrev_b32 v24, 16, v24
    v_mul_f32 v24, v24, v83
    v_cvt_pk_bf16_f32 v24, v24, v24
    v_lshlrev_b32 v24, 16, v24
    v_add_f32 v24, v24, v32
    v_cvt_pk_bf16_f32 v24, v24, v24
    v_lshlrev_b32 v24, 16, v24
    v_mul_f32 v24, v24, v82
    v_cvt_pk_bf16_f32 v24, v24, v24
    v_lshlrev_b32 v24, 16, v24
    v_mul_f32 v32, v32, v82
    v_cvt_pk_bf16_f32 v32, v32, v32
    v_lshlrev_b32 v32, 16, v32
    v_sub_f32 v24, v24, v32
    v_cvt_pk_bf16_f32 v25, v25, v25
    v_lshlrev_b32 v25, 16, v25
    v_mul_f32 v25, v25, v83
    v_cvt_pk_bf16_f32 v25, v25, v25
    v_lshlrev_b32 v25, 16, v25
    v_add_f32 v25, v25, v33
    v_cvt_pk_bf16_f32 v25, v25, v25
    v_lshlrev_b32 v25, 16, v25
    v_mul_f32 v25, v25, v82
    v_cvt_pk_bf16_f32 v25, v25, v25
    v_lshlrev_b32 v25, 16, v25
    v_mul_f32 v33, v33, v82
    v_cvt_pk_bf16_f32 v33, v33, v33
    v_lshlrev_b32 v33, 16, v33
    v_sub_f32 v25, v25, v33
    v_cvt_pk_bf16_f32 v26, v26, v26
    v_lshlrev_b32 v26, 16, v26
    v_mul_f32 v26, v26, v83
    v_cvt_pk_bf16_f32 v26, v26, v26
    v_lshlrev_b32 v26, 16, v26
    v_add_f32 v26, v26, v34
    v_cvt_pk_bf16_f32 v26, v26, v26
    v_lshlrev_b32 v26, 16, v26
    v_mul_f32 v26, v26, v82
    v_cvt_pk_bf16_f32 v26, v26, v26
    v_lshlrev_b32 v26, 16, v26
    v_mul_f32 v34, v34, v82
    v_cvt_pk_bf16_f32 v34, v34, v34
    v_lshlrev_b32 v34, 16, v34
    v_sub_f32 v26, v26, v34
    v_cvt_pk_bf16_f32 v27, v27, v27
    v_lshlrev_b32 v27, 16, v27
    v_mul_f32 v27, v27, v83
    v_cvt_pk_bf16_f32 v27, v27, v27
    v_lshlrev_b32 v27, 16, v27
    v_add_f32 v27, v27, v35
    v_cvt_pk_bf16_f32 v27, v27, v27
    v_lshlrev_b32 v27, 16, v27
    v_mul_f32 v27, v27, v82
    v_cvt_pk_bf16_f32 v27, v27, v27
    v_lshlrev_b32 v27, 16, v27
    v_mul_f32 v35, v35, v82
    v_cvt_pk_bf16_f32 v35, v35, v35
    v_lshlrev_b32 v35, 16, v35
    v_sub_f32 v27, v27, v35
    s_lshl_b32 s39, s18, 8
    s_add_u32 s39, s39, 75776
    v_lshl_add_u32 v84, v11, 4, s39
    ds_write_b128 v84, v[24:27]
    v_lshl_add_u32 v85, s18, 2, v22
    s_mov_b64 exec, 1
    ds_add_u32 v85, v23 offset:36
    s_mov_b64 exec, -1
L_s_sc0:
    s_cmp_ge_u32 s57, 128
    s_cbranch_scc1 L_s_sc1
    s_ashr_i32 s39, s25, 31
    s_not_b32 s39, s39
    s_or_b32 s39, s39, 0x80000000
    s_xor_b32 s39, s25, s39
    s_and_b32 s39, s39, 0xffff0000
    v_mov_b32 v150, s39
    v_mul_f32 v147, 0xbfb8aa3b, v150
    v_exp_f32 v147, v147
    s_nop 0
    v_add_f32 v147, 1.0, v147
    v_rcp_f32 v147, v147
    s_nop 0
    v_cvt_pk_bf16_f32 v147, v147, v147
    v_lshlrev_b32 v147, 16, v147
    v_pk_add_f32 v[88:89], v[88:89], v[92:93]
    v_pk_add_f32 v[90:91], v[90:91], v[94:95]
    v_pk_add_f32 v[88:89], v[88:89], v[96:97]
    v_pk_add_f32 v[90:91], v[90:91], v[98:99]
    v_pk_add_f32 v[88:89], v[88:89], v[100:101]
    v_pk_add_f32 v[90:91], v[90:91], v[102:103]
    v_pk_add_f32 v[88:89], v[88:89], v[104:105]
    v_pk_add_f32 v[90:91], v[90:91], v[106:107]
    v_pk_add_f32 v[88:89], v[88:89], v[108:109]
    v_pk_add_f32 v[90:91], v[90:91], v[110:111]
    v_pk_add_f32 v[88:89], v[88:89], v[112:113]
    v_pk_add_f32 v[90:91], v[90:91], v[114:115]
    v_pk_add_f32 v[88:89], v[88:89], v[116:117]
    v_pk_add_f32 v[90:91], v[90:91], v[118:119]
    v_pk_add_f32 v[88:89], v[88:89], v[120:121]
    v_pk_add_f32 v[90:91], v[90:91], v[122:123]
    v_pk_add_f32 v[88:89], v[88:89], v[124:125]
    v_pk_add_f32 v[90:91], v[90:91], v[126:127]
    v_pk_add_f32 v[88:89], v[88:89], v[128:129]
    v_pk_add_f32 v[90:91], v[90:91], v[130:131]
    v_pk_add_f32 v[88:89], v[88:89], v[132:133]
    v_pk_add_f32 v[90:91], v[90:91], v[134:135]
    v_pk_add_f32 v[88:89], v[88:89], v[136:137]
    v_pk_add_f32 v[90:91], v[90:91], v[138:139]
    v_pk_add_f32 v[88:89], v[88:89], v[140:141]
    v_pk_add_f32 v[90:91], v[90:91], v[142:143]
    v_mov_b32 v92, v88
    v_mov_b32 v93, v89
    v_mov_b32 v94, v90
    v_mov_b32 v95, v91
    s_nop 1
    v_permlane16_swap_b32 v88, v92
    v_permlane16_swap_b32 v89, v93
    v_permlane16_swap_b32 v90, v94
    v_permlane16_swap_b32 v91, v95
    s_nop 1
    v_add_f32 v88, v88, v92
    v_add_f32 v89, v89, v93
    v_add_f32 v90, v90, v94
    v_add_f32 v91, v91, v95
    v_mov_b32 v92, v88
    v_mov_b32 v93, v89
    v_mov_b32 v94, v90
    v_mov_b32 v95, v91
    s_nop 1
    v_permlane32_swap_b32 v88, v92
    v_permlane32_swap_b32 v89, v93
    v_permlane32_swap_b32 v90, v94
    v_permlane32_swap_b32 v91, v95
    s_nop 1
    v_add_f32 v88, v88, v92
    v_add_f32 v89, v89, v93
    v_add_f32 v90, v90, v94
    v_add_f32 v91, v91, v95
    v_sub_f32 v146, 1.0, v146
    v_cvt_pk_bf16_f32 v146, v146, v146
    v_lshlrev_b32 v146, 16, v146
    v_lshlrev_b32 v96, 16, v144
    v_and_b32 v97, s21, v144
    v_lshlrev_b32 v98, 16, v145
    v_and_b32 v99, s21, v145
    v_cvt_pk_bf16_f32 v88, v88, v88
    v_lshlrev_b32 v88, 16, v88
    v_mul_f32 v88, v88, v147
    v_cvt_pk_bf16_f32 v88, v88, v88
    v_lshlrev_b32 v88, 16, v88
    v_add_f32 v88, v88, v96
    v_cvt_pk_bf16_f32 v88, v88, v88
    v_lshlrev_b32 v88, 16, v88
    v_mul_f32 v88, v88, v146
    v_cvt_pk_bf16_f32 v88, v88, v88
    v_lshlrev_b32 v88, 16, v88
    v_mul_f32 v96, v96, v146
    v_cvt_pk_bf16_f32 v96, v96, v96
    v_lshlrev_b32 v96, 16, v96
    v_sub_f32 v88, v88, v96
    v_cvt_pk_bf16_f32 v89, v89, v89
    v_lshlrev_b32 v89, 16, v89
    v_mul_f32 v89, v89, v147
    v_cvt_pk_bf16_f32 v89, v89, v89
    v_lshlrev_b32 v89, 16, v89
    v_add_f32 v89, v89, v97
    v_cvt_pk_bf16_f32 v89, v89, v89
    v_lshlrev_b32 v89, 16, v89
    v_mul_f32 v89, v89, v146
    v_cvt_pk_bf16_f32 v89, v89, v89
    v_lshlrev_b32 v89, 16, v89
    v_mul_f32 v97, v97, v146
    v_cvt_pk_bf16_f32 v97, v97, v97
    v_lshlrev_b32 v97, 16, v97
    v_sub_f32 v89, v89, v97
    v_cvt_pk_bf16_f32 v90, v90, v90
    v_lshlrev_b32 v90, 16, v90
    v_mul_f32 v90, v90, v147
    v_cvt_pk_bf16_f32 v90, v90, v90
    v_lshlrev_b32 v90, 16, v90
    v_add_f32 v90, v90, v98
    v_cvt_pk_bf16_f32 v90, v90, v90
    v_lshlrev_b32 v90, 16, v90
    v_mul_f32 v90, v90, v146
    v_cvt_pk_bf16_f32 v90, v90, v90
    v_lshlrev_b32 v90, 16, v90
    v_mul_f32 v98, v98, v146
    v_cvt_pk_bf16_f32 v98, v98, v98
    v_lshlrev_b32 v98, 16, v98
    v_sub_f32 v90, v90, v98
    v_cvt_pk_bf16_f32 v91, v91, v91
    v_lshlrev_b32 v91, 16, v91
    v_mul_f32 v91, v91, v147
    v_cvt_pk_bf16_f32 v91, v91, v91
    v_lshlrev_b32 v91, 16, v91
    v_add_f32 v91, v91, v99
    v_cvt_pk_bf16_f32 v91, v91, v91
    v_lshlrev_b32 v91, 16, v91
    v_mul_f32 v91, v91, v146
    v_cvt_pk_bf16_f32 v91, v91, v91
    v_lshlrev_b32 v91, 16, v91
    v_mul_f32 v99, v99, v146
    v_cvt_pk_bf16_f32 v99, v99, v99
    v_lshlrev_b32 v99, 16, v99
    v_sub_f32 v91, v91, v99
    s_lshl_b32 s39, s18, 8
    s_add_u32 s39, s39, 76800
    v_lshl_add_u32 v148, v11, 4, s39
    ds_write_b128 v148, v[88:91]
    v_lshl_add_u32 v149, s18, 2, v22
    s_mov_b64 exec, 1
    ds_add_u32 v149, v23 offset:52
    s_mov_b64 exec, -1
L_s_sc1:
L_s_end:
    s_endpgm
L_exit:
    s_endpgm
L_gemm:
    s_add_u32 s94, s42, 9469952
    s_addc_u32 s95, s43, 0
    s_load_dword s93, s[94:95], 0
    s_lshr_b32 s20, s18, 1
    s_lshl_b32 s50, s3, 8
    s_lshl_b32 s39, s38, 3
    s_add_u32 s50, s50, s39
    s_lshl_b32 s50, s50, 11
    s_lshl_b32 s51, s18, 9
    s_add_u32 s50, s50, s51
    s_lshl_b32 s39, s18, 14
    s_add_u32 m0, s39, 98304
    v_and_b32 v4, 31, v0
    v_lshlrev_b32 v4, 4, v4
    v_bfe_u32 v5, v0, 5, 1
    v_lshl_add_u32 v5, v5, 11, v4
    v_add_u32 v4, s51, v4
    v_mov_b32 v6, s44
    v_mov_b32 v7, s45
    s_mov_b32 exec_lo, 0
    v_mov_b32 v6, s80
    v_mov_b32 v7, s81
    s_mov_b32 exec_lo, -1
    v_add_co_u32 v6, vcc, v6, v4
    s_mov_b32 s4, s40
    s_mov_b32 s5, s41
    s_mov_b32 s6, 4194304
    s_mov_b32 s7, 0x20000
    v_addc_co_u32 v7, vcc, 0, v7, vcc
    buffer_load_dwordx4 v5, s[4:7], s50 offen  lds
    s_add_u32 m0, m0, 1024
    s_add_u32 s50, s50, 4096
    buffer_load_dwordx4 v5, s[4:7], s50 offen  lds
    s_add_u32 m0, m0, 1024
    s_add_u32 s50, s50, 4096
    buffer_load_dwordx4 v5, s[4:7], s50 offen  lds
    s_add_u32 m0, m0, 1024
    s_add_u32 s50, s50, 4096
    buffer_load_dwordx4 v5, s[4:7], s50 offen  lds
    s_add_u32 m0, m0, 1024
    s_add_u32 s50, s50, 4096
    global_load_lds_dwordx4 v[6:7], off
    s_and_b32 s39, s3, 1
    s_lshl_b32 s50, s39, 9
    s_lshr_b32 s39, s3, 1
    s_lshl_b32 s39, s39, 7
    s_add_u32 s50, s50, s39
    s_lshl_b32 s39, s38, 2
    s_add_u32 s50, s50, s39
    s_add_u32 s50, s50, s18
    s_lshl_b32 s50, s50, 11
    v_and_b32 v4, 63, v0
    v_lshl_add_u32 v3, v4, 5, s50
    global_load_dword v10, v3, s[68:69]
    global_load_dword v11, v3, s[70:71]
    s_mov_b64 s[8:9], s[72:73]
    s_mov_b64 s[10:11], s[74:75]
    s_mov_b64 s[52:53], s[72:73]
    s_mov_b64 s[54:55], s[74:75]
    s_mov_b64 s[58:59], s[78:79]
    s_mov_b64 s[36:37], s[82:83]
    v_and_b32 v24, 63, v0
    s_and_b32 s19, s18, 1
    s_lshl_b32 s23, s18, 12
    v_lshrrev_b32 v25, 4, v24
    v_lshrrev_b32 v56, 3, v24
    v_and_b32 v57, 7, v24
    v_lshrrev_b32 v58, 1, v56
    v_xor_b32 v57, v57, v58
    v_lshlrev_b32 v57, 4, v57
    s_mov_b32 s12, s42
    s_mov_b32 s13, s43
    s_mov_b32 s14, 25165824
    s_mov_b32 s15, 0x20000
    s_lshl_b32 s38, s17, 14
    s_add_u32 s38, s38, 8388608
    s_add_u32 s24, s42, s38
    s_addc_u32 s25, s43, 0
    s_mov_b32 s26, 16384
    s_mov_b32 s27, 0x20000
    s_cmp_lt_u32 s18, 2
    s_cselect_b32 s28, s52, s54
    s_cselect_b32 s29, s53, s55
    s_sub_u32 s28, s28, 3072
    s_subb_u32 s29, s29, 0
    s_mov_b32 s30, 2100224
    s_mov_b32 s31, 0x20000
    s_mov_b32 s32, s36
    s_mov_b32 s33, s37
    s_mov_b32 s34, 8388608
    s_mov_b32 s35, 0x20000
    v_bfe_u32 v59, v24, 1, 3
    v_xor_b32 v59, v59, v25
    v_lshlrev_b32 v59, 4, v59
    v_lshl_add_u32 v59, v26, 7, v59
    s_lshl_b32 s38, s19, 13
    s_lshl_b32 s39, s20, 13
    v_xor_b32 v58, 0, v59
    v_add_u32 v16, s38, v58
    v_add_u32 v18, s39, v58
    v_add_u32 v20, 0x10000, v16
    v_add_u32 v22, 0x10000, v18
    v_xor_b32 v58, 64, v59
    v_add_u32 v17, s38, v58
    v_add_u32 v19, s39, v58
    v_add_u32 v21, 0x10000, v17
    v_add_u32 v23, 0x10000, v19
    v_and_b32 v58, 31, v24
    v_lshlrev_b32 v27, 4, v58
    s_sub_u32 s38, 15, s16
    s_lshl_b32 s38, s38, 10
    s_lshl_b32 s39, s20, 9
    s_add_u32 s92, s38, s39
    v_add_u32 v27, s92, v27
    s_cmp_eq_u32 s19, 1
    s_cselect_b64 s[98:99], -1, 0
    s_waitcnt lgkmcnt(0)
    s_mul_i32 s93, s93, 1664525
    s_add_u32 s93, s93, 1013904223
    s_lshl_b32 s38, s20, 8
    s_add_u32 s38, s38, 32768
    v_lshl_add_u32 v193, v26, 4, s38
    s_lshl_b32 s39, s19, 11
    v_lshl_add_u32 v192, v25, 9, v193
    v_add_u32 v192, s39, v192
    v_lshlrev_b32 v194, 10, v25
    v_lshl_add_u32 v194, v26, 4, v194
    s_add_u32 s38, s92, 1024
    v_add_u32 v194, s38, v194
    v_sub_u32 v58, s16, v25
    v_mov_b32 v59, s93
    v_cmp_lt_i32 vcc, 0, v58
    s_nop 1
    v_cndmask_b32 v198, 0, v59, vcc
    v_cmp_lt_i32 vcc, 4, v58
    s_nop 1
    v_cndmask_b32 v199, 0, v59, vcc
    v_cmp_lt_i32 vcc, 8, v58
    s_nop 1
    v_cndmask_b32 v200, 0, v59, vcc
    v_cmp_lt_i32 vcc, 12, v58
    s_nop 1
    v_cndmask_b32 v201, 0, v59, vcc
    s_mul_i32 s38, s18, 9216
    s_add_u32 s38, s38, 36864
    v_mul_u32_u24 v195, 144, v26
    v_lshl_add_u32 v195, v25, 5, v195
    v_add_u32 v195, s38, v195
    v_bfe_u32 v196, v24, 2, 2
    v_lshl_add_u32 v196, v25, 3, v196
    v_mul_u32_u24 v196, 144, v196
    v_and_b32 v58, 3, v24
    v_lshl_add_u32 v196, v58, 3, v196
    v_add_u32 v196, s38, v196
    v_lshlrev_b32 v197, 4, v24
    s_lshl_b32 s38, s17, 6
    s_lshl_b32 s39, s19, 5
    s_add_u32 s38, s38, s39
    v_add_u32 v58, s38, v56
    v_lshl_add_u32 v58, v58, 11, v57
    v_xor_b32 v59, 64, v58
    v_add_u32 v202, 3072, v58
    v_add_u32 v203, 18432, v59
    v_add_u32 v204, 33792, v58
    v_add_u32 v205, 49152, v59
    s_and_b32 s55, s17, 7
    s_and_b32 s54, s17, 8
    s_lshl_b32 s48, s16, 19
    s_lshl_b32 s39, s17, 15
    s_add_u32 s53, s48, s39
    s_lshl_b32 s39, s20, 11
    s_add_u32 s53, s53, s39
    s_lshl_b32 s39, s19, 14
    s_add_u32 s53, s53, s39
    s_lshl_b32 s51, s16, 7
    s_lshl_b32 s38, s18, 5
    s_add_u32 s51, s51, s38
    s_lshl_b32 s57, s51, 3
    s_add_u32 s57, s57, 9453568
    s_lshl_b32 s56, s51, 11
    s_lshl_b32 s39, s17, 7
    s_add_u32 s56, s56, s39
    v_lshlrev_b32 v220, 11, v25
    v_lshl_add_u32 v220, v26, 3, v220
    v_and_b32 v221, 31, v24
    v_lshlrev_b32 v221, 3, v221
    v_lshl_add_u32 v222, v26, 3, s39
    s_not_b32 s39, s93
    v_mov_b32 v60, s39
    v_mov_b32 v61, s39
    v_mov_b32 v62, s39
    v_mov_b32 v63, s39
    v_lshlrev_b32 v59, 2, v24
    s_mul_hi_u32 s8, s2, 76695845
    s_mul_i32 s9, s8, 56
    s_sub_u32 s9, s2, s9
    s_lshl_b32 s10, s9, 10
    s_lshl_b32 s11, s8, 8
    s_add_u32 s10, s10, s11
    s_add_u32 s10, s10, 9568256
    s_lshl_b32 s11, s8, 14
    s_lshl_b32 s9, s9, 8
    s_add_u32 s11, s11, s9
    s_add_u32 s11, s11, 9633792
    s_lshl_b32 s9, s16, 12
    s_lshl_b32 s38, s17, 8
    s_add_u32 s9, s9, s38
    s_add_u32 s9, s9, 9502720
    s_cmp_ge_u32 s2, 224
    s_cselect_b32 s10, s9, s10
    s_cselect_b32 s11, s9, s11
    s_cmp_eq_u32 s18, 1
    s_cselect_b32 s9, s10, s9
    s_cmp_eq_u32 s18, 3
    s_cselect_b32 s9, s11, s9
    s_mov_b32 exec_hi, 0
    buffer_store_dword v60, v59, s[12:15], s9 offen sc1
    buffer_store_dwordx4 v[60:63], v27, s[24:27], 0 offen sc1
    s_mov_b32 exec_hi, -1
    s_lshl_b32 s39, s18, 14
    s_add_u32 s39, s39, 98304
    v_and_b32 v4, 7, v24
    v_lshlrev_b32 v4, 9, v4
    v_bfe_u32 v5, v24, 3, 1
    v_lshl_add_u32 v4, v5, 6, v4
    v_lshl_add_u32 v4, v25, 4, v4
    v_add_u32 v4, s39, v4
    v_and_b32 v7, 1, v24
    v_lshlrev_b32 v5, 9, v7
    v_bfe_u32 v6, v24, 1, 1
    v_lshl_add_u32 v5, v6, 6, v5
    v_lshl_add_u32 v5, v25, 4, v5
    v_add_u32 v5, s39, v5
    v_lshrrev_b32 v6, 1, v25
    v_lshlrev_b32 v6, 6, v6
    v_lshl_add_u32 v6, v7, 5, v6
    v_and_b32 v7, 1, v25
    v_lshl_add_u32 v6, v7, 4, v6
    s_lshl_b32 s39, s18, 7
    s_add_u32 s39, s39, 163328
    v_add_u32 v6, s39, v6
    s_waitcnt vmcnt(9)
    v_lshlrev_b32 v224, 16, v224
    v_lshlrev_b32 v225, 16, v225
    v_lshlrev_b32 v226, 16, v226
    v_lshlrev_b32 v227, 16, v227
    v_lshlrev_b32 v228, 16, v228
    v_lshlrev_b32 v229, 16, v229
    v_mul_f32 v230, 1069066811, v228
    v_mul_f32 v231, 1069066811, v229
    v_exp_f32 v230, v230
    v_exp_f32 v231, v231
    s_nop 0
    v_cvt_pk_bf16_f32 v230, v230, v230
    v_lshlrev_b32 v230, 16, v230
    v_cvt_pk_bf16_f32 v231, v231, v231
    v_lshlrev_b32 v231, 16, v231
    v_pk_mul_f32 v[232:233], v[230:231], v[224:225] op_sel:[0,0] op_sel_hi:[1,1]
    v_pk_mul_f32 v[234:235], v[230:231], v[226:227] op_sel:[0,0] op_sel_hi:[1,1]
    v_mul_f32 v232, 1069066811, v232
    v_mul_f32 v234, 1042479491, v234
    v_mul_f32 v233, 1069066811, v233
    v_mul_f32 v235, 1042479491, v235
    v_exp_f32 v232, v232
    v_rndne_f32 v236, v234
    v_exp_f32 v233, v233
    v_rndne_f32 v237, v235
    v_sub_f32 v234, v234, v236
    v_sub_f32 v235, v235, v237
    v_cos_f32 v236, v234
    v_sin_f32 v238, v234
    v_cos_f32 v237, v235
    v_sin_f32 v239, v235
    v_pk_mul_f32 v[240:241], v[224:225], v[224:225] op_sel:[0,0] op_sel_hi:[1,1]
    v_pk_fma_f32 v[240:241], v[226:227], v[226:227], v[240:241] op_sel:[0,0,0] op_sel_hi:[1,1,1]
    v_pk_mul_f32 v[28:29], v[232:233], v[236:237] op_sel:[0,0] op_sel_hi:[1,1]
    v_pk_mul_f32 v[30:31], v[232:233], v[238:239] op_sel:[0,0] op_sel_hi:[1,1]
    v_rcp_f32 v240, v240
    v_rcp_f32 v241, v241
    v_add_f32 v230, -1.0, v28
    v_add_f32 v231, -1.0, v29
    v_pk_add_f32 v[240:241], v[240:241], v[240:241]
    v_pk_mul_f32 v[232:233], v[230:231], v[224:225] op_sel:[0,0] op_sel_hi:[1,1]
    v_pk_fma_f32 v[232:233], v[30:31], v[226:227], v[232:233] op_sel:[0,0,0] op_sel_hi:[1,1,1]
    v_pk_mul_f32 v[234:235], v[30:31], v[224:225] op_sel:[0,0] op_sel_hi:[1,1]
    v_pk_fma_f32 v[234:235], v[230:231], v[226:227], v[234:235] op_sel:[0,0,0] op_sel_hi:[1,1,1] neg_lo:[1,0,0] neg_hi:[1,0,0]
    v_pk_mul_f32 v[32:33], v[232:233], v[240:241] op_sel:[0,0] op_sel_hi:[1,1]
    v_pk_mul_f32 v[34:35], v[234:235], v[240:241] op_sel:[0,0] op_sel_hi:[1,1]
    v_pk_mul_f32 v[224:225], v[28:29], v[28:29] op_sel:[0,0] op_sel_hi:[1,1]
    v_pk_mul_f32 v[226:227], v[28:29], v[30:31] op_sel:[0,0] op_sel_hi:[1,1]
    v_pk_fma_f32 v[224:225], v[30:31], v[30:31], v[224:225] op_sel:[0,0,0] op_sel_hi:[1,1,1] neg_lo:[1,0,0] neg_hi:[1,0,0]
    v_pk_add_f32 v[226:227], v[226:227], v[226:227]
    v_pk_mul_f32 v[228:229], v[224:225], v[224:225] op_sel:[0,0] op_sel_hi:[1,1]
    v_pk_mul_f32 v[230:231], v[224:225], v[226:227] op_sel:[0,0] op_sel_hi:[1,1]
    v_pk_fma_f32 v[228:229], v[226:227], v[226:227], v[228:229] op_sel:[0,0,0] op_sel_hi:[1,1,1] neg_lo:[1,0,0] neg_hi:[1,0,0]
    v_pk_add_f32 v[230:231], v[230:231], v[230:231]
    v_pk_mul_f32 v[36:37], v[228:229], v[228:229] op_sel:[0,0] op_sel_hi:[1,1]
    v_pk_mul_f32 v[38:39], v[228:229], v[230:231] op_sel:[0,0] op_sel_hi:[1,1]
    v_pk_fma_f32 v[36:37], v[230:231], v[230:231], v[36:37] op_sel:[0,0,0] op_sel_hi:[1,1,1] neg_lo:[1,0,0] neg_hi:[1,0,0]
    v_pk_add_f32 v[38:39], v[38:39], v[38:39]
    v_pk_mul_f32 v[40:41], v[36:37], v[36:37] op_sel:[0,0] op_sel_hi:[1,1]
    v_pk_mul_f32 v[42:43], v[36:37], v[38:39] op_sel:[0,0] op_sel_hi:[1,1]
    v_pk_fma_f32 v[40:41], v[38:39], v[38:39], v[40:41] op_sel:[0,0,0] op_sel_hi:[1,1,1] neg_lo:[1,0,0] neg_hi:[1,0,0]
    v_pk_add_f32 v[42:43], v[42:43], v[42:43]
    v_pk_mul_f32 v[224:225], v[40:41], v[40:41] op_sel:[0,0] op_sel_hi:[1,1]
    v_pk_mul_f32 v[226:227], v[40:41], v[42:43] op_sel:[0,0] op_sel_hi:[1,1]
    v_pk_fma_f32 v[224:225], v[42:43], v[42:43], v[224:225] op_sel:[0,0,0] op_sel_hi:[1,1,1] neg_lo:[1,0,0] neg_hi:[1,0,0]
    v_pk_add_f32 v[226:227], v[226:227], v[226:227]
    v_pk_mul_f32 v[228:229], v[224:225], v[224:225] op_sel:[0,0] op_sel_hi:[1,1]
    v_pk_mul_f32 v[230:231], v[224:225], v[226:227] op_sel:[0,0] op_sel_hi:[1,1]
    v_pk_fma_f32 v[228:229], v[226:227], v[226:227], v[228:229] op_sel:[0,0,0] op_sel_hi:[1,1,1] neg_lo:[1,0,0] neg_hi:[1,0,0]
    v_pk_add_f32 v[230:231], v[230:231], v[230:231]
    v_and_b32 v240, 1, v25
    v_cmp_eq_u32 s[84:85], 1, v240
    v_cmp_lt_u32 s[86:87], 1, v25
    s_nop 0
    v_cndmask_b32 v232, 1.0, v40, s[84:85]
    v_cndmask_b32 v234, 0, v42, s[84:85]
    v_cndmask_b32 v233, 1.0, v41, s[84:85]
    v_cndmask_b32 v235, 0, v43, s[84:85]
    v_cndmask_b32 v236, 1.0, v224, s[86:87]
    v_cndmask_b32 v238, 0, v226, s[86:87]
    v_cndmask_b32 v237, 1.0, v225, s[86:87]
    v_cndmask_b32 v239, 0, v227, s[86:87]
    v_pk_mul_f32 v[242:243], v[232:233], v[236:237] op_sel:[0,0] op_sel_hi:[1,1]
    v_pk_mul_f32 v[244:245], v[232:233], v[238:239] op_sel:[0,0] op_sel_hi:[1,1]
    v_pk_fma_f32 v[242:243], v[234:235], v[238:239], v[242:243] op_sel:[0,0,0] op_sel_hi:[1,1,1] neg_lo:[1,0,0] neg_hi:[1,0,0]
    v_pk_fma_f32 v[244:245], v[234:235], v[236:237], v[244:245] op_sel:[0,0,0] op_sel_hi:[1,1,1]
    v_cndmask_b32 v232, 1.0, v228, s[98:99]
    v_cndmask_b32 v234, 0, v230, s[98:99]
    v_cndmask_b32 v233, 1.0, v229, s[98:99]
    v_cndmask_b32 v235, 0, v231, s[98:99]
    v_pk_mul_f32 v[52:53], v[242:243], v[232:233] op_sel:[0,0] op_sel_hi:[1,1]
    v_pk_mul_f32 v[54:55], v[242:243], v[234:235] op_sel:[0,0] op_sel_hi:[1,1]
    v_pk_fma_f32 v[52:53], v[244:245], v[234:235], v[52:53] op_sel:[0,0,0] op_sel_hi:[1,1,1] neg_lo:[1,0,0] neg_hi:[1,0,0]
    v_pk_fma_f32 v[54:55], v[244:245], v[232:233], v[54:55] op_sel:[0,0,0] op_sel_hi:[1,1,1]
    v_pk_mul_f32 v[224:225], v[228:229], v[228:229] op_sel:[0,0] op_sel_hi:[1,1]
    v_pk_mul_f32 v[226:227], v[228:229], v[230:231] op_sel:[0,0] op_sel_hi:[1,1]
    v_pk_fma_f32 v[224:225], v[230:231], v[230:231], v[224:225] op_sel:[0,0,0] op_sel_hi:[1,1,1] neg_lo:[1,0,0] neg_hi:[1,0,0]
    v_pk_add_f32 v[226:227], v[226:227], v[226:227]
    v_pk_mul_f32 v[228:229], v[224:225], v[224:225] op_sel:[0,0] op_sel_hi:[1,1]
    v_pk_mul_f32 v[230:231], v[224:225], v[226:227] op_sel:[0,0] op_sel_hi:[1,1]
    v_pk_fma_f32 v[228:229], v[226:227], v[226:227], v[228:229] op_sel:[0,0,0] op_sel_hi:[1,1,1] neg_lo:[1,0,0] neg_hi:[1,0,0]
    v_pk_add_f32 v[230:231], v[230:231], v[230:231]
    v_pk_mul_f32 v[44:45], v[228:229], v[228:229] op_sel:[0,0] op_sel_hi:[1,1]
    v_pk_mul_f32 v[46:47], v[228:229], v[230:231] op_sel:[0,0] op_sel_hi:[1,1]
    v_pk_fma_f32 v[44:45], v[230:231], v[230:231], v[44:45] op_sel:[0,0,0] op_sel_hi:[1,1,1] neg_lo:[1,0,0] neg_hi:[1,0,0]
    v_pk_add_f32 v[46:47], v[46:47], v[46:47]
    v_cndmask_b32 v232, 1.0, v224, s[84:85]
    v_cndmask_b32 v234, 0, v226, s[84:85]
    v_cndmask_b32 v233, 1.0, v225, s[84:85]
    v_cndmask_b32 v235, 0, v227, s[84:85]
    v_cndmask_b32 v236, 1.0, v228, s[86:87]
    v_cndmask_b32 v238, 0, v230, s[86:87]
    v_cndmask_b32 v237, 1.0, v229, s[86:87]
    v_cndmask_b32 v239, 0, v231, s[86:87]
    v_pk_mul_f32 v[48:49], v[232:233], v[236:237] op_sel:[0,0] op_sel_hi:[1,1]
    v_pk_mul_f32 v[50:51], v[232:233], v[238:239] op_sel:[0,0] op_sel_hi:[1,1]
    v_pk_fma_f32 v[48:49], v[234:235], v[238:239], v[48:49] op_sel:[0,0,0] op_sel_hi:[1,1,1] neg_lo:[1,0,0] neg_hi:[1,0,0]
    v_pk_fma_f32 v[50:51], v[234:235], v[236:237], v[50:51] op_sel:[0,0,0] op_sel_hi:[1,1,1]
    v_mov_b32 v224, v52
    v_mov_b32 v226, v54
    v_mul_f32 v225, v36, v52
    v_mul_f32 v227, v36, v54
    v_fma_f32 v225, -v38, v54, v225
    v_fma_f32 v227, v38, v52, v227
    v_pk_mul_f32 v[206:207], v[32:33], v[224:225] op_sel:[0,0] op_sel_hi:[0,1]
    v_pk_mul_f32 v[208:209], v[32:33], v[226:227] op_sel:[0,0] op_sel_hi:[0,1]
    v_pk_fma_f32 v[206:207], v[34:35], v[226:227], v[206:207] op_sel:[0,0,0] op_sel_hi:[0,1,1] neg_lo:[1,0,0] neg_hi:[1,0,0]
    v_pk_fma_f32 v[208:209], v[34:35], v[224:225], v[208:209] op_sel:[0,0,0] op_sel_hi:[0,1,1]
    v_mov_b32 v224, v53
    v_mov_b32 v226, v55
    v_mul_f32 v225, v37, v53
    v_mul_f32 v227, v37, v55
    v_fma_f32 v225, -v39, v55, v225
    v_fma_f32 v227, v39, v53, v227
    v_pk_mul_f32 v[210:211], v[32:33], v[224:225] op_sel:[1,0] op_sel_hi:[1,1]
    v_pk_mul_f32 v[212:213], v[32:33], v[226:227] op_sel:[1,0] op_sel_hi:[1,1]
    v_pk_fma_f32 v[210:211], v[34:35], v[226:227], v[210:211] op_sel:[1,0,0] op_sel_hi:[1,1,1] neg_lo:[1,0,0] neg_hi:[1,0,0]
    v_pk_fma_f32 v[212:213], v[34:35], v[224:225], v[212:213] op_sel:[1,0,0] op_sel_hi:[1,1,1]
    s_waitcnt vmcnt(4)
    ds_read_b128 v[224:227], v4 offset:0
    ds_read_b128 v[240:243], v5 offset:4096
    ds_read_b128 v[228:231], v4 offset:128
    ds_read_b128 v[244:247], v5 offset:4224
    ds_read_b128 v[232:235], v4 offset:256
    ds_read_b128 v[248:251], v5 offset:4352
    ds_read_b128 v[236:239], v4 offset:384
    ds_read_b128 v[252:255], v5 offset:4480
    s_waitcnt lgkmcnt(0)
    v_mfma_f32_16x16x32_bf16 v[12:15], v[224:227], v[240:243], 0
    v_mfma_f32_16x16x32_bf16 v[12:15], v[228:231], v[244:247], v[12:15]
    v_mfma_f32_16x16x32_bf16 v[12:15], v[232:235], v[248:251], v[12:15]
    v_mfma_f32_16x16x32_bf16 v[12:15], v[236:239], v[252:255], v[12:15]
    s_nop 7
    s_mov_b32 exec_lo, 0x00030003
    s_mov_b32 exec_hi, 0x000c000c
    ds_write_b128 v6, v[12:15]
    s_mov_b64 exec, -1
    s_waitcnt lgkmcnt(0)
    s_barrier
    ds_read_b128 v[128:131], v16 offset:0
    ds_read_b128 v[144:147], v18 offset:16384
    ds_read_b128 v[148:151], v18 offset:18432
    ds_read_b128 v[152:155], v18 offset:20480
    ds_read_b128 v[156:159], v18 offset:22528
    ds_read_b128 v[132:135], v16 offset:2048
    ds_read_b128 v[136:139], v16 offset:4096
    ds_read_b128 v[140:143], v16 offset:6144
    s_waitcnt lgkmcnt(0)
    v_mfma_f32_16x16x32_bf16 v[64:67], v[128:131], v[144:147], 0
    ds_read_b128 v[160:163], v17 offset:0
    v_mfma_f32_16x16x32_bf16 v[68:71], v[128:131], v[148:151], 0
    ds_read_b128 v[176:179], v19 offset:16384
    v_mfma_f32_16x16x32_bf16 v[72:75], v[128:131], v[152:155], 0
    v_mfma_f32_16x16x32_bf16 v[76:79], v[128:131], v[156:159], 0
    ds_read_b128 v[180:183], v19 offset:18432
    v_mfma_f32_16x16x32_bf16 v[80:83], v[132:135], v[144:147], 0
    ds_read_b128 v[184:187], v19 offset:20480
    v_mfma_f32_16x16x32_bf16 v[84:87], v[132:135], v[148:151], 0
    v_mfma_f32_16x16x32_bf16 v[88:91], v[132:135], v[152:155], 0
    ds_read_b128 v[188:191], v19 offset:22528
    v_mfma_f32_16x16x32_bf16 v[92:95], v[132:135], v[156:159], 0
    ds_read_b128 v[164:167], v17 offset:2048
    v_mfma_f32_16x16x32_bf16 v[96:99], v[136:139], v[144:147], 0
    v_mfma_f32_16x16x32_bf16 v[100:103], v[136:139], v[148:151], 0
    ds_read_b128 v[168:171], v17 offset:4096
    v_mfma_f32_16x16x32_bf16 v[104:107], v[136:139], v[152:155], 0
    ds_read_b128 v[172:175], v17 offset:6144
    v_mfma_f32_16x16x32_bf16 v[108:111], v[136:139], v[156:159], 0
    v_mfma_f32_16x16x32_bf16 v[112:115], v[140:143], v[144:147], 0
    v_mfma_f32_16x16x32_bf16 v[116:119], v[140:143], v[148:151], 0
    v_mfma_f32_16x16x32_bf16 v[120:123], v[140:143], v[152:155], 0
    v_mfma_f32_16x16x32_bf16 v[124:127], v[140:143], v[156:159], 0
    s_waitcnt lgkmcnt(0)
    s_barrier
    v_mfma_f32_16x16x32_bf16 v[64:67], v[160:163], v[176:179], v[64:67]
    ds_read_b128 v[128:131], v16 offset:32768
    v_mfma_f32_16x16x32_bf16 v[68:71], v[160:163], v[180:183], v[68:71]
    ds_read_b128 v[144:147], v18 offset:49152
    v_mfma_f32_16x16x32_bf16 v[72:75], v[160:163], v[184:187], v[72:75]
    v_mfma_f32_16x16x32_bf16 v[76:79], v[160:163], v[188:191], v[76:79]
    ds_read_b128 v[148:151], v18 offset:51200
    v_mfma_f32_16x16x32_bf16 v[80:83], v[164:167], v[176:179], v[80:83]
    ds_read_b128 v[152:155], v18 offset:53248
    v_mfma_f32_16x16x32_bf16 v[84:87], v[164:167], v[180:183], v[84:87]
    v_mfma_f32_16x16x32_bf16 v[88:91], v[164:167], v[184:187], v[88:91]
    ds_read_b128 v[156:159], v18 offset:55296
    v_mfma_f32_16x16x32_bf16 v[92:95], v[164:167], v[188:191], v[92:95]
    ds_read_b128 v[132:135], v16 offset:34816
    v_mfma_f32_16x16x32_bf16 v[96:99], v[168:171], v[176:179], v[96:99]
    v_mfma_f32_16x16x32_bf16 v[100:103], v[168:171], v[180:183], v[100:103]
    ds_read_b128 v[136:139], v16 offset:36864
    v_mfma_f32_16x16x32_bf16 v[104:107], v[168:171], v[184:187], v[104:107]
    ds_read_b128 v[140:143], v16 offset:38912
    v_mfma_f32_16x16x32_bf16 v[108:111], v[168:171], v[188:191], v[108:111]
    v_mfma_f32_16x16x32_bf16 v[112:115], v[172:175], v[176:179], v[112:115]
    v_mfma_f32_16x16x32_bf16 v[116:119], v[172:175], v[180:183], v[116:119]
    v_mfma_f32_16x16x32_bf16 v[120:123], v[172:175], v[184:187], v[120:123]
    v_mfma_f32_16x16x32_bf16 v[124:127], v[172:175], v[188:191], v[124:127]
    s_waitcnt lgkmcnt(0)
    v_mfma_f32_16x16x32_bf16 v[64:67], v[128:131], v[144:147], v[64:67]
    ds_read_b128 v[160:163], v17 offset:32768
    v_mfma_f32_16x16x32_bf16 v[68:71], v[128:131], v[148:151], v[68:71]
    ds_read_b128 v[176:179], v19 offset:49152
    v_mfma_f32_16x16x32_bf16 v[72:75], v[128:131], v[152:155], v[72:75]
    v_mfma_f32_16x16x32_bf16 v[76:79], v[128:131], v[156:159], v[76:79]
    ds_read_b128 v[180:183], v19 offset:51200
    v_mfma_f32_16x16x32_bf16 v[80:83], v[132:135], v[144:147], v[80:83]
    ds_read_b128 v[184:187], v19 offset:53248
    v_mfma_f32_16x16x32_bf16 v[84:87], v[132:135], v[148:151], v[84:87]
    v_mfma_f32_16x16x32_bf16 v[88:91], v[132:135], v[152:155], v[88:91]
    ds_read_b128 v[188:191], v19 offset:55296
    v_mfma_f32_16x16x32_bf16 v[92:95], v[132:135], v[156:159], v[92:95]
    ds_read_b128 v[164:167], v17 offset:34816
    v_mfma_f32_16x16x32_bf16 v[96:99], v[136:139], v[144:147], v[96:99]
    v_mfma_f32_16x16x32_bf16 v[100:103], v[136:139], v[148:151], v[100:103]
    ds_read_b128 v[168:171], v17 offset:36864
    v_mfma_f32_16x16x32_bf16 v[104:107], v[136:139], v[152:155], v[104:107]
    ds_read_b128 v[172:175], v17 offset:38912
    v_mfma_f32_16x16x32_bf16 v[108:111], v[136:139], v[156:159], v[108:111]
    v_mfma_f32_16x16x32_bf16 v[112:115], v[140:143], v[144:147], v[112:115]
    v_mfma_f32_16x16x32_bf16 v[116:119], v[140:143], v[148:151], v[116:119]
    v_mfma_f32_16x16x32_bf16 v[120:123], v[140:143], v[152:155], v[120:123]
    v_mfma_f32_16x16x32_bf16 v[124:127], v[140:143], v[156:159], v[124:127]
    s_waitcnt lgkmcnt(0)
    s_barrier
    v_mfma_f32_16x16x32_bf16 v[64:67], v[160:163], v[176:179], v[64:67]
    ds_read_b128 v[128:131], v20 offset:0
    v_mfma_f32_16x16x32_bf16 v[68:71], v[160:163], v[180:183], v[68:71]
    ds_read_b128 v[144:147], v22 offset:16384
    v_mfma_f32_16x16x32_bf16 v[72:75], v[160:163], v[184:187], v[72:75]
    v_mfma_f32_16x16x32_bf16 v[76:79], v[160:163], v[188:191], v[76:79]
    ds_read_b128 v[148:151], v22 offset:18432
    v_mfma_f32_16x16x32_bf16 v[80:83], v[164:167], v[176:179], v[80:83]
    ds_read_b128 v[152:155], v22 offset:20480
    v_mfma_f32_16x16x32_bf16 v[84:87], v[164:167], v[180:183], v[84:87]
    v_mfma_f32_16x16x32_bf16 v[88:91], v[164:167], v[184:187], v[88:91]
    ds_read_b128 v[156:159], v22 offset:22528
    v_mfma_f32_16x16x32_bf16 v[92:95], v[164:167], v[188:191], v[92:95]
    ds_read_b128 v[132:135], v20 offset:2048
    v_mfma_f32_16x16x32_bf16 v[96:99], v[168:171], v[176:179], v[96:99]
    v_mfma_f32_16x16x32_bf16 v[100:103], v[168:171], v[180:183], v[100:103]
    ds_read_b128 v[136:139], v20 offset:4096
    v_mfma_f32_16x16x32_bf16 v[104:107], v[168:171], v[184:187], v[104:107]
    ds_read_b128 v[140:143], v20 offset:6144
    v_mfma_f32_16x16x32_bf16 v[108:111], v[168:171], v[188:191], v[108:111]
    v_mfma_f32_16x16x32_bf16 v[112:115], v[172:175], v[176:179], v[112:115]
    v_mfma_f32_16x16x32_bf16 v[116:119], v[172:175], v[180:183], v[116:119]
    v_mfma_f32_16x16x32_bf16 v[120:123], v[172:175], v[184:187], v[120:123]
    v_mfma_f32_16x16x32_bf16 v[124:127], v[172:175], v[188:191], v[124:127]
    s_waitcnt lgkmcnt(0)
    v_mfma_f32_16x16x32_bf16 v[64:67], v[128:131], v[144:147], v[64:67]
    ds_read_b128 v[160:163], v21 offset:0
    v_mfma_f32_16x16x32_bf16 v[68:71], v[128:131], v[148:151], v[68:71]
    ds_read_b128 v[176:179], v23 offset:16384
    v_mfma_f32_16x16x32_bf16 v[72:75], v[128:131], v[152:155], v[72:75]
    v_mfma_f32_16x16x32_bf16 v[76:79], v[128:131], v[156:159], v[76:79]
    ds_read_b128 v[180:183], v23 offset:18432
    v_mfma_f32_16x16x32_bf16 v[80:83], v[132:135], v[144:147], v[80:83]
    ds_read_b128 v[184:187], v23 offset:20480
    v_mfma_f32_16x16x32_bf16 v[84:87], v[132:135], v[148:151], v[84:87]
    v_mfma_f32_16x16x32_bf16 v[88:91], v[132:135], v[152:155], v[88:91]
    ds_read_b128 v[188:191], v23 offset:22528
    v_mfma_f32_16x16x32_bf16 v[92:95], v[132:135], v[156:159], v[92:95]
    ds_read_b128 v[164:167], v21 offset:2048
    v_mfma_f32_16x16x32_bf16 v[96:99], v[136:139], v[144:147], v[96:99]
    v_mfma_f32_16x16x32_bf16 v[100:103], v[136:139], v[148:151], v[100:103]
    ds_read_b128 v[168:171], v21 offset:4096
    v_mfma_f32_16x16x32_bf16 v[104:107], v[136:139], v[152:155], v[104:107]
    ds_read_b128 v[172:175], v21 offset:6144
    v_mfma_f32_16x16x32_bf16 v[108:111], v[136:139], v[156:159], v[108:111]
    v_mfma_f32_16x16x32_bf16 v[112:115], v[140:143], v[144:147], v[112:115]
    v_mfma_f32_16x16x32_bf16 v[116:119], v[140:143], v[148:151], v[116:119]
    v_mfma_f32_16x16x32_bf16 v[120:123], v[140:143], v[152:155], v[120:123]
    v_mfma_f32_16x16x32_bf16 v[124:127], v[140:143], v[156:159], v[124:127]
    s_waitcnt lgkmcnt(0)
    s_barrier
    v_mfma_f32_16x16x32_bf16 v[64:67], v[160:163], v[176:179], v[64:67]
    ds_read_b128 v[128:131], v16 offset:0
    v_mfma_f32_16x16x32_bf16 v[68:71], v[160:163], v[180:183], v[68:71]
    ds_read_b128 v[144:147], v18 offset:16384
    v_mfma_f32_16x16x32_bf16 v[72:75], v[160:163], v[184:187], v[72:75]
    v_mfma_f32_16x16x32_bf16 v[76:79], v[160:163], v[188:191], v[76:79]
    ds_read_b128 v[148:151], v18 offset:18432
    v_mfma_f32_16x16x32_bf16 v[80:83], v[164:167], v[176:179], v[80:83]
    ds_read_b128 v[152:155], v18 offset:20480
    v_mfma_f32_16x16x32_bf16 v[84:87], v[164:167], v[180:183], v[84:87]
    v_mfma_f32_16x16x32_bf16 v[88:91], v[164:167], v[184:187], v[88:91]
    ds_read_b128 v[156:159], v18 offset:22528
    v_mfma_f32_16x16x32_bf16 v[92:95], v[164:167], v[188:191], v[92:95]
    ds_read_b128 v[132:135], v16 offset:2048
    v_mfma_f32_16x16x32_bf16 v[96:99], v[168:171], v[176:179], v[96:99]
    v_mfma_f32_16x16x32_bf16 v[100:103], v[168:171], v[180:183], v[100:103]
    ds_read_b128 v[136:139], v16 offset:4096
    v_mfma_f32_16x16x32_bf16 v[104:107], v[168:171], v[184:187], v[104:107]
    ds_read_b128 v[140:143], v16 offset:6144
    v_mfma_f32_16x16x32_bf16 v[108:111], v[168:171], v[188:191], v[108:111]
    v_mfma_f32_16x16x32_bf16 v[112:115], v[172:175], v[176:179], v[112:115]
    v_mfma_f32_16x16x32_bf16 v[116:119], v[172:175], v[180:183], v[116:119]
    v_mfma_f32_16x16x32_bf16 v[120:123], v[172:175], v[184:187], v[120:123]
    v_mfma_f32_16x16x32_bf16 v[124:127], v[172:175], v[188:191], v[124:127]
    s_waitcnt lgkmcnt(0)
    v_mfma_f32_16x16x32_bf16 v[64:67], v[128:131], v[144:147], v[64:67]
    ds_read_b128 v[160:163], v17 offset:0
    v_mfma_f32_16x16x32_bf16 v[68:71], v[128:131], v[148:151], v[68:71]
    ds_read_b128 v[176:179], v19 offset:16384
    v_mfma_f32_16x16x32_bf16 v[72:75], v[128:131], v[152:155], v[72:75]
    v_mfma_f32_16x16x32_bf16 v[76:79], v[128:131], v[156:159], v[76:79]
    ds_read_b128 v[180:183], v19 offset:18432
    v_mfma_f32_16x16x32_bf16 v[80:83], v[132:135], v[144:147], v[80:83]
    ds_read_b128 v[184:187], v19 offset:20480
    v_mfma_f32_16x16x32_bf16 v[84:87], v[132:135], v[148:151], v[84:87]
    v_mfma_f32_16x16x32_bf16 v[88:91], v[132:135], v[152:155], v[88:91]
    ds_read_b128 v[188:191], v19 offset:22528
    v_mfma_f32_16x16x32_bf16 v[92:95], v[132:135], v[156:159], v[92:95]
    ds_read_b128 v[164:167], v17 offset:2048
    v_mfma_f32_16x16x32_bf16 v[96:99], v[136:139], v[144:147], v[96:99]
    v_mfma_f32_16x16x32_bf16 v[100:103], v[136:139], v[148:151], v[100:103]
    ds_read_b128 v[168:171], v17 offset:4096
    v_mfma_f32_16x16x32_bf16 v[104:107], v[136:139], v[152:155], v[104:107]
    ds_read_b128 v[172:175], v17 offset:6144
    v_mfma_f32_16x16x32_bf16 v[108:111], v[136:139], v[156:159], v[108:111]
    v_mfma_f32_16x16x32_bf16 v[112:115], v[140:143], v[144:147], v[112:115]
    v_mfma_f32_16x16x32_bf16 v[116:119], v[140:143], v[148:151], v[116:119]
    v_mfma_f32_16x16x32_bf16 v[120:123], v[140:143], v[152:155], v[120:123]
    v_mfma_f32_16x16x32_bf16 v[124:127], v[140:143], v[156:159], v[124:127]
    s_waitcnt lgkmcnt(0)
    s_barrier
    v_mfma_f32_16x16x32_bf16 v[64:67], v[160:163], v[176:179], v[64:67]
    ds_read_b128 v[128:131], v16 offset:32768
    v_mfma_f32_16x16x32_bf16 v[68:71], v[160:163], v[180:183], v[68:71]
    ds_read_b128 v[144:147], v18 offset:49152
    v_mfma_f32_16x16x32_bf16 v[72:75], v[160:163], v[184:187], v[72:75]
    v_mfma_f32_16x16x32_bf16 v[76:79], v[160:163], v[188:191], v[76:79]
    ds_read_b128 v[148:151], v18 offset:51200
    v_mfma_f32_16x16x32_bf16 v[80:83], v[164:167], v[176:179], v[80:83]
    ds_read_b128 v[152:155], v18 offset:53248
    v_mfma_f32_16x16x32_bf16 v[84:87], v[164:167], v[180:183], v[84:87]
    v_mfma_f32_16x16x32_bf16 v[88:91], v[164:167], v[184:187], v[88:91]
    ds_read_b128 v[156:159], v18 offset:55296
    v_mfma_f32_16x16x32_bf16 v[92:95], v[164:167], v[188:191], v[92:95]
    ds_read_b128 v[132:135], v16 offset:34816
    v_mfma_f32_16x16x32_bf16 v[96:99], v[168:171], v[176:179], v[96:99]
    v_mfma_f32_16x16x32_bf16 v[100:103], v[168:171], v[180:183], v[100:103]
    ds_read_b128 v[136:139], v16 offset:36864
    v_mfma_f32_16x16x32_bf16 v[104:107], v[168:171], v[184:187], v[104:107]
    ds_read_b128 v[140:143], v16 offset:38912
    v_mfma_f32_16x16x32_bf16 v[108:111], v[168:171], v[188:191], v[108:111]
    v_mfma_f32_16x16x32_bf16 v[112:115], v[172:175], v[176:179], v[112:115]
    v_mfma_f32_16x16x32_bf16 v[116:119], v[172:175], v[180:183], v[116:119]
    v_mfma_f32_16x16x32_bf16 v[120:123], v[172:175], v[184:187], v[120:123]
    v_mfma_f32_16x16x32_bf16 v[124:127], v[172:175], v[188:191], v[124:127]
    s_waitcnt lgkmcnt(0)
    v_mfma_f32_16x16x32_bf16 v[64:67], v[128:131], v[144:147], v[64:67]
    ds_read_b128 v[160:163], v17 offset:32768
    v_mfma_f32_16x16x32_bf16 v[68:71], v[128:131], v[148:151], v[68:71]
    ds_read_b128 v[176:179], v19 offset:49152
    v_mfma_f32_16x16x32_bf16 v[72:75], v[128:131], v[152:155], v[72:75]
    v_mfma_f32_16x16x32_bf16 v[76:79], v[128:131], v[156:159], v[76:79]
    ds_read_b128 v[180:183], v19 offset:51200
    v_mfma_f32_16x16x32_bf16 v[80:83], v[132:135], v[144:147], v[80:83]
    ds_read_b128 v[184:187], v19 offset:53248
    v_mfma_f32_16x16x32_bf16 v[84:87], v[132:135], v[148:151], v[84:87]
    v_mfma_f32_16x16x32_bf16 v[88:91], v[132:135], v[152:155], v[88:91]
    ds_read_b128 v[188:191], v19 offset:55296
    v_mfma_f32_16x16x32_bf16 v[92:95], v[132:135], v[156:159], v[92:95]
    ds_read_b128 v[164:167], v17 offset:34816
    v_mfma_f32_16x16x32_bf16 v[96:99], v[136:139], v[144:147], v[96:99]
    v_mfma_f32_16x16x32_bf16 v[100:103], v[136:139], v[148:151], v[100:103]
    ds_read_b128 v[168:171], v17 offset:36864
    v_mfma_f32_16x16x32_bf16 v[104:107], v[136:139], v[152:155], v[104:107]
    ds_read_b128 v[172:175], v17 offset:38912
    v_mfma_f32_16x16x32_bf16 v[108:111], v[136:139], v[156:159], v[108:111]
    v_mfma_f32_16x16x32_bf16 v[112:115], v[140:143], v[144:147], v[112:115]
    v_mfma_f32_16x16x32_bf16 v[116:119], v[140:143], v[148:151], v[116:119]
    v_mfma_f32_16x16x32_bf16 v[120:123], v[140:143], v[152:155], v[120:123]
    v_mfma_f32_16x16x32_bf16 v[124:127], v[140:143], v[156:159], v[124:127]
    s_waitcnt lgkmcnt(0)
    s_barrier
    v_mfma_f32_16x16x32_bf16 v[64:67], v[160:163], v[176:179], v[64:67]
    ds_read_b128 v[128:131], v20 offset:0
    v_mfma_f32_16x16x32_bf16 v[68:71], v[160:163], v[180:183], v[68:71]
    ds_read_b128 v[144:147], v22 offset:16384
    v_mfma_f32_16x16x32_bf16 v[72:75], v[160:163], v[184:187], v[72:75]
    v_mfma_f32_16x16x32_bf16 v[76:79], v[160:163], v[188:191], v[76:79]
    ds_read_b128 v[148:151], v22 offset:18432
    v_mfma_f32_16x16x32_bf16 v[80:83], v[164:167], v[176:179], v[80:83]
    ds_read_b128 v[152:155], v22 offset:20480
    v_mfma_f32_16x16x32_bf16 v[84:87], v[164:167], v[180:183], v[84:87]
    v_mfma_f32_16x16x32_bf16 v[88:91], v[164:167], v[184:187], v[88:91]
    ds_read_b128 v[156:159], v22 offset:22528
    v_mfma_f32_16x16x32_bf16 v[92:95], v[164:167], v[188:191], v[92:95]
    ds_read_b128 v[132:135], v20 offset:2048
    v_mfma_f32_16x16x32_bf16 v[96:99], v[168:171], v[176:179], v[96:99]
    v_mfma_f32_16x16x32_bf16 v[100:103], v[168:171], v[180:183], v[100:103]
    ds_read_b128 v[136:139], v20 offset:4096
    v_mfma_f32_16x16x32_bf16 v[104:107], v[168:171], v[184:187], v[104:107]
    ds_read_b128 v[140:143], v20 offset:6144
    v_mfma_f32_16x16x32_bf16 v[108:111], v[168:171], v[188:191], v[108:111]
    v_mfma_f32_16x16x32_bf16 v[112:115], v[172:175], v[176:179], v[112:115]
    v_mfma_f32_16x16x32_bf16 v[116:119], v[172:175], v[180:183], v[116:119]
    v_mfma_f32_16x16x32_bf16 v[120:123], v[172:175], v[184:187], v[120:123]
    v_mfma_f32_16x16x32_bf16 v[124:127], v[172:175], v[188:191], v[124:127]
    s_waitcnt lgkmcnt(0)
    v_mfma_f32_16x16x32_bf16 v[64:67], v[128:131], v[144:147], v[64:67]
    ds_read_b128 v[160:163], v21 offset:0
    v_mfma_f32_16x16x32_bf16 v[68:71], v[128:131], v[148:151], v[68:71]
    ds_read_b128 v[176:179], v23 offset:16384
    v_mfma_f32_16x16x32_bf16 v[72:75], v[128:131], v[152:155], v[72:75]
    v_mfma_f32_16x16x32_bf16 v[76:79], v[128:131], v[156:159], v[76:79]
    ds_read_b128 v[180:183], v23 offset:18432
    v_mfma_f32_16x16x32_bf16 v[80:83], v[132:135], v[144:147], v[80:83]
    ds_read_b128 v[184:187], v23 offset:20480
    v_mfma_f32_16x16x32_bf16 v[84:87], v[132:135], v[148:151], v[84:87]
    v_mfma_f32_16x16x32_bf16 v[88:91], v[132:135], v[152:155], v[88:91]
    ds_read_b128 v[188:191], v23 offset:22528
    v_mfma_f32_16x16x32_bf16 v[92:95], v[132:135], v[156:159], v[92:95]
    ds_read_b128 v[164:167], v21 offset:2048
    v_mfma_f32_16x16x32_bf16 v[96:99], v[136:139], v[144:147], v[96:99]
    v_mfma_f32_16x16x32_bf16 v[100:103], v[136:139], v[148:151], v[100:103]
    ds_read_b128 v[168:171], v21 offset:4096
    v_mfma_f32_16x16x32_bf16 v[104:107], v[136:139], v[152:155], v[104:107]
    ds_read_b128 v[172:175], v21 offset:6144
    v_mfma_f32_16x16x32_bf16 v[108:111], v[136:139], v[156:159], v[108:111]
    v_mfma_f32_16x16x32_bf16 v[112:115], v[140:143], v[144:147], v[112:115]
    v_mfma_f32_16x16x32_bf16 v[116:119], v[140:143], v[148:151], v[116:119]
    v_mfma_f32_16x16x32_bf16 v[120:123], v[140:143], v[152:155], v[120:123]
    v_mfma_f32_16x16x32_bf16 v[124:127], v[140:143], v[156:159], v[124:127]
    s_waitcnt lgkmcnt(0)
    s_barrier
    v_mfma_f32_16x16x32_bf16 v[64:67], v[160:163], v[176:179], v[64:67]
    ds_read_b128 v[128:131], v16 offset:0
    v_mfma_f32_16x16x32_bf16 v[68:71], v[160:163], v[180:183], v[68:71]
    ds_read_b128 v[144:147], v18 offset:16384
    v_mfma_f32_16x16x32_bf16 v[72:75], v[160:163], v[184:187], v[72:75]
    v_mfma_f32_16x16x32_bf16 v[76:79], v[160:163], v[188:191], v[76:79]
    ds_read_b128 v[148:151], v18 offset:18432
    v_mfma_f32_16x16x32_bf16 v[80:83], v[164:167], v[176:179], v[80:83]
    ds_read_b128 v[152:155], v18 offset:20480
    v_mfma_f32_16x16x32_bf16 v[84:87], v[164:167], v[180:183], v[84:87]
    v_mfma_f32_16x16x32_bf16 v[88:91], v[164:167], v[184:187], v[88:91]
    ds_read_b128 v[156:159], v18 offset:22528
    v_mfma_f32_16x16x32_bf16 v[92:95], v[164:167], v[188:191], v[92:95]
    ds_read_b128 v[132:135], v16 offset:2048
    v_mfma_f32_16x16x32_bf16 v[96:99], v[168:171], v[176:179], v[96:99]
    v_mfma_f32_16x16x32_bf16 v[100:103], v[168:171], v[180:183], v[100:103]
    ds_read_b128 v[136:139], v16 offset:4096
    v_mfma_f32_16x16x32_bf16 v[104:107], v[168:171], v[184:187], v[104:107]
    ds_read_b128 v[140:143], v16 offset:6144
    v_mfma_f32_16x16x32_bf16 v[108:111], v[168:171], v[188:191], v[108:111]
    v_mfma_f32_16x16x32_bf16 v[112:115], v[172:175], v[176:179], v[112:115]
    v_mfma_f32_16x16x32_bf16 v[116:119], v[172:175], v[180:183], v[116:119]
    v_mfma_f32_16x16x32_bf16 v[120:123], v[172:175], v[184:187], v[120:123]
    v_mfma_f32_16x16x32_bf16 v[124:127], v[172:175], v[188:191], v[124:127]
    s_waitcnt lgkmcnt(0)
    v_mfma_f32_16x16x32_bf16 v[64:67], v[128:131], v[144:147], v[64:67]
    ds_read_b128 v[160:163], v17 offset:0
    v_mfma_f32_16x16x32_bf16 v[68:71], v[128:131], v[148:151], v[68:71]
    ds_read_b128 v[176:179], v19 offset:16384
    v_mfma_f32_16x16x32_bf16 v[72:75], v[128:131], v[152:155], v[72:75]
    v_mfma_f32_16x16x32_bf16 v[76:79], v[128:131], v[156:159], v[76:79]
    ds_read_b128 v[180:183], v19 offset:18432
    v_mfma_f32_16x16x32_bf16 v[80:83], v[132:135], v[144:147], v[80:83]
    ds_read_b128 v[184:187], v19 offset:20480
    v_mfma_f32_16x16x32_bf16 v[84:87], v[132:135], v[148:151], v[84:87]
    v_mfma_f32_16x16x32_bf16 v[88:91], v[132:135], v[152:155], v[88:91]
    ds_read_b128 v[188:191], v19 offset:22528
    v_mfma_f32_16x16x32_bf16 v[92:95], v[132:135], v[156:159], v[92:95]
    ds_read_b128 v[164:167], v17 offset:2048
    v_mfma_f32_16x16x32_bf16 v[96:99], v[136:139], v[144:147], v[96:99]
    v_mfma_f32_16x16x32_bf16 v[100:103], v[136:139], v[148:151], v[100:103]
    ds_read_b128 v[168:171], v17 offset:4096
    v_mfma_f32_16x16x32_bf16 v[104:107], v[136:139], v[152:155], v[104:107]
    ds_read_b128 v[172:175], v17 offset:6144
    v_mfma_f32_16x16x32_bf16 v[108:111], v[136:139], v[156:159], v[108:111]
    v_mfma_f32_16x16x32_bf16 v[112:115], v[140:143], v[144:147], v[112:115]
    v_mfma_f32_16x16x32_bf16 v[116:119], v[140:143], v[148:151], v[116:119]
    v_mfma_f32_16x16x32_bf16 v[120:123], v[140:143], v[152:155], v[120:123]
    v_mfma_f32_16x16x32_bf16 v[124:127], v[140:143], v[156:159], v[124:127]
    s_waitcnt lgkmcnt(0)
    s_barrier
    v_mfma_f32_16x16x32_bf16 v[64:67], v[160:163], v[176:179], v[64:67]
    ds_read_b128 v[128:131], v16 offset:32768
    v_mfma_f32_16x16x32_bf16 v[68:71], v[160:163], v[180:183], v[68:71]
    ds_read_b128 v[144:147], v18 offset:49152
    v_mfma_f32_16x16x32_bf16 v[72:75], v[160:163], v[184:187], v[72:75]
    v_mfma_f32_16x16x32_bf16 v[76:79], v[160:163], v[188:191], v[76:79]
    ds_read_b128 v[148:151], v18 offset:51200
    v_mfma_f32_16x16x32_bf16 v[80:83], v[164:167], v[176:179], v[80:83]
    ds_read_b128 v[152:155], v18 offset:53248
    v_mfma_f32_16x16x32_bf16 v[84:87], v[164:167], v[180:183], v[84:87]
    v_mfma_f32_16x16x32_bf16 v[88:91], v[164:167], v[184:187], v[88:91]
    ds_read_b128 v[156:159], v18 offset:55296
    v_mfma_f32_16x16x32_bf16 v[92:95], v[164:167], v[188:191], v[92:95]
    ds_read_b128 v[132:135], v16 offset:34816
    v_mfma_f32_16x16x32_bf16 v[96:99], v[168:171], v[176:179], v[96:99]
    v_mfma_f32_16x16x32_bf16 v[100:103], v[168:171], v[180:183], v[100:103]
    ds_read_b128 v[136:139], v16 offset:36864
    v_mfma_f32_16x16x32_bf16 v[104:107], v[168:171], v[184:187], v[104:107]
    ds_read_b128 v[140:143], v16 offset:38912
    v_mfma_f32_16x16x32_bf16 v[108:111], v[168:171], v[188:191], v[108:111]
    v_mfma_f32_16x16x32_bf16 v[112:115], v[172:175], v[176:179], v[112:115]
    v_mfma_f32_16x16x32_bf16 v[116:119], v[172:175], v[180:183], v[116:119]
    v_mfma_f32_16x16x32_bf16 v[120:123], v[172:175], v[184:187], v[120:123]
    v_mfma_f32_16x16x32_bf16 v[124:127], v[172:175], v[188:191], v[124:127]
    s_waitcnt lgkmcnt(0)
    v_mfma_f32_16x16x32_bf16 v[64:67], v[128:131], v[144:147], v[64:67]
    ds_read_b128 v[160:163], v17 offset:32768
    v_mfma_f32_16x16x32_bf16 v[68:71], v[128:131], v[148:151], v[68:71]
    ds_read_b128 v[176:179], v19 offset:49152
    v_mfma_f32_16x16x32_bf16 v[72:75], v[128:131], v[152:155], v[72:75]
    v_mfma_f32_16x16x32_bf16 v[76:79], v[128:131], v[156:159], v[76:79]
    ds_read_b128 v[180:183], v19 offset:51200
    v_mfma_f32_16x16x32_bf16 v[80:83], v[132:135], v[144:147], v[80:83]
    ds_read_b128 v[184:187], v19 offset:53248
    v_mfma_f32_16x16x32_bf16 v[84:87], v[132:135], v[148:151], v[84:87]
    v_mfma_f32_16x16x32_bf16 v[88:91], v[132:135], v[152:155], v[88:91]
    ds_read_b128 v[188:191], v19 offset:55296
    v_mfma_f32_16x16x32_bf16 v[92:95], v[132:135], v[156:159], v[92:95]
    ds_read_b128 v[164:167], v17 offset:34816
    v_mfma_f32_16x16x32_bf16 v[96:99], v[136:139], v[144:147], v[96:99]
    v_mfma_f32_16x16x32_bf16 v[100:103], v[136:139], v[148:151], v[100:103]
    ds_read_b128 v[168:171], v17 offset:36864
    v_mfma_f32_16x16x32_bf16 v[104:107], v[136:139], v[152:155], v[104:107]
    ds_read_b128 v[172:175], v17 offset:38912
    v_mfma_f32_16x16x32_bf16 v[108:111], v[136:139], v[156:159], v[108:111]
    v_mfma_f32_16x16x32_bf16 v[112:115], v[140:143], v[144:147], v[112:115]
    v_mfma_f32_16x16x32_bf16 v[116:119], v[140:143], v[148:151], v[116:119]
    v_mfma_f32_16x16x32_bf16 v[120:123], v[140:143], v[152:155], v[120:123]
    v_mfma_f32_16x16x32_bf16 v[124:127], v[140:143], v[156:159], v[124:127]
    s_waitcnt lgkmcnt(0)
    s_barrier
    v_mfma_f32_16x16x32_bf16 v[64:67], v[160:163], v[176:179], v[64:67]
    ds_read_b128 v[128:131], v20 offset:0
    v_mfma_f32_16x16x32_bf16 v[68:71], v[160:163], v[180:183], v[68:71]
    ds_read_b128 v[144:147], v22 offset:16384
    v_mfma_f32_16x16x32_bf16 v[72:75], v[160:163], v[184:187], v[72:75]
    v_mfma_f32_16x16x32_bf16 v[76:79], v[160:163], v[188:191], v[76:79]
    ds_read_b128 v[148:151], v22 offset:18432
    v_mfma_f32_16x16x32_bf16 v[80:83], v[164:167], v[176:179], v[80:83]
    ds_read_b128 v[152:155], v22 offset:20480
    v_mfma_f32_16x16x32_bf16 v[84:87], v[164:167], v[180:183], v[84:87]
    v_mfma_f32_16x16x32_bf16 v[88:91], v[164:167], v[184:187], v[88:91]
    ds_read_b128 v[156:159], v22 offset:22528
    v_mfma_f32_16x16x32_bf16 v[92:95], v[164:167], v[188:191], v[92:95]
    ds_read_b128 v[132:135], v20 offset:2048
    v_mfma_f32_16x16x32_bf16 v[96:99], v[168:171], v[176:179], v[96:99]
    v_mfma_f32_16x16x32_bf16 v[100:103], v[168:171], v[180:183], v[100:103]
    ds_read_b128 v[136:139], v20 offset:4096
    v_mfma_f32_16x16x32_bf16 v[104:107], v[168:171], v[184:187], v[104:107]
    ds_read_b128 v[140:143], v20 offset:6144
    v_mfma_f32_16x16x32_bf16 v[108:111], v[168:171], v[188:191], v[108:111]
    v_mfma_f32_16x16x32_bf16 v[112:115], v[172:175], v[176:179], v[112:115]
    v_mfma_f32_16x16x32_bf16 v[116:119], v[172:175], v[180:183], v[116:119]
    v_mfma_f32_16x16x32_bf16 v[120:123], v[172:175], v[184:187], v[120:123]
    v_mfma_f32_16x16x32_bf16 v[124:127], v[172:175], v[188:191], v[124:127]
    s_waitcnt lgkmcnt(0)
    v_mfma_f32_16x16x32_bf16 v[64:67], v[128:131], v[144:147], v[64:67]
    ds_read_b128 v[160:163], v21 offset:0
    v_mfma_f32_16x16x32_bf16 v[68:71], v[128:131], v[148:151], v[68:71]
    ds_read_b128 v[176:179], v23 offset:16384
    v_mfma_f32_16x16x32_bf16 v[72:75], v[128:131], v[152:155], v[72:75]
    v_mfma_f32_16x16x32_bf16 v[76:79], v[128:131], v[156:159], v[76:79]
    ds_read_b128 v[180:183], v23 offset:18432
    v_mfma_f32_16x16x32_bf16 v[80:83], v[132:135], v[144:147], v[80:83]
    ds_read_b128 v[184:187], v23 offset:20480
    v_mfma_f32_16x16x32_bf16 v[84:87], v[132:135], v[148:151], v[84:87]
    v_mfma_f32_16x16x32_bf16 v[88:91], v[132:135], v[152:155], v[88:91]
    ds_read_b128 v[188:191], v23 offset:22528
    v_mfma_f32_16x16x32_bf16 v[92:95], v[132:135], v[156:159], v[92:95]
    ds_read_b128 v[164:167], v21 offset:2048
    v_mfma_f32_16x16x32_bf16 v[96:99], v[136:139], v[144:147], v[96:99]
    v_mfma_f32_16x16x32_bf16 v[100:103], v[136:139], v[148:151], v[100:103]
    ds_read_b128 v[168:171], v21 offset:4096
    v_mfma_f32_16x16x32_bf16 v[104:107], v[136:139], v[152:155], v[104:107]
    ds_read_b128 v[172:175], v21 offset:6144
    v_mfma_f32_16x16x32_bf16 v[108:111], v[136:139], v[156:159], v[108:111]
    v_mfma_f32_16x16x32_bf16 v[112:115], v[140:143], v[144:147], v[112:115]
    v_mfma_f32_16x16x32_bf16 v[116:119], v[140:143], v[148:151], v[116:119]
    v_mfma_f32_16x16x32_bf16 v[120:123], v[140:143], v[152:155], v[120:123]
    v_mfma_f32_16x16x32_bf16 v[124:127], v[140:143], v[156:159], v[124:127]
    s_waitcnt lgkmcnt(0)
    s_barrier
    v_mfma_f32_16x16x32_bf16 v[64:67], v[160:163], v[176:179], v[64:67]
    ds_read_b128 v[128:131], v16 offset:0
    v_mfma_f32_16x16x32_bf16 v[68:71], v[160:163], v[180:183], v[68:71]
    ds_read_b128 v[144:147], v18 offset:16384
    v_mfma_f32_16x16x32_bf16 v[72:75], v[160:163], v[184:187], v[72:75]
    v_mfma_f32_16x16x32_bf16 v[76:79], v[160:163], v[188:191], v[76:79]
    ds_read_b128 v[148:151], v18 offset:18432
    v_mfma_f32_16x16x32_bf16 v[80:83], v[164:167], v[176:179], v[80:83]
    ds_read_b128 v[152:155], v18 offset:20480
    v_mfma_f32_16x16x32_bf16 v[84:87], v[164:167], v[180:183], v[84:87]
    v_mfma_f32_16x16x32_bf16 v[88:91], v[164:167], v[184:187], v[88:91]
    ds_read_b128 v[156:159], v18 offset:22528
    v_mfma_f32_16x16x32_bf16 v[92:95], v[164:167], v[188:191], v[92:95]
    ds_read_b128 v[132:135], v16 offset:2048
    v_mfma_f32_16x16x32_bf16 v[96:99], v[168:171], v[176:179], v[96:99]
    v_mfma_f32_16x16x32_bf16 v[100:103], v[168:171], v[180:183], v[100:103]
    ds_read_b128 v[136:139], v16 offset:4096
    v_mfma_f32_16x16x32_bf16 v[104:107], v[168:171], v[184:187], v[104:107]
    ds_read_b128 v[140:143], v16 offset:6144
    v_mfma_f32_16x16x32_bf16 v[108:111], v[168:171], v[188:191], v[108:111]
    v_mfma_f32_16x16x32_bf16 v[112:115], v[172:175], v[176:179], v[112:115]
    v_mfma_f32_16x16x32_bf16 v[116:119], v[172:175], v[180:183], v[116:119]
    v_mfma_f32_16x16x32_bf16 v[120:123], v[172:175], v[184:187], v[120:123]
    v_mfma_f32_16x16x32_bf16 v[124:127], v[172:175], v[188:191], v[124:127]
    s_waitcnt lgkmcnt(0)
    v_mfma_f32_16x16x32_bf16 v[64:67], v[128:131], v[144:147], v[64:67]
    ds_read_b128 v[160:163], v17 offset:0
    v_mfma_f32_16x16x32_bf16 v[68:71], v[128:131], v[148:151], v[68:71]
    ds_read_b128 v[176:179], v19 offset:16384
    v_mfma_f32_16x16x32_bf16 v[72:75], v[128:131], v[152:155], v[72:75]
    v_mfma_f32_16x16x32_bf16 v[76:79], v[128:131], v[156:159], v[76:79]
    ds_read_b128 v[180:183], v19 offset:18432
    v_mfma_f32_16x16x32_bf16 v[80:83], v[132:135], v[144:147], v[80:83]
    ds_read_b128 v[184:187], v19 offset:20480
    v_mfma_f32_16x16x32_bf16 v[84:87], v[132:135], v[148:151], v[84:87]
    v_mfma_f32_16x16x32_bf16 v[88:91], v[132:135], v[152:155], v[88:91]
    ds_read_b128 v[188:191], v19 offset:22528
    v_mfma_f32_16x16x32_bf16 v[92:95], v[132:135], v[156:159], v[92:95]
    ds_read_b128 v[164:167], v17 offset:2048
    v_mfma_f32_16x16x32_bf16 v[96:99], v[136:139], v[144:147], v[96:99]
    v_mfma_f32_16x16x32_bf16 v[100:103], v[136:139], v[148:151], v[100:103]
    ds_read_b128 v[168:171], v17 offset:4096
    v_mfma_f32_16x16x32_bf16 v[104:107], v[136:139], v[152:155], v[104:107]
    ds_read_b128 v[172:175], v17 offset:6144
    v_mfma_f32_16x16x32_bf16 v[108:111], v[136:139], v[156:159], v[108:111]
    v_mfma_f32_16x16x32_bf16 v[112:115], v[140:143], v[144:147], v[112:115]
    v_mfma_f32_16x16x32_bf16 v[116:119], v[140:143], v[148:151], v[116:119]
    v_mfma_f32_16x16x32_bf16 v[120:123], v[140:143], v[152:155], v[120:123]
    v_mfma_f32_16x16x32_bf16 v[124:127], v[140:143], v[156:159], v[124:127]
    s_waitcnt lgkmcnt(0)
    s_barrier
    v_mfma_f32_16x16x32_bf16 v[64:67], v[160:163], v[176:179], v[64:67]
    ds_read_b128 v[128:131], v16 offset:32768
    v_mfma_f32_16x16x32_bf16 v[68:71], v[160:163], v[180:183], v[68:71]
    ds_read_b128 v[144:147], v18 offset:49152
    v_mfma_f32_16x16x32_bf16 v[72:75], v[160:163], v[184:187], v[72:75]
    v_mfma_f32_16x16x32_bf16 v[76:79], v[160:163], v[188:191], v[76:79]
    ds_read_b128 v[148:151], v18 offset:51200
    v_mfma_f32_16x16x32_bf16 v[80:83], v[164:167], v[176:179], v[80:83]
    ds_read_b128 v[152:155], v18 offset:53248
    v_mfma_f32_16x16x32_bf16 v[84:87], v[164:167], v[180:183], v[84:87]
    v_mfma_f32_16x16x32_bf16 v[88:91], v[164:167], v[184:187], v[88:91]
    ds_read_b128 v[156:159], v18 offset:55296
    v_mfma_f32_16x16x32_bf16 v[92:95], v[164:167], v[188:191], v[92:95]
    ds_read_b128 v[132:135], v16 offset:34816
    v_mfma_f32_16x16x32_bf16 v[96:99], v[168:171], v[176:179], v[96:99]
    v_mfma_f32_16x16x32_bf16 v[100:103], v[168:171], v[180:183], v[100:103]
    ds_read_b128 v[136:139], v16 offset:36864
    v_mfma_f32_16x16x32_bf16 v[104:107], v[168:171], v[184:187], v[104:107]
    ds_read_b128 v[140:143], v16 offset:38912
    v_mfma_f32_16x16x32_bf16 v[108:111], v[168:171], v[188:191], v[108:111]
    v_mfma_f32_16x16x32_bf16 v[112:115], v[172:175], v[176:179], v[112:115]
    v_mfma_f32_16x16x32_bf16 v[116:119], v[172:175], v[180:183], v[116:119]
    v_mfma_f32_16x16x32_bf16 v[120:123], v[172:175], v[184:187], v[120:123]
    v_mfma_f32_16x16x32_bf16 v[124:127], v[172:175], v[188:191], v[124:127]
    s_waitcnt lgkmcnt(0)
    v_mfma_f32_16x16x32_bf16 v[64:67], v[128:131], v[144:147], v[64:67]
    ds_read_b128 v[160:163], v17 offset:32768
    v_mfma_f32_16x16x32_bf16 v[68:71], v[128:131], v[148:151], v[68:71]
    ds_read_b128 v[176:179], v19 offset:49152
    v_mfma_f32_16x16x32_bf16 v[72:75], v[128:131], v[152:155], v[72:75]
    v_mfma_f32_16x16x32_bf16 v[76:79], v[128:131], v[156:159], v[76:79]
    ds_read_b128 v[180:183], v19 offset:51200
    v_mfma_f32_16x16x32_bf16 v[80:83], v[132:135], v[144:147], v[80:83]
    ds_read_b128 v[184:187], v19 offset:53248
    v_mfma_f32_16x16x32_bf16 v[84:87], v[132:135], v[148:151], v[84:87]
    v_mfma_f32_16x16x32_bf16 v[88:91], v[132:135], v[152:155], v[88:91]
    ds_read_b128 v[188:191], v19 offset:55296
    v_mfma_f32_16x16x32_bf16 v[92:95], v[132:135], v[156:159], v[92:95]
    ds_read_b128 v[164:167], v17 offset:34816
    v_mfma_f32_16x16x32_bf16 v[96:99], v[136:139], v[144:147], v[96:99]
    v_mfma_f32_16x16x32_bf16 v[100:103], v[136:139], v[148:151], v[100:103]
    ds_read_b128 v[168:171], v17 offset:36864
    v_mfma_f32_16x16x32_bf16 v[104:107], v[136:139], v[152:155], v[104:107]
    ds_read_b128 v[172:175], v17 offset:38912
    v_mfma_f32_16x16x32_bf16 v[108:111], v[136:139], v[156:159], v[108:111]
    v_mfma_f32_16x16x32_bf16 v[112:115], v[140:143], v[144:147], v[112:115]
    v_mfma_f32_16x16x32_bf16 v[116:119], v[140:143], v[148:151], v[116:119]
    v_mfma_f32_16x16x32_bf16 v[120:123], v[140:143], v[152:155], v[120:123]
    v_mfma_f32_16x16x32_bf16 v[124:127], v[140:143], v[156:159], v[124:127]
    s_waitcnt lgkmcnt(0)
    s_barrier
    v_mfma_f32_16x16x32_bf16 v[64:67], v[160:163], v[176:179], v[64:67]
    ds_read_b128 v[128:131], v20 offset:0
    v_mfma_f32_16x16x32_bf16 v[68:71], v[160:163], v[180:183], v[68:71]
    ds_read_b128 v[144:147], v22 offset:16384
    v_mfma_f32_16x16x32_bf16 v[72:75], v[160:163], v[184:187], v[72:75]
    v_mfma_f32_16x16x32_bf16 v[76:79], v[160:163], v[188:191], v[76:79]
    ds_read_b128 v[148:151], v22 offset:18432
    v_mfma_f32_16x16x32_bf16 v[80:83], v[164:167], v[176:179], v[80:83]
    ds_read_b128 v[152:155], v22 offset:20480
    v_mfma_f32_16x16x32_bf16 v[84:87], v[164:167], v[180:183], v[84:87]
    v_mfma_f32_16x16x32_bf16 v[88:91], v[164:167], v[184:187], v[88:91]
    ds_read_b128 v[156:159], v22 offset:22528
    v_mfma_f32_16x16x32_bf16 v[92:95], v[164:167], v[188:191], v[92:95]
    ds_read_b128 v[132:135], v20 offset:2048
    v_mfma_f32_16x16x32_bf16 v[96:99], v[168:171], v[176:179], v[96:99]
    v_mfma_f32_16x16x32_bf16 v[100:103], v[168:171], v[180:183], v[100:103]
    ds_read_b128 v[136:139], v20 offset:4096
    v_mfma_f32_16x16x32_bf16 v[104:107], v[168:171], v[184:187], v[104:107]
    ds_read_b128 v[140:143], v20 offset:6144
    v_mfma_f32_16x16x32_bf16 v[108:111], v[168:171], v[188:191], v[108:111]
    v_mfma_f32_16x16x32_bf16 v[112:115], v[172:175], v[176:179], v[112:115]
    v_mfma_f32_16x16x32_bf16 v[116:119], v[172:175], v[180:183], v[116:119]
    v_mfma_f32_16x16x32_bf16 v[120:123], v[172:175], v[184:187], v[120:123]
    v_mfma_f32_16x16x32_bf16 v[124:127], v[172:175], v[188:191], v[124:127]
    s_waitcnt lgkmcnt(0)
    v_mfma_f32_16x16x32_bf16 v[64:67], v[128:131], v[144:147], v[64:67]
    ds_read_b128 v[160:163], v21 offset:0
    v_mfma_f32_16x16x32_bf16 v[68:71], v[128:131], v[148:151], v[68:71]
    ds_read_b128 v[176:179], v23 offset:16384
    v_mfma_f32_16x16x32_bf16 v[72:75], v[128:131], v[152:155], v[72:75]
    v_mfma_f32_16x16x32_bf16 v[76:79], v[128:131], v[156:159], v[76:79]
    ds_read_b128 v[180:183], v23 offset:18432
    v_mfma_f32_16x16x32_bf16 v[80:83], v[132:135], v[144:147], v[80:83]
    ds_read_b128 v[184:187], v23 offset:20480
    v_mfma_f32_16x16x32_bf16 v[84:87], v[132:135], v[148:151], v[84:87]
    v_mfma_f32_16x16x32_bf16 v[88:91], v[132:135], v[152:155], v[88:91]
    ds_read_b128 v[188:191], v23 offset:22528
    v_mfma_f32_16x16x32_bf16 v[92:95], v[132:135], v[156:159], v[92:95]
    ds_read_b128 v[164:167], v21 offset:2048
    v_mfma_f32_16x16x32_bf16 v[96:99], v[136:139], v[144:147], v[96:99]
    v_mfma_f32_16x16x32_bf16 v[100:103], v[136:139], v[148:151], v[100:103]
    ds_read_b128 v[168:171], v21 offset:4096
    v_mfma_f32_16x16x32_bf16 v[104:107], v[136:139], v[152:155], v[104:107]
    ds_read_b128 v[172:175], v21 offset:6144
    v_mfma_f32_16x16x32_bf16 v[108:111], v[136:139], v[156:159], v[108:111]
    v_mfma_f32_16x16x32_bf16 v[112:115], v[140:143], v[144:147], v[112:115]
    v_mfma_f32_16x16x32_bf16 v[116:119], v[140:143], v[148:151], v[116:119]
    v_mfma_f32_16x16x32_bf16 v[120:123], v[140:143], v[152:155], v[120:123]
    v_mfma_f32_16x16x32_bf16 v[124:127], v[140:143], v[156:159], v[124:127]
    s_waitcnt lgkmcnt(0)
    s_barrier
    v_mfma_f32_16x16x32_bf16 v[64:67], v[160:163], v[176:179], v[64:67]
    ds_read_b128 v[128:131], v16 offset:0
    v_mfma_f32_16x16x32_bf16 v[68:71], v[160:163], v[180:183], v[68:71]
    ds_read_b128 v[144:147], v18 offset:16384
    v_mfma_f32_16x16x32_bf16 v[72:75], v[160:163], v[184:187], v[72:75]
    v_mfma_f32_16x16x32_bf16 v[76:79], v[160:163], v[188:191], v[76:79]
    ds_read_b128 v[148:151], v18 offset:18432
    v_mfma_f32_16x16x32_bf16 v[80:83], v[164:167], v[176:179], v[80:83]
    ds_read_b128 v[152:155], v18 offset:20480
    v_mfma_f32_16x16x32_bf16 v[84:87], v[164:167], v[180:183], v[84:87]
    v_mfma_f32_16x16x32_bf16 v[88:91], v[164:167], v[184:187], v[88:91]
    ds_read_b128 v[156:159], v18 offset:22528
    v_mfma_f32_16x16x32_bf16 v[92:95], v[164:167], v[188:191], v[92:95]
    ds_read_b128 v[132:135], v16 offset:2048
    v_mfma_f32_16x16x32_bf16 v[96:99], v[168:171], v[176:179], v[96:99]
    v_mfma_f32_16x16x32_bf16 v[100:103], v[168:171], v[180:183], v[100:103]
    ds_read_b128 v[136:139], v16 offset:4096
    v_mfma_f32_16x16x32_bf16 v[104:107], v[168:171], v[184:187], v[104:107]
    ds_read_b128 v[140:143], v16 offset:6144
    v_mfma_f32_16x16x32_bf16 v[108:111], v[168:171], v[188:191], v[108:111]
    v_mfma_f32_16x16x32_bf16 v[112:115], v[172:175], v[176:179], v[112:115]
    v_mfma_f32_16x16x32_bf16 v[116:119], v[172:175], v[180:183], v[116:119]
    v_mfma_f32_16x16x32_bf16 v[120:123], v[172:175], v[184:187], v[120:123]
    v_mfma_f32_16x16x32_bf16 v[124:127], v[172:175], v[188:191], v[124:127]
    s_waitcnt lgkmcnt(0)
    v_mfma_f32_16x16x32_bf16 v[64:67], v[128:131], v[144:147], v[64:67]
    ds_read_b128 v[160:163], v17 offset:0
    v_mfma_f32_16x16x32_bf16 v[68:71], v[128:131], v[148:151], v[68:71]
    ds_read_b128 v[176:179], v19 offset:16384
    v_mfma_f32_16x16x32_bf16 v[72:75], v[128:131], v[152:155], v[72:75]
    v_mfma_f32_16x16x32_bf16 v[76:79], v[128:131], v[156:159], v[76:79]
    ds_read_b128 v[180:183], v19 offset:18432
    v_mfma_f32_16x16x32_bf16 v[80:83], v[132:135], v[144:147], v[80:83]
    ds_read_b128 v[184:187], v19 offset:20480
    v_mfma_f32_16x16x32_bf16 v[84:87], v[132:135], v[148:151], v[84:87]
    v_mfma_f32_16x16x32_bf16 v[88:91], v[132:135], v[152:155], v[88:91]
    ds_read_b128 v[188:191], v19 offset:22528
    v_mfma_f32_16x16x32_bf16 v[92:95], v[132:135], v[156:159], v[92:95]
    ds_read_b128 v[164:167], v17 offset:2048
    v_mfma_f32_16x16x32_bf16 v[96:99], v[136:139], v[144:147], v[96:99]
    v_mfma_f32_16x16x32_bf16 v[100:103], v[136:139], v[148:151], v[100:103]
    ds_read_b128 v[168:171], v17 offset:4096
    v_mfma_f32_16x16x32_bf16 v[104:107], v[136:139], v[152:155], v[104:107]
    ds_read_b128 v[172:175], v17 offset:6144
    v_mfma_f32_16x16x32_bf16 v[108:111], v[136:139], v[156:159], v[108:111]
    v_mfma_f32_16x16x32_bf16 v[112:115], v[140:143], v[144:147], v[112:115]
    v_mfma_f32_16x16x32_bf16 v[116:119], v[140:143], v[148:151], v[116:119]
    v_mfma_f32_16x16x32_bf16 v[120:123], v[140:143], v[152:155], v[120:123]
    v_mfma_f32_16x16x32_bf16 v[124:127], v[140:143], v[156:159], v[124:127]
    s_waitcnt lgkmcnt(0)
    s_barrier
    v_mfma_f32_16x16x32_bf16 v[64:67], v[160:163], v[176:179], v[64:67]
    ds_read_b128 v[128:131], v16 offset:32768
    v_mfma_f32_16x16x32_bf16 v[68:71], v[160:163], v[180:183], v[68:71]
    ds_read_b128 v[144:147], v18 offset:49152
    v_mfma_f32_16x16x32_bf16 v[72:75], v[160:163], v[184:187], v[72:75]
    v_mfma_f32_16x16x32_bf16 v[76:79], v[160:163], v[188:191], v[76:79]
    ds_read_b128 v[148:151], v18 offset:51200
    v_mfma_f32_16x16x32_bf16 v[80:83], v[164:167], v[176:179], v[80:83]
    ds_read_b128 v[152:155], v18 offset:53248
    v_mfma_f32_16x16x32_bf16 v[84:87], v[164:167], v[180:183], v[84:87]
    v_mfma_f32_16x16x32_bf16 v[88:91], v[164:167], v[184:187], v[88:91]
    ds_read_b128 v[156:159], v18 offset:55296
    v_mfma_f32_16x16x32_bf16 v[92:95], v[164:167], v[188:191], v[92:95]
    ds_read_b128 v[132:135], v16 offset:34816
    v_mfma_f32_16x16x32_bf16 v[96:99], v[168:171], v[176:179], v[96:99]
    v_mfma_f32_16x16x32_bf16 v[100:103], v[168:171], v[180:183], v[100:103]
    ds_read_b128 v[136:139], v16 offset:36864
    v_mfma_f32_16x16x32_bf16 v[104:107], v[168:171], v[184:187], v[104:107]
    ds_read_b128 v[140:143], v16 offset:38912
    v_mfma_f32_16x16x32_bf16 v[108:111], v[168:171], v[188:191], v[108:111]
    v_mfma_f32_16x16x32_bf16 v[112:115], v[172:175], v[176:179], v[112:115]
    v_mfma_f32_16x16x32_bf16 v[116:119], v[172:175], v[180:183], v[116:119]
    v_mfma_f32_16x16x32_bf16 v[120:123], v[172:175], v[184:187], v[120:123]
    v_mfma_f32_16x16x32_bf16 v[124:127], v[172:175], v[188:191], v[124:127]
    s_waitcnt lgkmcnt(0)
    v_mfma_f32_16x16x32_bf16 v[64:67], v[128:131], v[144:147], v[64:67]
    ds_read_b128 v[160:163], v17 offset:32768
    v_mfma_f32_16x16x32_bf16 v[68:71], v[128:131], v[148:151], v[68:71]
    ds_read_b128 v[176:179], v19 offset:49152
    v_mfma_f32_16x16x32_bf16 v[72:75], v[128:131], v[152:155], v[72:75]
    v_mfma_f32_16x16x32_bf16 v[76:79], v[128:131], v[156:159], v[76:79]
    ds_read_b128 v[180:183], v19 offset:51200
    v_mfma_f32_16x16x32_bf16 v[80:83], v[132:135], v[144:147], v[80:83]
    ds_read_b128 v[184:187], v19 offset:53248
    v_mfma_f32_16x16x32_bf16 v[84:87], v[132:135], v[148:151], v[84:87]
    v_mfma_f32_16x16x32_bf16 v[88:91], v[132:135], v[152:155], v[88:91]
    ds_read_b128 v[188:191], v19 offset:55296
    v_mfma_f32_16x16x32_bf16 v[92:95], v[132:135], v[156:159], v[92:95]
    ds_read_b128 v[164:167], v17 offset:34816
    v_mfma_f32_16x16x32_bf16 v[96:99], v[136:139], v[144:147], v[96:99]
    v_mfma_f32_16x16x32_bf16 v[100:103], v[136:139], v[148:151], v[100:103]
    ds_read_b128 v[168:171], v17 offset:36864
    v_mfma_f32_16x16x32_bf16 v[104:107], v[136:139], v[152:155], v[104:107]
    ds_read_b128 v[172:175], v17 offset:38912
    v_mfma_f32_16x16x32_bf16 v[108:111], v[136:139], v[156:159], v[108:111]
    v_mfma_f32_16x16x32_bf16 v[112:115], v[140:143], v[144:147], v[112:115]
    v_mfma_f32_16x16x32_bf16 v[116:119], v[140:143], v[148:151], v[116:119]
    v_mfma_f32_16x16x32_bf16 v[120:123], v[140:143], v[152:155], v[120:123]
    v_mfma_f32_16x16x32_bf16 v[124:127], v[140:143], v[156:159], v[124:127]
    s_waitcnt lgkmcnt(0)
    s_barrier
    v_mfma_f32_16x16x32_bf16 v[64:67], v[160:163], v[176:179], v[64:67]
    ds_read_b128 v[128:131], v20 offset:0
    v_mfma_f32_16x16x32_bf16 v[68:71], v[160:163], v[180:183], v[68:71]
    ds_read_b128 v[144:147], v22 offset:16384
    v_mfma_f32_16x16x32_bf16 v[72:75], v[160:163], v[184:187], v[72:75]
    v_mfma_f32_16x16x32_bf16 v[76:79], v[160:163], v[188:191], v[76:79]
    ds_read_b128 v[148:151], v22 offset:18432
    v_mfma_f32_16x16x32_bf16 v[80:83], v[164:167], v[176:179], v[80:83]
    ds_read_b128 v[152:155], v22 offset:20480
    v_mfma_f32_16x16x32_bf16 v[84:87], v[164:167], v[180:183], v[84:87]
    v_mfma_f32_16x16x32_bf16 v[88:91], v[164:167], v[184:187], v[88:91]
    ds_read_b128 v[156:159], v22 offset:22528
    v_mfma_f32_16x16x32_bf16 v[92:95], v[164:167], v[188:191], v[92:95]
    ds_read_b128 v[132:135], v20 offset:2048
    v_mfma_f32_16x16x32_bf16 v[96:99], v[168:171], v[176:179], v[96:99]
    v_mfma_f32_16x16x32_bf16 v[100:103], v[168:171], v[180:183], v[100:103]
    ds_read_b128 v[136:139], v20 offset:4096
    v_mfma_f32_16x16x32_bf16 v[104:107], v[168:171], v[184:187], v[104:107]
    ds_read_b128 v[140:143], v20 offset:6144
    v_mfma_f32_16x16x32_bf16 v[108:111], v[168:171], v[188:191], v[108:111]
    v_mfma_f32_16x16x32_bf16 v[112:115], v[172:175], v[176:179], v[112:115]
    v_mfma_f32_16x16x32_bf16 v[116:119], v[172:175], v[180:183], v[116:119]
    v_mfma_f32_16x16x32_bf16 v[120:123], v[172:175], v[184:187], v[120:123]
    v_mfma_f32_16x16x32_bf16 v[124:127], v[172:175], v[188:191], v[124:127]
    s_waitcnt lgkmcnt(0)
    v_mfma_f32_16x16x32_bf16 v[64:67], v[128:131], v[144:147], v[64:67]
    ds_read_b128 v[160:163], v21 offset:0
    v_mfma_f32_16x16x32_bf16 v[68:71], v[128:131], v[148:151], v[68:71]
    ds_read_b128 v[176:179], v23 offset:16384
    v_mfma_f32_16x16x32_bf16 v[72:75], v[128:131], v[152:155], v[72:75]
    v_mfma_f32_16x16x32_bf16 v[76:79], v[128:131], v[156:159], v[76:79]
    ds_read_b128 v[180:183], v23 offset:18432
    v_mfma_f32_16x16x32_bf16 v[80:83], v[132:135], v[144:147], v[80:83]
    ds_read_b128 v[184:187], v23 offset:20480
    v_mfma_f32_16x16x32_bf16 v[84:87], v[132:135], v[148:151], v[84:87]
    v_mfma_f32_16x16x32_bf16 v[88:91], v[132:135], v[152:155], v[88:91]
    ds_read_b128 v[188:191], v23 offset:22528
    v_mfma_f32_16x16x32_bf16 v[92:95], v[132:135], v[156:159], v[92:95]
    ds_read_b128 v[164:167], v21 offset:2048
    v_mfma_f32_16x16x32_bf16 v[96:99], v[136:139], v[144:147], v[96:99]
    v_mfma_f32_16x16x32_bf16 v[100:103], v[136:139], v[148:151], v[100:103]
    ds_read_b128 v[168:171], v21 offset:4096
    v_mfma_f32_16x16x32_bf16 v[104:107], v[136:139], v[152:155], v[104:107]
    ds_read_b128 v[172:175], v21 offset:6144
    v_mfma_f32_16x16x32_bf16 v[108:111], v[136:139], v[156:159], v[108:111]
    v_mfma_f32_16x16x32_bf16 v[112:115], v[140:143], v[144:147], v[112:115]
    v_mfma_f32_16x16x32_bf16 v[116:119], v[140:143], v[148:151], v[116:119]
    v_mfma_f32_16x16x32_bf16 v[120:123], v[140:143], v[152:155], v[120:123]
    v_mfma_f32_16x16x32_bf16 v[124:127], v[140:143], v[156:159], v[124:127]
    s_waitcnt lgkmcnt(0)
    s_barrier
    v_mfma_f32_16x16x32_bf16 v[64:67], v[160:163], v[176:179], v[64:67]
    ds_read_b128 v[128:131], v16 offset:0
    v_mfma_f32_16x16x32_bf16 v[68:71], v[160:163], v[180:183], v[68:71]
    ds_read_b128 v[144:147], v18 offset:16384
    v_mfma_f32_16x16x32_bf16 v[72:75], v[160:163], v[184:187], v[72:75]
    v_mfma_f32_16x16x32_bf16 v[76:79], v[160:163], v[188:191], v[76:79]
    ds_read_b128 v[148:151], v18 offset:18432
    v_mfma_f32_16x16x32_bf16 v[80:83], v[164:167], v[176:179], v[80:83]
    ds_read_b128 v[152:155], v18 offset:20480
    v_mfma_f32_16x16x32_bf16 v[84:87], v[164:167], v[180:183], v[84:87]
    v_mfma_f32_16x16x32_bf16 v[88:91], v[164:167], v[184:187], v[88:91]
    ds_read_b128 v[156:159], v18 offset:22528
    v_mfma_f32_16x16x32_bf16 v[92:95], v[164:167], v[188:191], v[92:95]
    ds_read_b128 v[132:135], v16 offset:2048
    v_mfma_f32_16x16x32_bf16 v[96:99], v[168:171], v[176:179], v[96:99]
    v_mfma_f32_16x16x32_bf16 v[100:103], v[168:171], v[180:183], v[100:103]
    ds_read_b128 v[136:139], v16 offset:4096
    v_mfma_f32_16x16x32_bf16 v[104:107], v[168:171], v[184:187], v[104:107]
    ds_read_b128 v[140:143], v16 offset:6144
    v_mfma_f32_16x16x32_bf16 v[108:111], v[168:171], v[188:191], v[108:111]
    v_mfma_f32_16x16x32_bf16 v[112:115], v[172:175], v[176:179], v[112:115]
    v_mfma_f32_16x16x32_bf16 v[116:119], v[172:175], v[180:183], v[116:119]
    v_mfma_f32_16x16x32_bf16 v[120:123], v[172:175], v[184:187], v[120:123]
    v_mfma_f32_16x16x32_bf16 v[124:127], v[172:175], v[188:191], v[124:127]
    s_waitcnt lgkmcnt(0)
    v_mfma_f32_16x16x32_bf16 v[64:67], v[128:131], v[144:147], v[64:67]
    ds_read_b128 v[160:163], v17 offset:0
    v_mfma_f32_16x16x32_bf16 v[68:71], v[128:131], v[148:151], v[68:71]
    ds_read_b128 v[176:179], v19 offset:16384
    v_mfma_f32_16x16x32_bf16 v[72:75], v[128:131], v[152:155], v[72:75]
    v_mfma_f32_16x16x32_bf16 v[76:79], v[128:131], v[156:159], v[76:79]
    ds_read_b128 v[180:183], v19 offset:18432
    v_mfma_f32_16x16x32_bf16 v[80:83], v[132:135], v[144:147], v[80:83]
    ds_read_b128 v[184:187], v19 offset:20480
    v_mfma_f32_16x16x32_bf16 v[84:87], v[132:135], v[148:151], v[84:87]
    v_mfma_f32_16x16x32_bf16 v[88:91], v[132:135], v[152:155], v[88:91]
    ds_read_b128 v[188:191], v19 offset:22528
    v_mfma_f32_16x16x32_bf16 v[92:95], v[132:135], v[156:159], v[92:95]
    ds_read_b128 v[164:167], v17 offset:2048
    v_mfma_f32_16x16x32_bf16 v[96:99], v[136:139], v[144:147], v[96:99]
    v_mfma_f32_16x16x32_bf16 v[100:103], v[136:139], v[148:151], v[100:103]
    ds_read_b128 v[168:171], v17 offset:4096
    v_mfma_f32_16x16x32_bf16 v[104:107], v[136:139], v[152:155], v[104:107]
    ds_read_b128 v[172:175], v17 offset:6144
    v_mfma_f32_16x16x32_bf16 v[108:111], v[136:139], v[156:159], v[108:111]
    v_mfma_f32_16x16x32_bf16 v[112:115], v[140:143], v[144:147], v[112:115]
    v_mfma_f32_16x16x32_bf16 v[116:119], v[140:143], v[148:151], v[116:119]
    v_mfma_f32_16x16x32_bf16 v[120:123], v[140:143], v[152:155], v[120:123]
    v_mfma_f32_16x16x32_bf16 v[124:127], v[140:143], v[156:159], v[124:127]
    s_waitcnt lgkmcnt(0) vmcnt(0)
    v_mfma_f32_16x16x32_bf16 v[64:67], v[160:163], v[176:179], v[64:67]
    v_mfma_f32_16x16x32_bf16 v[68:71], v[160:163], v[180:183], v[68:71]
    v_mfma_f32_16x16x32_bf16 v[72:75], v[160:163], v[184:187], v[72:75]
    v_mfma_f32_16x16x32_bf16 v[76:79], v[160:163], v[188:191], v[76:79]
    v_mfma_f32_16x16x32_bf16 v[80:83], v[164:167], v[176:179], v[80:83]
    v_mfma_f32_16x16x32_bf16 v[84:87], v[164:167], v[180:183], v[84:87]
    v_mfma_f32_16x16x32_bf16 v[88:91], v[164:167], v[184:187], v[88:91]
    v_mfma_f32_16x16x32_bf16 v[92:95], v[164:167], v[188:191], v[92:95]
    v_mfma_f32_16x16x32_bf16 v[96:99], v[168:171], v[176:179], v[96:99]
    v_mfma_f32_16x16x32_bf16 v[100:103], v[168:171], v[180:183], v[100:103]
    v_mfma_f32_16x16x32_bf16 v[104:107], v[168:171], v[184:187], v[104:107]
    v_mfma_f32_16x16x32_bf16 v[108:111], v[168:171], v[188:191], v[108:111]
    v_mfma_f32_16x16x32_bf16 v[112:115], v[172:175], v[176:179], v[112:115]
    v_mfma_f32_16x16x32_bf16 v[116:119], v[172:175], v[180:183], v[116:119]
    v_mfma_f32_16x16x32_bf16 v[120:123], v[172:175], v[184:187], v[120:123]
    v_mfma_f32_16x16x32_bf16 v[124:127], v[172:175], v[188:191], v[124:127]
    s_mov_b32 s44, 0
    s_mov_b32 s45, 4096
    s_mov_b32 s46, 8192
    s_mov_b32 s47, 12288
    v_mov_b32 v61, s93
    v_mov_b32 v63, s93
    v_and_b32 v216, 31, v24
    v_lshlrev_b32 v216, 2, v216
    v_add_u32 v216, 73728, v216
    v_mov_b32 v218, 0
    ds_write_b32 v216, v218
    v_pk_fma_f32 v[16:17], v[30:31], v[72:73], v[66:67] op_sel:[0,0,0] op_sel_hi:[0,1,1] neg_lo:[1,0,0] neg_hi:[1,0,0]
    v_pk_fma_f32 v[18:19], v[30:31], v[64:65], v[74:75] op_sel:[0,0,0] op_sel_hi:[0,1,1]
    v_pk_fma_f32 v[8:9], v[28:29], v[64:65], v[16:17] op_sel:[0,0,0] op_sel_hi:[0,1,1]
    v_pk_fma_f32 v[10:11], v[28:29], v[72:73], v[18:19] op_sel:[0,0,0] op_sel_hi:[0,1,1]
    v_pk_fma_f32 v[20:21], v[30:31], v[76:77], v[70:71] op_sel:[1,0,0] op_sel_hi:[1,1,1] neg_lo:[1,0,0] neg_hi:[1,0,0]
    v_pk_fma_f32 v[22:23], v[30:31], v[68:69], v[78:79] op_sel:[1,0,0] op_sel_hi:[1,1,1]
    v_pk_fma_f32 v[12:13], v[28:29], v[68:69], v[20:21] op_sel:[1,0,0] op_sel_hi:[1,1,1]
    v_pk_fma_f32 v[14:15], v[28:29], v[76:77], v[22:23] op_sel:[1,0,0] op_sel_hi:[1,1,1]
    v_pk_fma_f32 v[16:17], v[30:31], v[10:11], v[80:81] op_sel:[0,0,0] op_sel_hi:[0,1,1] neg_lo:[1,0,0] neg_hi:[1,0,0]
    v_pk_fma_f32 v[18:19], v[30:31], v[8:9], v[88:89] op_sel:[0,0,0] op_sel_hi:[0,1,1]
    v_pk_fma_f32 v[8:9], v[28:29], v[8:9], v[16:17] op_sel:[0,0,0] op_sel_hi:[0,1,1]
    v_pk_fma_f32 v[10:11], v[28:29], v[10:11], v[18:19] op_sel:[0,0,0] op_sel_hi:[0,1,1]
    v_pk_fma_f32 v[20:21], v[30:31], v[14:15], v[84:85] op_sel:[1,0,0] op_sel_hi:[1,1,1] neg_lo:[1,0,0] neg_hi:[1,0,0]
    v_pk_fma_f32 v[22:23], v[30:31], v[12:13], v[92:93] op_sel:[1,0,0] op_sel_hi:[1,1,1]
    v_pk_fma_f32 v[12:13], v[28:29], v[12:13], v[20:21] op_sel:[1,0,0] op_sel_hi:[1,1,1]
    v_pk_fma_f32 v[14:15], v[28:29], v[14:15], v[22:23] op_sel:[1,0,0] op_sel_hi:[1,1,1]
    v_pk_fma_f32 v[16:17], v[30:31], v[10:11], v[82:83] op_sel:[0,0,0] op_sel_hi:[0,1,1] neg_lo:[1,0,0] neg_hi:[1,0,0]
    v_pk_fma_f32 v[18:19], v[30:31], v[8:9], v[90:91] op_sel:[0,0,0] op_sel_hi:[0,1,1]
    v_pk_fma_f32 v[8:9], v[28:29], v[8:9], v[16:17] op_sel:[0,0,0] op_sel_hi:[0,1,1]
    v_pk_fma_f32 v[10:11], v[28:29], v[10:11], v[18:19] op_sel:[0,0,0] op_sel_hi:[0,1,1]
    v_pk_fma_f32 v[20:21], v[30:31], v[14:15], v[86:87] op_sel:[1,0,0] op_sel_hi:[1,1,1] neg_lo:[1,0,0] neg_hi:[1,0,0]
    v_pk_fma_f32 v[22:23], v[30:31], v[12:13], v[94:95] op_sel:[1,0,0] op_sel_hi:[1,1,1]
    v_pk_fma_f32 v[12:13], v[28:29], v[12:13], v[20:21] op_sel:[1,0,0] op_sel_hi:[1,1,1]
    v_pk_fma_f32 v[14:15], v[28:29], v[14:15], v[22:23] op_sel:[1,0,0] op_sel_hi:[1,1,1]
    v_pk_fma_f32 v[16:17], v[30:31], v[10:11], v[96:97] op_sel:[0,0,0] op_sel_hi:[0,1,1] neg_lo:[1,0,0] neg_hi:[1,0,0]
    v_pk_fma_f32 v[18:19], v[30:31], v[8:9], v[104:105] op_sel:[0,0,0] op_sel_hi:[0,1,1]
    v_pk_fma_f32 v[8:9], v[28:29], v[8:9], v[16:17] op_sel:[0,0,0] op_sel_hi:[0,1,1]
    v_pk_fma_f32 v[10:11], v[28:29], v[10:11], v[18:19] op_sel:[0,0,0] op_sel_hi:[0,1,1]
    v_pk_fma_f32 v[20:21], v[30:31], v[14:15], v[100:101] op_sel:[1,0,0] op_sel_hi:[1,1,1] neg_lo:[1,0,0] neg_hi:[1,0,0]
    v_pk_fma_f32 v[22:23], v[30:31], v[12:13], v[108:109] op_sel:[1,0,0] op_sel_hi:[1,1,1]
    v_pk_fma_f32 v[12:13], v[28:29], v[12:13], v[20:21] op_sel:[1,0,0] op_sel_hi:[1,1,1]
    v_pk_fma_f32 v[14:15], v[28:29], v[14:15], v[22:23] op_sel:[1,0,0] op_sel_hi:[1,1,1]
    v_pk_fma_f32 v[16:17], v[30:31], v[10:11], v[98:99] op_sel:[0,0,0] op_sel_hi:[0,1,1] neg_lo:[1,0,0] neg_hi:[1,0,0]
    v_pk_fma_f32 v[18:19], v[30:31], v[8:9], v[106:107] op_sel:[0,0,0] op_sel_hi:[0,1,1]
    v_pk_fma_f32 v[8:9], v[28:29], v[8:9], v[16:17] op_sel:[0,0,0] op_sel_hi:[0,1,1]
    v_pk_fma_f32 v[10:11], v[28:29], v[10:11], v[18:19] op_sel:[0,0,0] op_sel_hi:[0,1,1]
    v_pk_fma_f32 v[20:21], v[30:31], v[14:15], v[102:103] op_sel:[1,0,0] op_sel_hi:[1,1,1] neg_lo:[1,0,0] neg_hi:[1,0,0]
    v_pk_fma_f32 v[22:23], v[30:31], v[12:13], v[110:111] op_sel:[1,0,0] op_sel_hi:[1,1,1]
    v_pk_fma_f32 v[12:13], v[28:29], v[12:13], v[20:21] op_sel:[1,0,0] op_sel_hi:[1,1,1]
    v_pk_fma_f32 v[14:15], v[28:29], v[14:15], v[22:23] op_sel:[1,0,0] op_sel_hi:[1,1,1]
    v_pk_fma_f32 v[16:17], v[30:31], v[10:11], v[112:113] op_sel:[0,0,0] op_sel_hi:[0,1,1] neg_lo:[1,0,0] neg_hi:[1,0,0]
    v_pk_fma_f32 v[18:19], v[30:31], v[8:9], v[120:121] op_sel:[0,0,0] op_sel_hi:[0,1,1]
    v_pk_fma_f32 v[8:9], v[28:29], v[8:9], v[16:17] op_sel:[0,0,0] op_sel_hi:[0,1,1]
    v_pk_fma_f32 v[10:11], v[28:29], v[10:11], v[18:19] op_sel:[0,0,0] op_sel_hi:[0,1,1]
    v_pk_fma_f32 v[20:21], v[30:31], v[14:15], v[116:117] op_sel:[1,0,0] op_sel_hi:[1,1,1] neg_lo:[1,0,0] neg_hi:[1,0,0]
    v_pk_fma_f32 v[22:23], v[30:31], v[12:13], v[124:125] op_sel:[1,0,0] op_sel_hi:[1,1,1]
    v_pk_fma_f32 v[12:13], v[28:29], v[12:13], v[20:21] op_sel:[1,0,0] op_sel_hi:[1,1,1]
    v_pk_fma_f32 v[14:15], v[28:29], v[14:15], v[22:23] op_sel:[1,0,0] op_sel_hi:[1,1,1]
    v_pk_fma_f32 v[16:17], v[30:31], v[10:11], v[114:115] op_sel:[0,0,0] op_sel_hi:[0,1,1] neg_lo:[1,0,0] neg_hi:[1,0,0]
    v_pk_fma_f32 v[18:19], v[30:31], v[8:9], v[122:123] op_sel:[0,0,0] op_sel_hi:[0,1,1]
    v_pk_fma_f32 v[8:9], v[28:29], v[8:9], v[16:17] op_sel:[0,0,0] op_sel_hi:[0,1,1]
    v_pk_fma_f32 v[10:11], v[28:29], v[10:11], v[18:19] op_sel:[0,0,0] op_sel_hi:[0,1,1]
    v_pk_fma_f32 v[20:21], v[30:31], v[14:15], v[118:119] op_sel:[1,0,0] op_sel_hi:[1,1,1] neg_lo:[1,0,0] neg_hi:[1,0,0]
    v_pk_fma_f32 v[22:23], v[30:31], v[12:13], v[126:127] op_sel:[1,0,0] op_sel_hi:[1,1,1]
    v_pk_fma_f32 v[12:13], v[28:29], v[12:13], v[20:21] op_sel:[1,0,0] op_sel_hi:[1,1,1]
    v_pk_fma_f32 v[14:15], v[28:29], v[14:15], v[22:23] op_sel:[1,0,0] op_sel_hi:[1,1,1]
    v_fma_f32 v56, -v38, v10, v9
    v_fma_f32 v58, v38, v8, v11
    v_fma_f32 v57, -v39, v14, v13
    v_fma_f32 v59, v39, v12, v15
    v_fma_f32 v56, v36, v8, v56
    v_fma_f32 v58, v36, v10, v58
    v_fma_f32 v57, v37, v12, v57
    v_fma_f32 v59, v37, v14, v59
    ds_write_b128 v192, v[56:59]
    s_waitcnt lgkmcnt(0)
    s_barrier
    ds_read_b128 v[160:163], v193 offset:0
    ds_read_b128 v[164:167], v193 offset:512
    ds_read_b128 v[168:171], v193 offset:1024
    ds_read_b128 v[172:175], v193 offset:1536
    ds_read_b128 v[176:179], v193 offset:2048
    ds_read_b128 v[180:183], v193 offset:2560
    ds_read_b128 v[184:187], v193 offset:3072
    ds_read_b128 v[188:191], v193 offset:3584
    s_waitcnt lgkmcnt(6)
    v_pk_fma_f32 v[164:165], v[42:43], v[162:163], v[164:165] op_sel:[0,0,0] op_sel_hi:[1,1,1] neg_lo:[1,0,0] neg_hi:[1,0,0]
    v_pk_fma_f32 v[166:167], v[42:43], v[160:161], v[166:167] op_sel:[0,0,0] op_sel_hi:[1,1,1]
    v_pk_fma_f32 v[164:165], v[40:41], v[160:161], v[164:165] op_sel:[0,0,0] op_sel_hi:[1,1,1]
    v_pk_fma_f32 v[166:167], v[40:41], v[162:163], v[166:167] op_sel:[0,0,0] op_sel_hi:[1,1,1]
    s_waitcnt lgkmcnt(5)
    v_pk_fma_f32 v[168:169], v[42:43], v[166:167], v[168:169] op_sel:[0,0,0] op_sel_hi:[1,1,1] neg_lo:[1,0,0] neg_hi:[1,0,0]
    v_pk_fma_f32 v[170:171], v[42:43], v[164:165], v[170:171] op_sel:[0,0,0] op_sel_hi:[1,1,1]
    v_pk_fma_f32 v[168:169], v[40:41], v[164:165], v[168:169] op_sel:[0,0,0] op_sel_hi:[1,1,1]
    v_pk_fma_f32 v[170:171], v[40:41], v[166:167], v[170:171] op_sel:[0,0,0] op_sel_hi:[1,1,1]
    s_waitcnt lgkmcnt(4)
    v_pk_fma_f32 v[172:173], v[42:43], v[170:171], v[172:173] op_sel:[0,0,0] op_sel_hi:[1,1,1] neg_lo:[1,0,0] neg_hi:[1,0,0]
    v_pk_fma_f32 v[174:175], v[42:43], v[168:169], v[174:175] op_sel:[0,0,0] op_sel_hi:[1,1,1]
    v_pk_fma_f32 v[172:173], v[40:41], v[168:169], v[172:173] op_sel:[0,0,0] op_sel_hi:[1,1,1]
    v_pk_fma_f32 v[174:175], v[40:41], v[170:171], v[174:175] op_sel:[0,0,0] op_sel_hi:[1,1,1]
    s_waitcnt lgkmcnt(3)
    v_pk_fma_f32 v[176:177], v[42:43], v[174:175], v[176:177] op_sel:[0,0,0] op_sel_hi:[1,1,1] neg_lo:[1,0,0] neg_hi:[1,0,0]
    v_pk_fma_f32 v[178:179], v[42:43], v[172:173], v[178:179] op_sel:[0,0,0] op_sel_hi:[1,1,1]
    v_pk_fma_f32 v[176:177], v[40:41], v[172:173], v[176:177] op_sel:[0,0,0] op_sel_hi:[1,1,1]
    v_pk_fma_f32 v[178:179], v[40:41], v[174:175], v[178:179] op_sel:[0,0,0] op_sel_hi:[1,1,1]
    s_waitcnt lgkmcnt(2)
    v_pk_fma_f32 v[180:181], v[42:43], v[178:179], v[180:181] op_sel:[0,0,0] op_sel_hi:[1,1,1] neg_lo:[1,0,0] neg_hi:[1,0,0]
    v_pk_fma_f32 v[182:183], v[42:43], v[176:177], v[182:183] op_sel:[0,0,0] op_sel_hi:[1,1,1]
    v_pk_fma_f32 v[180:181], v[40:41], v[176:177], v[180:181] op_sel:[0,0,0] op_sel_hi:[1,1,1]
    v_pk_fma_f32 v[182:183], v[40:41], v[178:179], v[182:183] op_sel:[0,0,0] op_sel_hi:[1,1,1]
    s_waitcnt lgkmcnt(1)
    v_pk_fma_f32 v[184:185], v[42:43], v[182:183], v[184:185] op_sel:[0,0,0] op_sel_hi:[1,1,1] neg_lo:[1,0,0] neg_hi:[1,0,0]
    v_pk_fma_f32 v[186:187], v[42:43], v[180:181], v[186:187] op_sel:[0,0,0] op_sel_hi:[1,1,1]
    v_pk_fma_f32 v[184:185], v[40:41], v[180:181], v[184:185] op_sel:[0,0,0] op_sel_hi:[1,1,1]
    v_pk_fma_f32 v[186:187], v[40:41], v[182:183], v[186:187] op_sel:[0,0,0] op_sel_hi:[1,1,1]
    s_waitcnt lgkmcnt(0)
    v_pk_fma_f32 v[188:189], v[42:43], v[186:187], v[188:189] op_sel:[0,0,0] op_sel_hi:[1,1,1] neg_lo:[1,0,0] neg_hi:[1,0,0]
    v_pk_fma_f32 v[190:191], v[42:43], v[184:185], v[190:191] op_sel:[0,0,0] op_sel_hi:[1,1,1]
    v_pk_fma_f32 v[188:189], v[40:41], v[184:185], v[188:189] op_sel:[0,0,0] op_sel_hi:[1,1,1]
    v_pk_fma_f32 v[190:191], v[40:41], v[186:187], v[190:191] op_sel:[0,0,0] op_sel_hi:[1,1,1]
    v_cndmask_b32 v60, v188, v189, s[84:85]
    v_cndmask_b32 v62, v190, v191, s[84:85]
    s_cmp_lg_u32 s19, 0
    s_cbranch_scc1 L_nopub
    s_mov_b32 exec_hi, 0
    buffer_store_dwordx4 v[60:63], v27, s[24:27], 0 offen sc1
    s_mov_b32 exec_hi, -1
L_nopub:
    v_cndmask_b32 v16, 0, v172, s[98:99]
    v_cndmask_b32 v17, v160, v176, s[98:99]
    v_cndmask_b32 v18, v164, v180, s[98:99]
    v_cndmask_b32 v19, v168, v184, s[98:99]
    v_cndmask_b32 v16, v16, v17, s[84:85]
    v_cndmask_b32 v18, v18, v19, s[84:85]
    v_cndmask_b32 v216, v16, v18, s[86:87]
    v_cndmask_b32 v16, 0, v173, s[98:99]
    v_cndmask_b32 v17, v161, v177, s[98:99]
    v_cndmask_b32 v18, v165, v181, s[98:99]
    v_cndmask_b32 v19, v169, v185, s[98:99]
    v_cndmask_b32 v16, v16, v17, s[84:85]
    v_cndmask_b32 v18, v18, v19, s[84:85]
    v_cndmask_b32 v217, v16, v18, s[86:87]
    v_cndmask_b32 v16, 0, v174, s[98:99]
    v_cndmask_b32 v17, v162, v178, s[98:99]
    v_cndmask_b32 v18, v166, v182, s[98:99]
    v_cndmask_b32 v19, v170, v186, s[98:99]
    v_cndmask_b32 v16, v16, v17, s[84:85]
    v_cndmask_b32 v18, v18, v19, s[84:85]
    v_cndmask_b32 v218, v16, v18, s[86:87]
    v_cndmask_b32 v16, 0, v175, s[98:99]
    v_cndmask_b32 v17, v163, v179, s[98:99]
    v_cndmask_b32 v18, v167, v183, s[98:99]
    v_cndmask_b32 v19, v171, v187, s[98:99]
    v_cndmask_b32 v16, v16, v17, s[84:85]
    v_cndmask_b32 v18, v18, v19, s[84:85]
    v_cndmask_b32 v219, v16, v18, s[86:87]
    v_mov_b32 v16, v216
    v_mov_b32 v18, v218
    v_fma_f32 v17, -v38, v218, v8
    v_fma_f32 v19, v38, v216, v10
    v_fma_f32 v17, v36, v216, v17
    v_fma_f32 v19, v36, v218, v19
    v_pk_mul_f32 v[56:57], v[32:33], v[16:17] op_sel:[0,0] op_sel_hi:[0,1]
    v_pk_mul_f32 v[58:59], v[32:33], v[18:19] op_sel:[0,0] op_sel_hi:[0,1]
    v_pk_fma_f32 v[56:57], v[34:35], v[18:19], v[56:57] op_sel:[0,0,0] op_sel_hi:[0,1,1] neg_lo:[1,0,0] neg_hi:[1,0,0]
    v_pk_fma_f32 v[58:59], v[34:35], v[16:17], v[58:59] op_sel:[0,0,0] op_sel_hi:[0,1,1]
    v_mov_b32 v16, v217
    v_mov_b32 v18, v219
    v_fma_f32 v17, -v39, v219, v12
    v_fma_f32 v19, v39, v217, v14
    v_fma_f32 v17, v37, v217, v17
    v_fma_f32 v19, v37, v219, v19
    v_pk_mul_f32 v[60:61], v[32:33], v[16:17] op_sel:[1,0] op_sel_hi:[1,1]
    v_pk_mul_f32 v[62:63], v[32:33], v[18:19] op_sel:[1,0] op_sel_hi:[1,1]
    v_pk_fma_f32 v[60:61], v[34:35], v[18:19], v[60:61] op_sel:[1,0,0] op_sel_hi:[1,1,1] neg_lo:[1,0,0] neg_hi:[1,0,0]
    v_pk_fma_f32 v[62:63], v[34:35], v[16:17], v[62:63] op_sel:[1,0,0] op_sel_hi:[1,1,1]
    v_pk_mul_f32 v[128:129], v[32:33], v[72:73] op_sel:[0,0] op_sel_hi:[0,1]
    v_pk_fma_f32 v[128:129], v[34:35], v[64:65], v[128:129] op_sel:[0,0,0] op_sel_hi:[0,1,1]
    v_pk_mul_f32 v[64:65], v[32:33], v[64:65] op_sel:[0,0] op_sel_hi:[0,1]
    v_pk_fma_f32 v[64:65], v[34:35], v[72:73], v[64:65] op_sel:[0,0,0] op_sel_hi:[0,1,1] neg_lo:[1,0,0] neg_hi:[1,0,0]
    v_pk_mul_f32 v[144:145], v[32:33], v[76:77] op_sel:[1,0] op_sel_hi:[1,1]
    v_pk_fma_f32 v[144:145], v[34:35], v[68:69], v[144:145] op_sel:[1,0,0] op_sel_hi:[1,1,1]
    v_pk_mul_f32 v[68:69], v[32:33], v[68:69] op_sel:[1,0] op_sel_hi:[1,1]
    v_pk_fma_f32 v[68:69], v[34:35], v[76:77], v[68:69] op_sel:[1,0,0] op_sel_hi:[1,1,1] neg_lo:[1,0,0] neg_hi:[1,0,0]
    v_pk_mul_f32 v[130:131], v[32:33], v[74:75] op_sel:[0,0] op_sel_hi:[0,1]
    v_pk_fma_f32 v[130:131], v[34:35], v[66:67], v[130:131] op_sel:[0,0,0] op_sel_hi:[0,1,1]
    v_pk_mul_f32 v[66:67], v[32:33], v[66:67] op_sel:[0,0] op_sel_hi:[0,1]
    v_pk_fma_f32 v[66:67], v[34:35], v[74:75], v[66:67] op_sel:[0,0,0] op_sel_hi:[0,1,1] neg_lo:[1,0,0] neg_hi:[1,0,0]
    buffer_load_dwordx4 v[160:163], v194, s[24:27], s44 offen offset:0 sc1
    buffer_load_dwordx4 v[164:167], v194, s[24:27], s45 offen offset:0 sc1
    buffer_load_dwordx4 v[168:171], v194, s[24:27], s46 offen offset:0 sc1
    buffer_load_dwordx4 v[172:175], v194, s[24:27], s47 offen offset:0 sc1
    buffer_load_dwordx4 v[176:179], v194, s[24:27], s44 offen offset:256 sc1
    buffer_load_dwordx4 v[180:183], v194, s[24:27], s45 offen offset:256 sc1
    buffer_load_dwordx4 v[184:187], v194, s[24:27], s46 offen offset:256 sc1
    buffer_load_dwordx4 v[188:191], v194, s[24:27], s47 offen offset:256 sc1
    v_pk_mul_f32 v[146:147], v[32:33], v[78:79] op_sel:[1,0] op_sel_hi:[1,1]
    v_pk_fma_f32 v[146:147], v[34:35], v[70:71], v[146:147] op_sel:[1,0,0] op_sel_hi:[1,1,1]
    v_pk_mul_f32 v[70:71], v[32:33], v[70:71] op_sel:[1,0] op_sel_hi:[1,1]
    v_pk_fma_f32 v[70:71], v[34:35], v[78:79], v[70:71] op_sel:[1,0,0] op_sel_hi:[1,1,1] neg_lo:[1,0,0] neg_hi:[1,0,0]
    v_pk_mul_f32 v[132:133], v[32:33], v[88:89] op_sel:[0,0] op_sel_hi:[0,1]
    v_pk_fma_f32 v[132:133], v[34:35], v[80:81], v[132:133] op_sel:[0,0,0] op_sel_hi:[0,1,1]
    v_pk_mul_f32 v[80:81], v[32:33], v[80:81] op_sel:[0,0] op_sel_hi:[0,1]
    v_pk_fma_f32 v[80:81], v[34:35], v[88:89], v[80:81] op_sel:[0,0,0] op_sel_hi:[0,1,1] neg_lo:[1,0,0] neg_hi:[1,0,0]
    v_pk_mul_f32 v[148:149], v[32:33], v[92:93] op_sel:[1,0] op_sel_hi:[1,1]
    v_pk_fma_f32 v[148:149], v[34:35], v[84:85], v[148:149] op_sel:[1,0,0] op_sel_hi:[1,1,1]
    v_pk_mul_f32 v[84:85], v[32:33], v[84:85] op_sel:[1,0] op_sel_hi:[1,1]
    v_pk_fma_f32 v[84:85], v[34:35], v[92:93], v[84:85] op_sel:[1,0,0] op_sel_hi:[1,1,1] neg_lo:[1,0,0] neg_hi:[1,0,0]
    v_pk_mul_f32 v[134:135], v[32:33], v[90:91] op_sel:[0,0] op_sel_hi:[0,1]
    v_pk_fma_f32 v[134:135], v[34:35], v[82:83], v[134:135] op_sel:[0,0,0] op_sel_hi:[0,1,1]
    v_pk_mul_f32 v[82:83], v[32:33], v[82:83] op_sel:[0,0] op_sel_hi:[0,1]
    v_pk_fma_f32 v[82:83], v[34:35], v[90:91], v[82:83] op_sel:[0,0,0] op_sel_hi:[0,1,1] neg_lo:[1,0,0] neg_hi:[1,0,0]
    v_pk_mul_f32 v[150:151], v[32:33], v[94:95] op_sel:[1,0] op_sel_hi:[1,1]
    v_pk_fma_f32 v[150:151], v[34:35], v[86:87], v[150:151] op_sel:[1,0,0] op_sel_hi:[1,1,1]
    v_pk_mul_f32 v[86:87], v[32:33], v[86:87] op_sel:[1,0] op_sel_hi:[1,1]
    v_pk_fma_f32 v[86:87], v[34:35], v[94:95], v[86:87] op_sel:[1,0,0] op_sel_hi:[1,1,1] neg_lo:[1,0,0] neg_hi:[1,0,0]
    v_pk_mul_f32 v[136:137], v[32:33], v[104:105] op_sel:[0,0] op_sel_hi:[0,1]
    v_pk_fma_f32 v[136:137], v[34:35], v[96:97], v[136:137] op_sel:[0,0,0] op_sel_hi:[0,1,1]
    v_pk_mul_f32 v[96:97], v[32:33], v[96:97] op_sel:[0,0] op_sel_hi:[0,1]
    v_pk_fma_f32 v[96:97], v[34:35], v[104:105], v[96:97] op_sel:[0,0,0] op_sel_hi:[0,1,1] neg_lo:[1,0,0] neg_hi:[1,0,0]
    v_pk_mul_f32 v[152:153], v[32:33], v[108:109] op_sel:[1,0] op_sel_hi:[1,1]
    v_pk_fma_f32 v[152:153], v[34:35], v[100:101], v[152:153] op_sel:[1,0,0] op_sel_hi:[1,1,1]
    v_pk_mul_f32 v[100:101], v[32:33], v[100:101] op_sel:[1,0] op_sel_hi:[1,1]
    v_pk_fma_f32 v[100:101], v[34:35], v[108:109], v[100:101] op_sel:[1,0,0] op_sel_hi:[1,1,1] neg_lo:[1,0,0] neg_hi:[1,0,0]
    v_pk_mul_f32 v[138:139], v[32:33], v[106:107] op_sel:[0,0] op_sel_hi:[0,1]
    v_pk_fma_f32 v[138:139], v[34:35], v[98:99], v[138:139] op_sel:[0,0,0] op_sel_hi:[0,1,1]
    v_pk_mul_f32 v[98:99], v[32:33], v[98:99] op_sel:[0,0] op_sel_hi:[0,1]
    v_pk_fma_f32 v[98:99], v[34:35], v[106:107], v[98:99] op_sel:[0,0,0] op_sel_hi:[0,1,1] neg_lo:[1,0,0] neg_hi:[1,0,0]
    v_pk_mul_f32 v[154:155], v[32:33], v[110:111] op_sel:[1,0] op_sel_hi:[1,1]
    v_pk_fma_f32 v[154:155], v[34:35], v[102:103], v[154:155] op_sel:[1,0,0] op_sel_hi:[1,1,1]
    v_pk_mul_f32 v[102:103], v[32:33], v[102:103] op_sel:[1,0] op_sel_hi:[1,1]
    v_pk_fma_f32 v[102:103], v[34:35], v[110:111], v[102:103] op_sel:[1,0,0] op_sel_hi:[1,1,1] neg_lo:[1,0,0] neg_hi:[1,0,0]
    v_pk_mul_f32 v[140:141], v[32:33], v[120:121] op_sel:[0,0] op_sel_hi:[0,1]
    v_pk_fma_f32 v[140:141], v[34:35], v[112:113], v[140:141] op_sel:[0,0,0] op_sel_hi:[0,1,1]
    v_pk_mul_f32 v[112:113], v[32:33], v[112:113] op_sel:[0,0] op_sel_hi:[0,1]
    v_pk_fma_f32 v[112:113], v[34:35], v[120:121], v[112:113] op_sel:[0,0,0] op_sel_hi:[0,1,1] neg_lo:[1,0,0] neg_hi:[1,0,0]
    v_pk_mul_f32 v[156:157], v[32:33], v[124:125] op_sel:[1,0] op_sel_hi:[1,1]
    v_pk_fma_f32 v[156:157], v[34:35], v[116:117], v[156:157] op_sel:[1,0,0] op_sel_hi:[1,1,1]
    v_pk_mul_f32 v[116:117], v[32:33], v[116:117] op_sel:[1,0] op_sel_hi:[1,1]
    v_pk_fma_f32 v[116:117], v[34:35], v[124:125], v[116:117] op_sel:[1,0,0] op_sel_hi:[1,1,1] neg_lo:[1,0,0] neg_hi:[1,0,0]
    v_pk_mul_f32 v[142:143], v[32:33], v[122:123] op_sel:[0,0] op_sel_hi:[0,1]
    v_pk_fma_f32 v[142:143], v[34:35], v[114:115], v[142:143] op_sel:[0,0,0] op_sel_hi:[0,1,1]
    v_pk_mul_f32 v[114:115], v[32:33], v[114:115] op_sel:[0,0] op_sel_hi:[0,1]
    v_pk_fma_f32 v[114:115], v[34:35], v[122:123], v[114:115] op_sel:[0,0,0] op_sel_hi:[0,1,1] neg_lo:[1,0,0] neg_hi:[1,0,0]
    v_pk_mul_f32 v[158:159], v[32:33], v[126:127] op_sel:[1,0] op_sel_hi:[1,1]
    v_pk_fma_f32 v[158:159], v[34:35], v[118:119], v[158:159] op_sel:[1,0,0] op_sel_hi:[1,1,1]
    v_pk_mul_f32 v[118:119], v[32:33], v[118:119] op_sel:[1,0] op_sel_hi:[1,1]
    v_pk_fma_f32 v[118:119], v[34:35], v[126:127], v[118:119] op_sel:[1,0,0] op_sel_hi:[1,1,1] neg_lo:[1,0,0] neg_hi:[1,0,0]
    buffer_load_dwordx2 v[240:241], v221, s[12:15], s57 offen sc1
    global_load_dwordx2 v[242:243], v222, s[58:59]
    buffer_load_dwordx2 v[224:225], v220, s[4:7], s56 offen
    s_add_u32 s56, s56, 8192
    buffer_load_dwordx2 v[226:227], v220, s[4:7], s56 offen
    s_add_u32 s56, s56, 8192
    buffer_load_dwordx2 v[228:229], v220, s[4:7], s56 offen
    s_add_u32 s56, s56, 8192
    buffer_load_dwordx2 v[230:231], v220, s[4:7], s56 offen
    s_add_u32 s56, s56, 8192
    buffer_load_dwordx2 v[232:233], v220, s[4:7], s56 offen
    s_add_u32 s56, s56, 8192
    buffer_load_dwordx2 v[234:235], v220, s[4:7], s56 offen
    s_add_u32 s56, s56, 8192
    buffer_load_dwordx2 v[236:237], v220, s[4:7], s56 offen
    s_add_u32 s56, s56, 8192
    buffer_load_dwordx2 v[238:239], v220, s[4:7], s56 offen
    s_add_u32 s56, s56, 8192
    s_waitcnt vmcnt(10)
L_poll:
    v_xor_b32 v161, v161, v198
    v_xor_b32 v163, v163, v198
    v_xor_b32 v165, v165, v199
    v_xor_b32 v167, v167, v199
    v_xor_b32 v169, v169, v200
    v_xor_b32 v171, v171, v200
    v_xor_b32 v173, v173, v201
    v_xor_b32 v175, v175, v201
    v_xor_b32 v177, v177, v198
    v_xor_b32 v179, v179, v198
    v_xor_b32 v181, v181, v199
    v_xor_b32 v183, v183, v199
    v_xor_b32 v185, v185, v200
    v_xor_b32 v187, v187, v200
    v_xor_b32 v189, v189, v201
    v_xor_b32 v191, v191, v201
    v_or3_b32 v214, v161, v163, v165
    v_or3_b32 v214, v214, v167, v169
    v_or3_b32 v214, v214, v171, v173
    v_or3_b32 v214, v214, v175, v177
    v_or3_b32 v214, v214, v179, v181
    v_or3_b32 v214, v214, v183, v185
    v_or3_b32 v214, v214, v187, v189
    v_or_b32 v214, v214, v191
    v_cmp_ne_u32 vcc, 0, v214
    s_nop 1
    s_cmp_eq_u64 vcc, 0
    s_cbranch_scc1 L_got
    s_sub_u32 s96, s96, 1
    s_cbranch_scc1 L_got
    s_sleep 1
    buffer_load_dwordx4 v[160:163], v194, s[24:27], s44 offen offset:0 sc1
    buffer_load_dwordx4 v[164:167], v194, s[24:27], s45 offen offset:0 sc1
    buffer_load_dwordx4 v[168:171], v194, s[24:27], s46 offen offset:0 sc1
    buffer_load_dwordx4 v[172:175], v194, s[24:27], s47 offen offset:0 sc1
    buffer_load_dwordx4 v[176:179], v194, s[24:27], s44 offen offset:256 sc1
    buffer_load_dwordx4 v[180:183], v194, s[24:27], s45 offen offset:256 sc1
    buffer_load_dwordx4 v[184:187], v194, s[24:27], s46 offen offset:256 sc1
    buffer_load_dwordx4 v[188:191], v194, s[24:27], s47 offen offset:256 sc1
    s_waitcnt vmcnt(0)
    s_branch L_poll
L_got:
    v_fma_f32 v168, -v46, v174, v168
    v_fma_f32 v170, v46, v172, v170
    v_fma_f32 v168, v44, v172, v168
    v_fma_f32 v170, v44, v174, v170
    v_fma_f32 v184, -v47, v190, v184
    v_fma_f32 v186, v47, v188, v186
    v_fma_f32 v184, v45, v188, v184
    v_fma_f32 v186, v45, v190, v186
    v_fma_f32 v164, -v46, v170, v164
    v_fma_f32 v166, v46, v168, v166
    v_fma_f32 v164, v44, v168, v164
    v_fma_f32 v166, v44, v170, v166
    v_fma_f32 v180, -v47, v186, v180
    v_fma_f32 v182, v47, v184, v182
    v_fma_f32 v180, v45, v184, v180
    v_fma_f32 v182, v45, v186, v182
    v_fma_f32 v160, -v46, v166, v160
    v_fma_f32 v162, v46, v164, v162
    v_fma_f32 v160, v44, v164, v160
    v_fma_f32 v162, v44, v166, v162
    v_fma_f32 v176, -v47, v182, v176
    v_fma_f32 v178, v47, v180, v178
    v_fma_f32 v176, v45, v180, v176
    v_fma_f32 v178, v45, v182, v178
    v_mul_f32 v16, v48, v160
    v_mul_f32 v17, v48, v162
    v_fma_f32 v16, -v50, v162, v16
    v_fma_f32 v17, v50, v160, v17
    v_mul_f32 v18, v49, v176
    v_mul_f32 v19, v49, v178
    v_fma_f32 v18, -v51, v178, v18
    v_fma_f32 v19, v51, v176, v19
    v_mov_b32 v20, v16
    v_mov_b32 v21, v17
    v_mov_b32 v22, v18
    v_mov_b32 v23, v19
    s_nop 1
    v_permlane16_swap_b32 v16, v20
    v_permlane16_swap_b32 v17, v21
    v_permlane16_swap_b32 v18, v22
    v_permlane16_swap_b32 v19, v23
    s_nop 1
    v_add_f32 v16, v16, v20
    v_add_f32 v17, v17, v21
    v_add_f32 v18, v18, v22
    v_add_f32 v19, v19, v23
    v_mov_b32 v20, v16
    v_mov_b32 v21, v17
    v_mov_b32 v22, v18
    v_mov_b32 v23, v19
    s_nop 1
    v_permlane32_swap_b32 v16, v20
    v_permlane32_swap_b32 v17, v21
    v_permlane32_swap_b32 v18, v22
    v_permlane32_swap_b32 v19, v23
    s_nop 1
    v_add_f32 v16, v16, v20
    v_add_f32 v17, v17, v21
    v_add_f32 v18, v18, v22
    v_add_f32 v19, v19, v23
    v_pk_fma_f32 v[56:57], v[16:17], v[206:207], v[56:57] op_sel:[0,0,0] op_sel_hi:[0,1,1]
    v_pk_fma_f32 v[58:59], v[16:17], v[208:209], v[58:59] op_sel:[0,0,0] op_sel_hi:[0,1,1]
    v_pk_fma_f32 v[56:57], v[16:17], v[208:209], v[56:57] op_sel:[1,0,0] op_sel_hi:[1,1,1] neg_lo:[1,0,0] neg_hi:[1,0,0]
    v_pk_fma_f32 v[58:59], v[16:17], v[206:207], v[58:59] op_sel:[1,0,0] op_sel_hi:[1,1,1]
    v_pk_fma_f32 v[60:61], v[18:19], v[210:211], v[60:61] op_sel:[0,0,0] op_sel_hi:[0,1,1]
    v_pk_fma_f32 v[62:63], v[18:19], v[212:213], v[62:63] op_sel:[0,0,0] op_sel_hi:[0,1,1]
    v_pk_fma_f32 v[60:61], v[18:19], v[212:213], v[60:61] op_sel:[1,0,0] op_sel_hi:[1,1,1] neg_lo:[1,0,0] neg_hi:[1,0,0]
    v_pk_fma_f32 v[62:63], v[18:19], v[210:211], v[62:63] op_sel:[1,0,0] op_sel_hi:[1,1,1]
    v_pk_fma_f32 v[64:65], v[30:31], v[58:59], v[64:65] op_sel:[0,0,0] op_sel_hi:[0,1,1] neg_lo:[1,0,0] neg_hi:[1,0,0]
    v_pk_fma_f32 v[128:129], v[30:31], v[56:57], v[128:129] op_sel:[0,0,0] op_sel_hi:[0,1,1]
    v_pk_fma_f32 v[64:65], v[28:29], v[56:57], v[64:65] op_sel:[0,0,0] op_sel_hi:[0,1,1]
    v_pk_fma_f32 v[128:129], v[28:29], v[58:59], v[128:129] op_sel:[0,0,0] op_sel_hi:[0,1,1]
    v_pk_fma_f32 v[68:69], v[30:31], v[62:63], v[68:69] op_sel:[1,0,0] op_sel_hi:[1,1,1] neg_lo:[1,0,0] neg_hi:[1,0,0]
    v_pk_fma_f32 v[144:145], v[30:31], v[60:61], v[144:145] op_sel:[1,0,0] op_sel_hi:[1,1,1]
    v_pk_fma_f32 v[68:69], v[28:29], v[60:61], v[68:69] op_sel:[1,0,0] op_sel_hi:[1,1,1]
    v_pk_fma_f32 v[144:145], v[28:29], v[62:63], v[144:145] op_sel:[1,0,0] op_sel_hi:[1,1,1]
    v_pk_fma_f32 v[66:67], v[30:31], v[128:129], v[66:67] op_sel:[0,0,0] op_sel_hi:[0,1,1] neg_lo:[1,0,0] neg_hi:[1,0,0]
    v_pk_fma_f32 v[130:131], v[30:31], v[64:65], v[130:131] op_sel:[0,0,0] op_sel_hi:[0,1,1]
    v_pk_fma_f32 v[66:67], v[28:29], v[64:65], v[66:67] op_sel:[0,0,0] op_sel_hi:[0,1,1]
    v_pk_fma_f32 v[130:131], v[28:29], v[128:129], v[130:131] op_sel:[0,0,0] op_sel_hi:[0,1,1]
    v_pk_fma_f32 v[70:71], v[30:31], v[144:145], v[70:71] op_sel:[1,0,0] op_sel_hi:[1,1,1] neg_lo:[1,0,0] neg_hi:[1,0,0]
    v_pk_fma_f32 v[146:147], v[30:31], v[68:69], v[146:147] op_sel:[1,0,0] op_sel_hi:[1,1,1]
    v_pk_fma_f32 v[70:71], v[28:29], v[68:69], v[70:71] op_sel:[1,0,0] op_sel_hi:[1,1,1]
    v_pk_fma_f32 v[146:147], v[28:29], v[144:145], v[146:147] op_sel:[1,0,0] op_sel_hi:[1,1,1]
    v_cvt_pk_bf16_f32 v160, v64, v66
    v_cvt_pk_bf16_f32 v168, -v128, -v130
    v_cvt_pk_bf16_f32 v164, v65, v67
    v_cvt_pk_bf16_f32 v172, -v129, -v131
    v_cvt_pk_bf16_f32 v176, v68, v70
    v_cvt_pk_bf16_f32 v184, -v144, -v146
    v_cvt_pk_bf16_f32 v180, v69, v71
    v_cvt_pk_bf16_f32 v188, -v145, -v147
    v_pk_fma_f32 v[80:81], v[30:31], v[130:131], v[80:81] op_sel:[0,0,0] op_sel_hi:[0,1,1] neg_lo:[1,0,0] neg_hi:[1,0,0]
    v_pk_fma_f32 v[132:133], v[30:31], v[66:67], v[132:133] op_sel:[0,0,0] op_sel_hi:[0,1,1]
    v_pk_fma_f32 v[80:81], v[28:29], v[66:67], v[80:81] op_sel:[0,0,0] op_sel_hi:[0,1,1]
    v_pk_fma_f32 v[132:133], v[28:29], v[130:131], v[132:133] op_sel:[0,0,0] op_sel_hi:[0,1,1]
    v_pk_fma_f32 v[84:85], v[30:31], v[146:147], v[84:85] op_sel:[1,0,0] op_sel_hi:[1,1,1] neg_lo:[1,0,0] neg_hi:[1,0,0]
    v_pk_fma_f32 v[148:149], v[30:31], v[70:71], v[148:149] op_sel:[1,0,0] op_sel_hi:[1,1,1]
    v_pk_fma_f32 v[84:85], v[28:29], v[70:71], v[84:85] op_sel:[1,0,0] op_sel_hi:[1,1,1]
    v_pk_fma_f32 v[148:149], v[28:29], v[146:147], v[148:149] op_sel:[1,0,0] op_sel_hi:[1,1,1]
    v_pk_fma_f32 v[82:83], v[30:31], v[132:133], v[82:83] op_sel:[0,0,0] op_sel_hi:[0,1,1] neg_lo:[1,0,0] neg_hi:[1,0,0]
    v_pk_fma_f32 v[134:135], v[30:31], v[80:81], v[134:135] op_sel:[0,0,0] op_sel_hi:[0,1,1]
    v_pk_fma_f32 v[82:83], v[28:29], v[80:81], v[82:83] op_sel:[0,0,0] op_sel_hi:[0,1,1]
    v_pk_fma_f32 v[134:135], v[28:29], v[132:133], v[134:135] op_sel:[0,0,0] op_sel_hi:[0,1,1]
    v_pk_fma_f32 v[86:87], v[30:31], v[148:149], v[86:87] op_sel:[1,0,0] op_sel_hi:[1,1,1] neg_lo:[1,0,0] neg_hi:[1,0,0]
    v_pk_fma_f32 v[150:151], v[30:31], v[84:85], v[150:151] op_sel:[1,0,0] op_sel_hi:[1,1,1]
    v_pk_fma_f32 v[86:87], v[28:29], v[84:85], v[86:87] op_sel:[1,0,0] op_sel_hi:[1,1,1]
    v_pk_fma_f32 v[150:151], v[28:29], v[148:149], v[150:151] op_sel:[1,0,0] op_sel_hi:[1,1,1]
    v_cvt_pk_bf16_f32 v161, v80, v82
    v_cvt_pk_bf16_f32 v169, -v132, -v134
    v_cvt_pk_bf16_f32 v165, v81, v83
    v_cvt_pk_bf16_f32 v173, -v133, -v135
    v_cvt_pk_bf16_f32 v177, v84, v86
    v_cvt_pk_bf16_f32 v185, -v148, -v150
    v_cvt_pk_bf16_f32 v181, v85, v87
    v_cvt_pk_bf16_f32 v189, -v149, -v151
    v_pk_fma_f32 v[96:97], v[30:31], v[134:135], v[96:97] op_sel:[0,0,0] op_sel_hi:[0,1,1] neg_lo:[1,0,0] neg_hi:[1,0,0]
    v_pk_fma_f32 v[136:137], v[30:31], v[82:83], v[136:137] op_sel:[0,0,0] op_sel_hi:[0,1,1]
    v_pk_fma_f32 v[96:97], v[28:29], v[82:83], v[96:97] op_sel:[0,0,0] op_sel_hi:[0,1,1]
    v_pk_fma_f32 v[136:137], v[28:29], v[134:135], v[136:137] op_sel:[0,0,0] op_sel_hi:[0,1,1]
    v_pk_fma_f32 v[100:101], v[30:31], v[150:151], v[100:101] op_sel:[1,0,0] op_sel_hi:[1,1,1] neg_lo:[1,0,0] neg_hi:[1,0,0]
    v_pk_fma_f32 v[152:153], v[30:31], v[86:87], v[152:153] op_sel:[1,0,0] op_sel_hi:[1,1,1]
    v_pk_fma_f32 v[100:101], v[28:29], v[86:87], v[100:101] op_sel:[1,0,0] op_sel_hi:[1,1,1]
    v_pk_fma_f32 v[152:153], v[28:29], v[150:151], v[152:153] op_sel:[1,0,0] op_sel_hi:[1,1,1]
    v_pk_fma_f32 v[98:99], v[30:31], v[136:137], v[98:99] op_sel:[0,0,0] op_sel_hi:[0,1,1] neg_lo:[1,0,0] neg_hi:[1,0,0]
    v_pk_fma_f32 v[138:139], v[30:31], v[96:97], v[138:139] op_sel:[0,0,0] op_sel_hi:[0,1,1]
    v_pk_fma_f32 v[98:99], v[28:29], v[96:97], v[98:99] op_sel:[0,0,0] op_sel_hi:[0,1,1]
    v_pk_fma_f32 v[138:139], v[28:29], v[136:137], v[138:139] op_sel:[0,0,0] op_sel_hi:[0,1,1]
    v_pk_fma_f32 v[102:103], v[30:31], v[152:153], v[102:103] op_sel:[1,0,0] op_sel_hi:[1,1,1] neg_lo:[1,0,0] neg_hi:[1,0,0]
    v_pk_fma_f32 v[154:155], v[30:31], v[100:101], v[154:155] op_sel:[1,0,0] op_sel_hi:[1,1,1]
    v_pk_fma_f32 v[102:103], v[28:29], v[100:101], v[102:103] op_sel:[1,0,0] op_sel_hi:[1,1,1]
    v_pk_fma_f32 v[154:155], v[28:29], v[152:153], v[154:155] op_sel:[1,0,0] op_sel_hi:[1,1,1]
    v_cvt_pk_bf16_f32 v162, v96, v98
    v_cvt_pk_bf16_f32 v170, -v136, -v138
    v_cvt_pk_bf16_f32 v166, v97, v99
    v_cvt_pk_bf16_f32 v174, -v137, -v139
    v_cvt_pk_bf16_f32 v178, v100, v102
    v_cvt_pk_bf16_f32 v186, -v152, -v154
    v_cvt_pk_bf16_f32 v182, v101, v103
    v_cvt_pk_bf16_f32 v190, -v153, -v155
    v_pk_fma_f32 v[112:113], v[30:31], v[138:139], v[112:113] op_sel:[0,0,0] op_sel_hi:[0,1,1] neg_lo:[1,0,0] neg_hi:[1,0,0]
    v_pk_fma_f32 v[140:141], v[30:31], v[98:99], v[140:141] op_sel:[0,0,0] op_sel_hi:[0,1,1]
    v_pk_fma_f32 v[112:113], v[28:29], v[98:99], v[112:113] op_sel:[0,0,0] op_sel_hi:[0,1,1]
    v_pk_fma_f32 v[140:141], v[28:29], v[138:139], v[140:141] op_sel:[0,0,0] op_sel_hi:[0,1,1]
    v_pk_fma_f32 v[116:117], v[30:31], v[154:155], v[116:117] op_sel:[1,0,0] op_sel_hi:[1,1,1] neg_lo:[1,0,0] neg_hi:[1,0,0]
    v_pk_fma_f32 v[156:157], v[30:31], v[102:103], v[156:157] op_sel:[1,0,0] op_sel_hi:[1,1,1]
    v_pk_fma_f32 v[116:117], v[28:29], v[102:103], v[116:117] op_sel:[1,0,0] op_sel_hi:[1,1,1]
    v_pk_fma_f32 v[156:157], v[28:29], v[154:155], v[156:157] op_sel:[1,0,0] op_sel_hi:[1,1,1]
    v_pk_fma_f32 v[114:115], v[30:31], v[140:141], v[114:115] op_sel:[0,0,0] op_sel_hi:[0,1,1] neg_lo:[1,0,0] neg_hi:[1,0,0]
    v_pk_fma_f32 v[142:143], v[30:31], v[112:113], v[142:143] op_sel:[0,0,0] op_sel_hi:[0,1,1]
    v_pk_fma_f32 v[114:115], v[28:29], v[112:113], v[114:115] op_sel:[0,0,0] op_sel_hi:[0,1,1]
    v_pk_fma_f32 v[142:143], v[28:29], v[140:141], v[142:143] op_sel:[0,0,0] op_sel_hi:[0,1,1]
    v_pk_fma_f32 v[118:119], v[30:31], v[156:157], v[118:119] op_sel:[1,0,0] op_sel_hi:[1,1,1] neg_lo:[1,0,0] neg_hi:[1,0,0]
    v_pk_fma_f32 v[158:159], v[30:31], v[116:117], v[158:159] op_sel:[1,0,0] op_sel_hi:[1,1,1]
    v_pk_fma_f32 v[118:119], v[28:29], v[116:117], v[118:119] op_sel:[1,0,0] op_sel_hi:[1,1,1]
    v_pk_fma_f32 v[158:159], v[28:29], v[156:157], v[158:159] op_sel:[1,0,0] op_sel_hi:[1,1,1]
    v_cvt_pk_bf16_f32 v163, v112, v114
    v_cvt_pk_bf16_f32 v171, -v140, -v142
    v_cvt_pk_bf16_f32 v167, v113, v115
    v_cvt_pk_bf16_f32 v175, -v141, -v143
    v_cvt_pk_bf16_f32 v179, v116, v118
    v_cvt_pk_bf16_f32 v187, -v156, -v158
    v_cvt_pk_bf16_f32 v183, v117, v119
    v_cvt_pk_bf16_f32 v191, -v157, -v159
    ds_write_b128 v195, v[160:163] offset:0
    ds_write_b128 v195, v[164:167] offset:16
    ds_write_b128 v195, v[176:179] offset:2304
    ds_write_b128 v195, v[180:183] offset:2320
    ds_write_b128 v195, v[168:171] offset:4608
    ds_write_b128 v195, v[172:175] offset:4624
    ds_write_b128 v195, v[184:187] offset:6912
    ds_write_b128 v195, v[188:191] offset:6928
    s_waitcnt lgkmcnt(4)
    ds_read_b64_tr_b16 v[128:129], v196 offset:0
    ds_read_b64_tr_b16 v[130:131], v196 offset:576
    ds_read_b64_tr_b16 v[132:133], v196 offset:32
    ds_read_b64_tr_b16 v[134:135], v196 offset:608
    ds_read_b64_tr_b16 v[136:137], v196 offset:64
    ds_read_b64_tr_b16 v[138:139], v196 offset:640
    ds_read_b64_tr_b16 v[140:141], v196 offset:96
    ds_read_b64_tr_b16 v[142:143], v196 offset:672
    s_waitcnt lgkmcnt(8)
    ds_read_b64_tr_b16 v[144:145], v196 offset:4608
    ds_read_b64_tr_b16 v[146:147], v196 offset:5184
    ds_read_b64_tr_b16 v[148:149], v196 offset:4640
    ds_read_b64_tr_b16 v[150:151], v196 offset:5216
    ds_read_b64_tr_b16 v[152:153], v196 offset:4672
    ds_read_b64_tr_b16 v[154:155], v196 offset:5248
    ds_read_b64_tr_b16 v[156:157], v196 offset:4704
    ds_read_b64_tr_b16 v[158:159], v196 offset:5280
    s_add_u32 s39, s53, 0
    s_waitcnt lgkmcnt(14)
    buffer_store_dwordx4 v[128:131], v197, s[12:15], s39 offen offset:0 sc1
    s_waitcnt lgkmcnt(12)
    buffer_store_dwordx4 v[132:135], v197, s[12:15], s39 offen offset:1024 sc1
    s_add_u32 s39, s53, 8192
    s_waitcnt lgkmcnt(10)
    buffer_store_dwordx4 v[136:139], v197, s[12:15], s39 offen offset:0 sc1
    s_waitcnt lgkmcnt(8)
    buffer_store_dwordx4 v[140:143], v197, s[12:15], s39 offen offset:1024 sc1
    s_add_u32 s39, s53, 4096
    s_waitcnt lgkmcnt(6)
    buffer_store_dwordx4 v[144:147], v197, s[12:15], s39 offen offset:0 sc1
    s_waitcnt lgkmcnt(4)
    buffer_store_dwordx4 v[148:151], v197, s[12:15], s39 offen offset:1024 sc1
    s_add_u32 s39, s53, 12288
    s_waitcnt lgkmcnt(2)
    buffer_store_dwordx4 v[152:155], v197, s[12:15], s39 offen offset:0 sc1
    s_waitcnt lgkmcnt(0)
    buffer_store_dwordx4 v[156:159], v197, s[12:15], s39 offen offset:1024 sc1
    s_waitcnt vmcnt(8)
L_gchk:
    v_cmp_ne_u32 vcc, s93, v241
    s_nop 1
    s_cmp_eq_u64 vcc, 0
    s_cbranch_scc1 L_gok
    s_sub_u32 s96, s96, 1
    s_cbranch_scc1 L_gok
    buffer_load_dwordx2 v[240:241], v221, s[12:15], s57 offen sc1
    s_waitcnt vmcnt(0)
    s_branch L_gchk
L_gok:
    v_lshlrev_b32 v6, 2, v25
    ds_bpermute_b32 v36, v6, v240 offset:0
    ds_bpermute_b32 v37, v6, v240 offset:16
    ds_bpermute_b32 v38, v6, v240 offset:32
    ds_bpermute_b32 v39, v6, v240 offset:48
    ds_bpermute_b32 v40, v6, v240 offset:64
    ds_bpermute_b32 v41, v6, v240 offset:80
    ds_bpermute_b32 v42, v6, v240 offset:96
    ds_bpermute_b32 v43, v6, v240 offset:112
    s_mov_b32 s10, 0xffff0000
    s_add_u32 m0, s23, 81920
    s_mov_b32 s21, s17
    s_lshl_b32 s21, s21, 7
    buffer_load_dwordx4 v202, s[28:31], s21 offen offset:0  lds
    v_lshlrev_b32 v252, 16, v242
    v_and_b32 v253, s10, v242
    v_lshlrev_b32 v254, 16, v243
    v_and_b32 v255, s10, v243
    s_waitcnt lgkmcnt(0)
    v_sub_f32 v12, 1.0, v36
    buffer_load_dwordx4 v203, s[28:31], s21 offen offset:1024  lds
    v_cvt_pk_bf16_f32 v12, v12, v12
    v_lshlrev_b32 v12, 16, v12
    v_lshlrev_b32 v8, 16, v224
    v_and_b32 v9, s10, v224
    v_mul_f32 v10, v8, v252
    v_mul_f32 v11, v9, v253
    buffer_load_dwordx4 v204, s[28:31], s21 offen offset:2048  lds
    v_cvt_pk_bf16_f32 v10, v10, v11
    v_mul_f32 v8, v8, v12
    v_mul_f32 v9, v9, v12
    v_cvt_pk_bf16_f32 v8, v8, v9
    v_and_b32 v11, s10, v10
    v_lshlrev_b32 v10, 16, v10
    buffer_load_dwordx4 v205, s[28:31], s21 offen offset:3072  lds
    v_and_b32 v9, s10, v8
    v_lshlrev_b32 v8, 16, v8
    v_fma_f32 v72, v36, v10, v8
    v_fma_f32 v73, v36, v11, v9
    v_lshlrev_b32 v8, 16, v225
    v_and_b32 v9, s10, v225
    s_add_u32 m0, s23, 0
    s_cmp_le_u32 s55, 0
    s_cselect_b32 s21, 1, 0
    s_or_b32 s21, s21, s54
    s_lshl_b32 s21, s21, 7
    buffer_load_dwordx4 v202, s[28:31], s21 offen offset:0  lds
    v_mul_f32 v10, v8, v254
    v_mul_f32 v11, v9, v255
    v_cvt_pk_bf16_f32 v10, v10, v11
    v_mul_f32 v8, v8, v12
    v_mul_f32 v9, v9, v12
    v_cvt_pk_bf16_f32 v8, v8, v9
    buffer_load_dwordx4 v203, s[28:31], s21 offen offset:1024  lds
    v_and_b32 v11, s10, v10
    v_lshlrev_b32 v10, 16, v10
    v_and_b32 v9, s10, v8
    v_lshlrev_b32 v8, 16, v8
    v_fma_f32 v74, v36, v10, v8
    v_fma_f32 v75, v36, v11, v9
    buffer_load_dwordx4 v204, s[28:31], s21 offen offset:2048  lds
    v_sub_f32 v12, 1.0, v37
    v_cvt_pk_bf16_f32 v12, v12, v12
    v_lshlrev_b32 v12, 16, v12
    v_lshlrev_b32 v8, 16, v226
    v_and_b32 v9, s10, v226
    v_mul_f32 v10, v8, v252
    buffer_load_dwordx4 v205, s[28:31], s21 offen offset:3072  lds
    v_mul_f32 v11, v9, v253
    v_cvt_pk_bf16_f32 v10, v10, v11
    v_mul_f32 v8, v8, v12
    v_mul_f32 v9, v9, v12
    v_cvt_pk_bf16_f32 v8, v8, v9
    v_and_b32 v11, s10, v10
    s_add_u32 m0, s23, 16384
    s_cmp_le_u32 s55, 1
    s_cselect_b32 s21, 2, 1
    s_or_b32 s21, s21, s54
    s_lshl_b32 s21, s21, 7
    buffer_load_dwordx4 v202, s[28:31], s21 offen offset:0  lds
    v_lshlrev_b32 v10, 16, v10
    v_and_b32 v9, s10, v8
    v_lshlrev_b32 v8, 16, v8
    v_fma_f32 v76, v37, v10, v8
    v_fma_f32 v77, v37, v11, v9
    v_lshlrev_b32 v8, 16, v227
    buffer_load_dwordx4 v203, s[28:31], s21 offen offset:1024  lds
    v_and_b32 v9, s10, v227
    v_mul_f32 v10, v8, v254
    v_mul_f32 v11, v9, v255
    v_cvt_pk_bf16_f32 v10, v10, v11
    v_mul_f32 v8, v8, v12
    v_mul_f32 v9, v9, v12
    buffer_load_dwordx4 v204, s[28:31], s21 offen offset:2048  lds
    v_cvt_pk_bf16_f32 v8, v8, v9
    v_and_b32 v11, s10, v10
    v_lshlrev_b32 v10, 16, v10
    v_and_b32 v9, s10, v8
    v_lshlrev_b32 v8, 16, v8
    v_fma_f32 v78, v37, v10, v8
    buffer_load_dwordx4 v205, s[28:31], s21 offen offset:3072  lds
    v_fma_f32 v79, v37, v11, v9
    v_sub_f32 v12, 1.0, v38
    v_cvt_pk_bf16_f32 v12, v12, v12
    v_lshlrev_b32 v12, 16, v12
    v_lshlrev_b32 v8, 16, v228
    v_and_b32 v9, s10, v228
    v_mul_f32 v10, v8, v252
    v_mul_f32 v11, v9, v253
    v_cvt_pk_bf16_f32 v10, v10, v11
    v_mul_f32 v8, v8, v12
    v_mul_f32 v9, v9, v12
    v_cvt_pk_bf16_f32 v8, v8, v9
    v_and_b32 v11, s10, v10
    v_lshlrev_b32 v10, 16, v10
    v_and_b32 v9, s10, v8
    v_lshlrev_b32 v8, 16, v8
    v_fma_f32 v88, v38, v10, v8
    v_fma_f32 v89, v38, v11, v9
    v_lshlrev_b32 v8, 16, v229
    v_and_b32 v9, s10, v229
    v_mul_f32 v10, v8, v254
    v_mul_f32 v11, v9, v255
    v_cvt_pk_bf16_f32 v10, v10, v11
    v_mul_f32 v8, v8, v12
    v_mul_f32 v9, v9, v12
    v_cvt_pk_bf16_f32 v8, v8, v9
    v_and_b32 v11, s10, v10
    v_lshlrev_b32 v10, 16, v10
    v_and_b32 v9, s10, v8
    v_lshlrev_b32 v8, 16, v8
    v_fma_f32 v90, v38, v10, v8
    v_fma_f32 v91, v38, v11, v9
    v_sub_f32 v12, 1.0, v39
    v_cvt_pk_bf16_f32 v12, v12, v12
    v_lshlrev_b32 v12, 16, v12
    v_lshlrev_b32 v8, 16, v230
    v_and_b32 v9, s10, v230
    v_mul_f32 v10, v8, v252
    v_mul_f32 v11, v9, v253
    v_cvt_pk_bf16_f32 v10, v10, v11
    v_mul_f32 v8, v8, v12
    v_mul_f32 v9, v9, v12
    v_cvt_pk_bf16_f32 v8, v8, v9
    v_and_b32 v11, s10, v10
    v_lshlrev_b32 v10, 16, v10
    v_and_b32 v9, s10, v8
    v_lshlrev_b32 v8, 16, v8
    v_fma_f32 v92, v39, v10, v8
    v_fma_f32 v93, v39, v11, v9
    v_lshlrev_b32 v8, 16, v231
    v_and_b32 v9, s10, v231
    v_mul_f32 v10, v8, v254
    v_mul_f32 v11, v9, v255
    v_cvt_pk_bf16_f32 v10, v10, v11
    v_mul_f32 v8, v8, v12
    v_mul_f32 v9, v9, v12
    v_cvt_pk_bf16_f32 v8, v8, v9
    v_and_b32 v11, s10, v10
    v_lshlrev_b32 v10, 16, v10
    v_and_b32 v9, s10, v8
    v_lshlrev_b32 v8, 16, v8
    v_fma_f32 v94, v39, v10, v8
    v_fma_f32 v95, v39, v11, v9
    v_sub_f32 v12, 1.0, v40
    v_cvt_pk_bf16_f32 v12, v12, v12
    v_lshlrev_b32 v12, 16, v12
    v_lshlrev_b32 v8, 16, v232
    v_and_b32 v9, s10, v232
    v_mul_f32 v10, v8, v252
    v_mul_f32 v11, v9, v253
    v_cvt_pk_bf16_f32 v10, v10, v11
    v_mul_f32 v8, v8, v12
    v_mul_f32 v9, v9, v12
    v_cvt_pk_bf16_f32 v8, v8, v9
    v_and_b32 v11, s10, v10
    v_lshlrev_b32 v10, 16, v10
    v_and_b32 v9, s10, v8
    v_lshlrev_b32 v8, 16, v8
    v_fma_f32 v104, v40, v10, v8
    v_fma_f32 v105, v40, v11, v9
    v_lshlrev_b32 v8, 16, v233
    v_and_b32 v9, s10, v233
    v_mul_f32 v10, v8, v254
    v_mul_f32 v11, v9, v255
    v_cvt_pk_bf16_f32 v10, v10, v11
    v_mul_f32 v8, v8, v12
    v_mul_f32 v9, v9, v12
    v_cvt_pk_bf16_f32 v8, v8, v9
    v_and_b32 v11, s10, v10
    v_lshlrev_b32 v10, 16, v10
    v_and_b32 v9, s10, v8
    v_lshlrev_b32 v8, 16, v8
    v_fma_f32 v106, v40, v10, v8
    v_fma_f32 v107, v40, v11, v9
    v_sub_f32 v12, 1.0, v41
    v_cvt_pk_bf16_f32 v12, v12, v12
    v_lshlrev_b32 v12, 16, v12
    v_lshlrev_b32 v8, 16, v234
    v_and_b32 v9, s10, v234
    v_mul_f32 v10, v8, v252
    v_mul_f32 v11, v9, v253
    v_cvt_pk_bf16_f32 v10, v10, v11
    v_mul_f32 v8, v8, v12
    v_mul_f32 v9, v9, v12
    v_cvt_pk_bf16_f32 v8, v8, v9
    v_and_b32 v11, s10, v10
    v_lshlrev_b32 v10, 16, v10
    v_and_b32 v9, s10, v8
    v_lshlrev_b32 v8, 16, v8
    v_fma_f32 v108, v41, v10, v8
    v_fma_f32 v109, v41, v11, v9
    v_lshlrev_b32 v8, 16, v235
    v_and_b32 v9, s10, v235
    v_mul_f32 v10, v8, v254
    v_mul_f32 v11, v9, v255
    v_cvt_pk_bf16_f32 v10, v10, v11
    v_mul_f32 v8, v8, v12
    v_mul_f32 v9, v9, v12
    v_cvt_pk_bf16_f32 v8, v8, v9
    v_and_b32 v11, s10, v10
    v_lshlrev_b32 v10, 16, v10
    v_and_b32 v9, s10, v8
    v_lshlrev_b32 v8, 16, v8
    v_fma_f32 v110, v41, v10, v8
    v_fma_f32 v111, v41, v11, v9
    v_sub_f32 v12, 1.0, v42
    v_cvt_pk_bf16_f32 v12, v12, v12
    v_lshlrev_b32 v12, 16, v12
    v_lshlrev_b32 v8, 16, v236
    v_and_b32 v9, s10, v236
    v_mul_f32 v10, v8, v252
    v_mul_f32 v11, v9, v253
    v_cvt_pk_bf16_f32 v10, v10, v11
    v_mul_f32 v8, v8, v12
    v_mul_f32 v9, v9, v12
    v_cvt_pk_bf16_f32 v8, v8, v9
    v_and_b32 v11, s10, v10
    v_lshlrev_b32 v10, 16, v10
    v_and_b32 v9, s10, v8
    v_lshlrev_b32 v8, 16, v8
    v_fma_f32 v120, v42, v10, v8
    v_fma_f32 v121, v42, v11, v9
    v_lshlrev_b32 v8, 16, v237
    v_and_b32 v9, s10, v237
    v_mul_f32 v10, v8, v254
    v_mul_f32 v11, v9, v255
    v_cvt_pk_bf16_f32 v10, v10, v11
    v_mul_f32 v8, v8, v12
    v_mul_f32 v9, v9, v12
    v_cvt_pk_bf16_f32 v8, v8, v9
    v_and_b32 v11, s10, v10
    v_lshlrev_b32 v10, 16, v10
    v_and_b32 v9, s10, v8
    v_lshlrev_b32 v8, 16, v8
    v_fma_f32 v122, v42, v10, v8
    v_fma_f32 v123, v42, v11, v9
    v_sub_f32 v12, 1.0, v43
    v_cvt_pk_bf16_f32 v12, v12, v12
    v_lshlrev_b32 v12, 16, v12
    v_lshlrev_b32 v8, 16, v238
    v_and_b32 v9, s10, v238
    v_mul_f32 v10, v8, v252
    v_mul_f32 v11, v9, v253
    v_cvt_pk_bf16_f32 v10, v10, v11
    v_mul_f32 v8, v8, v12
    v_mul_f32 v9, v9, v12
    v_cvt_pk_bf16_f32 v8, v8, v9
    v_and_b32 v11, s10, v10
    v_lshlrev_b32 v10, 16, v10
    v_and_b32 v9, s10, v8
    v_lshlrev_b32 v8, 16, v8
    v_fma_f32 v124, v43, v10, v8
    v_fma_f32 v125, v43, v11, v9
    v_lshlrev_b32 v8, 16, v239
    v_and_b32 v9, s10, v239
    v_mul_f32 v10, v8, v254
    v_mul_f32 v11, v9, v255
    v_cvt_pk_bf16_f32 v10, v10, v11
    v_mul_f32 v8, v8, v12
    v_mul_f32 v9, v9, v12
    v_cvt_pk_bf16_f32 v8, v8, v9
    v_and_b32 v11, s10, v10
    v_lshlrev_b32 v10, 16, v10
    v_and_b32 v9, s10, v8
    v_lshlrev_b32 v8, 16, v8
    v_fma_f32 v126, v43, v10, v8
    v_fma_f32 v127, v43, v11, v9
    v_mov_b32 v16, v202
    v_mov_b32 v17, v203
    v_mov_b32 v18, v204
    v_mov_b32 v19, v205
    v_mov_b32 v28, v197
    v_add_u32 v29, 4096, v197
    s_lshl_b32 s38, s18, 13
    s_add_u32 s50, s48, s38
    v_mov_b32 v32, 73728
    v_mov_b32 v33, 1
    v_bfe_u32 v59, v24, 1, 3
    v_xor_b32 v59, v59, v25
    v_lshlrev_b32 v59, 4, v59
    v_lshl_add_u32 v59, v26, 7, v59
    v_xor_b32 v20, 0, v59
    v_add_u32 v22, 0x10000, v20
    v_xor_b32 v21, 64, v59
    v_add_u32 v23, 0x10000, v21
    v_xor_b32 v30, s54, v26
    v_lshlrev_b32 v30, 8, v30
    v_mov_b32 v58, s93
    v_lshlrev_b32 v59, 2, v24
    s_lshl_b32 s52, s16, 12
    s_add_u32 s52, s52, 9502720
    s_lshl_b32 s46, s17, 8
    s_add_u32 s46, s46, s52
    s_mul_i32 s38, s18, 8704
    v_mul_u32_u24 v44, 272, v26
    v_lshl_add_u32 v44, v25, 4, v44
    v_add_u32 v44, s38, v44
    v_mul_u32_u24 v45, 272, v25
    v_lshl_add_u32 v45, v26, 4, v45
    v_add_u32 v45, s38, v45
    v_lshlrev_b32 v46, 12, v25
    v_lshl_add_u32 v46, v26, 4, v46
    v_lshlrev_b32 v47, 2, v24
    v_add_u32 v47, 73984, v47
    s_lshl_b32 s56, s51, 12
    s_lshl_b32 s39, s17, 8
    s_add_u32 s56, s56, s39
    s_sub_u32 s38, s20, s18
    s_mul_i32 s38, s38, 9216
    s_lshl_b32 s39, s19, 6
    s_add_u32 s38, s38, s39
    v_add_u32 v35, s38, v196
    s_waitcnt vmcnt(12)
    v_mov_b32 v57, 1
    s_mov_b64 exec, 1
    ds_add_rtn_u32 v57, v32, v57 offset:12
    s_mov_b64 exec, -1
    s_waitcnt lgkmcnt(0)
    v_readfirstlane_b32 s39, v57
    s_nop 1
    s_cmp_lg_u32 s39, 3
    s_cbranch_scc1 L_nohf
    s_mov_b32 exec_hi, 0
    buffer_store_dword v58, v59, s[12:15], s46 offen sc1
    s_mov_b32 exec_hi, -1
    s_waitcnt vmcnt(1)
    s_branch L_hfd
L_nohf:
    s_waitcnt vmcnt(0)
L_hfd:
    s_mov_b64 exec, 1
    ds_add_u32 v32, v33 offset:4
    s_mov_b64 exec, -1
    s_mov_b64 exec, 255
    buffer_load_dword v31, v30, s[12:15], s52 offen sc1
    s_mov_b64 exec, -1
L_sync0:
    ds_read_b32 v34, v32 offset:4
    s_waitcnt lgkmcnt(0)
    v_readfirstlane_b32 s38, v34
    s_nop 1
    s_cmp_ge_u32 s38, 4
    s_cbranch_scc1 L_sync0_ok
    s_sub_u32 s96, s96, 1
    s_cbranch_scc1 L_sync0_ok
    s_sleep 0
    s_branch L_sync0
L_sync0_ok:
    ds_read_b64_tr_b16 v[160:161], v35 offset:0
    ds_read_b64_tr_b16 v[162:163], v35 offset:576
    ds_read_b64_tr_b16 v[164:165], v35 offset:32
    ds_read_b64_tr_b16 v[166:167], v35 offset:608
    ds_read_b64_tr_b16 v[168:169], v35 offset:18432
    ds_read_b64_tr_b16 v[170:171], v35 offset:19008
    ds_read_b64_tr_b16 v[172:173], v35 offset:18464
    ds_read_b64_tr_b16 v[174:175], v35 offset:19040
    s_waitcnt lgkmcnt(4)
    ds_read_b64_tr_b16 v[176:177], v35 offset:4608
    ds_read_b64_tr_b16 v[178:179], v35 offset:5184
    ds_read_b64_tr_b16 v[180:181], v35 offset:4640
    ds_read_b64_tr_b16 v[182:183], v35 offset:5216
    ds_read_b64_tr_b16 v[184:185], v35 offset:23040
    ds_read_b64_tr_b16 v[186:187], v35 offset:23616
    ds_read_b64_tr_b16 v[188:189], v35 offset:23072
    ds_read_b64_tr_b16 v[190:191], v35 offset:23648
    s_mov_b64 exec, 1
    ds_add_u32 v32, v33 offset:72
    s_mov_b64 exec, -1
    s_waitcnt lgkmcnt(4)
    ds_read_b128 v[224:227], v22 offset:16384
    ds_read_b128 v[228:231], v22 offset:18432
    ds_read_b128 v[232:235], v22 offset:20480
    ds_read_b128 v[236:239], v22 offset:22528
    ds_read_b128 v[240:243], v23 offset:16384
    ds_read_b128 v[244:247], v23 offset:18432
    ds_read_b128 v[248:251], v23 offset:20480
    ds_read_b128 v[252:255], v23 offset:22528
    s_waitcnt lgkmcnt(4)
    v_mfma_f32_16x16x32_bf16 v[128:131], v[224:227], v[160:163], 0
    v_mfma_f32_16x16x32_bf16 v[132:135], v[228:231], v[160:163], 0
    v_mfma_f32_16x16x32_bf16 v[136:139], v[232:235], v[160:163], 0
    v_mfma_f32_16x16x32_bf16 v[140:143], v[236:239], v[160:163], 0
    v_mfma_f32_16x16x32_bf16 v[144:147], v[224:227], v[164:167], 0
    v_mfma_f32_16x16x32_bf16 v[148:151], v[228:231], v[164:167], 0
    v_mfma_f32_16x16x32_bf16 v[152:155], v[232:235], v[164:167], 0
    v_mfma_f32_16x16x32_bf16 v[156:159], v[236:239], v[164:167], 0
    ds_read_b128 v[224:227], v22 offset:24576
    ds_read_b128 v[228:231], v22 offset:26624
    ds_read_b128 v[232:235], v22 offset:28672
    ds_read_b128 v[236:239], v22 offset:30720
    s_waitcnt lgkmcnt(4)
    v_mfma_f32_16x16x32_bf16 v[128:131], v[240:243], v[168:171], v[128:131]
    v_mfma_f32_16x16x32_bf16 v[132:135], v[244:247], v[168:171], v[132:135]
    v_mfma_f32_16x16x32_bf16 v[136:139], v[248:251], v[168:171], v[136:139]
    v_mfma_f32_16x16x32_bf16 v[140:143], v[252:255], v[168:171], v[140:143]
    v_mfma_f32_16x16x32_bf16 v[144:147], v[240:243], v[172:175], v[144:147]
    v_mfma_f32_16x16x32_bf16 v[148:151], v[244:247], v[172:175], v[148:151]
    v_mfma_f32_16x16x32_bf16 v[152:155], v[248:251], v[172:175], v[152:155]
    v_mfma_f32_16x16x32_bf16 v[156:159], v[252:255], v[172:175], v[156:159]
    ds_read_b128 v[240:243], v23 offset:24576
    ds_read_b128 v[244:247], v23 offset:26624
    ds_read_b128 v[248:251], v23 offset:28672
    ds_read_b128 v[252:255], v23 offset:30720
    s_waitcnt lgkmcnt(4)
    v_mfma_f32_16x16x32_bf16 v[128:131], v[224:227], v[176:179], v[128:131]
    v_mfma_f32_16x16x32_bf16 v[132:135], v[228:231], v[176:179], v[132:135]
    v_mfma_f32_16x16x32_bf16 v[136:139], v[232:235], v[176:179], v[136:139]
    v_mfma_f32_16x16x32_bf16 v[140:143], v[236:239], v[176:179], v[140:143]
    v_mfma_f32_16x16x32_bf16 v[144:147], v[224:227], v[180:183], v[144:147]
    v_mfma_f32_16x16x32_bf16 v[148:151], v[228:231], v[180:183], v[148:151]
    v_mfma_f32_16x16x32_bf16 v[152:155], v[232:235], v[180:183], v[152:155]
    v_mfma_f32_16x16x32_bf16 v[156:159], v[236:239], v[180:183], v[156:159]
    ds_read_b128 v[224:227], v20 offset:0
    ds_read_b128 v[228:231], v20 offset:2048
    ds_read_b128 v[232:235], v20 offset:4096
    ds_read_b128 v[236:239], v20 offset:6144
    s_waitcnt lgkmcnt(4)
    v_mfma_f32_16x16x32_bf16 v[128:131], v[240:243], v[184:187], v[128:131]
    v_mfma_f32_16x16x32_bf16 v[132:135], v[244:247], v[184:187], v[132:135]
    v_mfma_f32_16x16x32_bf16 v[136:139], v[248:251], v[184:187], v[136:139]
    v_mfma_f32_16x16x32_bf16 v[140:143], v[252:255], v[184:187], v[140:143]
    v_mfma_f32_16x16x32_bf16 v[144:147], v[240:243], v[188:191], v[144:147]
    v_mfma_f32_16x16x32_bf16 v[148:151], v[244:247], v[188:191], v[148:151]
    v_mfma_f32_16x16x32_bf16 v[152:155], v[248:251], v[188:191], v[152:155]
    v_mfma_f32_16x16x32_bf16 v[156:159], v[252:255], v[188:191], v[156:159]
L_hpoll:
    s_waitcnt vmcnt(0)
    v_cmp_ne_u32 vcc, s93, v31
    s_nop 1
    s_and_b32 s38, vcc_lo, 255
    s_cbranch_scc0 L_hgo
    s_sub_u32 s96, s96, 1
    s_cbranch_scc1 L_hgo
    s_sleep 1
    s_mov_b64 exec, 255
    buffer_load_dword v31, v30, s[12:15], s52 offen sc1
    s_mov_b64 exec, -1
    s_branch L_hpoll
L_hgo:
    s_cmp_le_u32 s55, 0
    s_cselect_b32 s49, 1, 0
    s_or_b32 s49, s49, s54
    s_lshl_b32 s49, s49, 15
    s_add_u32 s49, s49, s50
    buffer_load_dwordx4 v[192:195], v28, s[12:15], s49 offen offset:0 sc1
    buffer_load_dwordx4 v[196:199], v28, s[12:15], s49 offen offset:1024 sc1
    buffer_load_dwordx4 v[200:203], v28, s[12:15], s49 offen offset:2048 sc1
    buffer_load_dwordx4 v[204:207], v28, s[12:15], s49 offen offset:3072 sc1
    buffer_load_dwordx4 v[208:211], v29, s[12:15], s49 offen offset:0 sc1
    buffer_load_dwordx4 v[212:215], v29, s[12:15], s49 offen offset:1024 sc1
    buffer_load_dwordx4 v[216:219], v29, s[12:15], s49 offen offset:2048 sc1
    buffer_load_dwordx4 v[220:223], v29, s[12:15], s49 offen offset:3072 sc1
L_sync1:
    ds_read_b32 v34, v32 offset:72
    s_waitcnt lgkmcnt(0)
    v_readfirstlane_b32 s38, v34
    s_nop 1
    s_cmp_ge_u32 s38, 4
    s_cbranch_scc1 L_sync1_ok
    s_sub_u32 s96, s96, 1
    s_cbranch_scc1 L_sync1_ok
    s_sleep 0
    s_branch L_sync1
L_sync1_ok:
    s_cmp_le_u32 s55, 1
    s_cselect_b32 s49, 2, 1
    s_or_b32 s49, s49, s54
    s_lshl_b32 s49, s49, 15
    s_add_u32 s49, s49, s50
    buffer_load_dwordx4 v[160:163], v28, s[12:15], s49 offen offset:0 sc1
    buffer_load_dwordx4 v[164:167], v28, s[12:15], s49 offen offset:1024 sc1
    buffer_load_dwordx4 v[168:171], v28, s[12:15], s49 offen offset:2048 sc1
    buffer_load_dwordx4 v[172:175], v28, s[12:15], s49 offen offset:3072 sc1
    buffer_load_dwordx4 v[176:179], v29, s[12:15], s49 offen offset:0 sc1
    buffer_load_dwordx4 v[180:183], v29, s[12:15], s49 offen offset:1024 sc1
    buffer_load_dwordx4 v[184:187], v29, s[12:15], s49 offen offset:2048 sc1
    buffer_load_dwordx4 v[188:191], v29, s[12:15], s49 offen offset:3072 sc1
    ds_read_b128 v[240:243], v21 offset:0
    ds_read_b128 v[244:247], v21 offset:2048
    ds_read_b128 v[248:251], v21 offset:4096
    ds_read_b128 v[252:255], v21 offset:6144
    s_waitcnt vmcnt(14) lgkmcnt(4)
    v_mfma_f32_16x16x32_bf16 v[128:131], v[224:227], v[192:195], v[128:131]
    v_mfma_f32_16x16x32_bf16 v[132:135], v[228:231], v[192:195], v[132:135]
    v_mfma_f32_16x16x32_bf16 v[136:139], v[232:235], v[192:195], v[136:139]
    v_mfma_f32_16x16x32_bf16 v[140:143], v[236:239], v[192:195], v[140:143]
    s_cmp_le_u32 s55, 2
    s_cselect_b32 s49, 3, 2
    s_or_b32 s49, s49, s54
    s_lshl_b32 s49, s49, 15
    s_add_u32 s49, s49, s50
    buffer_load_dwordx4 v[192:195], v28, s[12:15], s49 offen offset:0 sc1
    s_add_u32 m0, s23, 32768
    s_cmp_le_u32 s55, 2
    s_cselect_b32 s21, 3, 2
    s_or_b32 s21, s21, s54
    s_lshl_b32 s21, s21, 7
    buffer_load_dwordx4 v16, s[28:31], s21 offen offset:0  lds
    v_mfma_f32_16x16x32_bf16 v[144:147], v[224:227], v[196:199], v[144:147]
    v_mfma_f32_16x16x32_bf16 v[148:151], v[228:231], v[196:199], v[148:151]
    v_mfma_f32_16x16x32_bf16 v[152:155], v[232:235], v[196:199], v[152:155]
    v_mfma_f32_16x16x32_bf16 v[156:159], v[236:239], v[196:199], v[156:159]
    buffer_load_dwordx4 v[196:199], v28, s[12:15], s49 offen offset:1024 sc1
    buffer_load_dwordx4 v17, s[28:31], s21 offen offset:1024  lds
    ds_read_b128 v[224:227], v20 offset:8192
    ds_read_b128 v[228:231], v20 offset:10240
    ds_read_b128 v[232:235], v20 offset:12288
    ds_read_b128 v[236:239], v20 offset:14336
    s_waitcnt vmcnt(16) lgkmcnt(4)
    s_mov_b64 exec, 1
    ds_add_u32 v32, v33 offset:16
    s_mov_b64 exec, -1
    v_mfma_f32_16x16x32_bf16 v[128:131], v[240:243], v[200:203], v[128:131]
    v_mfma_f32_16x16x32_bf16 v[132:135], v[244:247], v[200:203], v[132:135]
    v_mfma_f32_16x16x32_bf16 v[136:139], v[248:251], v[200:203], v[136:139]
    v_mfma_f32_16x16x32_bf16 v[140:143], v[252:255], v[200:203], v[140:143]
    buffer_load_dwordx4 v[200:203], v28, s[12:15], s49 offen offset:2048 sc1
    buffer_load_dwordx4 v18, s[28:31], s21 offen offset:2048  lds
    v_mfma_f32_16x16x32_bf16 v[144:147], v[240:243], v[204:207], v[144:147]
    v_mfma_f32_16x16x32_bf16 v[148:151], v[244:247], v[204:207], v[148:151]
    v_mfma_f32_16x16x32_bf16 v[152:155], v[248:251], v[204:207], v[152:155]
    v_mfma_f32_16x16x32_bf16 v[156:159], v[252:255], v[204:207], v[156:159]
    buffer_load_dwordx4 v[204:207], v28, s[12:15], s49 offen offset:3072 sc1
    buffer_load_dwordx4 v19, s[28:31], s21 offen offset:3072  lds
    ds_read_b128 v[240:243], v21 offset:8192
    ds_read_b128 v[244:247], v21 offset:10240
    ds_read_b128 v[248:251], v21 offset:12288
    ds_read_b128 v[252:255], v21 offset:14336
    s_waitcnt vmcnt(18) lgkmcnt(4)
    v_mfma_f32_16x16x32_bf16 v[128:131], v[224:227], v[208:211], v[128:131]
    v_mfma_f32_16x16x32_bf16 v[132:135], v[228:231], v[208:211], v[132:135]
    v_mfma_f32_16x16x32_bf16 v[136:139], v[232:235], v[208:211], v[136:139]
    v_mfma_f32_16x16x32_bf16 v[140:143], v[236:239], v[208:211], v[140:143]
    ds_read_b32 v34, v32 offset:16
    buffer_load_dwordx4 v[208:211], v29, s[12:15], s49 offen offset:0 sc1
    s_add_u32 m0, s23, 49152
    s_cmp_le_u32 s55, 3
    s_cselect_b32 s21, 4, 3
    s_or_b32 s21, s21, s54
    s_lshl_b32 s21, s21, 7
    buffer_load_dwordx4 v16, s[28:31], s21 offen offset:0  lds
    v_mfma_f32_16x16x32_bf16 v[144:147], v[224:227], v[212:215], v[144:147]
    v_mfma_f32_16x16x32_bf16 v[148:151], v[228:231], v[212:215], v[148:151]
    v_mfma_f32_16x16x32_bf16 v[152:155], v[232:235], v[212:215], v[152:155]
    v_mfma_f32_16x16x32_bf16 v[156:159], v[236:239], v[212:215], v[156:159]
    buffer_load_dwordx4 v[212:215], v29, s[12:15], s49 offen offset:1024 sc1
    s_waitcnt lgkmcnt(0)
    v_readfirstlane_b32 s38, v34
    s_nop 1
    s_cmp_ge_u32 s38, 4
    s_cbranch_scc1 L_st1_ok
L_st1:
    ds_read_b32 v34, v32 offset:16
    s_waitcnt lgkmcnt(0)
    v_readfirstlane_b32 s38, v34
    s_nop 1
    s_cmp_ge_u32 s38, 4
    s_cbranch_scc1 L_st1_ok
    s_sub_u32 s96, s96, 1
    s_cbranch_scc1 L_st1_ok
    s_sleep 0
    s_branch L_st1
L_st1_ok:
    ds_read_b128 v[224:227], v20 offset:16384
    ds_read_b128 v[228:231], v20 offset:18432
    ds_read_b128 v[232:235], v20 offset:20480
    ds_read_b128 v[236:239], v20 offset:22528
    s_waitcnt vmcnt(19)
    v_mfma_f32_16x16x32_bf16 v[128:131], v[240:243], v[216:219], v[128:131]
    v_mfma_f32_16x16x32_bf16 v[132:135], v[244:247], v[216:219], v[132:135]
    v_mfma_f32_16x16x32_bf16 v[136:139], v[248:251], v[216:219], v[136:139]
    v_mfma_f32_16x16x32_bf16 v[140:143], v[252:255], v[216:219], v[140:143]
    buffer_load_dwordx4 v[216:219], v29, s[12:15], s49 offen offset:2048 sc1
    buffer_load_dwordx4 v17, s[28:31], s21 offen offset:1024  lds
    v_mfma_f32_16x16x32_bf16 v[144:147], v[240:243], v[220:223], v[144:147]
    v_mfma_f32_16x16x32_bf16 v[148:151], v[244:247], v[220:223], v[148:151]
    v_mfma_f32_16x16x32_bf16 v[152:155], v[248:251], v[220:223], v[152:155]
    v_mfma_f32_16x16x32_bf16 v[156:159], v[252:255], v[220:223], v[156:159]
    buffer_load_dwordx4 v[220:223], v29, s[12:15], s49 offen offset:3072 sc1
    buffer_load_dwordx4 v18, s[28:31], s21 offen offset:2048  lds
    ds_read_b128 v[240:243], v21 offset:16384
    ds_read_b128 v[244:247], v21 offset:18432
    ds_read_b128 v[248:251], v21 offset:20480
    ds_read_b128 v[252:255], v21 offset:22528
    s_waitcnt vmcnt(21) lgkmcnt(4)
    v_mfma_f32_16x16x32_bf16 v[128:131], v[224:227], v[160:163], v[128:131]
    v_mfma_f32_16x16x32_bf16 v[132:135], v[228:231], v[160:163], v[132:135]
    v_mfma_f32_16x16x32_bf16 v[136:139], v[232:235], v[160:163], v[136:139]
    v_mfma_f32_16x16x32_bf16 v[140:143], v[236:239], v[160:163], v[140:143]
    s_cmp_le_u32 s55, 3
    s_cselect_b32 s49, 4, 3
    s_or_b32 s49, s49, s54
    s_lshl_b32 s49, s49, 15
    s_add_u32 s49, s49, s50
    buffer_load_dwordx4 v[160:163], v28, s[12:15], s49 offen offset:0 sc1
    buffer_load_dwordx4 v19, s[28:31], s21 offen offset:3072  lds
    v_mfma_f32_16x16x32_bf16 v[144:147], v[224:227], v[164:167], v[144:147]
    v_mfma_f32_16x16x32_bf16 v[148:151], v[228:231], v[164:167], v[148:151]
    v_mfma_f32_16x16x32_bf16 v[152:155], v[232:235], v[164:167], v[152:155]
    v_mfma_f32_16x16x32_bf16 v[156:159], v[236:239], v[164:167], v[156:159]
    buffer_load_dwordx4 v[164:167], v28, s[12:15], s49 offen offset:1024 sc1
    ds_read_b128 v[224:227], v20 offset:24576
    ds_read_b128 v[228:231], v20 offset:26624
    ds_read_b128 v[232:235], v20 offset:28672
    ds_read_b128 v[236:239], v20 offset:30720
    s_waitcnt vmcnt(10) lgkmcnt(4)
    s_mov_b64 exec, 1
    ds_add_u32 v32, v33 offset:16
    s_mov_b64 exec, -1
    v_mfma_f32_16x16x32_bf16 v[128:131], v[240:243], v[168:171], v[128:131]
    v_mfma_f32_16x16x32_bf16 v[132:135], v[244:247], v[168:171], v[132:135]
    v_mfma_f32_16x16x32_bf16 v[136:139], v[248:251], v[168:171], v[136:139]
    v_mfma_f32_16x16x32_bf16 v[140:143], v[252:255], v[168:171], v[140:143]
    buffer_load_dwordx4 v[168:171], v28, s[12:15], s49 offen offset:2048 sc1
    s_add_u32 m0, s23, 81920
    s_cmp_le_u32 s55, 4
    s_cselect_b32 s21, 5, 4
    s_or_b32 s21, s21, s54
    s_lshl_b32 s21, s21, 7
    buffer_load_dwordx4 v16, s[28:31], s21 offen offset:0  lds
    v_mfma_f32_16x16x32_bf16 v[144:147], v[240:243], v[172:175], v[144:147]
    v_mfma_f32_16x16x32_bf16 v[148:151], v[244:247], v[172:175], v[148:151]
    v_mfma_f32_16x16x32_bf16 v[152:155], v[248:251], v[172:175], v[152:155]
    v_mfma_f32_16x16x32_bf16 v[156:159], v[252:255], v[172:175], v[156:159]
    buffer_load_dwordx4 v[172:175], v28, s[12:15], s49 offen offset:3072 sc1
    ds_read_b128 v[240:243], v21 offset:24576
    ds_read_b128 v[244:247], v21 offset:26624
    ds_read_b128 v[248:251], v21 offset:28672
    ds_read_b128 v[252:255], v21 offset:30720
    s_waitcnt vmcnt(23) lgkmcnt(4)
    v_mfma_f32_16x16x32_bf16 v[128:131], v[224:227], v[176:179], v[128:131]
    v_mfma_f32_16x16x32_bf16 v[132:135], v[228:231], v[176:179], v[132:135]
    v_mfma_f32_16x16x32_bf16 v[136:139], v[232:235], v[176:179], v[136:139]
    v_mfma_f32_16x16x32_bf16 v[140:143], v[236:239], v[176:179], v[140:143]
    ds_read_b32 v34, v32 offset:16
    buffer_load_dwordx4 v[176:179], v29, s[12:15], s49 offen offset:0 sc1
    buffer_load_dwordx4 v17, s[28:31], s21 offen offset:1024  lds
    v_mfma_f32_16x16x32_bf16 v[144:147], v[224:227], v[180:183], v[144:147]
    v_mfma_f32_16x16x32_bf16 v[148:151], v[228:231], v[180:183], v[148:151]
    v_mfma_f32_16x16x32_bf16 v[152:155], v[232:235], v[180:183], v[152:155]
    v_mfma_f32_16x16x32_bf16 v[156:159], v[236:239], v[180:183], v[156:159]
    buffer_load_dwordx4 v[180:183], v29, s[12:15], s49 offen offset:1024 sc1
    s_waitcnt lgkmcnt(0)
    v_readfirstlane_b32 s38, v34
    s_nop 1
    s_cmp_ge_u32 s38, 8
    s_cbranch_scc1 L_st2_ok
L_st2:
    ds_read_b32 v34, v32 offset:16
    s_waitcnt lgkmcnt(0)
    v_readfirstlane_b32 s38, v34
    s_nop 1
    s_cmp_ge_u32 s38, 8
    s_cbranch_scc1 L_st2_ok
    s_sub_u32 s96, s96, 1
    s_cbranch_scc1 L_st2_ok
    s_sleep 0
    s_branch L_st2
L_st2_ok:
    ds_read_b128 v[224:227], v20 offset:32768
    ds_read_b128 v[228:231], v20 offset:34816
    ds_read_b128 v[232:235], v20 offset:36864
    ds_read_b128 v[236:239], v20 offset:38912
    s_waitcnt vmcnt(24)
    v_mfma_f32_16x16x32_bf16 v[128:131], v[240:243], v[184:187], v[128:131]
    v_mfma_f32_16x16x32_bf16 v[132:135], v[244:247], v[184:187], v[132:135]
    v_mfma_f32_16x16x32_bf16 v[136:139], v[248:251], v[184:187], v[136:139]
    v_mfma_f32_16x16x32_bf16 v[140:143], v[252:255], v[184:187], v[140:143]
    buffer_load_dwordx4 v[184:187], v29, s[12:15], s49 offen offset:2048 sc1
    buffer_load_dwordx4 v18, s[28:31], s21 offen offset:2048  lds
    v_mfma_f32_16x16x32_bf16 v[144:147], v[240:243], v[188:191], v[144:147]
    v_mfma_f32_16x16x32_bf16 v[148:151], v[244:247], v[188:191], v[148:151]
    v_mfma_f32_16x16x32_bf16 v[152:155], v[248:251], v[188:191], v[152:155]
    v_mfma_f32_16x16x32_bf16 v[156:159], v[252:255], v[188:191], v[156:159]
    buffer_load_dwordx4 v[188:191], v29, s[12:15], s49 offen offset:3072 sc1
    buffer_load_dwordx4 v19, s[28:31], s21 offen offset:3072  lds
    ds_read_b128 v[240:243], v21 offset:32768
    ds_read_b128 v[244:247], v21 offset:34816
    ds_read_b128 v[248:251], v21 offset:36864
    ds_read_b128 v[252:255], v21 offset:38912
    s_waitcnt vmcnt(25) lgkmcnt(4)
    v_mfma_f32_16x16x32_bf16 v[128:131], v[224:227], v[192:195], v[128:131]
    v_mfma_f32_16x16x32_bf16 v[132:135], v[228:231], v[192:195], v[132:135]
    v_mfma_f32_16x16x32_bf16 v[136:139], v[232:235], v[192:195], v[136:139]
    v_mfma_f32_16x16x32_bf16 v[140:143], v[236:239], v[192:195], v[140:143]
    s_cmp_le_u32 s55, 4
    s_cselect_b32 s49, 5, 4
    s_or_b32 s49, s49, s54
    s_lshl_b32 s49, s49, 15
    s_add_u32 s49, s49, s50
    buffer_load_dwordx4 v[192:195], v28, s[12:15], s49 offen offset:0 sc1
    s_add_u32 m0, s23, 0
    s_cmp_le_u32 s55, 5
    s_cselect_b32 s21, 6, 5
    s_or_b32 s21, s21, s54
    s_lshl_b32 s21, s21, 7
    buffer_load_dwordx4 v16, s[28:31], s21 offen offset:0  lds
    v_mfma_f32_16x16x32_bf16 v[144:147], v[224:227], v[196:199], v[144:147]
    v_mfma_f32_16x16x32_bf16 v[148:151], v[228:231], v[196:199], v[148:151]
    v_mfma_f32_16x16x32_bf16 v[152:155], v[232:235], v[196:199], v[152:155]
    v_mfma_f32_16x16x32_bf16 v[156:159], v[236:239], v[196:199], v[156:159]
    buffer_load_dwordx4 v[196:199], v28, s[12:15], s49 offen offset:1024 sc1
    ds_read_b128 v[224:227], v20 offset:40960
    ds_read_b128 v[228:231], v20 offset:43008
    ds_read_b128 v[232:235], v20 offset:45056
    ds_read_b128 v[236:239], v20 offset:47104
    s_waitcnt vmcnt(14) lgkmcnt(4)
    s_mov_b64 exec, 1
    ds_add_u32 v32, v33 offset:16
    s_mov_b64 exec, -1
    v_mfma_f32_16x16x32_bf16 v[128:131], v[240:243], v[200:203], v[128:131]
    v_mfma_f32_16x16x32_bf16 v[132:135], v[244:247], v[200:203], v[132:135]
    v_mfma_f32_16x16x32_bf16 v[136:139], v[248:251], v[200:203], v[136:139]
    v_mfma_f32_16x16x32_bf16 v[140:143], v[252:255], v[200:203], v[140:143]
    buffer_load_dwordx4 v[200:203], v28, s[12:15], s49 offen offset:2048 sc1
    buffer_load_dwordx4 v17, s[28:31], s21 offen offset:1024  lds
    v_mfma_f32_16x16x32_bf16 v[144:147], v[240:243], v[204:207], v[144:147]
    v_mfma_f32_16x16x32_bf16 v[148:151], v[244:247], v[204:207], v[148:151]
    v_mfma_f32_16x16x32_bf16 v[152:155], v[248:251], v[204:207], v[152:155]
    v_mfma_f32_16x16x32_bf16 v[156:159], v[252:255], v[204:207], v[156:159]
    buffer_load_dwordx4 v[204:207], v28, s[12:15], s49 offen offset:3072 sc1
    ds_read_b128 v[240:243], v21 offset:40960
    ds_read_b128 v[244:247], v21 offset:43008
    ds_read_b128 v[248:251], v21 offset:45056
    ds_read_b128 v[252:255], v21 offset:47104
    s_waitcnt vmcnt(23) lgkmcnt(4)
    v_mfma_f32_16x16x32_bf16 v[128:131], v[224:227], v[208:211], v[128:131]
    v_mfma_f32_16x16x32_bf16 v[132:135], v[228:231], v[208:211], v[132:135]
    v_mfma_f32_16x16x32_bf16 v[136:139], v[232:235], v[208:211], v[136:139]
    v_mfma_f32_16x16x32_bf16 v[140:143], v[236:239], v[208:211], v[140:143]
    ds_read_b32 v34, v32 offset:16
    buffer_load_dwordx4 v[208:211], v29, s[12:15], s49 offen offset:0 sc1
    buffer_load_dwordx4 v18, s[28:31], s21 offen offset:2048  lds
    v_mfma_f32_16x16x32_bf16 v[144:147], v[224:227], v[212:215], v[144:147]
    v_mfma_f32_16x16x32_bf16 v[148:151], v[228:231], v[212:215], v[148:151]
    v_mfma_f32_16x16x32_bf16 v[152:155], v[232:235], v[212:215], v[152:155]
    v_mfma_f32_16x16x32_bf16 v[156:159], v[236:239], v[212:215], v[156:159]
    buffer_load_dwordx4 v[212:215], v29, s[12:15], s49 offen offset:1024 sc1
    s_waitcnt lgkmcnt(0)
    v_readfirstlane_b32 s38, v34
    s_nop 1
    s_cmp_ge_u32 s38, 12
    s_cbranch_scc1 L_st3_ok
L_st3:
    ds_read_b32 v34, v32 offset:16
    s_waitcnt lgkmcnt(0)
    v_readfirstlane_b32 s38, v34
    s_nop 1
    s_cmp_ge_u32 s38, 12
    s_cbranch_scc1 L_st3_ok
    s_sub_u32 s96, s96, 1
    s_cbranch_scc1 L_st3_ok
    s_sleep 0
    s_branch L_st3
L_st3_ok:
    ds_read_b128 v[224:227], v20 offset:49152
    ds_read_b128 v[228:231], v20 offset:51200
    ds_read_b128 v[232:235], v20 offset:53248
    ds_read_b128 v[236:239], v20 offset:55296
    s_waitcnt vmcnt(23)
    v_mfma_f32_16x16x32_bf16 v[128:131], v[240:243], v[216:219], v[128:131]
    v_mfma_f32_16x16x32_bf16 v[132:135], v[244:247], v[216:219], v[132:135]
    v_mfma_f32_16x16x32_bf16 v[136:139], v[248:251], v[216:219], v[136:139]
    v_mfma_f32_16x16x32_bf16 v[140:143], v[252:255], v[216:219], v[140:143]
    buffer_load_dwordx4 v[216:219], v29, s[12:15], s49 offen offset:2048 sc1
    buffer_load_dwordx4 v19, s[28:31], s21 offen offset:3072  lds
    v_mfma_f32_16x16x32_bf16 v[144:147], v[240:243], v[220:223], v[144:147]
    v_mfma_f32_16x16x32_bf16 v[148:151], v[244:247], v[220:223], v[148:151]
    v_mfma_f32_16x16x32_bf16 v[152:155], v[248:251], v[220:223], v[152:155]
    v_mfma_f32_16x16x32_bf16 v[156:159], v[252:255], v[220:223], v[156:159]
    buffer_load_dwordx4 v[220:223], v29, s[12:15], s49 offen offset:3072 sc1
    ds_read_b128 v[240:243], v21 offset:49152
    ds_read_b128 v[244:247], v21 offset:51200
    ds_read_b128 v[248:251], v21 offset:53248
    ds_read_b128 v[252:255], v21 offset:55296
    s_waitcnt vmcnt(22) lgkmcnt(4)
    v_mfma_f32_16x16x32_bf16 v[128:131], v[224:227], v[160:163], v[128:131]
    v_mfma_f32_16x16x32_bf16 v[132:135], v[228:231], v[160:163], v[132:135]
    v_mfma_f32_16x16x32_bf16 v[136:139], v[232:235], v[160:163], v[136:139]
    v_mfma_f32_16x16x32_bf16 v[140:143], v[236:239], v[160:163], v[140:143]
    s_cmp_le_u32 s55, 5
    s_cselect_b32 s49, 6, 5
    s_or_b32 s49, s49, s54
    s_lshl_b32 s49, s49, 15
    s_add_u32 s49, s49, s50
    buffer_load_dwordx4 v[160:163], v28, s[12:15], s49 offen offset:0 sc1
    s_add_u32 m0, s23, 16384
    s_cmp_le_u32 s55, 6
    s_cselect_b32 s21, 7, 6
    s_or_b32 s21, s21, s54
    s_lshl_b32 s21, s21, 7
    buffer_load_dwordx4 v16, s[28:31], s21 offen offset:0  lds
    v_mfma_f32_16x16x32_bf16 v[144:147], v[224:227], v[164:167], v[144:147]
    v_mfma_f32_16x16x32_bf16 v[148:151], v[228:231], v[164:167], v[148:151]
    v_mfma_f32_16x16x32_bf16 v[152:155], v[232:235], v[164:167], v[152:155]
    v_mfma_f32_16x16x32_bf16 v[156:159], v[236:239], v[164:167], v[156:159]
    buffer_load_dwordx4 v[164:167], v28, s[12:15], s49 offen offset:1024 sc1
    ds_read_b128 v[224:227], v20 offset:57344
    ds_read_b128 v[228:231], v20 offset:59392
    ds_read_b128 v[232:235], v20 offset:61440
    ds_read_b128 v[236:239], v20 offset:63488
    s_waitcnt vmcnt(15) lgkmcnt(4)
    s_mov_b64 exec, 1
    ds_add_u32 v32, v33 offset:16
    s_mov_b64 exec, -1
    v_mfma_f32_16x16x32_bf16 v[128:131], v[240:243], v[168:171], v[128:131]
    v_mfma_f32_16x16x32_bf16 v[132:135], v[244:247], v[168:171], v[132:135]
    v_mfma_f32_16x16x32_bf16 v[136:139], v[248:251], v[168:171], v[136:139]
    v_mfma_f32_16x16x32_bf16 v[140:143], v[252:255], v[168:171], v[140:143]
    buffer_load_dwordx4 v[168:171], v28, s[12:15], s49 offen offset:2048 sc1
    buffer_load_dwordx4 v17, s[28:31], s21 offen offset:1024  lds
    v_mfma_f32_16x16x32_bf16 v[144:147], v[240:243], v[172:175], v[144:147]
    v_mfma_f32_16x16x32_bf16 v[148:151], v[244:247], v[172:175], v[148:151]
    v_mfma_f32_16x16x32_bf16 v[152:155], v[248:251], v[172:175], v[152:155]
    v_mfma_f32_16x16x32_bf16 v[156:159], v[252:255], v[172:175], v[156:159]
    buffer_load_dwordx4 v[172:175], v28, s[12:15], s49 offen offset:3072 sc1
    ds_read_b128 v[240:243], v21 offset:57344
    ds_read_b128 v[244:247], v21 offset:59392
    ds_read_b128 v[248:251], v21 offset:61440
    ds_read_b128 v[252:255], v21 offset:63488
    s_waitcnt vmcnt(22) lgkmcnt(4)
    v_mfma_f32_16x16x32_bf16 v[128:131], v[224:227], v[176:179], v[128:131]
    v_mfma_f32_16x16x32_bf16 v[132:135], v[228:231], v[176:179], v[132:135]
    v_mfma_f32_16x16x32_bf16 v[136:139], v[232:235], v[176:179], v[136:139]
    v_mfma_f32_16x16x32_bf16 v[140:143], v[236:239], v[176:179], v[140:143]
    ds_read_b32 v34, v32 offset:16
    buffer_load_dwordx4 v[176:179], v29, s[12:15], s49 offen offset:0 sc1
    buffer_load_dwordx4 v18, s[28:31], s21 offen offset:2048  lds
    v_mfma_f32_16x16x32_bf16 v[144:147], v[224:227], v[180:183], v[144:147]
    v_mfma_f32_16x16x32_bf16 v[148:151], v[228:231], v[180:183], v[148:151]
    v_mfma_f32_16x16x32_bf16 v[152:155], v[232:235], v[180:183], v[152:155]
    v_mfma_f32_16x16x32_bf16 v[156:159], v[236:239], v[180:183], v[156:159]
    buffer_load_dwordx4 v[180:183], v29, s[12:15], s49 offen offset:1024 sc1
    s_waitcnt lgkmcnt(0)
    v_readfirstlane_b32 s38, v34
    s_nop 1
    s_cmp_ge_u32 s38, 16
    s_cbranch_scc1 L_st4_ok
L_st4:
    ds_read_b32 v34, v32 offset:16
    s_waitcnt lgkmcnt(0)
    v_readfirstlane_b32 s38, v34
    s_nop 1
    s_cmp_ge_u32 s38, 16
    s_cbranch_scc1 L_st4_ok
    s_sub_u32 s96, s96, 1
    s_cbranch_scc1 L_st4_ok
    s_sleep 0
    s_branch L_st4
L_st4_ok:
    ds_read_b128 v[224:227], v22 offset:16384
    ds_read_b128 v[228:231], v22 offset:18432
    ds_read_b128 v[232:235], v22 offset:20480
    ds_read_b128 v[236:239], v22 offset:22528
    s_waitcnt vmcnt(22)
    v_mfma_f32_16x16x32_bf16 v[128:131], v[240:243], v[184:187], v[128:131]
    v_mfma_f32_16x16x32_bf16 v[132:135], v[244:247], v[184:187], v[132:135]
    v_mfma_f32_16x16x32_bf16 v[136:139], v[248:251], v[184:187], v[136:139]
    v_mfma_f32_16x16x32_bf16 v[140:143], v[252:255], v[184:187], v[140:143]
    buffer_load_dwordx4 v[184:187], v29, s[12:15], s49 offen offset:2048 sc1
    buffer_load_dwordx4 v19, s[28:31], s21 offen offset:3072  lds
    v_mfma_f32_16x16x32_bf16 v[144:147], v[240:243], v[188:191], v[144:147]
    v_mfma_f32_16x16x32_bf16 v[148:151], v[244:247], v[188:191], v[148:151]
    v_mfma_f32_16x16x32_bf16 v[152:155], v[248:251], v[188:191], v[152:155]
    v_mfma_f32_16x16x32_bf16 v[156:159], v[252:255], v[188:191], v[156:159]
    buffer_load_dwordx4 v[188:191], v29, s[12:15], s49 offen offset:3072 sc1
    ds_read_b128 v[240:243], v23 offset:16384
    ds_read_b128 v[244:247], v23 offset:18432
    ds_read_b128 v[248:251], v23 offset:20480
    ds_read_b128 v[252:255], v23 offset:22528
    s_waitcnt vmcnt(21) lgkmcnt(4)
    v_mfma_f32_16x16x32_bf16 v[128:131], v[224:227], v[192:195], v[128:131]
    v_mfma_f32_16x16x32_bf16 v[132:135], v[228:231], v[192:195], v[132:135]
    v_mfma_f32_16x16x32_bf16 v[136:139], v[232:235], v[192:195], v[136:139]
    v_mfma_f32_16x16x32_bf16 v[140:143], v[236:239], v[192:195], v[140:143]
    s_cmp_le_u32 s55, 6
    s_cselect_b32 s49, 7, 6
    s_or_b32 s49, s49, s54
    s_lshl_b32 s49, s49, 15
    s_add_u32 s49, s49, s50
    buffer_load_dwordx4 v[192:195], v28, s[12:15], s49 offen offset:0 sc1
    s_add_u32 m0, s23, 32768
    s_xor_b32 s21, s54, 8
    s_lshl_b32 s21, s21, 7
    buffer_load_dwordx4 v16, s[28:31], s21 offen offset:0  lds
    v_mfma_f32_16x16x32_bf16 v[144:147], v[224:227], v[196:199], v[144:147]
    v_mfma_f32_16x16x32_bf16 v[148:151], v[228:231], v[196:199], v[148:151]
    v_mfma_f32_16x16x32_bf16 v[152:155], v[232:235], v[196:199], v[152:155]
    v_mfma_f32_16x16x32_bf16 v[156:159], v[236:239], v[196:199], v[156:159]
    buffer_load_dwordx4 v[196:199], v28, s[12:15], s49 offen offset:1024 sc1
    s_mov_b64 exec, 0xff00
    buffer_load_dword v31, v30, s[12:15], s52 offen sc1
    s_mov_b64 exec, -1
    ds_read_b128 v[224:227], v22 offset:24576
    ds_read_b128 v[228:231], v22 offset:26624
    ds_read_b128 v[232:235], v22 offset:28672
    ds_read_b128 v[236:239], v22 offset:30720
    s_waitcnt vmcnt(17) lgkmcnt(4)
    s_mov_b64 exec, 1
    ds_add_u32 v32, v33 offset:16
    s_mov_b64 exec, -1
    v_mfma_f32_16x16x32_bf16 v[128:131], v[240:243], v[200:203], v[128:131]
    v_mfma_f32_16x16x32_bf16 v[132:135], v[244:247], v[200:203], v[132:135]
    v_mfma_f32_16x16x32_bf16 v[136:139], v[248:251], v[200:203], v[136:139]
    v_mfma_f32_16x16x32_bf16 v[140:143], v[252:255], v[200:203], v[140:143]
    buffer_load_dwordx4 v[200:203], v28, s[12:15], s49 offen offset:2048 sc1
    buffer_load_dwordx4 v17, s[28:31], s21 offen offset:1024  lds
    v_mfma_f32_16x16x32_bf16 v[144:147], v[240:243], v[204:207], v[144:147]
    v_mfma_f32_16x16x32_bf16 v[148:151], v[244:247], v[204:207], v[148:151]
    v_mfma_f32_16x16x32_bf16 v[152:155], v[248:251], v[204:207], v[152:155]
    v_mfma_f32_16x16x32_bf16 v[156:159], v[252:255], v[204:207], v[156:159]
    buffer_load_dwordx4 v[204:207], v28, s[12:15], s49 offen offset:3072 sc1
    ds_read_b128 v[240:243], v23 offset:24576
    ds_read_b128 v[244:247], v23 offset:26624
    ds_read_b128 v[248:251], v23 offset:28672
    ds_read_b128 v[252:255], v23 offset:30720
    s_waitcnt vmcnt(22) lgkmcnt(4)
    v_mfma_f32_16x16x32_bf16 v[128:131], v[224:227], v[208:211], v[128:131]
    v_mfma_f32_16x16x32_bf16 v[132:135], v[228:231], v[208:211], v[132:135]
    v_mfma_f32_16x16x32_bf16 v[136:139], v[232:235], v[208:211], v[136:139]
    v_mfma_f32_16x16x32_bf16 v[140:143], v[236:239], v[208:211], v[140:143]
    ds_read_b32 v34, v32 offset:16
    buffer_load_dwordx4 v[208:211], v29, s[12:15], s49 offen offset:0 sc1
    buffer_load_dwordx4 v18, s[28:31], s21 offen offset:2048  lds
    v_mfma_f32_16x16x32_bf16 v[144:147], v[224:227], v[212:215], v[144:147]
    v_mfma_f32_16x16x32_bf16 v[148:151], v[228:231], v[212:215], v[148:151]
    v_mfma_f32_16x16x32_bf16 v[152:155], v[232:235], v[212:215], v[152:155]
    v_mfma_f32_16x16x32_bf16 v[156:159], v[236:239], v[212:215], v[156:159]
    buffer_load_dwordx4 v[212:215], v29, s[12:15], s49 offen offset:1024 sc1
    s_waitcnt lgkmcnt(0)
    v_readfirstlane_b32 s38, v34
    s_nop 1
    s_cmp_ge_u32 s38, 20
    s_cbranch_scc1 L_st5_ok
L_st5:
    ds_read_b32 v34, v32 offset:16
    s_waitcnt lgkmcnt(0)
    v_readfirstlane_b32 s38, v34
    s_nop 1
    s_cmp_ge_u32 s38, 20
    s_cbranch_scc1 L_st5_ok
    s_sub_u32 s96, s96, 1
    s_cbranch_scc1 L_st5_ok
    s_sleep 0
    s_branch L_st5
L_st5_ok:
    ds_read_b128 v[224:227], v20 offset:0
    ds_read_b128 v[228:231], v20 offset:2048
    ds_read_b128 v[232:235], v20 offset:4096
    ds_read_b128 v[236:239], v20 offset:6144
    s_waitcnt vmcnt(22)
    v_mfma_f32_16x16x32_bf16 v[128:131], v[240:243], v[216:219], v[128:131]
    v_mfma_f32_16x16x32_bf16 v[132:135], v[244:247], v[216:219], v[132:135]
    v_mfma_f32_16x16x32_bf16 v[136:139], v[248:251], v[216:219], v[136:139]
    v_mfma_f32_16x16x32_bf16 v[140:143], v[252:255], v[216:219], v[140:143]
    buffer_load_dwordx4 v[216:219], v29, s[12:15], s49 offen offset:2048 sc1
    buffer_load_dwordx4 v19, s[28:31], s21 offen offset:3072  lds
    v_mfma_f32_16x16x32_bf16 v[144:147], v[240:243], v[220:223], v[144:147]
    v_mfma_f32_16x16x32_bf16 v[148:151], v[244:247], v[220:223], v[148:151]
    v_mfma_f32_16x16x32_bf16 v[152:155], v[248:251], v[220:223], v[152:155]
    v_mfma_f32_16x16x32_bf16 v[156:159], v[252:255], v[220:223], v[156:159]
    buffer_load_dwordx4 v[220:223], v29, s[12:15], s49 offen offset:3072 sc1
    s_waitcnt vmcnt(9)
L_h2poll:
    v_cmp_ne_u32 vcc, s93, v31
    s_nop 1
    s_and_b32 s38, vcc_lo, 0xff00
    s_cbranch_scc0 L_h2go
    s_sub_u32 s96, s96, 1
    s_cbranch_scc1 L_h2go
    s_sleep 2
    s_mov_b64 exec, 0xff00
    buffer_load_dword v31, v30, s[12:15], s52 offen sc1
    s_mov_b64 exec, -1
    s_waitcnt vmcnt(0)
    s_branch L_h2poll
L_h2go:
    ds_read_b128 v[240:243], v21 offset:0
    ds_read_b128 v[244:247], v21 offset:2048
    ds_read_b128 v[248:251], v21 offset:4096
    ds_read_b128 v[252:255], v21 offset:6144
    s_waitcnt vmcnt(22) lgkmcnt(4)
    v_mfma_f32_16x16x32_bf16 v[128:131], v[224:227], v[160:163], v[128:131]
    v_mfma_f32_16x16x32_bf16 v[132:135], v[228:231], v[160:163], v[132:135]
    v_mfma_f32_16x16x32_bf16 v[136:139], v[232:235], v[160:163], v[136:139]
    v_mfma_f32_16x16x32_bf16 v[140:143], v[236:239], v[160:163], v[140:143]
    s_xor_b32 s49, s54, 8
    s_lshl_b32 s49, s49, 15
    s_add_u32 s49, s49, s50
    buffer_load_dwordx4 v[160:163], v28, s[12:15], s49 offen offset:0 sc1
    s_add_u32 m0, s23, 49152
    s_xor_b32 s21, s54, 9
    s_lshl_b32 s21, s21, 7
    buffer_load_dwordx4 v16, s[28:31], s21 offen offset:0  lds
    v_mfma_f32_16x16x32_bf16 v[144:147], v[224:227], v[164:167], v[144:147]
    v_mfma_f32_16x16x32_bf16 v[148:151], v[228:231], v[164:167], v[148:151]
    v_mfma_f32_16x16x32_bf16 v[152:155], v[232:235], v[164:167], v[152:155]
    v_mfma_f32_16x16x32_bf16 v[156:159], v[236:239], v[164:167], v[156:159]
    buffer_load_dwordx4 v[164:167], v28, s[12:15], s49 offen offset:1024 sc1
    ds_read_b128 v[224:227], v20 offset:8192
    ds_read_b128 v[228:231], v20 offset:10240
    ds_read_b128 v[232:235], v20 offset:12288
    ds_read_b128 v[236:239], v20 offset:14336
    s_waitcnt vmcnt(17) lgkmcnt(4)
    s_mov_b64 exec, 1
    ds_add_u32 v32, v33 offset:16
    s_mov_b64 exec, -1
    v_mfma_f32_16x16x32_bf16 v[128:131], v[240:243], v[168:171], v[128:131]
    v_mfma_f32_16x16x32_bf16 v[132:135], v[244:247], v[168:171], v[132:135]
    v_mfma_f32_16x16x32_bf16 v[136:139], v[248:251], v[168:171], v[136:139]
    v_mfma_f32_16x16x32_bf16 v[140:143], v[252:255], v[168:171], v[140:143]
    buffer_load_dwordx4 v[168:171], v28, s[12:15], s49 offen offset:2048 sc1
    buffer_load_dwordx4 v17, s[28:31], s21 offen offset:1024  lds
    v_mfma_f32_16x16x32_bf16 v[144:147], v[240:243], v[172:175], v[144:147]
    v_mfma_f32_16x16x32_bf16 v[148:151], v[244:247], v[172:175], v[148:151]
    v_mfma_f32_16x16x32_bf16 v[152:155], v[248:251], v[172:175], v[152:155]
    v_mfma_f32_16x16x32_bf16 v[156:159], v[252:255], v[172:175], v[156:159]
    buffer_load_dwordx4 v[172:175], v28, s[12:15], s49 offen offset:3072 sc1
    ds_read_b128 v[240:243], v21 offset:8192
    ds_read_b128 v[244:247], v21 offset:10240
    ds_read_b128 v[248:251], v21 offset:12288
    ds_read_b128 v[252:255], v21 offset:14336
    s_waitcnt vmcnt(22) lgkmcnt(4)
    v_mfma_f32_16x16x32_bf16 v[128:131], v[224:227], v[176:179], v[128:131]
    v_mfma_f32_16x16x32_bf16 v[132:135], v[228:231], v[176:179], v[132:135]
    v_mfma_f32_16x16x32_bf16 v[136:139], v[232:235], v[176:179], v[136:139]
    v_mfma_f32_16x16x32_bf16 v[140:143], v[236:239], v[176:179], v[140:143]
    ds_read_b32 v34, v32 offset:16
    buffer_load_dwordx4 v[176:179], v29, s[12:15], s49 offen offset:0 sc1
    buffer_load_dwordx4 v18, s[28:31], s21 offen offset:2048  lds
    v_mfma_f32_16x16x32_bf16 v[144:147], v[224:227], v[180:183], v[144:147]
    v_mfma_f32_16x16x32_bf16 v[148:151], v[228:231], v[180:183], v[148:151]
    v_mfma_f32_16x16x32_bf16 v[152:155], v[232:235], v[180:183], v[152:155]
    v_mfma_f32_16x16x32_bf16 v[156:159], v[236:239], v[180:183], v[156:159]
    buffer_load_dwordx4 v[180:183], v29, s[12:15], s49 offen offset:1024 sc1
    s_waitcnt lgkmcnt(0)
    v_readfirstlane_b32 s38, v34
    s_nop 1
    s_cmp_ge_u32 s38, 24
    s_cbranch_scc1 L_st6_ok
L_st6:
    ds_read_b32 v34, v32 offset:16
    s_waitcnt lgkmcnt(0)
    v_readfirstlane_b32 s38, v34
    s_nop 1
    s_cmp_ge_u32 s38, 24
    s_cbranch_scc1 L_st6_ok
    s_sub_u32 s96, s96, 1
    s_cbranch_scc1 L_st6_ok
    s_sleep 0
    s_branch L_st6
L_st6_ok:
    ds_read_b128 v[224:227], v20 offset:16384
    ds_read_b128 v[228:231], v20 offset:18432
    ds_read_b128 v[232:235], v20 offset:20480
    ds_read_b128 v[236:239], v20 offset:22528
    s_waitcnt vmcnt(22)
    v_mfma_f32_16x16x32_bf16 v[128:131], v[240:243], v[184:187], v[128:131]
    v_mfma_f32_16x16x32_bf16 v[132:135], v[244:247], v[184:187], v[132:135]
    v_mfma_f32_16x16x32_bf16 v[136:139], v[248:251], v[184:187], v[136:139]
    v_mfma_f32_16x16x32_bf16 v[140:143], v[252:255], v[184:187], v[140:143]
    buffer_load_dwordx4 v[184:187], v29, s[12:15], s49 offen offset:2048 sc1
    buffer_load_dwordx4 v19, s[28:31], s21 offen offset:3072  lds
    v_mfma_f32_16x16x32_bf16 v[144:147], v[240:243], v[188:191], v[144:147]
    v_mfma_f32_16x16x32_bf16 v[148:151], v[244:247], v[188:191], v[148:151]
    v_mfma_f32_16x16x32_bf16 v[152:155], v[248:251], v[188:191], v[152:155]
    v_mfma_f32_16x16x32_bf16 v[156:159], v[252:255], v[188:191], v[156:159]
    buffer_load_dwordx4 v[188:191], v29, s[12:15], s49 offen offset:3072 sc1
    ds_read_b128 v[240:243], v21 offset:16384
    ds_read_b128 v[244:247], v21 offset:18432
    ds_read_b128 v[248:251], v21 offset:20480
    ds_read_b128 v[252:255], v21 offset:22528
    s_waitcnt vmcnt(22) lgkmcnt(4)
    v_mfma_f32_16x16x32_bf16 v[128:131], v[224:227], v[192:195], v[128:131]
    v_mfma_f32_16x16x32_bf16 v[132:135], v[228:231], v[192:195], v[132:135]
    v_mfma_f32_16x16x32_bf16 v[136:139], v[232:235], v[192:195], v[136:139]
    v_mfma_f32_16x16x32_bf16 v[140:143], v[236:239], v[192:195], v[140:143]
    s_xor_b32 s49, s54, 9
    s_lshl_b32 s49, s49, 15
    s_add_u32 s49, s49, s50
    buffer_load_dwordx4 v[192:195], v28, s[12:15], s49 offen offset:0 sc1
    s_add_u32 m0, s23, 81920
    s_xor_b32 s21, s54, 10
    s_lshl_b32 s21, s21, 7
    buffer_load_dwordx4 v16, s[28:31], s21 offen offset:0  lds
    v_mfma_f32_16x16x32_bf16 v[144:147], v[224:227], v[196:199], v[144:147]
    v_mfma_f32_16x16x32_bf16 v[148:151], v[228:231], v[196:199], v[148:151]
    v_mfma_f32_16x16x32_bf16 v[152:155], v[232:235], v[196:199], v[152:155]
    v_mfma_f32_16x16x32_bf16 v[156:159], v[236:239], v[196:199], v[156:159]
    buffer_load_dwordx4 v[196:199], v28, s[12:15], s49 offen offset:1024 sc1
    ds_read_b128 v[224:227], v20 offset:24576
    ds_read_b128 v[228:231], v20 offset:26624
    ds_read_b128 v[232:235], v20 offset:28672
    ds_read_b128 v[236:239], v20 offset:30720
    s_waitcnt vmcnt(16) lgkmcnt(4)
    s_mov_b64 exec, 1
    ds_add_u32 v32, v33 offset:16
    s_mov_b64 exec, -1
    v_mfma_f32_16x16x32_bf16 v[128:131], v[240:243], v[200:203], v[128:131]
    v_mfma_f32_16x16x32_bf16 v[132:135], v[244:247], v[200:203], v[132:135]
    v_mfma_f32_16x16x32_bf16 v[136:139], v[248:251], v[200:203], v[136:139]
    v_mfma_f32_16x16x32_bf16 v[140:143], v[252:255], v[200:203], v[140:143]
    buffer_load_dwordx4 v[200:203], v28, s[12:15], s49 offen offset:2048 sc1
    buffer_load_dwordx4 v17, s[28:31], s21 offen offset:1024  lds
    v_mfma_f32_16x16x32_bf16 v[144:147], v[240:243], v[204:207], v[144:147]
    v_mfma_f32_16x16x32_bf16 v[148:151], v[244:247], v[204:207], v[148:151]
    v_mfma_f32_16x16x32_bf16 v[152:155], v[248:251], v[204:207], v[152:155]
    v_mfma_f32_16x16x32_bf16 v[156:159], v[252:255], v[204:207], v[156:159]
    buffer_load_dwordx4 v[204:207], v28, s[12:15], s49 offen offset:3072 sc1
    ds_read_b128 v[240:243], v21 offset:24576
    ds_read_b128 v[244:247], v21 offset:26624
    ds_read_b128 v[248:251], v21 offset:28672
    ds_read_b128 v[252:255], v21 offset:30720
    s_waitcnt vmcnt(21) lgkmcnt(4)
    v_mfma_f32_16x16x32_bf16 v[128:131], v[224:227], v[208:211], v[128:131]
    v_mfma_f32_16x16x32_bf16 v[132:135], v[228:231], v[208:211], v[132:135]
    v_mfma_f32_16x16x32_bf16 v[136:139], v[232:235], v[208:211], v[136:139]
    v_mfma_f32_16x16x32_bf16 v[140:143], v[236:239], v[208:211], v[140:143]
    ds_read_b32 v34, v32 offset:16
    buffer_load_dwordx4 v[208:211], v29, s[12:15], s49 offen offset:0 sc1
    buffer_load_dwordx4 v18, s[28:31], s21 offen offset:2048  lds
    v_mfma_f32_16x16x32_bf16 v[144:147], v[224:227], v[212:215], v[144:147]
    v_mfma_f32_16x16x32_bf16 v[148:151], v[228:231], v[212:215], v[148:151]
    v_mfma_f32_16x16x32_bf16 v[152:155], v[232:235], v[212:215], v[152:155]
    v_mfma_f32_16x16x32_bf16 v[156:159], v[236:239], v[212:215], v[156:159]
    buffer_load_dwordx4 v[212:215], v29, s[12:15], s49 offen offset:1024 sc1
    s_waitcnt lgkmcnt(0)
    v_readfirstlane_b32 s38, v34
    s_nop 1
    s_cmp_ge_u32 s38, 28
    s_cbranch_scc1 L_st7_ok
L_st7:
    ds_read_b32 v34, v32 offset:16
    s_waitcnt lgkmcnt(0)
    v_readfirstlane_b32 s38, v34
    s_nop 1
    s_cmp_ge_u32 s38, 28
    s_cbranch_scc1 L_st7_ok
    s_sub_u32 s96, s96, 1
    s_cbranch_scc1 L_st7_ok
    s_sleep 0
    s_branch L_st7
L_st7_ok:
    ds_read_b128 v[224:227], v20 offset:32768
    ds_read_b128 v[228:231], v20 offset:34816
    ds_read_b128 v[232:235], v20 offset:36864
    ds_read_b128 v[236:239], v20 offset:38912
    s_waitcnt vmcnt(21)
    v_mfma_f32_16x16x32_bf16 v[128:131], v[240:243], v[216:219], v[128:131]
    v_mfma_f32_16x16x32_bf16 v[132:135], v[244:247], v[216:219], v[132:135]
    v_mfma_f32_16x16x32_bf16 v[136:139], v[248:251], v[216:219], v[136:139]
    v_mfma_f32_16x16x32_bf16 v[140:143], v[252:255], v[216:219], v[140:143]
    buffer_load_dwordx4 v[216:219], v29, s[12:15], s49 offen offset:2048 sc1
    buffer_load_dwordx4 v19, s[28:31], s21 offen offset:3072  lds
    v_mfma_f32_16x16x32_bf16 v[144:147], v[240:243], v[220:223], v[144:147]
    v_mfma_f32_16x16x32_bf16 v[148:151], v[244:247], v[220:223], v[148:151]
    v_mfma_f32_16x16x32_bf16 v[152:155], v[248:251], v[220:223], v[152:155]
    v_mfma_f32_16x16x32_bf16 v[156:159], v[252:255], v[220:223], v[156:159]
    buffer_load_dwordx4 v[220:223], v29, s[12:15], s49 offen offset:3072 sc1
    ds_read_b128 v[240:243], v21 offset:32768
    ds_read_b128 v[244:247], v21 offset:34816
    ds_read_b128 v[248:251], v21 offset:36864
    ds_read_b128 v[252:255], v21 offset:38912
    s_waitcnt vmcnt(21) lgkmcnt(4)
    v_mfma_f32_16x16x32_bf16 v[128:131], v[224:227], v[160:163], v[128:131]
    v_mfma_f32_16x16x32_bf16 v[132:135], v[228:231], v[160:163], v[132:135]
    v_mfma_f32_16x16x32_bf16 v[136:139], v[232:235], v[160:163], v[136:139]
    v_mfma_f32_16x16x32_bf16 v[140:143], v[236:239], v[160:163], v[140:143]
    s_xor_b32 s49, s54, 10
    s_lshl_b32 s49, s49, 15
    s_add_u32 s49, s49, s50
    buffer_load_dwordx4 v[160:163], v28, s[12:15], s49 offen offset:0 sc1
    s_add_u32 m0, s23, 0
    s_xor_b32 s21, s54, 11
    s_lshl_b32 s21, s21, 7
    buffer_load_dwordx4 v16, s[28:31], s21 offen offset:0  lds
    v_mfma_f32_16x16x32_bf16 v[144:147], v[224:227], v[164:167], v[144:147]
    v_mfma_f32_16x16x32_bf16 v[148:151], v[228:231], v[164:167], v[148:151]
    v_mfma_f32_16x16x32_bf16 v[152:155], v[232:235], v[164:167], v[152:155]
    v_mfma_f32_16x16x32_bf16 v[156:159], v[236:239], v[164:167], v[156:159]
    buffer_load_dwordx4 v[164:167], v28, s[12:15], s49 offen offset:1024 sc1
    ds_read_b128 v[224:227], v20 offset:40960
    ds_read_b128 v[228:231], v20 offset:43008
    ds_read_b128 v[232:235], v20 offset:45056
    ds_read_b128 v[236:239], v20 offset:47104
    s_waitcnt vmcnt(16) lgkmcnt(4)
    s_mov_b64 exec, 1
    ds_add_u32 v32, v33 offset:16
    s_mov_b64 exec, -1
    v_mfma_f32_16x16x32_bf16 v[128:131], v[240:243], v[168:171], v[128:131]
    v_mfma_f32_16x16x32_bf16 v[132:135], v[244:247], v[168:171], v[132:135]
    v_mfma_f32_16x16x32_bf16 v[136:139], v[248:251], v[168:171], v[136:139]
    v_mfma_f32_16x16x32_bf16 v[140:143], v[252:255], v[168:171], v[140:143]
    buffer_load_dwordx4 v[168:171], v28, s[12:15], s49 offen offset:2048 sc1
    buffer_load_dwordx4 v17, s[28:31], s21 offen offset:1024  lds
    v_mfma_f32_16x16x32_bf16 v[144:147], v[240:243], v[172:175], v[144:147]
    v_mfma_f32_16x16x32_bf16 v[148:151], v[244:247], v[172:175], v[148:151]
    v_mfma_f32_16x16x32_bf16 v[152:155], v[248:251], v[172:175], v[152:155]
    v_mfma_f32_16x16x32_bf16 v[156:159], v[252:255], v[172:175], v[156:159]
    buffer_load_dwordx4 v[172:175], v28, s[12:15], s49 offen offset:3072 sc1
    ds_read_b128 v[240:243], v21 offset:40960
    ds_read_b128 v[244:247], v21 offset:43008
    ds_read_b128 v[248:251], v21 offset:45056
    ds_read_b128 v[252:255], v21 offset:47104
    s_waitcnt vmcnt(21) lgkmcnt(4)
    v_mfma_f32_16x16x32_bf16 v[128:131], v[224:227], v[176:179], v[128:131]
    v_mfma_f32_16x16x32_bf16 v[132:135], v[228:231], v[176:179], v[132:135]
    v_mfma_f32_16x16x32_bf16 v[136:139], v[232:235], v[176:179], v[136:139]
    v_mfma_f32_16x16x32_bf16 v[140:143], v[236:239], v[176:179], v[140:143]
    ds_read_b32 v34, v32 offset:16
    buffer_load_dwordx4 v[176:179], v29, s[12:15], s49 offen offset:0 sc1
    buffer_load_dwordx4 v18, s[28:31], s21 offen offset:2048  lds
    v_mfma_f32_16x16x32_bf16 v[144:147], v[224:227], v[180:183], v[144:147]
    v_mfma_f32_16x16x32_bf16 v[148:151], v[228:231], v[180:183], v[148:151]
    v_mfma_f32_16x16x32_bf16 v[152:155], v[232:235], v[180:183], v[152:155]
    v_mfma_f32_16x16x32_bf16 v[156:159], v[236:239], v[180:183], v[156:159]
    buffer_load_dwordx4 v[180:183], v29, s[12:15], s49 offen offset:1024 sc1
    s_waitcnt lgkmcnt(0)
    v_readfirstlane_b32 s38, v34
    s_nop 1
    s_cmp_ge_u32 s38, 32
    s_cbranch_scc1 L_st8_ok
L_st8:
    ds_read_b32 v34, v32 offset:16
    s_waitcnt lgkmcnt(0)
    v_readfirstlane_b32 s38, v34
    s_nop 1
    s_cmp_ge_u32 s38, 32
    s_cbranch_scc1 L_st8_ok
    s_sub_u32 s96, s96, 1
    s_cbranch_scc1 L_st8_ok
    s_sleep 0
    s_branch L_st8
L_st8_ok:
    ds_read_b128 v[224:227], v20 offset:49152
    ds_read_b128 v[228:231], v20 offset:51200
    ds_read_b128 v[232:235], v20 offset:53248
    ds_read_b128 v[236:239], v20 offset:55296
    s_waitcnt vmcnt(21)
    v_mfma_f32_16x16x32_bf16 v[128:131], v[240:243], v[184:187], v[128:131]
    v_mfma_f32_16x16x32_bf16 v[132:135], v[244:247], v[184:187], v[132:135]
    v_mfma_f32_16x16x32_bf16 v[136:139], v[248:251], v[184:187], v[136:139]
    v_mfma_f32_16x16x32_bf16 v[140:143], v[252:255], v[184:187], v[140:143]
    buffer_load_dwordx4 v[184:187], v29, s[12:15], s49 offen offset:2048 sc1
    buffer_load_dwordx4 v19, s[28:31], s21 offen offset:3072  lds
    v_mfma_f32_16x16x32_bf16 v[144:147], v[240:243], v[188:191], v[144:147]
    v_mfma_f32_16x16x32_bf16 v[148:151], v[244:247], v[188:191], v[148:151]
    v_mfma_f32_16x16x32_bf16 v[152:155], v[248:251], v[188:191], v[152:155]
    v_mfma_f32_16x16x32_bf16 v[156:159], v[252:255], v[188:191], v[156:159]
    buffer_load_dwordx4 v[188:191], v29, s[12:15], s49 offen offset:3072 sc1
    ds_read_b128 v[240:243], v21 offset:49152
    ds_read_b128 v[244:247], v21 offset:51200
    ds_read_b128 v[248:251], v21 offset:53248
    ds_read_b128 v[252:255], v21 offset:55296
    s_waitcnt vmcnt(21) lgkmcnt(4)
    v_mfma_f32_16x16x32_bf16 v[128:131], v[224:227], v[192:195], v[128:131]
    v_mfma_f32_16x16x32_bf16 v[132:135], v[228:231], v[192:195], v[132:135]
    v_mfma_f32_16x16x32_bf16 v[136:139], v[232:235], v[192:195], v[136:139]
    v_mfma_f32_16x16x32_bf16 v[140:143], v[236:239], v[192:195], v[140:143]
    s_xor_b32 s49, s54, 11
    s_lshl_b32 s49, s49, 15
    s_add_u32 s49, s49, s50
    buffer_load_dwordx4 v[192:195], v28, s[12:15], s49 offen offset:0 sc1
    s_add_u32 m0, s23, 16384
    s_xor_b32 s21, s54, 12
    s_lshl_b32 s21, s21, 7
    buffer_load_dwordx4 v16, s[28:31], s21 offen offset:0  lds
    v_mfma_f32_16x16x32_bf16 v[144:147], v[224:227], v[196:199], v[144:147]
    v_mfma_f32_16x16x32_bf16 v[148:151], v[228:231], v[196:199], v[148:151]
    v_mfma_f32_16x16x32_bf16 v[152:155], v[232:235], v[196:199], v[152:155]
    v_mfma_f32_16x16x32_bf16 v[156:159], v[236:239], v[196:199], v[156:159]
    buffer_load_dwordx4 v[196:199], v28, s[12:15], s49 offen offset:1024 sc1
    ds_read_b128 v[224:227], v20 offset:57344
    ds_read_b128 v[228:231], v20 offset:59392
    ds_read_b128 v[232:235], v20 offset:61440
    ds_read_b128 v[236:239], v20 offset:63488
    s_waitcnt vmcnt(16) lgkmcnt(4)
    s_mov_b64 exec, 1
    ds_add_u32 v32, v33 offset:16
    s_mov_b64 exec, -1
    v_mfma_f32_16x16x32_bf16 v[128:131], v[240:243], v[200:203], v[128:131]
    v_mfma_f32_16x16x32_bf16 v[132:135], v[244:247], v[200:203], v[132:135]
    v_mfma_f32_16x16x32_bf16 v[136:139], v[248:251], v[200:203], v[136:139]
    v_mfma_f32_16x16x32_bf16 v[140:143], v[252:255], v[200:203], v[140:143]
    buffer_load_dwordx4 v[200:203], v28, s[12:15], s49 offen offset:2048 sc1
    buffer_load_dwordx4 v17, s[28:31], s21 offen offset:1024  lds
    v_mfma_f32_16x16x32_bf16 v[144:147], v[240:243], v[204:207], v[144:147]
    v_mfma_f32_16x16x32_bf16 v[148:151], v[244:247], v[204:207], v[148:151]
    v_mfma_f32_16x16x32_bf16 v[152:155], v[248:251], v[204:207], v[152:155]
    v_mfma_f32_16x16x32_bf16 v[156:159], v[252:255], v[204:207], v[156:159]
    buffer_load_dwordx4 v[204:207], v28, s[12:15], s49 offen offset:3072 sc1
    ds_read_b128 v[240:243], v21 offset:57344
    ds_read_b128 v[244:247], v21 offset:59392
    ds_read_b128 v[248:251], v21 offset:61440
    ds_read_b128 v[252:255], v21 offset:63488
    s_waitcnt vmcnt(21) lgkmcnt(4)
    v_mfma_f32_16x16x32_bf16 v[128:131], v[224:227], v[208:211], v[128:131]
    v_mfma_f32_16x16x32_bf16 v[132:135], v[228:231], v[208:211], v[132:135]
    v_mfma_f32_16x16x32_bf16 v[136:139], v[232:235], v[208:211], v[136:139]
    v_mfma_f32_16x16x32_bf16 v[140:143], v[236:239], v[208:211], v[140:143]
    ds_read_b32 v34, v32 offset:16
    buffer_load_dwordx4 v[208:211], v29, s[12:15], s49 offen offset:0 sc1
    buffer_load_dwordx4 v18, s[28:31], s21 offen offset:2048  lds
    v_mfma_f32_16x16x32_bf16 v[144:147], v[224:227], v[212:215], v[144:147]
    v_mfma_f32_16x16x32_bf16 v[148:151], v[228:231], v[212:215], v[148:151]
    v_mfma_f32_16x16x32_bf16 v[152:155], v[232:235], v[212:215], v[152:155]
    v_mfma_f32_16x16x32_bf16 v[156:159], v[236:239], v[212:215], v[156:159]
    buffer_load_dwordx4 v[212:215], v29, s[12:15], s49 offen offset:1024 sc1
    s_waitcnt lgkmcnt(0)
    v_readfirstlane_b32 s38, v34
    s_nop 1
    s_cmp_ge_u32 s38, 36
    s_cbranch_scc1 L_st9_ok
L_st9:
    ds_read_b32 v34, v32 offset:16
    s_waitcnt lgkmcnt(0)
    v_readfirstlane_b32 s38, v34
    s_nop 1
    s_cmp_ge_u32 s38, 36
    s_cbranch_scc1 L_st9_ok
    s_sub_u32 s96, s96, 1
    s_cbranch_scc1 L_st9_ok
    s_sleep 0
    s_branch L_st9
L_st9_ok:
    ds_read_b128 v[224:227], v22 offset:16384
    ds_read_b128 v[228:231], v22 offset:18432
    ds_read_b128 v[232:235], v22 offset:20480
    ds_read_b128 v[236:239], v22 offset:22528
    s_waitcnt vmcnt(21)
    v_mfma_f32_16x16x32_bf16 v[128:131], v[240:243], v[216:219], v[128:131]
    v_mfma_f32_16x16x32_bf16 v[132:135], v[244:247], v[216:219], v[132:135]
    v_mfma_f32_16x16x32_bf16 v[136:139], v[248:251], v[216:219], v[136:139]
    v_mfma_f32_16x16x32_bf16 v[140:143], v[252:255], v[216:219], v[140:143]
    buffer_load_dwordx4 v[216:219], v29, s[12:15], s49 offen offset:2048 sc1
    buffer_load_dwordx4 v19, s[28:31], s21 offen offset:3072  lds
    v_mfma_f32_16x16x32_bf16 v[144:147], v[240:243], v[220:223], v[144:147]
    v_mfma_f32_16x16x32_bf16 v[148:151], v[244:247], v[220:223], v[148:151]
    v_mfma_f32_16x16x32_bf16 v[152:155], v[248:251], v[220:223], v[152:155]
    v_mfma_f32_16x16x32_bf16 v[156:159], v[252:255], v[220:223], v[156:159]
    buffer_load_dwordx4 v[220:223], v29, s[12:15], s49 offen offset:3072 sc1
    ds_read_b128 v[240:243], v23 offset:16384
    ds_read_b128 v[244:247], v23 offset:18432
    ds_read_b128 v[248:251], v23 offset:20480
    ds_read_b128 v[252:255], v23 offset:22528
    s_waitcnt vmcnt(21) lgkmcnt(4)
    v_mfma_f32_16x16x32_bf16 v[128:131], v[224:227], v[160:163], v[128:131]
    v_mfma_f32_16x16x32_bf16 v[132:135], v[228:231], v[160:163], v[132:135]
    v_mfma_f32_16x16x32_bf16 v[136:139], v[232:235], v[160:163], v[136:139]
    v_mfma_f32_16x16x32_bf16 v[140:143], v[236:239], v[160:163], v[140:143]
    s_xor_b32 s49, s54, 12
    s_lshl_b32 s49, s49, 15
    s_add_u32 s49, s49, s50
    buffer_load_dwordx4 v[160:163], v28, s[12:15], s49 offen offset:0 sc1
    s_add_u32 m0, s23, 32768
    s_xor_b32 s21, s54, 13
    s_lshl_b32 s21, s21, 7
    buffer_load_dwordx4 v16, s[28:31], s21 offen offset:0  lds
    v_mfma_f32_16x16x32_bf16 v[144:147], v[224:227], v[164:167], v[144:147]
    v_mfma_f32_16x16x32_bf16 v[148:151], v[228:231], v[164:167], v[148:151]
    v_mfma_f32_16x16x32_bf16 v[152:155], v[232:235], v[164:167], v[152:155]
    v_mfma_f32_16x16x32_bf16 v[156:159], v[236:239], v[164:167], v[156:159]
    buffer_load_dwordx4 v[164:167], v28, s[12:15], s49 offen offset:1024 sc1
    ds_read_b128 v[224:227], v22 offset:24576
    ds_read_b128 v[228:231], v22 offset:26624
    ds_read_b128 v[232:235], v22 offset:28672
    ds_read_b128 v[236:239], v22 offset:30720
    s_waitcnt vmcnt(16) lgkmcnt(4)
    s_mov_b64 exec, 1
    ds_add_u32 v32, v33 offset:16
    s_mov_b64 exec, -1
    v_mfma_f32_16x16x32_bf16 v[128:131], v[240:243], v[168:171], v[128:131]
    v_mfma_f32_16x16x32_bf16 v[132:135], v[244:247], v[168:171], v[132:135]
    v_mfma_f32_16x16x32_bf16 v[136:139], v[248:251], v[168:171], v[136:139]
    v_mfma_f32_16x16x32_bf16 v[140:143], v[252:255], v[168:171], v[140:143]
    buffer_load_dwordx4 v[168:171], v28, s[12:15], s49 offen offset:2048 sc1
    buffer_load_dwordx4 v17, s[28:31], s21 offen offset:1024  lds
    v_mfma_f32_16x16x32_bf16 v[144:147], v[240:243], v[172:175], v[144:147]
    v_mfma_f32_16x16x32_bf16 v[148:151], v[244:247], v[172:175], v[148:151]
    v_mfma_f32_16x16x32_bf16 v[152:155], v[248:251], v[172:175], v[152:155]
    v_mfma_f32_16x16x32_bf16 v[156:159], v[252:255], v[172:175], v[156:159]
    buffer_load_dwordx4 v[172:175], v28, s[12:15], s49 offen offset:3072 sc1
    ds_read_b128 v[240:243], v23 offset:24576
    ds_read_b128 v[244:247], v23 offset:26624
    ds_read_b128 v[248:251], v23 offset:28672
    ds_read_b128 v[252:255], v23 offset:30720
    s_waitcnt vmcnt(21) lgkmcnt(4)
    v_mfma_f32_16x16x32_bf16 v[128:131], v[224:227], v[176:179], v[128:131]
    v_mfma_f32_16x16x32_bf16 v[132:135], v[228:231], v[176:179], v[132:135]
    v_mfma_f32_16x16x32_bf16 v[136:139], v[232:235], v[176:179], v[136:139]
    v_mfma_f32_16x16x32_bf16 v[140:143], v[236:239], v[176:179], v[140:143]
    ds_read_b32 v34, v32 offset:16
    buffer_load_dwordx4 v[176:179], v29, s[12:15], s49 offen offset:0 sc1
    buffer_load_dwordx4 v18, s[28:31], s21 offen offset:2048  lds
    v_mfma_f32_16x16x32_bf16 v[144:147], v[224:227], v[180:183], v[144:147]
    v_mfma_f32_16x16x32_bf16 v[148:151], v[228:231], v[180:183], v[148:151]
    v_mfma_f32_16x16x32_bf16 v[152:155], v[232:235], v[180:183], v[152:155]
    v_mfma_f32_16x16x32_bf16 v[156:159], v[236:239], v[180:183], v[156:159]
    buffer_load_dwordx4 v[180:183], v29, s[12:15], s49 offen offset:1024 sc1
    s_waitcnt lgkmcnt(0)
    v_readfirstlane_b32 s38, v34
    s_nop 1
    s_cmp_ge_u32 s38, 40
    s_cbranch_scc1 L_st10_ok
L_st10:
    ds_read_b32 v34, v32 offset:16
    s_waitcnt lgkmcnt(0)
    v_readfirstlane_b32 s38, v34
    s_nop 1
    s_cmp_ge_u32 s38, 40
    s_cbranch_scc1 L_st10_ok
    s_sub_u32 s96, s96, 1
    s_cbranch_scc1 L_st10_ok
    s_sleep 0
    s_branch L_st10
L_st10_ok:
    ds_read_b128 v[224:227], v20 offset:0
    ds_read_b128 v[228:231], v20 offset:2048
    ds_read_b128 v[232:235], v20 offset:4096
    ds_read_b128 v[236:239], v20 offset:6144
    s_waitcnt vmcnt(21)
    v_mfma_f32_16x16x32_bf16 v[128:131], v[240:243], v[184:187], v[128:131]
    v_mfma_f32_16x16x32_bf16 v[132:135], v[244:247], v[184:187], v[132:135]
    v_mfma_f32_16x16x32_bf16 v[136:139], v[248:251], v[184:187], v[136:139]
    v_mfma_f32_16x16x32_bf16 v[140:143], v[252:255], v[184:187], v[140:143]
    buffer_load_dwordx4 v[184:187], v29, s[12:15], s49 offen offset:2048 sc1
    buffer_load_dwordx4 v19, s[28:31], s21 offen offset:3072  lds
    v_mfma_f32_16x16x32_bf16 v[144:147], v[240:243], v[188:191], v[144:147]
    v_mfma_f32_16x16x32_bf16 v[148:151], v[244:247], v[188:191], v[148:151]
    v_mfma_f32_16x16x32_bf16 v[152:155], v[248:251], v[188:191], v[152:155]
    v_mfma_f32_16x16x32_bf16 v[156:159], v[252:255], v[188:191], v[156:159]
    buffer_load_dwordx4 v[188:191], v29, s[12:15], s49 offen offset:3072 sc1
    ds_read_b128 v[240:243], v21 offset:0
    ds_read_b128 v[244:247], v21 offset:2048
    ds_read_b128 v[248:251], v21 offset:4096
    ds_read_b128 v[252:255], v21 offset:6144
    s_waitcnt vmcnt(21) lgkmcnt(4)
    v_mfma_f32_16x16x32_bf16 v[128:131], v[224:227], v[192:195], v[128:131]
    v_mfma_f32_16x16x32_bf16 v[132:135], v[228:231], v[192:195], v[132:135]
    v_mfma_f32_16x16x32_bf16 v[136:139], v[232:235], v[192:195], v[136:139]
    v_mfma_f32_16x16x32_bf16 v[140:143], v[236:239], v[192:195], v[140:143]
    s_xor_b32 s49, s54, 13
    s_lshl_b32 s49, s49, 15
    s_add_u32 s49, s49, s50
    buffer_load_dwordx4 v[192:195], v28, s[12:15], s49 offen offset:0 sc1
    s_add_u32 m0, s23, 49152
    s_xor_b32 s21, s54, 14
    s_lshl_b32 s21, s21, 7
    buffer_load_dwordx4 v16, s[28:31], s21 offen offset:0  lds
    v_mfma_f32_16x16x32_bf16 v[144:147], v[224:227], v[196:199], v[144:147]
    v_mfma_f32_16x16x32_bf16 v[148:151], v[228:231], v[196:199], v[148:151]
    v_mfma_f32_16x16x32_bf16 v[152:155], v[232:235], v[196:199], v[152:155]
    v_mfma_f32_16x16x32_bf16 v[156:159], v[236:239], v[196:199], v[156:159]
    buffer_load_dwordx4 v[196:199], v28, s[12:15], s49 offen offset:1024 sc1
    ds_read_b128 v[224:227], v20 offset:8192
    ds_read_b128 v[228:231], v20 offset:10240
    ds_read_b128 v[232:235], v20 offset:12288
    ds_read_b128 v[236:239], v20 offset:14336
    s_waitcnt vmcnt(16) lgkmcnt(4)
    s_mov_b64 exec, 1
    ds_add_u32 v32, v33 offset:16
    s_mov_b64 exec, -1
    v_mfma_f32_16x16x32_bf16 v[128:131], v[240:243], v[200:203], v[128:131]
    v_mfma_f32_16x16x32_bf16 v[132:135], v[244:247], v[200:203], v[132:135]
    v_mfma_f32_16x16x32_bf16 v[136:139], v[248:251], v[200:203], v[136:139]
    v_mfma_f32_16x16x32_bf16 v[140:143], v[252:255], v[200:203], v[140:143]
    buffer_load_dwordx4 v[200:203], v28, s[12:15], s49 offen offset:2048 sc1
    buffer_load_dwordx4 v17, s[28:31], s21 offen offset:1024  lds
    v_mfma_f32_16x16x32_bf16 v[144:147], v[240:243], v[204:207], v[144:147]
    v_mfma_f32_16x16x32_bf16 v[148:151], v[244:247], v[204:207], v[148:151]
    v_mfma_f32_16x16x32_bf16 v[152:155], v[248:251], v[204:207], v[152:155]
    v_mfma_f32_16x16x32_bf16 v[156:159], v[252:255], v[204:207], v[156:159]
    buffer_load_dwordx4 v[204:207], v28, s[12:15], s49 offen offset:3072 sc1
    ds_read_b128 v[240:243], v21 offset:8192
    ds_read_b128 v[244:247], v21 offset:10240
    ds_read_b128 v[248:251], v21 offset:12288
    ds_read_b128 v[252:255], v21 offset:14336
    s_waitcnt vmcnt(21) lgkmcnt(4)
    v_mfma_f32_16x16x32_bf16 v[128:131], v[224:227], v[208:211], v[128:131]
    v_mfma_f32_16x16x32_bf16 v[132:135], v[228:231], v[208:211], v[132:135]
    v_mfma_f32_16x16x32_bf16 v[136:139], v[232:235], v[208:211], v[136:139]
    v_mfma_f32_16x16x32_bf16 v[140:143], v[236:239], v[208:211], v[140:143]
    ds_read_b32 v34, v32 offset:16
    buffer_load_dwordx4 v[208:211], v29, s[12:15], s49 offen offset:0 sc1
    buffer_load_dwordx4 v18, s[28:31], s21 offen offset:2048  lds
    v_mfma_f32_16x16x32_bf16 v[144:147], v[224:227], v[212:215], v[144:147]
    v_mfma_f32_16x16x32_bf16 v[148:151], v[228:231], v[212:215], v[148:151]
    v_mfma_f32_16x16x32_bf16 v[152:155], v[232:235], v[212:215], v[152:155]
    v_mfma_f32_16x16x32_bf16 v[156:159], v[236:239], v[212:215], v[156:159]
    buffer_load_dwordx4 v[212:215], v29, s[12:15], s49 offen offset:1024 sc1
    s_waitcnt lgkmcnt(0)
    v_readfirstlane_b32 s38, v34
    s_nop 1
    s_cmp_ge_u32 s38, 44
    s_cbranch_scc1 L_st11_ok
L_st11:
    ds_read_b32 v34, v32 offset:16
    s_waitcnt lgkmcnt(0)
    v_readfirstlane_b32 s38, v34
    s_nop 1
    s_cmp_ge_u32 s38, 44
    s_cbranch_scc1 L_st11_ok
    s_sub_u32 s96, s96, 1
    s_cbranch_scc1 L_st11_ok
    s_sleep 0
    s_branch L_st11
L_st11_ok:
    ds_read_b128 v[224:227], v20 offset:16384
    ds_read_b128 v[228:231], v20 offset:18432
    ds_read_b128 v[232:235], v20 offset:20480
    ds_read_b128 v[236:239], v20 offset:22528
    s_waitcnt vmcnt(21)
    v_mfma_f32_16x16x32_bf16 v[128:131], v[240:243], v[216:219], v[128:131]
    v_mfma_f32_16x16x32_bf16 v[132:135], v[244:247], v[216:219], v[132:135]
    v_mfma_f32_16x16x32_bf16 v[136:139], v[248:251], v[216:219], v[136:139]
    v_mfma_f32_16x16x32_bf16 v[140:143], v[252:255], v[216:219], v[140:143]
    buffer_load_dwordx4 v[216:219], v29, s[12:15], s49 offen offset:2048 sc1
    buffer_load_dwordx4 v19, s[28:31], s21 offen offset:3072  lds
    v_mfma_f32_16x16x32_bf16 v[144:147], v[240:243], v[220:223], v[144:147]
    v_mfma_f32_16x16x32_bf16 v[148:151], v[244:247], v[220:223], v[148:151]
    v_mfma_f32_16x16x32_bf16 v[152:155], v[248:251], v[220:223], v[152:155]
    v_mfma_f32_16x16x32_bf16 v[156:159], v[252:255], v[220:223], v[156:159]
    buffer_load_dwordx4 v[220:223], v29, s[12:15], s49 offen offset:3072 sc1
    ds_read_b128 v[240:243], v21 offset:16384
    ds_read_b128 v[244:247], v21 offset:18432
    ds_read_b128 v[248:251], v21 offset:20480
    ds_read_b128 v[252:255], v21 offset:22528
    s_waitcnt vmcnt(21) lgkmcnt(4)
    v_mfma_f32_16x16x32_bf16 v[128:131], v[224:227], v[160:163], v[128:131]
    v_mfma_f32_16x16x32_bf16 v[132:135], v[228:231], v[160:163], v[132:135]
    v_mfma_f32_16x16x32_bf16 v[136:139], v[232:235], v[160:163], v[136:139]
    v_mfma_f32_16x16x32_bf16 v[140:143], v[236:239], v[160:163], v[140:143]
    s_xor_b32 s49, s54, 14
    s_lshl_b32 s49, s49, 15
    s_add_u32 s49, s49, s50
    buffer_load_dwordx4 v[160:163], v28, s[12:15], s49 offen offset:0 sc1
    s_add_u32 m0, s23, 81920
    s_xor_b32 s21, s54, 15
    s_lshl_b32 s21, s21, 7
    buffer_load_dwordx4 v16, s[28:31], s21 offen offset:0  lds
    v_mfma_f32_16x16x32_bf16 v[144:147], v[224:227], v[164:167], v[144:147]
    v_mfma_f32_16x16x32_bf16 v[148:151], v[228:231], v[164:167], v[148:151]
    v_mfma_f32_16x16x32_bf16 v[152:155], v[232:235], v[164:167], v[152:155]
    v_mfma_f32_16x16x32_bf16 v[156:159], v[236:239], v[164:167], v[156:159]
    buffer_load_dwordx4 v[164:167], v28, s[12:15], s49 offen offset:1024 sc1
    ds_read_b128 v[224:227], v20 offset:24576
    ds_read_b128 v[228:231], v20 offset:26624
    ds_read_b128 v[232:235], v20 offset:28672
    ds_read_b128 v[236:239], v20 offset:30720
    s_waitcnt vmcnt(16) lgkmcnt(4)
    s_mov_b64 exec, 1
    ds_add_u32 v32, v33 offset:16
    s_mov_b64 exec, -1
    v_mfma_f32_16x16x32_bf16 v[128:131], v[240:243], v[168:171], v[128:131]
    v_mfma_f32_16x16x32_bf16 v[132:135], v[244:247], v[168:171], v[132:135]
    v_mfma_f32_16x16x32_bf16 v[136:139], v[248:251], v[168:171], v[136:139]
    v_mfma_f32_16x16x32_bf16 v[140:143], v[252:255], v[168:171], v[140:143]
    buffer_load_dwordx4 v[168:171], v28, s[12:15], s49 offen offset:2048 sc1
    buffer_load_dwordx4 v17, s[28:31], s21 offen offset:1024  lds
    v_mfma_f32_16x16x32_bf16 v[144:147], v[240:243], v[172:175], v[144:147]
    v_mfma_f32_16x16x32_bf16 v[148:151], v[244:247], v[172:175], v[148:151]
    v_mfma_f32_16x16x32_bf16 v[152:155], v[248:251], v[172:175], v[152:155]
    v_mfma_f32_16x16x32_bf16 v[156:159], v[252:255], v[172:175], v[156:159]
    buffer_load_dwordx4 v[172:175], v28, s[12:15], s49 offen offset:3072 sc1
    ds_read_b128 v[240:243], v21 offset:24576
    ds_read_b128 v[244:247], v21 offset:26624
    ds_read_b128 v[248:251], v21 offset:28672
    ds_read_b128 v[252:255], v21 offset:30720
    s_waitcnt vmcnt(21) lgkmcnt(4)
    v_mfma_f32_16x16x32_bf16 v[128:131], v[224:227], v[176:179], v[128:131]
    v_mfma_f32_16x16x32_bf16 v[132:135], v[228:231], v[176:179], v[132:135]
    v_mfma_f32_16x16x32_bf16 v[136:139], v[232:235], v[176:179], v[136:139]
    v_mfma_f32_16x16x32_bf16 v[140:143], v[236:239], v[176:179], v[140:143]
    ds_read_b32 v34, v32 offset:16
    buffer_load_dwordx4 v[176:179], v29, s[12:15], s49 offen offset:0 sc1
    buffer_load_dwordx4 v18, s[28:31], s21 offen offset:2048  lds
    v_mfma_f32_16x16x32_bf16 v[144:147], v[224:227], v[180:183], v[144:147]
    v_mfma_f32_16x16x32_bf16 v[148:151], v[228:231], v[180:183], v[148:151]
    v_mfma_f32_16x16x32_bf16 v[152:155], v[232:235], v[180:183], v[152:155]
    v_mfma_f32_16x16x32_bf16 v[156:159], v[236:239], v[180:183], v[156:159]
    buffer_load_dwordx4 v[180:183], v29, s[12:15], s49 offen offset:1024 sc1
    s_waitcnt lgkmcnt(0)
    v_readfirstlane_b32 s38, v34
    s_nop 1
    s_cmp_ge_u32 s38, 48
    s_cbranch_scc1 L_st12_ok
L_st12:
    ds_read_b32 v34, v32 offset:16
    s_waitcnt lgkmcnt(0)
    v_readfirstlane_b32 s38, v34
    s_nop 1
    s_cmp_ge_u32 s38, 48
    s_cbranch_scc1 L_st12_ok
    s_sub_u32 s96, s96, 1
    s_cbranch_scc1 L_st12_ok
    s_sleep 0
    s_branch L_st12
L_st12_ok:
    ds_read_b128 v[224:227], v20 offset:32768
    ds_read_b128 v[228:231], v20 offset:34816
    ds_read_b128 v[232:235], v20 offset:36864
    ds_read_b128 v[236:239], v20 offset:38912
    s_waitcnt vmcnt(21)
    v_mfma_f32_16x16x32_bf16 v[128:131], v[240:243], v[184:187], v[128:131]
    v_mfma_f32_16x16x32_bf16 v[132:135], v[244:247], v[184:187], v[132:135]
    v_mfma_f32_16x16x32_bf16 v[136:139], v[248:251], v[184:187], v[136:139]
    v_mfma_f32_16x16x32_bf16 v[140:143], v[252:255], v[184:187], v[140:143]
    buffer_load_dwordx4 v[184:187], v29, s[12:15], s49 offen offset:2048 sc1
    buffer_load_dwordx4 v19, s[28:31], s21 offen offset:3072  lds
    v_mfma_f32_16x16x32_bf16 v[144:147], v[240:243], v[188:191], v[144:147]
    v_mfma_f32_16x16x32_bf16 v[148:151], v[244:247], v[188:191], v[148:151]
    v_mfma_f32_16x16x32_bf16 v[152:155], v[248:251], v[188:191], v[152:155]
    v_mfma_f32_16x16x32_bf16 v[156:159], v[252:255], v[188:191], v[156:159]
    buffer_load_dwordx4 v[188:191], v29, s[12:15], s49 offen offset:3072 sc1
    ds_read_b128 v[240:243], v21 offset:32768
    ds_read_b128 v[244:247], v21 offset:34816
    ds_read_b128 v[248:251], v21 offset:36864
    ds_read_b128 v[252:255], v21 offset:38912
    s_waitcnt vmcnt(21) lgkmcnt(4)
    v_mfma_f32_16x16x32_bf16 v[128:131], v[224:227], v[192:195], v[128:131]
    v_mfma_f32_16x16x32_bf16 v[132:135], v[228:231], v[192:195], v[132:135]
    v_mfma_f32_16x16x32_bf16 v[136:139], v[232:235], v[192:195], v[136:139]
    v_mfma_f32_16x16x32_bf16 v[140:143], v[236:239], v[192:195], v[140:143]
    s_xor_b32 s49, s54, 15
    s_lshl_b32 s49, s49, 15
    s_add_u32 s49, s49, s50
    buffer_load_dwordx4 v[192:195], v28, s[12:15], s49 offen offset:0 sc1
    v_mfma_f32_16x16x32_bf16 v[144:147], v[224:227], v[196:199], v[144:147]
    v_mfma_f32_16x16x32_bf16 v[148:151], v[228:231], v[196:199], v[148:151]
    v_mfma_f32_16x16x32_bf16 v[152:155], v[232:235], v[196:199], v[152:155]
    v_mfma_f32_16x16x32_bf16 v[156:159], v[236:239], v[196:199], v[156:159]
    buffer_load_dwordx4 v[196:199], v28, s[12:15], s49 offen offset:1024 sc1
    ds_read_b128 v[224:227], v20 offset:40960
    ds_read_b128 v[228:231], v20 offset:43008
    ds_read_b128 v[232:235], v20 offset:45056
    ds_read_b128 v[236:239], v20 offset:47104
    s_waitcnt vmcnt(15) lgkmcnt(4)
    s_mov_b64 exec, 1
    ds_add_u32 v32, v33 offset:16
    s_mov_b64 exec, -1
    v_mfma_f32_16x16x32_bf16 v[128:131], v[240:243], v[200:203], v[128:131]
    v_mfma_f32_16x16x32_bf16 v[132:135], v[244:247], v[200:203], v[132:135]
    v_mfma_f32_16x16x32_bf16 v[136:139], v[248:251], v[200:203], v[136:139]
    v_mfma_f32_16x16x32_bf16 v[140:143], v[252:255], v[200:203], v[140:143]
    buffer_load_dwordx4 v[200:203], v28, s[12:15], s49 offen offset:2048 sc1
    v_mfma_f32_16x16x32_bf16 v[144:147], v[240:243], v[204:207], v[144:147]
    v_mfma_f32_16x16x32_bf16 v[148:151], v[244:247], v[204:207], v[148:151]
    v_mfma_f32_16x16x32_bf16 v[152:155], v[248:251], v[204:207], v[152:155]
    v_mfma_f32_16x16x32_bf16 v[156:159], v[252:255], v[204:207], v[156:159]
    buffer_load_dwordx4 v[204:207], v28, s[12:15], s49 offen offset:3072 sc1
    ds_read_b128 v[240:243], v21 offset:40960
    ds_read_b128 v[244:247], v21 offset:43008
    ds_read_b128 v[248:251], v21 offset:45056
    ds_read_b128 v[252:255], v21 offset:47104
    s_waitcnt vmcnt(19) lgkmcnt(4)
    v_mfma_f32_16x16x32_bf16 v[128:131], v[224:227], v[208:211], v[128:131]
    v_mfma_f32_16x16x32_bf16 v[132:135], v[228:231], v[208:211], v[132:135]
    v_mfma_f32_16x16x32_bf16 v[136:139], v[232:235], v[208:211], v[136:139]
    v_mfma_f32_16x16x32_bf16 v[140:143], v[236:239], v[208:211], v[140:143]
    ds_read_b32 v34, v32 offset:16
    buffer_load_dwordx4 v[208:211], v29, s[12:15], s49 offen offset:0 sc1
    v_mfma_f32_16x16x32_bf16 v[144:147], v[224:227], v[212:215], v[144:147]
    v_mfma_f32_16x16x32_bf16 v[148:151], v[228:231], v[212:215], v[148:151]
    v_mfma_f32_16x16x32_bf16 v[152:155], v[232:235], v[212:215], v[152:155]
    v_mfma_f32_16x16x32_bf16 v[156:159], v[236:239], v[212:215], v[156:159]
    buffer_load_dwordx4 v[212:215], v29, s[12:15], s49 offen offset:1024 sc1
    s_waitcnt lgkmcnt(0)
    v_readfirstlane_b32 s38, v34
    s_nop 1
    s_cmp_ge_u32 s38, 52
    s_cbranch_scc1 L_st13_ok
L_st13:
    ds_read_b32 v34, v32 offset:16
    s_waitcnt lgkmcnt(0)
    v_readfirstlane_b32 s38, v34
    s_nop 1
    s_cmp_ge_u32 s38, 52
    s_cbranch_scc1 L_st13_ok
    s_sub_u32 s96, s96, 1
    s_cbranch_scc1 L_st13_ok
    s_sleep 0
    s_branch L_st13
L_st13_ok:
    ds_read_b128 v[224:227], v20 offset:49152
    ds_read_b128 v[228:231], v20 offset:51200
    ds_read_b128 v[232:235], v20 offset:53248
    ds_read_b128 v[236:239], v20 offset:55296
    s_waitcnt vmcnt(18)
    v_mfma_f32_16x16x32_bf16 v[128:131], v[240:243], v[216:219], v[128:131]
    v_mfma_f32_16x16x32_bf16 v[132:135], v[244:247], v[216:219], v[132:135]
    v_mfma_f32_16x16x32_bf16 v[136:139], v[248:251], v[216:219], v[136:139]
    v_mfma_f32_16x16x32_bf16 v[140:143], v[252:255], v[216:219], v[140:143]
    buffer_load_dwordx4 v[216:219], v29, s[12:15], s49 offen offset:2048 sc1
    v_mfma_f32_16x16x32_bf16 v[144:147], v[240:243], v[220:223], v[144:147]
    v_mfma_f32_16x16x32_bf16 v[148:151], v[244:247], v[220:223], v[148:151]
    v_mfma_f32_16x16x32_bf16 v[152:155], v[248:251], v[220:223], v[152:155]
    v_mfma_f32_16x16x32_bf16 v[156:159], v[252:255], v[220:223], v[156:159]
    buffer_load_dwordx4 v[220:223], v29, s[12:15], s49 offen offset:3072 sc1
    ds_read_b128 v[240:243], v21 offset:49152
    ds_read_b128 v[244:247], v21 offset:51200
    ds_read_b128 v[248:251], v21 offset:53248
    ds_read_b128 v[252:255], v21 offset:55296
    s_waitcnt vmcnt(17) lgkmcnt(4)
    v_mfma_f32_16x16x32_bf16 v[128:131], v[224:227], v[160:163], v[128:131]
    v_mfma_f32_16x16x32_bf16 v[132:135], v[228:231], v[160:163], v[132:135]
    v_mfma_f32_16x16x32_bf16 v[136:139], v[232:235], v[160:163], v[136:139]
    v_mfma_f32_16x16x32_bf16 v[140:143], v[236:239], v[160:163], v[140:143]
    v_mfma_f32_16x16x32_bf16 v[144:147], v[224:227], v[164:167], v[144:147]
    v_mfma_f32_16x16x32_bf16 v[148:151], v[228:231], v[164:167], v[148:151]
    v_mfma_f32_16x16x32_bf16 v[152:155], v[232:235], v[164:167], v[152:155]
    v_mfma_f32_16x16x32_bf16 v[156:159], v[236:239], v[164:167], v[156:159]
    ds_read_b128 v[224:227], v20 offset:57344
    ds_read_b128 v[228:231], v20 offset:59392
    ds_read_b128 v[232:235], v20 offset:61440
    ds_read_b128 v[236:239], v20 offset:63488
    s_waitcnt vmcnt(9) lgkmcnt(4)
    s_mov_b64 exec, 1
    ds_add_u32 v32, v33 offset:16
    s_mov_b64 exec, -1
    v_mfma_f32_16x16x32_bf16 v[128:131], v[240:243], v[168:171], v[128:131]
    v_mfma_f32_16x16x32_bf16 v[132:135], v[244:247], v[168:171], v[132:135]
    v_mfma_f32_16x16x32_bf16 v[136:139], v[248:251], v[168:171], v[136:139]
    v_mfma_f32_16x16x32_bf16 v[140:143], v[252:255], v[168:171], v[140:143]
    v_mfma_f32_16x16x32_bf16 v[144:147], v[240:243], v[172:175], v[144:147]
    v_mfma_f32_16x16x32_bf16 v[148:151], v[244:247], v[172:175], v[148:151]
    v_mfma_f32_16x16x32_bf16 v[152:155], v[248:251], v[172:175], v[152:155]
    v_mfma_f32_16x16x32_bf16 v[156:159], v[252:255], v[172:175], v[156:159]
    ds_read_b128 v[240:243], v21 offset:57344
    ds_read_b128 v[244:247], v21 offset:59392
    ds_read_b128 v[248:251], v21 offset:61440
    ds_read_b128 v[252:255], v21 offset:63488
    s_waitcnt vmcnt(11) lgkmcnt(4)
    v_mfma_f32_16x16x32_bf16 v[128:131], v[224:227], v[176:179], v[128:131]
    v_mfma_f32_16x16x32_bf16 v[132:135], v[228:231], v[176:179], v[132:135]
    v_mfma_f32_16x16x32_bf16 v[136:139], v[232:235], v[176:179], v[136:139]
    v_mfma_f32_16x16x32_bf16 v[140:143], v[236:239], v[176:179], v[140:143]
    ds_read_b32 v34, v32 offset:16
    v_mfma_f32_16x16x32_bf16 v[144:147], v[224:227], v[180:183], v[144:147]
    v_mfma_f32_16x16x32_bf16 v[148:151], v[228:231], v[180:183], v[148:151]
    v_mfma_f32_16x16x32_bf16 v[152:155], v[232:235], v[180:183], v[152:155]
    v_mfma_f32_16x16x32_bf16 v[156:159], v[236:239], v[180:183], v[156:159]
    s_waitcnt lgkmcnt(0)
    v_readfirstlane_b32 s38, v34
    s_nop 1
    s_cmp_ge_u32 s38, 56
    s_cbranch_scc1 L_st14_ok
L_st14:
    ds_read_b32 v34, v32 offset:16
    s_waitcnt lgkmcnt(0)
    v_readfirstlane_b32 s38, v34
    s_nop 1
    s_cmp_ge_u32 s38, 56
    s_cbranch_scc1 L_st14_ok
    s_sub_u32 s96, s96, 1
    s_cbranch_scc1 L_st14_ok
    s_sleep 0
    s_branch L_st14
L_st14_ok:
    ds_read_b128 v[224:227], v22 offset:16384
    ds_read_b128 v[228:231], v22 offset:18432
    ds_read_b128 v[232:235], v22 offset:20480
    ds_read_b128 v[236:239], v22 offset:22528
    s_waitcnt vmcnt(8)
    v_mfma_f32_16x16x32_bf16 v[128:131], v[240:243], v[184:187], v[128:131]
    v_mfma_f32_16x16x32_bf16 v[132:135], v[244:247], v[184:187], v[132:135]
    v_mfma_f32_16x16x32_bf16 v[136:139], v[248:251], v[184:187], v[136:139]
    v_mfma_f32_16x16x32_bf16 v[140:143], v[252:255], v[184:187], v[140:143]
    v_mfma_f32_16x16x32_bf16 v[144:147], v[240:243], v[188:191], v[144:147]
    v_mfma_f32_16x16x32_bf16 v[148:151], v[244:247], v[188:191], v[148:151]
    v_mfma_f32_16x16x32_bf16 v[152:155], v[248:251], v[188:191], v[152:155]
    v_mfma_f32_16x16x32_bf16 v[156:159], v[252:255], v[188:191], v[156:159]
L_topw:
    ds_read_b32 v34, v32 offset:32
    s_waitcnt lgkmcnt(0)
    v_readfirstlane_b32 s38, v34
    s_nop 1
    s_cmp_ge_u32 s38, 1
    s_cbranch_scc1 L_topw_ok
    s_sub_u32 s96, s96, 1
    s_cbranch_scc1 L_topw_ok
    s_sleep 1
    s_branch L_topw
L_topw_ok:
    ds_read_b32 v60, v47
    s_sub_u32 s38, 2047, s51
    s_waitcnt lgkmcnt(0)
    v_and_b32 v60, 0x7ff, v60
    v_sub_u32 v60, s38, v60
    v_cmp_gt_u32 vcc, 32, v60
    s_nop 1
    s_and_b32 s57, vcc_lo, 0xff
L_fix:
    s_cmp_eq_u32 s57, 0
    s_cbranch_scc1 L_fixd
    s_ff1_i32_b32 s8, s57
    s_bitset0_b32 s57, s8
    v_readlane_b32 s9, v60, s8
    v_lshl_add_u32 v52, s8, 2, v32
L_dfw:
    ds_read_b32 v53, v52 offset:36
    s_waitcnt lgkmcnt(0)
    v_readfirstlane_b32 s38, v53
    s_nop 1
    s_cmp_ge_u32 s38, 1
    s_cbranch_scc1 L_dfw_ok
    s_sub_u32 s96, s96, 1
    s_cbranch_scc1 L_dfw_ok
    s_sleep 2
    s_branch L_dfw
L_dfw_ok:
    s_lshl_b32 s38, s8, 8
    s_add_u32 s38, s38, 75776
    v_lshl_add_u32 v52, v26, 4, s38
    ds_read_b128 v[48:51], v52
    s_and_b32 s38, s9, 3
    s_lshl_b32 s38, s38, 4
    s_lshl_b64 s[10:11], 0xffff, s38
    s_lshr_b32 s9, s9, 2
    s_waitcnt lgkmcnt(0)
    s_mov_b64 exec, s[10:11]
    s_cmp_lg_u32 s9, 0
    s_cbranch_scc1 L_fx0
    v_pk_add_f32 v[72:73], v[72:73], v[48:49]
    v_pk_add_f32 v[74:75], v[74:75], v[50:51]
L_fx0:
    s_cmp_lg_u32 s9, 1
    s_cbranch_scc1 L_fx1
    v_pk_add_f32 v[76:77], v[76:77], v[48:49]
    v_pk_add_f32 v[78:79], v[78:79], v[50:51]
L_fx1:
    s_cmp_lg_u32 s9, 2
    s_cbranch_scc1 L_fx2
    v_pk_add_f32 v[88:89], v[88:89], v[48:49]
    v_pk_add_f32 v[90:91], v[90:91], v[50:51]
L_fx2:
    s_cmp_lg_u32 s9, 3
    s_cbranch_scc1 L_fx3
    v_pk_add_f32 v[92:93], v[92:93], v[48:49]
    v_pk_add_f32 v[94:95], v[94:95], v[50:51]
L_fx3:
    s_cmp_lg_u32 s9, 4
    s_cbranch_scc1 L_fx4
    v_pk_add_f32 v[104:105], v[104:105], v[48:49]
    v_pk_add_f32 v[106:107], v[106:107], v[50:51]
L_fx4:
    s_cmp_lg_u32 s9, 5
    s_cbranch_scc1 L_fx5
    v_pk_add_f32 v[108:109], v[108:109], v[48:49]
    v_pk_add_f32 v[110:111], v[110:111], v[50:51]
L_fx5:
    s_cmp_lg_u32 s9, 6
    s_cbranch_scc1 L_fx6
    v_pk_add_f32 v[120:121], v[120:121], v[48:49]
    v_pk_add_f32 v[122:123], v[122:123], v[50:51]
L_fx6:
    s_cmp_lg_u32 s9, 7
    s_cbranch_scc1 L_fx7
    v_pk_add_f32 v[124:125], v[124:125], v[48:49]
    v_pk_add_f32 v[126:127], v[126:127], v[50:51]
L_fx7:
    s_mov_b64 exec, -1
    s_branch L_fix
L_fixd:
    ds_read_b128 v[240:243], v23 offset:16384
    ds_read_b128 v[244:247], v23 offset:18432
    ds_read_b128 v[248:251], v23 offset:20480
    ds_read_b128 v[252:255], v23 offset:22528
    s_waitcnt vmcnt(6) lgkmcnt(4)
    v_mfma_f32_16x16x32_bf16 v[128:131], v[224:227], v[192:195], v[128:131]
    v_mfma_f32_16x16x32_bf16 v[132:135], v[228:231], v[192:195], v[132:135]
    v_mfma_f32_16x16x32_bf16 v[136:139], v[232:235], v[192:195], v[136:139]
    v_mfma_f32_16x16x32_bf16 v[140:143], v[236:239], v[192:195], v[140:143]
    v_mfma_f32_16x16x32_bf16 v[144:147], v[224:227], v[196:199], v[144:147]
    v_mfma_f32_16x16x32_bf16 v[148:151], v[228:231], v[196:199], v[148:151]
    v_mfma_f32_16x16x32_bf16 v[152:155], v[232:235], v[196:199], v[152:155]
    v_mfma_f32_16x16x32_bf16 v[156:159], v[236:239], v[196:199], v[156:159]
    ds_read_b128 v[224:227], v22 offset:24576
    ds_read_b128 v[228:231], v22 offset:26624
    ds_read_b128 v[232:235], v22 offset:28672
    ds_read_b128 v[236:239], v22 offset:30720
    s_waitcnt vmcnt(4) lgkmcnt(4)
    v_mfma_f32_16x16x32_bf16 v[128:131], v[240:243], v[200:203], v[128:131]
    v_mfma_f32_16x16x32_bf16 v[132:135], v[244:247], v[200:203], v[132:135]
    v_mfma_f32_16x16x32_bf16 v[136:139], v[248:251], v[200:203], v[136:139]
    v_mfma_f32_16x16x32_bf16 v[140:143], v[252:255], v[200:203], v[140:143]
    v_mfma_f32_16x16x32_bf16 v[144:147], v[240:243], v[204:207], v[144:147]
    v_mfma_f32_16x16x32_bf16 v[148:151], v[244:247], v[204:207], v[148:151]
    v_mfma_f32_16x16x32_bf16 v[152:155], v[248:251], v[204:207], v[152:155]
    v_mfma_f32_16x16x32_bf16 v[156:159], v[252:255], v[204:207], v[156:159]
    ds_read_b128 v[240:243], v23 offset:24576
    ds_read_b128 v[244:247], v23 offset:26624
    ds_read_b128 v[248:251], v23 offset:28672
    ds_read_b128 v[252:255], v23 offset:30720
    s_waitcnt vmcnt(2) lgkmcnt(4)
    v_mfma_f32_16x16x32_bf16 v[128:131], v[224:227], v[208:211], v[128:131]
    v_mfma_f32_16x16x32_bf16 v[132:135], v[228:231], v[208:211], v[132:135]
    v_mfma_f32_16x16x32_bf16 v[136:139], v[232:235], v[208:211], v[136:139]
    v_mfma_f32_16x16x32_bf16 v[140:143], v[236:239], v[208:211], v[140:143]
    v_mfma_f32_16x16x32_bf16 v[144:147], v[224:227], v[212:215], v[144:147]
    v_mfma_f32_16x16x32_bf16 v[148:151], v[228:231], v[212:215], v[148:151]
    v_mfma_f32_16x16x32_bf16 v[152:155], v[232:235], v[212:215], v[152:155]
    v_mfma_f32_16x16x32_bf16 v[156:159], v[236:239], v[212:215], v[156:159]
    s_waitcnt vmcnt(0) lgkmcnt(0)
    v_mfma_f32_16x16x32_bf16 v[128:131], v[240:243], v[216:219], v[128:131]
    v_mfma_f32_16x16x32_bf16 v[132:135], v[244:247], v[216:219], v[132:135]
    v_mfma_f32_16x16x32_bf16 v[136:139], v[248:251], v[216:219], v[136:139]
    v_mfma_f32_16x16x32_bf16 v[140:143], v[252:255], v[216:219], v[140:143]
    v_mfma_f32_16x16x32_bf16 v[144:147], v[240:243], v[220:223], v[144:147]
    v_mfma_f32_16x16x32_bf16 v[148:151], v[244:247], v[220:223], v[148:151]
    v_mfma_f32_16x16x32_bf16 v[152:155], v[248:251], v[220:223], v[152:155]
    v_mfma_f32_16x16x32_bf16 v[156:159], v[252:255], v[220:223], v[156:159]
    s_nop 3
    ds_write_b128 v44, v[128:131] offset:0
    ds_write_b128 v44, v[132:135] offset:64
    ds_write_b128 v44, v[136:139] offset:128
    ds_write_b128 v44, v[140:143] offset:192
    ds_read_b128 v[160:163], v45 offset:0
    ds_read_b128 v[164:167], v45 offset:1088
    ds_read_b128 v[168:171], v45 offset:2176
    ds_read_b128 v[172:175], v45 offset:3264
    ds_write_b128 v44, v[144:147] offset:4352
    ds_write_b128 v44, v[148:151] offset:4416
    ds_write_b128 v44, v[152:155] offset:4480
    ds_write_b128 v44, v[156:159] offset:4544
    ds_read_b128 v[176:179], v45 offset:4352
    ds_read_b128 v[180:183], v45 offset:5440
    ds_read_b128 v[184:187], v45 offset:6528
    ds_read_b128 v[188:191], v45 offset:7616
    s_waitcnt lgkmcnt(11)
    v_pk_fma_f32 v[160:161], v[36:37], v[160:161], v[72:73] op_sel:[0,0,0] op_sel_hi:[0,1,1]
    v_pk_fma_f32 v[162:163], v[36:37], v[162:163], v[74:75] op_sel:[0,0,0] op_sel_hi:[0,1,1]
    buffer_store_dwordx4 v[160:163], v46, s[32:35], s56 offen sc1
    s_add_u32 s56, s56, 16384
    s_waitcnt lgkmcnt(10)
    v_pk_fma_f32 v[164:165], v[36:37], v[164:165], v[76:77] op_sel:[1,0,0] op_sel_hi:[1,1,1]
    v_pk_fma_f32 v[166:167], v[36:37], v[166:167], v[78:79] op_sel:[1,0,0] op_sel_hi:[1,1,1]
    buffer_store_dwordx4 v[164:167], v46, s[32:35], s56 offen sc1
    s_add_u32 s56, s56, 16384
    s_waitcnt lgkmcnt(9)
    v_pk_fma_f32 v[168:169], v[38:39], v[168:169], v[88:89] op_sel:[0,0,0] op_sel_hi:[0,1,1]
    v_pk_fma_f32 v[170:171], v[38:39], v[170:171], v[90:91] op_sel:[0,0,0] op_sel_hi:[0,1,1]
    buffer_store_dwordx4 v[168:171], v46, s[32:35], s56 offen sc1
    s_add_u32 s56, s56, 16384
    s_waitcnt lgkmcnt(8)
    v_pk_fma_f32 v[172:173], v[38:39], v[172:173], v[92:93] op_sel:[1,0,0] op_sel_hi:[1,1,1]
    v_pk_fma_f32 v[174:175], v[38:39], v[174:175], v[94:95] op_sel:[1,0,0] op_sel_hi:[1,1,1]
    buffer_store_dwordx4 v[172:175], v46, s[32:35], s56 offen sc1
    s_add_u32 s56, s56, 16384
    s_waitcnt lgkmcnt(3)
    v_pk_fma_f32 v[176:177], v[40:41], v[176:177], v[104:105] op_sel:[0,0,0] op_sel_hi:[0,1,1]
    v_pk_fma_f32 v[178:179], v[40:41], v[178:179], v[106:107] op_sel:[0,0,0] op_sel_hi:[0,1,1]
    buffer_store_dwordx4 v[176:179], v46, s[32:35], s56 offen sc1
    s_add_u32 s56, s56, 16384
    s_waitcnt lgkmcnt(2)
    v_pk_fma_f32 v[180:181], v[40:41], v[180:181], v[108:109] op_sel:[1,0,0] op_sel_hi:[1,1,1]
    v_pk_fma_f32 v[182:183], v[40:41], v[182:183], v[110:111] op_sel:[1,0,0] op_sel_hi:[1,1,1]
    buffer_store_dwordx4 v[180:183], v46, s[32:35], s56 offen sc1
    s_add_u32 s56, s56, 16384
    s_waitcnt lgkmcnt(1)
    v_pk_fma_f32 v[184:185], v[42:43], v[184:185], v[120:121] op_sel:[0,0,0] op_sel_hi:[0,1,1]
    v_pk_fma_f32 v[186:187], v[42:43], v[186:187], v[122:123] op_sel:[0,0,0] op_sel_hi:[0,1,1]
    buffer_store_dwordx4 v[184:187], v46, s[32:35], s56 offen sc1
    s_add_u32 s56, s56, 16384
    s_waitcnt lgkmcnt(0)
    v_pk_fma_f32 v[188:189], v[42:43], v[188:189], v[124:125] op_sel:[1,0,0] op_sel_hi:[1,1,1]
    v_pk_fma_f32 v[190:191], v[42:43], v[190:191], v[126:127] op_sel:[1,0,0] op_sel_hi:[1,1,1]
    buffer_store_dwordx4 v[188:191], v46, s[32:35], s56 offen sc1
    s_add_u32 s56, s56, 16384
    s_endpgm
L_code_end:
.section .rodata,"a"
.p2align 6
.amdhsa_kernel gated_mix__ssm_conv_s5__moe_arch_mod__prompt_kernel
  .amdhsa_next_free_vgpr 256
  .amdhsa_next_free_sgpr 102
  .amdhsa_accum_offset 256
  .amdhsa_group_segment_fixed_size 0
  .amdhsa_kernarg_size 144
  .amdhsa_user_sgpr_count 2
  .amdhsa_user_sgpr_kernarg_segment_ptr 1
  .amdhsa_system_sgpr_workgroup_id_x 1
  .amdhsa_float_denorm_mode_32 3
.end_amdhsa_kernel
```

```asm
; @launch grid=(256,1,1) block=(512,1,1) lds=163840
.amdgcn_target "amdgcn-amd-amdhsa--gfx950"
.text
.globl gated_mix__ssm_conv_s5__moe_arch_mod__prompt_kernel
.p2align 8
.type gated_mix__ssm_conv_s5__moe_arch_mod__prompt_kernel,@function
gated_mix__ssm_conv_s5__moe_arch_mod__prompt_kernel:
L_code_start:
    s_getpc_b64 s[32:33]
    s_load_dwordx2 s[40:41], s[0:1], 0
    s_load_dwordx16 s[64:79], s[0:1], 8
    s_load_dwordx8 s[44:51], s[0:1], 80
    s_load_dwordx4 s[80:83], s[0:1], 112
    s_load_dwordx2 s[42:43], s[0:1], 136
    v_lshrrev_b32 v1, 6, v0
    s_cmp_ge_u32 s2, 256
    s_cbranch_scc1 L_exit
    s_sub_u32 s32, s32, 4
    s_subb_u32 s33, s33, 0
    s_mov_b32 s34, L_code_end-L_code_start
    s_mov_b32 s35, 0x20000
    s_lshr_b32 s59, s2, 3
    s_lshl_b32 s59, s59, 11
    v_lshlrev_b32 v2, 2, v0
    buffer_load_dword v9, v2, s[32:35], s59 offen
    v_readfirstlane_b32 s18, v1
    s_mov_b32 s96, 1048576
    s_and_b32 s3, s2, 7
    s_lshr_b32 s39, s3, 2
    s_lshl_b32 s39, s39, 1
    s_xor_b32 s3, s3, s39
    s_lshr_b32 s38, s2, 3
    s_lshr_b32 s16, s3, 1
    s_lshl_b32 s16, s16, 2
    s_and_b32 s39, s38, 3
    s_add_u32 s16, s16, s39
    s_and_b32 s17, s3, 1
    s_lshl_b32 s17, s17, 3
    s_lshr_b32 s39, s38, 2
    s_add_u32 s17, s17, s39
    s_cmp_ge_u32 s18, 4
    s_cbranch_scc1 L_side
    v_and_b32 v26, 15, v0
    v_bfe_u32 v4, v0, 7, 1
    v_lshl_add_u32 v4, v4, 5, v26
    s_lshl_b32 s39, s17, 6
    v_add_lshl_u32 v255, s39, v4, 1
    s_waitcnt lgkmcnt(0)
    global_load_ushort v224, v255, s[64:65] offset:0
    global_load_ushort v226, v255, s[66:67] offset:0
    global_load_ushort v228, v255, s[76:77] offset:0
    global_load_ushort v225, v255, s[64:65] offset:32
    global_load_ushort v227, v255, s[66:67] offset:32
    global_load_ushort v229, v255, s[76:77] offset:32
    s_branch L_gemm
L_side:
    s_sub_u32 s18, s18, 4
    v_and_b32 v2, 63, v0
    s_lshl_b32 s19, s3, 8
    s_lshl_b32 s39, s38, 3
    s_add_u32 s19, s19, s39
    s_mov_b32 s56, 0
    s_lshl_b32 s58, s18, 12
    v_lshrrev_b32 v4, 3, v2
    v_and_b32 v5, 7, v2
    v_lshrrev_b32 v6, 4, v2
    v_xor_b32 v5, v5, v6
    v_lshlrev_b32 v5, 4, v5
    v_lshrrev_b32 v7, 1, v2
    v_and_b32 v7, 16, v7
    v_and_or_b32 v7, v2, 8, v7
    v_and_or_b32 v6, v6, 1, v7
    s_lshr_b32 s20, s18, 1
    s_and_b32 s21, s18, 1
    s_lshl_b32 s38, s20, 6
    s_lshl_b32 s39, s21, 2
    s_add_u32 s38, s38, s39
    s_lshl_b32 s39, s16, 7
    s_add_u32 s38, s38, s39
    v_add_u32 v6, s38, v6
    v_lshl_add_u32 v6, v6, 11, v5
    v_xor_b32 v7, 64, v6
    v_add_u32 v100, 3072, v6
    v_add_u32 v101, 67584, v7
    v_add_u32 v102, 5120, v6
    v_add_u32 v103, 69632, v7
    s_lshl_b32 s38, s17, 6
    s_lshl_b32 s39, s20, 5
    s_add_u32 s38, s38, s39
    v_add_u32 v6, s38, v4
    v_lshl_add_u32 v6, v6, 11, v5
    v_xor_b32 v7, 64, v6
    v_add_u32 v104, 3072, v6
    v_add_u32 v105, 18432, v7
    v_add_u32 v106, 33792, v6
    v_add_u32 v107, 49152, v7
    s_waitcnt lgkmcnt(0)
    s_sub_u32 s8, s40, 3072
    s_subb_u32 s9, s41, 0
    s_mov_b32 s10, 4197376
    s_mov_b32 s11, 0x20000
    s_add_u32 m0, s58, 0
    s_add_u32 s57, s56, 0
    s_and_b32 s57, s57, 2047
    buffer_load_dwordx4 v100, s[8:11], s57 offen offset:0  lds
    buffer_load_dwordx4 v101, s[8:11], s57 offen offset:1024  lds
    buffer_load_dwordx4 v102, s[8:11], s57 offen offset:2048  lds
    buffer_load_dwordx4 v103, s[8:11], s57 offen offset:3072  lds
    s_cmp_eq_u32 s21, 0
    s_cselect_b32 s24, s68, s70
    s_cselect_b32 s25, s69, s71
    s_sub_u32 s24, s24, 3072
    s_subb_u32 s25, s25, 0
    s_mov_b32 s26, 2100224
    s_mov_b32 s27, 0x20000
    s_add_u32 m0, s58, 16384
    s_nop 0
    buffer_load_dwordx4 v104, s[24:27], s57 offen offset:0  lds
    buffer_load_dwordx4 v105, s[24:27], s57 offen offset:1024  lds
    buffer_load_dwordx4 v106, s[24:27], s57 offen offset:2048  lds
    buffer_load_dwordx4 v107, s[24:27], s57 offen offset:3072  lds
    s_add_u32 s94, s42, 9469952
    s_addc_u32 s95, s43, 0
    s_load_dword s93, s[94:95], 0
    s_mov_b32 s12, s42
    s_mov_b32 s13, s43
    s_mov_b32 s14, 25165824
    s_mov_b32 s15, 0x20000
    s_mov_b32 s21, 0xffff0000
    v_and_b32 v11, 15, v2
    s_bfe_u32 s38, s2, 0x30003
    s_min_u32 s39, s38, 6
    s_and_b32 s36, s38, 1
    s_cmp_eq_u32 s18, 0
    s_cselect_b64 s[98:99], s[82:83], s[46:47]
    s_cselect_b64 s[100:101], s[42:43], s[48:49]
    s_cselect_b32 s39, s38, s39
    s_mov_b32 s37, s39
    s_cmp_eq_u32 s18, 2
    s_cselect_b64 s[98:99], s[50:51], s[98:99]
    s_cselect_b64 s[100:101], s[42:43], s[100:101]
    s_cselect_b32 s38, 8, 0
    s_add_u32 s37, s37, s38
    s_cmp_eq_u32 s18, 3
    s_cselect_b64 s[98:99], s[72:73], s[98:99]
    s_cselect_b64 s[100:101], s[74:75], s[100:101]
    s_cselect_b32 s39, s36, s39
    s_cselect_b32 s37, s36, s37
    s_lshl_b32 s39, s39, 20
    s_lshl_b32 s37, s37, 20
    s_load_dword s97, s[98:99], s39
    s_load_dword s97, s[100:101], s37
    s_add_u32 m0, s58, 32768
    s_add_u32 s57, s56, 128
    s_and_b32 s57, s57, 2047
    buffer_load_dwordx4 v100, s[8:11], s57 offen offset:0  lds
    buffer_load_dwordx4 v101, s[8:11], s57 offen offset:1024  lds
    buffer_load_dwordx4 v102, s[8:11], s57 offen offset:2048  lds
    buffer_load_dwordx4 v103, s[8:11], s57 offen offset:3072  lds
    s_add_u32 m0, s58, 49152
    s_nop 0
    buffer_load_dwordx4 v104, s[24:27], s57 offen offset:0  lds
    buffer_load_dwordx4 v105, s[24:27], s57 offen offset:1024  lds
    buffer_load_dwordx4 v106, s[24:27], s57 offen offset:2048  lds
    buffer_load_dwordx4 v107, s[24:27], s57 offen offset:3072  lds
    v_lshlrev_b32 v3, 4, v2
    s_mul_hi_u32 s23, s2, 76695845
    s_mul_i32 s38, s23, 56
    s_sub_u32 s22, s2, s38
    v_lshrrev_b32 v5, 3, v2
    v_and_b32 v8, 7, v2
    v_and_b32 v12, 3, v5
    v_lshlrev_b32 v12, 1, v12
    v_xor_b32 v8, v8, v12
    v_mul_u32_u24 v4, 7168, v5
    v_lshl_add_u32 v4, v8, 4, v4
    s_lshl_b32 s38, s18, 6
    s_lshl_b32 s39, s23, 8
    s_add_u32 s44, s38, s39
    s_mul_i32 s45, s44, 7168
    s_lshl_b32 s39, s22, 7
    s_add_u32 s45, s45, s39
    s_lshl_b32 s92, s18, 14
    s_add_u32 s92, s92, 98304
    s_mov_b32 s52, s46
    s_mov_b32 s53, s47
    s_mov_b32 s54, 7340032
    s_mov_b32 s55, 0x20000
    s_mov_b32 s28, s48
    s_mov_b32 s29, s49
    s_mov_b32 s30, 7340032
    s_mov_b32 s31, 0x20000
    s_mov_b32 s46, s92
    s_cmp_ge_u32 s2, 224
    s_cselect_b32 s54, 0, s54
    s_cselect_b32 s30, 0, s30
    s_and_b32 s39, s3, 1
    s_lshl_b32 s36, s39, 9
    s_lshr_b32 s39, s3, 1
    s_lshl_b32 s39, s39, 7
    s_add_u32 s36, s36, s39
    s_lshr_b32 s39, s2, 3
    s_lshl_b32 s39, s39, 2
    s_add_u32 s36, s36, s39
    s_add_u32 s36, s36, s18
    s_lshl_b32 s36, s36, 11
    s_add_u32 s84, s72, s36
    s_addc_u32 s85, s73, 0
    s_add_u32 s86, s74, s36
    s_addc_u32 s87, s75, 0
    s_lshr_b32 s37, s2, 3
    s_mul_i32 s37, s37, 4
    s_lshr_b32 s37, s37, 5
    s_mul_i32 s37, s37, 3
    s_add_u32 s37, s37, 1
    v_lshlrev_b32 v5, 11, v5
    v_lshl_add_u32 v5, v8, 4, v5
    s_lshl_b32 s47, s22, 17
    s_lshl_b32 s39, s23, 9
    s_add_u32 s47, s47, s39
    s_lshl_b32 s39, s18, 7
    s_add_u32 s47, s47, s39
    s_mov_b32 s4, s50
    s_mov_b32 s5, s51
    s_mov_b32 s6, 7340032
    s_mov_b32 s7, 0x20000
    s_cmp_ge_u32 s2, 224
    s_cselect_b32 s6, 0, s6
    v_lshrrev_b32 v10, 4, v2
    v_mov_b32 v23, 1
    s_waitcnt vmcnt(8) lgkmcnt(0)
    s_barrier
    s_add_u32 m0, s58, 65536
    s_add_u32 s57, s56, 256
    s_and_b32 s57, s57, 2047
    buffer_load_dwordx4 v100, s[8:11], s57 offen offset:0  lds
    buffer_load_dwordx4 v101, s[8:11], s57 offen offset:1024  lds
    buffer_load_dwordx4 v102, s[8:11], s57 offen offset:2048  lds
    buffer_load_dwordx4 v103, s[8:11], s57 offen offset:3072  lds
    s_add_u32 m0, s58, 81920
    s_nop 0
    buffer_load_dwordx4 v104, s[24:27], s57 offen offset:0  lds
    buffer_load_dwordx4 v105, s[24:27], s57 offen offset:1024  lds
    buffer_load_dwordx4 v106, s[24:27], s57 offen offset:2048  lds
    buffer_load_dwordx4 v107, s[24:27], s57 offen offset:3072  lds
    s_mul_i32 s93, s93, 1664525
    s_add_u32 s93, s93, 1013904223
    s_lshl_b32 s94, s18, 12
    s_add_u32 s94, s94, 9437184
    s_mov_b32 s20, 1
    s_mov_b32 s19, s58
    s_add_u32 s92, s58, 98304
    s_add_u32 s95, s57, 128
    s_and_b32 s95, s95, 2047
    s_add_u32 s97, s37, 1
    s_min_u32 s97, s97, 14
L_s_loop:
    s_mov_b32 m0, s19
    s_mov_b32 s57, s95
    s_waitcnt vmcnt(8)
    s_barrier
    buffer_load_dwordx4 v100, s[8:11], s57 offen offset:0 lds
    s_load_dword s36, s[84:85], 0
    s_load_dword s36, s[84:85], 64
    buffer_load_dwordx4 v101, s[8:11], s57 offen offset:1024 lds
    s_load_dword s36, s[86:87], 0
    s_load_dword s36, s[86:87], 64
    buffer_load_dwordx4 v102, s[8:11], s57 offen offset:2048 lds
    s_add_u32 s84, s84, 128
    s_addc_u32 s85, s85, 0
    s_add_u32 s86, s86, 128
    s_addc_u32 s87, s87, 0
    buffer_load_dwordx4 v103, s[8:11], s57 offen offset:3072 lds
    s_add_u32 s95, s57, 128
    s_and_b32 s95, s95, 2047
    s_add_u32 m0, m0, 16384
    s_nop 0
    buffer_load_dwordx4 v104, s[24:27], s57 offen offset:0 lds
    s_add_u32 s19, s19, 32768
    s_cmp_eq_u32 s19, s92
    s_cselect_b32 s19, s58, s19
    buffer_load_dwordx4 v105, s[24:27], s57 offen offset:1024 lds
    s_add_u32 s20, s20, 1
    buffer_load_dwordx4 v106, s[24:27], s57 offen offset:2048 lds
    s_cmp_lg_u32 s20, s97
    buffer_load_dwordx4 v107, s[24:27], s57 offen offset:3072 lds
    s_cbranch_scc1 L_s_loop
    s_cmp_eq_u32 s20, 14
    s_cbranch_scc1 L_s_loopend
    s_add_u32 m0, s46, 0
    s_add_u32 s39, s45, 0
    buffer_load_dwordx4 v4, s[52:55], s39 offen nt lds
    s_add_u32 m0, s46, 1024
    s_add_u32 s39, s45, 57344
    buffer_load_dwordx4 v4, s[52:55], s39 offen nt lds
    s_add_u32 m0, s46, 2048
    s_add_u32 s39, s45, 114688
    buffer_load_dwordx4 v4, s[52:55], s39 offen nt lds
    s_add_u32 m0, s46, 3072
    s_add_u32 s39, s45, 172032
    buffer_load_dwordx4 v4, s[52:55], s39 offen nt lds
    s_add_u32 m0, s46, 4096
    s_add_u32 s39, s45, 229376
    buffer_load_dwordx4 v4, s[52:55], s39 offen nt lds
    s_add_u32 m0, s46, 5120
    s_add_u32 s39, s45, 286720
    buffer_load_dwordx4 v4, s[52:55], s39 offen nt lds
    s_add_u32 m0, s46, 6144
    s_add_u32 s39, s45, 344064
    buffer_load_dwordx4 v4, s[52:55], s39 offen nt lds
    s_add_u32 m0, s46, 7168
    s_add_u32 s39, s45, 401408
    buffer_load_dwordx4 v4, s[52:55], s39 offen nt lds
    s_add_u32 m0, s46, 8192
    s_add_u32 s39, s45, 0
    buffer_load_dwordx4 v4, s[28:31], s39 offen nt lds
    s_add_u32 m0, s46, 9216
    s_add_u32 s39, s45, 57344
    buffer_load_dwordx4 v4, s[28:31], s39 offen nt lds
    s_add_u32 m0, s46, 10240
    s_add_u32 s39, s45, 114688
    buffer_load_dwordx4 v4, s[28:31], s39 offen nt lds
    s_add_u32 m0, s46, 11264
    s_add_u32 s39, s45, 172032
    buffer_load_dwordx4 v4, s[28:31], s39 offen nt lds
    s_add_u32 m0, s46, 12288
    s_add_u32 s39, s45, 229376
    buffer_load_dwordx4 v4, s[28:31], s39 offen nt lds
    s_add_u32 m0, s46, 13312
    s_add_u32 s39, s45, 286720
    buffer_load_dwordx4 v4, s[28:31], s39 offen nt lds
    s_add_u32 m0, s46, 14336
    s_add_u32 s39, s45, 344064
    buffer_load_dwordx4 v4, s[28:31], s39 offen nt lds
    s_add_u32 m0, s46, 15360
    s_add_u32 s39, s45, 401408
    buffer_load_dwordx4 v4, s[28:31], s39 offen nt lds
    v_lshlrev_b32 v9, 5, v2
    s_mov_b32 s97, 14
    s_branch L_s_loop
L_s_loopend:
    buffer_load_dwordx4 v[80:83], v3, s[12:15], s94 offen offset:0 sc1
    buffer_load_dwordx4 v[84:87], v3, s[12:15], s94 offen offset:1024 sc1
    buffer_load_dwordx4 v[88:91], v3, s[12:15], s94 offen offset:2048 sc1
    buffer_load_dwordx4 v[92:95], v3, s[12:15], s94 offen offset:3072 sc1
    s_load_dword s36, s[84:85], 0
    s_load_dword s36, s[84:85], 64
    s_load_dword s36, s[86:87], 0
    s_load_dword s36, s[86:87], 64
    s_add_u32 s84, s84, 128
    s_addc_u32 s85, s85, 0
    s_add_u32 s86, s86, 128
    s_addc_u32 s87, s87, 0
    s_waitcnt vmcnt(12)
    s_barrier
    buffer_load_dwordx4 v[200:203], v5, s[4:7], s47 offen nt
    s_add_u32 s47, s47, 16384
    buffer_load_dwordx4 v[204:207], v5, s[4:7], s47 offen nt
    s_add_u32 s47, s47, 16384
    buffer_load_dwordx4 v[208:211], v5, s[4:7], s47 offen nt
    s_add_u32 s47, s47, 16384
    buffer_load_dwordx4 v[212:215], v5, s[4:7], s47 offen nt
    s_add_u32 s47, s47, 16384
    buffer_load_dwordx4 v[216:219], v5, s[4:7], s47 offen nt
    s_add_u32 s47, s47, 16384
    buffer_load_dwordx4 v[220:223], v5, s[4:7], s47 offen nt
    s_add_u32 s47, s47, 16384
    buffer_load_dwordx4 v[224:227], v5, s[4:7], s47 offen nt
    s_add_u32 s47, s47, 16384
    buffer_load_dwordx4 v[228:231], v5, s[4:7], s47 offen nt
    s_add_u32 s47, s47, 16384
    v_bfe_u32 v12, v2, 2, 2
    v_lshl_add_u32 v13, v10, 3, v12
    v_lshlrev_b32 v13, 7, v13
    v_and_b32 v14, 3, v2
    v_lshl_add_u32 v13, v14, 3, v13
    v_add_u32 v13, s46, v13
    v_xor_b32 v14, 0, v12
    v_lshl_add_u32 v16, v14, 5, v13
    v_xor_b32 v14, 1, v12
    v_lshl_add_u32 v17, v14, 5, v13
    v_xor_b32 v14, 2, v12
    v_lshl_add_u32 v18, v14, 5, v13
    v_xor_b32 v14, 3, v12
    v_lshl_add_u32 v19, v14, 5, v13
    s_mov_b32 s8, s40
    s_mov_b32 s9, s41
    s_mov_b32 s10, 4194304
    s_mov_b32 s11, 0x20000
    v_mov_b32 v22, 73728
    s_waitcnt vmcnt(12)
    s_barrier
    s_load_dword s36, s[84:85], 0
    s_load_dword s36, s[84:85], 64
    s_load_dword s36, s[86:87], 0
    s_load_dword s36, s[86:87], 64
    s_add_u32 s84, s84, 128
    s_addc_u32 s85, s85, 0
    s_add_u32 s86, s86, 128
    s_addc_u32 s87, s87, 0
    s_load_dword s36, s[84:85], 0
    s_load_dword s36, s[84:85], 64
    s_load_dword s36, s[86:87], 0
    s_load_dword s36, s[86:87], 64
    s_add_u32 s84, s84, 128
    s_addc_u32 s85, s85, 0
    s_add_u32 s86, s86, 128
    s_addc_u32 s87, s87, 0
    s_barrier
    v_mov_b32 v8, 0
    s_mov_b32 s95, -1
    s_waitcnt vmcnt(8)
L_s_poll:
    v_xor_b32 v81, s93, v81
    v_xor_b32 v83, s93, v83
    v_xor_b32 v85, s93, v85
    v_xor_b32 v87, s93, v87
    v_xor_b32 v89, s93, v89
    v_xor_b32 v91, s93, v91
    v_xor_b32 v93, s93, v93
    v_xor_b32 v95, s93, v95
    v_or3_b32 v9, v81, v83, v85
    v_or3_b32 v9, v9, v87, v89
    v_or3_b32 v9, v9, v91, v93
    v_or_b32 v9, v9, v95
    v_cmp_ne_u32 vcc, 0, v9
    s_nop 1
    s_cmp_eq_u64 vcc, 0
    s_cbranch_scc1 L_s_go
    s_sub_u32 s96, s96, 1
    s_cbranch_scc1 L_s_go
    buffer_load_dwordx4 v[80:83], v3, s[12:15], s94 offen offset:0 sc1
    buffer_load_dwordx4 v[84:87], v3, s[12:15], s94 offen offset:1024 sc1
    buffer_load_dwordx4 v[88:91], v3, s[12:15], s94 offen offset:2048 sc1
    buffer_load_dwordx4 v[92:95], v3, s[12:15], s94 offen offset:3072 sc1
    s_waitcnt vmcnt(0)
    s_branch L_s_poll
L_s_go:
    v_sub_u32 v72, s95, v80
    v_sub_u32 v73, s95, v82
    v_sub_u32 v74, s95, v84
    v_sub_u32 v75, s95, v86
    v_sub_u32 v76, s95, v88
    v_sub_u32 v77, s95, v90
    v_sub_u32 v78, s95, v92
    v_sub_u32 v79, s95, v94
    v_min3_u32 v9, v72, v73, v74
    v_min3_u32 v15, v75, v76, v77
    v_min3_u32 v9, v9, v78, v79
    v_min_u32 v9, v9, v15
    s_nop 1
    v_min_u32_dpp v9, v9, v9 row_ror:8 row_mask:0xf bank_mask:0xf
    s_nop 1
    v_min_u32_dpp v9, v9, v9 row_ror:4 row_mask:0xf bank_mask:0xf
    s_nop 1
    v_min_u32_dpp v9, v9, v9 row_ror:2 row_mask:0xf bank_mask:0xf
    s_nop 1
    v_min_u32_dpp v9, v9, v9 row_ror:1 row_mask:0xf bank_mask:0xf
    s_nop 0
    v_readlane_b32 s48, v9, 0
    v_readlane_b32 s49, v9, 16
    v_readlane_b32 s50, v9, 32
    v_readlane_b32 s51, v9, 48
    s_nop 0
    s_min_u32 s48, s48, s49
    s_min_u32 s50, s50, s51
    s_min_u32 s48, s48, s50
    s_sub_u32 s95, s95, s48
    v_writelane_b32 v8, s95, 0
    s_sub_u32 s95, s95, 1
    v_sub_u32 v72, s95, v80
    v_sub_u32 v73, s95, v82
    v_sub_u32 v74, s95, v84
    v_sub_u32 v75, s95, v86
    v_sub_u32 v76, s95, v88
    v_sub_u32 v77, s95, v90
    v_sub_u32 v78, s95, v92
    v_sub_u32 v79, s95, v94
    v_min3_u32 v9, v72, v73, v74
    v_min3_u32 v15, v75, v76, v77
    v_min3_u32 v9, v9, v78, v79
    v_min_u32 v9, v9, v15
    s_nop 1
    v_min_u32_dpp v9, v9, v9 row_ror:8 row_mask:0xf bank_mask:0xf
    s_nop 1
    v_min_u32_dpp v9, v9, v9 row_ror:4 row_mask:0xf bank_mask:0xf
    s_nop 1
    v_min_u32_dpp v9, v9, v9 row_ror:2 row_mask:0xf bank_mask:0xf
    s_nop 1
    v_min_u32_dpp v9, v9, v9 row_ror:1 row_mask:0xf bank_mask:0xf
    s_nop 0
    v_readlane_b32 s48, v9, 0
    v_readlane_b32 s49, v9, 16
    v_readlane_b32 s50, v9, 32
    v_readlane_b32 s51, v9, 48
    s_nop 0
    s_min_u32 s48, s48, s49
    s_min_u32 s50, s50, s51
    s_min_u32 s48, s48, s50
    s_sub_u32 s95, s95, s48
    v_writelane_b32 v8, s95, 1
    s_sub_u32 s95, s95, 1
    v_sub_u32 v72, s95, v80
    v_sub_u32 v73, s95, v82
    v_sub_u32 v74, s95, v84
    v_sub_u32 v75, s95, v86
    v_sub_u32 v76, s95, v88
    v_sub_u32 v77, s95, v90
    v_sub_u32 v78, s95, v92
    v_sub_u32 v79, s95, v94
    v_min3_u32 v9, v72, v73, v74
    v_min3_u32 v15, v75, v76, v77
    v_min3_u32 v9, v9, v78, v79
    v_min_u32 v9, v9, v15
    s_nop 1
    v_min_u32_dpp v9, v9, v9 row_ror:8 row_mask:0xf bank_mask:0xf
    s_nop 1
    v_min_u32_dpp v9, v9, v9 row_ror:4 row_mask:0xf bank_mask:0xf
    s_nop 1
    v_min_u32_dpp v9, v9, v9 row_ror:2 row_mask:0xf bank_mask:0xf
    s_nop 1
    v_min_u32_dpp v9, v9, v9 row_ror:1 row_mask:0xf bank_mask:0xf
    s_nop 0
    v_readlane_b32 s48, v9, 0
    v_readlane_b32 s49, v9, 16
    v_readlane_b32 s50, v9, 32
    v_readlane_b32 s51, v9, 48
    s_nop 0
    s_min_u32 s48, s48, s49
    s_min_u32 s50, s50, s51
    s_min_u32 s48, s48, s50
    s_sub_u32 s95, s95, s48
    v_writelane_b32 v8, s95, 2
    s_sub_u32 s95, s95, 1
    v_sub_u32 v72, s95, v80
    v_sub_u32 v73, s95, v82
    v_sub_u32 v74, s95, v84
    v_sub_u32 v75, s95, v86
    v_sub_u32 v76, s95, v88
    v_sub_u32 v77, s95, v90
    v_sub_u32 v78, s95, v92
    v_sub_u32 v79, s95, v94
    v_min3_u32 v9, v72, v73, v74
    v_min3_u32 v15, v75, v76, v77
    v_min3_u32 v9, v9, v78, v79
    v_min_u32 v9, v9, v15
    s_nop 1
    v_min_u32_dpp v9, v9, v9 row_ror:8 row_mask:0xf bank_mask:0xf
    s_nop 1
    v_min_u32_dpp v9, v9, v9 row_ror:4 row_mask:0xf bank_mask:0xf
    s_nop 1
    v_min_u32_dpp v9, v9, v9 row_ror:2 row_mask:0xf bank_mask:0xf
    s_nop 1
    v_min_u32_dpp v9, v9, v9 row_ror:1 row_mask:0xf bank_mask:0xf
    s_nop 0
    v_readlane_b32 s48, v9, 0
    v_readlane_b32 s49, v9, 16
    v_readlane_b32 s50, v9, 32
    v_readlane_b32 s51, v9, 48
    s_nop 0
    s_min_u32 s48, s48, s49
    s_min_u32 s50, s50, s51
    s_min_u32 s48, s48, s50
    s_sub_u32 s95, s95, s48
    v_writelane_b32 v8, s95, 3
    s_sub_u32 s95, s95, 1
    v_sub_u32 v72, s95, v80
    v_sub_u32 v73, s95, v82
    v_sub_u32 v74, s95, v84
    v_sub_u32 v75, s95, v86
    v_sub_u32 v76, s95, v88
    v_sub_u32 v77, s95, v90
    v_sub_u32 v78, s95, v92
    v_sub_u32 v79, s95, v94
    v_min3_u32 v9, v72, v73, v74
    v_min3_u32 v15, v75, v76, v77
    v_min3_u32 v9, v9, v78, v79
    v_min_u32 v9, v9, v15
    s_nop 1
    v_min_u32_dpp v9, v9, v9 row_ror:8 row_mask:0xf bank_mask:0xf
    s_nop 1
    v_min_u32_dpp v9, v9, v9 row_ror:4 row_mask:0xf bank_mask:0xf
    s_nop 1
    v_min_u32_dpp v9, v9, v9 row_ror:2 row_mask:0xf bank_mask:0xf
    s_nop 1
    v_min_u32_dpp v9, v9, v9 row_ror:1 row_mask:0xf bank_mask:0xf
    s_nop 0
    v_readlane_b32 s48, v9, 0
    v_readlane_b32 s49, v9, 16
    v_readlane_b32 s50, v9, 32
    v_readlane_b32 s51, v9, 48
    s_nop 0
    s_min_u32 s48, s48, s49
    s_min_u32 s50, s50, s51
    s_min_u32 s48, s48, s50
    s_sub_u32 s95, s95, s48
    v_writelane_b32 v8, s95, 4
    s_sub_u32 s95, s95, 1
    v_sub_u32 v72, s95, v80
    v_sub_u32 v73, s95, v82
    v_sub_u32 v74, s95, v84
    v_sub_u32 v75, s95, v86
    v_sub_u32 v76, s95, v88
    v_sub_u32 v77, s95, v90
    v_sub_u32 v78, s95, v92
    v_sub_u32 v79, s95, v94
    v_min3_u32 v9, v72, v73, v74
    v_min3_u32 v15, v75, v76, v77
    v_min3_u32 v9, v9, v78, v79
    v_min_u32 v9, v9, v15
    s_nop 1
    v_min_u32_dpp v9, v9, v9 row_ror:8 row_mask:0xf bank_mask:0xf
    s_nop 1
    v_min_u32_dpp v9, v9, v9 row_ror:4 row_mask:0xf bank_mask:0xf
    s_nop 1
    v_min_u32_dpp v9, v9, v9 row_ror:2 row_mask:0xf bank_mask:0xf
    s_nop 1
    v_min_u32_dpp v9, v9, v9 row_ror:1 row_mask:0xf bank_mask:0xf
    s_nop 0
    v_readlane_b32 s48, v9, 0
    v_readlane_b32 s49, v9, 16
    v_readlane_b32 s50, v9, 32
    v_readlane_b32 s51, v9, 48
    s_nop 0
    s_min_u32 s48, s48, s49
    s_min_u32 s50, s50, s51
    s_min_u32 s48, s48, s50
    s_sub_u32 s95, s95, s48
    v_writelane_b32 v8, s95, 5
    s_sub_u32 s95, s95, 1
    v_sub_u32 v72, s95, v80
    v_sub_u32 v73, s95, v82
    v_sub_u32 v74, s95, v84
    v_sub_u32 v75, s95, v86
    v_sub_u32 v76, s95, v88
    v_sub_u32 v77, s95, v90
    v_sub_u32 v78, s95, v92
    v_sub_u32 v79, s95, v94
    v_min3_u32 v9, v72, v73, v74
    v_min3_u32 v15, v75, v76, v77
    v_min3_u32 v9, v9, v78, v79
    v_min_u32 v9, v9, v15
    s_nop 1
    v_min_u32_dpp v9, v9, v9 row_ror:8 row_mask:0xf bank_mask:0xf
    s_nop 1
    v_min_u32_dpp v9, v9, v9 row_ror:4 row_mask:0xf bank_mask:0xf
    s_nop 1
    v_min_u32_dpp v9, v9, v9 row_ror:2 row_mask:0xf bank_mask:0xf
    s_nop 1
    v_min_u32_dpp v9, v9, v9 row_ror:1 row_mask:0xf bank_mask:0xf
    s_nop 0
    v_readlane_b32 s48, v9, 0
    v_readlane_b32 s49, v9, 16
    v_readlane_b32 s50, v9, 32
    v_readlane_b32 s51, v9, 48
    s_nop 0
    s_min_u32 s48, s48, s49
    s_min_u32 s50, s50, s51
    s_min_u32 s48, s48, s50
    s_sub_u32 s95, s95, s48
    v_writelane_b32 v8, s95, 6
    s_sub_u32 s95, s95, 1
    v_sub_u32 v72, s95, v80
    v_sub_u32 v73, s95, v82
    v_sub_u32 v74, s95, v84
    v_sub_u32 v75, s95, v86
    v_sub_u32 v76, s95, v88
    v_sub_u32 v77, s95, v90
    v_sub_u32 v78, s95, v92
    v_sub_u32 v79, s95, v94
    v_min3_u32 v9, v72, v73, v74
    v_min3_u32 v15, v75, v76, v77
    v_min3_u32 v9, v9, v78, v79
    v_min_u32 v9, v9, v15
    s_nop 1
    v_min_u32_dpp v9, v9, v9 row_ror:8 row_mask:0xf bank_mask:0xf
    s_nop 1
    v_min_u32_dpp v9, v9, v9 row_ror:4 row_mask:0xf bank_mask:0xf
    s_nop 1
    v_min_u32_dpp v9, v9, v9 row_ror:2 row_mask:0xf bank_mask:0xf
    s_nop 1
    v_min_u32_dpp v9, v9, v9 row_ror:1 row_mask:0xf bank_mask:0xf
    s_nop 0
    v_readlane_b32 s48, v9, 0
    v_readlane_b32 s49, v9, 16
    v_readlane_b32 s50, v9, 32
    v_readlane_b32 s51, v9, 48
    s_nop 0
    s_min_u32 s48, s48, s49
    s_min_u32 s50, s50, s51
    s_min_u32 s48, s48, s50
    s_sub_u32 s95, s95, s48
    v_writelane_b32 v8, s95, 7
    s_sub_u32 s95, s95, 1
    s_lshl_b32 s38, s18, 5
    s_add_u32 s38, s38, 73856
    v_lshl_add_u32 v9, v2, 2, s38
    v_mov_b32 v15, 73856
    s_mov_b64 exec, 0xff
    ds_write_b32 v9, v8
    s_mov_b64 exec, 1
    ds_add_u32 v22, v23 offset:8
    s_mov_b64 exec, -1
L_s_cw:
    ds_read_b32 v14, v22 offset:8
    s_waitcnt lgkmcnt(0)
    v_readfirstlane_b32 s38, v14
    s_nop 1
    s_cmp_ge_u32 s38, 4
    s_cbranch_scc1 L_s_cw_ok
    s_sub_u32 s96, s96, 1
    s_cbranch_scc1 L_s_cw_ok
    s_sleep 0
    s_branch L_s_cw
L_s_cw_ok:
    v_and_b32 v9, 31, v2
    v_lshl_add_u32 v9, v9, 2, v15
    ds_read_b32 v14, v9
    ds_read_b128 v[64:67], v15 offset:0
    ds_read_b128 v[68:71], v15 offset:16
    ds_read_b128 v[72:75], v15 offset:32
    ds_read_b128 v[76:79], v15 offset:48
    ds_read_b128 v[80:83], v15 offset:64
    ds_read_b128 v[84:87], v15 offset:80
    ds_read_b128 v[88:91], v15 offset:96
    ds_read_b128 v[92:95], v15 offset:112
    v_mov_b32 v12, 0
    s_waitcnt lgkmcnt(0)
    v_cmp_gt_u32 s[48:49], v64, v14
    v_cmp_gt_u32 s[50:51], v65, v14
    s_nop 0
    v_addc_co_u32 v12, vcc, 0, v12, s[48:49]
    v_addc_co_u32 v12, vcc, 0, v12, s[50:51]
    v_cmp_gt_u32 s[48:49], v66, v14
    v_cmp_gt_u32 s[50:51], v67, v14
    s_nop 0
    v_addc_co_u32 v12, vcc, 0, v12, s[48:49]
    v_addc_co_u32 v12, vcc, 0, v12, s[50:51]
    v_cmp_gt_u32 s[48:49], v68, v14
    v_cmp_gt_u32 s[50:51], v69, v14
    s_nop 0
    v_addc_co_u32 v12, vcc, 0, v12, s[48:49]
    v_addc_co_u32 v12, vcc, 0, v12, s[50:51]
    v_cmp_gt_u32 s[48:49], v70, v14
    v_cmp_gt_u32 s[50:51], v71, v14
    s_nop 0
    v_addc_co_u32 v12, vcc, 0, v12, s[48:49]
    v_addc_co_u32 v12, vcc, 0, v12, s[50:51]
    v_cmp_gt_u32 s[48:49], v72, v14
    v_cmp_gt_u32 s[50:51], v73, v14
    s_nop 0
    v_addc_co_u32 v12, vcc, 0, v12, s[48:49]
    v_addc_co_u32 v12, vcc, 0, v12, s[50:51]
    v_cmp_gt_u32 s[48:49], v74, v14
    v_cmp_gt_u32 s[50:51], v75, v14
    s_nop 0
    v_addc_co_u32 v12, vcc, 0, v12, s[48:49]
    v_addc_co_u32 v12, vcc, 0, v12, s[50:51]
    v_cmp_gt_u32 s[48:49], v76, v14
    v_cmp_gt_u32 s[50:51], v77, v14
    s_nop 0
    v_addc_co_u32 v12, vcc, 0, v12, s[48:49]
    v_addc_co_u32 v12, vcc, 0, v12, s[50:51]
    v_cmp_gt_u32 s[48:49], v78, v14
    v_cmp_gt_u32 s[50:51], v79, v14
    s_nop 0
    v_addc_co_u32 v12, vcc, 0, v12, s[48:49]
    v_addc_co_u32 v12, vcc, 0, v12, s[50:51]
    v_cmp_gt_u32 s[48:49], v80, v14
    v_cmp_gt_u32 s[50:51], v81, v14
    s_nop 0
    v_addc_co_u32 v12, vcc, 0, v12, s[48:49]
    v_addc_co_u32 v12, vcc, 0, v12, s[50:51]
    v_cmp_gt_u32 s[48:49], v82, v14
    v_cmp_gt_u32 s[50:51], v83, v14
    s_nop 0
    v_addc_co_u32 v12, vcc, 0, v12, s[48:49]
    v_addc_co_u32 v12, vcc, 0, v12, s[50:51]
    v_cmp_gt_u32 s[48:49], v84, v14
    v_cmp_gt_u32 s[50:51], v85, v14
    s_nop 0
    v_addc_co_u32 v12, vcc, 0, v12, s[48:49]
    v_addc_co_u32 v12, vcc, 0, v12, s[50:51]
    v_cmp_gt_u32 s[48:49], v86, v14
    v_cmp_gt_u32 s[50:51], v87, v14
    s_nop 0
    v_addc_co_u32 v12, vcc, 0, v12, s[48:49]
    v_addc_co_u32 v12, vcc, 0, v12, s[50:51]
    v_cmp_gt_u32 s[48:49], v88, v14
    v_cmp_gt_u32 s[50:51], v89, v14
    s_nop 0
    v_addc_co_u32 v12, vcc, 0, v12, s[48:49]
    v_addc_co_u32 v12, vcc, 0, v12, s[50:51]
    v_cmp_gt_u32 s[48:49], v90, v14
    v_cmp_gt_u32 s[50:51], v91, v14
    s_nop 0
    v_addc_co_u32 v12, vcc, 0, v12, s[48:49]
    v_addc_co_u32 v12, vcc, 0, v12, s[50:51]
    v_cmp_gt_u32 s[48:49], v92, v14
    v_cmp_gt_u32 s[50:51], v93, v14
    s_nop 0
    v_addc_co_u32 v12, vcc, 0, v12, s[48:49]
    v_addc_co_u32 v12, vcc, 0, v12, s[50:51]
    v_cmp_gt_u32 s[48:49], v94, v14
    v_cmp_gt_u32 s[50:51], v95, v14
    s_nop 0
    v_addc_co_u32 v12, vcc, 0, v12, s[48:49]
    v_addc_co_u32 v12, vcc, 0, v12, s[50:51]
    v_lshlrev_b32 v12, 2, v12
    s_mov_b32 exec_hi, 0
    ds_permute_b32 v13, v12, v14
    s_mov_b64 exec, -1
    v_and_b32 v12, 7, v2
    v_lshlrev_b32 v12, 2, v12
    s_waitcnt lgkmcnt(0)
    ds_bpermute_b32 v8, v12, v13
    s_lshl_b32 s38, s44, 1
    s_and_b32 s38, s38, 2047
    s_waitcnt lgkmcnt(0)
    v_not_b32 v9, v8
    v_and_b32 v9, 0x7ff, v9
    v_lshlrev_b32 v9, 11, v9
    v_lshl_add_u32 v9, v10, 4, v9
    buffer_load_dwordx4 v[56:59], v9, s[8:11], s38 offen offset:0
    buffer_load_dwordx4 v[60:63], v9, s[8:11], s38 offen offset:64
    v_lshlrev_b32 v9, 2, v2
    v_add_u32 v9, 73984, v9
    s_mov_b64 exec, 0xff
    ds_write_b32 v9, v8
    s_mov_b64 exec, 1
    ds_add_u32 v22, v23 offset:32
    s_mov_b64 exec, -1
    s_or_b32 s38, s2, s18
    s_cbranch_scc1 L_s_noep
    s_mov_b64 exec, 1
    s_mov_b32 s38, 9469952
    v_mov_b32 v13, s93
    v_mov_b32 v9, 0
    buffer_store_dword v13, v9, s[12:15], s38 offen
    s_mov_b64 exec, -1
L_s_noep:
    s_cmp_ge_u32 s2, 224
    s_cbranch_scc1 L_s_cons
    s_waitcnt vmcnt(0)
    s_setprio 2
    ds_read_b64_tr_b16 v[100:101], v16 offset:0
    ds_read_b64_tr_b16 v[102:103], v16 offset:512
    ds_read_b64_tr_b16 v[104:105], v16 offset:4096
    ds_read_b64_tr_b16 v[106:107], v16 offset:4608
    ds_read_b64_tr_b16 v[108:109], v17 offset:0
    ds_read_b64_tr_b16 v[110:111], v17 offset:512
    ds_read_b64_tr_b16 v[112:113], v17 offset:4096
    ds_read_b64_tr_b16 v[114:115], v17 offset:4608
    ds_read_b64_tr_b16 v[116:117], v18 offset:0
    ds_read_b64_tr_b16 v[118:119], v18 offset:512
    ds_read_b64_tr_b16 v[120:121], v18 offset:4096
    ds_read_b64_tr_b16 v[122:123], v18 offset:4608
    ds_read_b64_tr_b16 v[124:125], v19 offset:0
    ds_read_b64_tr_b16 v[126:127], v19 offset:512
    ds_read_b64_tr_b16 v[128:129], v19 offset:4096
    ds_read_b64_tr_b16 v[130:131], v19 offset:4608
    s_waitcnt lgkmcnt(0)
    ds_read_b64_tr_b16 v[132:133], v16 offset:8192
    ds_read_b64_tr_b16 v[134:135], v16 offset:8704
    ds_read_b64_tr_b16 v[136:137], v16 offset:12288
    ds_read_b64_tr_b16 v[138:139], v16 offset:12800
    ds_read_b64_tr_b16 v[140:141], v17 offset:8192
    ds_read_b64_tr_b16 v[142:143], v17 offset:8704
    ds_read_b64_tr_b16 v[144:145], v17 offset:12288
    ds_read_b64_tr_b16 v[146:147], v17 offset:12800
    ds_read_b64_tr_b16 v[148:149], v18 offset:8192
    ds_read_b64_tr_b16 v[150:151], v18 offset:8704
    ds_read_b64_tr_b16 v[152:153], v18 offset:12288
    ds_read_b64_tr_b16 v[154:155], v18 offset:12800
    ds_read_b64_tr_b16 v[156:157], v19 offset:8192
    ds_read_b64_tr_b16 v[158:159], v19 offset:8704
    ds_read_b64_tr_b16 v[160:161], v19 offset:12288
    ds_read_b64_tr_b16 v[162:163], v19 offset:12800
    s_waitcnt lgkmcnt(0)
    v_mfma_f32_16x16x32_bf16 v[24:27], v[100:103], v[56:59], 0
    v_mfma_f32_16x16x32_bf16 v[28:31], v[108:111], v[56:59], 0
    v_mfma_f32_16x16x32_bf16 v[32:35], v[116:119], v[56:59], 0
    v_mfma_f32_16x16x32_bf16 v[36:39], v[124:127], v[56:59], 0
    v_mfma_f32_16x16x32_bf16 v[40:43], v[132:135], v[56:59], 0
    v_mfma_f32_16x16x32_bf16 v[44:47], v[140:143], v[56:59], 0
    v_mfma_f32_16x16x32_bf16 v[48:51], v[148:151], v[56:59], 0
    v_mfma_f32_16x16x32_bf16 v[52:55], v[156:159], v[56:59], 0
    v_mfma_f32_16x16x32_bf16 v[24:27], v[104:107], v[60:63], v[24:27]
    v_mfma_f32_16x16x32_bf16 v[28:31], v[112:115], v[60:63], v[28:31]
    v_mfma_f32_16x16x32_bf16 v[32:35], v[120:123], v[60:63], v[32:35]
    v_mfma_f32_16x16x32_bf16 v[36:39], v[128:131], v[60:63], v[36:39]
    v_mfma_f32_16x16x32_bf16 v[40:43], v[136:139], v[60:63], v[40:43]
    v_mfma_f32_16x16x32_bf16 v[44:47], v[144:147], v[60:63], v[44:47]
    v_mfma_f32_16x16x32_bf16 v[48:51], v[152:155], v[60:63], v[48:51]
    v_mfma_f32_16x16x32_bf16 v[52:55], v[160:163], v[60:63], v[52:55]
    v_add_u32 v13, s46, v3
    s_nop 7
    ds_write_b128 v13, v[24:27] offset:0
    ds_write_b128 v13, v[28:31] offset:1024
    ds_write_b128 v13, v[32:35] offset:2048
    ds_write_b128 v13, v[36:39] offset:3072
    ds_write_b128 v13, v[40:43] offset:4096
    ds_write_b128 v13, v[44:47] offset:5120
    ds_write_b128 v13, v[48:51] offset:6144
    ds_write_b128 v13, v[52:55] offset:7168
    s_mov_b64 exec, 1
    ds_add_u32 v22, v23 offset:0
    s_mov_b64 exec, -1
    v_and_b32 v14, 8, v2
    v_lshl_add_u32 v13, v14, 7, v3
    s_lshl_b32 s38, s18, 11
    s_add_u32 s38, s38, 98304
    v_add_u32 v13, s38, v13
    v_and_b32 v12, 7, v2
    v_mul_u32_u24 v12, 14336, v12
    v_lshl_add_u32 v12, v10, 4, v12
    v_lshl_add_u32 v12, v14, 3, v12
    s_mul_i32 s56, s23, 229376
    s_lshl_b32 s39, s22, 8
    s_add_u32 s56, s56, s39
    s_lshr_b32 s39, s18, 1
    s_mul_i32 s39, s39, 114688
    s_add_u32 s56, s56, s39
    s_and_b32 s39, s18, 1
    s_lshl_b32 s39, s39, 7
    s_add_u32 s56, s56, s39
    s_add_u32 s56, s56, 10485760
L_s_guw:
    ds_read_b32 v15, v22 offset:0
    s_waitcnt lgkmcnt(0)
    v_readfirstlane_b32 s38, v15
    s_nop 1
    s_cmp_ge_u32 s38, 4
    s_cbranch_scc1 L_s_guw_ok
    s_sub_u32 s96, s96, 1
    s_cbranch_scc1 L_s_guw_ok
    s_sleep 0
    s_branch L_s_guw
L_s_guw_ok:
    ds_read_b128 v[64:67], v13 offset:0
    ds_read_b128 v[68:71], v13 offset:16384
    ds_read_b128 v[72:75], v13 offset:32768
    ds_read_b128 v[76:79], v13 offset:49152
    s_lshl_b32 s58, s22, 10
    s_lshl_b32 s39, s23, 8
    s_add_u32 s58, s58, s39
    s_add_u32 s58, s58, 9568256
    s_waitcnt lgkmcnt(0)
    v_pk_add_f32 v[64:65], v[64:65], v[68:69]
    v_pk_add_f32 v[72:73], v[72:73], v[76:77]
    v_pk_add_f32 v[64:65], v[64:65], v[72:73]
    v_pk_add_f32 v[66:67], v[66:67], v[70:71]
    v_pk_add_f32 v[74:75], v[74:75], v[78:79]
    v_pk_add_f32 v[66:67], v[66:67], v[74:75]
    buffer_store_dwordx4 v[64:67], v12, s[12:15], s56 offen sc1
    v_mov_b32 v13, s93
    v_lshlrev_b32 v14, 2, v2
    s_waitcnt vmcnt(0)
    v_mov_b32 v15, 1
    s_mov_b64 exec, 1
    ds_add_rtn_u32 v15, v22, v15 offset:28
    s_mov_b64 exec, -1
    s_waitcnt lgkmcnt(0)
    v_readfirstlane_b32 s39, v15
    s_nop 1
    s_cmp_lg_u32 s39, 3
    s_cbranch_scc1 L_s_nogf
    s_mov_b32 exec_hi, 0
    buffer_store_dword v13, v14, s[12:15], s58 offen sc1
    s_mov_b32 exec_hi, -1
L_s_nogf:
    v_add_u32 v13, s46, v3
    ds_write_b128 v13, v[200:203] offset:8192
    ds_write_b128 v13, v[204:207] offset:9216
    ds_write_b128 v13, v[208:211] offset:10240
    ds_write_b128 v13, v[212:215] offset:11264
    ds_write_b128 v13, v[216:219] offset:12288
    ds_write_b128 v13, v[220:223] offset:13312
    ds_write_b128 v13, v[224:227] offset:14336
    ds_write_b128 v13, v[228:231] offset:15360
    s_lshl_b32 s56, s22, 10
    s_add_u32 s56, s56, 9568256
    v_and_b32 v13, 3, v2
    v_lshlrev_b32 v13, 8, v13
    v_lshrrev_b32 v6, 5, v2
    v_lshl_add_u32 v6, s18, 1, v6
    v_and_b32 v7, 1, v10
    v_lshl_add_u32 v9, v7, 3, v6
    v_mul_u32_u24 v9, 14336, v9
    v_lshl_add_u32 v9, v11, 4, v9
    s_cmp_lg_u32 s18, 0
    s_cbranch_scc1 L_s_gw
L_s_gpoll:
    s_mov_b64 exec, 0xf
    buffer_load_dword v14, v13, s[12:15], s56 offen sc1
    s_waitcnt vmcnt(0)
    v_cmp_ne_u32 vcc, s93, v14
    s_mov_b64 exec, -1
    s_nop 0
    s_cmp_eq_u64 vcc, 0
    s_cbranch_scc1 L_s_ggo
    s_sub_u32 s96, s96, 1
    s_cbranch_scc1 L_s_ggo
    s_sleep 6
    s_branch L_s_gpoll
L_s_ggo:
    s_mov_b64 exec, 1
    ds_add_u32 v22, v23 offset:68
    s_mov_b64 exec, -1
L_s_gw:
    ds_read_b32 v15, v22 offset:68
    s_waitcnt lgkmcnt(0)
    v_readfirstlane_b32 s38, v15
    s_nop 1
    s_cmp_ge_u32 s38, 1
    s_cbranch_scc1 L_s_gw_ok
    s_sub_u32 s96, s96, 1
    s_cbranch_scc1 L_s_gw_ok
    s_sleep 2
    s_branch L_s_gw
L_s_gw_ok:
    s_lshl_b32 s38, s22, 8
    s_add_u32 s38, s38, 10485760
    buffer_load_dwordx4 v[24:27], v9, s[12:15], s38 offen sc1
    s_add_u32 s38, s38, 229376
    buffer_load_dwordx4 v[28:31], v9, s[12:15], s38 offen sc1
    s_add_u32 s38, s38, 229376
    buffer_load_dwordx4 v[32:35], v9, s[12:15], s38 offen sc1
    s_add_u32 s38, s38, 229376
    buffer_load_dwordx4 v[36:39], v9, s[12:15], s38 offen sc1
    s_add_u32 s38, s38, 229376
    ds_read_b64_tr_b16 v[64:65], v16 offset:8192
    ds_read_b64_tr_b16 v[66:67], v16 offset:8704
    ds_read_b64_tr_b16 v[68:69], v16 offset:12288
    ds_read_b64_tr_b16 v[70:71], v16 offset:12800
    ds_read_b64_tr_b16 v[72:73], v17 offset:8192
    ds_read_b64_tr_b16 v[74:75], v17 offset:8704
    ds_read_b64_tr_b16 v[76:77], v17 offset:12288
    ds_read_b64_tr_b16 v[78:79], v17 offset:12800
    ds_read_b64_tr_b16 v[80:81], v18 offset:8192
    ds_read_b64_tr_b16 v[82:83], v18 offset:8704
    ds_read_b64_tr_b16 v[84:85], v18 offset:12288
    ds_read_b64_tr_b16 v[86:87], v18 offset:12800
    ds_read_b64_tr_b16 v[88:89], v19 offset:8192
    ds_read_b64_tr_b16 v[90:91], v19 offset:8704
    ds_read_b64_tr_b16 v[92:93], v19 offset:12288
    ds_read_b64_tr_b16 v[94:95], v19 offset:12800
    s_waitcnt vmcnt(0)
    v_pk_add_f32 v[24:25], v[24:25], v[28:29]
    v_pk_add_f32 v[32:33], v[32:33], v[36:37]
    v_pk_add_f32 v[24:25], v[24:25], v[32:33]
    v_pk_add_f32 v[26:27], v[26:27], v[30:31]
    v_pk_add_f32 v[34:35], v[34:35], v[38:39]
    v_pk_add_f32 v[26:27], v[26:27], v[34:35]
    v_cvt_pk_bf16_f32 v24, v24, v24
    v_lshlrev_b32 v24, 16, v24
    v_mov_b32 v28, v24
    v_cvt_pk_bf16_f32 v25, v25, v25
    v_lshlrev_b32 v25, 16, v25
    v_mov_b32 v29, v25
    v_cvt_pk_bf16_f32 v26, v26, v26
    v_lshlrev_b32 v26, 16, v26
    v_mov_b32 v30, v26
    v_cvt_pk_bf16_f32 v27, v27, v27
    v_lshlrev_b32 v27, 16, v27
    v_mov_b32 v31, v27
    s_nop 1
    v_permlane16_swap_b32 v24, v28
    v_permlane16_swap_b32 v25, v29
    v_permlane16_swap_b32 v26, v30
    v_permlane16_swap_b32 v27, v31
    s_nop 1
    v_mul_f32 v40, 0xbfb8aa3b, v24
    v_exp_f32 v40, v40
    s_nop 0
    v_add_f32 v40, 1.0, v40
    v_rcp_f32 v40, v40
    s_nop 0
    v_mul_f32 v40, v40, v24
    v_cvt_pk_bf16_f32 v40, v40, v40
    v_lshlrev_b32 v40, 16, v40
    v_mul_f32 v40, v40, v28
    v_mul_f32 v41, 0xbfb8aa3b, v25
    v_exp_f32 v41, v41
    s_nop 0
    v_add_f32 v41, 1.0, v41
    v_rcp_f32 v41, v41
    s_nop 0
    v_mul_f32 v41, v41, v25
    v_cvt_pk_bf16_f32 v41, v41, v41
    v_lshlrev_b32 v41, 16, v41
    v_mul_f32 v41, v41, v29
    v_mul_f32 v42, 0xbfb8aa3b, v26
    v_exp_f32 v42, v42
    s_nop 0
    v_add_f32 v42, 1.0, v42
    v_rcp_f32 v42, v42
    s_nop 0
    v_mul_f32 v42, v42, v26
    v_cvt_pk_bf16_f32 v42, v42, v42
    v_lshlrev_b32 v42, 16, v42
    v_mul_f32 v42, v42, v30
    v_mul_f32 v43, 0xbfb8aa3b, v27
    v_exp_f32 v43, v43
    s_nop 0
    v_add_f32 v43, 1.0, v43
    v_rcp_f32 v43, v43
    s_nop 0
    v_mul_f32 v43, v43, v27
    v_cvt_pk_bf16_f32 v43, v43, v43
    v_lshlrev_b32 v43, 16, v43
    v_mul_f32 v43, v43, v31
    v_cvt_pk_bf16_f32 v40, v40, v41
    v_cvt_pk_bf16_f32 v41, v42, v43
    v_mul_u32_u24 v9, 144, v6
    v_lshl_add_u32 v9, v11, 3, v9
    v_add_u32 v9, 74240, v9
    ds_write_b64 v9, v[40:41]
    s_mov_b64 exec, 1
    ds_add_u32 v22, v23 offset:20
    s_mov_b64 exec, -1
    v_and_b32 v9, 7, v2
    v_mul_u32_u24 v9, 144, v9
    v_lshl_add_u32 v9, v10, 4, v9
    v_add_u32 v9, 74240, v9
L_s_aw:
    ds_read_b32 v15, v22 offset:20
    s_waitcnt lgkmcnt(0)
    v_readfirstlane_b32 s38, v15
    s_nop 1
    s_cmp_ge_u32 s38, 4
    s_cbranch_scc1 L_s_aw_ok
    s_sub_u32 s96, s96, 1
    s_cbranch_scc1 L_s_aw_ok
    s_sleep 1
    s_branch L_s_aw
L_s_aw_ok:
    ds_read_b128 v[40:43], v9
    ds_read_b128 v[44:47], v9 offset:64
    s_mov_b32 s38, 229376
    v_and_b32 v15, 7, v2
    v_mul_lo_u32 v15, v15, s38
    v_lshl_add_u32 v15, v10, 4, v15
    v_and_b32 v14, 8, v2
    v_lshl_add_u32 v15, v14, 3, v15
    s_lshl_b32 s38, s22, 12
    s_lshl_b32 s39, s23, 10
    s_add_u32 s38, s38, s39
    s_lshl_b32 s39, s18, 8
    s_add_u32 s38, s38, s39
    s_add_u32 s38, s38, 13631488
    v_cmp_eq_u32 vcc, 8, v14
    s_waitcnt lgkmcnt(0)
    v_mfma_f32_16x16x32_bf16 v[48:51], v[64:67], v[40:43], 0
    v_mfma_f32_16x16x32_bf16 v[52:55], v[72:75], v[40:43], 0
    v_mfma_f32_16x16x32_bf16 v[56:59], v[80:83], v[40:43], 0
    v_mfma_f32_16x16x32_bf16 v[60:63], v[88:91], v[40:43], 0
    v_mfma_f32_16x16x32_bf16 v[48:51], v[68:71], v[44:47], v[48:51]
    v_mfma_f32_16x16x32_bf16 v[52:55], v[76:79], v[44:47], v[52:55]
    v_mfma_f32_16x16x32_bf16 v[56:59], v[84:87], v[44:47], v[56:59]
    v_mfma_f32_16x16x32_bf16 v[60:63], v[92:95], v[44:47], v[60:63]
    s_nop 7
    v_cndmask_b32 v48, v48, v52, vcc
    v_cndmask_b32 v49, v49, v53, vcc
    v_cndmask_b32 v50, v50, v54, vcc
    v_cndmask_b32 v51, v51, v55, vcc
    buffer_store_dwordx4 v[48:51], v15, s[12:15], s38 offen offset:0 sc1
    v_cndmask_b32 v56, v56, v60, vcc
    v_cndmask_b32 v57, v57, v61, vcc
    v_cndmask_b32 v58, v58, v62, vcc
    v_cndmask_b32 v59, v59, v63, vcc
    buffer_store_dwordx4 v[56:59], v15, s[12:15], s38 offen offset:128 sc1
    s_lshl_b32 s58, s23, 14
    s_lshl_b32 s39, s22, 8
    s_add_u32 s58, s58, s39
    s_add_u32 s58, s58, 9633792
    v_mov_b32 v13, s93
    v_lshlrev_b32 v14, 2, v2
    s_waitcnt vmcnt(0)
    v_mov_b32 v15, 1
    s_mov_b64 exec, 1
    ds_add_rtn_u32 v15, v22, v15 offset:24
    s_mov_b64 exec, -1
    s_waitcnt lgkmcnt(0)
    v_readfirstlane_b32 s39, v15
    s_nop 1
    s_cmp_lg_u32 s39, 3
    s_cbranch_scc1 L_s_cons
    s_mov_b32 exec_hi, 0
    buffer_store_dword v13, v14, s[12:15], s58 offen sc1
    s_mov_b32 exec_hi, -1
L_s_cons:
    s_add_u32 s38, s18, 4
    v_readlane_b32 s24, v8, s18
    v_readlane_b32 s25, v8, s38
    s_lshl_b32 s45, s16, 7
    s_and_b32 s26, s24, 0x7ff
    s_sub_u32 s26, 2047, s26
    s_sub_u32 s56, s26, s45
    s_and_b32 s27, s25, 0x7ff
    s_sub_u32 s27, 2047, s27
    s_sub_u32 s57, s27, s45
    s_waitcnt lgkmcnt(0)
    s_min_u32 s38, s56, s57
    s_cmp_ge_u32 s38, 128
    s_cbranch_scc1 L_s_end
L_s_pw:
    ds_read_b32 v15, v22 offset:16
    s_waitcnt lgkmcnt(0)
    v_readfirstlane_b32 s38, v15
    s_nop 1
    s_cmp_ge_u32 s38, 24
    s_cbranch_scc1 L_s_pw_ok
    s_sub_u32 s96, s96, 1
    s_cbranch_scc1 L_s_pw_ok
    s_sleep 8
    s_branch L_s_pw
L_s_pw_ok:
    s_lshr_b32 s58, s17, 2
    s_lshl_b32 s58, s58, 14
    s_add_u32 s58, s58, 9633792
    v_min_u32 v4, 55, v2
    v_lshlrev_b32 v4, 8, v4
    v_lshlrev_b32 v6, 12, v10
    v_lshl_add_u32 v6, v11, 4, v6
    v_lshlrev_b32 v9, 3, v11
    v_mov_b32 v7, 0
L_s_ypoll:
    buffer_load_dword v5, v4, s[12:15], s58 offen sc1
    s_waitcnt vmcnt(0)
    v_cmp_ne_u32 vcc, s93, v5
    s_nop 1
    s_cmp_eq_u64 vcc, 0
    s_cbranch_scc1 L_s_ygo
    s_sub_u32 s96, s96, 1
    s_cbranch_scc1 L_s_ygo
    s_sleep 6
    s_branch L_s_ypoll
L_s_ygo:
    s_cmp_ge_u32 s56, 128
    s_cbranch_scc1 L_s_sk0
    s_add_u32 s39, s18, 0
    s_mul_i32 s39, s39, 229376
    s_lshl_b32 s3, s17, 8
    s_add_u32 s39, s39, s3
    s_add_u32 s39, s39, 13631488
    buffer_load_dwordx4 v[24:27], v6, s[12:15], s39 offen sc1
    s_add_u32 s39, s39, 16384
    buffer_load_dwordx4 v[28:31], v6, s[12:15], s39 offen sc1
    s_add_u32 s39, s39, 16384
    buffer_load_dwordx4 v[32:35], v6, s[12:15], s39 offen sc1
    s_add_u32 s39, s39, 16384
    buffer_load_dwordx4 v[36:39], v6, s[12:15], s39 offen sc1
    s_add_u32 s39, s39, 16384
    buffer_load_dwordx4 v[40:43], v6, s[12:15], s39 offen sc1
    s_add_u32 s39, s39, 16384
    buffer_load_dwordx4 v[44:47], v6, s[12:15], s39 offen sc1
    s_add_u32 s39, s39, 16384
    buffer_load_dwordx4 v[48:51], v6, s[12:15], s39 offen sc1
    s_add_u32 s39, s39, 16384
    buffer_load_dwordx4 v[52:55], v6, s[12:15], s39 offen sc1
    s_add_u32 s39, s39, 16384
    buffer_load_dwordx4 v[56:59], v6, s[12:15], s39 offen sc1
    s_add_u32 s39, s39, 16384
    buffer_load_dwordx4 v[60:63], v6, s[12:15], s39 offen sc1
    s_add_u32 s39, s39, 16384
    buffer_load_dwordx4 v[64:67], v6, s[12:15], s39 offen sc1
    s_add_u32 s39, s39, 16384
    buffer_load_dwordx4 v[68:71], v6, s[12:15], s39 offen sc1
    s_add_u32 s39, s39, 16384
    buffer_load_dwordx4 v[72:75], v6, s[12:15], s39 offen sc1
    s_add_u32 s39, s39, 16384
    buffer_load_dwordx4 v[76:79], v6, s[12:15], s39 offen sc1
    s_add_u32 s39, s39, 16384
    s_lshl_b32 s39, s26, 11
    s_lshl_b32 s3, s17, 7
    s_add_u32 s39, s39, s3
    buffer_load_dwordx2 v[80:81], v9, s[8:11], s39 offen
    s_lshl_b32 s39, s26, 3
    s_add_u32 s39, s39, 9453568
    buffer_load_dword v82, v7, s[12:15], s39 offen sc1
L_s_sk0:
    s_cmp_ge_u32 s57, 128
    s_cbranch_scc1 L_s_sk1
    s_add_u32 s39, s18, 4
    s_mul_i32 s39, s39, 229376
    s_lshl_b32 s3, s17, 8
    s_add_u32 s39, s39, s3
    s_add_u32 s39, s39, 13631488
    buffer_load_dwordx4 v[88:91], v6, s[12:15], s39 offen sc1
    s_add_u32 s39, s39, 16384
    buffer_load_dwordx4 v[92:95], v6, s[12:15], s39 offen sc1
    s_add_u32 s39, s39, 16384
    buffer_load_dwordx4 v[96:99], v6, s[12:15], s39 offen sc1
    s_add_u32 s39, s39, 16384
    buffer_load_dwordx4 v[100:103], v6, s[12:15], s39 offen sc1
    s_add_u32 s39, s39, 16384
    buffer_load_dwordx4 v[104:107], v6, s[12:15], s39 offen sc1
    s_add_u32 s39, s39, 16384
    buffer_load_dwordx4 v[108:111], v6, s[12:15], s39 offen sc1
    s_add_u32 s39, s39, 16384
    buffer_load_dwordx4 v[112:115], v6, s[12:15], s39 offen sc1
    s_add_u32 s39, s39, 16384
    buffer_load_dwordx4 v[116:119], v6, s[12:15], s39 offen sc1
    s_add_u32 s39, s39, 16384
    buffer_load_dwordx4 v[120:123], v6, s[12:15], s39 offen sc1
    s_add_u32 s39, s39, 16384
    buffer_load_dwordx4 v[124:127], v6, s[12:15], s39 offen sc1
    s_add_u32 s39, s39, 16384
    buffer_load_dwordx4 v[128:131], v6, s[12:15], s39 offen sc1
    s_add_u32 s39, s39, 16384
    buffer_load_dwordx4 v[132:135], v6, s[12:15], s39 offen sc1
    s_add_u32 s39, s39, 16384
    buffer_load_dwordx4 v[136:139], v6, s[12:15], s39 offen sc1
    s_add_u32 s39, s39, 16384
    buffer_load_dwordx4 v[140:143], v6, s[12:15], s39 offen sc1
    s_add_u32 s39, s39, 16384
    s_lshl_b32 s39, s27, 11
    s_lshl_b32 s3, s17, 7
    s_add_u32 s39, s39, s3
    buffer_load_dwordx2 v[144:145], v9, s[8:11], s39 offen
    s_lshl_b32 s39, s27, 3
    s_add_u32 s39, s39, 9453568
    buffer_load_dword v146, v7, s[12:15], s39 offen sc1
L_s_sk1:
    s_waitcnt vmcnt(0)
    s_cmp_ge_u32 s56, 128
    s_cbranch_scc1 L_s_sc0
    s_ashr_i32 s39, s24, 31
    s_not_b32 s39, s39
    s_or_b32 s39, s39, 0x80000000
    s_xor_b32 s39, s24, s39
    s_and_b32 s39, s39, 0xffff0000
    v_mov_b32 v86, s39
    v_mul_f32 v83, 0xbfb8aa3b, v86
    v_exp_f32 v83, v83
    s_nop 0
    v_add_f32 v83, 1.0, v83
    v_rcp_f32 v83, v83
    s_nop 0
    v_cvt_pk_bf16_f32 v83, v83, v83
    v_lshlrev_b32 v83, 16, v83
    v_pk_add_f32 v[24:25], v[24:25], v[28:29]
    v_pk_add_f32 v[26:27], v[26:27], v[30:31]
    v_pk_add_f32 v[24:25], v[24:25], v[32:33]
    v_pk_add_f32 v[26:27], v[26:27], v[34:35]
    v_pk_add_f32 v[24:25], v[24:25], v[36:37]
    v_pk_add_f32 v[26:27], v[26:27], v[38:39]
    v_pk_add_f32 v[24:25], v[24:25], v[40:41]
    v_pk_add_f32 v[26:27], v[26:27], v[42:43]
    v_pk_add_f32 v[24:25], v[24:25], v[44:45]
    v_pk_add_f32 v[26:27], v[26:27], v[46:47]
    v_pk_add_f32 v[24:25], v[24:25], v[48:49]
    v_pk_add_f32 v[26:27], v[26:27], v[50:51]
    v_pk_add_f32 v[24:25], v[24:25], v[52:53]
    v_pk_add_f32 v[26:27], v[26:27], v[54:55]
    v_pk_add_f32 v[24:25], v[24:25], v[56:57]
    v_pk_add_f32 v[26:27], v[26:27], v[58:59]
    v_pk_add_f32 v[24:25], v[24:25], v[60:61]
    v_pk_add_f32 v[26:27], v[26:27], v[62:63]
    v_pk_add_f32 v[24:25], v[24:25], v[64:65]
    v_pk_add_f32 v[26:27], v[26:27], v[66:67]
    v_pk_add_f32 v[24:25], v[24:25], v[68:69]
    v_pk_add_f32 v[26:27], v[26:27], v[70:71]
    v_pk_add_f32 v[24:25], v[24:25], v[72:73]
    v_pk_add_f32 v[26:27], v[26:27], v[74:75]
    v_pk_add_f32 v[24:25], v[24:25], v[76:77]
    v_pk_add_f32 v[26:27], v[26:27], v[78:79]
    v_mov_b32 v28, v24
    v_mov_b32 v29, v25
    v_mov_b32 v30, v26
    v_mov_b32 v31, v27
    s_nop 1
    v_permlane16_swap_b32 v24, v28
    v_permlane16_swap_b32 v25, v29
    v_permlane16_swap_b32 v26, v30
    v_permlane16_swap_b32 v27, v31
    s_nop 1
    v_add_f32 v24, v24, v28
    v_add_f32 v25, v25, v29
    v_add_f32 v26, v26, v30
    v_add_f32 v27, v27, v31
    v_mov_b32 v28, v24
    v_mov_b32 v29, v25
    v_mov_b32 v30, v26
    v_mov_b32 v31, v27
    s_nop 1
    v_permlane32_swap_b32 v24, v28
    v_permlane32_swap_b32 v25, v29
    v_permlane32_swap_b32 v26, v30
    v_permlane32_swap_b32 v27, v31
    s_nop 1
    v_add_f32 v24, v24, v28
    v_add_f32 v25, v25, v29
    v_add_f32 v26, v26, v30
    v_add_f32 v27, v27, v31
    v_sub_f32 v82, 1.0, v82
    v_cvt_pk_bf16_f32 v82, v82, v82
    v_lshlrev_b32 v82, 16, v82
    v_lshlrev_b32 v32, 16, v80
    v_and_b32 v33, s21, v80
    v_lshlrev_b32 v34, 16, v81
    v_and_b32 v35, s21, v81
    v_cvt_pk_bf16_f32 v24, v24, v24
    v_lshlrev_b32 v24, 16, v24
    v_mul_f32 v24, v24, v83
    v_cvt_pk_bf16_f32 v24, v24, v24
    v_lshlrev_b32 v24, 16, v24
    v_add_f32 v24, v24, v32
    v_cvt_pk_bf16_f32 v24, v24, v24
    v_lshlrev_b32 v24, 16, v24
    v_mul_f32 v24, v24, v82
    v_cvt_pk_bf16_f32 v24, v24, v24
    v_lshlrev_b32 v24, 16, v24
    v_mul_f32 v32, v32, v82
    v_cvt_pk_bf16_f32 v32, v32, v32
    v_lshlrev_b32 v32, 16, v32
    v_sub_f32 v24, v24, v32
    v_cvt_pk_bf16_f32 v25, v25, v25
    v_lshlrev_b32 v25, 16, v25
    v_mul_f32 v25, v25, v83
    v_cvt_pk_bf16_f32 v25, v25, v25
    v_lshlrev_b32 v25, 16, v25
    v_add_f32 v25, v25, v33
    v_cvt_pk_bf16_f32 v25, v25, v25
    v_lshlrev_b32 v25, 16, v25
    v_mul_f32 v25, v25, v82
    v_cvt_pk_bf16_f32 v25, v25, v25
    v_lshlrev_b32 v25, 16, v25
    v_mul_f32 v33, v33, v82
    v_cvt_pk_bf16_f32 v33, v33, v33
    v_lshlrev_b32 v33, 16, v33
    v_sub_f32 v25, v25, v33
    v_cvt_pk_bf16_f32 v26, v26, v26
    v_lshlrev_b32 v26, 16, v26
    v_mul_f32 v26, v26, v83
    v_cvt_pk_bf16_f32 v26, v26, v26
    v_lshlrev_b32 v26, 16, v26
    v_add_f32 v26, v26, v34
    v_cvt_pk_bf16_f32 v26, v26, v26
    v_lshlrev_b32 v26, 16, v26
    v_mul_f32 v26, v26, v82
    v_cvt_pk_bf16_f32 v26, v26, v26
    v_lshlrev_b32 v26, 16, v26
    v_mul_f32 v34, v34, v82
    v_cvt_pk_bf16_f32 v34, v34, v34
    v_lshlrev_b32 v34, 16, v34
    v_sub_f32 v26, v26, v34
    v_cvt_pk_bf16_f32 v27, v27, v27
    v_lshlrev_b32 v27, 16, v27
    v_mul_f32 v27, v27, v83
    v_cvt_pk_bf16_f32 v27, v27, v27
    v_lshlrev_b32 v27, 16, v27
    v_add_f32 v27, v27, v35
    v_cvt_pk_bf16_f32 v27, v27, v27
    v_lshlrev_b32 v27, 16, v27
    v_mul_f32 v27, v27, v82
    v_cvt_pk_bf16_f32 v27, v27, v27
    v_lshlrev_b32 v27, 16, v27
    v_mul_f32 v35, v35, v82
    v_cvt_pk_bf16_f32 v35, v35, v35
    v_lshlrev_b32 v35, 16, v35
    v_sub_f32 v27, v27, v35
    s_lshl_b32 s39, s18, 8
    s_add_u32 s39, s39, 75776
    v_lshl_add_u32 v84, v11, 4, s39
    ds_write_b128 v84, v[24:27]
    v_lshl_add_u32 v85, s18, 2, v22
    s_mov_b64 exec, 1
    ds_add_u32 v85, v23 offset:36
    s_mov_b64 exec, -1
L_s_sc0:
    s_cmp_ge_u32 s57, 128
    s_cbranch_scc1 L_s_sc1
    s_ashr_i32 s39, s25, 31
    s_not_b32 s39, s39
    s_or_b32 s39, s39, 0x80000000
    s_xor_b32 s39, s25, s39
    s_and_b32 s39, s39, 0xffff0000
    v_mov_b32 v150, s39
    v_mul_f32 v147, 0xbfb8aa3b, v150
    v_exp_f32 v147, v147
    s_nop 0
    v_add_f32 v147, 1.0, v147
    v_rcp_f32 v147, v147
    s_nop 0
    v_cvt_pk_bf16_f32 v147, v147, v147
    v_lshlrev_b32 v147, 16, v147
    v_pk_add_f32 v[88:89], v[88:89], v[92:93]
    v_pk_add_f32 v[90:91], v[90:91], v[94:95]
    v_pk_add_f32 v[88:89], v[88:89], v[96:97]
    v_pk_add_f32 v[90:91], v[90:91], v[98:99]
    v_pk_add_f32 v[88:89], v[88:89], v[100:101]
    v_pk_add_f32 v[90:91], v[90:91], v[102:103]
    v_pk_add_f32 v[88:89], v[88:89], v[104:105]
    v_pk_add_f32 v[90:91], v[90:91], v[106:107]
    v_pk_add_f32 v[88:89], v[88:89], v[108:109]
    v_pk_add_f32 v[90:91], v[90:91], v[110:111]
    v_pk_add_f32 v[88:89], v[88:89], v[112:113]
    v_pk_add_f32 v[90:91], v[90:91], v[114:115]
    v_pk_add_f32 v[88:89], v[88:89], v[116:117]
    v_pk_add_f32 v[90:91], v[90:91], v[118:119]
    v_pk_add_f32 v[88:89], v[88:89], v[120:121]
    v_pk_add_f32 v[90:91], v[90:91], v[122:123]
    v_pk_add_f32 v[88:89], v[88:89], v[124:125]
    v_pk_add_f32 v[90:91], v[90:91], v[126:127]
    v_pk_add_f32 v[88:89], v[88:89], v[128:129]
    v_pk_add_f32 v[90:91], v[90:91], v[130:131]
    v_pk_add_f32 v[88:89], v[88:89], v[132:133]
    v_pk_add_f32 v[90:91], v[90:91], v[134:135]
    v_pk_add_f32 v[88:89], v[88:89], v[136:137]
    v_pk_add_f32 v[90:91], v[90:91], v[138:139]
    v_pk_add_f32 v[88:89], v[88:89], v[140:141]
    v_pk_add_f32 v[90:91], v[90:91], v[142:143]
    v_mov_b32 v92, v88
    v_mov_b32 v93, v89
    v_mov_b32 v94, v90
    v_mov_b32 v95, v91
    s_nop 1
    v_permlane16_swap_b32 v88, v92
    v_permlane16_swap_b32 v89, v93
    v_permlane16_swap_b32 v90, v94
    v_permlane16_swap_b32 v91, v95
    s_nop 1
    v_add_f32 v88, v88, v92
    v_add_f32 v89, v89, v93
    v_add_f32 v90, v90, v94
    v_add_f32 v91, v91, v95
    v_mov_b32 v92, v88
    v_mov_b32 v93, v89
    v_mov_b32 v94, v90
    v_mov_b32 v95, v91
    s_nop 1
    v_permlane32_swap_b32 v88, v92
    v_permlane32_swap_b32 v89, v93
    v_permlane32_swap_b32 v90, v94
    v_permlane32_swap_b32 v91, v95
    s_nop 1
    v_add_f32 v88, v88, v92
    v_add_f32 v89, v89, v93
    v_add_f32 v90, v90, v94
    v_add_f32 v91, v91, v95
    v_sub_f32 v146, 1.0, v146
    v_cvt_pk_bf16_f32 v146, v146, v146
    v_lshlrev_b32 v146, 16, v146
    v_lshlrev_b32 v96, 16, v144
    v_and_b32 v97, s21, v144
    v_lshlrev_b32 v98, 16, v145
    v_and_b32 v99, s21, v145
    v_cvt_pk_bf16_f32 v88, v88, v88
    v_lshlrev_b32 v88, 16, v88
    v_mul_f32 v88, v88, v147
    v_cvt_pk_bf16_f32 v88, v88, v88
    v_lshlrev_b32 v88, 16, v88
    v_add_f32 v88, v88, v96
    v_cvt_pk_bf16_f32 v88, v88, v88
    v_lshlrev_b32 v88, 16, v88
    v_mul_f32 v88, v88, v146
    v_cvt_pk_bf16_f32 v88, v88, v88
    v_lshlrev_b32 v88, 16, v88
    v_mul_f32 v96, v96, v146
    v_cvt_pk_bf16_f32 v96, v96, v96
    v_lshlrev_b32 v96, 16, v96
    v_sub_f32 v88, v88, v96
    v_cvt_pk_bf16_f32 v89, v89, v89
    v_lshlrev_b32 v89, 16, v89
    v_mul_f32 v89, v89, v147
    v_cvt_pk_bf16_f32 v89, v89, v89
    v_lshlrev_b32 v89, 16, v89
    v_add_f32 v89, v89, v97
    v_cvt_pk_bf16_f32 v89, v89, v89
    v_lshlrev_b32 v89, 16, v89
    v_mul_f32 v89, v89, v146
    v_cvt_pk_bf16_f32 v89, v89, v89
    v_lshlrev_b32 v89, 16, v89
    v_mul_f32 v97, v97, v146
    v_cvt_pk_bf16_f32 v97, v97, v97
    v_lshlrev_b32 v97, 16, v97
    v_sub_f32 v89, v89, v97
    v_cvt_pk_bf16_f32 v90, v90, v90
    v_lshlrev_b32 v90, 16, v90
    v_mul_f32 v90, v90, v147
    v_cvt_pk_bf16_f32 v90, v90, v90
    v_lshlrev_b32 v90, 16, v90
    v_add_f32 v90, v90, v98
    v_cvt_pk_bf16_f32 v90, v90, v90
    v_lshlrev_b32 v90, 16, v90
    v_mul_f32 v90, v90, v146
    v_cvt_pk_bf16_f32 v90, v90, v90
    v_lshlrev_b32 v90, 16, v90
    v_mul_f32 v98, v98, v146
    v_cvt_pk_bf16_f32 v98, v98, v98
    v_lshlrev_b32 v98, 16, v98
    v_sub_f32 v90, v90, v98
    v_cvt_pk_bf16_f32 v91, v91, v91
    v_lshlrev_b32 v91, 16, v91
    v_mul_f32 v91, v91, v147
    v_cvt_pk_bf16_f32 v91, v91, v91
    v_lshlrev_b32 v91, 16, v91
    v_add_f32 v91, v91, v99
    v_cvt_pk_bf16_f32 v91, v91, v91
    v_lshlrev_b32 v91, 16, v91
    v_mul_f32 v91, v91, v146
    v_cvt_pk_bf16_f32 v91, v91, v91
    v_lshlrev_b32 v91, 16, v91
    v_mul_f32 v99, v99, v146
    v_cvt_pk_bf16_f32 v99, v99, v99
    v_lshlrev_b32 v99, 16, v99
    v_sub_f32 v91, v91, v99
    s_lshl_b32 s39, s18, 8
    s_add_u32 s39, s39, 76800
    v_lshl_add_u32 v148, v11, 4, s39
    ds_write_b128 v148, v[88:91]
    v_lshl_add_u32 v149, s18, 2, v22
    s_mov_b64 exec, 1
    ds_add_u32 v149, v23 offset:52
    s_mov_b64 exec, -1
L_s_sc1:
L_s_end:
    s_endpgm
L_exit:
    s_endpgm
L_gemm:
    s_add_u32 s94, s42, 9469952
    s_addc_u32 s95, s43, 0
    s_load_dword s93, s[94:95], 0
    s_lshr_b32 s20, s18, 1
    s_lshl_b32 s50, s3, 8
    s_lshl_b32 s39, s38, 3
    s_add_u32 s50, s50, s39
    s_lshl_b32 s50, s50, 11
    s_lshl_b32 s51, s18, 9
    s_add_u32 s50, s50, s51
    s_lshl_b32 s39, s18, 14
    s_add_u32 m0, s39, 98304
    v_and_b32 v4, 31, v0
    v_lshlrev_b32 v4, 4, v4
    v_bfe_u32 v5, v0, 5, 1
    v_lshl_add_u32 v5, v5, 11, v4
    v_add_u32 v4, s51, v4
    v_mov_b32 v6, s44
    v_mov_b32 v7, s45
    s_mov_b32 exec_lo, 0
    v_mov_b32 v6, s80
    v_mov_b32 v7, s81
    s_mov_b32 exec_lo, -1
    v_add_co_u32 v6, vcc, v6, v4
    s_mov_b32 s4, s40
    s_mov_b32 s5, s41
    s_mov_b32 s6, 4194304
    s_mov_b32 s7, 0x20000
    v_addc_co_u32 v7, vcc, 0, v7, vcc
    buffer_load_dwordx4 v5, s[4:7], s50 offen  lds
    s_add_u32 m0, m0, 1024
    s_add_u32 s50, s50, 4096
    buffer_load_dwordx4 v5, s[4:7], s50 offen  lds
    s_add_u32 m0, m0, 1024
    s_add_u32 s50, s50, 4096
    buffer_load_dwordx4 v5, s[4:7], s50 offen  lds
    s_add_u32 m0, m0, 1024
    s_add_u32 s50, s50, 4096
    buffer_load_dwordx4 v5, s[4:7], s50 offen  lds
    s_add_u32 m0, m0, 1024
    s_add_u32 s50, s50, 4096
    global_load_lds_dwordx4 v[6:7], off
    s_and_b32 s39, s3, 1
    s_lshl_b32 s50, s39, 9
    s_lshr_b32 s39, s3, 1
    s_lshl_b32 s39, s39, 7
    s_add_u32 s50, s50, s39
    s_lshl_b32 s39, s38, 2
    s_add_u32 s50, s50, s39
    s_add_u32 s50, s50, s18
    s_lshl_b32 s50, s50, 11
    v_and_b32 v4, 63, v0
    v_lshl_add_u32 v3, v4, 5, s50
    global_load_dword v10, v3, s[68:69]
    global_load_dword v11, v3, s[70:71]
    s_mov_b64 s[8:9], s[72:73]
    s_mov_b64 s[10:11], s[74:75]
    s_mov_b64 s[52:53], s[72:73]
    s_mov_b64 s[54:55], s[74:75]
    s_mov_b64 s[58:59], s[78:79]
    s_mov_b64 s[36:37], s[82:83]
    v_and_b32 v24, 63, v0
    s_and_b32 s19, s18, 1
    s_lshl_b32 s23, s18, 12
    v_lshrrev_b32 v25, 4, v24
    v_lshrrev_b32 v56, 3, v24
    v_and_b32 v57, 7, v24
    v_lshrrev_b32 v58, 1, v56
    v_xor_b32 v57, v57, v58
    v_lshlrev_b32 v57, 4, v57
    s_mov_b32 s12, s42
    s_mov_b32 s13, s43
    s_mov_b32 s14, 25165824
    s_mov_b32 s15, 0x20000
    s_lshl_b32 s38, s17, 14
    s_add_u32 s38, s38, 8388608
    s_add_u32 s24, s42, s38
    s_addc_u32 s25, s43, 0
    s_mov_b32 s26, 16384
    s_mov_b32 s27, 0x20000
    s_cmp_lt_u32 s18, 2
    s_cselect_b32 s28, s52, s54
    s_cselect_b32 s29, s53, s55
    s_sub_u32 s28, s28, 3072
    s_subb_u32 s29, s29, 0
    s_mov_b32 s30, 2100224
    s_mov_b32 s31, 0x20000
    s_mov_b32 s32, s36
    s_mov_b32 s33, s37
    s_mov_b32 s34, 8388608
    s_mov_b32 s35, 0x20000
    v_bfe_u32 v59, v24, 1, 3
    v_xor_b32 v59, v59, v25
    v_lshlrev_b32 v59, 4, v59
    v_lshl_add_u32 v59, v26, 7, v59
    s_lshl_b32 s38, s19, 13
    s_lshl_b32 s39, s20, 13
    v_xor_b32 v58, 0, v59
    v_add_u32 v16, s38, v58
    v_add_u32 v18, s39, v58
    v_add_u32 v20, 0x10000, v16
    v_add_u32 v22, 0x10000, v18
    v_xor_b32 v58, 64, v59
    v_add_u32 v17, s38, v58
    v_add_u32 v19, s39, v58
    v_add_u32 v21, 0x10000, v17
    v_add_u32 v23, 0x10000, v19
    v_and_b32 v58, 31, v24
    v_lshlrev_b32 v27, 4, v58
    s_sub_u32 s38, 15, s16
    s_lshl_b32 s38, s38, 10
    s_lshl_b32 s39, s20, 9
    s_add_u32 s92, s38, s39
    v_add_u32 v27, s92, v27
    s_cmp_eq_u32 s19, 1
    s_cselect_b64 s[98:99], -1, 0
    s_waitcnt lgkmcnt(0)
    s_mul_i32 s93, s93, 1664525
    s_add_u32 s93, s93, 1013904223
    s_lshl_b32 s38, s20, 8
    s_add_u32 s38, s38, 32768
    v_lshl_add_u32 v193, v26, 4, s38
    s_lshl_b32 s39, s19, 11
    v_lshl_add_u32 v192, v25, 9, v193
    v_add_u32 v192, s39, v192
    v_lshlrev_b32 v194, 10, v25
    v_lshl_add_u32 v194, v26, 4, v194
    s_add_u32 s38, s92, 1024
    v_add_u32 v194, s38, v194
    v_sub_u32 v58, s16, v25
    v_mov_b32 v59, s93
    v_cmp_lt_i32 vcc, 0, v58
    s_nop 1
    v_cndmask_b32 v198, 0, v59, vcc
    v_cmp_lt_i32 vcc, 4, v58
    s_nop 1
    v_cndmask_b32 v199, 0, v59, vcc
    v_cmp_lt_i32 vcc, 8, v58
    s_nop 1
    v_cndmask_b32 v200, 0, v59, vcc
    v_cmp_lt_i32 vcc, 12, v58
    s_nop 1
    v_cndmask_b32 v201, 0, v59, vcc
    s_mul_i32 s38, s18, 9216
    s_add_u32 s38, s38, 36864
    v_mul_u32_u24 v195, 144, v26
    v_lshl_add_u32 v195, v25, 5, v195
    v_add_u32 v195, s38, v195
    v_bfe_u32 v196, v24, 2, 2
    v_lshl_add_u32 v196, v25, 3, v196
    v_mul_u32_u24 v196, 144, v196
    v_and_b32 v58, 3, v24
    v_lshl_add_u32 v196, v58, 3, v196
    v_add_u32 v196, s38, v196
    v_lshlrev_b32 v197, 4, v24
    s_lshl_b32 s38, s17, 6
    s_lshl_b32 s39, s19, 5
    s_add_u32 s38, s38, s39
    v_add_u32 v58, s38, v56
    v_lshl_add_u32 v58, v58, 11, v57
    v_xor_b32 v59, 64, v58
    v_add_u32 v202, 3072, v58
    v_add_u32 v203, 18432, v59
    v_add_u32 v204, 33792, v58
    v_add_u32 v205, 49152, v59
    s_and_b32 s55, s17, 7
    s_and_b32 s54, s17, 8
    s_lshl_b32 s48, s16, 19
    s_lshl_b32 s39, s17, 15
    s_add_u32 s53, s48, s39
    s_lshl_b32 s39, s20, 11
    s_add_u32 s53, s53, s39
    s_lshl_b32 s39, s19, 14
    s_add_u32 s53, s53, s39
    s_lshl_b32 s51, s16, 7
    s_lshl_b32 s38, s18, 5
    s_add_u32 s51, s51, s38
    s_lshl_b32 s57, s51, 3
    s_add_u32 s57, s57, 9453568
    s_lshl_b32 s56, s51, 11
    s_lshl_b32 s39, s17, 7
    s_add_u32 s56, s56, s39
    v_lshlrev_b32 v220, 11, v25
    v_lshl_add_u32 v220, v26, 3, v220
    v_and_b32 v221, 31, v24
    v_lshlrev_b32 v221, 3, v221
    v_lshl_add_u32 v222, v26, 3, s39
    s_not_b32 s39, s93
    v_mov_b32 v60, s39
    v_mov_b32 v61, s39
    v_mov_b32 v62, s39
    v_mov_b32 v63, s39
    v_lshlrev_b32 v59, 2, v24
    s_mul_hi_u32 s8, s2, 76695845
    s_mul_i32 s9, s8, 56
    s_sub_u32 s9, s2, s9
    s_lshl_b32 s10, s9, 10
    s_lshl_b32 s11, s8, 8
    s_add_u32 s10, s10, s11
    s_add_u32 s10, s10, 9568256
    s_lshl_b32 s11, s8, 14
    s_lshl_b32 s9, s9, 8
    s_add_u32 s11, s11, s9
    s_add_u32 s11, s11, 9633792
    s_lshl_b32 s9, s16, 12
    s_lshl_b32 s38, s17, 8
    s_add_u32 s9, s9, s38
    s_add_u32 s9, s9, 9502720
    s_cmp_ge_u32 s2, 224
    s_cselect_b32 s10, s9, s10
    s_cselect_b32 s11, s9, s11
    s_cmp_eq_u32 s18, 1
    s_cselect_b32 s9, s10, s9
    s_cmp_eq_u32 s18, 3
    s_cselect_b32 s9, s11, s9
    s_mov_b32 exec_hi, 0
    buffer_store_dword v60, v59, s[12:15], s9 offen sc1
    buffer_store_dwordx4 v[60:63], v27, s[24:27], 0 offen sc1
    s_mov_b32 exec_hi, -1
    s_lshl_b32 s39, s18, 14
    s_add_u32 s39, s39, 98304
    v_and_b32 v4, 7, v24
    v_lshlrev_b32 v4, 9, v4
    v_bfe_u32 v5, v24, 3, 1
    v_lshl_add_u32 v4, v5, 6, v4
    v_lshl_add_u32 v4, v25, 4, v4
    v_add_u32 v4, s39, v4
    v_and_b32 v7, 1, v24
    v_lshlrev_b32 v5, 9, v7
    v_bfe_u32 v6, v24, 1, 1
    v_lshl_add_u32 v5, v6, 6, v5
    v_lshl_add_u32 v5, v25, 4, v5
    v_add_u32 v5, s39, v5
    v_lshrrev_b32 v6, 1, v25
    v_lshlrev_b32 v6, 6, v6
    v_lshl_add_u32 v6, v7, 5, v6
    v_and_b32 v7, 1, v25
    v_lshl_add_u32 v6, v7, 4, v6
    s_lshl_b32 s39, s18, 7
    s_add_u32 s39, s39, 163328
    v_add_u32 v6, s39, v6
    s_waitcnt vmcnt(9)
    v_lshlrev_b32 v224, 16, v224
    v_lshlrev_b32 v225, 16, v225
    v_lshlrev_b32 v226, 16, v226
    v_lshlrev_b32 v227, 16, v227
    v_lshlrev_b32 v228, 16, v228
    v_lshlrev_b32 v229, 16, v229
    v_mul_f32 v230, 1069066811, v228
    v_mul_f32 v231, 1069066811, v229
    v_exp_f32 v230, v230
    v_exp_f32 v231, v231
    s_nop 0
    v_cvt_pk_bf16_f32 v230, v230, v230
    v_lshlrev_b32 v230, 16, v230
    v_cvt_pk_bf16_f32 v231, v231, v231
    v_lshlrev_b32 v231, 16, v231
    v_pk_mul_f32 v[232:233], v[230:231], v[224:225] op_sel:[0,0] op_sel_hi:[1,1]
    v_pk_mul_f32 v[234:235], v[230:231], v[226:227] op_sel:[0,0] op_sel_hi:[1,1]
    v_mul_f32 v232, 1069066811, v232
    v_mul_f32 v234, 1042479491, v234
    v_mul_f32 v233, 1069066811, v233
    v_mul_f32 v235, 1042479491, v235
    v_exp_f32 v232, v232
    v_rndne_f32 v236, v234
    v_exp_f32 v233, v233
    v_rndne_f32 v237, v235
    v_sub_f32 v234, v234, v236
    v_sub_f32 v235, v235, v237
    v_cos_f32 v236, v234
    v_sin_f32 v238, v234
    v_cos_f32 v237, v235
    v_sin_f32 v239, v235
    v_pk_mul_f32 v[240:241], v[224:225], v[224:225] op_sel:[0,0] op_sel_hi:[1,1]
    v_pk_fma_f32 v[240:241], v[226:227], v[226:227], v[240:241] op_sel:[0,0,0] op_sel_hi:[1,1,1]
    v_pk_mul_f32 v[28:29], v[232:233], v[236:237] op_sel:[0,0] op_sel_hi:[1,1]
    v_pk_mul_f32 v[30:31], v[232:233], v[238:239] op_sel:[0,0] op_sel_hi:[1,1]
    v_rcp_f32 v240, v240
    v_rcp_f32 v241, v241
    v_add_f32 v230, -1.0, v28
    v_add_f32 v231, -1.0, v29
    v_pk_add_f32 v[240:241], v[240:241], v[240:241]
    v_pk_mul_f32 v[232:233], v[230:231], v[224:225] op_sel:[0,0] op_sel_hi:[1,1]
    v_pk_fma_f32 v[232:233], v[30:31], v[226:227], v[232:233] op_sel:[0,0,0] op_sel_hi:[1,1,1]
    v_pk_mul_f32 v[234:235], v[30:31], v[224:225] op_sel:[0,0] op_sel_hi:[1,1]
    v_pk_fma_f32 v[234:235], v[230:231], v[226:227], v[234:235] op_sel:[0,0,0] op_sel_hi:[1,1,1] neg_lo:[1,0,0] neg_hi:[1,0,0]
    v_pk_mul_f32 v[32:33], v[232:233], v[240:241] op_sel:[0,0] op_sel_hi:[1,1]
    v_pk_mul_f32 v[34:35], v[234:235], v[240:241] op_sel:[0,0] op_sel_hi:[1,1]
    v_pk_mul_f32 v[224:225], v[28:29], v[28:29] op_sel:[0,0] op_sel_hi:[1,1]
    v_pk_mul_f32 v[226:227], v[28:29], v[30:31] op_sel:[0,0] op_sel_hi:[1,1]
    v_pk_fma_f32 v[224:225], v[30:31], v[30:31], v[224:225] op_sel:[0,0,0] op_sel_hi:[1,1,1] neg_lo:[1,0,0] neg_hi:[1,0,0]
    v_pk_add_f32 v[226:227], v[226:227], v[226:227]
    v_pk_mul_f32 v[228:229], v[224:225], v[224:225] op_sel:[0,0] op_sel_hi:[1,1]
    v_pk_mul_f32 v[230:231], v[224:225], v[226:227] op_sel:[0,0] op_sel_hi:[1,1]
    v_pk_fma_f32 v[228:229], v[226:227], v[226:227], v[228:229] op_sel:[0,0,0] op_sel_hi:[1,1,1] neg_lo:[1,0,0] neg_hi:[1,0,0]
    v_pk_add_f32 v[230:231], v[230:231], v[230:231]
    v_pk_mul_f32 v[36:37], v[228:229], v[228:229] op_sel:[0,0] op_sel_hi:[1,1]
    v_pk_mul_f32 v[38:39], v[228:229], v[230:231] op_sel:[0,0] op_sel_hi:[1,1]
    v_pk_fma_f32 v[36:37], v[230:231], v[230:231], v[36:37] op_sel:[0,0,0] op_sel_hi:[1,1,1] neg_lo:[1,0,0] neg_hi:[1,0,0]
    v_pk_add_f32 v[38:39], v[38:39], v[38:39]
    v_pk_mul_f32 v[40:41], v[36:37], v[36:37] op_sel:[0,0] op_sel_hi:[1,1]
    v_pk_mul_f32 v[42:43], v[36:37], v[38:39] op_sel:[0,0] op_sel_hi:[1,1]
    v_pk_fma_f32 v[40:41], v[38:39], v[38:39], v[40:41] op_sel:[0,0,0] op_sel_hi:[1,1,1] neg_lo:[1,0,0] neg_hi:[1,0,0]
    v_pk_add_f32 v[42:43], v[42:43], v[42:43]
    v_pk_mul_f32 v[224:225], v[40:41], v[40:41] op_sel:[0,0] op_sel_hi:[1,1]
    v_pk_mul_f32 v[226:227], v[40:41], v[42:43] op_sel:[0,0] op_sel_hi:[1,1]
    v_pk_fma_f32 v[224:225], v[42:43], v[42:43], v[224:225] op_sel:[0,0,0] op_sel_hi:[1,1,1] neg_lo:[1,0,0] neg_hi:[1,0,0]
    v_pk_add_f32 v[226:227], v[226:227], v[226:227]
    v_pk_mul_f32 v[228:229], v[224:225], v[224:225] op_sel:[0,0] op_sel_hi:[1,1]
    v_pk_mul_f32 v[230:231], v[224:225], v[226:227] op_sel:[0,0] op_sel_hi:[1,1]
    v_pk_fma_f32 v[228:229], v[226:227], v[226:227], v[228:229] op_sel:[0,0,0] op_sel_hi:[1,1,1] neg_lo:[1,0,0] neg_hi:[1,0,0]
    v_pk_add_f32 v[230:231], v[230:231], v[230:231]
    v_and_b32 v240, 1, v25
    v_cmp_eq_u32 s[84:85], 1, v240
    v_cmp_lt_u32 s[86:87], 1, v25
    s_nop 0
    v_cndmask_b32 v232, 1.0, v40, s[84:85]
    v_cndmask_b32 v234, 0, v42, s[84:85]
    v_cndmask_b32 v233, 1.0, v41, s[84:85]
    v_cndmask_b32 v235, 0, v43, s[84:85]
    v_cndmask_b32 v236, 1.0, v224, s[86:87]
    v_cndmask_b32 v238, 0, v226, s[86:87]
    v_cndmask_b32 v237, 1.0, v225, s[86:87]
    v_cndmask_b32 v239, 0, v227, s[86:87]
    v_pk_mul_f32 v[242:243], v[232:233], v[236:237] op_sel:[0,0] op_sel_hi:[1,1]
    v_pk_mul_f32 v[244:245], v[232:233], v[238:239] op_sel:[0,0] op_sel_hi:[1,1]
    v_pk_fma_f32 v[242:243], v[234:235], v[238:239], v[242:243] op_sel:[0,0,0] op_sel_hi:[1,1,1] neg_lo:[1,0,0] neg_hi:[1,0,0]
    v_pk_fma_f32 v[244:245], v[234:235], v[236:237], v[244:245] op_sel:[0,0,0] op_sel_hi:[1,1,1]
    v_cndmask_b32 v232, 1.0, v228, s[98:99]
    v_cndmask_b32 v234, 0, v230, s[98:99]
    v_cndmask_b32 v233, 1.0, v229, s[98:99]
    v_cndmask_b32 v235, 0, v231, s[98:99]
    v_pk_mul_f32 v[52:53], v[242:243], v[232:233] op_sel:[0,0] op_sel_hi:[1,1]
    v_pk_mul_f32 v[54:55], v[242:243], v[234:235] op_sel:[0,0] op_sel_hi:[1,1]
    v_pk_fma_f32 v[52:53], v[244:245], v[234:235], v[52:53] op_sel:[0,0,0] op_sel_hi:[1,1,1] neg_lo:[1,0,0] neg_hi:[1,0,0]
    v_pk_fma_f32 v[54:55], v[244:245], v[232:233], v[54:55] op_sel:[0,0,0] op_sel_hi:[1,1,1]
    v_pk_mul_f32 v[224:225], v[228:229], v[228:229] op_sel:[0,0] op_sel_hi:[1,1]
    v_pk_mul_f32 v[226:227], v[228:229], v[230:231] op_sel:[0,0] op_sel_hi:[1,1]
    v_pk_fma_f32 v[224:225], v[230:231], v[230:231], v[224:225] op_sel:[0,0,0] op_sel_hi:[1,1,1] neg_lo:[1,0,0] neg_hi:[1,0,0]
    v_pk_add_f32 v[226:227], v[226:227], v[226:227]
    v_pk_mul_f32 v[228:229], v[224:225], v[224:225] op_sel:[0,0] op_sel_hi:[1,1]
    v_pk_mul_f32 v[230:231], v[224:225], v[226:227] op_sel:[0,0] op_sel_hi:[1,1]
    v_pk_fma_f32 v[228:229], v[226:227], v[226:227], v[228:229] op_sel:[0,0,0] op_sel_hi:[1,1,1] neg_lo:[1,0,0] neg_hi:[1,0,0]
    v_pk_add_f32 v[230:231], v[230:231], v[230:231]
    v_pk_mul_f32 v[44:45], v[228:229], v[228:229] op_sel:[0,0] op_sel_hi:[1,1]
    v_pk_mul_f32 v[46:47], v[228:229], v[230:231] op_sel:[0,0] op_sel_hi:[1,1]
    v_pk_fma_f32 v[44:45], v[230:231], v[230:231], v[44:45] op_sel:[0,0,0] op_sel_hi:[1,1,1] neg_lo:[1,0,0] neg_hi:[1,0,0]
    v_pk_add_f32 v[46:47], v[46:47], v[46:47]
    v_cndmask_b32 v232, 1.0, v224, s[84:85]
    v_cndmask_b32 v234, 0, v226, s[84:85]
    v_cndmask_b32 v233, 1.0, v225, s[84:85]
    v_cndmask_b32 v235, 0, v227, s[84:85]
    v_cndmask_b32 v236, 1.0, v228, s[86:87]
    v_cndmask_b32 v238, 0, v230, s[86:87]
    v_cndmask_b32 v237, 1.0, v229, s[86:87]
    v_cndmask_b32 v239, 0, v231, s[86:87]
    v_pk_mul_f32 v[48:49], v[232:233], v[236:237] op_sel:[0,0] op_sel_hi:[1,1]
    v_pk_mul_f32 v[50:51], v[232:233], v[238:239] op_sel:[0,0] op_sel_hi:[1,1]
    v_pk_fma_f32 v[48:49], v[234:235], v[238:239], v[48:49] op_sel:[0,0,0] op_sel_hi:[1,1,1] neg_lo:[1,0,0] neg_hi:[1,0,0]
    v_pk_fma_f32 v[50:51], v[234:235], v[236:237], v[50:51] op_sel:[0,0,0] op_sel_hi:[1,1,1]
    v_mov_b32 v224, v52
    v_mov_b32 v226, v54
    v_mul_f32 v225, v36, v52
    v_mul_f32 v227, v36, v54
    v_fma_f32 v225, -v38, v54, v225
    v_fma_f32 v227, v38, v52, v227
    v_pk_mul_f32 v[206:207], v[32:33], v[224:225] op_sel:[0,0] op_sel_hi:[0,1]
    v_pk_mul_f32 v[208:209], v[32:33], v[226:227] op_sel:[0,0] op_sel_hi:[0,1]
    v_pk_fma_f32 v[206:207], v[34:35], v[226:227], v[206:207] op_sel:[0,0,0] op_sel_hi:[0,1,1] neg_lo:[1,0,0] neg_hi:[1,0,0]
    v_pk_fma_f32 v[208:209], v[34:35], v[224:225], v[208:209] op_sel:[0,0,0] op_sel_hi:[0,1,1]
    v_mov_b32 v224, v53
    v_mov_b32 v226, v55
    v_mul_f32 v225, v37, v53
    v_mul_f32 v227, v37, v55
    v_fma_f32 v225, -v39, v55, v225
    v_fma_f32 v227, v39, v53, v227
    v_pk_mul_f32 v[210:211], v[32:33], v[224:225] op_sel:[1,0] op_sel_hi:[1,1]
    v_pk_mul_f32 v[212:213], v[32:33], v[226:227] op_sel:[1,0] op_sel_hi:[1,1]
    v_pk_fma_f32 v[210:211], v[34:35], v[226:227], v[210:211] op_sel:[1,0,0] op_sel_hi:[1,1,1] neg_lo:[1,0,0] neg_hi:[1,0,0]
    v_pk_fma_f32 v[212:213], v[34:35], v[224:225], v[212:213] op_sel:[1,0,0] op_sel_hi:[1,1,1]
    s_waitcnt vmcnt(4)
    ds_read_b128 v[224:227], v4 offset:0
    ds_read_b128 v[240:243], v5 offset:4096
    ds_read_b128 v[228:231], v4 offset:128
    ds_read_b128 v[244:247], v5 offset:4224
    ds_read_b128 v[232:235], v4 offset:256
    ds_read_b128 v[248:251], v5 offset:4352
    ds_read_b128 v[236:239], v4 offset:384
    ds_read_b128 v[252:255], v5 offset:4480
    s_waitcnt lgkmcnt(0)
    v_mfma_f32_16x16x32_bf16 v[12:15], v[224:227], v[240:243], 0
    v_mfma_f32_16x16x32_bf16 v[12:15], v[228:231], v[244:247], v[12:15]
    v_mfma_f32_16x16x32_bf16 v[12:15], v[232:235], v[248:251], v[12:15]
    v_mfma_f32_16x16x32_bf16 v[12:15], v[236:239], v[252:255], v[12:15]
    s_lshl_b32 s39, s18, 2
    s_add_u32 s39, s39, 163312
    v_mov_b32 v4, s39
    v_mov_b32 v5, s93
    v_mov_b32 v7, 163312
    s_nop 3
    s_mov_b32 exec_lo, 0x00030003
    s_mov_b32 exec_hi, 0x000c000c
    ds_write_b128 v6, v[12:15]
    s_mov_b64 exec, -1
    ds_write_b32 v4, v5
    v_lshl_add_u32 v6, v26, 2, v7
    v_and_b32 v138, 7, v24
    s_lshl_b32 s38, s3, 8
    s_lshr_b32 s39, s2, 3
    s_lshl_b32 s39, s39, 3
    s_add_u32 s8, s38, s39
    s_sub_u32 s38, 2047, s8
    v_sub_u32 v139, s38, v138
    v_lshlrev_b32 v138, 3, v138
    v_bfe_u32 v140, v24, 3, 1
    v_lshl_add_u32 v138, v140, 14, v138
    s_lshl_b32 s8, s8, 3
    s_add_u32 s8, s8, 9437184
    s_mov_b32 s9, 0xffff0000
    s_cmp_lg_u32 s18, 0
    s_cbranch_scc1 L_nokey
L_rgw:
    ds_read_b128 v[144:147], v7
    ds_read_b32 v128, v6 offset:16
    ds_read_b32 v129, v6 offset:80
    ds_read_b32 v130, v6 offset:144
    ds_read_b32 v131, v6 offset:208
    ds_read_b32 v132, v6 offset:272
    ds_read_b32 v133, v6 offset:336
    ds_read_b32 v134, v6 offset:400
    ds_read_b32 v135, v6 offset:464
    s_waitcnt lgkmcnt(0)
    v_xor_b32 v144, s93, v144
    v_xor_b32 v145, s93, v145
    v_xor_b32 v146, s93, v146
    v_xor_b32 v147, s93, v147
    v_or3_b32 v144, v144, v145, v146
    v_or_b32 v144, v144, v147
    v_cmp_ne_u32 vcc, 0, v144
    s_nop 1
    s_cmp_eq_u64 vcc, 0
    s_cbranch_scc1 L_rgo
    s_sub_u32 s96, s96, 1
    s_cbranch_scc1 L_rgo
    s_branch L_rgw
L_rgo:
    v_not_b32 v144, s93
    v_not_b32 v145, s93
    v_not_b32 v146, s93
    v_not_b32 v147, s93
    ds_write_b128 v7, v[144:147]
    v_pk_add_f32 v[128:129], v[128:129], v[130:131]
    v_pk_add_f32 v[132:133], v[132:133], v[134:135]
    v_pk_add_f32 v[128:129], v[128:129], v[132:133]
    v_add_f32 v128, v128, v129
    v_cvt_pk_bf16_f32 v128, v128, v128
    v_lshlrev_b32 v128, 16, v128
    v_mul_f32 v130, 0xbfb8aa3b, v128
    v_exp_f32 v130, v130
    s_nop 0
    v_add_f32 v130, 1.0, v130
    v_rcp_f32 v130, v130
    s_nop 0
    v_cvt_pk_bf16_f32 v130, v130, v130
    v_lshlrev_b32 v130, 16, v130
    v_cmp_eq_u32 vcc, 1, v140
    v_ashrrev_i32 v129, 31, v128
    v_or_b32 v129, 0x80000000, v129
    v_xor_b32 v128, v128, v129
    v_and_or_b32 v128, v128, s9, v139
    v_cndmask_b32 v4, v128, v130, vcc
L_nokey:
    s_waitcnt lgkmcnt(0)
    s_barrier
    s_cmp_lg_u32 s18, 0
    s_cbranch_scc1 L_nokey2
    s_mov_b64 exec, 0xffff
    buffer_store_dwordx2 v[4:5], v138, s[12:15], s8 offen sc1
    s_mov_b64 exec, -1
L_nokey2:
    ds_read_b128 v[128:131], v16 offset:0
    ds_read_b128 v[144:147], v18 offset:16384
    ds_read_b128 v[148:151], v18 offset:18432
    ds_read_b128 v[152:155], v18 offset:20480
    ds_read_b128 v[156:159], v18 offset:22528
    ds_read_b128 v[132:135], v16 offset:2048
    ds_read_b128 v[136:139], v16 offset:4096
    ds_read_b128 v[140:143], v16 offset:6144
    s_waitcnt lgkmcnt(0)
    v_mfma_f32_16x16x32_bf16 v[64:67], v[128:131], v[144:147], 0
    ds_read_b128 v[160:163], v17 offset:0
    v_mfma_f32_16x16x32_bf16 v[68:71], v[128:131], v[148:151], 0
    ds_read_b128 v[176:179], v19 offset:16384
    v_mfma_f32_16x16x32_bf16 v[72:75], v[128:131], v[152:155], 0
    v_mfma_f32_16x16x32_bf16 v[76:79], v[128:131], v[156:159], 0
    ds_read_b128 v[180:183], v19 offset:18432
    v_mfma_f32_16x16x32_bf16 v[80:83], v[132:135], v[144:147], 0
    ds_read_b128 v[184:187], v19 offset:20480
    v_mfma_f32_16x16x32_bf16 v[84:87], v[132:135], v[148:151], 0
    v_mfma_f32_16x16x32_bf16 v[88:91], v[132:135], v[152:155], 0
    ds_read_b128 v[188:191], v19 offset:22528
    v_mfma_f32_16x16x32_bf16 v[92:95], v[132:135], v[156:159], 0
    ds_read_b128 v[164:167], v17 offset:2048
    v_mfma_f32_16x16x32_bf16 v[96:99], v[136:139], v[144:147], 0
    v_mfma_f32_16x16x32_bf16 v[100:103], v[136:139], v[148:151], 0
    ds_read_b128 v[168:171], v17 offset:4096
    v_mfma_f32_16x16x32_bf16 v[104:107], v[136:139], v[152:155], 0
    ds_read_b128 v[172:175], v17 offset:6144
    v_mfma_f32_16x16x32_bf16 v[108:111], v[136:139], v[156:159], 0
    v_mfma_f32_16x16x32_bf16 v[112:115], v[140:143], v[144:147], 0
    v_mfma_f32_16x16x32_bf16 v[116:119], v[140:143], v[148:151], 0
    v_mfma_f32_16x16x32_bf16 v[120:123], v[140:143], v[152:155], 0
    v_mfma_f32_16x16x32_bf16 v[124:127], v[140:143], v[156:159], 0
    s_waitcnt lgkmcnt(0)
    s_barrier
    v_mfma_f32_16x16x32_bf16 v[64:67], v[160:163], v[176:179], v[64:67]
    ds_read_b128 v[128:131], v16 offset:32768
    v_mfma_f32_16x16x32_bf16 v[68:71], v[160:163], v[180:183], v[68:71]
    ds_read_b128 v[144:147], v18 offset:49152
    v_mfma_f32_16x16x32_bf16 v[72:75], v[160:163], v[184:187], v[72:75]
    v_mfma_f32_16x16x32_bf16 v[76:79], v[160:163], v[188:191], v[76:79]
    ds_read_b128 v[148:151], v18 offset:51200
    v_mfma_f32_16x16x32_bf16 v[80:83], v[164:167], v[176:179], v[80:83]
    ds_read_b128 v[152:155], v18 offset:53248
    v_mfma_f32_16x16x32_bf16 v[84:87], v[164:167], v[180:183], v[84:87]
    v_mfma_f32_16x16x32_bf16 v[88:91], v[164:167], v[184:187], v[88:91]
    ds_read_b128 v[156:159], v18 offset:55296
    v_mfma_f32_16x16x32_bf16 v[92:95], v[164:167], v[188:191], v[92:95]
    ds_read_b128 v[132:135], v16 offset:34816
    v_mfma_f32_16x16x32_bf16 v[96:99], v[168:171], v[176:179], v[96:99]
    v_mfma_f32_16x16x32_bf16 v[100:103], v[168:171], v[180:183], v[100:103]
    ds_read_b128 v[136:139], v16 offset:36864
    v_mfma_f32_16x16x32_bf16 v[104:107], v[168:171], v[184:187], v[104:107]
    ds_read_b128 v[140:143], v16 offset:38912
    v_mfma_f32_16x16x32_bf16 v[108:111], v[168:171], v[188:191], v[108:111]
    v_mfma_f32_16x16x32_bf16 v[112:115], v[172:175], v[176:179], v[112:115]
    v_mfma_f32_16x16x32_bf16 v[116:119], v[172:175], v[180:183], v[116:119]
    v_mfma_f32_16x16x32_bf16 v[120:123], v[172:175], v[184:187], v[120:123]
    v_mfma_f32_16x16x32_bf16 v[124:127], v[172:175], v[188:191], v[124:127]
    s_waitcnt lgkmcnt(0)
    v_mfma_f32_16x16x32_bf16 v[64:67], v[128:131], v[144:147], v[64:67]
    ds_read_b128 v[160:163], v17 offset:32768
    v_mfma_f32_16x16x32_bf16 v[68:71], v[128:131], v[148:151], v[68:71]
    ds_read_b128 v[176:179], v19 offset:49152
    v_mfma_f32_16x16x32_bf16 v[72:75], v[128:131], v[152:155], v[72:75]
    v_mfma_f32_16x16x32_bf16 v[76:79], v[128:131], v[156:159], v[76:79]
    ds_read_b128 v[180:183], v19 offset:51200
    v_mfma_f32_16x16x32_bf16 v[80:83], v[132:135], v[144:147], v[80:83]
    ds_read_b128 v[184:187], v19 offset:53248
    v_mfma_f32_16x16x32_bf16 v[84:87], v[132:135], v[148:151], v[84:87]
    v_mfma_f32_16x16x32_bf16 v[88:91], v[132:135], v[152:155], v[88:91]
    ds_read_b128 v[188:191], v19 offset:55296
    v_mfma_f32_16x16x32_bf16 v[92:95], v[132:135], v[156:159], v[92:95]
    ds_read_b128 v[164:167], v17 offset:34816
    v_mfma_f32_16x16x32_bf16 v[96:99], v[136:139], v[144:147], v[96:99]
    v_mfma_f32_16x16x32_bf16 v[100:103], v[136:139], v[148:151], v[100:103]
    ds_read_b128 v[168:171], v17 offset:36864
    v_mfma_f32_16x16x32_bf16 v[104:107], v[136:139], v[152:155], v[104:107]
    ds_read_b128 v[172:175], v17 offset:38912
    v_mfma_f32_16x16x32_bf16 v[108:111], v[136:139], v[156:159], v[108:111]
    v_mfma_f32_16x16x32_bf16 v[112:115], v[140:143], v[144:147], v[112:115]
    v_mfma_f32_16x16x32_bf16 v[116:119], v[140:143], v[148:151], v[116:119]
    v_mfma_f32_16x16x32_bf16 v[120:123], v[140:143], v[152:155], v[120:123]
    v_mfma_f32_16x16x32_bf16 v[124:127], v[140:143], v[156:159], v[124:127]
    s_waitcnt lgkmcnt(0)
    s_barrier
    v_mfma_f32_16x16x32_bf16 v[64:67], v[160:163], v[176:179], v[64:67]
    ds_read_b128 v[128:131], v20 offset:0
    v_mfma_f32_16x16x32_bf16 v[68:71], v[160:163], v[180:183], v[68:71]
    ds_read_b128 v[144:147], v22 offset:16384
    v_mfma_f32_16x16x32_bf16 v[72:75], v[160:163], v[184:187], v[72:75]
    v_mfma_f32_16x16x32_bf16 v[76:79], v[160:163], v[188:191], v[76:79]
    ds_read_b128 v[148:151], v22 offset:18432
    v_mfma_f32_16x16x32_bf16 v[80:83], v[164:167], v[176:179], v[80:83]
    ds_read_b128 v[152:155], v22 offset:20480
    v_mfma_f32_16x16x32_bf16 v[84:87], v[164:167], v[180:183], v[84:87]
    v_mfma_f32_16x16x32_bf16 v[88:91], v[164:167], v[184:187], v[88:91]
    ds_read_b128 v[156:159], v22 offset:22528
    v_mfma_f32_16x16x32_bf16 v[92:95], v[164:167], v[188:191], v[92:95]
    ds_read_b128 v[132:135], v20 offset:2048
    v_mfma_f32_16x16x32_bf16 v[96:99], v[168:171], v[176:179], v[96:99]
    v_mfma_f32_16x16x32_bf16 v[100:103], v[168:171], v[180:183], v[100:103]
    ds_read_b128 v[136:139], v20 offset:4096
    v_mfma_f32_16x16x32_bf16 v[104:107], v[168:171], v[184:187], v[104:107]
    ds_read_b128 v[140:143], v20 offset:6144
    v_mfma_f32_16x16x32_bf16 v[108:111], v[168:171], v[188:191], v[108:111]
    v_mfma_f32_16x16x32_bf16 v[112:115], v[172:175], v[176:179], v[112:115]
    v_mfma_f32_16x16x32_bf16 v[116:119], v[172:175], v[180:183], v[116:119]
    v_mfma_f32_16x16x32_bf16 v[120:123], v[172:175], v[184:187], v[120:123]
    v_mfma_f32_16x16x32_bf16 v[124:127], v[172:175], v[188:191], v[124:127]
    s_waitcnt lgkmcnt(0)
    v_mfma_f32_16x16x32_bf16 v[64:67], v[128:131], v[144:147], v[64:67]
    ds_read_b128 v[160:163], v21 offset:0
    v_mfma_f32_16x16x32_bf16 v[68:71], v[128:131], v[148:151], v[68:71]
    ds_read_b128 v[176:179], v23 offset:16384
    v_mfma_f32_16x16x32_bf16 v[72:75], v[128:131], v[152:155], v[72:75]
    v_mfma_f32_16x16x32_bf16 v[76:79], v[128:131], v[156:159], v[76:79]
    ds_read_b128 v[180:183], v23 offset:18432
    v_mfma_f32_16x16x32_bf16 v[80:83], v[132:135], v[144:147], v[80:83]
    ds_read_b128 v[184:187], v23 offset:20480
    v_mfma_f32_16x16x32_bf16 v[84:87], v[132:135], v[148:151], v[84:87]
    v_mfma_f32_16x16x32_bf16 v[88:91], v[132:135], v[152:155], v[88:91]
    ds_read_b128 v[188:191], v23 offset:22528
    v_mfma_f32_16x16x32_bf16 v[92:95], v[132:135], v[156:159], v[92:95]
    ds_read_b128 v[164:167], v21 offset:2048
    v_mfma_f32_16x16x32_bf16 v[96:99], v[136:139], v[144:147], v[96:99]
    v_mfma_f32_16x16x32_bf16 v[100:103], v[136:139], v[148:151], v[100:103]
    ds_read_b128 v[168:171], v21 offset:4096
    v_mfma_f32_16x16x32_bf16 v[104:107], v[136:139], v[152:155], v[104:107]
    ds_read_b128 v[172:175], v21 offset:6144
    v_mfma_f32_16x16x32_bf16 v[108:111], v[136:139], v[156:159], v[108:111]
    v_mfma_f32_16x16x32_bf16 v[112:115], v[140:143], v[144:147], v[112:115]
    v_mfma_f32_16x16x32_bf16 v[116:119], v[140:143], v[148:151], v[116:119]
    v_mfma_f32_16x16x32_bf16 v[120:123], v[140:143], v[152:155], v[120:123]
    v_mfma_f32_16x16x32_bf16 v[124:127], v[140:143], v[156:159], v[124:127]
    s_waitcnt lgkmcnt(0)
    s_barrier
    v_mfma_f32_16x16x32_bf16 v[64:67], v[160:163], v[176:179], v[64:67]
    ds_read_b128 v[128:131], v16 offset:0
    v_mfma_f32_16x16x32_bf16 v[68:71], v[160:163], v[180:183], v[68:71]
    ds_read_b128 v[144:147], v18 offset:16384
    v_mfma_f32_16x16x32_bf16 v[72:75], v[160:163], v[184:187], v[72:75]
    v_mfma_f32_16x16x32_bf16 v[76:79], v[160:163], v[188:191], v[76:79]
    ds_read_b128 v[148:151], v18 offset:18432
    v_mfma_f32_16x16x32_bf16 v[80:83], v[164:167], v[176:179], v[80:83]
    ds_read_b128 v[152:155], v18 offset:20480
    v_mfma_f32_16x16x32_bf16 v[84:87], v[164:167], v[180:183], v[84:87]
    v_mfma_f32_16x16x32_bf16 v[88:91], v[164:167], v[184:187], v[88:91]
    ds_read_b128 v[156:159], v18 offset:22528
    v_mfma_f32_16x16x32_bf16 v[92:95], v[164:167], v[188:191], v[92:95]
    ds_read_b128 v[132:135], v16 offset:2048
    v_mfma_f32_16x16x32_bf16 v[96:99], v[168:171], v[176:179], v[96:99]
    v_mfma_f32_16x16x32_bf16 v[100:103], v[168:171], v[180:183], v[100:103]
    ds_read_b128 v[136:139], v16 offset:4096
    v_mfma_f32_16x16x32_bf16 v[104:107], v[168:171], v[184:187], v[104:107]
    ds_read_b128 v[140:143], v16 offset:6144
    v_mfma_f32_16x16x32_bf16 v[108:111], v[168:171], v[188:191], v[108:111]
    v_mfma_f32_16x16x32_bf16 v[112:115], v[172:175], v[176:179], v[112:115]
    v_mfma_f32_16x16x32_bf16 v[116:119], v[172:175], v[180:183], v[116:119]
    v_mfma_f32_16x16x32_bf16 v[120:123], v[172:175], v[184:187], v[120:123]
    v_mfma_f32_16x16x32_bf16 v[124:127], v[172:175], v[188:191], v[124:127]
    s_waitcnt lgkmcnt(0)
    v_mfma_f32_16x16x32_bf16 v[64:67], v[128:131], v[144:147], v[64:67]
    ds_read_b128 v[160:163], v17 offset:0
    v_mfma_f32_16x16x32_bf16 v[68:71], v[128:131], v[148:151], v[68:71]
    ds_read_b128 v[176:179], v19 offset:16384
    v_mfma_f32_16x16x32_bf16 v[72:75], v[128:131], v[152:155], v[72:75]
    v_mfma_f32_16x16x32_bf16 v[76:79], v[128:131], v[156:159], v[76:79]
    ds_read_b128 v[180:183], v19 offset:18432
    v_mfma_f32_16x16x32_bf16 v[80:83], v[132:135], v[144:147], v[80:83]
    ds_read_b128 v[184:187], v19 offset:20480
    v_mfma_f32_16x16x32_bf16 v[84:87], v[132:135], v[148:151], v[84:87]
    v_mfma_f32_16x16x32_bf16 v[88:91], v[132:135], v[152:155], v[88:91]
    ds_read_b128 v[188:191], v19 offset:22528
    v_mfma_f32_16x16x32_bf16 v[92:95], v[132:135], v[156:159], v[92:95]
    ds_read_b128 v[164:167], v17 offset:2048
    v_mfma_f32_16x16x32_bf16 v[96:99], v[136:139], v[144:147], v[96:99]
    v_mfma_f32_16x16x32_bf16 v[100:103], v[136:139], v[148:151], v[100:103]
    ds_read_b128 v[168:171], v17 offset:4096
    v_mfma_f32_16x16x32_bf16 v[104:107], v[136:139], v[152:155], v[104:107]
    ds_read_b128 v[172:175], v17 offset:6144
    v_mfma_f32_16x16x32_bf16 v[108:111], v[136:139], v[156:159], v[108:111]
    v_mfma_f32_16x16x32_bf16 v[112:115], v[140:143], v[144:147], v[112:115]
    v_mfma_f32_16x16x32_bf16 v[116:119], v[140:143], v[148:151], v[116:119]
    v_mfma_f32_16x16x32_bf16 v[120:123], v[140:143], v[152:155], v[120:123]
    v_mfma_f32_16x16x32_bf16 v[124:127], v[140:143], v[156:159], v[124:127]
    s_waitcnt lgkmcnt(0)
    s_barrier
    v_mfma_f32_16x16x32_bf16 v[64:67], v[160:163], v[176:179], v[64:67]
    ds_read_b128 v[128:131], v16 offset:32768
    v_mfma_f32_16x16x32_bf16 v[68:71], v[160:163], v[180:183], v[68:71]
    ds_read_b128 v[144:147], v18 offset:49152
    v_mfma_f32_16x16x32_bf16 v[72:75], v[160:163], v[184:187], v[72:75]
    v_mfma_f32_16x16x32_bf16 v[76:79], v[160:163], v[188:191], v[76:79]
    ds_read_b128 v[148:151], v18 offset:51200
    v_mfma_f32_16x16x32_bf16 v[80:83], v[164:167], v[176:179], v[80:83]
    ds_read_b128 v[152:155], v18 offset:53248
    v_mfma_f32_16x16x32_bf16 v[84:87], v[164:167], v[180:183], v[84:87]
    v_mfma_f32_16x16x32_bf16 v[88:91], v[164:167], v[184:187], v[88:91]
    ds_read_b128 v[156:159], v18 offset:55296
    v_mfma_f32_16x16x32_bf16 v[92:95], v[164:167], v[188:191], v[92:95]
    ds_read_b128 v[132:135], v16 offset:34816
    v_mfma_f32_16x16x32_bf16 v[96:99], v[168:171], v[176:179], v[96:99]
    v_mfma_f32_16x16x32_bf16 v[100:103], v[168:171], v[180:183], v[100:103]
    ds_read_b128 v[136:139], v16 offset:36864
    v_mfma_f32_16x16x32_bf16 v[104:107], v[168:171], v[184:187], v[104:107]
    ds_read_b128 v[140:143], v16 offset:38912
    v_mfma_f32_16x16x32_bf16 v[108:111], v[168:171], v[188:191], v[108:111]
    v_mfma_f32_16x16x32_bf16 v[112:115], v[172:175], v[176:179], v[112:115]
    v_mfma_f32_16x16x32_bf16 v[116:119], v[172:175], v[180:183], v[116:119]
    v_mfma_f32_16x16x32_bf16 v[120:123], v[172:175], v[184:187], v[120:123]
    v_mfma_f32_16x16x32_bf16 v[124:127], v[172:175], v[188:191], v[124:127]
    s_waitcnt lgkmcnt(0)
    v_mfma_f32_16x16x32_bf16 v[64:67], v[128:131], v[144:147], v[64:67]
    ds_read_b128 v[160:163], v17 offset:32768
    v_mfma_f32_16x16x32_bf16 v[68:71], v[128:131], v[148:151], v[68:71]
    ds_read_b128 v[176:179], v19 offset:49152
    v_mfma_f32_16x16x32_bf16 v[72:75], v[128:131], v[152:155], v[72:75]
    v_mfma_f32_16x16x32_bf16 v[76:79], v[128:131], v[156:159], v[76:79]
    ds_read_b128 v[180:183], v19 offset:51200
    v_mfma_f32_16x16x32_bf16 v[80:83], v[132:135], v[144:147], v[80:83]
    ds_read_b128 v[184:187], v19 offset:53248
    v_mfma_f32_16x16x32_bf16 v[84:87], v[132:135], v[148:151], v[84:87]
    v_mfma_f32_16x16x32_bf16 v[88:91], v[132:135], v[152:155], v[88:91]
    ds_read_b128 v[188:191], v19 offset:55296
    v_mfma_f32_16x16x32_bf16 v[92:95], v[132:135], v[156:159], v[92:95]
    ds_read_b128 v[164:167], v17 offset:34816
    v_mfma_f32_16x16x32_bf16 v[96:99], v[136:139], v[144:147], v[96:99]
    v_mfma_f32_16x16x32_bf16 v[100:103], v[136:139], v[148:151], v[100:103]
    ds_read_b128 v[168:171], v17 offset:36864
    v_mfma_f32_16x16x32_bf16 v[104:107], v[136:139], v[152:155], v[104:107]
    ds_read_b128 v[172:175], v17 offset:38912
    v_mfma_f32_16x16x32_bf16 v[108:111], v[136:139], v[156:159], v[108:111]
    v_mfma_f32_16x16x32_bf16 v[112:115], v[140:143], v[144:147], v[112:115]
    v_mfma_f32_16x16x32_bf16 v[116:119], v[140:143], v[148:151], v[116:119]
    v_mfma_f32_16x16x32_bf16 v[120:123], v[140:143], v[152:155], v[120:123]
    v_mfma_f32_16x16x32_bf16 v[124:127], v[140:143], v[156:159], v[124:127]
    s_waitcnt lgkmcnt(0)
    s_barrier
    v_mfma_f32_16x16x32_bf16 v[64:67], v[160:163], v[176:179], v[64:67]
    ds_read_b128 v[128:131], v20 offset:0
    v_mfma_f32_16x16x32_bf16 v[68:71], v[160:163], v[180:183], v[68:71]
    ds_read_b128 v[144:147], v22 offset:16384
    v_mfma_f32_16x16x32_bf16 v[72:75], v[160:163], v[184:187], v[72:75]
    v_mfma_f32_16x16x32_bf16 v[76:79], v[160:163], v[188:191], v[76:79]
    ds_read_b128 v[148:151], v22 offset:18432
    v_mfma_f32_16x16x32_bf16 v[80:83], v[164:167], v[176:179], v[80:83]
    ds_read_b128 v[152:155], v22 offset:20480
    v_mfma_f32_16x16x32_bf16 v[84:87], v[164:167], v[180:183], v[84:87]
    v_mfma_f32_16x16x32_bf16 v[88:91], v[164:167], v[184:187], v[88:91]
    ds_read_b128 v[156:159], v22 offset:22528
    v_mfma_f32_16x16x32_bf16 v[92:95], v[164:167], v[188:191], v[92:95]
    ds_read_b128 v[132:135], v20 offset:2048
    v_mfma_f32_16x16x32_bf16 v[96:99], v[168:171], v[176:179], v[96:99]
    v_mfma_f32_16x16x32_bf16 v[100:103], v[168:171], v[180:183], v[100:103]
    ds_read_b128 v[136:139], v20 offset:4096
    v_mfma_f32_16x16x32_bf16 v[104:107], v[168:171], v[184:187], v[104:107]
    ds_read_b128 v[140:143], v20 offset:6144
    v_mfma_f32_16x16x32_bf16 v[108:111], v[168:171], v[188:191], v[108:111]
    v_mfma_f32_16x16x32_bf16 v[112:115], v[172:175], v[176:179], v[112:115]
    v_mfma_f32_16x16x32_bf16 v[116:119], v[172:175], v[180:183], v[116:119]
    v_mfma_f32_16x16x32_bf16 v[120:123], v[172:175], v[184:187], v[120:123]
    v_mfma_f32_16x16x32_bf16 v[124:127], v[172:175], v[188:191], v[124:127]
    s_waitcnt lgkmcnt(0)
    v_mfma_f32_16x16x32_bf16 v[64:67], v[128:131], v[144:147], v[64:67]
    ds_read_b128 v[160:163], v21 offset:0
    v_mfma_f32_16x16x32_bf16 v[68:71], v[128:131], v[148:151], v[68:71]
    ds_read_b128 v[176:179], v23 offset:16384
    v_mfma_f32_16x16x32_bf16 v[72:75], v[128:131], v[152:155], v[72:75]
    v_mfma_f32_16x16x32_bf16 v[76:79], v[128:131], v[156:159], v[76:79]
    ds_read_b128 v[180:183], v23 offset:18432
    v_mfma_f32_16x16x32_bf16 v[80:83], v[132:135], v[144:147], v[80:83]
    ds_read_b128 v[184:187], v23 offset:20480
    v_mfma_f32_16x16x32_bf16 v[84:87], v[132:135], v[148:151], v[84:87]
    v_mfma_f32_16x16x32_bf16 v[88:91], v[132:135], v[152:155], v[88:91]
    ds_read_b128 v[188:191], v23 offset:22528
    v_mfma_f32_16x16x32_bf16 v[92:95], v[132:135], v[156:159], v[92:95]
    ds_read_b128 v[164:167], v21 offset:2048
    v_mfma_f32_16x16x32_bf16 v[96:99], v[136:139], v[144:147], v[96:99]
    v_mfma_f32_16x16x32_bf16 v[100:103], v[136:139], v[148:151], v[100:103]
    ds_read_b128 v[168:171], v21 offset:4096
    v_mfma_f32_16x16x32_bf16 v[104:107], v[136:139], v[152:155], v[104:107]
    ds_read_b128 v[172:175], v21 offset:6144
    v_mfma_f32_16x16x32_bf16 v[108:111], v[136:139], v[156:159], v[108:111]
    v_mfma_f32_16x16x32_bf16 v[112:115], v[140:143], v[144:147], v[112:115]
    v_mfma_f32_16x16x32_bf16 v[116:119], v[140:143], v[148:151], v[116:119]
    v_mfma_f32_16x16x32_bf16 v[120:123], v[140:143], v[152:155], v[120:123]
    v_mfma_f32_16x16x32_bf16 v[124:127], v[140:143], v[156:159], v[124:127]
    s_waitcnt lgkmcnt(0)
    s_barrier
    v_mfma_f32_16x16x32_bf16 v[64:67], v[160:163], v[176:179], v[64:67]
    ds_read_b128 v[128:131], v16 offset:0
    v_mfma_f32_16x16x32_bf16 v[68:71], v[160:163], v[180:183], v[68:71]
    ds_read_b128 v[144:147], v18 offset:16384
    v_mfma_f32_16x16x32_bf16 v[72:75], v[160:163], v[184:187], v[72:75]
    v_mfma_f32_16x16x32_bf16 v[76:79], v[160:163], v[188:191], v[76:79]
    ds_read_b128 v[148:151], v18 offset:18432
    v_mfma_f32_16x16x32_bf16 v[80:83], v[164:167], v[176:179], v[80:83]
    ds_read_b128 v[152:155], v18 offset:20480
    v_mfma_f32_16x16x32_bf16 v[84:87], v[164:167], v[180:183], v[84:87]
    v_mfma_f32_16x16x32_bf16 v[88:91], v[164:167], v[184:187], v[88:91]
    ds_read_b128 v[156:159], v18 offset:22528
    v_mfma_f32_16x16x32_bf16 v[92:95], v[164:167], v[188:191], v[92:95]
    ds_read_b128 v[132:135], v16 offset:2048
    v_mfma_f32_16x16x32_bf16 v[96:99], v[168:171], v[176:179], v[96:99]
    v_mfma_f32_16x16x32_bf16 v[100:103], v[168:171], v[180:183], v[100:103]
    ds_read_b128 v[136:139], v16 offset:4096
    v_mfma_f32_16x16x32_bf16 v[104:107], v[168:171], v[184:187], v[104:107]
    ds_read_b128 v[140:143], v16 offset:6144
    v_mfma_f32_16x16x32_bf16 v[108:111], v[168:171], v[188:191], v[108:111]
    v_mfma_f32_16x16x32_bf16 v[112:115], v[172:175], v[176:179], v[112:115]
    v_mfma_f32_16x16x32_bf16 v[116:119], v[172:175], v[180:183], v[116:119]
    v_mfma_f32_16x16x32_bf16 v[120:123], v[172:175], v[184:187], v[120:123]
    v_mfma_f32_16x16x32_bf16 v[124:127], v[172:175], v[188:191], v[124:127]
    s_waitcnt lgkmcnt(0)
    v_mfma_f32_16x16x32_bf16 v[64:67], v[128:131], v[144:147], v[64:67]
    ds_read_b128 v[160:163], v17 offset:0
    v_mfma_f32_16x16x32_bf16 v[68:71], v[128:131], v[148:151], v[68:71]
    ds_read_b128 v[176:179], v19 offset:16384
    v_mfma_f32_16x16x32_bf16 v[72:75], v[128:131], v[152:155], v[72:75]
    v_mfma_f32_16x16x32_bf16 v[76:79], v[128:131], v[156:159], v[76:79]
    ds_read_b128 v[180:183], v19 offset:18432
    v_mfma_f32_16x16x32_bf16 v[80:83], v[132:135], v[144:147], v[80:83]
    ds_read_b128 v[184:187], v19 offset:20480
    v_mfma_f32_16x16x32_bf16 v[84:87], v[132:135], v[148:151], v[84:87]
    v_mfma_f32_16x16x32_bf16 v[88:91], v[132:135], v[152:155], v[88:91]
    ds_read_b128 v[188:191], v19 offset:22528
    v_mfma_f32_16x16x32_bf16 v[92:95], v[132:135], v[156:159], v[92:95]
    ds_read_b128 v[164:167], v17 offset:2048
    v_mfma_f32_16x16x32_bf16 v[96:99], v[136:139], v[144:147], v[96:99]
    v_mfma_f32_16x16x32_bf16 v[100:103], v[136:139], v[148:151], v[100:103]
    ds_read_b128 v[168:171], v17 offset:4096
    v_mfma_f32_16x16x32_bf16 v[104:107], v[136:139], v[152:155], v[104:107]
    ds_read_b128 v[172:175], v17 offset:6144
    v_mfma_f32_16x16x32_bf16 v[108:111], v[136:139], v[156:159], v[108:111]
    v_mfma_f32_16x16x32_bf16 v[112:115], v[140:143], v[144:147], v[112:115]
    v_mfma_f32_16x16x32_bf16 v[116:119], v[140:143], v[148:151], v[116:119]
    v_mfma_f32_16x16x32_bf16 v[120:123], v[140:143], v[152:155], v[120:123]
    v_mfma_f32_16x16x32_bf16 v[124:127], v[140:143], v[156:159], v[124:127]
    s_waitcnt lgkmcnt(0)
    s_barrier
    v_mfma_f32_16x16x32_bf16 v[64:67], v[160:163], v[176:179], v[64:67]
    ds_read_b128 v[128:131], v16 offset:32768
    v_mfma_f32_16x16x32_bf16 v[68:71], v[160:163], v[180:183], v[68:71]
    ds_read_b128 v[144:147], v18 offset:49152
    v_mfma_f32_16x16x32_bf16 v[72:75], v[160:163], v[184:187], v[72:75]
    v_mfma_f32_16x16x32_bf16 v[76:79], v[160:163], v[188:191], v[76:79]
    ds_read_b128 v[148:151], v18 offset:51200
    v_mfma_f32_16x16x32_bf16 v[80:83], v[164:167], v[176:179], v[80:83]
    ds_read_b128 v[152:155], v18 offset:53248
    v_mfma_f32_16x16x32_bf16 v[84:87], v[164:167], v[180:183], v[84:87]
    v_mfma_f32_16x16x32_bf16 v[88:91], v[164:167], v[184:187], v[88:91]
    ds_read_b128 v[156:159], v18 offset:55296
    v_mfma_f32_16x16x32_bf16 v[92:95], v[164:167], v[188:191], v[92:95]
    ds_read_b128 v[132:135], v16 offset:34816
    v_mfma_f32_16x16x32_bf16 v[96:99], v[168:171], v[176:179], v[96:99]
    v_mfma_f32_16x16x32_bf16 v[100:103], v[168:171], v[180:183], v[100:103]
    ds_read_b128 v[136:139], v16 offset:36864
    v_mfma_f32_16x16x32_bf16 v[104:107], v[168:171], v[184:187], v[104:107]
    ds_read_b128 v[140:143], v16 offset:38912
    v_mfma_f32_16x16x32_bf16 v[108:111], v[168:171], v[188:191], v[108:111]
    v_mfma_f32_16x16x32_bf16 v[112:115], v[172:175], v[176:179], v[112:115]
    v_mfma_f32_16x16x32_bf16 v[116:119], v[172:175], v[180:183], v[116:119]
    v_mfma_f32_16x16x32_bf16 v[120:123], v[172:175], v[184:187], v[120:123]
    v_mfma_f32_16x16x32_bf16 v[124:127], v[172:175], v[188:191], v[124:127]
    s_waitcnt lgkmcnt(0)
    v_mfma_f32_16x16x32_bf16 v[64:67], v[128:131], v[144:147], v[64:67]
    ds_read_b128 v[160:163], v17 offset:32768
    v_mfma_f32_16x16x32_bf16 v[68:71], v[128:131], v[148:151], v[68:71]
    ds_read_b128 v[176:179], v19 offset:49152
    v_mfma_f32_16x16x32_bf16 v[72:75], v[128:131], v[152:155], v[72:75]
    v_mfma_f32_16x16x32_bf16 v[76:79], v[128:131], v[156:159], v[76:79]
    ds_read_b128 v[180:183], v19 offset:51200
    v_mfma_f32_16x16x32_bf16 v[80:83], v[132:135], v[144:147], v[80:83]
    ds_read_b128 v[184:187], v19 offset:53248
    v_mfma_f32_16x16x32_bf16 v[84:87], v[132:135], v[148:151], v[84:87]
    v_mfma_f32_16x16x32_bf16 v[88:91], v[132:135], v[152:155], v[88:91]
    ds_read_b128 v[188:191], v19 offset:55296
    v_mfma_f32_16x16x32_bf16 v[92:95], v[132:135], v[156:159], v[92:95]
    ds_read_b128 v[164:167], v17 offset:34816
    v_mfma_f32_16x16x32_bf16 v[96:99], v[136:139], v[144:147], v[96:99]
    v_mfma_f32_16x16x32_bf16 v[100:103], v[136:139], v[148:151], v[100:103]
    ds_read_b128 v[168:171], v17 offset:36864
    v_mfma_f32_16x16x32_bf16 v[104:107], v[136:139], v[152:155], v[104:107]
    ds_read_b128 v[172:175], v17 offset:38912
    v_mfma_f32_16x16x32_bf16 v[108:111], v[136:139], v[156:159], v[108:111]
    v_mfma_f32_16x16x32_bf16 v[112:115], v[140:143], v[144:147], v[112:115]
    v_mfma_f32_16x16x32_bf16 v[116:119], v[140:143], v[148:151], v[116:119]
    v_mfma_f32_16x16x32_bf16 v[120:123], v[140:143], v[152:155], v[120:123]
    v_mfma_f32_16x16x32_bf16 v[124:127], v[140:143], v[156:159], v[124:127]
    s_waitcnt lgkmcnt(0)
    s_barrier
    v_mfma_f32_16x16x32_bf16 v[64:67], v[160:163], v[176:179], v[64:67]
    ds_read_b128 v[128:131], v20 offset:0
    v_mfma_f32_16x16x32_bf16 v[68:71], v[160:163], v[180:183], v[68:71]
    ds_read_b128 v[144:147], v22 offset:16384
    v_mfma_f32_16x16x32_bf16 v[72:75], v[160:163], v[184:187], v[72:75]
    v_mfma_f32_16x16x32_bf16 v[76:79], v[160:163], v[188:191], v[76:79]
    ds_read_b128 v[148:151], v22 offset:18432
    v_mfma_f32_16x16x32_bf16 v[80:83], v[164:167], v[176:179], v[80:83]
    ds_read_b128 v[152:155], v22 offset:20480
    v_mfma_f32_16x16x32_bf16 v[84:87], v[164:167], v[180:183], v[84:87]
    v_mfma_f32_16x16x32_bf16 v[88:91], v[164:167], v[184:187], v[88:91]
    ds_read_b128 v[156:159], v22 offset:22528
    v_mfma_f32_16x16x32_bf16 v[92:95], v[164:167], v[188:191], v[92:95]
    ds_read_b128 v[132:135], v20 offset:2048
    v_mfma_f32_16x16x32_bf16 v[96:99], v[168:171], v[176:179], v[96:99]
    v_mfma_f32_16x16x32_bf16 v[100:103], v[168:171], v[180:183], v[100:103]
    ds_read_b128 v[136:139], v20 offset:4096
    v_mfma_f32_16x16x32_bf16 v[104:107], v[168:171], v[184:187], v[104:107]
    ds_read_b128 v[140:143], v20 offset:6144
    v_mfma_f32_16x16x32_bf16 v[108:111], v[168:171], v[188:191], v[108:111]
    v_mfma_f32_16x16x32_bf16 v[112:115], v[172:175], v[176:179], v[112:115]
    v_mfma_f32_16x16x32_bf16 v[116:119], v[172:175], v[180:183], v[116:119]
    v_mfma_f32_16x16x32_bf16 v[120:123], v[172:175], v[184:187], v[120:123]
    v_mfma_f32_16x16x32_bf16 v[124:127], v[172:175], v[188:191], v[124:127]
    s_waitcnt lgkmcnt(0)
    v_mfma_f32_16x16x32_bf16 v[64:67], v[128:131], v[144:147], v[64:67]
    ds_read_b128 v[160:163], v21 offset:0
    v_mfma_f32_16x16x32_bf16 v[68:71], v[128:131], v[148:151], v[68:71]
    ds_read_b128 v[176:179], v23 offset:16384
    v_mfma_f32_16x16x32_bf16 v[72:75], v[128:131], v[152:155], v[72:75]
    v_mfma_f32_16x16x32_bf16 v[76:79], v[128:131], v[156:159], v[76:79]
    ds_read_b128 v[180:183], v23 offset:18432
    v_mfma_f32_16x16x32_bf16 v[80:83], v[132:135], v[144:147], v[80:83]
    ds_read_b128 v[184:187], v23 offset:20480
    v_mfma_f32_16x16x32_bf16 v[84:87], v[132:135], v[148:151], v[84:87]
    v_mfma_f32_16x16x32_bf16 v[88:91], v[132:135], v[152:155], v[88:91]
    ds_read_b128 v[188:191], v23 offset:22528
    v_mfma_f32_16x16x32_bf16 v[92:95], v[132:135], v[156:159], v[92:95]
    ds_read_b128 v[164:167], v21 offset:2048
    v_mfma_f32_16x16x32_bf16 v[96:99], v[136:139], v[144:147], v[96:99]
    v_mfma_f32_16x16x32_bf16 v[100:103], v[136:139], v[148:151], v[100:103]
    ds_read_b128 v[168:171], v21 offset:4096
    v_mfma_f32_16x16x32_bf16 v[104:107], v[136:139], v[152:155], v[104:107]
    ds_read_b128 v[172:175], v21 offset:6144
    v_mfma_f32_16x16x32_bf16 v[108:111], v[136:139], v[156:159], v[108:111]
    v_mfma_f32_16x16x32_bf16 v[112:115], v[140:143], v[144:147], v[112:115]
    v_mfma_f32_16x16x32_bf16 v[116:119], v[140:143], v[148:151], v[116:119]
    v_mfma_f32_16x16x32_bf16 v[120:123], v[140:143], v[152:155], v[120:123]
    v_mfma_f32_16x16x32_bf16 v[124:127], v[140:143], v[156:159], v[124:127]
    s_waitcnt lgkmcnt(0)
    s_barrier
    v_mfma_f32_16x16x32_bf16 v[64:67], v[160:163], v[176:179], v[64:67]
    ds_read_b128 v[128:131], v16 offset:0
    v_mfma_f32_16x16x32_bf16 v[68:71], v[160:163], v[180:183], v[68:71]
    ds_read_b128 v[144:147], v18 offset:16384
    v_mfma_f32_16x16x32_bf16 v[72:75], v[160:163], v[184:187], v[72:75]
    v_mfma_f32_16x16x32_bf16 v[76:79], v[160:163], v[188:191], v[76:79]
    ds_read_b128 v[148:151], v18 offset:18432
    v_mfma_f32_16x16x32_bf16 v[80:83], v[164:167], v[176:179], v[80:83]
    ds_read_b128 v[152:155], v18 offset:20480
    v_mfma_f32_16x16x32_bf16 v[84:87], v[164:167], v[180:183], v[84:87]
    v_mfma_f32_16x16x32_bf16 v[88:91], v[164:167], v[184:187], v[88:91]
    ds_read_b128 v[156:159], v18 offset:22528
    v_mfma_f32_16x16x32_bf16 v[92:95], v[164:167], v[188:191], v[92:95]
    ds_read_b128 v[132:135], v16 offset:2048
    v_mfma_f32_16x16x32_bf16 v[96:99], v[168:171], v[176:179], v[96:99]
    v_mfma_f32_16x16x32_bf16 v[100:103], v[168:171], v[180:183], v[100:103]
    ds_read_b128 v[136:139], v16 offset:4096
    v_mfma_f32_16x16x32_bf16 v[104:107], v[168:171], v[184:187], v[104:107]
    ds_read_b128 v[140:143], v16 offset:6144
    v_mfma_f32_16x16x32_bf16 v[108:111], v[168:171], v[188:191], v[108:111]
    v_mfma_f32_16x16x32_bf16 v[112:115], v[172:175], v[176:179], v[112:115]
    v_mfma_f32_16x16x32_bf16 v[116:119], v[172:175], v[180:183], v[116:119]
    v_mfma_f32_16x16x32_bf16 v[120:123], v[172:175], v[184:187], v[120:123]
    v_mfma_f32_16x16x32_bf16 v[124:127], v[172:175], v[188:191], v[124:127]
    s_waitcnt lgkmcnt(0)
    v_mfma_f32_16x16x32_bf16 v[64:67], v[128:131], v[144:147], v[64:67]
    ds_read_b128 v[160:163], v17 offset:0
    v_mfma_f32_16x16x32_bf16 v[68:71], v[128:131], v[148:151], v[68:71]
    ds_read_b128 v[176:179], v19 offset:16384
    v_mfma_f32_16x16x32_bf16 v[72:75], v[128:131], v[152:155], v[72:75]
    v_mfma_f32_16x16x32_bf16 v[76:79], v[128:131], v[156:159], v[76:79]
    ds_read_b128 v[180:183], v19 offset:18432
    v_mfma_f32_16x16x32_bf16 v[80:83], v[132:135], v[144:147], v[80:83]
    ds_read_b128 v[184:187], v19 offset:20480
    v_mfma_f32_16x16x32_bf16 v[84:87], v[132:135], v[148:151], v[84:87]
    v_mfma_f32_16x16x32_bf16 v[88:91], v[132:135], v[152:155], v[88:91]
    ds_read_b128 v[188:191], v19 offset:22528
    v_mfma_f32_16x16x32_bf16 v[92:95], v[132:135], v[156:159], v[92:95]
    ds_read_b128 v[164:167], v17 offset:2048
    v_mfma_f32_16x16x32_bf16 v[96:99], v[136:139], v[144:147], v[96:99]
    v_mfma_f32_16x16x32_bf16 v[100:103], v[136:139], v[148:151], v[100:103]
    ds_read_b128 v[168:171], v17 offset:4096
    v_mfma_f32_16x16x32_bf16 v[104:107], v[136:139], v[152:155], v[104:107]
    ds_read_b128 v[172:175], v17 offset:6144
    v_mfma_f32_16x16x32_bf16 v[108:111], v[136:139], v[156:159], v[108:111]
    v_mfma_f32_16x16x32_bf16 v[112:115], v[140:143], v[144:147], v[112:115]
    v_mfma_f32_16x16x32_bf16 v[116:119], v[140:143], v[148:151], v[116:119]
    v_mfma_f32_16x16x32_bf16 v[120:123], v[140:143], v[152:155], v[120:123]
    v_mfma_f32_16x16x32_bf16 v[124:127], v[140:143], v[156:159], v[124:127]
    s_waitcnt lgkmcnt(0)
    s_barrier
    v_mfma_f32_16x16x32_bf16 v[64:67], v[160:163], v[176:179], v[64:67]
    ds_read_b128 v[128:131], v16 offset:32768
    v_mfma_f32_16x16x32_bf16 v[68:71], v[160:163], v[180:183], v[68:71]
    ds_read_b128 v[144:147], v18 offset:49152
    v_mfma_f32_16x16x32_bf16 v[72:75], v[160:163], v[184:187], v[72:75]
    v_mfma_f32_16x16x32_bf16 v[76:79], v[160:163], v[188:191], v[76:79]
    ds_read_b128 v[148:151], v18 offset:51200
    v_mfma_f32_16x16x32_bf16 v[80:83], v[164:167], v[176:179], v[80:83]
    ds_read_b128 v[152:155], v18 offset:53248
    v_mfma_f32_16x16x32_bf16 v[84:87], v[164:167], v[180:183], v[84:87]
    v_mfma_f32_16x16x32_bf16 v[88:91], v[164:167], v[184:187], v[88:91]
    ds_read_b128 v[156:159], v18 offset:55296
    v_mfma_f32_16x16x32_bf16 v[92:95], v[164:167], v[188:191], v[92:95]
    ds_read_b128 v[132:135], v16 offset:34816
    v_mfma_f32_16x16x32_bf16 v[96:99], v[168:171], v[176:179], v[96:99]
    v_mfma_f32_16x16x32_bf16 v[100:103], v[168:171], v[180:183], v[100:103]
    ds_read_b128 v[136:139], v16 offset:36864
    v_mfma_f32_16x16x32_bf16 v[104:107], v[168:171], v[184:187], v[104:107]
    ds_read_b128 v[140:143], v16 offset:38912
    v_mfma_f32_16x16x32_bf16 v[108:111], v[168:171], v[188:191], v[108:111]
    v_mfma_f32_16x16x32_bf16 v[112:115], v[172:175], v[176:179], v[112:115]
    v_mfma_f32_16x16x32_bf16 v[116:119], v[172:175], v[180:183], v[116:119]
    v_mfma_f32_16x16x32_bf16 v[120:123], v[172:175], v[184:187], v[120:123]
    v_mfma_f32_16x16x32_bf16 v[124:127], v[172:175], v[188:191], v[124:127]
    s_waitcnt lgkmcnt(0)
    v_mfma_f32_16x16x32_bf16 v[64:67], v[128:131], v[144:147], v[64:67]
    ds_read_b128 v[160:163], v17 offset:32768
    v_mfma_f32_16x16x32_bf16 v[68:71], v[128:131], v[148:151], v[68:71]
    ds_read_b128 v[176:179], v19 offset:49152
    v_mfma_f32_16x16x32_bf16 v[72:75], v[128:131], v[152:155], v[72:75]
    v_mfma_f32_16x16x32_bf16 v[76:79], v[128:131], v[156:159], v[76:79]
    ds_read_b128 v[180:183], v19 offset:51200
    v_mfma_f32_16x16x32_bf16 v[80:83], v[132:135], v[144:147], v[80:83]
    ds_read_b128 v[184:187], v19 offset:53248
    v_mfma_f32_16x16x32_bf16 v[84:87], v[132:135], v[148:151], v[84:87]
    v_mfma_f32_16x16x32_bf16 v[88:91], v[132:135], v[152:155], v[88:91]
    ds_read_b128 v[188:191], v19 offset:55296
    v_mfma_f32_16x16x32_bf16 v[92:95], v[132:135], v[156:159], v[92:95]
    ds_read_b128 v[164:167], v17 offset:34816
    v_mfma_f32_16x16x32_bf16 v[96:99], v[136:139], v[144:147], v[96:99]
    v_mfma_f32_16x16x32_bf16 v[100:103], v[136:139], v[148:151], v[100:103]
    ds_read_b128 v[168:171], v17 offset:36864
    v_mfma_f32_16x16x32_bf16 v[104:107], v[136:139], v[152:155], v[104:107]
    ds_read_b128 v[172:175], v17 offset:38912
    v_mfma_f32_16x16x32_bf16 v[108:111], v[136:139], v[156:159], v[108:111]
    v_mfma_f32_16x16x32_bf16 v[112:115], v[140:143], v[144:147], v[112:115]
    v_mfma_f32_16x16x32_bf16 v[116:119], v[140:143], v[148:151], v[116:119]
    v_mfma_f32_16x16x32_bf16 v[120:123], v[140:143], v[152:155], v[120:123]
    v_mfma_f32_16x16x32_bf16 v[124:127], v[140:143], v[156:159], v[124:127]
    s_waitcnt lgkmcnt(0)
    s_barrier
    v_mfma_f32_16x16x32_bf16 v[64:67], v[160:163], v[176:179], v[64:67]
    ds_read_b128 v[128:131], v20 offset:0
    v_mfma_f32_16x16x32_bf16 v[68:71], v[160:163], v[180:183], v[68:71]
    ds_read_b128 v[144:147], v22 offset:16384
    v_mfma_f32_16x16x32_bf16 v[72:75], v[160:163], v[184:187], v[72:75]
    v_mfma_f32_16x16x32_bf16 v[76:79], v[160:163], v[188:191], v[76:79]
    ds_read_b128 v[148:151], v22 offset:18432
    v_mfma_f32_16x16x32_bf16 v[80:83], v[164:167], v[176:179], v[80:83]
    ds_read_b128 v[152:155], v22 offset:20480
    v_mfma_f32_16x16x32_bf16 v[84:87], v[164:167], v[180:183], v[84:87]
    v_mfma_f32_16x16x32_bf16 v[88:91], v[164:167], v[184:187], v[88:91]
    ds_read_b128 v[156:159], v22 offset:22528
    v_mfma_f32_16x16x32_bf16 v[92:95], v[164:167], v[188:191], v[92:95]
    ds_read_b128 v[132:135], v20 offset:2048
    v_mfma_f32_16x16x32_bf16 v[96:99], v[168:171], v[176:179], v[96:99]
    v_mfma_f32_16x16x32_bf16 v[100:103], v[168:171], v[180:183], v[100:103]
    ds_read_b128 v[136:139], v20 offset:4096
    v_mfma_f32_16x16x32_bf16 v[104:107], v[168:171], v[184:187], v[104:107]
    ds_read_b128 v[140:143], v20 offset:6144
    v_mfma_f32_16x16x32_bf16 v[108:111], v[168:171], v[188:191], v[108:111]
    v_mfma_f32_16x16x32_bf16 v[112:115], v[172:175], v[176:179], v[112:115]
    v_mfma_f32_16x16x32_bf16 v[116:119], v[172:175], v[180:183], v[116:119]
    v_mfma_f32_16x16x32_bf16 v[120:123], v[172:175], v[184:187], v[120:123]
    v_mfma_f32_16x16x32_bf16 v[124:127], v[172:175], v[188:191], v[124:127]
    s_waitcnt lgkmcnt(0)
    v_mfma_f32_16x16x32_bf16 v[64:67], v[128:131], v[144:147], v[64:67]
    ds_read_b128 v[160:163], v21 offset:0
    v_mfma_f32_16x16x32_bf16 v[68:71], v[128:131], v[148:151], v[68:71]
    ds_read_b128 v[176:179], v23 offset:16384
    v_mfma_f32_16x16x32_bf16 v[72:75], v[128:131], v[152:155], v[72:75]
    v_mfma_f32_16x16x32_bf16 v[76:79], v[128:131], v[156:159], v[76:79]
    ds_read_b128 v[180:183], v23 offset:18432
    v_mfma_f32_16x16x32_bf16 v[80:83], v[132:135], v[144:147], v[80:83]
    ds_read_b128 v[184:187], v23 offset:20480
    v_mfma_f32_16x16x32_bf16 v[84:87], v[132:135], v[148:151], v[84:87]
    v_mfma_f32_16x16x32_bf16 v[88:91], v[132:135], v[152:155], v[88:91]
    ds_read_b128 v[188:191], v23 offset:22528
    v_mfma_f32_16x16x32_bf16 v[92:95], v[132:135], v[156:159], v[92:95]
    ds_read_b128 v[164:167], v21 offset:2048
    v_mfma_f32_16x16x32_bf16 v[96:99], v[136:139], v[144:147], v[96:99]
    v_mfma_f32_16x16x32_bf16 v[100:103], v[136:139], v[148:151], v[100:103]
    ds_read_b128 v[168:171], v21 offset:4096
    v_mfma_f32_16x16x32_bf16 v[104:107], v[136:139], v[152:155], v[104:107]
    ds_read_b128 v[172:175], v21 offset:6144
    v_mfma_f32_16x16x32_bf16 v[108:111], v[136:139], v[156:159], v[108:111]
    v_mfma_f32_16x16x32_bf16 v[112:115], v[140:143], v[144:147], v[112:115]
    v_mfma_f32_16x16x32_bf16 v[116:119], v[140:143], v[148:151], v[116:119]
    v_mfma_f32_16x16x32_bf16 v[120:123], v[140:143], v[152:155], v[120:123]
    v_mfma_f32_16x16x32_bf16 v[124:127], v[140:143], v[156:159], v[124:127]
    s_waitcnt lgkmcnt(0)
    s_barrier
    v_mfma_f32_16x16x32_bf16 v[64:67], v[160:163], v[176:179], v[64:67]
    ds_read_b128 v[128:131], v16 offset:0
    v_mfma_f32_16x16x32_bf16 v[68:71], v[160:163], v[180:183], v[68:71]
    ds_read_b128 v[144:147], v18 offset:16384
    v_mfma_f32_16x16x32_bf16 v[72:75], v[160:163], v[184:187], v[72:75]
    v_mfma_f32_16x16x32_bf16 v[76:79], v[160:163], v[188:191], v[76:79]
    ds_read_b128 v[148:151], v18 offset:18432
    v_mfma_f32_16x16x32_bf16 v[80:83], v[164:167], v[176:179], v[80:83]
    ds_read_b128 v[152:155], v18 offset:20480
    v_mfma_f32_16x16x32_bf16 v[84:87], v[164:167], v[180:183], v[84:87]
    v_mfma_f32_16x16x32_bf16 v[88:91], v[164:167], v[184:187], v[88:91]
    ds_read_b128 v[156:159], v18 offset:22528
    v_mfma_f32_16x16x32_bf16 v[92:95], v[164:167], v[188:191], v[92:95]
    ds_read_b128 v[132:135], v16 offset:2048
    v_mfma_f32_16x16x32_bf16 v[96:99], v[168:171], v[176:179], v[96:99]
    v_mfma_f32_16x16x32_bf16 v[100:103], v[168:171], v[180:183], v[100:103]
    ds_read_b128 v[136:139], v16 offset:4096
    v_mfma_f32_16x16x32_bf16 v[104:107], v[168:171], v[184:187], v[104:107]
    ds_read_b128 v[140:143], v16 offset:6144
    v_mfma_f32_16x16x32_bf16 v[108:111], v[168:171], v[188:191], v[108:111]
    v_mfma_f32_16x16x32_bf16 v[112:115], v[172:175], v[176:179], v[112:115]
    v_mfma_f32_16x16x32_bf16 v[116:119], v[172:175], v[180:183], v[116:119]
    v_mfma_f32_16x16x32_bf16 v[120:123], v[172:175], v[184:187], v[120:123]
    v_mfma_f32_16x16x32_bf16 v[124:127], v[172:175], v[188:191], v[124:127]
    s_waitcnt lgkmcnt(0)
    v_mfma_f32_16x16x32_bf16 v[64:67], v[128:131], v[144:147], v[64:67]
    ds_read_b128 v[160:163], v17 offset:0
    v_mfma_f32_16x16x32_bf16 v[68:71], v[128:131], v[148:151], v[68:71]
    ds_read_b128 v[176:179], v19 offset:16384
    v_mfma_f32_16x16x32_bf16 v[72:75], v[128:131], v[152:155], v[72:75]
    v_mfma_f32_16x16x32_bf16 v[76:79], v[128:131], v[156:159], v[76:79]
    ds_read_b128 v[180:183], v19 offset:18432
    v_mfma_f32_16x16x32_bf16 v[80:83], v[132:135], v[144:147], v[80:83]
    ds_read_b128 v[184:187], v19 offset:20480
    v_mfma_f32_16x16x32_bf16 v[84:87], v[132:135], v[148:151], v[84:87]
    v_mfma_f32_16x16x32_bf16 v[88:91], v[132:135], v[152:155], v[88:91]
    ds_read_b128 v[188:191], v19 offset:22528
    v_mfma_f32_16x16x32_bf16 v[92:95], v[132:135], v[156:159], v[92:95]
    ds_read_b128 v[164:167], v17 offset:2048
    v_mfma_f32_16x16x32_bf16 v[96:99], v[136:139], v[144:147], v[96:99]
    v_mfma_f32_16x16x32_bf16 v[100:103], v[136:139], v[148:151], v[100:103]
    ds_read_b128 v[168:171], v17 offset:4096
    v_mfma_f32_16x16x32_bf16 v[104:107], v[136:139], v[152:155], v[104:107]
    ds_read_b128 v[172:175], v17 offset:6144
    v_mfma_f32_16x16x32_bf16 v[108:111], v[136:139], v[156:159], v[108:111]
    v_mfma_f32_16x16x32_bf16 v[112:115], v[140:143], v[144:147], v[112:115]
    v_mfma_f32_16x16x32_bf16 v[116:119], v[140:143], v[148:151], v[116:119]
    v_mfma_f32_16x16x32_bf16 v[120:123], v[140:143], v[152:155], v[120:123]
    v_mfma_f32_16x16x32_bf16 v[124:127], v[140:143], v[156:159], v[124:127]
    s_waitcnt lgkmcnt(0)
    s_barrier
    v_mfma_f32_16x16x32_bf16 v[64:67], v[160:163], v[176:179], v[64:67]
    ds_read_b128 v[128:131], v16 offset:32768
    v_mfma_f32_16x16x32_bf16 v[68:71], v[160:163], v[180:183], v[68:71]
    ds_read_b128 v[144:147], v18 offset:49152
    v_mfma_f32_16x16x32_bf16 v[72:75], v[160:163], v[184:187], v[72:75]
    v_mfma_f32_16x16x32_bf16 v[76:79], v[160:163], v[188:191], v[76:79]
    ds_read_b128 v[148:151], v18 offset:51200
    v_mfma_f32_16x16x32_bf16 v[80:83], v[164:167], v[176:179], v[80:83]
    ds_read_b128 v[152:155], v18 offset:53248
    v_mfma_f32_16x16x32_bf16 v[84:87], v[164:167], v[180:183], v[84:87]
    v_mfma_f32_16x16x32_bf16 v[88:91], v[164:167], v[184:187], v[88:91]
    ds_read_b128 v[156:159], v18 offset:55296
    v_mfma_f32_16x16x32_bf16 v[92:95], v[164:167], v[188:191], v[92:95]
    ds_read_b128 v[132:135], v16 offset:34816
    v_mfma_f32_16x16x32_bf16 v[96:99], v[168:171], v[176:179], v[96:99]
    v_mfma_f32_16x16x32_bf16 v[100:103], v[168:171], v[180:183], v[100:103]
    ds_read_b128 v[136:139], v16 offset:36864
    v_mfma_f32_16x16x32_bf16 v[104:107], v[168:171], v[184:187], v[104:107]
    ds_read_b128 v[140:143], v16 offset:38912
    v_mfma_f32_16x16x32_bf16 v[108:111], v[168:171], v[188:191], v[108:111]
    v_mfma_f32_16x16x32_bf16 v[112:115], v[172:175], v[176:179], v[112:115]
    v_mfma_f32_16x16x32_bf16 v[116:119], v[172:175], v[180:183], v[116:119]
    v_mfma_f32_16x16x32_bf16 v[120:123], v[172:175], v[184:187], v[120:123]
    v_mfma_f32_16x16x32_bf16 v[124:127], v[172:175], v[188:191], v[124:127]
    s_waitcnt lgkmcnt(0)
    v_mfma_f32_16x16x32_bf16 v[64:67], v[128:131], v[144:147], v[64:67]
    ds_read_b128 v[160:163], v17 offset:32768
    v_mfma_f32_16x16x32_bf16 v[68:71], v[128:131], v[148:151], v[68:71]
    ds_read_b128 v[176:179], v19 offset:49152
    v_mfma_f32_16x16x32_bf16 v[72:75], v[128:131], v[152:155], v[72:75]
    v_mfma_f32_16x16x32_bf16 v[76:79], v[128:131], v[156:159], v[76:79]
    ds_read_b128 v[180:183], v19 offset:51200
    v_mfma_f32_16x16x32_bf16 v[80:83], v[132:135], v[144:147], v[80:83]
    ds_read_b128 v[184:187], v19 offset:53248
    v_mfma_f32_16x16x32_bf16 v[84:87], v[132:135], v[148:151], v[84:87]
    v_mfma_f32_16x16x32_bf16 v[88:91], v[132:135], v[152:155], v[88:91]
    ds_read_b128 v[188:191], v19 offset:55296
    v_mfma_f32_16x16x32_bf16 v[92:95], v[132:135], v[156:159], v[92:95]
    ds_read_b128 v[164:167], v17 offset:34816
    v_mfma_f32_16x16x32_bf16 v[96:99], v[136:139], v[144:147], v[96:99]
    v_mfma_f32_16x16x32_bf16 v[100:103], v[136:139], v[148:151], v[100:103]
    ds_read_b128 v[168:171], v17 offset:36864
    v_mfma_f32_16x16x32_bf16 v[104:107], v[136:139], v[152:155], v[104:107]
    ds_read_b128 v[172:175], v17 offset:38912
    v_mfma_f32_16x16x32_bf16 v[108:111], v[136:139], v[156:159], v[108:111]
    v_mfma_f32_16x16x32_bf16 v[112:115], v[140:143], v[144:147], v[112:115]
    v_mfma_f32_16x16x32_bf16 v[116:119], v[140:143], v[148:151], v[116:119]
    v_mfma_f32_16x16x32_bf16 v[120:123], v[140:143], v[152:155], v[120:123]
    v_mfma_f32_16x16x32_bf16 v[124:127], v[140:143], v[156:159], v[124:127]
    s_waitcnt lgkmcnt(0)
    s_barrier
    v_mfma_f32_16x16x32_bf16 v[64:67], v[160:163], v[176:179], v[64:67]
    ds_read_b128 v[128:131], v20 offset:0
    v_mfma_f32_16x16x32_bf16 v[68:71], v[160:163], v[180:183], v[68:71]
    ds_read_b128 v[144:147], v22 offset:16384
    v_mfma_f32_16x16x32_bf16 v[72:75], v[160:163], v[184:187], v[72:75]
    v_mfma_f32_16x16x32_bf16 v[76:79], v[160:163], v[188:191], v[76:79]
    ds_read_b128 v[148:151], v22 offset:18432
    v_mfma_f32_16x16x32_bf16 v[80:83], v[164:167], v[176:179], v[80:83]
    ds_read_b128 v[152:155], v22 offset:20480
    v_mfma_f32_16x16x32_bf16 v[84:87], v[164:167], v[180:183], v[84:87]
    v_mfma_f32_16x16x32_bf16 v[88:91], v[164:167], v[184:187], v[88:91]
    ds_read_b128 v[156:159], v22 offset:22528
    v_mfma_f32_16x16x32_bf16 v[92:95], v[164:167], v[188:191], v[92:95]
    ds_read_b128 v[132:135], v20 offset:2048
    v_mfma_f32_16x16x32_bf16 v[96:99], v[168:171], v[176:179], v[96:99]
    v_mfma_f32_16x16x32_bf16 v[100:103], v[168:171], v[180:183], v[100:103]
    ds_read_b128 v[136:139], v20 offset:4096
    v_mfma_f32_16x16x32_bf16 v[104:107], v[168:171], v[184:187], v[104:107]
    ds_read_b128 v[140:143], v20 offset:6144
    v_mfma_f32_16x16x32_bf16 v[108:111], v[168:171], v[188:191], v[108:111]
    v_mfma_f32_16x16x32_bf16 v[112:115], v[172:175], v[176:179], v[112:115]
    v_mfma_f32_16x16x32_bf16 v[116:119], v[172:175], v[180:183], v[116:119]
    v_mfma_f32_16x16x32_bf16 v[120:123], v[172:175], v[184:187], v[120:123]
    v_mfma_f32_16x16x32_bf16 v[124:127], v[172:175], v[188:191], v[124:127]
    s_waitcnt lgkmcnt(0)
    v_mfma_f32_16x16x32_bf16 v[64:67], v[128:131], v[144:147], v[64:67]
    ds_read_b128 v[160:163], v21 offset:0
    v_mfma_f32_16x16x32_bf16 v[68:71], v[128:131], v[148:151], v[68:71]
    ds_read_b128 v[176:179], v23 offset:16384
    v_mfma_f32_16x16x32_bf16 v[72:75], v[128:131], v[152:155], v[72:75]
    v_mfma_f32_16x16x32_bf16 v[76:79], v[128:131], v[156:159], v[76:79]
    ds_read_b128 v[180:183], v23 offset:18432
    v_mfma_f32_16x16x32_bf16 v[80:83], v[132:135], v[144:147], v[80:83]
    ds_read_b128 v[184:187], v23 offset:20480
    v_mfma_f32_16x16x32_bf16 v[84:87], v[132:135], v[148:151], v[84:87]
    v_mfma_f32_16x16x32_bf16 v[88:91], v[132:135], v[152:155], v[88:91]
    ds_read_b128 v[188:191], v23 offset:22528
    v_mfma_f32_16x16x32_bf16 v[92:95], v[132:135], v[156:159], v[92:95]
    ds_read_b128 v[164:167], v21 offset:2048
    v_mfma_f32_16x16x32_bf16 v[96:99], v[136:139], v[144:147], v[96:99]
    v_mfma_f32_16x16x32_bf16 v[100:103], v[136:139], v[148:151], v[100:103]
    ds_read_b128 v[168:171], v21 offset:4096
    v_mfma_f32_16x16x32_bf16 v[104:107], v[136:139], v[152:155], v[104:107]
    ds_read_b128 v[172:175], v21 offset:6144
    v_mfma_f32_16x16x32_bf16 v[108:111], v[136:139], v[156:159], v[108:111]
    v_mfma_f32_16x16x32_bf16 v[112:115], v[140:143], v[144:147], v[112:115]
    v_mfma_f32_16x16x32_bf16 v[116:119], v[140:143], v[148:151], v[116:119]
    v_mfma_f32_16x16x32_bf16 v[120:123], v[140:143], v[152:155], v[120:123]
    v_mfma_f32_16x16x32_bf16 v[124:127], v[140:143], v[156:159], v[124:127]
    s_waitcnt lgkmcnt(0)
    s_barrier
    v_mfma_f32_16x16x32_bf16 v[64:67], v[160:163], v[176:179], v[64:67]
    ds_read_b128 v[128:131], v16 offset:0
    v_mfma_f32_16x16x32_bf16 v[68:71], v[160:163], v[180:183], v[68:71]
    ds_read_b128 v[144:147], v18 offset:16384
    v_mfma_f32_16x16x32_bf16 v[72:75], v[160:163], v[184:187], v[72:75]
    v_mfma_f32_16x16x32_bf16 v[76:79], v[160:163], v[188:191], v[76:79]
    ds_read_b128 v[148:151], v18 offset:18432
    v_mfma_f32_16x16x32_bf16 v[80:83], v[164:167], v[176:179], v[80:83]
    ds_read_b128 v[152:155], v18 offset:20480
    v_mfma_f32_16x16x32_bf16 v[84:87], v[164:167], v[180:183], v[84:87]
    v_mfma_f32_16x16x32_bf16 v[88:91], v[164:167], v[184:187], v[88:91]
    ds_read_b128 v[156:159], v18 offset:22528
    v_mfma_f32_16x16x32_bf16 v[92:95], v[164:167], v[188:191], v[92:95]
    ds_read_b128 v[132:135], v16 offset:2048
    v_mfma_f32_16x16x32_bf16 v[96:99], v[168:171], v[176:179], v[96:99]
    v_mfma_f32_16x16x32_bf16 v[100:103], v[168:171], v[180:183], v[100:103]
    ds_read_b128 v[136:139], v16 offset:4096
    v_mfma_f32_16x16x32_bf16 v[104:107], v[168:171], v[184:187], v[104:107]
    ds_read_b128 v[140:143], v16 offset:6144
    v_mfma_f32_16x16x32_bf16 v[108:111], v[168:171], v[188:191], v[108:111]
    v_mfma_f32_16x16x32_bf16 v[112:115], v[172:175], v[176:179], v[112:115]
    v_mfma_f32_16x16x32_bf16 v[116:119], v[172:175], v[180:183], v[116:119]
    v_mfma_f32_16x16x32_bf16 v[120:123], v[172:175], v[184:187], v[120:123]
    v_mfma_f32_16x16x32_bf16 v[124:127], v[172:175], v[188:191], v[124:127]
    s_waitcnt lgkmcnt(0)
    v_mfma_f32_16x16x32_bf16 v[64:67], v[128:131], v[144:147], v[64:67]
    ds_read_b128 v[160:163], v17 offset:0
    v_mfma_f32_16x16x32_bf16 v[68:71], v[128:131], v[148:151], v[68:71]
    ds_read_b128 v[176:179], v19 offset:16384
    v_mfma_f32_16x16x32_bf16 v[72:75], v[128:131], v[152:155], v[72:75]
    v_mfma_f32_16x16x32_bf16 v[76:79], v[128:131], v[156:159], v[76:79]
    ds_read_b128 v[180:183], v19 offset:18432
    v_mfma_f32_16x16x32_bf16 v[80:83], v[132:135], v[144:147], v[80:83]
    ds_read_b128 v[184:187], v19 offset:20480
    v_mfma_f32_16x16x32_bf16 v[84:87], v[132:135], v[148:151], v[84:87]
    v_mfma_f32_16x16x32_bf16 v[88:91], v[132:135], v[152:155], v[88:91]
    ds_read_b128 v[188:191], v19 offset:22528
    v_mfma_f32_16x16x32_bf16 v[92:95], v[132:135], v[156:159], v[92:95]
    ds_read_b128 v[164:167], v17 offset:2048
    v_mfma_f32_16x16x32_bf16 v[96:99], v[136:139], v[144:147], v[96:99]
    v_mfma_f32_16x16x32_bf16 v[100:103], v[136:139], v[148:151], v[100:103]
    ds_read_b128 v[168:171], v17 offset:4096
    v_mfma_f32_16x16x32_bf16 v[104:107], v[136:139], v[152:155], v[104:107]
    ds_read_b128 v[172:175], v17 offset:6144
    v_mfma_f32_16x16x32_bf16 v[108:111], v[136:139], v[156:159], v[108:111]
    v_mfma_f32_16x16x32_bf16 v[112:115], v[140:143], v[144:147], v[112:115]
    v_mfma_f32_16x16x32_bf16 v[116:119], v[140:143], v[148:151], v[116:119]
    v_mfma_f32_16x16x32_bf16 v[120:123], v[140:143], v[152:155], v[120:123]
    v_mfma_f32_16x16x32_bf16 v[124:127], v[140:143], v[156:159], v[124:127]
    s_waitcnt lgkmcnt(0) vmcnt(0)
    v_mfma_f32_16x16x32_bf16 v[64:67], v[160:163], v[176:179], v[64:67]
    v_mfma_f32_16x16x32_bf16 v[68:71], v[160:163], v[180:183], v[68:71]
    v_mfma_f32_16x16x32_bf16 v[72:75], v[160:163], v[184:187], v[72:75]
    v_mfma_f32_16x16x32_bf16 v[76:79], v[160:163], v[188:191], v[76:79]
    v_mfma_f32_16x16x32_bf16 v[80:83], v[164:167], v[176:179], v[80:83]
    v_mfma_f32_16x16x32_bf16 v[84:87], v[164:167], v[180:183], v[84:87]
    v_mfma_f32_16x16x32_bf16 v[88:91], v[164:167], v[184:187], v[88:91]
    v_mfma_f32_16x16x32_bf16 v[92:95], v[164:167], v[188:191], v[92:95]
    v_mfma_f32_16x16x32_bf16 v[96:99], v[168:171], v[176:179], v[96:99]
    v_mfma_f32_16x16x32_bf16 v[100:103], v[168:171], v[180:183], v[100:103]
    v_mfma_f32_16x16x32_bf16 v[104:107], v[168:171], v[184:187], v[104:107]
    v_mfma_f32_16x16x32_bf16 v[108:111], v[168:171], v[188:191], v[108:111]
    v_mfma_f32_16x16x32_bf16 v[112:115], v[172:175], v[176:179], v[112:115]
    v_mfma_f32_16x16x32_bf16 v[116:119], v[172:175], v[180:183], v[116:119]
    v_mfma_f32_16x16x32_bf16 v[120:123], v[172:175], v[184:187], v[120:123]
    v_mfma_f32_16x16x32_bf16 v[124:127], v[172:175], v[188:191], v[124:127]
    s_mov_b32 s44, 0
    s_mov_b32 s45, 4096
    s_mov_b32 s46, 8192
    s_mov_b32 s47, 12288
    v_mov_b32 v61, s93
    v_mov_b32 v63, s93
    v_and_b32 v216, 31, v24
    v_lshlrev_b32 v216, 2, v216
    v_add_u32 v216, 73728, v216
    v_mov_b32 v218, 0
    ds_write_b32 v216, v218
    v_pk_fma_f32 v[16:17], v[30:31], v[72:73], v[66:67] op_sel:[0,0,0] op_sel_hi:[0,1,1] neg_lo:[1,0,0] neg_hi:[1,0,0]
    v_pk_fma_f32 v[18:19], v[30:31], v[64:65], v[74:75] op_sel:[0,0,0] op_sel_hi:[0,1,1]
    v_pk_fma_f32 v[8:9], v[28:29], v[64:65], v[16:17] op_sel:[0,0,0] op_sel_hi:[0,1,1]
    v_pk_fma_f32 v[10:11], v[28:29], v[72:73], v[18:19] op_sel:[0,0,0] op_sel_hi:[0,1,1]
    v_pk_fma_f32 v[20:21], v[30:31], v[76:77], v[70:71] op_sel:[1,0,0] op_sel_hi:[1,1,1] neg_lo:[1,0,0] neg_hi:[1,0,0]
    v_pk_fma_f32 v[22:23], v[30:31], v[68:69], v[78:79] op_sel:[1,0,0] op_sel_hi:[1,1,1]
    v_pk_fma_f32 v[12:13], v[28:29], v[68:69], v[20:21] op_sel:[1,0,0] op_sel_hi:[1,1,1]
    v_pk_fma_f32 v[14:15], v[28:29], v[76:77], v[22:23] op_sel:[1,0,0] op_sel_hi:[1,1,1]
    v_pk_fma_f32 v[16:17], v[30:31], v[10:11], v[80:81] op_sel:[0,0,0] op_sel_hi:[0,1,1] neg_lo:[1,0,0] neg_hi:[1,0,0]
    v_pk_fma_f32 v[18:19], v[30:31], v[8:9], v[88:89] op_sel:[0,0,0] op_sel_hi:[0,1,1]
    v_pk_fma_f32 v[8:9], v[28:29], v[8:9], v[16:17] op_sel:[0,0,0] op_sel_hi:[0,1,1]
    v_pk_fma_f32 v[10:11], v[28:29], v[10:11], v[18:19] op_sel:[0,0,0] op_sel_hi:[0,1,1]
    v_pk_fma_f32 v[20:21], v[30:31], v[14:15], v[84:85] op_sel:[1,0,0] op_sel_hi:[1,1,1] neg_lo:[1,0,0] neg_hi:[1,0,0]
    v_pk_fma_f32 v[22:23], v[30:31], v[12:13], v[92:93] op_sel:[1,0,0] op_sel_hi:[1,1,1]
    v_pk_fma_f32 v[12:13], v[28:29], v[12:13], v[20:21] op_sel:[1,0,0] op_sel_hi:[1,1,1]
    v_pk_fma_f32 v[14:15], v[28:29], v[14:15], v[22:23] op_sel:[1,0,0] op_sel_hi:[1,1,1]
    v_pk_fma_f32 v[16:17], v[30:31], v[10:11], v[82:83] op_sel:[0,0,0] op_sel_hi:[0,1,1] neg_lo:[1,0,0] neg_hi:[1,0,0]
    v_pk_fma_f32 v[18:19], v[30:31], v[8:9], v[90:91] op_sel:[0,0,0] op_sel_hi:[0,1,1]
    v_pk_fma_f32 v[8:9], v[28:29], v[8:9], v[16:17] op_sel:[0,0,0] op_sel_hi:[0,1,1]
    v_pk_fma_f32 v[10:11], v[28:29], v[10:11], v[18:19] op_sel:[0,0,0] op_sel_hi:[0,1,1]
    v_pk_fma_f32 v[20:21], v[30:31], v[14:15], v[86:87] op_sel:[1,0,0] op_sel_hi:[1,1,1] neg_lo:[1,0,0] neg_hi:[1,0,0]
    v_pk_fma_f32 v[22:23], v[30:31], v[12:13], v[94:95] op_sel:[1,0,0] op_sel_hi:[1,1,1]
    v_pk_fma_f32 v[12:13], v[28:29], v[12:13], v[20:21] op_sel:[1,0,0] op_sel_hi:[1,1,1]
    v_pk_fma_f32 v[14:15], v[28:29], v[14:15], v[22:23] op_sel:[1,0,0] op_sel_hi:[1,1,1]
    v_pk_fma_f32 v[16:17], v[30:31], v[10:11], v[96:97] op_sel:[0,0,0] op_sel_hi:[0,1,1] neg_lo:[1,0,0] neg_hi:[1,0,0]
    v_pk_fma_f32 v[18:19], v[30:31], v[8:9], v[104:105] op_sel:[0,0,0] op_sel_hi:[0,1,1]
    v_pk_fma_f32 v[8:9], v[28:29], v[8:9], v[16:17] op_sel:[0,0,0] op_sel_hi:[0,1,1]
    v_pk_fma_f32 v[10:11], v[28:29], v[10:11], v[18:19] op_sel:[0,0,0] op_sel_hi:[0,1,1]
    v_pk_fma_f32 v[20:21], v[30:31], v[14:15], v[100:101] op_sel:[1,0,0] op_sel_hi:[1,1,1] neg_lo:[1,0,0] neg_hi:[1,0,0]
    v_pk_fma_f32 v[22:23], v[30:31], v[12:13], v[108:109] op_sel:[1,0,0] op_sel_hi:[1,1,1]
    v_pk_fma_f32 v[12:13], v[28:29], v[12:13], v[20:21] op_sel:[1,0,0] op_sel_hi:[1,1,1]
    v_pk_fma_f32 v[14:15], v[28:29], v[14:15], v[22:23] op_sel:[1,0,0] op_sel_hi:[1,1,1]
    v_pk_fma_f32 v[16:17], v[30:31], v[10:11], v[98:99] op_sel:[0,0,0] op_sel_hi:[0,1,1] neg_lo:[1,0,0] neg_hi:[1,0,0]
    v_pk_fma_f32 v[18:19], v[30:31], v[8:9], v[106:107] op_sel:[0,0,0] op_sel_hi:[0,1,1]
    v_pk_fma_f32 v[8:9], v[28:29], v[8:9], v[16:17] op_sel:[0,0,0] op_sel_hi:[0,1,1]
    v_pk_fma_f32 v[10:11], v[28:29], v[10:11], v[18:19] op_sel:[0,0,0] op_sel_hi:[0,1,1]
    v_pk_fma_f32 v[20:21], v[30:31], v[14:15], v[102:103] op_sel:[1,0,0] op_sel_hi:[1,1,1] neg_lo:[1,0,0] neg_hi:[1,0,0]
    v_pk_fma_f32 v[22:23], v[30:31], v[12:13], v[110:111] op_sel:[1,0,0] op_sel_hi:[1,1,1]
    v_pk_fma_f32 v[12:13], v[28:29], v[12:13], v[20:21] op_sel:[1,0,0] op_sel_hi:[1,1,1]
    v_pk_fma_f32 v[14:15], v[28:29], v[14:15], v[22:23] op_sel:[1,0,0] op_sel_hi:[1,1,1]
    v_pk_fma_f32 v[16:17], v[30:31], v[10:11], v[112:113] op_sel:[0,0,0] op_sel_hi:[0,1,1] neg_lo:[1,0,0] neg_hi:[1,0,0]
    v_pk_fma_f32 v[18:19], v[30:31], v[8:9], v[120:121] op_sel:[0,0,0] op_sel_hi:[0,1,1]
    v_pk_fma_f32 v[8:9], v[28:29], v[8:9], v[16:17] op_sel:[0,0,0] op_sel_hi:[0,1,1]
    v_pk_fma_f32 v[10:11], v[28:29], v[10:11], v[18:19] op_sel:[0,0,0] op_sel_hi:[0,1,1]
    v_pk_fma_f32 v[20:21], v[30:31], v[14:15], v[116:117] op_sel:[1,0,0] op_sel_hi:[1,1,1] neg_lo:[1,0,0] neg_hi:[1,0,0]
    v_pk_fma_f32 v[22:23], v[30:31], v[12:13], v[124:125] op_sel:[1,0,0] op_sel_hi:[1,1,1]
    v_pk_fma_f32 v[12:13], v[28:29], v[12:13], v[20:21] op_sel:[1,0,0] op_sel_hi:[1,1,1]
    v_pk_fma_f32 v[14:15], v[28:29], v[14:15], v[22:23] op_sel:[1,0,0] op_sel_hi:[1,1,1]
    v_pk_fma_f32 v[16:17], v[30:31], v[10:11], v[114:115] op_sel:[0,0,0] op_sel_hi:[0,1,1] neg_lo:[1,0,0] neg_hi:[1,0,0]
    v_pk_fma_f32 v[18:19], v[30:31], v[8:9], v[122:123] op_sel:[0,0,0] op_sel_hi:[0,1,1]
    v_pk_fma_f32 v[8:9], v[28:29], v[8:9], v[16:17] op_sel:[0,0,0] op_sel_hi:[0,1,1]
    v_pk_fma_f32 v[10:11], v[28:29], v[10:11], v[18:19] op_sel:[0,0,0] op_sel_hi:[0,1,1]
    v_pk_fma_f32 v[20:21], v[30:31], v[14:15], v[118:119] op_sel:[1,0,0] op_sel_hi:[1,1,1] neg_lo:[1,0,0] neg_hi:[1,0,0]
    v_pk_fma_f32 v[22:23], v[30:31], v[12:13], v[126:127] op_sel:[1,0,0] op_sel_hi:[1,1,1]
    v_pk_fma_f32 v[12:13], v[28:29], v[12:13], v[20:21] op_sel:[1,0,0] op_sel_hi:[1,1,1]
    v_pk_fma_f32 v[14:15], v[28:29], v[14:15], v[22:23] op_sel:[1,0,0] op_sel_hi:[1,1,1]
    v_fma_f32 v56, -v38, v10, v9
    v_fma_f32 v58, v38, v8, v11
    v_fma_f32 v57, -v39, v14, v13
    v_fma_f32 v59, v39, v12, v15
    v_fma_f32 v56, v36, v8, v56
    v_fma_f32 v58, v36, v10, v58
    v_fma_f32 v57, v37, v12, v57
    v_fma_f32 v59, v37, v14, v59
    ds_write_b128 v192, v[56:59]
    s_waitcnt lgkmcnt(0)
    s_barrier
    ds_read_b128 v[160:163], v193 offset:0
    ds_read_b128 v[164:167], v193 offset:512
    ds_read_b128 v[168:171], v193 offset:1024
    ds_read_b128 v[172:175], v193 offset:1536
    ds_read_b128 v[176:179], v193 offset:2048
    ds_read_b128 v[180:183], v193 offset:2560
    ds_read_b128 v[184:187], v193 offset:3072
    ds_read_b128 v[188:191], v193 offset:3584
    s_waitcnt lgkmcnt(6)
    v_pk_fma_f32 v[164:165], v[42:43], v[162:163], v[164:165] op_sel:[0,0,0] op_sel_hi:[1,1,1] neg_lo:[1,0,0] neg_hi:[1,0,0]
    v_pk_fma_f32 v[166:167], v[42:43], v[160:161], v[166:167] op_sel:[0,0,0] op_sel_hi:[1,1,1]
    v_pk_fma_f32 v[164:165], v[40:41], v[160:161], v[164:165] op_sel:[0,0,0] op_sel_hi:[1,1,1]
    v_pk_fma_f32 v[166:167], v[40:41], v[162:163], v[166:167] op_sel:[0,0,0] op_sel_hi:[1,1,1]
    s_waitcnt lgkmcnt(5)
    v_pk_fma_f32 v[168:169], v[42:43], v[166:167], v[168:169] op_sel:[0,0,0] op_sel_hi:[1,1,1] neg_lo:[1,0,0] neg_hi:[1,0,0]
    v_pk_fma_f32 v[170:171], v[42:43], v[164:165], v[170:171] op_sel:[0,0,0] op_sel_hi:[1,1,1]
    v_pk_fma_f32 v[168:169], v[40:41], v[164:165], v[168:169] op_sel:[0,0,0] op_sel_hi:[1,1,1]
    v_pk_fma_f32 v[170:171], v[40:41], v[166:167], v[170:171] op_sel:[0,0,0] op_sel_hi:[1,1,1]
    s_waitcnt lgkmcnt(4)
    v_pk_fma_f32 v[172:173], v[42:43], v[170:171], v[172:173] op_sel:[0,0,0] op_sel_hi:[1,1,1] neg_lo:[1,0,0] neg_hi:[1,0,0]
    v_pk_fma_f32 v[174:175], v[42:43], v[168:169], v[174:175] op_sel:[0,0,0] op_sel_hi:[1,1,1]
    v_pk_fma_f32 v[172:173], v[40:41], v[168:169], v[172:173] op_sel:[0,0,0] op_sel_hi:[1,1,1]
    v_pk_fma_f32 v[174:175], v[40:41], v[170:171], v[174:175] op_sel:[0,0,0] op_sel_hi:[1,1,1]
    s_waitcnt lgkmcnt(3)
    v_pk_fma_f32 v[176:177], v[42:43], v[174:175], v[176:177] op_sel:[0,0,0] op_sel_hi:[1,1,1] neg_lo:[1,0,0] neg_hi:[1,0,0]
    v_pk_fma_f32 v[178:179], v[42:43], v[172:173], v[178:179] op_sel:[0,0,0] op_sel_hi:[1,1,1]
    v_pk_fma_f32 v[176:177], v[40:41], v[172:173], v[176:177] op_sel:[0,0,0] op_sel_hi:[1,1,1]
    v_pk_fma_f32 v[178:179], v[40:41], v[174:175], v[178:179] op_sel:[0,0,0] op_sel_hi:[1,1,1]
    s_waitcnt lgkmcnt(2)
    v_pk_fma_f32 v[180:181], v[42:43], v[178:179], v[180:181] op_sel:[0,0,0] op_sel_hi:[1,1,1] neg_lo:[1,0,0] neg_hi:[1,0,0]
    v_pk_fma_f32 v[182:183], v[42:43], v[176:177], v[182:183] op_sel:[0,0,0] op_sel_hi:[1,1,1]
    v_pk_fma_f32 v[180:181], v[40:41], v[176:177], v[180:181] op_sel:[0,0,0] op_sel_hi:[1,1,1]
    v_pk_fma_f32 v[182:183], v[40:41], v[178:179], v[182:183] op_sel:[0,0,0] op_sel_hi:[1,1,1]
    s_waitcnt lgkmcnt(1)
    v_pk_fma_f32 v[184:185], v[42:43], v[182:183], v[184:185] op_sel:[0,0,0] op_sel_hi:[1,1,1] neg_lo:[1,0,0] neg_hi:[1,0,0]
    v_pk_fma_f32 v[186:187], v[42:43], v[180:181], v[186:187] op_sel:[0,0,0] op_sel_hi:[1,1,1]
    v_pk_fma_f32 v[184:185], v[40:41], v[180:181], v[184:185] op_sel:[0,0,0] op_sel_hi:[1,1,1]
    v_pk_fma_f32 v[186:187], v[40:41], v[182:183], v[186:187] op_sel:[0,0,0] op_sel_hi:[1,1,1]
    s_waitcnt lgkmcnt(0)
    v_pk_fma_f32 v[188:189], v[42:43], v[186:187], v[188:189] op_sel:[0,0,0] op_sel_hi:[1,1,1] neg_lo:[1,0,0] neg_hi:[1,0,0]
    v_pk_fma_f32 v[190:191], v[42:43], v[184:185], v[190:191] op_sel:[0,0,0] op_sel_hi:[1,1,1]
    v_pk_fma_f32 v[188:189], v[40:41], v[184:185], v[188:189] op_sel:[0,0,0] op_sel_hi:[1,1,1]
    v_pk_fma_f32 v[190:191], v[40:41], v[186:187], v[190:191] op_sel:[0,0,0] op_sel_hi:[1,1,1]
    v_cndmask_b32 v60, v188, v189, s[84:85]
    v_cndmask_b32 v62, v190, v191, s[84:85]
    s_cmp_lg_u32 s19, 0
    s_cbranch_scc1 L_nopub
    s_mov_b32 exec_hi, 0
    buffer_store_dwordx4 v[60:63], v27, s[24:27], 0 offen sc1
    s_mov_b32 exec_hi, -1
L_nopub:
    v_cndmask_b32 v16, 0, v172, s[98:99]
    v_cndmask_b32 v17, v160, v176, s[98:99]
    v_cndmask_b32 v18, v164, v180, s[98:99]
    v_cndmask_b32 v19, v168, v184, s[98:99]
    v_cndmask_b32 v16, v16, v17, s[84:85]
    v_cndmask_b32 v18, v18, v19, s[84:85]
    v_cndmask_b32 v216, v16, v18, s[86:87]
    v_cndmask_b32 v16, 0, v173, s[98:99]
    v_cndmask_b32 v17, v161, v177, s[98:99]
    v_cndmask_b32 v18, v165, v181, s[98:99]
    v_cndmask_b32 v19, v169, v185, s[98:99]
    v_cndmask_b32 v16, v16, v17, s[84:85]
    v_cndmask_b32 v18, v18, v19, s[84:85]
    v_cndmask_b32 v217, v16, v18, s[86:87]
    v_cndmask_b32 v16, 0, v174, s[98:99]
    v_cndmask_b32 v17, v162, v178, s[98:99]
    v_cndmask_b32 v18, v166, v182, s[98:99]
    v_cndmask_b32 v19, v170, v186, s[98:99]
    v_cndmask_b32 v16, v16, v17, s[84:85]
    v_cndmask_b32 v18, v18, v19, s[84:85]
    v_cndmask_b32 v218, v16, v18, s[86:87]
    v_cndmask_b32 v16, 0, v175, s[98:99]
    v_cndmask_b32 v17, v163, v179, s[98:99]
    v_cndmask_b32 v18, v167, v183, s[98:99]
    v_cndmask_b32 v19, v171, v187, s[98:99]
    v_cndmask_b32 v16, v16, v17, s[84:85]
    v_cndmask_b32 v18, v18, v19, s[84:85]
    v_cndmask_b32 v219, v16, v18, s[86:87]
    v_mov_b32 v16, v216
    v_mov_b32 v18, v218
    v_fma_f32 v17, -v38, v218, v8
    v_fma_f32 v19, v38, v216, v10
    v_fma_f32 v17, v36, v216, v17
    v_fma_f32 v19, v36, v218, v19
    v_pk_mul_f32 v[56:57], v[32:33], v[16:17] op_sel:[0,0] op_sel_hi:[0,1]
    v_pk_mul_f32 v[58:59], v[32:33], v[18:19] op_sel:[0,0] op_sel_hi:[0,1]
    v_pk_fma_f32 v[56:57], v[34:35], v[18:19], v[56:57] op_sel:[0,0,0] op_sel_hi:[0,1,1] neg_lo:[1,0,0] neg_hi:[1,0,0]
    v_pk_fma_f32 v[58:59], v[34:35], v[16:17], v[58:59] op_sel:[0,0,0] op_sel_hi:[0,1,1]
    v_mov_b32 v16, v217
    v_mov_b32 v18, v219
    v_fma_f32 v17, -v39, v219, v12
    v_fma_f32 v19, v39, v217, v14
    v_fma_f32 v17, v37, v217, v17
    v_fma_f32 v19, v37, v219, v19
    v_pk_mul_f32 v[60:61], v[32:33], v[16:17] op_sel:[1,0] op_sel_hi:[1,1]
    v_pk_mul_f32 v[62:63], v[32:33], v[18:19] op_sel:[1,0] op_sel_hi:[1,1]
    v_pk_fma_f32 v[60:61], v[34:35], v[18:19], v[60:61] op_sel:[1,0,0] op_sel_hi:[1,1,1] neg_lo:[1,0,0] neg_hi:[1,0,0]
    v_pk_fma_f32 v[62:63], v[34:35], v[16:17], v[62:63] op_sel:[1,0,0] op_sel_hi:[1,1,1]
    v_pk_mul_f32 v[128:129], v[32:33], v[72:73] op_sel:[0,0] op_sel_hi:[0,1]
    v_pk_fma_f32 v[128:129], v[34:35], v[64:65], v[128:129] op_sel:[0,0,0] op_sel_hi:[0,1,1]
    v_pk_mul_f32 v[64:65], v[32:33], v[64:65] op_sel:[0,0] op_sel_hi:[0,1]
    v_pk_fma_f32 v[64:65], v[34:35], v[72:73], v[64:65] op_sel:[0,0,0] op_sel_hi:[0,1,1] neg_lo:[1,0,0] neg_hi:[1,0,0]
    v_pk_mul_f32 v[144:145], v[32:33], v[76:77] op_sel:[1,0] op_sel_hi:[1,1]
    v_pk_fma_f32 v[144:145], v[34:35], v[68:69], v[144:145] op_sel:[1,0,0] op_sel_hi:[1,1,1]
    v_pk_mul_f32 v[68:69], v[32:33], v[68:69] op_sel:[1,0] op_sel_hi:[1,1]
    v_pk_fma_f32 v[68:69], v[34:35], v[76:77], v[68:69] op_sel:[1,0,0] op_sel_hi:[1,1,1] neg_lo:[1,0,0] neg_hi:[1,0,0]
    v_pk_mul_f32 v[130:131], v[32:33], v[74:75] op_sel:[0,0] op_sel_hi:[0,1]
    v_pk_fma_f32 v[130:131], v[34:35], v[66:67], v[130:131] op_sel:[0,0,0] op_sel_hi:[0,1,1]
    v_pk_mul_f32 v[66:67], v[32:33], v[66:67] op_sel:[0,0] op_sel_hi:[0,1]
    v_pk_fma_f32 v[66:67], v[34:35], v[74:75], v[66:67] op_sel:[0,0,0] op_sel_hi:[0,1,1] neg_lo:[1,0,0] neg_hi:[1,0,0]
    buffer_load_dwordx4 v[160:163], v194, s[24:27], s44 offen offset:0 sc1
    buffer_load_dwordx4 v[164:167], v194, s[24:27], s45 offen offset:0 sc1
    buffer_load_dwordx4 v[168:171], v194, s[24:27], s46 offen offset:0 sc1
    buffer_load_dwordx4 v[172:175], v194, s[24:27], s47 offen offset:0 sc1
    buffer_load_dwordx4 v[176:179], v194, s[24:27], s44 offen offset:256 sc1
    buffer_load_dwordx4 v[180:183], v194, s[24:27], s45 offen offset:256 sc1
    buffer_load_dwordx4 v[184:187], v194, s[24:27], s46 offen offset:256 sc1
    buffer_load_dwordx4 v[188:191], v194, s[24:27], s47 offen offset:256 sc1
    v_pk_mul_f32 v[146:147], v[32:33], v[78:79] op_sel:[1,0] op_sel_hi:[1,1]
    v_pk_fma_f32 v[146:147], v[34:35], v[70:71], v[146:147] op_sel:[1,0,0] op_sel_hi:[1,1,1]
    v_pk_mul_f32 v[70:71], v[32:33], v[70:71] op_sel:[1,0] op_sel_hi:[1,1]
    v_pk_fma_f32 v[70:71], v[34:35], v[78:79], v[70:71] op_sel:[1,0,0] op_sel_hi:[1,1,1] neg_lo:[1,0,0] neg_hi:[1,0,0]
    v_pk_mul_f32 v[132:133], v[32:33], v[88:89] op_sel:[0,0] op_sel_hi:[0,1]
    v_pk_fma_f32 v[132:133], v[34:35], v[80:81], v[132:133] op_sel:[0,0,0] op_sel_hi:[0,1,1]
    v_pk_mul_f32 v[80:81], v[32:33], v[80:81] op_sel:[0,0] op_sel_hi:[0,1]
    v_pk_fma_f32 v[80:81], v[34:35], v[88:89], v[80:81] op_sel:[0,0,0] op_sel_hi:[0,1,1] neg_lo:[1,0,0] neg_hi:[1,0,0]
    v_pk_mul_f32 v[148:149], v[32:33], v[92:93] op_sel:[1,0] op_sel_hi:[1,1]
    v_pk_fma_f32 v[148:149], v[34:35], v[84:85], v[148:149] op_sel:[1,0,0] op_sel_hi:[1,1,1]
    v_pk_mul_f32 v[84:85], v[32:33], v[84:85] op_sel:[1,0] op_sel_hi:[1,1]
    v_pk_fma_f32 v[84:85], v[34:35], v[92:93], v[84:85] op_sel:[1,0,0] op_sel_hi:[1,1,1] neg_lo:[1,0,0] neg_hi:[1,0,0]
    v_pk_mul_f32 v[134:135], v[32:33], v[90:91] op_sel:[0,0] op_sel_hi:[0,1]
    v_pk_fma_f32 v[134:135], v[34:35], v[82:83], v[134:135] op_sel:[0,0,0] op_sel_hi:[0,1,1]
    v_pk_mul_f32 v[82:83], v[32:33], v[82:83] op_sel:[0,0] op_sel_hi:[0,1]
    v_pk_fma_f32 v[82:83], v[34:35], v[90:91], v[82:83] op_sel:[0,0,0] op_sel_hi:[0,1,1] neg_lo:[1,0,0] neg_hi:[1,0,0]
    v_pk_mul_f32 v[150:151], v[32:33], v[94:95] op_sel:[1,0] op_sel_hi:[1,1]
    v_pk_fma_f32 v[150:151], v[34:35], v[86:87], v[150:151] op_sel:[1,0,0] op_sel_hi:[1,1,1]
    v_pk_mul_f32 v[86:87], v[32:33], v[86:87] op_sel:[1,0] op_sel_hi:[1,1]
    v_pk_fma_f32 v[86:87], v[34:35], v[94:95], v[86:87] op_sel:[1,0,0] op_sel_hi:[1,1,1] neg_lo:[1,0,0] neg_hi:[1,0,0]
    v_pk_mul_f32 v[136:137], v[32:33], v[104:105] op_sel:[0,0] op_sel_hi:[0,1]
    v_pk_fma_f32 v[136:137], v[34:35], v[96:97], v[136:137] op_sel:[0,0,0] op_sel_hi:[0,1,1]
    v_pk_mul_f32 v[96:97], v[32:33], v[96:97] op_sel:[0,0] op_sel_hi:[0,1]
    v_pk_fma_f32 v[96:97], v[34:35], v[104:105], v[96:97] op_sel:[0,0,0] op_sel_hi:[0,1,1] neg_lo:[1,0,0] neg_hi:[1,0,0]
    v_pk_mul_f32 v[152:153], v[32:33], v[108:109] op_sel:[1,0] op_sel_hi:[1,1]
    v_pk_fma_f32 v[152:153], v[34:35], v[100:101], v[152:153] op_sel:[1,0,0] op_sel_hi:[1,1,1]
    v_pk_mul_f32 v[100:101], v[32:33], v[100:101] op_sel:[1,0] op_sel_hi:[1,1]
    v_pk_fma_f32 v[100:101], v[34:35], v[108:109], v[100:101] op_sel:[1,0,0] op_sel_hi:[1,1,1] neg_lo:[1,0,0] neg_hi:[1,0,0]
    v_pk_mul_f32 v[138:139], v[32:33], v[106:107] op_sel:[0,0] op_sel_hi:[0,1]
    v_pk_fma_f32 v[138:139], v[34:35], v[98:99], v[138:139] op_sel:[0,0,0] op_sel_hi:[0,1,1]
    v_pk_mul_f32 v[98:99], v[32:33], v[98:99] op_sel:[0,0] op_sel_hi:[0,1]
    v_pk_fma_f32 v[98:99], v[34:35], v[106:107], v[98:99] op_sel:[0,0,0] op_sel_hi:[0,1,1] neg_lo:[1,0,0] neg_hi:[1,0,0]
    v_pk_mul_f32 v[154:155], v[32:33], v[110:111] op_sel:[1,0] op_sel_hi:[1,1]
    v_pk_fma_f32 v[154:155], v[34:35], v[102:103], v[154:155] op_sel:[1,0,0] op_sel_hi:[1,1,1]
    v_pk_mul_f32 v[102:103], v[32:33], v[102:103] op_sel:[1,0] op_sel_hi:[1,1]
    v_pk_fma_f32 v[102:103], v[34:35], v[110:111], v[102:103] op_sel:[1,0,0] op_sel_hi:[1,1,1] neg_lo:[1,0,0] neg_hi:[1,0,0]
    v_pk_mul_f32 v[140:141], v[32:33], v[120:121] op_sel:[0,0] op_sel_hi:[0,1]
    v_pk_fma_f32 v[140:141], v[34:35], v[112:113], v[140:141] op_sel:[0,0,0] op_sel_hi:[0,1,1]
    v_pk_mul_f32 v[112:113], v[32:33], v[112:113] op_sel:[0,0] op_sel_hi:[0,1]
    v_pk_fma_f32 v[112:113], v[34:35], v[120:121], v[112:113] op_sel:[0,0,0] op_sel_hi:[0,1,1] neg_lo:[1,0,0] neg_hi:[1,0,0]
    v_pk_mul_f32 v[156:157], v[32:33], v[124:125] op_sel:[1,0] op_sel_hi:[1,1]
    v_pk_fma_f32 v[156:157], v[34:35], v[116:117], v[156:157] op_sel:[1,0,0] op_sel_hi:[1,1,1]
    v_pk_mul_f32 v[116:117], v[32:33], v[116:117] op_sel:[1,0] op_sel_hi:[1,1]
    v_pk_fma_f32 v[116:117], v[34:35], v[124:125], v[116:117] op_sel:[1,0,0] op_sel_hi:[1,1,1] neg_lo:[1,0,0] neg_hi:[1,0,0]
    v_pk_mul_f32 v[142:143], v[32:33], v[122:123] op_sel:[0,0] op_sel_hi:[0,1]
    v_pk_fma_f32 v[142:143], v[34:35], v[114:115], v[142:143] op_sel:[0,0,0] op_sel_hi:[0,1,1]
    v_pk_mul_f32 v[114:115], v[32:33], v[114:115] op_sel:[0,0] op_sel_hi:[0,1]
    v_pk_fma_f32 v[114:115], v[34:35], v[122:123], v[114:115] op_sel:[0,0,0] op_sel_hi:[0,1,1] neg_lo:[1,0,0] neg_hi:[1,0,0]
    v_pk_mul_f32 v[158:159], v[32:33], v[126:127] op_sel:[1,0] op_sel_hi:[1,1]
    v_pk_fma_f32 v[158:159], v[34:35], v[118:119], v[158:159] op_sel:[1,0,0] op_sel_hi:[1,1,1]
    v_pk_mul_f32 v[118:119], v[32:33], v[118:119] op_sel:[1,0] op_sel_hi:[1,1]
    v_pk_fma_f32 v[118:119], v[34:35], v[126:127], v[118:119] op_sel:[1,0,0] op_sel_hi:[1,1,1] neg_lo:[1,0,0] neg_hi:[1,0,0]
    buffer_load_dwordx2 v[240:241], v221, s[12:15], s57 offen sc1
    global_load_dwordx2 v[242:243], v222, s[58:59]
    buffer_load_dwordx2 v[224:225], v220, s[4:7], s56 offen
    s_add_u32 s56, s56, 8192
    buffer_load_dwordx2 v[226:227], v220, s[4:7], s56 offen
    s_add_u32 s56, s56, 8192
    buffer_load_dwordx2 v[228:229], v220, s[4:7], s56 offen
    s_add_u32 s56, s56, 8192
    buffer_load_dwordx2 v[230:231], v220, s[4:7], s56 offen
    s_add_u32 s56, s56, 8192
    buffer_load_dwordx2 v[232:233], v220, s[4:7], s56 offen
    s_add_u32 s56, s56, 8192
    buffer_load_dwordx2 v[234:235], v220, s[4:7], s56 offen
    s_add_u32 s56, s56, 8192
    buffer_load_dwordx2 v[236:237], v220, s[4:7], s56 offen
    s_add_u32 s56, s56, 8192
    buffer_load_dwordx2 v[238:239], v220, s[4:7], s56 offen
    s_add_u32 s56, s56, 8192
    s_waitcnt vmcnt(10)
L_poll:
    v_xor_b32 v161, v161, v198
    v_xor_b32 v163, v163, v198
    v_xor_b32 v165, v165, v199
    v_xor_b32 v167, v167, v199
    v_xor_b32 v169, v169, v200
    v_xor_b32 v171, v171, v200
    v_xor_b32 v173, v173, v201
    v_xor_b32 v175, v175, v201
    v_xor_b32 v177, v177, v198
    v_xor_b32 v179, v179, v198
    v_xor_b32 v181, v181, v199
    v_xor_b32 v183, v183, v199
    v_xor_b32 v185, v185, v200
    v_xor_b32 v187, v187, v200
    v_xor_b32 v189, v189, v201
    v_xor_b32 v191, v191, v201
    v_or3_b32 v214, v161, v163, v165
    v_or3_b32 v214, v214, v167, v169
    v_or3_b32 v214, v214, v171, v173
    v_or3_b32 v214, v214, v175, v177
    v_or3_b32 v214, v214, v179, v181
    v_or3_b32 v214, v214, v183, v185
    v_or3_b32 v214, v214, v187, v189
    v_or_b32 v214, v214, v191
    v_cmp_ne_u32 vcc, 0, v214
    s_nop 1
    s_cmp_eq_u64 vcc, 0
    s_cbranch_scc1 L_got
    s_sub_u32 s96, s96, 1
    s_cbranch_scc1 L_got
    s_sleep 1
    buffer_load_dwordx4 v[160:163], v194, s[24:27], s44 offen offset:0 sc1
    buffer_load_dwordx4 v[164:167], v194, s[24:27], s45 offen offset:0 sc1
    buffer_load_dwordx4 v[168:171], v194, s[24:27], s46 offen offset:0 sc1
    buffer_load_dwordx4 v[172:175], v194, s[24:27], s47 offen offset:0 sc1
    buffer_load_dwordx4 v[176:179], v194, s[24:27], s44 offen offset:256 sc1
    buffer_load_dwordx4 v[180:183], v194, s[24:27], s45 offen offset:256 sc1
    buffer_load_dwordx4 v[184:187], v194, s[24:27], s46 offen offset:256 sc1
    buffer_load_dwordx4 v[188:191], v194, s[24:27], s47 offen offset:256 sc1
    s_waitcnt vmcnt(0)
    s_branch L_poll
L_got:
    v_fma_f32 v168, -v46, v174, v168
    v_fma_f32 v170, v46, v172, v170
    v_fma_f32 v168, v44, v172, v168
    v_fma_f32 v170, v44, v174, v170
    v_fma_f32 v184, -v47, v190, v184
    v_fma_f32 v186, v47, v188, v186
    v_fma_f32 v184, v45, v188, v184
    v_fma_f32 v186, v45, v190, v186
    v_fma_f32 v164, -v46, v170, v164
    v_fma_f32 v166, v46, v168, v166
    v_fma_f32 v164, v44, v168, v164
    v_fma_f32 v166, v44, v170, v166
    v_fma_f32 v180, -v47, v186, v180
    v_fma_f32 v182, v47, v184, v182
    v_fma_f32 v180, v45, v184, v180
    v_fma_f32 v182, v45, v186, v182
    v_fma_f32 v160, -v46, v166, v160
    v_fma_f32 v162, v46, v164, v162
    v_fma_f32 v160, v44, v164, v160
    v_fma_f32 v162, v44, v166, v162
    v_fma_f32 v176, -v47, v182, v176
    v_fma_f32 v178, v47, v180, v178
    v_fma_f32 v176, v45, v180, v176
    v_fma_f32 v178, v45, v182, v178
    v_mul_f32 v16, v48, v160
    v_mul_f32 v17, v48, v162
    v_fma_f32 v16, -v50, v162, v16
    v_fma_f32 v17, v50, v160, v17
    v_mul_f32 v18, v49, v176
    v_mul_f32 v19, v49, v178
    v_fma_f32 v18, -v51, v178, v18
    v_fma_f32 v19, v51, v176, v19
    v_mov_b32 v20, v16
    v_mov_b32 v21, v17
    v_mov_b32 v22, v18
    v_mov_b32 v23, v19
    s_nop 1
    v_permlane16_swap_b32 v16, v20
    v_permlane16_swap_b32 v17, v21
    v_permlane16_swap_b32 v18, v22
    v_permlane16_swap_b32 v19, v23
    s_nop 1
    v_add_f32 v16, v16, v20
    v_add_f32 v17, v17, v21
    v_add_f32 v18, v18, v22
    v_add_f32 v19, v19, v23
    v_mov_b32 v20, v16
    v_mov_b32 v21, v17
    v_mov_b32 v22, v18
    v_mov_b32 v23, v19
    s_nop 1
    v_permlane32_swap_b32 v16, v20
    v_permlane32_swap_b32 v17, v21
    v_permlane32_swap_b32 v18, v22
    v_permlane32_swap_b32 v19, v23
    s_nop 1
    v_add_f32 v16, v16, v20
    v_add_f32 v17, v17, v21
    v_add_f32 v18, v18, v22
    v_add_f32 v19, v19, v23
    v_pk_fma_f32 v[56:57], v[16:17], v[206:207], v[56:57] op_sel:[0,0,0] op_sel_hi:[0,1,1]
    v_pk_fma_f32 v[58:59], v[16:17], v[208:209], v[58:59] op_sel:[0,0,0] op_sel_hi:[0,1,1]
    v_pk_fma_f32 v[56:57], v[16:17], v[208:209], v[56:57] op_sel:[1,0,0] op_sel_hi:[1,1,1] neg_lo:[1,0,0] neg_hi:[1,0,0]
    v_pk_fma_f32 v[58:59], v[16:17], v[206:207], v[58:59] op_sel:[1,0,0] op_sel_hi:[1,1,1]
    v_pk_fma_f32 v[60:61], v[18:19], v[210:211], v[60:61] op_sel:[0,0,0] op_sel_hi:[0,1,1]
    v_pk_fma_f32 v[62:63], v[18:19], v[212:213], v[62:63] op_sel:[0,0,0] op_sel_hi:[0,1,1]
    v_pk_fma_f32 v[60:61], v[18:19], v[212:213], v[60:61] op_sel:[1,0,0] op_sel_hi:[1,1,1] neg_lo:[1,0,0] neg_hi:[1,0,0]
    v_pk_fma_f32 v[62:63], v[18:19], v[210:211], v[62:63] op_sel:[1,0,0] op_sel_hi:[1,1,1]
    v_pk_fma_f32 v[64:65], v[30:31], v[58:59], v[64:65] op_sel:[0,0,0] op_sel_hi:[0,1,1] neg_lo:[1,0,0] neg_hi:[1,0,0]
    v_pk_fma_f32 v[128:129], v[30:31], v[56:57], v[128:129] op_sel:[0,0,0] op_sel_hi:[0,1,1]
    v_pk_fma_f32 v[64:65], v[28:29], v[56:57], v[64:65] op_sel:[0,0,0] op_sel_hi:[0,1,1]
    v_pk_fma_f32 v[128:129], v[28:29], v[58:59], v[128:129] op_sel:[0,0,0] op_sel_hi:[0,1,1]
    v_pk_fma_f32 v[68:69], v[30:31], v[62:63], v[68:69] op_sel:[1,0,0] op_sel_hi:[1,1,1] neg_lo:[1,0,0] neg_hi:[1,0,0]
    v_pk_fma_f32 v[144:145], v[30:31], v[60:61], v[144:145] op_sel:[1,0,0] op_sel_hi:[1,1,1]
    v_pk_fma_f32 v[68:69], v[28:29], v[60:61], v[68:69] op_sel:[1,0,0] op_sel_hi:[1,1,1]
    v_pk_fma_f32 v[144:145], v[28:29], v[62:63], v[144:145] op_sel:[1,0,0] op_sel_hi:[1,1,1]
    v_pk_fma_f32 v[66:67], v[30:31], v[128:129], v[66:67] op_sel:[0,0,0] op_sel_hi:[0,1,1] neg_lo:[1,0,0] neg_hi:[1,0,0]
    v_pk_fma_f32 v[130:131], v[30:31], v[64:65], v[130:131] op_sel:[0,0,0] op_sel_hi:[0,1,1]
    v_pk_fma_f32 v[66:67], v[28:29], v[64:65], v[66:67] op_sel:[0,0,0] op_sel_hi:[0,1,1]
    v_pk_fma_f32 v[130:131], v[28:29], v[128:129], v[130:131] op_sel:[0,0,0] op_sel_hi:[0,1,1]
    v_pk_fma_f32 v[70:71], v[30:31], v[144:145], v[70:71] op_sel:[1,0,0] op_sel_hi:[1,1,1] neg_lo:[1,0,0] neg_hi:[1,0,0]
    v_pk_fma_f32 v[146:147], v[30:31], v[68:69], v[146:147] op_sel:[1,0,0] op_sel_hi:[1,1,1]
    v_pk_fma_f32 v[70:71], v[28:29], v[68:69], v[70:71] op_sel:[1,0,0] op_sel_hi:[1,1,1]
    v_pk_fma_f32 v[146:147], v[28:29], v[144:145], v[146:147] op_sel:[1,0,0] op_sel_hi:[1,1,1]
    v_cvt_pk_bf16_f32 v160, v64, v66
    v_cvt_pk_bf16_f32 v168, -v128, -v130
    v_cvt_pk_bf16_f32 v164, v65, v67
    v_cvt_pk_bf16_f32 v172, -v129, -v131
    v_cvt_pk_bf16_f32 v176, v68, v70
    v_cvt_pk_bf16_f32 v184, -v144, -v146
    v_cvt_pk_bf16_f32 v180, v69, v71
    v_cvt_pk_bf16_f32 v188, -v145, -v147
    v_pk_fma_f32 v[80:81], v[30:31], v[130:131], v[80:81] op_sel:[0,0,0] op_sel_hi:[0,1,1] neg_lo:[1,0,0] neg_hi:[1,0,0]
    v_pk_fma_f32 v[132:133], v[30:31], v[66:67], v[132:133] op_sel:[0,0,0] op_sel_hi:[0,1,1]
    v_pk_fma_f32 v[80:81], v[28:29], v[66:67], v[80:81] op_sel:[0,0,0] op_sel_hi:[0,1,1]
    v_pk_fma_f32 v[132:133], v[28:29], v[130:131], v[132:133] op_sel:[0,0,0] op_sel_hi:[0,1,1]
    v_pk_fma_f32 v[84:85], v[30:31], v[146:147], v[84:85] op_sel:[1,0,0] op_sel_hi:[1,1,1] neg_lo:[1,0,0] neg_hi:[1,0,0]
    v_pk_fma_f32 v[148:149], v[30:31], v[70:71], v[148:149] op_sel:[1,0,0] op_sel_hi:[1,1,1]
    v_pk_fma_f32 v[84:85], v[28:29], v[70:71], v[84:85] op_sel:[1,0,0] op_sel_hi:[1,1,1]
    v_pk_fma_f32 v[148:149], v[28:29], v[146:147], v[148:149] op_sel:[1,0,0] op_sel_hi:[1,1,1]
    v_pk_fma_f32 v[82:83], v[30:31], v[132:133], v[82:83] op_sel:[0,0,0] op_sel_hi:[0,1,1] neg_lo:[1,0,0] neg_hi:[1,0,0]
    v_pk_fma_f32 v[134:135], v[30:31], v[80:81], v[134:135] op_sel:[0,0,0] op_sel_hi:[0,1,1]
    v_pk_fma_f32 v[82:83], v[28:29], v[80:81], v[82:83] op_sel:[0,0,0] op_sel_hi:[0,1,1]
    v_pk_fma_f32 v[134:135], v[28:29], v[132:133], v[134:135] op_sel:[0,0,0] op_sel_hi:[0,1,1]
    v_pk_fma_f32 v[86:87], v[30:31], v[148:149], v[86:87] op_sel:[1,0,0] op_sel_hi:[1,1,1] neg_lo:[1,0,0] neg_hi:[1,0,0]
    v_pk_fma_f32 v[150:151], v[30:31], v[84:85], v[150:151] op_sel:[1,0,0] op_sel_hi:[1,1,1]
    v_pk_fma_f32 v[86:87], v[28:29], v[84:85], v[86:87] op_sel:[1,0,0] op_sel_hi:[1,1,1]
    v_pk_fma_f32 v[150:151], v[28:29], v[148:149], v[150:151] op_sel:[1,0,0] op_sel_hi:[1,1,1]
    v_cvt_pk_bf16_f32 v161, v80, v82
    v_cvt_pk_bf16_f32 v169, -v132, -v134
    v_cvt_pk_bf16_f32 v165, v81, v83
    v_cvt_pk_bf16_f32 v173, -v133, -v135
    v_cvt_pk_bf16_f32 v177, v84, v86
    v_cvt_pk_bf16_f32 v185, -v148, -v150
    v_cvt_pk_bf16_f32 v181, v85, v87
    v_cvt_pk_bf16_f32 v189, -v149, -v151
    v_pk_fma_f32 v[96:97], v[30:31], v[134:135], v[96:97] op_sel:[0,0,0] op_sel_hi:[0,1,1] neg_lo:[1,0,0] neg_hi:[1,0,0]
    v_pk_fma_f32 v[136:137], v[30:31], v[82:83], v[136:137] op_sel:[0,0,0] op_sel_hi:[0,1,1]
    v_pk_fma_f32 v[96:97], v[28:29], v[82:83], v[96:97] op_sel:[0,0,0] op_sel_hi:[0,1,1]
    v_pk_fma_f32 v[136:137], v[28:29], v[134:135], v[136:137] op_sel:[0,0,0] op_sel_hi:[0,1,1]
    v_pk_fma_f32 v[100:101], v[30:31], v[150:151], v[100:101] op_sel:[1,0,0] op_sel_hi:[1,1,1] neg_lo:[1,0,0] neg_hi:[1,0,0]
    v_pk_fma_f32 v[152:153], v[30:31], v[86:87], v[152:153] op_sel:[1,0,0] op_sel_hi:[1,1,1]
    v_pk_fma_f32 v[100:101], v[28:29], v[86:87], v[100:101] op_sel:[1,0,0] op_sel_hi:[1,1,1]
    v_pk_fma_f32 v[152:153], v[28:29], v[150:151], v[152:153] op_sel:[1,0,0] op_sel_hi:[1,1,1]
    v_pk_fma_f32 v[98:99], v[30:31], v[136:137], v[98:99] op_sel:[0,0,0] op_sel_hi:[0,1,1] neg_lo:[1,0,0] neg_hi:[1,0,0]
    v_pk_fma_f32 v[138:139], v[30:31], v[96:97], v[138:139] op_sel:[0,0,0] op_sel_hi:[0,1,1]
    v_pk_fma_f32 v[98:99], v[28:29], v[96:97], v[98:99] op_sel:[0,0,0] op_sel_hi:[0,1,1]
    v_pk_fma_f32 v[138:139], v[28:29], v[136:137], v[138:139] op_sel:[0,0,0] op_sel_hi:[0,1,1]
    v_pk_fma_f32 v[102:103], v[30:31], v[152:153], v[102:103] op_sel:[1,0,0] op_sel_hi:[1,1,1] neg_lo:[1,0,0] neg_hi:[1,0,0]
    v_pk_fma_f32 v[154:155], v[30:31], v[100:101], v[154:155] op_sel:[1,0,0] op_sel_hi:[1,1,1]
    v_pk_fma_f32 v[102:103], v[28:29], v[100:101], v[102:103] op_sel:[1,0,0] op_sel_hi:[1,1,1]
    v_pk_fma_f32 v[154:155], v[28:29], v[152:153], v[154:155] op_sel:[1,0,0] op_sel_hi:[1,1,1]
    v_cvt_pk_bf16_f32 v162, v96, v98
    v_cvt_pk_bf16_f32 v170, -v136, -v138
    v_cvt_pk_bf16_f32 v166, v97, v99
    v_cvt_pk_bf16_f32 v174, -v137, -v139
    v_cvt_pk_bf16_f32 v178, v100, v102
    v_cvt_pk_bf16_f32 v186, -v152, -v154
    v_cvt_pk_bf16_f32 v182, v101, v103
    v_cvt_pk_bf16_f32 v190, -v153, -v155
    v_pk_fma_f32 v[112:113], v[30:31], v[138:139], v[112:113] op_sel:[0,0,0] op_sel_hi:[0,1,1] neg_lo:[1,0,0] neg_hi:[1,0,0]
    v_pk_fma_f32 v[140:141], v[30:31], v[98:99], v[140:141] op_sel:[0,0,0] op_sel_hi:[0,1,1]
    v_pk_fma_f32 v[112:113], v[28:29], v[98:99], v[112:113] op_sel:[0,0,0] op_sel_hi:[0,1,1]
    v_pk_fma_f32 v[140:141], v[28:29], v[138:139], v[140:141] op_sel:[0,0,0] op_sel_hi:[0,1,1]
    v_pk_fma_f32 v[116:117], v[30:31], v[154:155], v[116:117] op_sel:[1,0,0] op_sel_hi:[1,1,1] neg_lo:[1,0,0] neg_hi:[1,0,0]
    v_pk_fma_f32 v[156:157], v[30:31], v[102:103], v[156:157] op_sel:[1,0,0] op_sel_hi:[1,1,1]
    v_pk_fma_f32 v[116:117], v[28:29], v[102:103], v[116:117] op_sel:[1,0,0] op_sel_hi:[1,1,1]
    v_pk_fma_f32 v[156:157], v[28:29], v[154:155], v[156:157] op_sel:[1,0,0] op_sel_hi:[1,1,1]
    v_pk_fma_f32 v[114:115], v[30:31], v[140:141], v[114:115] op_sel:[0,0,0] op_sel_hi:[0,1,1] neg_lo:[1,0,0] neg_hi:[1,0,0]
    v_pk_fma_f32 v[142:143], v[30:31], v[112:113], v[142:143] op_sel:[0,0,0] op_sel_hi:[0,1,1]
    v_pk_fma_f32 v[114:115], v[28:29], v[112:113], v[114:115] op_sel:[0,0,0] op_sel_hi:[0,1,1]
    v_pk_fma_f32 v[142:143], v[28:29], v[140:141], v[142:143] op_sel:[0,0,0] op_sel_hi:[0,1,1]
    v_pk_fma_f32 v[118:119], v[30:31], v[156:157], v[118:119] op_sel:[1,0,0] op_sel_hi:[1,1,1] neg_lo:[1,0,0] neg_hi:[1,0,0]
    v_pk_fma_f32 v[158:159], v[30:31], v[116:117], v[158:159] op_sel:[1,0,0] op_sel_hi:[1,1,1]
    v_pk_fma_f32 v[118:119], v[28:29], v[116:117], v[118:119] op_sel:[1,0,0] op_sel_hi:[1,1,1]
    v_pk_fma_f32 v[158:159], v[28:29], v[156:157], v[158:159] op_sel:[1,0,0] op_sel_hi:[1,1,1]
    v_cvt_pk_bf16_f32 v163, v112, v114
    v_cvt_pk_bf16_f32 v171, -v140, -v142
    v_cvt_pk_bf16_f32 v167, v113, v115
    v_cvt_pk_bf16_f32 v175, -v141, -v143
    v_cvt_pk_bf16_f32 v179, v116, v118
    v_cvt_pk_bf16_f32 v187, -v156, -v158
    v_cvt_pk_bf16_f32 v183, v117, v119
    v_cvt_pk_bf16_f32 v191, -v157, -v159
    ds_write_b128 v195, v[160:163] offset:0
    ds_write_b128 v195, v[164:167] offset:16
    ds_write_b128 v195, v[176:179] offset:2304
    ds_write_b128 v195, v[180:183] offset:2320
    ds_write_b128 v195, v[168:171] offset:4608
    ds_write_b128 v195, v[172:175] offset:4624
    ds_write_b128 v195, v[184:187] offset:6912
    ds_write_b128 v195, v[188:191] offset:6928
    s_waitcnt lgkmcnt(4)
    ds_read_b64_tr_b16 v[128:129], v196 offset:0
    ds_read_b64_tr_b16 v[130:131], v196 offset:576
    ds_read_b64_tr_b16 v[132:133], v196 offset:32
    ds_read_b64_tr_b16 v[134:135], v196 offset:608
    ds_read_b64_tr_b16 v[136:137], v196 offset:64
    ds_read_b64_tr_b16 v[138:139], v196 offset:640
    ds_read_b64_tr_b16 v[140:141], v196 offset:96
    ds_read_b64_tr_b16 v[142:143], v196 offset:672
    s_waitcnt lgkmcnt(8)
    ds_read_b64_tr_b16 v[144:145], v196 offset:4608
    ds_read_b64_tr_b16 v[146:147], v196 offset:5184
    ds_read_b64_tr_b16 v[148:149], v196 offset:4640
    ds_read_b64_tr_b16 v[150:151], v196 offset:5216
    ds_read_b64_tr_b16 v[152:153], v196 offset:4672
    ds_read_b64_tr_b16 v[154:155], v196 offset:5248
    ds_read_b64_tr_b16 v[156:157], v196 offset:4704
    ds_read_b64_tr_b16 v[158:159], v196 offset:5280
    s_add_u32 s39, s53, 0
    s_waitcnt lgkmcnt(14)
    buffer_store_dwordx4 v[128:131], v197, s[12:15], s39 offen offset:0 sc1
    s_waitcnt lgkmcnt(12)
    buffer_store_dwordx4 v[132:135], v197, s[12:15], s39 offen offset:1024 sc1
    s_add_u32 s39, s53, 8192
    s_waitcnt lgkmcnt(10)
    buffer_store_dwordx4 v[136:139], v197, s[12:15], s39 offen offset:0 sc1
    s_waitcnt lgkmcnt(8)
    buffer_store_dwordx4 v[140:143], v197, s[12:15], s39 offen offset:1024 sc1
    s_add_u32 s39, s53, 4096
    s_waitcnt lgkmcnt(6)
    buffer_store_dwordx4 v[144:147], v197, s[12:15], s39 offen offset:0 sc1
    s_waitcnt lgkmcnt(4)
    buffer_store_dwordx4 v[148:151], v197, s[12:15], s39 offen offset:1024 sc1
    s_add_u32 s39, s53, 12288
    s_waitcnt lgkmcnt(2)
    buffer_store_dwordx4 v[152:155], v197, s[12:15], s39 offen offset:0 sc1
    s_waitcnt lgkmcnt(0)
    buffer_store_dwordx4 v[156:159], v197, s[12:15], s39 offen offset:1024 sc1
    s_waitcnt vmcnt(8)
L_gchk:
    v_cmp_ne_u32 vcc, s93, v241
    s_nop 1
    s_cmp_eq_u64 vcc, 0
    s_cbranch_scc1 L_gok
    s_sub_u32 s96, s96, 1
    s_cbranch_scc1 L_gok
    buffer_load_dwordx2 v[240:241], v221, s[12:15], s57 offen sc1
    s_waitcnt vmcnt(0)
    s_branch L_gchk
L_gok:
    v_lshlrev_b32 v6, 2, v25
    ds_bpermute_b32 v36, v6, v240 offset:0
    ds_bpermute_b32 v37, v6, v240 offset:16
    ds_bpermute_b32 v38, v6, v240 offset:32
    ds_bpermute_b32 v39, v6, v240 offset:48
    ds_bpermute_b32 v40, v6, v240 offset:64
    ds_bpermute_b32 v41, v6, v240 offset:80
    ds_bpermute_b32 v42, v6, v240 offset:96
    ds_bpermute_b32 v43, v6, v240 offset:112
    s_mov_b32 s10, 0xffff0000
    s_add_u32 m0, s23, 81920
    s_mov_b32 s21, s17
    s_lshl_b32 s21, s21, 7
    buffer_load_dwordx4 v202, s[28:31], s21 offen offset:0  lds
    v_lshlrev_b32 v252, 16, v242
    v_and_b32 v253, s10, v242
    v_lshlrev_b32 v254, 16, v243
    v_and_b32 v255, s10, v243
    s_waitcnt lgkmcnt(0)
    v_sub_f32 v12, 1.0, v36
    buffer_load_dwordx4 v203, s[28:31], s21 offen offset:1024  lds
    v_cvt_pk_bf16_f32 v12, v12, v12
    v_lshlrev_b32 v12, 16, v12
    v_lshlrev_b32 v8, 16, v224
    v_and_b32 v9, s10, v224
    v_mul_f32 v10, v8, v252
    v_mul_f32 v11, v9, v253
    buffer_load_dwordx4 v204, s[28:31], s21 offen offset:2048  lds
    v_cvt_pk_bf16_f32 v10, v10, v11
    v_mul_f32 v8, v8, v12
    v_mul_f32 v9, v9, v12
    v_cvt_pk_bf16_f32 v8, v8, v9
    v_and_b32 v11, s10, v10
    v_lshlrev_b32 v10, 16, v10
    buffer_load_dwordx4 v205, s[28:31], s21 offen offset:3072  lds
    v_and_b32 v9, s10, v8
    v_lshlrev_b32 v8, 16, v8
    v_fma_f32 v72, v36, v10, v8
    v_fma_f32 v73, v36, v11, v9
    v_lshlrev_b32 v8, 16, v225
    v_and_b32 v9, s10, v225
    s_add_u32 m0, s23, 0
    s_cmp_le_u32 s55, 0
    s_cselect_b32 s21, 1, 0
    s_or_b32 s21, s21, s54
    s_lshl_b32 s21, s21, 7
    buffer_load_dwordx4 v202, s[28:31], s21 offen offset:0  lds
    v_mul_f32 v10, v8, v254
    v_mul_f32 v11, v9, v255
    v_cvt_pk_bf16_f32 v10, v10, v11
    v_mul_f32 v8, v8, v12
    v_mul_f32 v9, v9, v12
    v_cvt_pk_bf16_f32 v8, v8, v9
    buffer_load_dwordx4 v203, s[28:31], s21 offen offset:1024  lds
    v_and_b32 v11, s10, v10
    v_lshlrev_b32 v10, 16, v10
    v_and_b32 v9, s10, v8
    v_lshlrev_b32 v8, 16, v8
    v_fma_f32 v74, v36, v10, v8
    v_fma_f32 v75, v36, v11, v9
    buffer_load_dwordx4 v204, s[28:31], s21 offen offset:2048  lds
    v_sub_f32 v12, 1.0, v37
    v_cvt_pk_bf16_f32 v12, v12, v12
    v_lshlrev_b32 v12, 16, v12
    v_lshlrev_b32 v8, 16, v226
    v_and_b32 v9, s10, v226
    v_mul_f32 v10, v8, v252
    buffer_load_dwordx4 v205, s[28:31], s21 offen offset:3072  lds
    v_mul_f32 v11, v9, v253
    v_cvt_pk_bf16_f32 v10, v10, v11
    v_mul_f32 v8, v8, v12
    v_mul_f32 v9, v9, v12
    v_cvt_pk_bf16_f32 v8, v8, v9
    v_and_b32 v11, s10, v10
    s_add_u32 m0, s23, 16384
    s_cmp_le_u32 s55, 1
    s_cselect_b32 s21, 2, 1
    s_or_b32 s21, s21, s54
    s_lshl_b32 s21, s21, 7
    buffer_load_dwordx4 v202, s[28:31], s21 offen offset:0  lds
    v_lshlrev_b32 v10, 16, v10
    v_and_b32 v9, s10, v8
    v_lshlrev_b32 v8, 16, v8
    v_fma_f32 v76, v37, v10, v8
    v_fma_f32 v77, v37, v11, v9
    v_lshlrev_b32 v8, 16, v227
    buffer_load_dwordx4 v203, s[28:31], s21 offen offset:1024  lds
    v_and_b32 v9, s10, v227
    v_mul_f32 v10, v8, v254
    v_mul_f32 v11, v9, v255
    v_cvt_pk_bf16_f32 v10, v10, v11
    v_mul_f32 v8, v8, v12
    v_mul_f32 v9, v9, v12
    buffer_load_dwordx4 v204, s[28:31], s21 offen offset:2048  lds
    v_cvt_pk_bf16_f32 v8, v8, v9
    v_and_b32 v11, s10, v10
    v_lshlrev_b32 v10, 16, v10
    v_and_b32 v9, s10, v8
    v_lshlrev_b32 v8, 16, v8
    v_fma_f32 v78, v37, v10, v8
    buffer_load_dwordx4 v205, s[28:31], s21 offen offset:3072  lds
    v_fma_f32 v79, v37, v11, v9
    v_sub_f32 v12, 1.0, v38
    v_cvt_pk_bf16_f32 v12, v12, v12
    v_lshlrev_b32 v12, 16, v12
    v_lshlrev_b32 v8, 16, v228
    v_and_b32 v9, s10, v228
    v_mul_f32 v10, v8, v252
    v_mul_f32 v11, v9, v253
    v_cvt_pk_bf16_f32 v10, v10, v11
    v_mul_f32 v8, v8, v12
    v_mul_f32 v9, v9, v12
    v_cvt_pk_bf16_f32 v8, v8, v9
    v_and_b32 v11, s10, v10
    v_lshlrev_b32 v10, 16, v10
    v_and_b32 v9, s10, v8
    v_lshlrev_b32 v8, 16, v8
    v_fma_f32 v88, v38, v10, v8
    v_fma_f32 v89, v38, v11, v9
    v_lshlrev_b32 v8, 16, v229
    v_and_b32 v9, s10, v229
    v_mul_f32 v10, v8, v254
    v_mul_f32 v11, v9, v255
    v_cvt_pk_bf16_f32 v10, v10, v11
    v_mul_f32 v8, v8, v12
    v_mul_f32 v9, v9, v12
    v_cvt_pk_bf16_f32 v8, v8, v9
    v_and_b32 v11, s10, v10
    v_lshlrev_b32 v10, 16, v10
    v_and_b32 v9, s10, v8
    v_lshlrev_b32 v8, 16, v8
    v_fma_f32 v90, v38, v10, v8
    v_fma_f32 v91, v38, v11, v9
    v_sub_f32 v12, 1.0, v39
    v_cvt_pk_bf16_f32 v12, v12, v12
    v_lshlrev_b32 v12, 16, v12
    v_lshlrev_b32 v8, 16, v230
    v_and_b32 v9, s10, v230
    v_mul_f32 v10, v8, v252
    v_mul_f32 v11, v9, v253
    v_cvt_pk_bf16_f32 v10, v10, v11
    v_mul_f32 v8, v8, v12
    v_mul_f32 v9, v9, v12
    v_cvt_pk_bf16_f32 v8, v8, v9
    v_and_b32 v11, s10, v10
    v_lshlrev_b32 v10, 16, v10
    v_and_b32 v9, s10, v8
    v_lshlrev_b32 v8, 16, v8
    v_fma_f32 v92, v39, v10, v8
    v_fma_f32 v93, v39, v11, v9
    v_lshlrev_b32 v8, 16, v231
    v_and_b32 v9, s10, v231
    v_mul_f32 v10, v8, v254
    v_mul_f32 v11, v9, v255
    v_cvt_pk_bf16_f32 v10, v10, v11
    v_mul_f32 v8, v8, v12
    v_mul_f32 v9, v9, v12
    v_cvt_pk_bf16_f32 v8, v8, v9
    v_and_b32 v11, s10, v10
    v_lshlrev_b32 v10, 16, v10
    v_and_b32 v9, s10, v8
    v_lshlrev_b32 v8, 16, v8
    v_fma_f32 v94, v39, v10, v8
    v_fma_f32 v95, v39, v11, v9
    v_sub_f32 v12, 1.0, v40
    v_cvt_pk_bf16_f32 v12, v12, v12
    v_lshlrev_b32 v12, 16, v12
    v_lshlrev_b32 v8, 16, v232
    v_and_b32 v9, s10, v232
    v_mul_f32 v10, v8, v252
    v_mul_f32 v11, v9, v253
    v_cvt_pk_bf16_f32 v10, v10, v11
    v_mul_f32 v8, v8, v12
    v_mul_f32 v9, v9, v12
    v_cvt_pk_bf16_f32 v8, v8, v9
    v_and_b32 v11, s10, v10
    v_lshlrev_b32 v10, 16, v10
    v_and_b32 v9, s10, v8
    v_lshlrev_b32 v8, 16, v8
    v_fma_f32 v104, v40, v10, v8
    v_fma_f32 v105, v40, v11, v9
    v_lshlrev_b32 v8, 16, v233
    v_and_b32 v9, s10, v233
    v_mul_f32 v10, v8, v254
    v_mul_f32 v11, v9, v255
    v_cvt_pk_bf16_f32 v10, v10, v11
    v_mul_f32 v8, v8, v12
    v_mul_f32 v9, v9, v12
    v_cvt_pk_bf16_f32 v8, v8, v9
    v_and_b32 v11, s10, v10
    v_lshlrev_b32 v10, 16, v10
    v_and_b32 v9, s10, v8
    v_lshlrev_b32 v8, 16, v8
    v_fma_f32 v106, v40, v10, v8
    v_fma_f32 v107, v40, v11, v9
    v_sub_f32 v12, 1.0, v41
    v_cvt_pk_bf16_f32 v12, v12, v12
    v_lshlrev_b32 v12, 16, v12
    v_lshlrev_b32 v8, 16, v234
    v_and_b32 v9, s10, v234
    v_mul_f32 v10, v8, v252
    v_mul_f32 v11, v9, v253
    v_cvt_pk_bf16_f32 v10, v10, v11
    v_mul_f32 v8, v8, v12
    v_mul_f32 v9, v9, v12
    v_cvt_pk_bf16_f32 v8, v8, v9
    v_and_b32 v11, s10, v10
    v_lshlrev_b32 v10, 16, v10
    v_and_b32 v9, s10, v8
    v_lshlrev_b32 v8, 16, v8
    v_fma_f32 v108, v41, v10, v8
    v_fma_f32 v109, v41, v11, v9
    v_lshlrev_b32 v8, 16, v235
    v_and_b32 v9, s10, v235
    v_mul_f32 v10, v8, v254
    v_mul_f32 v11, v9, v255
    v_cvt_pk_bf16_f32 v10, v10, v11
    v_mul_f32 v8, v8, v12
    v_mul_f32 v9, v9, v12
    v_cvt_pk_bf16_f32 v8, v8, v9
    v_and_b32 v11, s10, v10
    v_lshlrev_b32 v10, 16, v10
    v_and_b32 v9, s10, v8
    v_lshlrev_b32 v8, 16, v8
    v_fma_f32 v110, v41, v10, v8
    v_fma_f32 v111, v41, v11, v9
    v_sub_f32 v12, 1.0, v42
    v_cvt_pk_bf16_f32 v12, v12, v12
    v_lshlrev_b32 v12, 16, v12
    v_lshlrev_b32 v8, 16, v236
    v_and_b32 v9, s10, v236
    v_mul_f32 v10, v8, v252
    v_mul_f32 v11, v9, v253
    v_cvt_pk_bf16_f32 v10, v10, v11
    v_mul_f32 v8, v8, v12
    v_mul_f32 v9, v9, v12
    v_cvt_pk_bf16_f32 v8, v8, v9
    v_and_b32 v11, s10, v10
    v_lshlrev_b32 v10, 16, v10
    v_and_b32 v9, s10, v8
    v_lshlrev_b32 v8, 16, v8
    v_fma_f32 v120, v42, v10, v8
    v_fma_f32 v121, v42, v11, v9
    v_lshlrev_b32 v8, 16, v237
    v_and_b32 v9, s10, v237
    v_mul_f32 v10, v8, v254
    v_mul_f32 v11, v9, v255
    v_cvt_pk_bf16_f32 v10, v10, v11
    v_mul_f32 v8, v8, v12
    v_mul_f32 v9, v9, v12
    v_cvt_pk_bf16_f32 v8, v8, v9
    v_and_b32 v11, s10, v10
    v_lshlrev_b32 v10, 16, v10
    v_and_b32 v9, s10, v8
    v_lshlrev_b32 v8, 16, v8
    v_fma_f32 v122, v42, v10, v8
    v_fma_f32 v123, v42, v11, v9
    v_sub_f32 v12, 1.0, v43
    v_cvt_pk_bf16_f32 v12, v12, v12
    v_lshlrev_b32 v12, 16, v12
    v_lshlrev_b32 v8, 16, v238
    v_and_b32 v9, s10, v238
    v_mul_f32 v10, v8, v252
    v_mul_f32 v11, v9, v253
    v_cvt_pk_bf16_f32 v10, v10, v11
    v_mul_f32 v8, v8, v12
    v_mul_f32 v9, v9, v12
    v_cvt_pk_bf16_f32 v8, v8, v9
    v_and_b32 v11, s10, v10
    v_lshlrev_b32 v10, 16, v10
    v_and_b32 v9, s10, v8
    v_lshlrev_b32 v8, 16, v8
    v_fma_f32 v124, v43, v10, v8
    v_fma_f32 v125, v43, v11, v9
    v_lshlrev_b32 v8, 16, v239
    v_and_b32 v9, s10, v239
    v_mul_f32 v10, v8, v254
    v_mul_f32 v11, v9, v255
    v_cvt_pk_bf16_f32 v10, v10, v11
    v_mul_f32 v8, v8, v12
    v_mul_f32 v9, v9, v12
    v_cvt_pk_bf16_f32 v8, v8, v9
    v_and_b32 v11, s10, v10
    v_lshlrev_b32 v10, 16, v10
    v_and_b32 v9, s10, v8
    v_lshlrev_b32 v8, 16, v8
    v_fma_f32 v126, v43, v10, v8
    v_fma_f32 v127, v43, v11, v9
    v_mov_b32 v16, v202
    v_mov_b32 v17, v203
    v_mov_b32 v18, v204
    v_mov_b32 v19, v205
    v_mov_b32 v28, v197
    v_add_u32 v29, 4096, v197
    s_lshl_b32 s38, s18, 13
    s_add_u32 s50, s48, s38
    v_mov_b32 v32, 73728
    v_mov_b32 v33, 1
    v_bfe_u32 v59, v24, 1, 3
    v_xor_b32 v59, v59, v25
    v_lshlrev_b32 v59, 4, v59
    v_lshl_add_u32 v59, v26, 7, v59
    v_xor_b32 v20, 0, v59
    v_add_u32 v22, 0x10000, v20
    v_xor_b32 v21, 64, v59
    v_add_u32 v23, 0x10000, v21
    v_xor_b32 v30, s54, v26
    v_lshlrev_b32 v30, 8, v30
    v_mov_b32 v58, s93
    v_lshlrev_b32 v59, 2, v24
    s_lshl_b32 s52, s16, 12
    s_add_u32 s52, s52, 9502720
    s_lshl_b32 s46, s17, 8
    s_add_u32 s46, s46, s52
    s_mul_i32 s38, s18, 8704
    v_mul_u32_u24 v44, 272, v26
    v_lshl_add_u32 v44, v25, 4, v44
    v_add_u32 v44, s38, v44
    v_mul_u32_u24 v45, 272, v25
    v_lshl_add_u32 v45, v26, 4, v45
    v_add_u32 v45, s38, v45
    v_lshlrev_b32 v46, 12, v25
    v_lshl_add_u32 v46, v26, 4, v46
    v_lshlrev_b32 v47, 2, v24
    v_add_u32 v47, 73984, v47
    s_lshl_b32 s56, s51, 12
    s_lshl_b32 s39, s17, 8
    s_add_u32 s56, s56, s39
    s_sub_u32 s38, s20, s18
    s_mul_i32 s38, s38, 9216
    s_lshl_b32 s39, s19, 6
    s_add_u32 s38, s38, s39
    v_add_u32 v35, s38, v196
    s_waitcnt vmcnt(12)
    v_mov_b32 v57, 1
    s_mov_b64 exec, 1
    ds_add_rtn_u32 v57, v32, v57 offset:12
    s_mov_b64 exec, -1
    s_waitcnt lgkmcnt(0)
    v_readfirstlane_b32 s39, v57
    s_nop 1
    s_cmp_lg_u32 s39, 3
    s_cbranch_scc1 L_nohf
    s_mov_b32 exec_hi, 0
    buffer_store_dword v58, v59, s[12:15], s46 offen sc1
    s_mov_b32 exec_hi, -1
    s_waitcnt vmcnt(1)
    s_branch L_hfd
L_nohf:
    s_waitcnt vmcnt(0)
L_hfd:
    s_mov_b64 exec, 1
    ds_add_u32 v32, v33 offset:4
    s_mov_b64 exec, -1
    s_mov_b64 exec, 255
    buffer_load_dword v31, v30, s[12:15], s52 offen sc1
    s_mov_b64 exec, -1
L_sync0:
    ds_read_b32 v34, v32 offset:4
    s_waitcnt lgkmcnt(0)
    v_readfirstlane_b32 s38, v34
    s_nop 1
    s_cmp_ge_u32 s38, 4
    s_cbranch_scc1 L_sync0_ok
    s_sub_u32 s96, s96, 1
    s_cbranch_scc1 L_sync0_ok
    s_sleep 0
    s_branch L_sync0
L_sync0_ok:
    ds_read_b64_tr_b16 v[160:161], v35 offset:0
    ds_read_b64_tr_b16 v[162:163], v35 offset:576
    ds_read_b64_tr_b16 v[164:165], v35 offset:32
    ds_read_b64_tr_b16 v[166:167], v35 offset:608
    ds_read_b64_tr_b16 v[168:169], v35 offset:18432
    ds_read_b64_tr_b16 v[170:171], v35 offset:19008
    ds_read_b64_tr_b16 v[172:173], v35 offset:18464
    ds_read_b64_tr_b16 v[174:175], v35 offset:19040
    s_waitcnt lgkmcnt(4)
    ds_read_b64_tr_b16 v[176:177], v35 offset:4608
    ds_read_b64_tr_b16 v[178:179], v35 offset:5184
    ds_read_b64_tr_b16 v[180:181], v35 offset:4640
    ds_read_b64_tr_b16 v[182:183], v35 offset:5216
    ds_read_b64_tr_b16 v[184:185], v35 offset:23040
    ds_read_b64_tr_b16 v[186:187], v35 offset:23616
    ds_read_b64_tr_b16 v[188:189], v35 offset:23072
    ds_read_b64_tr_b16 v[190:191], v35 offset:23648
    s_mov_b64 exec, 1
    ds_add_u32 v32, v33 offset:72
    s_mov_b64 exec, -1
    s_waitcnt lgkmcnt(4)
    ds_read_b128 v[224:227], v22 offset:16384
    ds_read_b128 v[228:231], v22 offset:18432
    ds_read_b128 v[232:235], v22 offset:20480
    ds_read_b128 v[236:239], v22 offset:22528
    ds_read_b128 v[240:243], v23 offset:16384
    ds_read_b128 v[244:247], v23 offset:18432
    ds_read_b128 v[248:251], v23 offset:20480
    ds_read_b128 v[252:255], v23 offset:22528
    s_waitcnt lgkmcnt(4)
    v_mfma_f32_16x16x32_bf16 v[128:131], v[224:227], v[160:163], 0
    v_mfma_f32_16x16x32_bf16 v[132:135], v[228:231], v[160:163], 0
    v_mfma_f32_16x16x32_bf16 v[136:139], v[232:235], v[160:163], 0
    v_mfma_f32_16x16x32_bf16 v[140:143], v[236:239], v[160:163], 0
    v_mfma_f32_16x16x32_bf16 v[144:147], v[224:227], v[164:167], 0
    v_mfma_f32_16x16x32_bf16 v[148:151], v[228:231], v[164:167], 0
    v_mfma_f32_16x16x32_bf16 v[152:155], v[232:235], v[164:167], 0
    v_mfma_f32_16x16x32_bf16 v[156:159], v[236:239], v[164:167], 0
    ds_read_b128 v[224:227], v22 offset:24576
    ds_read_b128 v[228:231], v22 offset:26624
    ds_read_b128 v[232:235], v22 offset:28672
    ds_read_b128 v[236:239], v22 offset:30720
    s_waitcnt lgkmcnt(4)
    v_mfma_f32_16x16x32_bf16 v[128:131], v[240:243], v[168:171], v[128:131]
    v_mfma_f32_16x16x32_bf16 v[132:135], v[244:247], v[168:171], v[132:135]
    v_mfma_f32_16x16x32_bf16 v[136:139], v[248:251], v[168:171], v[136:139]
    v_mfma_f32_16x16x32_bf16 v[140:143], v[252:255], v[168:171], v[140:143]
    v_mfma_f32_16x16x32_bf16 v[144:147], v[240:243], v[172:175], v[144:147]
    v_mfma_f32_16x16x32_bf16 v[148:151], v[244:247], v[172:175], v[148:151]
    v_mfma_f32_16x16x32_bf16 v[152:155], v[248:251], v[172:175], v[152:155]
    v_mfma_f32_16x16x32_bf16 v[156:159], v[252:255], v[172:175], v[156:159]
    ds_read_b128 v[240:243], v23 offset:24576
    ds_read_b128 v[244:247], v23 offset:26624
    ds_read_b128 v[248:251], v23 offset:28672
    ds_read_b128 v[252:255], v23 offset:30720
    s_waitcnt lgkmcnt(4)
    v_mfma_f32_16x16x32_bf16 v[128:131], v[224:227], v[176:179], v[128:131]
    v_mfma_f32_16x16x32_bf16 v[132:135], v[228:231], v[176:179], v[132:135]
    v_mfma_f32_16x16x32_bf16 v[136:139], v[232:235], v[176:179], v[136:139]
    v_mfma_f32_16x16x32_bf16 v[140:143], v[236:239], v[176:179], v[140:143]
    v_mfma_f32_16x16x32_bf16 v[144:147], v[224:227], v[180:183], v[144:147]
    v_mfma_f32_16x16x32_bf16 v[148:151], v[228:231], v[180:183], v[148:151]
    v_mfma_f32_16x16x32_bf16 v[152:155], v[232:235], v[180:183], v[152:155]
    v_mfma_f32_16x16x32_bf16 v[156:159], v[236:239], v[180:183], v[156:159]
    ds_read_b128 v[224:227], v20 offset:0
    ds_read_b128 v[228:231], v20 offset:2048
    ds_read_b128 v[232:235], v20 offset:4096
    ds_read_b128 v[236:239], v20 offset:6144
    s_waitcnt lgkmcnt(4)
    v_mfma_f32_16x16x32_bf16 v[128:131], v[240:243], v[184:187], v[128:131]
    v_mfma_f32_16x16x32_bf16 v[132:135], v[244:247], v[184:187], v[132:135]
    v_mfma_f32_16x16x32_bf16 v[136:139], v[248:251], v[184:187], v[136:139]
    v_mfma_f32_16x16x32_bf16 v[140:143], v[252:255], v[184:187], v[140:143]
    v_mfma_f32_16x16x32_bf16 v[144:147], v[240:243], v[188:191], v[144:147]
    v_mfma_f32_16x16x32_bf16 v[148:151], v[244:247], v[188:191], v[148:151]
    v_mfma_f32_16x16x32_bf16 v[152:155], v[248:251], v[188:191], v[152:155]
    v_mfma_f32_16x16x32_bf16 v[156:159], v[252:255], v[188:191], v[156:159]
L_hpoll:
    s_waitcnt vmcnt(0)
    v_cmp_ne_u32 vcc, s93, v31
    s_nop 1
    s_and_b32 s38, vcc_lo, 255
    s_cbranch_scc0 L_hgo
    s_sub_u32 s96, s96, 1
    s_cbranch_scc1 L_hgo
    s_sleep 1
    s_mov_b64 exec, 255
    buffer_load_dword v31, v30, s[12:15], s52 offen sc1
    s_mov_b64 exec, -1
    s_branch L_hpoll
L_hgo:
    s_cmp_le_u32 s55, 0
    s_cselect_b32 s49, 1, 0
    s_or_b32 s49, s49, s54
    s_lshl_b32 s49, s49, 15
    s_add_u32 s49, s49, s50
    buffer_load_dwordx4 v[192:195], v28, s[12:15], s49 offen offset:0 sc1
    buffer_load_dwordx4 v[196:199], v28, s[12:15], s49 offen offset:1024 sc1
    buffer_load_dwordx4 v[200:203], v28, s[12:15], s49 offen offset:2048 sc1
    buffer_load_dwordx4 v[204:207], v28, s[12:15], s49 offen offset:3072 sc1
    buffer_load_dwordx4 v[208:211], v29, s[12:15], s49 offen offset:0 sc1
    buffer_load_dwordx4 v[212:215], v29, s[12:15], s49 offen offset:1024 sc1
    buffer_load_dwordx4 v[216:219], v29, s[12:15], s49 offen offset:2048 sc1
    buffer_load_dwordx4 v[220:223], v29, s[12:15], s49 offen offset:3072 sc1
L_sync1:
    ds_read_b32 v34, v32 offset:72
    s_waitcnt lgkmcnt(0)
    v_readfirstlane_b32 s38, v34
    s_nop 1
    s_cmp_ge_u32 s38, 4
    s_cbranch_scc1 L_sync1_ok
    s_sub_u32 s96, s96, 1
    s_cbranch_scc1 L_sync1_ok
    s_sleep 0
    s_branch L_sync1
L_sync1_ok:
    s_cmp_le_u32 s55, 1
    s_cselect_b32 s49, 2, 1
    s_or_b32 s49, s49, s54
    s_lshl_b32 s49, s49, 15
    s_add_u32 s49, s49, s50
    buffer_load_dwordx4 v[160:163], v28, s[12:15], s49 offen offset:0 sc1
    buffer_load_dwordx4 v[164:167], v28, s[12:15], s49 offen offset:1024 sc1
    buffer_load_dwordx4 v[168:171], v28, s[12:15], s49 offen offset:2048 sc1
    buffer_load_dwordx4 v[172:175], v28, s[12:15], s49 offen offset:3072 sc1
    buffer_load_dwordx4 v[176:179], v29, s[12:15], s49 offen offset:0 sc1
    buffer_load_dwordx4 v[180:183], v29, s[12:15], s49 offen offset:1024 sc1
    buffer_load_dwordx4 v[184:187], v29, s[12:15], s49 offen offset:2048 sc1
    buffer_load_dwordx4 v[188:191], v29, s[12:15], s49 offen offset:3072 sc1
    ds_read_b128 v[240:243], v21 offset:0
    ds_read_b128 v[244:247], v21 offset:2048
    ds_read_b128 v[248:251], v21 offset:4096
    ds_read_b128 v[252:255], v21 offset:6144
    s_waitcnt vmcnt(14) lgkmcnt(4)
    v_mfma_f32_16x16x32_bf16 v[128:131], v[224:227], v[192:195], v[128:131]
    v_mfma_f32_16x16x32_bf16 v[132:135], v[228:231], v[192:195], v[132:135]
    v_mfma_f32_16x16x32_bf16 v[136:139], v[232:235], v[192:195], v[136:139]
    v_mfma_f32_16x16x32_bf16 v[140:143], v[236:239], v[192:195], v[140:143]
    s_cmp_le_u32 s55, 2
    s_cselect_b32 s49, 3, 2
    s_or_b32 s49, s49, s54
    s_lshl_b32 s49, s49, 15
    s_add_u32 s49, s49, s50
    buffer_load_dwordx4 v[192:195], v28, s[12:15], s49 offen offset:0 sc1
    s_add_u32 m0, s23, 32768
    s_cmp_le_u32 s55, 2
    s_cselect_b32 s21, 3, 2
    s_or_b32 s21, s21, s54
    s_lshl_b32 s21, s21, 7
    buffer_load_dwordx4 v16, s[28:31], s21 offen offset:0  lds
    v_mfma_f32_16x16x32_bf16 v[144:147], v[224:227], v[196:199], v[144:147]
    v_mfma_f32_16x16x32_bf16 v[148:151], v[228:231], v[196:199], v[148:151]
    v_mfma_f32_16x16x32_bf16 v[152:155], v[232:235], v[196:199], v[152:155]
    v_mfma_f32_16x16x32_bf16 v[156:159], v[236:239], v[196:199], v[156:159]
    buffer_load_dwordx4 v[196:199], v28, s[12:15], s49 offen offset:1024 sc1
    buffer_load_dwordx4 v17, s[28:31], s21 offen offset:1024  lds
    ds_read_b128 v[224:227], v20 offset:8192
    ds_read_b128 v[228:231], v20 offset:10240
    ds_read_b128 v[232:235], v20 offset:12288
    ds_read_b128 v[236:239], v20 offset:14336
    s_waitcnt vmcnt(16) lgkmcnt(4)
    s_mov_b64 exec, 1
    ds_add_u32 v32, v33 offset:16
    s_mov_b64 exec, -1
    v_mfma_f32_16x16x32_bf16 v[128:131], v[240:243], v[200:203], v[128:131]
    v_mfma_f32_16x16x32_bf16 v[132:135], v[244:247], v[200:203], v[132:135]
    v_mfma_f32_16x16x32_bf16 v[136:139], v[248:251], v[200:203], v[136:139]
    v_mfma_f32_16x16x32_bf16 v[140:143], v[252:255], v[200:203], v[140:143]
    buffer_load_dwordx4 v[200:203], v28, s[12:15], s49 offen offset:2048 sc1
    buffer_load_dwordx4 v18, s[28:31], s21 offen offset:2048  lds
    v_mfma_f32_16x16x32_bf16 v[144:147], v[240:243], v[204:207], v[144:147]
    v_mfma_f32_16x16x32_bf16 v[148:151], v[244:247], v[204:207], v[148:151]
    v_mfma_f32_16x16x32_bf16 v[152:155], v[248:251], v[204:207], v[152:155]
    v_mfma_f32_16x16x32_bf16 v[156:159], v[252:255], v[204:207], v[156:159]
    buffer_load_dwordx4 v[204:207], v28, s[12:15], s49 offen offset:3072 sc1
    buffer_load_dwordx4 v19, s[28:31], s21 offen offset:3072  lds
    ds_read_b128 v[240:243], v21 offset:8192
    ds_read_b128 v[244:247], v21 offset:10240
    ds_read_b128 v[248:251], v21 offset:12288
    ds_read_b128 v[252:255], v21 offset:14336
    s_waitcnt vmcnt(18) lgkmcnt(4)
    v_mfma_f32_16x16x32_bf16 v[128:131], v[224:227], v[208:211], v[128:131]
    v_mfma_f32_16x16x32_bf16 v[132:135], v[228:231], v[208:211], v[132:135]
    v_mfma_f32_16x16x32_bf16 v[136:139], v[232:235], v[208:211], v[136:139]
    v_mfma_f32_16x16x32_bf16 v[140:143], v[236:239], v[208:211], v[140:143]
    ds_read_b32 v34, v32 offset:16
    buffer_load_dwordx4 v[208:211], v29, s[12:15], s49 offen offset:0 sc1
    s_add_u32 m0, s23, 49152
    s_cmp_le_u32 s55, 3
    s_cselect_b32 s21, 4, 3
    s_or_b32 s21, s21, s54
    s_lshl_b32 s21, s21, 7
    buffer_load_dwordx4 v16, s[28:31], s21 offen offset:0  lds
    v_mfma_f32_16x16x32_bf16 v[144:147], v[224:227], v[212:215], v[144:147]
    v_mfma_f32_16x16x32_bf16 v[148:151], v[228:231], v[212:215], v[148:151]
    v_mfma_f32_16x16x32_bf16 v[152:155], v[232:235], v[212:215], v[152:155]
    v_mfma_f32_16x16x32_bf16 v[156:159], v[236:239], v[212:215], v[156:159]
    buffer_load_dwordx4 v[212:215], v29, s[12:15], s49 offen offset:1024 sc1
    s_waitcnt lgkmcnt(0)
    v_readfirstlane_b32 s38, v34
    s_nop 1
    s_cmp_ge_u32 s38, 4
    s_cbranch_scc1 L_st1_ok
L_st1:
    ds_read_b32 v34, v32 offset:16
    s_waitcnt lgkmcnt(0)
    v_readfirstlane_b32 s38, v34
    s_nop 1
    s_cmp_ge_u32 s38, 4
    s_cbranch_scc1 L_st1_ok
    s_sub_u32 s96, s96, 1
    s_cbranch_scc1 L_st1_ok
    s_sleep 0
    s_branch L_st1
L_st1_ok:
    ds_read_b128 v[224:227], v20 offset:16384
    ds_read_b128 v[228:231], v20 offset:18432
    ds_read_b128 v[232:235], v20 offset:20480
    ds_read_b128 v[236:239], v20 offset:22528
    s_waitcnt vmcnt(19)
    v_mfma_f32_16x16x32_bf16 v[128:131], v[240:243], v[216:219], v[128:131]
    v_mfma_f32_16x16x32_bf16 v[132:135], v[244:247], v[216:219], v[132:135]
    v_mfma_f32_16x16x32_bf16 v[136:139], v[248:251], v[216:219], v[136:139]
    v_mfma_f32_16x16x32_bf16 v[140:143], v[252:255], v[216:219], v[140:143]
    buffer_load_dwordx4 v[216:219], v29, s[12:15], s49 offen offset:2048 sc1
    buffer_load_dwordx4 v17, s[28:31], s21 offen offset:1024  lds
    v_mfma_f32_16x16x32_bf16 v[144:147], v[240:243], v[220:223], v[144:147]
    v_mfma_f32_16x16x32_bf16 v[148:151], v[244:247], v[220:223], v[148:151]
    v_mfma_f32_16x16x32_bf16 v[152:155], v[248:251], v[220:223], v[152:155]
    v_mfma_f32_16x16x32_bf16 v[156:159], v[252:255], v[220:223], v[156:159]
    buffer_load_dwordx4 v[220:223], v29, s[12:15], s49 offen offset:3072 sc1
    buffer_load_dwordx4 v18, s[28:31], s21 offen offset:2048  lds
    ds_read_b128 v[240:243], v21 offset:16384
    ds_read_b128 v[244:247], v21 offset:18432
    ds_read_b128 v[248:251], v21 offset:20480
    ds_read_b128 v[252:255], v21 offset:22528
    s_waitcnt vmcnt(21) lgkmcnt(4)
    v_mfma_f32_16x16x32_bf16 v[128:131], v[224:227], v[160:163], v[128:131]
    v_mfma_f32_16x16x32_bf16 v[132:135], v[228:231], v[160:163], v[132:135]
    v_mfma_f32_16x16x32_bf16 v[136:139], v[232:235], v[160:163], v[136:139]
    v_mfma_f32_16x16x32_bf16 v[140:143], v[236:239], v[160:163], v[140:143]
    s_cmp_le_u32 s55, 3
    s_cselect_b32 s49, 4, 3
    s_or_b32 s49, s49, s54
    s_lshl_b32 s49, s49, 15
    s_add_u32 s49, s49, s50
    buffer_load_dwordx4 v[160:163], v28, s[12:15], s49 offen offset:0 sc1
    buffer_load_dwordx4 v19, s[28:31], s21 offen offset:3072  lds
    v_mfma_f32_16x16x32_bf16 v[144:147], v[224:227], v[164:167], v[144:147]
    v_mfma_f32_16x16x32_bf16 v[148:151], v[228:231], v[164:167], v[148:151]
    v_mfma_f32_16x16x32_bf16 v[152:155], v[232:235], v[164:167], v[152:155]
    v_mfma_f32_16x16x32_bf16 v[156:159], v[236:239], v[164:167], v[156:159]
    buffer_load_dwordx4 v[164:167], v28, s[12:15], s49 offen offset:1024 sc1
    ds_read_b128 v[224:227], v20 offset:24576
    ds_read_b128 v[228:231], v20 offset:26624
    ds_read_b128 v[232:235], v20 offset:28672
    ds_read_b128 v[236:239], v20 offset:30720
    s_waitcnt vmcnt(10) lgkmcnt(4)
    s_mov_b64 exec, 1
    ds_add_u32 v32, v33 offset:16
    s_mov_b64 exec, -1
    v_mfma_f32_16x16x32_bf16 v[128:131], v[240:243], v[168:171], v[128:131]
    v_mfma_f32_16x16x32_bf16 v[132:135], v[244:247], v[168:171], v[132:135]
    v_mfma_f32_16x16x32_bf16 v[136:139], v[248:251], v[168:171], v[136:139]
    v_mfma_f32_16x16x32_bf16 v[140:143], v[252:255], v[168:171], v[140:143]
    buffer_load_dwordx4 v[168:171], v28, s[12:15], s49 offen offset:2048 sc1
    s_add_u32 m0, s23, 81920
    s_cmp_le_u32 s55, 4
    s_cselect_b32 s21, 5, 4
    s_or_b32 s21, s21, s54
    s_lshl_b32 s21, s21, 7
    buffer_load_dwordx4 v16, s[28:31], s21 offen offset:0  lds
    v_mfma_f32_16x16x32_bf16 v[144:147], v[240:243], v[172:175], v[144:147]
    v_mfma_f32_16x16x32_bf16 v[148:151], v[244:247], v[172:175], v[148:151]
    v_mfma_f32_16x16x32_bf16 v[152:155], v[248:251], v[172:175], v[152:155]
    v_mfma_f32_16x16x32_bf16 v[156:159], v[252:255], v[172:175], v[156:159]
    buffer_load_dwordx4 v[172:175], v28, s[12:15], s49 offen offset:3072 sc1
    ds_read_b128 v[240:243], v21 offset:24576
    ds_read_b128 v[244:247], v21 offset:26624
    ds_read_b128 v[248:251], v21 offset:28672
    ds_read_b128 v[252:255], v21 offset:30720
    s_waitcnt vmcnt(23) lgkmcnt(4)
    v_mfma_f32_16x16x32_bf16 v[128:131], v[224:227], v[176:179], v[128:131]
    v_mfma_f32_16x16x32_bf16 v[132:135], v[228:231], v[176:179], v[132:135]
    v_mfma_f32_16x16x32_bf16 v[136:139], v[232:235], v[176:179], v[136:139]
    v_mfma_f32_16x16x32_bf16 v[140:143], v[236:239], v[176:179], v[140:143]
    ds_read_b32 v34, v32 offset:16
    buffer_load_dwordx4 v[176:179], v29, s[12:15], s49 offen offset:0 sc1
    buffer_load_dwordx4 v17, s[28:31], s21 offen offset:1024  lds
    v_mfma_f32_16x16x32_bf16 v[144:147], v[224:227], v[180:183], v[144:147]
    v_mfma_f32_16x16x32_bf16 v[148:151], v[228:231], v[180:183], v[148:151]
    v_mfma_f32_16x16x32_bf16 v[152:155], v[232:235], v[180:183], v[152:155]
    v_mfma_f32_16x16x32_bf16 v[156:159], v[236:239], v[180:183], v[156:159]
    buffer_load_dwordx4 v[180:183], v29, s[12:15], s49 offen offset:1024 sc1
    s_waitcnt lgkmcnt(0)
    v_readfirstlane_b32 s38, v34
    s_nop 1
    s_cmp_ge_u32 s38, 8
    s_cbranch_scc1 L_st2_ok
L_st2:
    ds_read_b32 v34, v32 offset:16
    s_waitcnt lgkmcnt(0)
    v_readfirstlane_b32 s38, v34
    s_nop 1
    s_cmp_ge_u32 s38, 8
    s_cbranch_scc1 L_st2_ok
    s_sub_u32 s96, s96, 1
    s_cbranch_scc1 L_st2_ok
    s_sleep 0
    s_branch L_st2
L_st2_ok:
    ds_read_b128 v[224:227], v20 offset:32768
    ds_read_b128 v[228:231], v20 offset:34816
    ds_read_b128 v[232:235], v20 offset:36864
    ds_read_b128 v[236:239], v20 offset:38912
    s_waitcnt vmcnt(24)
    v_mfma_f32_16x16x32_bf16 v[128:131], v[240:243], v[184:187], v[128:131]
    v_mfma_f32_16x16x32_bf16 v[132:135], v[244:247], v[184:187], v[132:135]
    v_mfma_f32_16x16x32_bf16 v[136:139], v[248:251], v[184:187], v[136:139]
    v_mfma_f32_16x16x32_bf16 v[140:143], v[252:255], v[184:187], v[140:143]
    buffer_load_dwordx4 v[184:187], v29, s[12:15], s49 offen offset:2048 sc1
    buffer_load_dwordx4 v18, s[28:31], s21 offen offset:2048  lds
    v_mfma_f32_16x16x32_bf16 v[144:147], v[240:243], v[188:191], v[144:147]
    v_mfma_f32_16x16x32_bf16 v[148:151], v[244:247], v[188:191], v[148:151]
    v_mfma_f32_16x16x32_bf16 v[152:155], v[248:251], v[188:191], v[152:155]
    v_mfma_f32_16x16x32_bf16 v[156:159], v[252:255], v[188:191], v[156:159]
    buffer_load_dwordx4 v[188:191], v29, s[12:15], s49 offen offset:3072 sc1
    buffer_load_dwordx4 v19, s[28:31], s21 offen offset:3072  lds
    ds_read_b128 v[240:243], v21 offset:32768
    ds_read_b128 v[244:247], v21 offset:34816
    ds_read_b128 v[248:251], v21 offset:36864
    ds_read_b128 v[252:255], v21 offset:38912
    s_waitcnt vmcnt(25) lgkmcnt(4)
    v_mfma_f32_16x16x32_bf16 v[128:131], v[224:227], v[192:195], v[128:131]
    v_mfma_f32_16x16x32_bf16 v[132:135], v[228:231], v[192:195], v[132:135]
    v_mfma_f32_16x16x32_bf16 v[136:139], v[232:235], v[192:195], v[136:139]
    v_mfma_f32_16x16x32_bf16 v[140:143], v[236:239], v[192:195], v[140:143]
    s_cmp_le_u32 s55, 4
    s_cselect_b32 s49, 5, 4
    s_or_b32 s49, s49, s54
    s_lshl_b32 s49, s49, 15
    s_add_u32 s49, s49, s50
    buffer_load_dwordx4 v[192:195], v28, s[12:15], s49 offen offset:0 sc1
    s_add_u32 m0, s23, 0
    s_cmp_le_u32 s55, 5
    s_cselect_b32 s21, 6, 5
    s_or_b32 s21, s21, s54
    s_lshl_b32 s21, s21, 7
    buffer_load_dwordx4 v16, s[28:31], s21 offen offset:0  lds
    v_mfma_f32_16x16x32_bf16 v[144:147], v[224:227], v[196:199], v[144:147]
    v_mfma_f32_16x16x32_bf16 v[148:151], v[228:231], v[196:199], v[148:151]
    v_mfma_f32_16x16x32_bf16 v[152:155], v[232:235], v[196:199], v[152:155]
    v_mfma_f32_16x16x32_bf16 v[156:159], v[236:239], v[196:199], v[156:159]
    buffer_load_dwordx4 v[196:199], v28, s[12:15], s49 offen offset:1024 sc1
    ds_read_b128 v[224:227], v20 offset:40960
    ds_read_b128 v[228:231], v20 offset:43008
    ds_read_b128 v[232:235], v20 offset:45056
    ds_read_b128 v[236:239], v20 offset:47104
    s_waitcnt vmcnt(14) lgkmcnt(4)
    s_mov_b64 exec, 1
    ds_add_u32 v32, v33 offset:16
    s_mov_b64 exec, -1
    v_mfma_f32_16x16x32_bf16 v[128:131], v[240:243], v[200:203], v[128:131]
    v_mfma_f32_16x16x32_bf16 v[132:135], v[244:247], v[200:203], v[132:135]
    v_mfma_f32_16x16x32_bf16 v[136:139], v[248:251], v[200:203], v[136:139]
    v_mfma_f32_16x16x32_bf16 v[140:143], v[252:255], v[200:203], v[140:143]
    buffer_load_dwordx4 v[200:203], v28, s[12:15], s49 offen offset:2048 sc1
    buffer_load_dwordx4 v17, s[28:31], s21 offen offset:1024  lds
    v_mfma_f32_16x16x32_bf16 v[144:147], v[240:243], v[204:207], v[144:147]
    v_mfma_f32_16x16x32_bf16 v[148:151], v[244:247], v[204:207], v[148:151]
    v_mfma_f32_16x16x32_bf16 v[152:155], v[248:251], v[204:207], v[152:155]
    v_mfma_f32_16x16x32_bf16 v[156:159], v[252:255], v[204:207], v[156:159]
    buffer_load_dwordx4 v[204:207], v28, s[12:15], s49 offen offset:3072 sc1
    ds_read_b128 v[240:243], v21 offset:40960
    ds_read_b128 v[244:247], v21 offset:43008
    ds_read_b128 v[248:251], v21 offset:45056
    ds_read_b128 v[252:255], v21 offset:47104
    s_waitcnt vmcnt(23) lgkmcnt(4)
    v_mfma_f32_16x16x32_bf16 v[128:131], v[224:227], v[208:211], v[128:131]
    v_mfma_f32_16x16x32_bf16 v[132:135], v[228:231], v[208:211], v[132:135]
    v_mfma_f32_16x16x32_bf16 v[136:139], v[232:235], v[208:211], v[136:139]
    v_mfma_f32_16x16x32_bf16 v[140:143], v[236:239], v[208:211], v[140:143]
    ds_read_b32 v34, v32 offset:16
    buffer_load_dwordx4 v[208:211], v29, s[12:15], s49 offen offset:0 sc1
    buffer_load_dwordx4 v18, s[28:31], s21 offen offset:2048  lds
    v_mfma_f32_16x16x32_bf16 v[144:147], v[224:227], v[212:215], v[144:147]
    v_mfma_f32_16x16x32_bf16 v[148:151], v[228:231], v[212:215], v[148:151]
    v_mfma_f32_16x16x32_bf16 v[152:155], v[232:235], v[212:215], v[152:155]
    v_mfma_f32_16x16x32_bf16 v[156:159], v[236:239], v[212:215], v[156:159]
    buffer_load_dwordx4 v[212:215], v29, s[12:15], s49 offen offset:1024 sc1
    s_waitcnt lgkmcnt(0)
    v_readfirstlane_b32 s38, v34
    s_nop 1
    s_cmp_ge_u32 s38, 12
    s_cbranch_scc1 L_st3_ok
L_st3:
    ds_read_b32 v34, v32 offset:16
    s_waitcnt lgkmcnt(0)
    v_readfirstlane_b32 s38, v34
    s_nop 1
    s_cmp_ge_u32 s38, 12
    s_cbranch_scc1 L_st3_ok
    s_sub_u32 s96, s96, 1
    s_cbranch_scc1 L_st3_ok
    s_sleep 0
    s_branch L_st3
L_st3_ok:
    ds_read_b128 v[224:227], v20 offset:49152
    ds_read_b128 v[228:231], v20 offset:51200
    ds_read_b128 v[232:235], v20 offset:53248
    ds_read_b128 v[236:239], v20 offset:55296
    s_waitcnt vmcnt(23)
    v_mfma_f32_16x16x32_bf16 v[128:131], v[240:243], v[216:219], v[128:131]
    v_mfma_f32_16x16x32_bf16 v[132:135], v[244:247], v[216:219], v[132:135]
    v_mfma_f32_16x16x32_bf16 v[136:139], v[248:251], v[216:219], v[136:139]
    v_mfma_f32_16x16x32_bf16 v[140:143], v[252:255], v[216:219], v[140:143]
    buffer_load_dwordx4 v[216:219], v29, s[12:15], s49 offen offset:2048 sc1
    buffer_load_dwordx4 v19, s[28:31], s21 offen offset:3072  lds
    v_mfma_f32_16x16x32_bf16 v[144:147], v[240:243], v[220:223], v[144:147]
    v_mfma_f32_16x16x32_bf16 v[148:151], v[244:247], v[220:223], v[148:151]
    v_mfma_f32_16x16x32_bf16 v[152:155], v[248:251], v[220:223], v[152:155]
    v_mfma_f32_16x16x32_bf16 v[156:159], v[252:255], v[220:223], v[156:159]
    buffer_load_dwordx4 v[220:223], v29, s[12:15], s49 offen offset:3072 sc1
    ds_read_b128 v[240:243], v21 offset:49152
    ds_read_b128 v[244:247], v21 offset:51200
    ds_read_b128 v[248:251], v21 offset:53248
    ds_read_b128 v[252:255], v21 offset:55296
    s_waitcnt vmcnt(22) lgkmcnt(4)
    v_mfma_f32_16x16x32_bf16 v[128:131], v[224:227], v[160:163], v[128:131]
    v_mfma_f32_16x16x32_bf16 v[132:135], v[228:231], v[160:163], v[132:135]
    v_mfma_f32_16x16x32_bf16 v[136:139], v[232:235], v[160:163], v[136:139]
    v_mfma_f32_16x16x32_bf16 v[140:143], v[236:239], v[160:163], v[140:143]
    s_cmp_le_u32 s55, 5
    s_cselect_b32 s49, 6, 5
    s_or_b32 s49, s49, s54
    s_lshl_b32 s49, s49, 15
    s_add_u32 s49, s49, s50
    buffer_load_dwordx4 v[160:163], v28, s[12:15], s49 offen offset:0 sc1
    s_add_u32 m0, s23, 16384
    s_cmp_le_u32 s55, 6
    s_cselect_b32 s21, 7, 6
    s_or_b32 s21, s21, s54
    s_lshl_b32 s21, s21, 7
    buffer_load_dwordx4 v16, s[28:31], s21 offen offset:0  lds
    v_mfma_f32_16x16x32_bf16 v[144:147], v[224:227], v[164:167], v[144:147]
    v_mfma_f32_16x16x32_bf16 v[148:151], v[228:231], v[164:167], v[148:151]
    v_mfma_f32_16x16x32_bf16 v[152:155], v[232:235], v[164:167], v[152:155]
    v_mfma_f32_16x16x32_bf16 v[156:159], v[236:239], v[164:167], v[156:159]
    buffer_load_dwordx4 v[164:167], v28, s[12:15], s49 offen offset:1024 sc1
    ds_read_b128 v[224:227], v20 offset:57344
    ds_read_b128 v[228:231], v20 offset:59392
    ds_read_b128 v[232:235], v20 offset:61440
    ds_read_b128 v[236:239], v20 offset:63488
    s_waitcnt vmcnt(15) lgkmcnt(4)
    s_mov_b64 exec, 1
    ds_add_u32 v32, v33 offset:16
    s_mov_b64 exec, -1
    v_mfma_f32_16x16x32_bf16 v[128:131], v[240:243], v[168:171], v[128:131]
    v_mfma_f32_16x16x32_bf16 v[132:135], v[244:247], v[168:171], v[132:135]
    v_mfma_f32_16x16x32_bf16 v[136:139], v[248:251], v[168:171], v[136:139]
    v_mfma_f32_16x16x32_bf16 v[140:143], v[252:255], v[168:171], v[140:143]
    buffer_load_dwordx4 v[168:171], v28, s[12:15], s49 offen offset:2048 sc1
    buffer_load_dwordx4 v17, s[28:31], s21 offen offset:1024  lds
    v_mfma_f32_16x16x32_bf16 v[144:147], v[240:243], v[172:175], v[144:147]
    v_mfma_f32_16x16x32_bf16 v[148:151], v[244:247], v[172:175], v[148:151]
    v_mfma_f32_16x16x32_bf16 v[152:155], v[248:251], v[172:175], v[152:155]
    v_mfma_f32_16x16x32_bf16 v[156:159], v[252:255], v[172:175], v[156:159]
    buffer_load_dwordx4 v[172:175], v28, s[12:15], s49 offen offset:3072 sc1
    ds_read_b128 v[240:243], v21 offset:57344
    ds_read_b128 v[244:247], v21 offset:59392
    ds_read_b128 v[248:251], v21 offset:61440
    ds_read_b128 v[252:255], v21 offset:63488
    s_waitcnt vmcnt(22) lgkmcnt(4)
    v_mfma_f32_16x16x32_bf16 v[128:131], v[224:227], v[176:179], v[128:131]
    v_mfma_f32_16x16x32_bf16 v[132:135], v[228:231], v[176:179], v[132:135]
    v_mfma_f32_16x16x32_bf16 v[136:139], v[232:235], v[176:179], v[136:139]
    v_mfma_f32_16x16x32_bf16 v[140:143], v[236:239], v[176:179], v[140:143]
    ds_read_b32 v34, v32 offset:16
    buffer_load_dwordx4 v[176:179], v29, s[12:15], s49 offen offset:0 sc1
    buffer_load_dwordx4 v18, s[28:31], s21 offen offset:2048  lds
    v_mfma_f32_16x16x32_bf16 v[144:147], v[224:227], v[180:183], v[144:147]
    v_mfma_f32_16x16x32_bf16 v[148:151], v[228:231], v[180:183], v[148:151]
    v_mfma_f32_16x16x32_bf16 v[152:155], v[232:235], v[180:183], v[152:155]
    v_mfma_f32_16x16x32_bf16 v[156:159], v[236:239], v[180:183], v[156:159]
    buffer_load_dwordx4 v[180:183], v29, s[12:15], s49 offen offset:1024 sc1
    s_waitcnt lgkmcnt(0)
    v_readfirstlane_b32 s38, v34
    s_nop 1
    s_cmp_ge_u32 s38, 16
    s_cbranch_scc1 L_st4_ok
L_st4:
    ds_read_b32 v34, v32 offset:16
    s_waitcnt lgkmcnt(0)
    v_readfirstlane_b32 s38, v34
    s_nop 1
    s_cmp_ge_u32 s38, 16
    s_cbranch_scc1 L_st4_ok
    s_sub_u32 s96, s96, 1
    s_cbranch_scc1 L_st4_ok
    s_sleep 0
    s_branch L_st4
L_st4_ok:
    ds_read_b128 v[224:227], v22 offset:16384
    ds_read_b128 v[228:231], v22 offset:18432
    ds_read_b128 v[232:235], v22 offset:20480
    ds_read_b128 v[236:239], v22 offset:22528
    s_waitcnt vmcnt(22)
    v_mfma_f32_16x16x32_bf16 v[128:131], v[240:243], v[184:187], v[128:131]
    v_mfma_f32_16x16x32_bf16 v[132:135], v[244:247], v[184:187], v[132:135]
    v_mfma_f32_16x16x32_bf16 v[136:139], v[248:251], v[184:187], v[136:139]
    v_mfma_f32_16x16x32_bf16 v[140:143], v[252:255], v[184:187], v[140:143]
    buffer_load_dwordx4 v[184:187], v29, s[12:15], s49 offen offset:2048 sc1
    buffer_load_dwordx4 v19, s[28:31], s21 offen offset:3072  lds
    v_mfma_f32_16x16x32_bf16 v[144:147], v[240:243], v[188:191], v[144:147]
    v_mfma_f32_16x16x32_bf16 v[148:151], v[244:247], v[188:191], v[148:151]
    v_mfma_f32_16x16x32_bf16 v[152:155], v[248:251], v[188:191], v[152:155]
    v_mfma_f32_16x16x32_bf16 v[156:159], v[252:255], v[188:191], v[156:159]
    buffer_load_dwordx4 v[188:191], v29, s[12:15], s49 offen offset:3072 sc1
    ds_read_b128 v[240:243], v23 offset:16384
    ds_read_b128 v[244:247], v23 offset:18432
    ds_read_b128 v[248:251], v23 offset:20480
    ds_read_b128 v[252:255], v23 offset:22528
    s_waitcnt vmcnt(21) lgkmcnt(4)
    v_mfma_f32_16x16x32_bf16 v[128:131], v[224:227], v[192:195], v[128:131]
    v_mfma_f32_16x16x32_bf16 v[132:135], v[228:231], v[192:195], v[132:135]
    v_mfma_f32_16x16x32_bf16 v[136:139], v[232:235], v[192:195], v[136:139]
    v_mfma_f32_16x16x32_bf16 v[140:143], v[236:239], v[192:195], v[140:143]
    s_cmp_le_u32 s55, 6
    s_cselect_b32 s49, 7, 6
    s_or_b32 s49, s49, s54
    s_lshl_b32 s49, s49, 15
    s_add_u32 s49, s49, s50
    buffer_load_dwordx4 v[192:195], v28, s[12:15], s49 offen offset:0 sc1
    s_add_u32 m0, s23, 32768
    s_xor_b32 s21, s54, 8
    s_lshl_b32 s21, s21, 7
    buffer_load_dwordx4 v16, s[28:31], s21 offen offset:0  lds
    v_mfma_f32_16x16x32_bf16 v[144:147], v[224:227], v[196:199], v[144:147]
    v_mfma_f32_16x16x32_bf16 v[148:151], v[228:231], v[196:199], v[148:151]
    v_mfma_f32_16x16x32_bf16 v[152:155], v[232:235], v[196:199], v[152:155]
    v_mfma_f32_16x16x32_bf16 v[156:159], v[236:239], v[196:199], v[156:159]
    buffer_load_dwordx4 v[196:199], v28, s[12:15], s49 offen offset:1024 sc1
    s_mov_b64 exec, 0xff00
    buffer_load_dword v31, v30, s[12:15], s52 offen sc1
    s_mov_b64 exec, -1
    ds_read_b128 v[224:227], v22 offset:24576
    ds_read_b128 v[228:231], v22 offset:26624
    ds_read_b128 v[232:235], v22 offset:28672
    ds_read_b128 v[236:239], v22 offset:30720
    s_waitcnt vmcnt(17) lgkmcnt(4)
    s_mov_b64 exec, 1
    ds_add_u32 v32, v33 offset:16
    s_mov_b64 exec, -1
    v_mfma_f32_16x16x32_bf16 v[128:131], v[240:243], v[200:203], v[128:131]
    v_mfma_f32_16x16x32_bf16 v[132:135], v[244:247], v[200:203], v[132:135]
    v_mfma_f32_16x16x32_bf16 v[136:139], v[248:251], v[200:203], v[136:139]
    v_mfma_f32_16x16x32_bf16 v[140:143], v[252:255], v[200:203], v[140:143]
    buffer_load_dwordx4 v[200:203], v28, s[12:15], s49 offen offset:2048 sc1
    buffer_load_dwordx4 v17, s[28:31], s21 offen offset:1024  lds
    v_mfma_f32_16x16x32_bf16 v[144:147], v[240:243], v[204:207], v[144:147]
    v_mfma_f32_16x16x32_bf16 v[148:151], v[244:247], v[204:207], v[148:151]
    v_mfma_f32_16x16x32_bf16 v[152:155], v[248:251], v[204:207], v[152:155]
    v_mfma_f32_16x16x32_bf16 v[156:159], v[252:255], v[204:207], v[156:159]
    buffer_load_dwordx4 v[204:207], v28, s[12:15], s49 offen offset:3072 sc1
    ds_read_b128 v[240:243], v23 offset:24576
    ds_read_b128 v[244:247], v23 offset:26624
    ds_read_b128 v[248:251], v23 offset:28672
    ds_read_b128 v[252:255], v23 offset:30720
    s_waitcnt vmcnt(22) lgkmcnt(4)
    v_mfma_f32_16x16x32_bf16 v[128:131], v[224:227], v[208:211], v[128:131]
    v_mfma_f32_16x16x32_bf16 v[132:135], v[228:231], v[208:211], v[132:135]
    v_mfma_f32_16x16x32_bf16 v[136:139], v[232:235], v[208:211], v[136:139]
    v_mfma_f32_16x16x32_bf16 v[140:143], v[236:239], v[208:211], v[140:143]
    ds_read_b32 v34, v32 offset:16
    buffer_load_dwordx4 v[208:211], v29, s[12:15], s49 offen offset:0 sc1
    buffer_load_dwordx4 v18, s[28:31], s21 offen offset:2048  lds
    v_mfma_f32_16x16x32_bf16 v[144:147], v[224:227], v[212:215], v[144:147]
    v_mfma_f32_16x16x32_bf16 v[148:151], v[228:231], v[212:215], v[148:151]
    v_mfma_f32_16x16x32_bf16 v[152:155], v[232:235], v[212:215], v[152:155]
    v_mfma_f32_16x16x32_bf16 v[156:159], v[236:239], v[212:215], v[156:159]
    buffer_load_dwordx4 v[212:215], v29, s[12:15], s49 offen offset:1024 sc1
    s_waitcnt lgkmcnt(0)
    v_readfirstlane_b32 s38, v34
    s_nop 1
    s_cmp_ge_u32 s38, 20
    s_cbranch_scc1 L_st5_ok
L_st5:
    ds_read_b32 v34, v32 offset:16
    s_waitcnt lgkmcnt(0)
    v_readfirstlane_b32 s38, v34
    s_nop 1
    s_cmp_ge_u32 s38, 20
    s_cbranch_scc1 L_st5_ok
    s_sub_u32 s96, s96, 1
    s_cbranch_scc1 L_st5_ok
    s_sleep 0
    s_branch L_st5
L_st5_ok:
    ds_read_b128 v[224:227], v20 offset:0
    ds_read_b128 v[228:231], v20 offset:2048
    ds_read_b128 v[232:235], v20 offset:4096
    ds_read_b128 v[236:239], v20 offset:6144
    s_waitcnt vmcnt(22)
    v_mfma_f32_16x16x32_bf16 v[128:131], v[240:243], v[216:219], v[128:131]
    v_mfma_f32_16x16x32_bf16 v[132:135], v[244:247], v[216:219], v[132:135]
    v_mfma_f32_16x16x32_bf16 v[136:139], v[248:251], v[216:219], v[136:139]
    v_mfma_f32_16x16x32_bf16 v[140:143], v[252:255], v[216:219], v[140:143]
    buffer_load_dwordx4 v[216:219], v29, s[12:15], s49 offen offset:2048 sc1
    buffer_load_dwordx4 v19, s[28:31], s21 offen offset:3072  lds
    v_mfma_f32_16x16x32_bf16 v[144:147], v[240:243], v[220:223], v[144:147]
    v_mfma_f32_16x16x32_bf16 v[148:151], v[244:247], v[220:223], v[148:151]
    v_mfma_f32_16x16x32_bf16 v[152:155], v[248:251], v[220:223], v[152:155]
    v_mfma_f32_16x16x32_bf16 v[156:159], v[252:255], v[220:223], v[156:159]
    buffer_load_dwordx4 v[220:223], v29, s[12:15], s49 offen offset:3072 sc1
    s_waitcnt vmcnt(9)
L_h2poll:
    v_cmp_ne_u32 vcc, s93, v31
    s_nop 1
    s_and_b32 s38, vcc_lo, 0xff00
    s_cbranch_scc0 L_h2go
    s_sub_u32 s96, s96, 1
    s_cbranch_scc1 L_h2go
    s_sleep 2
    s_mov_b64 exec, 0xff00
    buffer_load_dword v31, v30, s[12:15], s52 offen sc1
    s_mov_b64 exec, -1
    s_waitcnt vmcnt(0)
    s_branch L_h2poll
L_h2go:
    ds_read_b128 v[240:243], v21 offset:0
    ds_read_b128 v[244:247], v21 offset:2048
    ds_read_b128 v[248:251], v21 offset:4096
    ds_read_b128 v[252:255], v21 offset:6144
    s_waitcnt vmcnt(22) lgkmcnt(4)
    v_mfma_f32_16x16x32_bf16 v[128:131], v[224:227], v[160:163], v[128:131]
    v_mfma_f32_16x16x32_bf16 v[132:135], v[228:231], v[160:163], v[132:135]
    v_mfma_f32_16x16x32_bf16 v[136:139], v[232:235], v[160:163], v[136:139]
    v_mfma_f32_16x16x32_bf16 v[140:143], v[236:239], v[160:163], v[140:143]
    s_xor_b32 s49, s54, 8
    s_lshl_b32 s49, s49, 15
    s_add_u32 s49, s49, s50
    buffer_load_dwordx4 v[160:163], v28, s[12:15], s49 offen offset:0 sc1
    s_add_u32 m0, s23, 49152
    s_xor_b32 s21, s54, 9
    s_lshl_b32 s21, s21, 7
    buffer_load_dwordx4 v16, s[28:31], s21 offen offset:0  lds
    v_mfma_f32_16x16x32_bf16 v[144:147], v[224:227], v[164:167], v[144:147]
    v_mfma_f32_16x16x32_bf16 v[148:151], v[228:231], v[164:167], v[148:151]
    v_mfma_f32_16x16x32_bf16 v[152:155], v[232:235], v[164:167], v[152:155]
    v_mfma_f32_16x16x32_bf16 v[156:159], v[236:239], v[164:167], v[156:159]
    buffer_load_dwordx4 v[164:167], v28, s[12:15], s49 offen offset:1024 sc1
    ds_read_b128 v[224:227], v20 offset:8192
    ds_read_b128 v[228:231], v20 offset:10240
    ds_read_b128 v[232:235], v20 offset:12288
    ds_read_b128 v[236:239], v20 offset:14336
    s_waitcnt vmcnt(17) lgkmcnt(4)
    s_mov_b64 exec, 1
    ds_add_u32 v32, v33 offset:16
    s_mov_b64 exec, -1
    v_mfma_f32_16x16x32_bf16 v[128:131], v[240:243], v[168:171], v[128:131]
    v_mfma_f32_16x16x32_bf16 v[132:135], v[244:247], v[168:171], v[132:135]
    v_mfma_f32_16x16x32_bf16 v[136:139], v[248:251], v[168:171], v[136:139]
    v_mfma_f32_16x16x32_bf16 v[140:143], v[252:255], v[168:171], v[140:143]
    buffer_load_dwordx4 v[168:171], v28, s[12:15], s49 offen offset:2048 sc1
    buffer_load_dwordx4 v17, s[28:31], s21 offen offset:1024  lds
    v_mfma_f32_16x16x32_bf16 v[144:147], v[240:243], v[172:175], v[144:147]
    v_mfma_f32_16x16x32_bf16 v[148:151], v[244:247], v[172:175], v[148:151]
    v_mfma_f32_16x16x32_bf16 v[152:155], v[248:251], v[172:175], v[152:155]
    v_mfma_f32_16x16x32_bf16 v[156:159], v[252:255], v[172:175], v[156:159]
    buffer_load_dwordx4 v[172:175], v28, s[12:15], s49 offen offset:3072 sc1
    ds_read_b128 v[240:243], v21 offset:8192
    ds_read_b128 v[244:247], v21 offset:10240
    ds_read_b128 v[248:251], v21 offset:12288
    ds_read_b128 v[252:255], v21 offset:14336
    s_waitcnt vmcnt(22) lgkmcnt(4)
    v_mfma_f32_16x16x32_bf16 v[128:131], v[224:227], v[176:179], v[128:131]
    v_mfma_f32_16x16x32_bf16 v[132:135], v[228:231], v[176:179], v[132:135]
    v_mfma_f32_16x16x32_bf16 v[136:139], v[232:235], v[176:179], v[136:139]
    v_mfma_f32_16x16x32_bf16 v[140:143], v[236:239], v[176:179], v[140:143]
    ds_read_b32 v34, v32 offset:16
    buffer_load_dwordx4 v[176:179], v29, s[12:15], s49 offen offset:0 sc1
    buffer_load_dwordx4 v18, s[28:31], s21 offen offset:2048  lds
    v_mfma_f32_16x16x32_bf16 v[144:147], v[224:227], v[180:183], v[144:147]
    v_mfma_f32_16x16x32_bf16 v[148:151], v[228:231], v[180:183], v[148:151]
    v_mfma_f32_16x16x32_bf16 v[152:155], v[232:235], v[180:183], v[152:155]
    v_mfma_f32_16x16x32_bf16 v[156:159], v[236:239], v[180:183], v[156:159]
    buffer_load_dwordx4 v[180:183], v29, s[12:15], s49 offen offset:1024 sc1
    s_waitcnt lgkmcnt(0)
    v_readfirstlane_b32 s38, v34
    s_nop 1
    s_cmp_ge_u32 s38, 24
    s_cbranch_scc1 L_st6_ok
L_st6:
    ds_read_b32 v34, v32 offset:16
    s_waitcnt lgkmcnt(0)
    v_readfirstlane_b32 s38, v34
    s_nop 1
    s_cmp_ge_u32 s38, 24
    s_cbranch_scc1 L_st6_ok
    s_sub_u32 s96, s96, 1
    s_cbranch_scc1 L_st6_ok
    s_sleep 0
    s_branch L_st6
L_st6_ok:
    ds_read_b128 v[224:227], v20 offset:16384
    ds_read_b128 v[228:231], v20 offset:18432
    ds_read_b128 v[232:235], v20 offset:20480
    ds_read_b128 v[236:239], v20 offset:22528
    s_waitcnt vmcnt(22)
    v_mfma_f32_16x16x32_bf16 v[128:131], v[240:243], v[184:187], v[128:131]
    v_mfma_f32_16x16x32_bf16 v[132:135], v[244:247], v[184:187], v[132:135]
    v_mfma_f32_16x16x32_bf16 v[136:139], v[248:251], v[184:187], v[136:139]
    v_mfma_f32_16x16x32_bf16 v[140:143], v[252:255], v[184:187], v[140:143]
    buffer_load_dwordx4 v[184:187], v29, s[12:15], s49 offen offset:2048 sc1
    buffer_load_dwordx4 v19, s[28:31], s21 offen offset:3072  lds
    v_mfma_f32_16x16x32_bf16 v[144:147], v[240:243], v[188:191], v[144:147]
    v_mfma_f32_16x16x32_bf16 v[148:151], v[244:247], v[188:191], v[148:151]
    v_mfma_f32_16x16x32_bf16 v[152:155], v[248:251], v[188:191], v[152:155]
    v_mfma_f32_16x16x32_bf16 v[156:159], v[252:255], v[188:191], v[156:159]
    buffer_load_dwordx4 v[188:191], v29, s[12:15], s49 offen offset:3072 sc1
    ds_read_b128 v[240:243], v21 offset:16384
    ds_read_b128 v[244:247], v21 offset:18432
    ds_read_b128 v[248:251], v21 offset:20480
    ds_read_b128 v[252:255], v21 offset:22528
    s_waitcnt vmcnt(22) lgkmcnt(4)
    v_mfma_f32_16x16x32_bf16 v[128:131], v[224:227], v[192:195], v[128:131]
    v_mfma_f32_16x16x32_bf16 v[132:135], v[228:231], v[192:195], v[132:135]
    v_mfma_f32_16x16x32_bf16 v[136:139], v[232:235], v[192:195], v[136:139]
    v_mfma_f32_16x16x32_bf16 v[140:143], v[236:239], v[192:195], v[140:143]
    s_xor_b32 s49, s54, 9
    s_lshl_b32 s49, s49, 15
    s_add_u32 s49, s49, s50
    buffer_load_dwordx4 v[192:195], v28, s[12:15], s49 offen offset:0 sc1
    s_add_u32 m0, s23, 81920
    s_xor_b32 s21, s54, 10
    s_lshl_b32 s21, s21, 7
    buffer_load_dwordx4 v16, s[28:31], s21 offen offset:0  lds
    v_mfma_f32_16x16x32_bf16 v[144:147], v[224:227], v[196:199], v[144:147]
    v_mfma_f32_16x16x32_bf16 v[148:151], v[228:231], v[196:199], v[148:151]
    v_mfma_f32_16x16x32_bf16 v[152:155], v[232:235], v[196:199], v[152:155]
    v_mfma_f32_16x16x32_bf16 v[156:159], v[236:239], v[196:199], v[156:159]
    buffer_load_dwordx4 v[196:199], v28, s[12:15], s49 offen offset:1024 sc1
    ds_read_b128 v[224:227], v20 offset:24576
    ds_read_b128 v[228:231], v20 offset:26624
    ds_read_b128 v[232:235], v20 offset:28672
    ds_read_b128 v[236:239], v20 offset:30720
    s_waitcnt vmcnt(16) lgkmcnt(4)
    s_mov_b64 exec, 1
    ds_add_u32 v32, v33 offset:16
    s_mov_b64 exec, -1
    v_mfma_f32_16x16x32_bf16 v[128:131], v[240:243], v[200:203], v[128:131]
    v_mfma_f32_16x16x32_bf16 v[132:135], v[244:247], v[200:203], v[132:135]
    v_mfma_f32_16x16x32_bf16 v[136:139], v[248:251], v[200:203], v[136:139]
    v_mfma_f32_16x16x32_bf16 v[140:143], v[252:255], v[200:203], v[140:143]
    buffer_load_dwordx4 v[200:203], v28, s[12:15], s49 offen offset:2048 sc1
    buffer_load_dwordx4 v17, s[28:31], s21 offen offset:1024  lds
    v_mfma_f32_16x16x32_bf16 v[144:147], v[240:243], v[204:207], v[144:147]
    v_mfma_f32_16x16x32_bf16 v[148:151], v[244:247], v[204:207], v[148:151]
    v_mfma_f32_16x16x32_bf16 v[152:155], v[248:251], v[204:207], v[152:155]
    v_mfma_f32_16x16x32_bf16 v[156:159], v[252:255], v[204:207], v[156:159]
    buffer_load_dwordx4 v[204:207], v28, s[12:15], s49 offen offset:3072 sc1
    ds_read_b128 v[240:243], v21 offset:24576
    ds_read_b128 v[244:247], v21 offset:26624
    ds_read_b128 v[248:251], v21 offset:28672
    ds_read_b128 v[252:255], v21 offset:30720
    s_waitcnt vmcnt(21) lgkmcnt(4)
    v_mfma_f32_16x16x32_bf16 v[128:131], v[224:227], v[208:211], v[128:131]
    v_mfma_f32_16x16x32_bf16 v[132:135], v[228:231], v[208:211], v[132:135]
    v_mfma_f32_16x16x32_bf16 v[136:139], v[232:235], v[208:211], v[136:139]
    v_mfma_f32_16x16x32_bf16 v[140:143], v[236:239], v[208:211], v[140:143]
    ds_read_b32 v34, v32 offset:16
    buffer_load_dwordx4 v[208:211], v29, s[12:15], s49 offen offset:0 sc1
    buffer_load_dwordx4 v18, s[28:31], s21 offen offset:2048  lds
    v_mfma_f32_16x16x32_bf16 v[144:147], v[224:227], v[212:215], v[144:147]
    v_mfma_f32_16x16x32_bf16 v[148:151], v[228:231], v[212:215], v[148:151]
    v_mfma_f32_16x16x32_bf16 v[152:155], v[232:235], v[212:215], v[152:155]
    v_mfma_f32_16x16x32_bf16 v[156:159], v[236:239], v[212:215], v[156:159]
    buffer_load_dwordx4 v[212:215], v29, s[12:15], s49 offen offset:1024 sc1
    s_waitcnt lgkmcnt(0)
    v_readfirstlane_b32 s38, v34
    s_nop 1
    s_cmp_ge_u32 s38, 28
    s_cbranch_scc1 L_st7_ok
L_st7:
    ds_read_b32 v34, v32 offset:16
    s_waitcnt lgkmcnt(0)
    v_readfirstlane_b32 s38, v34
    s_nop 1
    s_cmp_ge_u32 s38, 28
    s_cbranch_scc1 L_st7_ok
    s_sub_u32 s96, s96, 1
    s_cbranch_scc1 L_st7_ok
    s_sleep 0
    s_branch L_st7
L_st7_ok:
    ds_read_b128 v[224:227], v20 offset:32768
    ds_read_b128 v[228:231], v20 offset:34816
    ds_read_b128 v[232:235], v20 offset:36864
    ds_read_b128 v[236:239], v20 offset:38912
    s_waitcnt vmcnt(21)
    v_mfma_f32_16x16x32_bf16 v[128:131], v[240:243], v[216:219], v[128:131]
    v_mfma_f32_16x16x32_bf16 v[132:135], v[244:247], v[216:219], v[132:135]
    v_mfma_f32_16x16x32_bf16 v[136:139], v[248:251], v[216:219], v[136:139]
    v_mfma_f32_16x16x32_bf16 v[140:143], v[252:255], v[216:219], v[140:143]
    buffer_load_dwordx4 v[216:219], v29, s[12:15], s49 offen offset:2048 sc1
    buffer_load_dwordx4 v19, s[28:31], s21 offen offset:3072  lds
    v_mfma_f32_16x16x32_bf16 v[144:147], v[240:243], v[220:223], v[144:147]
    v_mfma_f32_16x16x32_bf16 v[148:151], v[244:247], v[220:223], v[148:151]
    v_mfma_f32_16x16x32_bf16 v[152:155], v[248:251], v[220:223], v[152:155]
    v_mfma_f32_16x16x32_bf16 v[156:159], v[252:255], v[220:223], v[156:159]
    buffer_load_dwordx4 v[220:223], v29, s[12:15], s49 offen offset:3072 sc1
    ds_read_b128 v[240:243], v21 offset:32768
    ds_read_b128 v[244:247], v21 offset:34816
    ds_read_b128 v[248:251], v21 offset:36864
    ds_read_b128 v[252:255], v21 offset:38912
    s_waitcnt vmcnt(21) lgkmcnt(4)
    v_mfma_f32_16x16x32_bf16 v[128:131], v[224:227], v[160:163], v[128:131]
    v_mfma_f32_16x16x32_bf16 v[132:135], v[228:231], v[160:163], v[132:135]
    v_mfma_f32_16x16x32_bf16 v[136:139], v[232:235], v[160:163], v[136:139]
    v_mfma_f32_16x16x32_bf16 v[140:143], v[236:239], v[160:163], v[140:143]
    s_xor_b32 s49, s54, 10
    s_lshl_b32 s49, s49, 15
    s_add_u32 s49, s49, s50
    buffer_load_dwordx4 v[160:163], v28, s[12:15], s49 offen offset:0 sc1
    s_add_u32 m0, s23, 0
    s_xor_b32 s21, s54, 11
    s_lshl_b32 s21, s21, 7
    buffer_load_dwordx4 v16, s[28:31], s21 offen offset:0  lds
    v_mfma_f32_16x16x32_bf16 v[144:147], v[224:227], v[164:167], v[144:147]
    v_mfma_f32_16x16x32_bf16 v[148:151], v[228:231], v[164:167], v[148:151]
    v_mfma_f32_16x16x32_bf16 v[152:155], v[232:235], v[164:167], v[152:155]
    v_mfma_f32_16x16x32_bf16 v[156:159], v[236:239], v[164:167], v[156:159]
    buffer_load_dwordx4 v[164:167], v28, s[12:15], s49 offen offset:1024 sc1
    ds_read_b128 v[224:227], v20 offset:40960
    ds_read_b128 v[228:231], v20 offset:43008
    ds_read_b128 v[232:235], v20 offset:45056
    ds_read_b128 v[236:239], v20 offset:47104
    s_waitcnt vmcnt(16) lgkmcnt(4)
    s_mov_b64 exec, 1
    ds_add_u32 v32, v33 offset:16
    s_mov_b64 exec, -1
    v_mfma_f32_16x16x32_bf16 v[128:131], v[240:243], v[168:171], v[128:131]
    v_mfma_f32_16x16x32_bf16 v[132:135], v[244:247], v[168:171], v[132:135]
    v_mfma_f32_16x16x32_bf16 v[136:139], v[248:251], v[168:171], v[136:139]
    v_mfma_f32_16x16x32_bf16 v[140:143], v[252:255], v[168:171], v[140:143]
    buffer_load_dwordx4 v[168:171], v28, s[12:15], s49 offen offset:2048 sc1
    buffer_load_dwordx4 v17, s[28:31], s21 offen offset:1024  lds
    v_mfma_f32_16x16x32_bf16 v[144:147], v[240:243], v[172:175], v[144:147]
    v_mfma_f32_16x16x32_bf16 v[148:151], v[244:247], v[172:175], v[148:151]
    v_mfma_f32_16x16x32_bf16 v[152:155], v[248:251], v[172:175], v[152:155]
    v_mfma_f32_16x16x32_bf16 v[156:159], v[252:255], v[172:175], v[156:159]
    buffer_load_dwordx4 v[172:175], v28, s[12:15], s49 offen offset:3072 sc1
    ds_read_b128 v[240:243], v21 offset:40960
    ds_read_b128 v[244:247], v21 offset:43008
    ds_read_b128 v[248:251], v21 offset:45056
    ds_read_b128 v[252:255], v21 offset:47104
    s_waitcnt vmcnt(21) lgkmcnt(4)
    v_mfma_f32_16x16x32_bf16 v[128:131], v[224:227], v[176:179], v[128:131]
    v_mfma_f32_16x16x32_bf16 v[132:135], v[228:231], v[176:179], v[132:135]
    v_mfma_f32_16x16x32_bf16 v[136:139], v[232:235], v[176:179], v[136:139]
    v_mfma_f32_16x16x32_bf16 v[140:143], v[236:239], v[176:179], v[140:143]
    ds_read_b32 v34, v32 offset:16
    buffer_load_dwordx4 v[176:179], v29, s[12:15], s49 offen offset:0 sc1
    buffer_load_dwordx4 v18, s[28:31], s21 offen offset:2048  lds
    v_mfma_f32_16x16x32_bf16 v[144:147], v[224:227], v[180:183], v[144:147]
    v_mfma_f32_16x16x32_bf16 v[148:151], v[228:231], v[180:183], v[148:151]
    v_mfma_f32_16x16x32_bf16 v[152:155], v[232:235], v[180:183], v[152:155]
    v_mfma_f32_16x16x32_bf16 v[156:159], v[236:239], v[180:183], v[156:159]
    buffer_load_dwordx4 v[180:183], v29, s[12:15], s49 offen offset:1024 sc1
    s_waitcnt lgkmcnt(0)
    v_readfirstlane_b32 s38, v34
    s_nop 1
    s_cmp_ge_u32 s38, 32
    s_cbranch_scc1 L_st8_ok
L_st8:
    ds_read_b32 v34, v32 offset:16
    s_waitcnt lgkmcnt(0)
    v_readfirstlane_b32 s38, v34
    s_nop 1
    s_cmp_ge_u32 s38, 32
    s_cbranch_scc1 L_st8_ok
    s_sub_u32 s96, s96, 1
    s_cbranch_scc1 L_st8_ok
    s_sleep 0
    s_branch L_st8
L_st8_ok:
    ds_read_b128 v[224:227], v20 offset:49152
    ds_read_b128 v[228:231], v20 offset:51200
    ds_read_b128 v[232:235], v20 offset:53248
    ds_read_b128 v[236:239], v20 offset:55296
    s_waitcnt vmcnt(21)
    v_mfma_f32_16x16x32_bf16 v[128:131], v[240:243], v[184:187], v[128:131]
    v_mfma_f32_16x16x32_bf16 v[132:135], v[244:247], v[184:187], v[132:135]
    v_mfma_f32_16x16x32_bf16 v[136:139], v[248:251], v[184:187], v[136:139]
    v_mfma_f32_16x16x32_bf16 v[140:143], v[252:255], v[184:187], v[140:143]
    buffer_load_dwordx4 v[184:187], v29, s[12:15], s49 offen offset:2048 sc1
    buffer_load_dwordx4 v19, s[28:31], s21 offen offset:3072  lds
    v_mfma_f32_16x16x32_bf16 v[144:147], v[240:243], v[188:191], v[144:147]
    v_mfma_f32_16x16x32_bf16 v[148:151], v[244:247], v[188:191], v[148:151]
    v_mfma_f32_16x16x32_bf16 v[152:155], v[248:251], v[188:191], v[152:155]
    v_mfma_f32_16x16x32_bf16 v[156:159], v[252:255], v[188:191], v[156:159]
    buffer_load_dwordx4 v[188:191], v29, s[12:15], s49 offen offset:3072 sc1
    ds_read_b128 v[240:243], v21 offset:49152
    ds_read_b128 v[244:247], v21 offset:51200
    ds_read_b128 v[248:251], v21 offset:53248
    ds_read_b128 v[252:255], v21 offset:55296
    s_waitcnt vmcnt(21) lgkmcnt(4)
    v_mfma_f32_16x16x32_bf16 v[128:131], v[224:227], v[192:195], v[128:131]
    v_mfma_f32_16x16x32_bf16 v[132:135], v[228:231], v[192:195], v[132:135]
    v_mfma_f32_16x16x32_bf16 v[136:139], v[232:235], v[192:195], v[136:139]
    v_mfma_f32_16x16x32_bf16 v[140:143], v[236:239], v[192:195], v[140:143]
    s_xor_b32 s49, s54, 11
    s_lshl_b32 s49, s49, 15
    s_add_u32 s49, s49, s50
    buffer_load_dwordx4 v[192:195], v28, s[12:15], s49 offen offset:0 sc1
    s_add_u32 m0, s23, 16384
    s_xor_b32 s21, s54, 12
    s_lshl_b32 s21, s21, 7
    buffer_load_dwordx4 v16, s[28:31], s21 offen offset:0  lds
    v_mfma_f32_16x16x32_bf16 v[144:147], v[224:227], v[196:199], v[144:147]
    v_mfma_f32_16x16x32_bf16 v[148:151], v[228:231], v[196:199], v[148:151]
    v_mfma_f32_16x16x32_bf16 v[152:155], v[232:235], v[196:199], v[152:155]
    v_mfma_f32_16x16x32_bf16 v[156:159], v[236:239], v[196:199], v[156:159]
    buffer_load_dwordx4 v[196:199], v28, s[12:15], s49 offen offset:1024 sc1
    ds_read_b128 v[224:227], v20 offset:57344
    ds_read_b128 v[228:231], v20 offset:59392
    ds_read_b128 v[232:235], v20 offset:61440
    ds_read_b128 v[236:239], v20 offset:63488
    s_waitcnt vmcnt(16) lgkmcnt(4)
    s_mov_b64 exec, 1
    ds_add_u32 v32, v33 offset:16
    s_mov_b64 exec, -1
    v_mfma_f32_16x16x32_bf16 v[128:131], v[240:243], v[200:203], v[128:131]
    v_mfma_f32_16x16x32_bf16 v[132:135], v[244:247], v[200:203], v[132:135]
    v_mfma_f32_16x16x32_bf16 v[136:139], v[248:251], v[200:203], v[136:139]
    v_mfma_f32_16x16x32_bf16 v[140:143], v[252:255], v[200:203], v[140:143]
    buffer_load_dwordx4 v[200:203], v28, s[12:15], s49 offen offset:2048 sc1
    buffer_load_dwordx4 v17, s[28:31], s21 offen offset:1024  lds
    v_mfma_f32_16x16x32_bf16 v[144:147], v[240:243], v[204:207], v[144:147]
    v_mfma_f32_16x16x32_bf16 v[148:151], v[244:247], v[204:207], v[148:151]
    v_mfma_f32_16x16x32_bf16 v[152:155], v[248:251], v[204:207], v[152:155]
    v_mfma_f32_16x16x32_bf16 v[156:159], v[252:255], v[204:207], v[156:159]
    buffer_load_dwordx4 v[204:207], v28, s[12:15], s49 offen offset:3072 sc1
    ds_read_b128 v[240:243], v21 offset:57344
    ds_read_b128 v[244:247], v21 offset:59392
    ds_read_b128 v[248:251], v21 offset:61440
    ds_read_b128 v[252:255], v21 offset:63488
    s_waitcnt vmcnt(21) lgkmcnt(4)
    v_mfma_f32_16x16x32_bf16 v[128:131], v[224:227], v[208:211], v[128:131]
    v_mfma_f32_16x16x32_bf16 v[132:135], v[228:231], v[208:211], v[132:135]
    v_mfma_f32_16x16x32_bf16 v[136:139], v[232:235], v[208:211], v[136:139]
    v_mfma_f32_16x16x32_bf16 v[140:143], v[236:239], v[208:211], v[140:143]
    ds_read_b32 v34, v32 offset:16
    buffer_load_dwordx4 v[208:211], v29, s[12:15], s49 offen offset:0 sc1
    buffer_load_dwordx4 v18, s[28:31], s21 offen offset:2048  lds
    v_mfma_f32_16x16x32_bf16 v[144:147], v[224:227], v[212:215], v[144:147]
    v_mfma_f32_16x16x32_bf16 v[148:151], v[228:231], v[212:215], v[148:151]
    v_mfma_f32_16x16x32_bf16 v[152:155], v[232:235], v[212:215], v[152:155]
    v_mfma_f32_16x16x32_bf16 v[156:159], v[236:239], v[212:215], v[156:159]
    buffer_load_dwordx4 v[212:215], v29, s[12:15], s49 offen offset:1024 sc1
    s_waitcnt lgkmcnt(0)
    v_readfirstlane_b32 s38, v34
    s_nop 1
    s_cmp_ge_u32 s38, 36
    s_cbranch_scc1 L_st9_ok
L_st9:
    ds_read_b32 v34, v32 offset:16
    s_waitcnt lgkmcnt(0)
    v_readfirstlane_b32 s38, v34
    s_nop 1
    s_cmp_ge_u32 s38, 36
    s_cbranch_scc1 L_st9_ok
    s_sub_u32 s96, s96, 1
    s_cbranch_scc1 L_st9_ok
    s_sleep 0
    s_branch L_st9
L_st9_ok:
    ds_read_b128 v[224:227], v22 offset:16384
    ds_read_b128 v[228:231], v22 offset:18432
    ds_read_b128 v[232:235], v22 offset:20480
    ds_read_b128 v[236:239], v22 offset:22528
    s_waitcnt vmcnt(21)
    v_mfma_f32_16x16x32_bf16 v[128:131], v[240:243], v[216:219], v[128:131]
    v_mfma_f32_16x16x32_bf16 v[132:135], v[244:247], v[216:219], v[132:135]
    v_mfma_f32_16x16x32_bf16 v[136:139], v[248:251], v[216:219], v[136:139]
    v_mfma_f32_16x16x32_bf16 v[140:143], v[252:255], v[216:219], v[140:143]
    buffer_load_dwordx4 v[216:219], v29, s[12:15], s49 offen offset:2048 sc1
    buffer_load_dwordx4 v19, s[28:31], s21 offen offset:3072  lds
    v_mfma_f32_16x16x32_bf16 v[144:147], v[240:243], v[220:223], v[144:147]
    v_mfma_f32_16x16x32_bf16 v[148:151], v[244:247], v[220:223], v[148:151]
    v_mfma_f32_16x16x32_bf16 v[152:155], v[248:251], v[220:223], v[152:155]
    v_mfma_f32_16x16x32_bf16 v[156:159], v[252:255], v[220:223], v[156:159]
    buffer_load_dwordx4 v[220:223], v29, s[12:15], s49 offen offset:3072 sc1
    ds_read_b128 v[240:243], v23 offset:16384
    ds_read_b128 v[244:247], v23 offset:18432
    ds_read_b128 v[248:251], v23 offset:20480
    ds_read_b128 v[252:255], v23 offset:22528
    s_waitcnt vmcnt(21) lgkmcnt(4)
    v_mfma_f32_16x16x32_bf16 v[128:131], v[224:227], v[160:163], v[128:131]
    v_mfma_f32_16x16x32_bf16 v[132:135], v[228:231], v[160:163], v[132:135]
    v_mfma_f32_16x16x32_bf16 v[136:139], v[232:235], v[160:163], v[136:139]
    v_mfma_f32_16x16x32_bf16 v[140:143], v[236:239], v[160:163], v[140:143]
    s_xor_b32 s49, s54, 12
    s_lshl_b32 s49, s49, 15
    s_add_u32 s49, s49, s50
    buffer_load_dwordx4 v[160:163], v28, s[12:15], s49 offen offset:0 sc1
    s_add_u32 m0, s23, 32768
    s_xor_b32 s21, s54, 13
    s_lshl_b32 s21, s21, 7
    buffer_load_dwordx4 v16, s[28:31], s21 offen offset:0  lds
    v_mfma_f32_16x16x32_bf16 v[144:147], v[224:227], v[164:167], v[144:147]
    v_mfma_f32_16x16x32_bf16 v[148:151], v[228:231], v[164:167], v[148:151]
    v_mfma_f32_16x16x32_bf16 v[152:155], v[232:235], v[164:167], v[152:155]
    v_mfma_f32_16x16x32_bf16 v[156:159], v[236:239], v[164:167], v[156:159]
    buffer_load_dwordx4 v[164:167], v28, s[12:15], s49 offen offset:1024 sc1
    ds_read_b128 v[224:227], v22 offset:24576
    ds_read_b128 v[228:231], v22 offset:26624
    ds_read_b128 v[232:235], v22 offset:28672
    ds_read_b128 v[236:239], v22 offset:30720
    s_waitcnt vmcnt(16) lgkmcnt(4)
    s_mov_b64 exec, 1
    ds_add_u32 v32, v33 offset:16
    s_mov_b64 exec, -1
    v_mfma_f32_16x16x32_bf16 v[128:131], v[240:243], v[168:171], v[128:131]
    v_mfma_f32_16x16x32_bf16 v[132:135], v[244:247], v[168:171], v[132:135]
    v_mfma_f32_16x16x32_bf16 v[136:139], v[248:251], v[168:171], v[136:139]
    v_mfma_f32_16x16x32_bf16 v[140:143], v[252:255], v[168:171], v[140:143]
    buffer_load_dwordx4 v[168:171], v28, s[12:15], s49 offen offset:2048 sc1
    buffer_load_dwordx4 v17, s[28:31], s21 offen offset:1024  lds
    v_mfma_f32_16x16x32_bf16 v[144:147], v[240:243], v[172:175], v[144:147]
    v_mfma_f32_16x16x32_bf16 v[148:151], v[244:247], v[172:175], v[148:151]
    v_mfma_f32_16x16x32_bf16 v[152:155], v[248:251], v[172:175], v[152:155]
    v_mfma_f32_16x16x32_bf16 v[156:159], v[252:255], v[172:175], v[156:159]
    buffer_load_dwordx4 v[172:175], v28, s[12:15], s49 offen offset:3072 sc1
    ds_read_b128 v[240:243], v23 offset:24576
    ds_read_b128 v[244:247], v23 offset:26624
    ds_read_b128 v[248:251], v23 offset:28672
    ds_read_b128 v[252:255], v23 offset:30720
    s_waitcnt vmcnt(21) lgkmcnt(4)
    v_mfma_f32_16x16x32_bf16 v[128:131], v[224:227], v[176:179], v[128:131]
    v_mfma_f32_16x16x32_bf16 v[132:135], v[228:231], v[176:179], v[132:135]
    v_mfma_f32_16x16x32_bf16 v[136:139], v[232:235], v[176:179], v[136:139]
    v_mfma_f32_16x16x32_bf16 v[140:143], v[236:239], v[176:179], v[140:143]
    ds_read_b32 v34, v32 offset:16
    buffer_load_dwordx4 v[176:179], v29, s[12:15], s49 offen offset:0 sc1
    buffer_load_dwordx4 v18, s[28:31], s21 offen offset:2048  lds
    v_mfma_f32_16x16x32_bf16 v[144:147], v[224:227], v[180:183], v[144:147]
    v_mfma_f32_16x16x32_bf16 v[148:151], v[228:231], v[180:183], v[148:151]
    v_mfma_f32_16x16x32_bf16 v[152:155], v[232:235], v[180:183], v[152:155]
    v_mfma_f32_16x16x32_bf16 v[156:159], v[236:239], v[180:183], v[156:159]
    buffer_load_dwordx4 v[180:183], v29, s[12:15], s49 offen offset:1024 sc1
    s_waitcnt lgkmcnt(0)
    v_readfirstlane_b32 s38, v34
    s_nop 1
    s_cmp_ge_u32 s38, 40
    s_cbranch_scc1 L_st10_ok
L_st10:
    ds_read_b32 v34, v32 offset:16
    s_waitcnt lgkmcnt(0)
    v_readfirstlane_b32 s38, v34
    s_nop 1
    s_cmp_ge_u32 s38, 40
    s_cbranch_scc1 L_st10_ok
    s_sub_u32 s96, s96, 1
    s_cbranch_scc1 L_st10_ok
    s_sleep 0
    s_branch L_st10
L_st10_ok:
    ds_read_b128 v[224:227], v20 offset:0
    ds_read_b128 v[228:231], v20 offset:2048
    ds_read_b128 v[232:235], v20 offset:4096
    ds_read_b128 v[236:239], v20 offset:6144
    s_waitcnt vmcnt(21)
    v_mfma_f32_16x16x32_bf16 v[128:131], v[240:243], v[184:187], v[128:131]
    v_mfma_f32_16x16x32_bf16 v[132:135], v[244:247], v[184:187], v[132:135]
    v_mfma_f32_16x16x32_bf16 v[136:139], v[248:251], v[184:187], v[136:139]
    v_mfma_f32_16x16x32_bf16 v[140:143], v[252:255], v[184:187], v[140:143]
    buffer_load_dwordx4 v[184:187], v29, s[12:15], s49 offen offset:2048 sc1
    buffer_load_dwordx4 v19, s[28:31], s21 offen offset:3072  lds
    v_mfma_f32_16x16x32_bf16 v[144:147], v[240:243], v[188:191], v[144:147]
    v_mfma_f32_16x16x32_bf16 v[148:151], v[244:247], v[188:191], v[148:151]
    v_mfma_f32_16x16x32_bf16 v[152:155], v[248:251], v[188:191], v[152:155]
    v_mfma_f32_16x16x32_bf16 v[156:159], v[252:255], v[188:191], v[156:159]
    buffer_load_dwordx4 v[188:191], v29, s[12:15], s49 offen offset:3072 sc1
    ds_read_b128 v[240:243], v21 offset:0
    ds_read_b128 v[244:247], v21 offset:2048
    ds_read_b128 v[248:251], v21 offset:4096
    ds_read_b128 v[252:255], v21 offset:6144
    s_waitcnt vmcnt(21) lgkmcnt(4)
    v_mfma_f32_16x16x32_bf16 v[128:131], v[224:227], v[192:195], v[128:131]
    v_mfma_f32_16x16x32_bf16 v[132:135], v[228:231], v[192:195], v[132:135]
    v_mfma_f32_16x16x32_bf16 v[136:139], v[232:235], v[192:195], v[136:139]
    v_mfma_f32_16x16x32_bf16 v[140:143], v[236:239], v[192:195], v[140:143]
    s_xor_b32 s49, s54, 13
    s_lshl_b32 s49, s49, 15
    s_add_u32 s49, s49, s50
    buffer_load_dwordx4 v[192:195], v28, s[12:15], s49 offen offset:0 sc1
    s_add_u32 m0, s23, 49152
    s_xor_b32 s21, s54, 14
    s_lshl_b32 s21, s21, 7
    buffer_load_dwordx4 v16, s[28:31], s21 offen offset:0  lds
    v_mfma_f32_16x16x32_bf16 v[144:147], v[224:227], v[196:199], v[144:147]
    v_mfma_f32_16x16x32_bf16 v[148:151], v[228:231], v[196:199], v[148:151]
    v_mfma_f32_16x16x32_bf16 v[152:155], v[232:235], v[196:199], v[152:155]
    v_mfma_f32_16x16x32_bf16 v[156:159], v[236:239], v[196:199], v[156:159]
    buffer_load_dwordx4 v[196:199], v28, s[12:15], s49 offen offset:1024 sc1
    ds_read_b128 v[224:227], v20 offset:8192
    ds_read_b128 v[228:231], v20 offset:10240
    ds_read_b128 v[232:235], v20 offset:12288
    ds_read_b128 v[236:239], v20 offset:14336
    s_waitcnt vmcnt(16) lgkmcnt(4)
    s_mov_b64 exec, 1
    ds_add_u32 v32, v33 offset:16
    s_mov_b64 exec, -1
    v_mfma_f32_16x16x32_bf16 v[128:131], v[240:243], v[200:203], v[128:131]
    v_mfma_f32_16x16x32_bf16 v[132:135], v[244:247], v[200:203], v[132:135]
    v_mfma_f32_16x16x32_bf16 v[136:139], v[248:251], v[200:203], v[136:139]
    v_mfma_f32_16x16x32_bf16 v[140:143], v[252:255], v[200:203], v[140:143]
    buffer_load_dwordx4 v[200:203], v28, s[12:15], s49 offen offset:2048 sc1
    buffer_load_dwordx4 v17, s[28:31], s21 offen offset:1024  lds
    v_mfma_f32_16x16x32_bf16 v[144:147], v[240:243], v[204:207], v[144:147]
    v_mfma_f32_16x16x32_bf16 v[148:151], v[244:247], v[204:207], v[148:151]
    v_mfma_f32_16x16x32_bf16 v[152:155], v[248:251], v[204:207], v[152:155]
    v_mfma_f32_16x16x32_bf16 v[156:159], v[252:255], v[204:207], v[156:159]
    buffer_load_dwordx4 v[204:207], v28, s[12:15], s49 offen offset:3072 sc1
    ds_read_b128 v[240:243], v21 offset:8192
    ds_read_b128 v[244:247], v21 offset:10240
    ds_read_b128 v[248:251], v21 offset:12288
    ds_read_b128 v[252:255], v21 offset:14336
    s_waitcnt vmcnt(21) lgkmcnt(4)
    v_mfma_f32_16x16x32_bf16 v[128:131], v[224:227], v[208:211], v[128:131]
    v_mfma_f32_16x16x32_bf16 v[132:135], v[228:231], v[208:211], v[132:135]
    v_mfma_f32_16x16x32_bf16 v[136:139], v[232:235], v[208:211], v[136:139]
    v_mfma_f32_16x16x32_bf16 v[140:143], v[236:239], v[208:211], v[140:143]
    ds_read_b32 v34, v32 offset:16
    buffer_load_dwordx4 v[208:211], v29, s[12:15], s49 offen offset:0 sc1
    buffer_load_dwordx4 v18, s[28:31], s21 offen offset:2048  lds
    v_mfma_f32_16x16x32_bf16 v[144:147], v[224:227], v[212:215], v[144:147]
    v_mfma_f32_16x16x32_bf16 v[148:151], v[228:231], v[212:215], v[148:151]
    v_mfma_f32_16x16x32_bf16 v[152:155], v[232:235], v[212:215], v[152:155]
    v_mfma_f32_16x16x32_bf16 v[156:159], v[236:239], v[212:215], v[156:159]
    buffer_load_dwordx4 v[212:215], v29, s[12:15], s49 offen offset:1024 sc1
    s_waitcnt lgkmcnt(0)
    v_readfirstlane_b32 s38, v34
    s_nop 1
    s_cmp_ge_u32 s38, 44
    s_cbranch_scc1 L_st11_ok
L_st11:
    ds_read_b32 v34, v32 offset:16
    s_waitcnt lgkmcnt(0)
    v_readfirstlane_b32 s38, v34
    s_nop 1
    s_cmp_ge_u32 s38, 44
    s_cbranch_scc1 L_st11_ok
    s_sub_u32 s96, s96, 1
    s_cbranch_scc1 L_st11_ok
    s_sleep 0
    s_branch L_st11
L_st11_ok:
    ds_read_b128 v[224:227], v20 offset:16384
    ds_read_b128 v[228:231], v20 offset:18432
    ds_read_b128 v[232:235], v20 offset:20480
    ds_read_b128 v[236:239], v20 offset:22528
    s_waitcnt vmcnt(21)
    v_mfma_f32_16x16x32_bf16 v[128:131], v[240:243], v[216:219], v[128:131]
    v_mfma_f32_16x16x32_bf16 v[132:135], v[244:247], v[216:219], v[132:135]
    v_mfma_f32_16x16x32_bf16 v[136:139], v[248:251], v[216:219], v[136:139]
    v_mfma_f32_16x16x32_bf16 v[140:143], v[252:255], v[216:219], v[140:143]
    buffer_load_dwordx4 v[216:219], v29, s[12:15], s49 offen offset:2048 sc1
    buffer_load_dwordx4 v19, s[28:31], s21 offen offset:3072  lds
    v_mfma_f32_16x16x32_bf16 v[144:147], v[240:243], v[220:223], v[144:147]
    v_mfma_f32_16x16x32_bf16 v[148:151], v[244:247], v[220:223], v[148:151]
    v_mfma_f32_16x16x32_bf16 v[152:155], v[248:251], v[220:223], v[152:155]
    v_mfma_f32_16x16x32_bf16 v[156:159], v[252:255], v[220:223], v[156:159]
    buffer_load_dwordx4 v[220:223], v29, s[12:15], s49 offen offset:3072 sc1
    ds_read_b128 v[240:243], v21 offset:16384
    ds_read_b128 v[244:247], v21 offset:18432
    ds_read_b128 v[248:251], v21 offset:20480
    ds_read_b128 v[252:255], v21 offset:22528
    s_waitcnt vmcnt(21) lgkmcnt(4)
    v_mfma_f32_16x16x32_bf16 v[128:131], v[224:227], v[160:163], v[128:131]
    v_mfma_f32_16x16x32_bf16 v[132:135], v[228:231], v[160:163], v[132:135]
    v_mfma_f32_16x16x32_bf16 v[136:139], v[232:235], v[160:163], v[136:139]
    v_mfma_f32_16x16x32_bf16 v[140:143], v[236:239], v[160:163], v[140:143]
    s_xor_b32 s49, s54, 14
    s_lshl_b32 s49, s49, 15
    s_add_u32 s49, s49, s50
    buffer_load_dwordx4 v[160:163], v28, s[12:15], s49 offen offset:0 sc1
    s_add_u32 m0, s23, 81920
    s_xor_b32 s21, s54, 15
    s_lshl_b32 s21, s21, 7
    buffer_load_dwordx4 v16, s[28:31], s21 offen offset:0  lds
    v_mfma_f32_16x16x32_bf16 v[144:147], v[224:227], v[164:167], v[144:147]
    v_mfma_f32_16x16x32_bf16 v[148:151], v[228:231], v[164:167], v[148:151]
    v_mfma_f32_16x16x32_bf16 v[152:155], v[232:235], v[164:167], v[152:155]
    v_mfma_f32_16x16x32_bf16 v[156:159], v[236:239], v[164:167], v[156:159]
    buffer_load_dwordx4 v[164:167], v28, s[12:15], s49 offen offset:1024 sc1
    ds_read_b128 v[224:227], v20 offset:24576
    ds_read_b128 v[228:231], v20 offset:26624
    ds_read_b128 v[232:235], v20 offset:28672
    ds_read_b128 v[236:239], v20 offset:30720
    s_waitcnt vmcnt(16) lgkmcnt(4)
    s_mov_b64 exec, 1
    ds_add_u32 v32, v33 offset:16
    s_mov_b64 exec, -1
    v_mfma_f32_16x16x32_bf16 v[128:131], v[240:243], v[168:171], v[128:131]
    v_mfma_f32_16x16x32_bf16 v[132:135], v[244:247], v[168:171], v[132:135]
    v_mfma_f32_16x16x32_bf16 v[136:139], v[248:251], v[168:171], v[136:139]
    v_mfma_f32_16x16x32_bf16 v[140:143], v[252:255], v[168:171], v[140:143]
    buffer_load_dwordx4 v[168:171], v28, s[12:15], s49 offen offset:2048 sc1
    buffer_load_dwordx4 v17, s[28:31], s21 offen offset:1024  lds
    v_mfma_f32_16x16x32_bf16 v[144:147], v[240:243], v[172:175], v[144:147]
    v_mfma_f32_16x16x32_bf16 v[148:151], v[244:247], v[172:175], v[148:151]
    v_mfma_f32_16x16x32_bf16 v[152:155], v[248:251], v[172:175], v[152:155]
    v_mfma_f32_16x16x32_bf16 v[156:159], v[252:255], v[172:175], v[156:159]
    buffer_load_dwordx4 v[172:175], v28, s[12:15], s49 offen offset:3072 sc1
    ds_read_b128 v[240:243], v21 offset:24576
    ds_read_b128 v[244:247], v21 offset:26624
    ds_read_b128 v[248:251], v21 offset:28672
    ds_read_b128 v[252:255], v21 offset:30720
    s_waitcnt vmcnt(21) lgkmcnt(4)
    v_mfma_f32_16x16x32_bf16 v[128:131], v[224:227], v[176:179], v[128:131]
    v_mfma_f32_16x16x32_bf16 v[132:135], v[228:231], v[176:179], v[132:135]
    v_mfma_f32_16x16x32_bf16 v[136:139], v[232:235], v[176:179], v[136:139]
    v_mfma_f32_16x16x32_bf16 v[140:143], v[236:239], v[176:179], v[140:143]
    ds_read_b32 v34, v32 offset:16
    buffer_load_dwordx4 v[176:179], v29, s[12:15], s49 offen offset:0 sc1
    buffer_load_dwordx4 v18, s[28:31], s21 offen offset:2048  lds
    v_mfma_f32_16x16x32_bf16 v[144:147], v[224:227], v[180:183], v[144:147]
    v_mfma_f32_16x16x32_bf16 v[148:151], v[228:231], v[180:183], v[148:151]
    v_mfma_f32_16x16x32_bf16 v[152:155], v[232:235], v[180:183], v[152:155]
    v_mfma_f32_16x16x32_bf16 v[156:159], v[236:239], v[180:183], v[156:159]
    buffer_load_dwordx4 v[180:183], v29, s[12:15], s49 offen offset:1024 sc1
    s_waitcnt lgkmcnt(0)
    v_readfirstlane_b32 s38, v34
    s_nop 1
    s_cmp_ge_u32 s38, 48
    s_cbranch_scc1 L_st12_ok
L_st12:
    ds_read_b32 v34, v32 offset:16
    s_waitcnt lgkmcnt(0)
    v_readfirstlane_b32 s38, v34
    s_nop 1
    s_cmp_ge_u32 s38, 48
    s_cbranch_scc1 L_st12_ok
    s_sub_u32 s96, s96, 1
    s_cbranch_scc1 L_st12_ok
    s_sleep 0
    s_branch L_st12
L_st12_ok:
    ds_read_b128 v[224:227], v20 offset:32768
    ds_read_b128 v[228:231], v20 offset:34816
    ds_read_b128 v[232:235], v20 offset:36864
    ds_read_b128 v[236:239], v20 offset:38912
    s_waitcnt vmcnt(21)
    v_mfma_f32_16x16x32_bf16 v[128:131], v[240:243], v[184:187], v[128:131]
    v_mfma_f32_16x16x32_bf16 v[132:135], v[244:247], v[184:187], v[132:135]
    v_mfma_f32_16x16x32_bf16 v[136:139], v[248:251], v[184:187], v[136:139]
    v_mfma_f32_16x16x32_bf16 v[140:143], v[252:255], v[184:187], v[140:143]
    buffer_load_dwordx4 v[184:187], v29, s[12:15], s49 offen offset:2048 sc1
    buffer_load_dwordx4 v19, s[28:31], s21 offen offset:3072  lds
    v_mfma_f32_16x16x32_bf16 v[144:147], v[240:243], v[188:191], v[144:147]
    v_mfma_f32_16x16x32_bf16 v[148:151], v[244:247], v[188:191], v[148:151]
    v_mfma_f32_16x16x32_bf16 v[152:155], v[248:251], v[188:191], v[152:155]
    v_mfma_f32_16x16x32_bf16 v[156:159], v[252:255], v[188:191], v[156:159]
    buffer_load_dwordx4 v[188:191], v29, s[12:15], s49 offen offset:3072 sc1
    ds_read_b128 v[240:243], v21 offset:32768
    ds_read_b128 v[244:247], v21 offset:34816
    ds_read_b128 v[248:251], v21 offset:36864
    ds_read_b128 v[252:255], v21 offset:38912
    s_waitcnt vmcnt(21) lgkmcnt(4)
    v_mfma_f32_16x16x32_bf16 v[128:131], v[224:227], v[192:195], v[128:131]
    v_mfma_f32_16x16x32_bf16 v[132:135], v[228:231], v[192:195], v[132:135]
    v_mfma_f32_16x16x32_bf16 v[136:139], v[232:235], v[192:195], v[136:139]
    v_mfma_f32_16x16x32_bf16 v[140:143], v[236:239], v[192:195], v[140:143]
    s_xor_b32 s49, s54, 15
    s_lshl_b32 s49, s49, 15
    s_add_u32 s49, s49, s50
    buffer_load_dwordx4 v[192:195], v28, s[12:15], s49 offen offset:0 sc1
    v_mfma_f32_16x16x32_bf16 v[144:147], v[224:227], v[196:199], v[144:147]
    v_mfma_f32_16x16x32_bf16 v[148:151], v[228:231], v[196:199], v[148:151]
    v_mfma_f32_16x16x32_bf16 v[152:155], v[232:235], v[196:199], v[152:155]
    v_mfma_f32_16x16x32_bf16 v[156:159], v[236:239], v[196:199], v[156:159]
    buffer_load_dwordx4 v[196:199], v28, s[12:15], s49 offen offset:1024 sc1
    ds_read_b128 v[224:227], v20 offset:40960
    ds_read_b128 v[228:231], v20 offset:43008
    ds_read_b128 v[232:235], v20 offset:45056
    ds_read_b128 v[236:239], v20 offset:47104
    s_waitcnt vmcnt(15) lgkmcnt(4)
    s_mov_b64 exec, 1
    ds_add_u32 v32, v33 offset:16
    s_mov_b64 exec, -1
    v_mfma_f32_16x16x32_bf16 v[128:131], v[240:243], v[200:203], v[128:131]
    v_mfma_f32_16x16x32_bf16 v[132:135], v[244:247], v[200:203], v[132:135]
    v_mfma_f32_16x16x32_bf16 v[136:139], v[248:251], v[200:203], v[136:139]
    v_mfma_f32_16x16x32_bf16 v[140:143], v[252:255], v[200:203], v[140:143]
    buffer_load_dwordx4 v[200:203], v28, s[12:15], s49 offen offset:2048 sc1
    v_mfma_f32_16x16x32_bf16 v[144:147], v[240:243], v[204:207], v[144:147]
    v_mfma_f32_16x16x32_bf16 v[148:151], v[244:247], v[204:207], v[148:151]
    v_mfma_f32_16x16x32_bf16 v[152:155], v[248:251], v[204:207], v[152:155]
    v_mfma_f32_16x16x32_bf16 v[156:159], v[252:255], v[204:207], v[156:159]
    buffer_load_dwordx4 v[204:207], v28, s[12:15], s49 offen offset:3072 sc1
    ds_read_b128 v[240:243], v21 offset:40960
    ds_read_b128 v[244:247], v21 offset:43008
    ds_read_b128 v[248:251], v21 offset:45056
    ds_read_b128 v[252:255], v21 offset:47104
    s_waitcnt vmcnt(19) lgkmcnt(4)
    v_mfma_f32_16x16x32_bf16 v[128:131], v[224:227], v[208:211], v[128:131]
    v_mfma_f32_16x16x32_bf16 v[132:135], v[228:231], v[208:211], v[132:135]
    v_mfma_f32_16x16x32_bf16 v[136:139], v[232:235], v[208:211], v[136:139]
    v_mfma_f32_16x16x32_bf16 v[140:143], v[236:239], v[208:211], v[140:143]
    ds_read_b32 v34, v32 offset:16
    buffer_load_dwordx4 v[208:211], v29, s[12:15], s49 offen offset:0 sc1
    v_mfma_f32_16x16x32_bf16 v[144:147], v[224:227], v[212:215], v[144:147]
    v_mfma_f32_16x16x32_bf16 v[148:151], v[228:231], v[212:215], v[148:151]
    v_mfma_f32_16x16x32_bf16 v[152:155], v[232:235], v[212:215], v[152:155]
    v_mfma_f32_16x16x32_bf16 v[156:159], v[236:239], v[212:215], v[156:159]
    buffer_load_dwordx4 v[212:215], v29, s[12:15], s49 offen offset:1024 sc1
    s_waitcnt lgkmcnt(0)
    v_readfirstlane_b32 s38, v34
    s_nop 1
    s_cmp_ge_u32 s38, 52
    s_cbranch_scc1 L_st13_ok
L_st13:
    ds_read_b32 v34, v32 offset:16
    s_waitcnt lgkmcnt(0)
    v_readfirstlane_b32 s38, v34
    s_nop 1
    s_cmp_ge_u32 s38, 52
    s_cbranch_scc1 L_st13_ok
    s_sub_u32 s96, s96, 1
    s_cbranch_scc1 L_st13_ok
    s_sleep 0
    s_branch L_st13
L_st13_ok:
    ds_read_b128 v[224:227], v20 offset:49152
    ds_read_b128 v[228:231], v20 offset:51200
    ds_read_b128 v[232:235], v20 offset:53248
    ds_read_b128 v[236:239], v20 offset:55296
    s_waitcnt vmcnt(18)
    v_mfma_f32_16x16x32_bf16 v[128:131], v[240:243], v[216:219], v[128:131]
    v_mfma_f32_16x16x32_bf16 v[132:135], v[244:247], v[216:219], v[132:135]
    v_mfma_f32_16x16x32_bf16 v[136:139], v[248:251], v[216:219], v[136:139]
    v_mfma_f32_16x16x32_bf16 v[140:143], v[252:255], v[216:219], v[140:143]
    buffer_load_dwordx4 v[216:219], v29, s[12:15], s49 offen offset:2048 sc1
    v_mfma_f32_16x16x32_bf16 v[144:147], v[240:243], v[220:223], v[144:147]
    v_mfma_f32_16x16x32_bf16 v[148:151], v[244:247], v[220:223], v[148:151]
    v_mfma_f32_16x16x32_bf16 v[152:155], v[248:251], v[220:223], v[152:155]
    v_mfma_f32_16x16x32_bf16 v[156:159], v[252:255], v[220:223], v[156:159]
    buffer_load_dwordx4 v[220:223], v29, s[12:15], s49 offen offset:3072 sc1
    ds_read_b128 v[240:243], v21 offset:49152
    ds_read_b128 v[244:247], v21 offset:51200
    ds_read_b128 v[248:251], v21 offset:53248
    ds_read_b128 v[252:255], v21 offset:55296
    s_waitcnt vmcnt(17) lgkmcnt(4)
    v_mfma_f32_16x16x32_bf16 v[128:131], v[224:227], v[160:163], v[128:131]
    v_mfma_f32_16x16x32_bf16 v[132:135], v[228:231], v[160:163], v[132:135]
    v_mfma_f32_16x16x32_bf16 v[136:139], v[232:235], v[160:163], v[136:139]
    v_mfma_f32_16x16x32_bf16 v[140:143], v[236:239], v[160:163], v[140:143]
    v_mfma_f32_16x16x32_bf16 v[144:147], v[224:227], v[164:167], v[144:147]
    v_mfma_f32_16x16x32_bf16 v[148:151], v[228:231], v[164:167], v[148:151]
    v_mfma_f32_16x16x32_bf16 v[152:155], v[232:235], v[164:167], v[152:155]
    v_mfma_f32_16x16x32_bf16 v[156:159], v[236:239], v[164:167], v[156:159]
    ds_read_b128 v[224:227], v20 offset:57344
    ds_read_b128 v[228:231], v20 offset:59392
    ds_read_b128 v[232:235], v20 offset:61440
    ds_read_b128 v[236:239], v20 offset:63488
    s_waitcnt vmcnt(9) lgkmcnt(4)
    s_mov_b64 exec, 1
    ds_add_u32 v32, v33 offset:16
    s_mov_b64 exec, -1
    v_mfma_f32_16x16x32_bf16 v[128:131], v[240:243], v[168:171], v[128:131]
    v_mfma_f32_16x16x32_bf16 v[132:135], v[244:247], v[168:171], v[132:135]
    v_mfma_f32_16x16x32_bf16 v[136:139], v[248:251], v[168:171], v[136:139]
    v_mfma_f32_16x16x32_bf16 v[140:143], v[252:255], v[168:171], v[140:143]
    v_mfma_f32_16x16x32_bf16 v[144:147], v[240:243], v[172:175], v[144:147]
    v_mfma_f32_16x16x32_bf16 v[148:151], v[244:247], v[172:175], v[148:151]
    v_mfma_f32_16x16x32_bf16 v[152:155], v[248:251], v[172:175], v[152:155]
    v_mfma_f32_16x16x32_bf16 v[156:159], v[252:255], v[172:175], v[156:159]
    ds_read_b128 v[240:243], v21 offset:57344
    ds_read_b128 v[244:247], v21 offset:59392
    ds_read_b128 v[248:251], v21 offset:61440
    ds_read_b128 v[252:255], v21 offset:63488
    s_waitcnt vmcnt(11) lgkmcnt(4)
    v_mfma_f32_16x16x32_bf16 v[128:131], v[224:227], v[176:179], v[128:131]
    v_mfma_f32_16x16x32_bf16 v[132:135], v[228:231], v[176:179], v[132:135]
    v_mfma_f32_16x16x32_bf16 v[136:139], v[232:235], v[176:179], v[136:139]
    v_mfma_f32_16x16x32_bf16 v[140:143], v[236:239], v[176:179], v[140:143]
    ds_read_b32 v34, v32 offset:16
    v_mfma_f32_16x16x32_bf16 v[144:147], v[224:227], v[180:183], v[144:147]
    v_mfma_f32_16x16x32_bf16 v[148:151], v[228:231], v[180:183], v[148:151]
    v_mfma_f32_16x16x32_bf16 v[152:155], v[232:235], v[180:183], v[152:155]
    v_mfma_f32_16x16x32_bf16 v[156:159], v[236:239], v[180:183], v[156:159]
    s_waitcnt lgkmcnt(0)
    v_readfirstlane_b32 s38, v34
    s_nop 1
    s_cmp_ge_u32 s38, 56
    s_cbranch_scc1 L_st14_ok
L_st14:
    ds_read_b32 v34, v32 offset:16
    s_waitcnt lgkmcnt(0)
    v_readfirstlane_b32 s38, v34
    s_nop 1
    s_cmp_ge_u32 s38, 56
    s_cbranch_scc1 L_st14_ok
    s_sub_u32 s96, s96, 1
    s_cbranch_scc1 L_st14_ok
    s_sleep 0
    s_branch L_st14
L_st14_ok:
    ds_read_b128 v[224:227], v22 offset:16384
    ds_read_b128 v[228:231], v22 offset:18432
    ds_read_b128 v[232:235], v22 offset:20480
    ds_read_b128 v[236:239], v22 offset:22528
    s_waitcnt vmcnt(8)
    v_mfma_f32_16x16x32_bf16 v[128:131], v[240:243], v[184:187], v[128:131]
    v_mfma_f32_16x16x32_bf16 v[132:135], v[244:247], v[184:187], v[132:135]
    v_mfma_f32_16x16x32_bf16 v[136:139], v[248:251], v[184:187], v[136:139]
    v_mfma_f32_16x16x32_bf16 v[140:143], v[252:255], v[184:187], v[140:143]
    v_mfma_f32_16x16x32_bf16 v[144:147], v[240:243], v[188:191], v[144:147]
    v_mfma_f32_16x16x32_bf16 v[148:151], v[244:247], v[188:191], v[148:151]
    v_mfma_f32_16x16x32_bf16 v[152:155], v[248:251], v[188:191], v[152:155]
    v_mfma_f32_16x16x32_bf16 v[156:159], v[252:255], v[188:191], v[156:159]
L_topw:
    ds_read_b32 v34, v32 offset:32
    s_waitcnt lgkmcnt(0)
    v_readfirstlane_b32 s38, v34
    s_nop 1
    s_cmp_ge_u32 s38, 1
    s_cbranch_scc1 L_topw_ok
    s_sub_u32 s96, s96, 1
    s_cbranch_scc1 L_topw_ok
    s_sleep 1
    s_branch L_topw
L_topw_ok:
    ds_read_b32 v60, v47
    s_sub_u32 s38, 2047, s51
    s_waitcnt lgkmcnt(0)
    v_and_b32 v60, 0x7ff, v60
    v_sub_u32 v60, s38, v60
    v_cmp_gt_u32 vcc, 32, v60
    s_nop 1
    s_and_b32 s57, vcc_lo, 0xff
L_fix:
    s_cmp_eq_u32 s57, 0
    s_cbranch_scc1 L_fixd
    s_ff1_i32_b32 s8, s57
    s_bitset0_b32 s57, s8
    v_readlane_b32 s9, v60, s8
    v_lshl_add_u32 v52, s8, 2, v32
L_dfw:
    ds_read_b32 v53, v52 offset:36
    s_waitcnt lgkmcnt(0)
    v_readfirstlane_b32 s38, v53
    s_nop 1
    s_cmp_ge_u32 s38, 1
    s_cbranch_scc1 L_dfw_ok
    s_sub_u32 s96, s96, 1
    s_cbranch_scc1 L_dfw_ok
    s_sleep 2
    s_branch L_dfw
L_dfw_ok:
    s_lshl_b32 s38, s8, 8
    s_add_u32 s38, s38, 75776
    v_lshl_add_u32 v52, v26, 4, s38
    ds_read_b128 v[48:51], v52
    s_and_b32 s38, s9, 3
    s_lshl_b32 s38, s38, 4
    s_lshl_b64 s[10:11], 0xffff, s38
    s_lshr_b32 s9, s9, 2
    s_waitcnt lgkmcnt(0)
    s_mov_b64 exec, s[10:11]
    s_cmp_lg_u32 s9, 0
    s_cbranch_scc1 L_fx0
    v_pk_add_f32 v[72:73], v[72:73], v[48:49]
    v_pk_add_f32 v[74:75], v[74:75], v[50:51]
L_fx0:
    s_cmp_lg_u32 s9, 1
    s_cbranch_scc1 L_fx1
    v_pk_add_f32 v[76:77], v[76:77], v[48:49]
    v_pk_add_f32 v[78:79], v[78:79], v[50:51]
L_fx1:
    s_cmp_lg_u32 s9, 2
    s_cbranch_scc1 L_fx2
    v_pk_add_f32 v[88:89], v[88:89], v[48:49]
    v_pk_add_f32 v[90:91], v[90:91], v[50:51]
L_fx2:
    s_cmp_lg_u32 s9, 3
    s_cbranch_scc1 L_fx3
    v_pk_add_f32 v[92:93], v[92:93], v[48:49]
    v_pk_add_f32 v[94:95], v[94:95], v[50:51]
L_fx3:
    s_cmp_lg_u32 s9, 4
    s_cbranch_scc1 L_fx4
    v_pk_add_f32 v[104:105], v[104:105], v[48:49]
    v_pk_add_f32 v[106:107], v[106:107], v[50:51]
L_fx4:
    s_cmp_lg_u32 s9, 5
    s_cbranch_scc1 L_fx5
    v_pk_add_f32 v[108:109], v[108:109], v[48:49]
    v_pk_add_f32 v[110:111], v[110:111], v[50:51]
L_fx5:
    s_cmp_lg_u32 s9, 6
    s_cbranch_scc1 L_fx6
    v_pk_add_f32 v[120:121], v[120:121], v[48:49]
    v_pk_add_f32 v[122:123], v[122:123], v[50:51]
L_fx6:
    s_cmp_lg_u32 s9, 7
    s_cbranch_scc1 L_fx7
    v_pk_add_f32 v[124:125], v[124:125], v[48:49]
    v_pk_add_f32 v[126:127], v[126:127], v[50:51]
L_fx7:
    s_mov_b64 exec, -1
    s_branch L_fix
L_fixd:
    ds_read_b128 v[240:243], v23 offset:16384
    ds_read_b128 v[244:247], v23 offset:18432
    ds_read_b128 v[248:251], v23 offset:20480
    ds_read_b128 v[252:255], v23 offset:22528
    s_waitcnt vmcnt(6) lgkmcnt(4)
    v_mfma_f32_16x16x32_bf16 v[128:131], v[224:227], v[192:195], v[128:131]
    v_mfma_f32_16x16x32_bf16 v[132:135], v[228:231], v[192:195], v[132:135]
    v_mfma_f32_16x16x32_bf16 v[136:139], v[232:235], v[192:195], v[136:139]
    v_mfma_f32_16x16x32_bf16 v[140:143], v[236:239], v[192:195], v[140:143]
    v_mfma_f32_16x16x32_bf16 v[144:147], v[224:227], v[196:199], v[144:147]
    v_mfma_f32_16x16x32_bf16 v[148:151], v[228:231], v[196:199], v[148:151]
    v_mfma_f32_16x16x32_bf16 v[152:155], v[232:235], v[196:199], v[152:155]
    v_mfma_f32_16x16x32_bf16 v[156:159], v[236:239], v[196:199], v[156:159]
    ds_read_b128 v[224:227], v22 offset:24576
    ds_read_b128 v[228:231], v22 offset:26624
    ds_read_b128 v[232:235], v22 offset:28672
    ds_read_b128 v[236:239], v22 offset:30720
    s_waitcnt vmcnt(4) lgkmcnt(4)
    v_mfma_f32_16x16x32_bf16 v[128:131], v[240:243], v[200:203], v[128:131]
    v_mfma_f32_16x16x32_bf16 v[132:135], v[244:247], v[200:203], v[132:135]
    v_mfma_f32_16x16x32_bf16 v[136:139], v[248:251], v[200:203], v[136:139]
    v_mfma_f32_16x16x32_bf16 v[140:143], v[252:255], v[200:203], v[140:143]
    v_mfma_f32_16x16x32_bf16 v[144:147], v[240:243], v[204:207], v[144:147]
    v_mfma_f32_16x16x32_bf16 v[148:151], v[244:247], v[204:207], v[148:151]
    v_mfma_f32_16x16x32_bf16 v[152:155], v[248:251], v[204:207], v[152:155]
    v_mfma_f32_16x16x32_bf16 v[156:159], v[252:255], v[204:207], v[156:159]
    ds_read_b128 v[240:243], v23 offset:24576
    ds_read_b128 v[244:247], v23 offset:26624
    ds_read_b128 v[248:251], v23 offset:28672
    ds_read_b128 v[252:255], v23 offset:30720
    s_waitcnt vmcnt(2) lgkmcnt(4)
    v_mfma_f32_16x16x32_bf16 v[128:131], v[224:227], v[208:211], v[128:131]
    v_mfma_f32_16x16x32_bf16 v[132:135], v[228:231], v[208:211], v[132:135]
    v_mfma_f32_16x16x32_bf16 v[136:139], v[232:235], v[208:211], v[136:139]
    v_mfma_f32_16x16x32_bf16 v[140:143], v[236:239], v[208:211], v[140:143]
    v_mfma_f32_16x16x32_bf16 v[144:147], v[224:227], v[212:215], v[144:147]
    v_mfma_f32_16x16x32_bf16 v[148:151], v[228:231], v[212:215], v[148:151]
    v_mfma_f32_16x16x32_bf16 v[152:155], v[232:235], v[212:215], v[152:155]
    v_mfma_f32_16x16x32_bf16 v[156:159], v[236:239], v[212:215], v[156:159]
    s_waitcnt vmcnt(0) lgkmcnt(0)
    v_mfma_f32_16x16x32_bf16 v[128:131], v[240:243], v[216:219], v[128:131]
    v_mfma_f32_16x16x32_bf16 v[132:135], v[244:247], v[216:219], v[132:135]
    v_mfma_f32_16x16x32_bf16 v[136:139], v[248:251], v[216:219], v[136:139]
    v_mfma_f32_16x16x32_bf16 v[140:143], v[252:255], v[216:219], v[140:143]
    v_mfma_f32_16x16x32_bf16 v[144:147], v[240:243], v[220:223], v[144:147]
    v_mfma_f32_16x16x32_bf16 v[148:151], v[244:247], v[220:223], v[148:151]
    v_mfma_f32_16x16x32_bf16 v[152:155], v[248:251], v[220:223], v[152:155]
    v_mfma_f32_16x16x32_bf16 v[156:159], v[252:255], v[220:223], v[156:159]
    s_nop 3
    ds_write_b128 v44, v[128:131] offset:0
    ds_write_b128 v44, v[132:135] offset:64
    ds_write_b128 v44, v[136:139] offset:128
    ds_write_b128 v44, v[140:143] offset:192
    ds_read_b128 v[160:163], v45 offset:0
    ds_read_b128 v[164:167], v45 offset:1088
    ds_read_b128 v[168:171], v45 offset:2176
    ds_read_b128 v[172:175], v45 offset:3264
    ds_write_b128 v44, v[144:147] offset:4352
    ds_write_b128 v44, v[148:151] offset:4416
    ds_write_b128 v44, v[152:155] offset:4480
    ds_write_b128 v44, v[156:159] offset:4544
    ds_read_b128 v[176:179], v45 offset:4352
    ds_read_b128 v[180:183], v45 offset:5440
    ds_read_b128 v[184:187], v45 offset:6528
    ds_read_b128 v[188:191], v45 offset:7616
    s_waitcnt lgkmcnt(11)
    v_pk_fma_f32 v[160:161], v[36:37], v[160:161], v[72:73] op_sel:[0,0,0] op_sel_hi:[0,1,1]
    v_pk_fma_f32 v[162:163], v[36:37], v[162:163], v[74:75] op_sel:[0,0,0] op_sel_hi:[0,1,1]
    buffer_store_dwordx4 v[160:163], v46, s[32:35], s56 offen sc1 nt
    s_add_u32 s56, s56, 16384
    s_waitcnt lgkmcnt(10)
    v_pk_fma_f32 v[164:165], v[36:37], v[164:165], v[76:77] op_sel:[1,0,0] op_sel_hi:[1,1,1]
    v_pk_fma_f32 v[166:167], v[36:37], v[166:167], v[78:79] op_sel:[1,0,0] op_sel_hi:[1,1,1]
    buffer_store_dwordx4 v[164:167], v46, s[32:35], s56 offen sc1 nt
    s_add_u32 s56, s56, 16384
    s_waitcnt lgkmcnt(9)
    v_pk_fma_f32 v[168:169], v[38:39], v[168:169], v[88:89] op_sel:[0,0,0] op_sel_hi:[0,1,1]
    v_pk_fma_f32 v[170:171], v[38:39], v[170:171], v[90:91] op_sel:[0,0,0] op_sel_hi:[0,1,1]
    buffer_store_dwordx4 v[168:171], v46, s[32:35], s56 offen sc1 nt
    s_add_u32 s56, s56, 16384
    s_waitcnt lgkmcnt(8)
    v_pk_fma_f32 v[172:173], v[38:39], v[172:173], v[92:93] op_sel:[1,0,0] op_sel_hi:[1,1,1]
    v_pk_fma_f32 v[174:175], v[38:39], v[174:175], v[94:95] op_sel:[1,0,0] op_sel_hi:[1,1,1]
    buffer_store_dwordx4 v[172:175], v46, s[32:35], s56 offen sc1 nt
    s_add_u32 s56, s56, 16384
    s_waitcnt lgkmcnt(3)
    v_pk_fma_f32 v[176:177], v[40:41], v[176:177], v[104:105] op_sel:[0,0,0] op_sel_hi:[0,1,1]
    v_pk_fma_f32 v[178:179], v[40:41], v[178:179], v[106:107] op_sel:[0,0,0] op_sel_hi:[0,1,1]
    buffer_store_dwordx4 v[176:179], v46, s[32:35], s56 offen sc1 nt
    s_add_u32 s56, s56, 16384
    s_waitcnt lgkmcnt(2)
    v_pk_fma_f32 v[180:181], v[40:41], v[180:181], v[108:109] op_sel:[1,0,0] op_sel_hi:[1,1,1]
    v_pk_fma_f32 v[182:183], v[40:41], v[182:183], v[110:111] op_sel:[1,0,0] op_sel_hi:[1,1,1]
    buffer_store_dwordx4 v[180:183], v46, s[32:35], s56 offen sc1 nt
    s_add_u32 s56, s56, 16384
    s_waitcnt lgkmcnt(1)
    v_pk_fma_f32 v[184:185], v[42:43], v[184:185], v[120:121] op_sel:[0,0,0] op_sel_hi:[0,1,1]
    v_pk_fma_f32 v[186:187], v[42:43], v[186:187], v[122:123] op_sel:[0,0,0] op_sel_hi:[0,1,1]
    buffer_store_dwordx4 v[184:187], v46, s[32:35], s56 offen sc1 nt
    s_add_u32 s56, s56, 16384
    s_waitcnt lgkmcnt(0)
    v_pk_fma_f32 v[188:189], v[42:43], v[188:189], v[124:125] op_sel:[1,0,0] op_sel_hi:[1,1,1]
    v_pk_fma_f32 v[190:191], v[42:43], v[190:191], v[126:127] op_sel:[1,0,0] op_sel_hi:[1,1,1]
    buffer_store_dwordx4 v[188:191], v46, s[32:35], s56 offen sc1 nt
    s_add_u32 s56, s56, 16384
    s_endpgm
L_code_end:
.section .rodata,"a"
.p2align 6
.amdhsa_kernel gated_mix__ssm_conv_s5__moe_arch_mod__prompt_kernel
  .amdhsa_next_free_vgpr 256
  .amdhsa_next_free_sgpr 102
  .amdhsa_accum_offset 256
  .amdhsa_group_segment_fixed_size 0
  .amdhsa_kernarg_size 144
  .amdhsa_user_sgpr_count 2
  .amdhsa_user_sgpr_kernarg_segment_ptr 1
  .amdhsa_system_sgpr_workgroup_id_x 1
  .amdhsa_float_denorm_mode_32 3
.end_amdhsa_kernel
```

```asm
; @launch grid=(256,1,1) block=(512,1,1) lds=163840
.amdgcn_target "amdgcn-amd-amdhsa--gfx950"
.text
.globl gated_mix__ssm_conv_s5__moe_arch_mod__prompt_kernel
.p2align 8
.type gated_mix__ssm_conv_s5__moe_arch_mod__prompt_kernel,@function
gated_mix__ssm_conv_s5__moe_arch_mod__prompt_kernel:
L_code_start:
    s_getpc_b64 s[32:33]
    s_load_dwordx2 s[40:41], s[0:1], 0
    s_load_dwordx16 s[64:79], s[0:1], 8
    s_load_dwordx8 s[44:51], s[0:1], 80
    s_load_dwordx4 s[80:83], s[0:1], 112
    s_load_dwordx2 s[42:43], s[0:1], 136
    v_lshrrev_b32 v1, 6, v0
    s_cmp_ge_u32 s2, 256
    s_cbranch_scc1 L_exit
    s_sub_u32 s32, s32, 4
    s_subb_u32 s33, s33, 0
    s_mov_b32 s34, L_code_end-L_code_start
    s_mov_b32 s35, 0x20000
    s_lshr_b32 s59, s2, 3
    s_lshl_b32 s59, s59, 11
    v_lshlrev_b32 v2, 2, v0
    buffer_load_dword v9, v2, s[32:35], s59 offen
    v_readfirstlane_b32 s18, v1
    s_mov_b32 s96, 1048576
    s_and_b32 s3, s2, 7
    s_lshr_b32 s39, s3, 2
    s_lshl_b32 s39, s39, 1
    s_xor_b32 s3, s3, s39
    s_lshr_b32 s38, s2, 3
    s_lshr_b32 s16, s3, 1
    s_lshl_b32 s16, s16, 2
    s_and_b32 s39, s38, 3
    s_add_u32 s16, s16, s39
    s_and_b32 s17, s3, 1
    s_lshl_b32 s17, s17, 3
    s_lshr_b32 s39, s38, 2
    s_add_u32 s17, s17, s39
    s_cmp_ge_u32 s18, 4
    s_cbranch_scc1 L_side
    v_and_b32 v26, 15, v0
    v_bfe_u32 v4, v0, 7, 1
    v_lshl_add_u32 v4, v4, 5, v26
    s_lshl_b32 s39, s17, 6
    v_add_lshl_u32 v255, s39, v4, 1
    s_waitcnt lgkmcnt(0)
    global_load_ushort v224, v255, s[64:65] offset:0
    global_load_ushort v226, v255, s[66:67] offset:0
    global_load_ushort v228, v255, s[76:77] offset:0
    global_load_ushort v225, v255, s[64:65] offset:32
    global_load_ushort v227, v255, s[66:67] offset:32
    global_load_ushort v229, v255, s[76:77] offset:32
    s_branch L_gemm
L_side:
    s_sub_u32 s18, s18, 4
    v_and_b32 v2, 63, v0
    s_lshl_b32 s19, s3, 8
    s_lshl_b32 s39, s38, 3
    s_add_u32 s19, s19, s39
    s_mov_b32 s56, 0
    s_lshl_b32 s58, s18, 12
    v_lshrrev_b32 v4, 3, v2
    v_and_b32 v5, 7, v2
    v_lshrrev_b32 v6, 4, v2
    v_xor_b32 v5, v5, v6
    v_lshlrev_b32 v5, 4, v5
    v_lshrrev_b32 v7, 1, v2
    v_and_b32 v7, 16, v7
    v_and_or_b32 v7, v2, 8, v7
    v_and_or_b32 v6, v6, 1, v7
    s_lshr_b32 s20, s18, 1
    s_and_b32 s21, s18, 1
    s_lshl_b32 s38, s20, 6
    s_lshl_b32 s39, s21, 2
    s_add_u32 s38, s38, s39
    s_lshl_b32 s39, s16, 7
    s_add_u32 s38, s38, s39
    v_add_u32 v6, s38, v6
    v_lshl_add_u32 v6, v6, 11, v5
    v_xor_b32 v7, 64, v6
    v_add_u32 v100, 3072, v6
    v_add_u32 v101, 67584, v7
    v_add_u32 v102, 5120, v6
    v_add_u32 v103, 69632, v7
    s_lshl_b32 s38, s17, 6
    s_lshl_b32 s39, s20, 5
    s_add_u32 s38, s38, s39
    v_add_u32 v6, s38, v4
    v_lshl_add_u32 v6, v6, 11, v5
    v_xor_b32 v7, 64, v6
    v_add_u32 v104, 3072, v6
    v_add_u32 v105, 18432, v7
    v_add_u32 v106, 33792, v6
    v_add_u32 v107, 49152, v7
    s_waitcnt lgkmcnt(0)
    s_sub_u32 s8, s40, 3072
    s_subb_u32 s9, s41, 0
    s_mov_b32 s10, 4197376
    s_mov_b32 s11, 0x20000
    s_add_u32 m0, s58, 0
    s_add_u32 s57, s56, 0
    s_and_b32 s57, s57, 2047
    buffer_load_dwordx4 v100, s[8:11], s57 offen offset:0  lds
    buffer_load_dwordx4 v101, s[8:11], s57 offen offset:1024  lds
    buffer_load_dwordx4 v102, s[8:11], s57 offen offset:2048  lds
    buffer_load_dwordx4 v103, s[8:11], s57 offen offset:3072  lds
    s_cmp_eq_u32 s21, 0
    s_cselect_b32 s24, s68, s70
    s_cselect_b32 s25, s69, s71
    s_sub_u32 s24, s24, 3072
    s_subb_u32 s25, s25, 0
    s_mov_b32 s26, 2100224
    s_mov_b32 s27, 0x20000
    s_add_u32 m0, s58, 16384
    s_nop 0
    buffer_load_dwordx4 v104, s[24:27], s57 offen offset:0  lds
    buffer_load_dwordx4 v105, s[24:27], s57 offen offset:1024  lds
    buffer_load_dwordx4 v106, s[24:27], s57 offen offset:2048  lds
    buffer_load_dwordx4 v107, s[24:27], s57 offen offset:3072  lds
    s_add_u32 s94, s42, 9469952
    s_addc_u32 s95, s43, 0
    s_load_dword s93, s[94:95], 0
    s_mov_b32 s12, s42
    s_mov_b32 s13, s43
    s_mov_b32 s14, 25165824
    s_mov_b32 s15, 0x20000
    s_mov_b32 s21, 0xffff0000
    v_and_b32 v11, 15, v2
    s_bfe_u32 s38, s2, 0x30003
    s_min_u32 s39, s38, 6
    s_and_b32 s36, s38, 1
    s_cmp_eq_u32 s18, 0
    s_cselect_b64 s[98:99], s[82:83], s[46:47]
    s_cselect_b64 s[100:101], s[42:43], s[48:49]
    s_cselect_b32 s39, s38, s39
    s_mov_b32 s37, s39
    s_cmp_eq_u32 s18, 2
    s_cselect_b64 s[98:99], s[50:51], s[98:99]
    s_cselect_b64 s[100:101], s[42:43], s[100:101]
    s_cselect_b32 s38, 8, 0
    s_add_u32 s37, s37, s38
    s_cmp_eq_u32 s18, 3
    s_cselect_b64 s[98:99], s[72:73], s[98:99]
    s_cselect_b64 s[100:101], s[74:75], s[100:101]
    s_cselect_b32 s39, s36, s39
    s_cselect_b32 s37, s36, s37
    s_lshl_b32 s39, s39, 20
    s_lshl_b32 s37, s37, 20
    s_load_dword s97, s[98:99], s39
    s_load_dword s97, s[100:101], s37
    s_add_u32 m0, s58, 32768
    s_add_u32 s57, s56, 128
    s_and_b32 s57, s57, 2047
    buffer_load_dwordx4 v100, s[8:11], s57 offen offset:0  lds
    buffer_load_dwordx4 v101, s[8:11], s57 offen offset:1024  lds
    buffer_load_dwordx4 v102, s[8:11], s57 offen offset:2048  lds
    buffer_load_dwordx4 v103, s[8:11], s57 offen offset:3072  lds
    s_add_u32 m0, s58, 49152
    s_nop 0
    buffer_load_dwordx4 v104, s[24:27], s57 offen offset:0  lds
    buffer_load_dwordx4 v105, s[24:27], s57 offen offset:1024  lds
    buffer_load_dwordx4 v106, s[24:27], s57 offen offset:2048  lds
    buffer_load_dwordx4 v107, s[24:27], s57 offen offset:3072  lds
    v_lshlrev_b32 v3, 4, v2
    s_mul_hi_u32 s23, s2, 76695845
    s_mul_i32 s38, s23, 56
    s_sub_u32 s22, s2, s38
    v_lshrrev_b32 v5, 3, v2
    v_and_b32 v8, 7, v2
    v_and_b32 v12, 3, v5
    v_lshlrev_b32 v12, 1, v12
    v_xor_b32 v8, v8, v12
    v_mul_u32_u24 v4, 7168, v5
    v_lshl_add_u32 v4, v8, 4, v4
    s_lshl_b32 s38, s18, 6
    s_lshl_b32 s39, s23, 8
    s_add_u32 s44, s38, s39
    s_mul_i32 s45, s44, 7168
    s_lshl_b32 s39, s22, 7
    s_add_u32 s45, s45, s39
    s_lshl_b32 s92, s18, 14
    s_add_u32 s92, s92, 98304
    s_mov_b32 s52, s46
    s_mov_b32 s53, s47
    s_mov_b32 s54, 7340032
    s_mov_b32 s55, 0x20000
    s_mov_b32 s28, s48
    s_mov_b32 s29, s49
    s_mov_b32 s30, 7340032
    s_mov_b32 s31, 0x20000
    s_mov_b32 s46, s92
    s_cmp_ge_u32 s2, 224
    s_cselect_b32 s54, 0, s54
    s_cselect_b32 s30, 0, s30
    s_and_b32 s39, s3, 1
    s_lshl_b32 s36, s39, 9
    s_lshr_b32 s39, s3, 1
    s_lshl_b32 s39, s39, 7
    s_add_u32 s36, s36, s39
    s_lshr_b32 s39, s2, 3
    s_lshl_b32 s39, s39, 2
    s_add_u32 s36, s36, s39
    s_add_u32 s36, s36, s18
    s_lshl_b32 s36, s36, 11
    s_add_u32 s84, s72, s36
    s_addc_u32 s85, s73, 0
    s_add_u32 s86, s74, s36
    s_addc_u32 s87, s75, 0
    s_lshr_b32 s37, s2, 3
    s_mul_i32 s37, s37, 12
    s_lshr_b32 s37, s37, 5
    s_mul_i32 s37, s37, 1
    s_add_u32 s37, s37, 0
    v_lshlrev_b32 v5, 11, v5
    v_lshl_add_u32 v5, v8, 4, v5
    s_lshl_b32 s47, s22, 17
    s_lshl_b32 s39, s23, 9
    s_add_u32 s47, s47, s39
    s_lshl_b32 s39, s18, 7
    s_add_u32 s47, s47, s39
    s_mov_b32 s4, s50
    s_mov_b32 s5, s51
    s_mov_b32 s6, 7340032
    s_mov_b32 s7, 0x20000
    s_cmp_ge_u32 s2, 224
    s_cselect_b32 s6, 0, s6
    v_lshrrev_b32 v10, 4, v2
    v_mov_b32 v23, 1
    s_mov_b32 s98, 0
    s_mov_b32 s99, 0
    s_cmp_lg_u32 s37, 0
    s_cbranch_scc1 L_s_nb0
    s_add_u32 m0, s46, 0
    s_add_u32 s39, s45, 0
    buffer_load_dwordx4 v4, s[52:55], s39 offen nt lds
    s_add_u32 m0, s46, 1024
    s_add_u32 s39, s45, 57344
    buffer_load_dwordx4 v4, s[52:55], s39 offen nt lds
    s_add_u32 m0, s46, 2048
    s_add_u32 s39, s45, 114688
    buffer_load_dwordx4 v4, s[52:55], s39 offen nt lds
    s_add_u32 m0, s46, 3072
    s_add_u32 s39, s45, 172032
    buffer_load_dwordx4 v4, s[52:55], s39 offen nt lds
    s_add_u32 m0, s46, 4096
    s_add_u32 s39, s45, 229376
    buffer_load_dwordx4 v4, s[52:55], s39 offen nt lds
    s_add_u32 m0, s46, 5120
    s_add_u32 s39, s45, 286720
    buffer_load_dwordx4 v4, s[52:55], s39 offen nt lds
    s_add_u32 m0, s46, 6144
    s_add_u32 s39, s45, 344064
    buffer_load_dwordx4 v4, s[52:55], s39 offen nt lds
    s_add_u32 m0, s46, 7168
    s_add_u32 s39, s45, 401408
    buffer_load_dwordx4 v4, s[52:55], s39 offen nt lds
    s_add_u32 m0, s46, 8192
    s_add_u32 s39, s45, 0
    buffer_load_dwordx4 v4, s[28:31], s39 offen nt lds
    s_add_u32 m0, s46, 9216
    s_add_u32 s39, s45, 57344
    buffer_load_dwordx4 v4, s[28:31], s39 offen nt lds
    s_add_u32 m0, s46, 10240
    s_add_u32 s39, s45, 114688
    buffer_load_dwordx4 v4, s[28:31], s39 offen nt lds
    s_add_u32 m0, s46, 11264
    s_add_u32 s39, s45, 172032
    buffer_load_dwordx4 v4, s[28:31], s39 offen nt lds
    s_add_u32 m0, s46, 12288
    s_add_u32 s39, s45, 229376
    buffer_load_dwordx4 v4, s[28:31], s39 offen nt lds
    s_add_u32 m0, s46, 13312
    s_add_u32 s39, s45, 286720
    buffer_load_dwordx4 v4, s[28:31], s39 offen nt lds
    s_add_u32 m0, s46, 14336
    s_add_u32 s39, s45, 344064
    buffer_load_dwordx4 v4, s[28:31], s39 offen nt lds
    s_add_u32 m0, s46, 15360
    s_add_u32 s39, s45, 401408
    buffer_load_dwordx4 v4, s[28:31], s39 offen nt lds
    s_mov_b32 s37, 13
    s_mov_b32 s99, 1
    s_mov_b32 s98, 1
    s_waitcnt vmcnt(24) lgkmcnt(0)
    s_branch L_s_b0
L_s_nb0:
    s_waitcnt vmcnt(8) lgkmcnt(0)
L_s_b0:
    s_barrier
    s_add_u32 m0, s58, 65536
    s_add_u32 s57, s56, 256
    s_and_b32 s57, s57, 2047
    buffer_load_dwordx4 v100, s[8:11], s57 offen offset:0  lds
    buffer_load_dwordx4 v101, s[8:11], s57 offen offset:1024  lds
    buffer_load_dwordx4 v102, s[8:11], s57 offen offset:2048  lds
    buffer_load_dwordx4 v103, s[8:11], s57 offen offset:3072  lds
    s_add_u32 m0, s58, 81920
    s_nop 0
    buffer_load_dwordx4 v104, s[24:27], s57 offen offset:0  lds
    buffer_load_dwordx4 v105, s[24:27], s57 offen offset:1024  lds
    buffer_load_dwordx4 v106, s[24:27], s57 offen offset:2048  lds
    buffer_load_dwordx4 v107, s[24:27], s57 offen offset:3072  lds
    s_mul_i32 s93, s93, 1664525
    s_add_u32 s93, s93, 1013904223
    s_lshl_b32 s94, s18, 12
    s_add_u32 s94, s94, 9437184
    s_mov_b32 s20, 1
    s_mov_b32 s19, s58
    s_add_u32 s92, s58, 98304
    s_add_u32 s95, s57, 128
    s_and_b32 s95, s95, 2047
    s_add_u32 s97, s37, 1
    s_min_u32 s97, s97, 14
L_s_loop:
    s_mov_b32 m0, s19
    s_mov_b32 s57, s95
    s_waitcnt vmcnt(24)
    s_sub_u32 s98, s98, 1
    s_cbranch_scc0 L_s_lw
    s_mov_b32 s98, 0
    s_waitcnt vmcnt(8)
L_s_lw:
    s_barrier
    buffer_load_dwordx4 v100, s[8:11], s57 offen offset:0 lds
    s_load_dword s36, s[84:85], 0
    s_load_dword s36, s[84:85], 64
    buffer_load_dwordx4 v101, s[8:11], s57 offen offset:1024 lds
    s_load_dword s36, s[86:87], 0
    s_load_dword s36, s[86:87], 64
    buffer_load_dwordx4 v102, s[8:11], s57 offen offset:2048 lds
    s_add_u32 s84, s84, 128
    s_addc_u32 s85, s85, 0
    s_add_u32 s86, s86, 128
    s_addc_u32 s87, s87, 0
    buffer_load_dwordx4 v103, s[8:11], s57 offen offset:3072 lds
    s_add_u32 s95, s57, 128
    s_and_b32 s95, s95, 2047
    s_add_u32 m0, m0, 16384
    s_nop 0
    buffer_load_dwordx4 v104, s[24:27], s57 offen offset:0 lds
    s_add_u32 s19, s19, 32768
    s_cmp_eq_u32 s19, s92
    s_cselect_b32 s19, s58, s19
    buffer_load_dwordx4 v105, s[24:27], s57 offen offset:1024 lds
    s_add_u32 s20, s20, 1
    buffer_load_dwordx4 v106, s[24:27], s57 offen offset:2048 lds
    s_cmp_lg_u32 s20, s97
    buffer_load_dwordx4 v107, s[24:27], s57 offen offset:3072 lds
    s_cbranch_scc1 L_s_loop
    s_cmp_eq_u32 s20, 14
    s_cbranch_scc1 L_s_loopend
    s_add_u32 m0, s46, 0
    s_add_u32 s39, s45, 0
    buffer_load_dwordx4 v4, s[52:55], s39 offen nt lds
    s_add_u32 m0, s46, 1024
    s_add_u32 s39, s45, 57344
    buffer_load_dwordx4 v4, s[52:55], s39 offen nt lds
    s_add_u32 m0, s46, 2048
    s_add_u32 s39, s45, 114688
    buffer_load_dwordx4 v4, s[52:55], s39 offen nt lds
    s_add_u32 m0, s46, 3072
    s_add_u32 s39, s45, 172032
    buffer_load_dwordx4 v4, s[52:55], s39 offen nt lds
    s_add_u32 m0, s46, 4096
    s_add_u32 s39, s45, 229376
    buffer_load_dwordx4 v4, s[52:55], s39 offen nt lds
    s_add_u32 m0, s46, 5120
    s_add_u32 s39, s45, 286720
    buffer_load_dwordx4 v4, s[52:55], s39 offen nt lds
    s_add_u32 m0, s46, 6144
    s_add_u32 s39, s45, 344064
    buffer_load_dwordx4 v4, s[52:55], s39 offen nt lds
    s_add_u32 m0, s46, 7168
    s_add_u32 s39, s45, 401408
    buffer_load_dwordx4 v4, s[52:55], s39 offen nt lds
    s_add_u32 m0, s46, 8192
    s_add_u32 s39, s45, 0
    buffer_load_dwordx4 v4, s[28:31], s39 offen nt lds
    s_add_u32 m0, s46, 9216
    s_add_u32 s39, s45, 57344
    buffer_load_dwordx4 v4, s[28:31], s39 offen nt lds
    s_add_u32 m0, s46, 10240
    s_add_u32 s39, s45, 114688
    buffer_load_dwordx4 v4, s[28:31], s39 offen nt lds
    s_add_u32 m0, s46, 11264
    s_add_u32 s39, s45, 172032
    buffer_load_dwordx4 v4, s[28:31], s39 offen nt lds
    s_add_u32 m0, s46, 12288
    s_add_u32 s39, s45, 229376
    buffer_load_dwordx4 v4, s[28:31], s39 offen nt lds
    s_add_u32 m0, s46, 13312
    s_add_u32 s39, s45, 286720
    buffer_load_dwordx4 v4, s[28:31], s39 offen nt lds
    s_add_u32 m0, s46, 14336
    s_add_u32 s39, s45, 344064
    buffer_load_dwordx4 v4, s[28:31], s39 offen nt lds
    s_add_u32 m0, s46, 15360
    s_add_u32 s39, s45, 401408
    buffer_load_dwordx4 v4, s[28:31], s39 offen nt lds
    v_lshlrev_b32 v9, 5, v2
    s_mov_b32 s98, 2
    s_mov_b32 s97, 14
    s_branch L_s_loop
L_s_loopend:
    buffer_load_dwordx4 v[80:83], v3, s[12:15], s94 offen offset:0 sc1
    buffer_load_dwordx4 v[84:87], v3, s[12:15], s94 offen offset:1024 sc1
    buffer_load_dwordx4 v[88:91], v3, s[12:15], s94 offen offset:2048 sc1
    buffer_load_dwordx4 v[92:95], v3, s[12:15], s94 offen offset:3072 sc1
    s_load_dword s36, s[84:85], 0
    s_load_dword s36, s[84:85], 64
    s_load_dword s36, s[86:87], 0
    s_load_dword s36, s[86:87], 64
    s_add_u32 s84, s84, 128
    s_addc_u32 s85, s85, 0
    s_add_u32 s86, s86, 128
    s_addc_u32 s87, s87, 0
    s_waitcnt vmcnt(12)
    s_barrier
    buffer_load_dwordx4 v[200:203], v5, s[4:7], s47 offen nt
    s_add_u32 s47, s47, 16384
    buffer_load_dwordx4 v[204:207], v5, s[4:7], s47 offen nt
    s_add_u32 s47, s47, 16384
    buffer_load_dwordx4 v[208:211], v5, s[4:7], s47 offen nt
    s_add_u32 s47, s47, 16384
    buffer_load_dwordx4 v[212:215], v5, s[4:7], s47 offen nt
    s_add_u32 s47, s47, 16384
    buffer_load_dwordx4 v[216:219], v5, s[4:7], s47 offen nt
    s_add_u32 s47, s47, 16384
    buffer_load_dwordx4 v[220:223], v5, s[4:7], s47 offen nt
    s_add_u32 s47, s47, 16384
    buffer_load_dwordx4 v[224:227], v5, s[4:7], s47 offen nt
    s_add_u32 s47, s47, 16384
    buffer_load_dwordx4 v[228:231], v5, s[4:7], s47 offen nt
    s_add_u32 s47, s47, 16384
    v_bfe_u32 v12, v2, 2, 2
    v_lshl_add_u32 v13, v10, 3, v12
    v_lshlrev_b32 v13, 7, v13
    v_and_b32 v14, 3, v2
    v_lshl_add_u32 v13, v14, 3, v13
    v_add_u32 v13, s46, v13
    v_xor_b32 v14, 0, v12
    v_lshl_add_u32 v16, v14, 5, v13
    v_xor_b32 v14, 1, v12
    v_lshl_add_u32 v17, v14, 5, v13
    v_xor_b32 v14, 2, v12
    v_lshl_add_u32 v18, v14, 5, v13
    v_xor_b32 v14, 3, v12
    v_lshl_add_u32 v19, v14, 5, v13
    s_mov_b32 s8, s40
    s_mov_b32 s9, s41
    s_mov_b32 s10, 4194304
    s_mov_b32 s11, 0x20000
    v_mov_b32 v22, 73728
    s_waitcnt vmcnt(12)
    s_barrier
    s_load_dword s36, s[84:85], 0
    s_load_dword s36, s[84:85], 64
    s_load_dword s36, s[86:87], 0
    s_load_dword s36, s[86:87], 64
    s_add_u32 s84, s84, 128
    s_addc_u32 s85, s85, 0
    s_add_u32 s86, s86, 128
    s_addc_u32 s87, s87, 0
    s_load_dword s36, s[84:85], 0
    s_load_dword s36, s[84:85], 64
    s_load_dword s36, s[86:87], 0
    s_load_dword s36, s[86:87], 64
    s_add_u32 s84, s84, 128
    s_addc_u32 s85, s85, 0
    s_add_u32 s86, s86, 128
    s_addc_u32 s87, s87, 0
    s_barrier
    v_mov_b32 v8, 0
    s_mov_b32 s95, -1
    s_waitcnt vmcnt(8)
L_s_poll:
    v_xor_b32 v81, s93, v81
    v_xor_b32 v83, s93, v83
    v_xor_b32 v85, s93, v85
    v_xor_b32 v87, s93, v87
    v_xor_b32 v89, s93, v89
    v_xor_b32 v91, s93, v91
    v_xor_b32 v93, s93, v93
    v_xor_b32 v95, s93, v95
    v_or3_b32 v9, v81, v83, v85
    v_or3_b32 v9, v9, v87, v89
    v_or3_b32 v9, v9, v91, v93
    v_or_b32 v9, v9, v95
    v_cmp_ne_u32 vcc, 0, v9
    s_nop 1
    s_cmp_eq_u64 vcc, 0
    s_cbranch_scc1 L_s_go
    s_sub_u32 s96, s96, 1
    s_cbranch_scc1 L_s_go
    buffer_load_dwordx4 v[80:83], v3, s[12:15], s94 offen offset:0 sc1
    buffer_load_dwordx4 v[84:87], v3, s[12:15], s94 offen offset:1024 sc1
    buffer_load_dwordx4 v[88:91], v3, s[12:15], s94 offen offset:2048 sc1
    buffer_load_dwordx4 v[92:95], v3, s[12:15], s94 offen offset:3072 sc1
    s_waitcnt vmcnt(0)
    s_branch L_s_poll
L_s_go:
    v_sub_u32 v72, s95, v80
    v_sub_u32 v73, s95, v82
    v_sub_u32 v74, s95, v84
    v_sub_u32 v75, s95, v86
    v_sub_u32 v76, s95, v88
    v_sub_u32 v77, s95, v90
    v_sub_u32 v78, s95, v92
    v_sub_u32 v79, s95, v94
    v_min3_u32 v9, v72, v73, v74
    v_min3_u32 v15, v75, v76, v77
    v_min3_u32 v9, v9, v78, v79
    v_min_u32 v9, v9, v15
    s_nop 1
    v_min_u32_dpp v9, v9, v9 row_ror:8 row_mask:0xf bank_mask:0xf
    s_nop 1
    v_min_u32_dpp v9, v9, v9 row_ror:4 row_mask:0xf bank_mask:0xf
    s_nop 1
    v_min_u32_dpp v9, v9, v9 row_ror:2 row_mask:0xf bank_mask:0xf
    s_nop 1
    v_min_u32_dpp v9, v9, v9 row_ror:1 row_mask:0xf bank_mask:0xf
    s_nop 0
    v_readlane_b32 s48, v9, 0
    v_readlane_b32 s49, v9, 16
    v_readlane_b32 s50, v9, 32
    v_readlane_b32 s51, v9, 48
    s_nop 0
    s_min_u32 s48, s48, s49
    s_min_u32 s50, s50, s51
    s_min_u32 s48, s48, s50
    s_sub_u32 s95, s95, s48
    v_writelane_b32 v8, s95, 0
    s_sub_u32 s95, s95, 1
    v_sub_u32 v72, s95, v80
    v_sub_u32 v73, s95, v82
    v_sub_u32 v74, s95, v84
    v_sub_u32 v75, s95, v86
    v_sub_u32 v76, s95, v88
    v_sub_u32 v77, s95, v90
    v_sub_u32 v78, s95, v92
    v_sub_u32 v79, s95, v94
    v_min3_u32 v9, v72, v73, v74
    v_min3_u32 v15, v75, v76, v77
    v_min3_u32 v9, v9, v78, v79
    v_min_u32 v9, v9, v15
    s_nop 1
    v_min_u32_dpp v9, v9, v9 row_ror:8 row_mask:0xf bank_mask:0xf
    s_nop 1
    v_min_u32_dpp v9, v9, v9 row_ror:4 row_mask:0xf bank_mask:0xf
    s_nop 1
    v_min_u32_dpp v9, v9, v9 row_ror:2 row_mask:0xf bank_mask:0xf
    s_nop 1
    v_min_u32_dpp v9, v9, v9 row_ror:1 row_mask:0xf bank_mask:0xf
    s_nop 0
    v_readlane_b32 s48, v9, 0
    v_readlane_b32 s49, v9, 16
    v_readlane_b32 s50, v9, 32
    v_readlane_b32 s51, v9, 48
    s_nop 0
    s_min_u32 s48, s48, s49
    s_min_u32 s50, s50, s51
    s_min_u32 s48, s48, s50
    s_sub_u32 s95, s95, s48
    v_writelane_b32 v8, s95, 1
    s_sub_u32 s95, s95, 1
    v_sub_u32 v72, s95, v80
    v_sub_u32 v73, s95, v82
    v_sub_u32 v74, s95, v84
    v_sub_u32 v75, s95, v86
    v_sub_u32 v76, s95, v88
    v_sub_u32 v77, s95, v90
    v_sub_u32 v78, s95, v92
    v_sub_u32 v79, s95, v94
    v_min3_u32 v9, v72, v73, v74
    v_min3_u32 v15, v75, v76, v77
    v_min3_u32 v9, v9, v78, v79
    v_min_u32 v9, v9, v15
    s_nop 1
    v_min_u32_dpp v9, v9, v9 row_ror:8 row_mask:0xf bank_mask:0xf
    s_nop 1
    v_min_u32_dpp v9, v9, v9 row_ror:4 row_mask:0xf bank_mask:0xf
    s_nop 1
    v_min_u32_dpp v9, v9, v9 row_ror:2 row_mask:0xf bank_mask:0xf
    s_nop 1
    v_min_u32_dpp v9, v9, v9 row_ror:1 row_mask:0xf bank_mask:0xf
    s_nop 0
    v_readlane_b32 s48, v9, 0
    v_readlane_b32 s49, v9, 16
    v_readlane_b32 s50, v9, 32
    v_readlane_b32 s51, v9, 48
    s_nop 0
    s_min_u32 s48, s48, s49
    s_min_u32 s50, s50, s51
    s_min_u32 s48, s48, s50
    s_sub_u32 s95, s95, s48
    v_writelane_b32 v8, s95, 2
    s_sub_u32 s95, s95, 1
    v_sub_u32 v72, s95, v80
    v_sub_u32 v73, s95, v82
    v_sub_u32 v74, s95, v84
    v_sub_u32 v75, s95, v86
    v_sub_u32 v76, s95, v88
    v_sub_u32 v77, s95, v90
    v_sub_u32 v78, s95, v92
    v_sub_u32 v79, s95, v94
    v_min3_u32 v9, v72, v73, v74
    v_min3_u32 v15, v75, v76, v77
    v_min3_u32 v9, v9, v78, v79
    v_min_u32 v9, v9, v15
    s_nop 1
    v_min_u32_dpp v9, v9, v9 row_ror:8 row_mask:0xf bank_mask:0xf
    s_nop 1
    v_min_u32_dpp v9, v9, v9 row_ror:4 row_mask:0xf bank_mask:0xf
    s_nop 1
    v_min_u32_dpp v9, v9, v9 row_ror:2 row_mask:0xf bank_mask:0xf
    s_nop 1
    v_min_u32_dpp v9, v9, v9 row_ror:1 row_mask:0xf bank_mask:0xf
    s_nop 0
    v_readlane_b32 s48, v9, 0
    v_readlane_b32 s49, v9, 16
    v_readlane_b32 s50, v9, 32
    v_readlane_b32 s51, v9, 48
    s_nop 0
    s_min_u32 s48, s48, s49
    s_min_u32 s50, s50, s51
    s_min_u32 s48, s48, s50
    s_sub_u32 s95, s95, s48
    v_writelane_b32 v8, s95, 3
    s_sub_u32 s95, s95, 1
    v_sub_u32 v72, s95, v80
    v_sub_u32 v73, s95, v82
    v_sub_u32 v74, s95, v84
    v_sub_u32 v75, s95, v86
    v_sub_u32 v76, s95, v88
    v_sub_u32 v77, s95, v90
    v_sub_u32 v78, s95, v92
    v_sub_u32 v79, s95, v94
    v_min3_u32 v9, v72, v73, v74
    v_min3_u32 v15, v75, v76, v77
    v_min3_u32 v9, v9, v78, v79
    v_min_u32 v9, v9, v15
    s_nop 1
    v_min_u32_dpp v9, v9, v9 row_ror:8 row_mask:0xf bank_mask:0xf
    s_nop 1
    v_min_u32_dpp v9, v9, v9 row_ror:4 row_mask:0xf bank_mask:0xf
    s_nop 1
    v_min_u32_dpp v9, v9, v9 row_ror:2 row_mask:0xf bank_mask:0xf
    s_nop 1
    v_min_u32_dpp v9, v9, v9 row_ror:1 row_mask:0xf bank_mask:0xf
    s_nop 0
    v_readlane_b32 s48, v9, 0
    v_readlane_b32 s49, v9, 16
    v_readlane_b32 s50, v9, 32
    v_readlane_b32 s51, v9, 48
    s_nop 0
    s_min_u32 s48, s48, s49
    s_min_u32 s50, s50, s51
    s_min_u32 s48, s48, s50
    s_sub_u32 s95, s95, s48
    v_writelane_b32 v8, s95, 4
    s_sub_u32 s95, s95, 1
    v_sub_u32 v72, s95, v80
    v_sub_u32 v73, s95, v82
    v_sub_u32 v74, s95, v84
    v_sub_u32 v75, s95, v86
    v_sub_u32 v76, s95, v88
    v_sub_u32 v77, s95, v90
    v_sub_u32 v78, s95, v92
    v_sub_u32 v79, s95, v94
    v_min3_u32 v9, v72, v73, v74
    v_min3_u32 v15, v75, v76, v77
    v_min3_u32 v9, v9, v78, v79
    v_min_u32 v9, v9, v15
    s_nop 1
    v_min_u32_dpp v9, v9, v9 row_ror:8 row_mask:0xf bank_mask:0xf
    s_nop 1
    v_min_u32_dpp v9, v9, v9 row_ror:4 row_mask:0xf bank_mask:0xf
    s_nop 1
    v_min_u32_dpp v9, v9, v9 row_ror:2 row_mask:0xf bank_mask:0xf
    s_nop 1
    v_min_u32_dpp v9, v9, v9 row_ror:1 row_mask:0xf bank_mask:0xf
    s_nop 0
    v_readlane_b32 s48, v9, 0
    v_readlane_b32 s49, v9, 16
    v_readlane_b32 s50, v9, 32
    v_readlane_b32 s51, v9, 48
    s_nop 0
    s_min_u32 s48, s48, s49
    s_min_u32 s50, s50, s51
    s_min_u32 s48, s48, s50
    s_sub_u32 s95, s95, s48
    v_writelane_b32 v8, s95, 5
    s_sub_u32 s95, s95, 1
    v_sub_u32 v72, s95, v80
    v_sub_u32 v73, s95, v82
    v_sub_u32 v74, s95, v84
    v_sub_u32 v75, s95, v86
    v_sub_u32 v76, s95, v88
    v_sub_u32 v77, s95, v90
    v_sub_u32 v78, s95, v92
    v_sub_u32 v79, s95, v94
    v_min3_u32 v9, v72, v73, v74
    v_min3_u32 v15, v75, v76, v77
    v_min3_u32 v9, v9, v78, v79
    v_min_u32 v9, v9, v15
    s_nop 1
    v_min_u32_dpp v9, v9, v9 row_ror:8 row_mask:0xf bank_mask:0xf
    s_nop 1
    v_min_u32_dpp v9, v9, v9 row_ror:4 row_mask:0xf bank_mask:0xf
    s_nop 1
    v_min_u32_dpp v9, v9, v9 row_ror:2 row_mask:0xf bank_mask:0xf
    s_nop 1
    v_min_u32_dpp v9, v9, v9 row_ror:1 row_mask:0xf bank_mask:0xf
    s_nop 0
    v_readlane_b32 s48, v9, 0
    v_readlane_b32 s49, v9, 16
    v_readlane_b32 s50, v9, 32
    v_readlane_b32 s51, v9, 48
    s_nop 0
    s_min_u32 s48, s48, s49
    s_min_u32 s50, s50, s51
    s_min_u32 s48, s48, s50
    s_sub_u32 s95, s95, s48
    v_writelane_b32 v8, s95, 6
    s_sub_u32 s95, s95, 1
    v_sub_u32 v72, s95, v80
    v_sub_u32 v73, s95, v82
    v_sub_u32 v74, s95, v84
    v_sub_u32 v75, s95, v86
    v_sub_u32 v76, s95, v88
    v_sub_u32 v77, s95, v90
    v_sub_u32 v78, s95, v92
    v_sub_u32 v79, s95, v94
    v_min3_u32 v9, v72, v73, v74
    v_min3_u32 v15, v75, v76, v77
    v_min3_u32 v9, v9, v78, v79
    v_min_u32 v9, v9, v15
    s_nop 1
    v_min_u32_dpp v9, v9, v9 row_ror:8 row_mask:0xf bank_mask:0xf
    s_nop 1
    v_min_u32_dpp v9, v9, v9 row_ror:4 row_mask:0xf bank_mask:0xf
    s_nop 1
    v_min_u32_dpp v9, v9, v9 row_ror:2 row_mask:0xf bank_mask:0xf
    s_nop 1
    v_min_u32_dpp v9, v9, v9 row_ror:1 row_mask:0xf bank_mask:0xf
    s_nop 0
    v_readlane_b32 s48, v9, 0
    v_readlane_b32 s49, v9, 16
    v_readlane_b32 s50, v9, 32
    v_readlane_b32 s51, v9, 48
    s_nop 0
    s_min_u32 s48, s48, s49
    s_min_u32 s50, s50, s51
    s_min_u32 s48, s48, s50
    s_sub_u32 s95, s95, s48
    v_writelane_b32 v8, s95, 7
    s_sub_u32 s95, s95, 1
    s_lshl_b32 s38, s18, 5
    s_add_u32 s38, s38, 73856
    v_lshl_add_u32 v9, v2, 2, s38
    v_mov_b32 v15, 73856
    s_mov_b64 exec, 0xff
    ds_write_b32 v9, v8
    s_mov_b64 exec, 1
    ds_add_u32 v22, v23 offset:8
    s_mov_b64 exec, -1
L_s_cw:
    ds_read_b32 v14, v22 offset:8
    s_waitcnt lgkmcnt(0)
    v_readfirstlane_b32 s38, v14
    s_nop 1
    s_cmp_ge_u32 s38, 4
    s_cbranch_scc1 L_s_cw_ok
    s_sub_u32 s96, s96, 1
    s_cbranch_scc1 L_s_cw_ok
    s_sleep 0
    s_branch L_s_cw
L_s_cw_ok:
    v_and_b32 v9, 31, v2
    v_lshl_add_u32 v9, v9, 2, v15
    ds_read_b32 v14, v9
    ds_read_b128 v[64:67], v15 offset:0
    ds_read_b128 v[68:71], v15 offset:16
    ds_read_b128 v[72:75], v15 offset:32
    ds_read_b128 v[76:79], v15 offset:48
    ds_read_b128 v[80:83], v15 offset:64
    ds_read_b128 v[84:87], v15 offset:80
    ds_read_b128 v[88:91], v15 offset:96
    ds_read_b128 v[92:95], v15 offset:112
    v_mov_b32 v12, 0
    s_waitcnt lgkmcnt(0)
    v_cmp_gt_u32 s[48:49], v64, v14
    v_cmp_gt_u32 s[50:51], v65, v14
    s_nop 0
    v_addc_co_u32 v12, vcc, 0, v12, s[48:49]
    v_addc_co_u32 v12, vcc, 0, v12, s[50:51]
    v_cmp_gt_u32 s[48:49], v66, v14
    v_cmp_gt_u32 s[50:51], v67, v14
    s_nop 0
    v_addc_co_u32 v12, vcc, 0, v12, s[48:49]
    v_addc_co_u32 v12, vcc, 0, v12, s[50:51]
    v_cmp_gt_u32 s[48:49], v68, v14
    v_cmp_gt_u32 s[50:51], v69, v14
    s_nop 0
    v_addc_co_u32 v12, vcc, 0, v12, s[48:49]
    v_addc_co_u32 v12, vcc, 0, v12, s[50:51]
    v_cmp_gt_u32 s[48:49], v70, v14
    v_cmp_gt_u32 s[50:51], v71, v14
    s_nop 0
    v_addc_co_u32 v12, vcc, 0, v12, s[48:49]
    v_addc_co_u32 v12, vcc, 0, v12, s[50:51]
    v_cmp_gt_u32 s[48:49], v72, v14
    v_cmp_gt_u32 s[50:51], v73, v14
    s_nop 0
    v_addc_co_u32 v12, vcc, 0, v12, s[48:49]
    v_addc_co_u32 v12, vcc, 0, v12, s[50:51]
    v_cmp_gt_u32 s[48:49], v74, v14
    v_cmp_gt_u32 s[50:51], v75, v14
    s_nop 0
    v_addc_co_u32 v12, vcc, 0, v12, s[48:49]
    v_addc_co_u32 v12, vcc, 0, v12, s[50:51]
    v_cmp_gt_u32 s[48:49], v76, v14
    v_cmp_gt_u32 s[50:51], v77, v14
    s_nop 0
    v_addc_co_u32 v12, vcc, 0, v12, s[48:49]
    v_addc_co_u32 v12, vcc, 0, v12, s[50:51]
    v_cmp_gt_u32 s[48:49], v78, v14
    v_cmp_gt_u32 s[50:51], v79, v14
    s_nop 0
    v_addc_co_u32 v12, vcc, 0, v12, s[48:49]
    v_addc_co_u32 v12, vcc, 0, v12, s[50:51]
    v_cmp_gt_u32 s[48:49], v80, v14
    v_cmp_gt_u32 s[50:51], v81, v14
    s_nop 0
    v_addc_co_u32 v12, vcc, 0, v12, s[48:49]
    v_addc_co_u32 v12, vcc, 0, v12, s[50:51]
    v_cmp_gt_u32 s[48:49], v82, v14
    v_cmp_gt_u32 s[50:51], v83, v14
    s_nop 0
    v_addc_co_u32 v12, vcc, 0, v12, s[48:49]
    v_addc_co_u32 v12, vcc, 0, v12, s[50:51]
    v_cmp_gt_u32 s[48:49], v84, v14
    v_cmp_gt_u32 s[50:51], v85, v14
    s_nop 0
    v_addc_co_u32 v12, vcc, 0, v12, s[48:49]
    v_addc_co_u32 v12, vcc, 0, v12, s[50:51]
    v_cmp_gt_u32 s[48:49], v86, v14
    v_cmp_gt_u32 s[50:51], v87, v14
    s_nop 0
    v_addc_co_u32 v12, vcc, 0, v12, s[48:49]
    v_addc_co_u32 v12, vcc, 0, v12, s[50:51]
    v_cmp_gt_u32 s[48:49], v88, v14
    v_cmp_gt_u32 s[50:51], v89, v14
    s_nop 0
    v_addc_co_u32 v12, vcc, 0, v12, s[48:49]
    v_addc_co_u32 v12, vcc, 0, v12, s[50:51]
    v_cmp_gt_u32 s[48:49], v90, v14
    v_cmp_gt_u32 s[50:51], v91, v14
    s_nop 0
    v_addc_co_u32 v12, vcc, 0, v12, s[48:49]
    v_addc_co_u32 v12, vcc, 0, v12, s[50:51]
    v_cmp_gt_u32 s[48:49], v92, v14
    v_cmp_gt_u32 s[50:51], v93, v14
    s_nop 0
    v_addc_co_u32 v12, vcc, 0, v12, s[48:49]
    v_addc_co_u32 v12, vcc, 0, v12, s[50:51]
    v_cmp_gt_u32 s[48:49], v94, v14
    v_cmp_gt_u32 s[50:51], v95, v14
    s_nop 0
    v_addc_co_u32 v12, vcc, 0, v12, s[48:49]
    v_addc_co_u32 v12, vcc, 0, v12, s[50:51]
    v_lshlrev_b32 v12, 2, v12
    s_mov_b32 exec_hi, 0
    ds_permute_b32 v13, v12, v14
    s_mov_b64 exec, -1
    v_and_b32 v12, 7, v2
    v_lshlrev_b32 v12, 2, v12
    s_waitcnt lgkmcnt(0)
    ds_bpermute_b32 v8, v12, v13
    s_lshl_b32 s38, s44, 1
    s_and_b32 s38, s38, 2047
    s_waitcnt lgkmcnt(0)
    v_not_b32 v9, v8
    v_and_b32 v9, 0x7ff, v9
    v_lshlrev_b32 v9, 11, v9
    v_lshl_add_u32 v9, v10, 4, v9
    buffer_load_dwordx4 v[56:59], v9, s[8:11], s38 offen offset:0
    buffer_load_dwordx4 v[60:63], v9, s[8:11], s38 offen offset:64
    v_lshlrev_b32 v9, 2, v2
    v_add_u32 v9, 73984, v9
    s_mov_b64 exec, 0xff
    ds_write_b32 v9, v8
    s_mov_b64 exec, 1
    ds_add_u32 v22, v23 offset:32
    s_mov_b64 exec, -1
    s_or_b32 s38, s2, s18
    s_cbranch_scc1 L_s_noep
    s_mov_b64 exec, 1
    s_mov_b32 s38, 9469952
    v_mov_b32 v13, s93
    v_mov_b32 v9, 0
    buffer_store_dword v13, v9, s[12:15], s38 offen
    s_mov_b64 exec, -1
L_s_noep:
    s_cmp_ge_u32 s2, 224
    s_cbranch_scc1 L_s_cons
    s_waitcnt vmcnt(0)
    s_setprio 2
    ds_read_b64_tr_b16 v[100:101], v16 offset:0
    ds_read_b64_tr_b16 v[102:103], v16 offset:512
    ds_read_b64_tr_b16 v[104:105], v16 offset:4096
    ds_read_b64_tr_b16 v[106:107], v16 offset:4608
    ds_read_b64_tr_b16 v[108:109], v17 offset:0
    ds_read_b64_tr_b16 v[110:111], v17 offset:512
    ds_read_b64_tr_b16 v[112:113], v17 offset:4096
    ds_read_b64_tr_b16 v[114:115], v17 offset:4608
    ds_read_b64_tr_b16 v[116:117], v18 offset:0
    ds_read_b64_tr_b16 v[118:119], v18 offset:512
    ds_read_b64_tr_b16 v[120:121], v18 offset:4096
    ds_read_b64_tr_b16 v[122:123], v18 offset:4608
    ds_read_b64_tr_b16 v[124:125], v19 offset:0
    ds_read_b64_tr_b16 v[126:127], v19 offset:512
    ds_read_b64_tr_b16 v[128:129], v19 offset:4096
    ds_read_b64_tr_b16 v[130:131], v19 offset:4608
    s_waitcnt lgkmcnt(0)
    ds_read_b64_tr_b16 v[132:133], v16 offset:8192
    ds_read_b64_tr_b16 v[134:135], v16 offset:8704
    ds_read_b64_tr_b16 v[136:137], v16 offset:12288
    ds_read_b64_tr_b16 v[138:139], v16 offset:12800
    ds_read_b64_tr_b16 v[140:141], v17 offset:8192
    ds_read_b64_tr_b16 v[142:143], v17 offset:8704
    ds_read_b64_tr_b16 v[144:145], v17 offset:12288
    ds_read_b64_tr_b16 v[146:147], v17 offset:12800
    ds_read_b64_tr_b16 v[148:149], v18 offset:8192
    ds_read_b64_tr_b16 v[150:151], v18 offset:8704
    ds_read_b64_tr_b16 v[152:153], v18 offset:12288
    ds_read_b64_tr_b16 v[154:155], v18 offset:12800
    ds_read_b64_tr_b16 v[156:157], v19 offset:8192
    ds_read_b64_tr_b16 v[158:159], v19 offset:8704
    ds_read_b64_tr_b16 v[160:161], v19 offset:12288
    ds_read_b64_tr_b16 v[162:163], v19 offset:12800
    s_waitcnt lgkmcnt(0)
    v_mfma_f32_16x16x32_bf16 v[24:27], v[100:103], v[56:59], 0
    v_mfma_f32_16x16x32_bf16 v[28:31], v[108:111], v[56:59], 0
    v_mfma_f32_16x16x32_bf16 v[32:35], v[116:119], v[56:59], 0
    v_mfma_f32_16x16x32_bf16 v[36:39], v[124:127], v[56:59], 0
    v_mfma_f32_16x16x32_bf16 v[40:43], v[132:135], v[56:59], 0
    v_mfma_f32_16x16x32_bf16 v[44:47], v[140:143], v[56:59], 0
    v_mfma_f32_16x16x32_bf16 v[48:51], v[148:151], v[56:59], 0
    v_mfma_f32_16x16x32_bf16 v[52:55], v[156:159], v[56:59], 0
    v_mfma_f32_16x16x32_bf16 v[24:27], v[104:107], v[60:63], v[24:27]
    v_mfma_f32_16x16x32_bf16 v[28:31], v[112:115], v[60:63], v[28:31]
    v_mfma_f32_16x16x32_bf16 v[32:35], v[120:123], v[60:63], v[32:35]
    v_mfma_f32_16x16x32_bf16 v[36:39], v[128:131], v[60:63], v[36:39]
    v_mfma_f32_16x16x32_bf16 v[40:43], v[136:139], v[60:63], v[40:43]
    v_mfma_f32_16x16x32_bf16 v[44:47], v[144:147], v[60:63], v[44:47]
    v_mfma_f32_16x16x32_bf16 v[48:51], v[152:155], v[60:63], v[48:51]
    v_mfma_f32_16x16x32_bf16 v[52:55], v[160:163], v[60:63], v[52:55]
    v_add_u32 v13, s46, v3
    s_nop 7
    ds_write_b128 v13, v[24:27] offset:0
    ds_write_b128 v13, v[28:31] offset:1024
    ds_write_b128 v13, v[32:35] offset:2048
    ds_write_b128 v13, v[36:39] offset:3072
    ds_write_b128 v13, v[40:43] offset:4096
    ds_write_b128 v13, v[44:47] offset:5120
    ds_write_b128 v13, v[48:51] offset:6144
    ds_write_b128 v13, v[52:55] offset:7168
    s_mov_b64 exec, 1
    ds_add_u32 v22, v23 offset:0
    s_mov_b64 exec, -1
    v_and_b32 v14, 8, v2
    v_lshl_add_u32 v13, v14, 7, v3
    s_lshl_b32 s38, s18, 11
    s_add_u32 s38, s38, 98304
    v_add_u32 v13, s38, v13
    v_and_b32 v12, 7, v2
    v_mul_u32_u24 v12, 14336, v12
    v_lshl_add_u32 v12, v10, 4, v12
    v_lshl_add_u32 v12, v14, 3, v12
    s_mul_i32 s56, s23, 229376
    s_lshl_b32 s39, s22, 8
    s_add_u32 s56, s56, s39
    s_lshr_b32 s39, s18, 1
    s_mul_i32 s39, s39, 114688
    s_add_u32 s56, s56, s39
    s_and_b32 s39, s18, 1
    s_lshl_b32 s39, s39, 7
    s_add_u32 s56, s56, s39
    s_add_u32 s56, s56, 10485760
L_s_guw:
    ds_read_b32 v15, v22 offset:0
    s_waitcnt lgkmcnt(0)
    v_readfirstlane_b32 s38, v15
    s_nop 1
    s_cmp_ge_u32 s38, 4
    s_cbranch_scc1 L_s_guw_ok
    s_sub_u32 s96, s96, 1
    s_cbranch_scc1 L_s_guw_ok
    s_sleep 0
    s_branch L_s_guw
L_s_guw_ok:
    ds_read_b128 v[64:67], v13 offset:0
    ds_read_b128 v[68:71], v13 offset:16384
    ds_read_b128 v[72:75], v13 offset:32768
    ds_read_b128 v[76:79], v13 offset:49152
    s_lshl_b32 s58, s22, 10
    s_lshl_b32 s39, s23, 8
    s_add_u32 s58, s58, s39
    s_add_u32 s58, s58, 9568256
    s_waitcnt lgkmcnt(0)
    v_pk_add_f32 v[64:65], v[64:65], v[68:69]
    v_pk_add_f32 v[72:73], v[72:73], v[76:77]
    v_pk_add_f32 v[64:65], v[64:65], v[72:73]
    v_pk_add_f32 v[66:67], v[66:67], v[70:71]
    v_pk_add_f32 v[74:75], v[74:75], v[78:79]
    v_pk_add_f32 v[66:67], v[66:67], v[74:75]
    buffer_store_dwordx4 v[64:67], v12, s[12:15], s56 offen sc1
    v_mov_b32 v13, s93
    v_lshlrev_b32 v14, 2, v2
    s_waitcnt vmcnt(0)
    v_mov_b32 v15, 1
    s_mov_b64 exec, 1
    ds_add_rtn_u32 v15, v22, v15 offset:28
    s_mov_b64 exec, -1
    s_waitcnt lgkmcnt(0)
    v_readfirstlane_b32 s39, v15
    s_nop 1
    s_cmp_lg_u32 s39, 3
    s_cbranch_scc1 L_s_nogf
    s_mov_b32 exec_hi, 0
    buffer_store_dword v13, v14, s[12:15], s58 offen sc1
    s_mov_b32 exec_hi, -1
L_s_nogf:
    v_add_u32 v13, s46, v3
    ds_write_b128 v13, v[200:203] offset:8192
    ds_write_b128 v13, v[204:207] offset:9216
    ds_write_b128 v13, v[208:211] offset:10240
    ds_write_b128 v13, v[212:215] offset:11264
    ds_write_b128 v13, v[216:219] offset:12288
    ds_write_b128 v13, v[220:223] offset:13312
    ds_write_b128 v13, v[224:227] offset:14336
    ds_write_b128 v13, v[228:231] offset:15360
    s_lshl_b32 s56, s22, 10
    s_add_u32 s56, s56, 9568256
    v_and_b32 v13, 3, v2
    v_lshlrev_b32 v13, 8, v13
    v_lshrrev_b32 v6, 5, v2
    v_lshl_add_u32 v6, s18, 1, v6
    v_and_b32 v7, 1, v10
    v_lshl_add_u32 v9, v7, 3, v6
    v_mul_u32_u24 v9, 14336, v9
    v_lshl_add_u32 v9, v11, 4, v9
    s_cmp_lg_u32 s18, 0
    s_cbranch_scc1 L_s_gw
L_s_gpoll:
    s_mov_b64 exec, 0xf
    buffer_load_dword v14, v13, s[12:15], s56 offen sc1
    s_waitcnt vmcnt(0)
    v_cmp_ne_u32 vcc, s93, v14
    s_mov_b64 exec, -1
    s_nop 0
    s_cmp_eq_u64 vcc, 0
    s_cbranch_scc1 L_s_ggo
    s_sub_u32 s96, s96, 1
    s_cbranch_scc1 L_s_ggo
    s_sleep 6
    s_branch L_s_gpoll
L_s_ggo:
    s_mov_b64 exec, 1
    ds_add_u32 v22, v23 offset:68
    s_mov_b64 exec, -1
L_s_gw:
    ds_read_b32 v15, v22 offset:68
    s_waitcnt lgkmcnt(0)
    v_readfirstlane_b32 s38, v15
    s_nop 1
    s_cmp_ge_u32 s38, 1
    s_cbranch_scc1 L_s_gw_ok
    s_sub_u32 s96, s96, 1
    s_cbranch_scc1 L_s_gw_ok
    s_sleep 2
    s_branch L_s_gw
L_s_gw_ok:
    s_lshl_b32 s38, s22, 8
    s_add_u32 s38, s38, 10485760
    buffer_load_dwordx4 v[24:27], v9, s[12:15], s38 offen sc1
    s_add_u32 s38, s38, 229376
    buffer_load_dwordx4 v[28:31], v9, s[12:15], s38 offen sc1
    s_add_u32 s38, s38, 229376
    buffer_load_dwordx4 v[32:35], v9, s[12:15], s38 offen sc1
    s_add_u32 s38, s38, 229376
    buffer_load_dwordx4 v[36:39], v9, s[12:15], s38 offen sc1
    s_add_u32 s38, s38, 229376
    ds_read_b64_tr_b16 v[64:65], v16 offset:8192
    ds_read_b64_tr_b16 v[66:67], v16 offset:8704
    ds_read_b64_tr_b16 v[68:69], v16 offset:12288
    ds_read_b64_tr_b16 v[70:71], v16 offset:12800
    ds_read_b64_tr_b16 v[72:73], v17 offset:8192
    ds_read_b64_tr_b16 v[74:75], v17 offset:8704
    ds_read_b64_tr_b16 v[76:77], v17 offset:12288
    ds_read_b64_tr_b16 v[78:79], v17 offset:12800
    ds_read_b64_tr_b16 v[80:81], v18 offset:8192
    ds_read_b64_tr_b16 v[82:83], v18 offset:8704
    ds_read_b64_tr_b16 v[84:85], v18 offset:12288
    ds_read_b64_tr_b16 v[86:87], v18 offset:12800
    ds_read_b64_tr_b16 v[88:89], v19 offset:8192
    ds_read_b64_tr_b16 v[90:91], v19 offset:8704
    ds_read_b64_tr_b16 v[92:93], v19 offset:12288
    ds_read_b64_tr_b16 v[94:95], v19 offset:12800
    s_waitcnt vmcnt(0)
    v_pk_add_f32 v[24:25], v[24:25], v[28:29]
    v_pk_add_f32 v[32:33], v[32:33], v[36:37]
    v_pk_add_f32 v[24:25], v[24:25], v[32:33]
    v_pk_add_f32 v[26:27], v[26:27], v[30:31]
    v_pk_add_f32 v[34:35], v[34:35], v[38:39]
    v_pk_add_f32 v[26:27], v[26:27], v[34:35]
    v_cvt_pk_bf16_f32 v24, v24, v24
    v_lshlrev_b32 v24, 16, v24
    v_mov_b32 v28, v24
    v_cvt_pk_bf16_f32 v25, v25, v25
    v_lshlrev_b32 v25, 16, v25
    v_mov_b32 v29, v25
    v_cvt_pk_bf16_f32 v26, v26, v26
    v_lshlrev_b32 v26, 16, v26
    v_mov_b32 v30, v26
    v_cvt_pk_bf16_f32 v27, v27, v27
    v_lshlrev_b32 v27, 16, v27
    v_mov_b32 v31, v27
    s_nop 1
    v_permlane16_swap_b32 v24, v28
    v_permlane16_swap_b32 v25, v29
    v_permlane16_swap_b32 v26, v30
    v_permlane16_swap_b32 v27, v31
    s_nop 1
    v_mul_f32 v40, 0xbfb8aa3b, v24
    v_exp_f32 v40, v40
    s_nop 0
    v_add_f32 v40, 1.0, v40
    v_rcp_f32 v40, v40
    s_nop 0
    v_mul_f32 v40, v40, v24
    v_cvt_pk_bf16_f32 v40, v40, v40
    v_lshlrev_b32 v40, 16, v40
    v_mul_f32 v40, v40, v28
    v_mul_f32 v41, 0xbfb8aa3b, v25
    v_exp_f32 v41, v41
    s_nop 0
    v_add_f32 v41, 1.0, v41
    v_rcp_f32 v41, v41
    s_nop 0
    v_mul_f32 v41, v41, v25
    v_cvt_pk_bf16_f32 v41, v41, v41
    v_lshlrev_b32 v41, 16, v41
    v_mul_f32 v41, v41, v29
    v_mul_f32 v42, 0xbfb8aa3b, v26
    v_exp_f32 v42, v42
    s_nop 0
    v_add_f32 v42, 1.0, v42
    v_rcp_f32 v42, v42
    s_nop 0
    v_mul_f32 v42, v42, v26
    v_cvt_pk_bf16_f32 v42, v42, v42
    v_lshlrev_b32 v42, 16, v42
    v_mul_f32 v42, v42, v30
    v_mul_f32 v43, 0xbfb8aa3b, v27
    v_exp_f32 v43, v43
    s_nop 0
    v_add_f32 v43, 1.0, v43
    v_rcp_f32 v43, v43
    s_nop 0
    v_mul_f32 v43, v43, v27
    v_cvt_pk_bf16_f32 v43, v43, v43
    v_lshlrev_b32 v43, 16, v43
    v_mul_f32 v43, v43, v31
    v_cvt_pk_bf16_f32 v40, v40, v41
    v_cvt_pk_bf16_f32 v41, v42, v43
    v_mul_u32_u24 v9, 144, v6
    v_lshl_add_u32 v9, v11, 3, v9
    v_add_u32 v9, 74240, v9
    ds_write_b64 v9, v[40:41]
    s_mov_b64 exec, 1
    ds_add_u32 v22, v23 offset:20
    s_mov_b64 exec, -1
    v_and_b32 v9, 7, v2
    v_mul_u32_u24 v9, 144, v9
    v_lshl_add_u32 v9, v10, 4, v9
    v_add_u32 v9, 74240, v9
L_s_aw:
    ds_read_b32 v15, v22 offset:20
    s_waitcnt lgkmcnt(0)
    v_readfirstlane_b32 s38, v15
    s_nop 1
    s_cmp_ge_u32 s38, 4
    s_cbranch_scc1 L_s_aw_ok
    s_sub_u32 s96, s96, 1
    s_cbranch_scc1 L_s_aw_ok
    s_sleep 1
    s_branch L_s_aw
L_s_aw_ok:
    ds_read_b128 v[40:43], v9
    ds_read_b128 v[44:47], v9 offset:64
    s_mov_b32 s38, 229376
    v_and_b32 v15, 7, v2
    v_mul_lo_u32 v15, v15, s38
    v_lshl_add_u32 v15, v10, 4, v15
    v_and_b32 v14, 8, v2
    v_lshl_add_u32 v15, v14, 3, v15
    s_lshl_b32 s38, s22, 12
    s_lshl_b32 s39, s23, 10
    s_add_u32 s38, s38, s39
    s_lshl_b32 s39, s18, 8
    s_add_u32 s38, s38, s39
    s_add_u32 s38, s38, 13631488
    v_cmp_eq_u32 vcc, 8, v14
    s_waitcnt lgkmcnt(0)
    v_mfma_f32_16x16x32_bf16 v[48:51], v[64:67], v[40:43], 0
    v_mfma_f32_16x16x32_bf16 v[52:55], v[72:75], v[40:43], 0
    v_mfma_f32_16x16x32_bf16 v[56:59], v[80:83], v[40:43], 0
    v_mfma_f32_16x16x32_bf16 v[60:63], v[88:91], v[40:43], 0
    v_mfma_f32_16x16x32_bf16 v[48:51], v[68:71], v[44:47], v[48:51]
    v_mfma_f32_16x16x32_bf16 v[52:55], v[76:79], v[44:47], v[52:55]
    v_mfma_f32_16x16x32_bf16 v[56:59], v[84:87], v[44:47], v[56:59]
    v_mfma_f32_16x16x32_bf16 v[60:63], v[92:95], v[44:47], v[60:63]
    s_nop 7
    v_cndmask_b32 v48, v48, v52, vcc
    v_cndmask_b32 v49, v49, v53, vcc
    v_cndmask_b32 v50, v50, v54, vcc
    v_cndmask_b32 v51, v51, v55, vcc
    buffer_store_dwordx4 v[48:51], v15, s[12:15], s38 offen offset:0 sc1
    v_cndmask_b32 v56, v56, v60, vcc
    v_cndmask_b32 v57, v57, v61, vcc
    v_cndmask_b32 v58, v58, v62, vcc
    v_cndmask_b32 v59, v59, v63, vcc
    buffer_store_dwordx4 v[56:59], v15, s[12:15], s38 offen offset:128 sc1
    s_lshl_b32 s58, s23, 14
    s_lshl_b32 s39, s22, 8
    s_add_u32 s58, s58, s39
    s_add_u32 s58, s58, 9633792
    v_mov_b32 v13, s93
    v_lshlrev_b32 v14, 2, v2
    s_waitcnt vmcnt(0)
    v_mov_b32 v15, 1
    s_mov_b64 exec, 1
    ds_add_rtn_u32 v15, v22, v15 offset:24
    s_mov_b64 exec, -1
    s_waitcnt lgkmcnt(0)
    v_readfirstlane_b32 s39, v15
    s_nop 1
    s_cmp_lg_u32 s39, 3
    s_cbranch_scc1 L_s_cons
    s_mov_b32 exec_hi, 0
    buffer_store_dword v13, v14, s[12:15], s58 offen sc1
    s_mov_b32 exec_hi, -1
L_s_cons:
    s_add_u32 s38, s18, 4
    v_readlane_b32 s24, v8, s18
    v_readlane_b32 s25, v8, s38
    s_lshl_b32 s45, s16, 7
    s_and_b32 s26, s24, 0x7ff
    s_sub_u32 s26, 2047, s26
    s_sub_u32 s56, s26, s45
    s_and_b32 s27, s25, 0x7ff
    s_sub_u32 s27, 2047, s27
    s_sub_u32 s57, s27, s45
    s_waitcnt lgkmcnt(0)
    s_min_u32 s38, s56, s57
    s_cmp_ge_u32 s38, 128
    s_cbranch_scc1 L_s_end
L_s_pw:
    ds_read_b32 v15, v22 offset:16
    s_waitcnt lgkmcnt(0)
    v_readfirstlane_b32 s38, v15
    s_nop 1
    s_cmp_ge_u32 s38, 28
    s_cbranch_scc1 L_s_pw_ok
    s_sub_u32 s96, s96, 1
    s_cbranch_scc1 L_s_pw_ok
    s_sleep 8
    s_branch L_s_pw
L_s_pw_ok:
    s_lshr_b32 s58, s17, 2
    s_lshl_b32 s58, s58, 14
    s_add_u32 s58, s58, 9633792
    v_min_u32 v4, 55, v2
    v_lshlrev_b32 v4, 8, v4
    v_lshlrev_b32 v6, 12, v10
    v_lshl_add_u32 v6, v11, 4, v6
    v_lshlrev_b32 v9, 3, v11
    v_mov_b32 v7, 0
L_s_ypoll:
    buffer_load_dword v5, v4, s[12:15], s58 offen sc1
    s_waitcnt vmcnt(0)
    v_cmp_ne_u32 vcc, s93, v5
    s_nop 1
    s_cmp_eq_u64 vcc, 0
    s_cbranch_scc1 L_s_ygo
    s_sub_u32 s96, s96, 1
    s_cbranch_scc1 L_s_ygo
    s_sleep 6
    s_branch L_s_ypoll
L_s_ygo:
    s_cmp_ge_u32 s56, 128
    s_cbranch_scc1 L_s_sk0
    s_add_u32 s39, s18, 0
    s_mul_i32 s39, s39, 229376
    s_lshl_b32 s3, s17, 8
    s_add_u32 s39, s39, s3
    s_add_u32 s39, s39, 13631488
    buffer_load_dwordx4 v[24:27], v6, s[12:15], s39 offen sc1
    s_add_u32 s39, s39, 16384
    buffer_load_dwordx4 v[28:31], v6, s[12:15], s39 offen sc1
    s_add_u32 s39, s39, 16384
    buffer_load_dwordx4 v[32:35], v6, s[12:15], s39 offen sc1
    s_add_u32 s39, s39, 16384
    buffer_load_dwordx4 v[36:39], v6, s[12:15], s39 offen sc1
    s_add_u32 s39, s39, 16384
    buffer_load_dwordx4 v[40:43], v6, s[12:15], s39 offen sc1
    s_add_u32 s39, s39, 16384
    buffer_load_dwordx4 v[44:47], v6, s[12:15], s39 offen sc1
    s_add_u32 s39, s39, 16384
    buffer_load_dwordx4 v[48:51], v6, s[12:15], s39 offen sc1
    s_add_u32 s39, s39, 16384
    buffer_load_dwordx4 v[52:55], v6, s[12:15], s39 offen sc1
    s_add_u32 s39, s39, 16384
    buffer_load_dwordx4 v[56:59], v6, s[12:15], s39 offen sc1
    s_add_u32 s39, s39, 16384
    buffer_load_dwordx4 v[60:63], v6, s[12:15], s39 offen sc1
    s_add_u32 s39, s39, 16384
    buffer_load_dwordx4 v[64:67], v6, s[12:15], s39 offen sc1
    s_add_u32 s39, s39, 16384
    buffer_load_dwordx4 v[68:71], v6, s[12:15], s39 offen sc1
    s_add_u32 s39, s39, 16384
    buffer_load_dwordx4 v[72:75], v6, s[12:15], s39 offen sc1
    s_add_u32 s39, s39, 16384
    buffer_load_dwordx4 v[76:79], v6, s[12:15], s39 offen sc1
    s_add_u32 s39, s39, 16384
    s_lshl_b32 s39, s26, 11
    s_lshl_b32 s3, s17, 7
    s_add_u32 s39, s39, s3
    buffer_load_dwordx2 v[80:81], v9, s[8:11], s39 offen
    s_lshl_b32 s39, s26, 3
    s_add_u32 s39, s39, 9453568
    buffer_load_dword v82, v7, s[12:15], s39 offen sc1
L_s_sk0:
    s_cmp_ge_u32 s57, 128
    s_cbranch_scc1 L_s_sk1
    s_add_u32 s39, s18, 4
    s_mul_i32 s39, s39, 229376
    s_lshl_b32 s3, s17, 8
    s_add_u32 s39, s39, s3
    s_add_u32 s39, s39, 13631488
    buffer_load_dwordx4 v[88:91], v6, s[12:15], s39 offen sc1
    s_add_u32 s39, s39, 16384
    buffer_load_dwordx4 v[92:95], v6, s[12:15], s39 offen sc1
    s_add_u32 s39, s39, 16384
    buffer_load_dwordx4 v[96:99], v6, s[12:15], s39 offen sc1
    s_add_u32 s39, s39, 16384
    buffer_load_dwordx4 v[100:103], v6, s[12:15], s39 offen sc1
    s_add_u32 s39, s39, 16384
    buffer_load_dwordx4 v[104:107], v6, s[12:15], s39 offen sc1
    s_add_u32 s39, s39, 16384
    buffer_load_dwordx4 v[108:111], v6, s[12:15], s39 offen sc1
    s_add_u32 s39, s39, 16384
    buffer_load_dwordx4 v[112:115], v6, s[12:15], s39 offen sc1
    s_add_u32 s39, s39, 16384
    buffer_load_dwordx4 v[116:119], v6, s[12:15], s39 offen sc1
    s_add_u32 s39, s39, 16384
    buffer_load_dwordx4 v[120:123], v6, s[12:15], s39 offen sc1
    s_add_u32 s39, s39, 16384
    buffer_load_dwordx4 v[124:127], v6, s[12:15], s39 offen sc1
    s_add_u32 s39, s39, 16384
    buffer_load_dwordx4 v[128:131], v6, s[12:15], s39 offen sc1
    s_add_u32 s39, s39, 16384
    buffer_load_dwordx4 v[132:135], v6, s[12:15], s39 offen sc1
    s_add_u32 s39, s39, 16384
    buffer_load_dwordx4 v[136:139], v6, s[12:15], s39 offen sc1
    s_add_u32 s39, s39, 16384
    buffer_load_dwordx4 v[140:143], v6, s[12:15], s39 offen sc1
    s_add_u32 s39, s39, 16384
    s_lshl_b32 s39, s27, 11
    s_lshl_b32 s3, s17, 7
    s_add_u32 s39, s39, s3
    buffer_load_dwordx2 v[144:145], v9, s[8:11], s39 offen
    s_lshl_b32 s39, s27, 3
    s_add_u32 s39, s39, 9453568
    buffer_load_dword v146, v7, s[12:15], s39 offen sc1
L_s_sk1:
    s_waitcnt vmcnt(0)
    s_cmp_ge_u32 s56, 128
    s_cbranch_scc1 L_s_sc0
    s_ashr_i32 s39, s24, 31
    s_not_b32 s39, s39
    s_or_b32 s39, s39, 0x80000000
    s_xor_b32 s39, s24, s39
    s_and_b32 s39, s39, 0xffff0000
    v_mov_b32 v86, s39
    v_mul_f32 v83, 0xbfb8aa3b, v86
    v_exp_f32 v83, v83
    s_nop 0
    v_add_f32 v83, 1.0, v83
    v_rcp_f32 v83, v83
    s_nop 0
    v_cvt_pk_bf16_f32 v83, v83, v83
    v_lshlrev_b32 v83, 16, v83
    v_pk_add_f32 v[24:25], v[24:25], v[28:29]
    v_pk_add_f32 v[26:27], v[26:27], v[30:31]
    v_pk_add_f32 v[24:25], v[24:25], v[32:33]
    v_pk_add_f32 v[26:27], v[26:27], v[34:35]
    v_pk_add_f32 v[24:25], v[24:25], v[36:37]
    v_pk_add_f32 v[26:27], v[26:27], v[38:39]
    v_pk_add_f32 v[24:25], v[24:25], v[40:41]
    v_pk_add_f32 v[26:27], v[26:27], v[42:43]
    v_pk_add_f32 v[24:25], v[24:25], v[44:45]
    v_pk_add_f32 v[26:27], v[26:27], v[46:47]
    v_pk_add_f32 v[24:25], v[24:25], v[48:49]
    v_pk_add_f32 v[26:27], v[26:27], v[50:51]
    v_pk_add_f32 v[24:25], v[24:25], v[52:53]
    v_pk_add_f32 v[26:27], v[26:27], v[54:55]
    v_pk_add_f32 v[24:25], v[24:25], v[56:57]
    v_pk_add_f32 v[26:27], v[26:27], v[58:59]
    v_pk_add_f32 v[24:25], v[24:25], v[60:61]
    v_pk_add_f32 v[26:27], v[26:27], v[62:63]
    v_pk_add_f32 v[24:25], v[24:25], v[64:65]
    v_pk_add_f32 v[26:27], v[26:27], v[66:67]
    v_pk_add_f32 v[24:25], v[24:25], v[68:69]
    v_pk_add_f32 v[26:27], v[26:27], v[70:71]
    v_pk_add_f32 v[24:25], v[24:25], v[72:73]
    v_pk_add_f32 v[26:27], v[26:27], v[74:75]
    v_pk_add_f32 v[24:25], v[24:25], v[76:77]
    v_pk_add_f32 v[26:27], v[26:27], v[78:79]
    v_mov_b32 v28, v24
    v_mov_b32 v29, v25
    v_mov_b32 v30, v26
    v_mov_b32 v31, v27
    s_nop 1
    v_permlane16_swap_b32 v24, v28
    v_permlane16_swap_b32 v25, v29
    v_permlane16_swap_b32 v26, v30
    v_permlane16_swap_b32 v27, v31
    s_nop 1
    v_add_f32 v24, v24, v28
    v_add_f32 v25, v25, v29
    v_add_f32 v26, v26, v30
    v_add_f32 v27, v27, v31
    v_mov_b32 v28, v24
    v_mov_b32 v29, v25
    v_mov_b32 v30, v26
    v_mov_b32 v31, v27
    s_nop 1
    v_permlane32_swap_b32 v24, v28
    v_permlane32_swap_b32 v25, v29
    v_permlane32_swap_b32 v26, v30
    v_permlane32_swap_b32 v27, v31
    s_nop 1
    v_add_f32 v24, v24, v28
    v_add_f32 v25, v25, v29
    v_add_f32 v26, v26, v30
    v_add_f32 v27, v27, v31
    v_sub_f32 v82, 1.0, v82
    v_cvt_pk_bf16_f32 v82, v82, v82
    v_lshlrev_b32 v82, 16, v82
    v_lshlrev_b32 v32, 16, v80
    v_and_b32 v33, s21, v80
    v_lshlrev_b32 v34, 16, v81
    v_and_b32 v35, s21, v81
    v_cvt_pk_bf16_f32 v24, v24, v24
    v_lshlrev_b32 v24, 16, v24
    v_mul_f32 v24, v24, v83
    v_cvt_pk_bf16_f32 v24, v24, v24
    v_lshlrev_b32 v24, 16, v24
    v_add_f32 v24, v24, v32
    v_cvt_pk_bf16_f32 v24, v24, v24
    v_lshlrev_b32 v24, 16, v24
    v_mul_f32 v24, v24, v82
    v_cvt_pk_bf16_f32 v24, v24, v24
    v_lshlrev_b32 v24, 16, v24
    v_mul_f32 v32, v32, v82
    v_cvt_pk_bf16_f32 v32, v32, v32
    v_lshlrev_b32 v32, 16, v32
    v_sub_f32 v24, v24, v32
    v_cvt_pk_bf16_f32 v25, v25, v25
    v_lshlrev_b32 v25, 16, v25
    v_mul_f32 v25, v25, v83
    v_cvt_pk_bf16_f32 v25, v25, v25
    v_lshlrev_b32 v25, 16, v25
    v_add_f32 v25, v25, v33
    v_cvt_pk_bf16_f32 v25, v25, v25
    v_lshlrev_b32 v25, 16, v25
    v_mul_f32 v25, v25, v82
    v_cvt_pk_bf16_f32 v25, v25, v25
    v_lshlrev_b32 v25, 16, v25
    v_mul_f32 v33, v33, v82
    v_cvt_pk_bf16_f32 v33, v33, v33
    v_lshlrev_b32 v33, 16, v33
    v_sub_f32 v25, v25, v33
    v_cvt_pk_bf16_f32 v26, v26, v26
    v_lshlrev_b32 v26, 16, v26
    v_mul_f32 v26, v26, v83
    v_cvt_pk_bf16_f32 v26, v26, v26
    v_lshlrev_b32 v26, 16, v26
    v_add_f32 v26, v26, v34
    v_cvt_pk_bf16_f32 v26, v26, v26
    v_lshlrev_b32 v26, 16, v26
    v_mul_f32 v26, v26, v82
    v_cvt_pk_bf16_f32 v26, v26, v26
    v_lshlrev_b32 v26, 16, v26
    v_mul_f32 v34, v34, v82
    v_cvt_pk_bf16_f32 v34, v34, v34
    v_lshlrev_b32 v34, 16, v34
    v_sub_f32 v26, v26, v34
    v_cvt_pk_bf16_f32 v27, v27, v27
    v_lshlrev_b32 v27, 16, v27
    v_mul_f32 v27, v27, v83
    v_cvt_pk_bf16_f32 v27, v27, v27
    v_lshlrev_b32 v27, 16, v27
    v_add_f32 v27, v27, v35
    v_cvt_pk_bf16_f32 v27, v27, v27
    v_lshlrev_b32 v27, 16, v27
    v_mul_f32 v27, v27, v82
    v_cvt_pk_bf16_f32 v27, v27, v27
    v_lshlrev_b32 v27, 16, v27
    v_mul_f32 v35, v35, v82
    v_cvt_pk_bf16_f32 v35, v35, v35
    v_lshlrev_b32 v35, 16, v35
    v_sub_f32 v27, v27, v35
    s_lshl_b32 s39, s18, 8
    s_add_u32 s39, s39, 75776
    v_lshl_add_u32 v84, v11, 4, s39
    ds_write_b128 v84, v[24:27]
    v_lshl_add_u32 v85, s18, 2, v22
    s_mov_b64 exec, 1
    ds_add_u32 v85, v23 offset:36
    s_mov_b64 exec, -1
L_s_sc0:
    s_cmp_ge_u32 s57, 128
    s_cbranch_scc1 L_s_sc1
    s_ashr_i32 s39, s25, 31
    s_not_b32 s39, s39
    s_or_b32 s39, s39, 0x80000000
    s_xor_b32 s39, s25, s39
    s_and_b32 s39, s39, 0xffff0000
    v_mov_b32 v150, s39
    v_mul_f32 v147, 0xbfb8aa3b, v150
    v_exp_f32 v147, v147
    s_nop 0
    v_add_f32 v147, 1.0, v147
    v_rcp_f32 v147, v147
    s_nop 0
    v_cvt_pk_bf16_f32 v147, v147, v147
    v_lshlrev_b32 v147, 16, v147
    v_pk_add_f32 v[88:89], v[88:89], v[92:93]
    v_pk_add_f32 v[90:91], v[90:91], v[94:95]
    v_pk_add_f32 v[88:89], v[88:89], v[96:97]
    v_pk_add_f32 v[90:91], v[90:91], v[98:99]
    v_pk_add_f32 v[88:89], v[88:89], v[100:101]
    v_pk_add_f32 v[90:91], v[90:91], v[102:103]
    v_pk_add_f32 v[88:89], v[88:89], v[104:105]
    v_pk_add_f32 v[90:91], v[90:91], v[106:107]
    v_pk_add_f32 v[88:89], v[88:89], v[108:109]
    v_pk_add_f32 v[90:91], v[90:91], v[110:111]
    v_pk_add_f32 v[88:89], v[88:89], v[112:113]
    v_pk_add_f32 v[90:91], v[90:91], v[114:115]
    v_pk_add_f32 v[88:89], v[88:89], v[116:117]
    v_pk_add_f32 v[90:91], v[90:91], v[118:119]
    v_pk_add_f32 v[88:89], v[88:89], v[120:121]
    v_pk_add_f32 v[90:91], v[90:91], v[122:123]
    v_pk_add_f32 v[88:89], v[88:89], v[124:125]
    v_pk_add_f32 v[90:91], v[90:91], v[126:127]
    v_pk_add_f32 v[88:89], v[88:89], v[128:129]
    v_pk_add_f32 v[90:91], v[90:91], v[130:131]
    v_pk_add_f32 v[88:89], v[88:89], v[132:133]
    v_pk_add_f32 v[90:91], v[90:91], v[134:135]
    v_pk_add_f32 v[88:89], v[88:89], v[136:137]
    v_pk_add_f32 v[90:91], v[90:91], v[138:139]
    v_pk_add_f32 v[88:89], v[88:89], v[140:141]
    v_pk_add_f32 v[90:91], v[90:91], v[142:143]
    v_mov_b32 v92, v88
    v_mov_b32 v93, v89
    v_mov_b32 v94, v90
    v_mov_b32 v95, v91
    s_nop 1
    v_permlane16_swap_b32 v88, v92
    v_permlane16_swap_b32 v89, v93
    v_permlane16_swap_b32 v90, v94
    v_permlane16_swap_b32 v91, v95
    s_nop 1
    v_add_f32 v88, v88, v92
    v_add_f32 v89, v89, v93
    v_add_f32 v90, v90, v94
    v_add_f32 v91, v91, v95
    v_mov_b32 v92, v88
    v_mov_b32 v93, v89
    v_mov_b32 v94, v90
    v_mov_b32 v95, v91
    s_nop 1
    v_permlane32_swap_b32 v88, v92
    v_permlane32_swap_b32 v89, v93
    v_permlane32_swap_b32 v90, v94
    v_permlane32_swap_b32 v91, v95
    s_nop 1
    v_add_f32 v88, v88, v92
    v_add_f32 v89, v89, v93
    v_add_f32 v90, v90, v94
    v_add_f32 v91, v91, v95
    v_sub_f32 v146, 1.0, v146
    v_cvt_pk_bf16_f32 v146, v146, v146
    v_lshlrev_b32 v146, 16, v146
    v_lshlrev_b32 v96, 16, v144
    v_and_b32 v97, s21, v144
    v_lshlrev_b32 v98, 16, v145
    v_and_b32 v99, s21, v145
    v_cvt_pk_bf16_f32 v88, v88, v88
    v_lshlrev_b32 v88, 16, v88
    v_mul_f32 v88, v88, v147
    v_cvt_pk_bf16_f32 v88, v88, v88
    v_lshlrev_b32 v88, 16, v88
    v_add_f32 v88, v88, v96
    v_cvt_pk_bf16_f32 v88, v88, v88
    v_lshlrev_b32 v88, 16, v88
    v_mul_f32 v88, v88, v146
    v_cvt_pk_bf16_f32 v88, v88, v88
    v_lshlrev_b32 v88, 16, v88
    v_mul_f32 v96, v96, v146
    v_cvt_pk_bf16_f32 v96, v96, v96
    v_lshlrev_b32 v96, 16, v96
    v_sub_f32 v88, v88, v96
    v_cvt_pk_bf16_f32 v89, v89, v89
    v_lshlrev_b32 v89, 16, v89
    v_mul_f32 v89, v89, v147
    v_cvt_pk_bf16_f32 v89, v89, v89
    v_lshlrev_b32 v89, 16, v89
    v_add_f32 v89, v89, v97
    v_cvt_pk_bf16_f32 v89, v89, v89
    v_lshlrev_b32 v89, 16, v89
    v_mul_f32 v89, v89, v146
    v_cvt_pk_bf16_f32 v89, v89, v89
    v_lshlrev_b32 v89, 16, v89
    v_mul_f32 v97, v97, v146
    v_cvt_pk_bf16_f32 v97, v97, v97
    v_lshlrev_b32 v97, 16, v97
    v_sub_f32 v89, v89, v97
    v_cvt_pk_bf16_f32 v90, v90, v90
    v_lshlrev_b32 v90, 16, v90
    v_mul_f32 v90, v90, v147
    v_cvt_pk_bf16_f32 v90, v90, v90
    v_lshlrev_b32 v90, 16, v90
    v_add_f32 v90, v90, v98
    v_cvt_pk_bf16_f32 v90, v90, v90
    v_lshlrev_b32 v90, 16, v90
    v_mul_f32 v90, v90, v146
    v_cvt_pk_bf16_f32 v90, v90, v90
    v_lshlrev_b32 v90, 16, v90
    v_mul_f32 v98, v98, v146
    v_cvt_pk_bf16_f32 v98, v98, v98
    v_lshlrev_b32 v98, 16, v98
    v_sub_f32 v90, v90, v98
    v_cvt_pk_bf16_f32 v91, v91, v91
    v_lshlrev_b32 v91, 16, v91
    v_mul_f32 v91, v91, v147
    v_cvt_pk_bf16_f32 v91, v91, v91
    v_lshlrev_b32 v91, 16, v91
    v_add_f32 v91, v91, v99
    v_cvt_pk_bf16_f32 v91, v91, v91
    v_lshlrev_b32 v91, 16, v91
    v_mul_f32 v91, v91, v146
    v_cvt_pk_bf16_f32 v91, v91, v91
    v_lshlrev_b32 v91, 16, v91
    v_mul_f32 v99, v99, v146
    v_cvt_pk_bf16_f32 v99, v99, v99
    v_lshlrev_b32 v99, 16, v99
    v_sub_f32 v91, v91, v99
    s_lshl_b32 s39, s18, 8
    s_add_u32 s39, s39, 76800
    v_lshl_add_u32 v148, v11, 4, s39
    ds_write_b128 v148, v[88:91]
    v_lshl_add_u32 v149, s18, 2, v22
    s_mov_b64 exec, 1
    ds_add_u32 v149, v23 offset:52
    s_mov_b64 exec, -1
L_s_sc1:
L_s_end:
    s_endpgm
L_exit:
    s_endpgm
L_gemm:
    s_add_u32 s94, s42, 9469952
    s_addc_u32 s95, s43, 0
    s_load_dword s93, s[94:95], 0
    s_lshr_b32 s20, s18, 1
    s_lshl_b32 s50, s3, 8
    s_lshl_b32 s39, s38, 3
    s_add_u32 s50, s50, s39
    s_lshl_b32 s50, s50, 11
    s_lshl_b32 s51, s18, 9
    s_add_u32 s50, s50, s51
    s_lshl_b32 s39, s18, 13
    s_add_u32 m0, s39, 65536
    v_and_b32 v4, 31, v0
    v_lshlrev_b32 v4, 4, v4
    v_bfe_u32 v5, v0, 5, 1
    v_lshl_add_u32 v5, v5, 11, v4
    v_add_u32 v4, s51, v4
    v_mov_b32 v6, s44
    v_mov_b32 v7, s45
    s_mov_b32 exec_lo, 0
    v_mov_b32 v6, s80
    v_mov_b32 v7, s81
    s_mov_b32 exec_lo, -1
    v_add_co_u32 v6, vcc, v6, v4
    s_mov_b32 s4, s40
    s_mov_b32 s5, s41
    s_mov_b32 s6, 4194304
    s_mov_b32 s7, 0x20000
    v_addc_co_u32 v7, vcc, 0, v7, vcc
    buffer_load_dwordx4 v5, s[4:7], s50 offen  lds
    s_add_u32 m0, m0, 1024
    s_add_u32 s50, s50, 4096
    buffer_load_dwordx4 v5, s[4:7], s50 offen  lds
    s_add_u32 m0, m0, 1024
    s_add_u32 s50, s50, 4096
    buffer_load_dwordx4 v5, s[4:7], s50 offen  lds
    s_add_u32 m0, m0, 1024
    s_add_u32 s50, s50, 4096
    buffer_load_dwordx4 v5, s[4:7], s50 offen  lds
    s_add_u32 m0, m0, 1024
    s_add_u32 s50, s50, 4096
    global_load_lds_dwordx4 v[6:7], off
    s_and_b32 s39, s3, 1
    s_lshl_b32 s50, s39, 9
    s_lshr_b32 s39, s3, 1
    s_lshl_b32 s39, s39, 7
    s_add_u32 s50, s50, s39
    s_lshl_b32 s39, s38, 2
    s_add_u32 s50, s50, s39
    s_add_u32 s50, s50, s18
    s_lshl_b32 s50, s50, 11
    v_and_b32 v4, 63, v0
    v_lshl_add_u32 v3, v4, 5, s50
    global_load_dword v10, v3, s[68:69]
    global_load_dword v11, v3, s[70:71]
    s_mov_b64 s[8:9], s[72:73]
    s_mov_b64 s[10:11], s[74:75]
    s_mov_b64 s[52:53], s[72:73]
    s_mov_b64 s[54:55], s[74:75]
    s_mov_b64 s[58:59], s[78:79]
    s_mov_b64 s[36:37], s[82:83]
    v_and_b32 v24, 63, v0
    s_and_b32 s19, s18, 1
    s_lshl_b32 s23, s18, 12
    v_lshrrev_b32 v25, 4, v24
    v_lshrrev_b32 v56, 3, v24
    v_and_b32 v57, 7, v24
    v_lshrrev_b32 v58, 1, v56
    v_xor_b32 v57, v57, v58
    v_lshlrev_b32 v57, 4, v57
    s_mov_b32 s12, s42
    s_mov_b32 s13, s43
    s_mov_b32 s14, 25165824
    s_mov_b32 s15, 0x20000
    s_lshl_b32 s38, s17, 14
    s_add_u32 s38, s38, 8388608
    s_add_u32 s24, s42, s38
    s_addc_u32 s25, s43, 0
    s_mov_b32 s26, 16384
    s_mov_b32 s27, 0x20000
    s_cmp_lt_u32 s18, 2
    s_cselect_b32 s28, s52, s54
    s_cselect_b32 s29, s53, s55
    s_sub_u32 s28, s28, 3072
    s_subb_u32 s29, s29, 0
    s_mov_b32 s30, 2100224
    s_mov_b32 s31, 0x20000
    s_mov_b32 s32, s36
    s_mov_b32 s33, s37
    s_mov_b32 s34, 8388608
    s_mov_b32 s35, 0x20000
    v_bfe_u32 v59, v24, 1, 3
    v_xor_b32 v59, v59, v25
    v_lshlrev_b32 v59, 4, v59
    v_lshl_add_u32 v59, v26, 7, v59
    s_lshl_b32 s38, s19, 13
    s_lshl_b32 s39, s20, 13
    v_xor_b32 v58, 0, v59
    v_add_u32 v16, s38, v58
    v_add_u32 v18, s39, v58
    v_add_u32 v20, 0x10000, v16
    v_add_u32 v22, 0x10000, v18
    v_xor_b32 v58, 64, v59
    v_add_u32 v17, s38, v58
    v_add_u32 v19, s39, v58
    v_add_u32 v21, 0x10000, v17
    v_add_u32 v23, 0x10000, v19
    v_and_b32 v58, 31, v24
    v_lshlrev_b32 v27, 4, v58
    s_sub_u32 s38, 15, s16
    s_lshl_b32 s38, s38, 10
    s_lshl_b32 s39, s20, 9
    s_add_u32 s92, s38, s39
    v_add_u32 v27, s92, v27
    s_cmp_eq_u32 s19, 1
    s_cselect_b64 s[98:99], -1, 0
    s_waitcnt lgkmcnt(0)
    s_mul_i32 s93, s93, 1664525
    s_add_u32 s93, s93, 1013904223
    s_lshl_b32 s38, s20, 8
    s_add_u32 s38, s38, 32768
    v_lshl_add_u32 v193, v26, 4, s38
    s_lshl_b32 s39, s19, 11
    v_lshl_add_u32 v192, v25, 9, v193
    v_add_u32 v192, s39, v192
    v_lshlrev_b32 v194, 10, v25
    v_lshl_add_u32 v194, v26, 4, v194
    s_add_u32 s38, s92, 1024
    v_add_u32 v194, s38, v194
    v_sub_u32 v58, s16, v25
    v_mov_b32 v59, s93
    v_cmp_lt_i32 vcc, 0, v58
    s_nop 1
    v_cndmask_b32 v198, 0, v59, vcc
    v_cmp_lt_i32 vcc, 4, v58
    s_nop 1
    v_cndmask_b32 v199, 0, v59, vcc
    v_cmp_lt_i32 vcc, 8, v58
    s_nop 1
    v_cndmask_b32 v200, 0, v59, vcc
    v_cmp_lt_i32 vcc, 12, v58
    s_nop 1
    v_cndmask_b32 v201, 0, v59, vcc
    s_mul_i32 s38, s18, 9216
    s_add_u32 s38, s38, 36864
    v_mul_u32_u24 v195, 144, v26
    v_lshl_add_u32 v195, v25, 5, v195
    v_add_u32 v195, s38, v195
    v_bfe_u32 v196, v24, 2, 2
    v_lshl_add_u32 v196, v25, 3, v196
    v_mul_u32_u24 v196, 144, v196
    v_and_b32 v58, 3, v24
    v_lshl_add_u32 v196, v58, 3, v196
    v_add_u32 v196, s38, v196
    v_lshlrev_b32 v197, 4, v24
    s_lshl_b32 s38, s17, 6
    s_lshl_b32 s39, s19, 5
    s_add_u32 s38, s38, s39
    v_add_u32 v58, s38, v56
    v_lshl_add_u32 v58, v58, 11, v57
    v_xor_b32 v59, 64, v58
    v_add_u32 v202, 3072, v58
    v_add_u32 v203, 18432, v59
    v_add_u32 v204, 33792, v58
    v_add_u32 v205, 49152, v59
    s_and_b32 s55, s17, 7
    s_and_b32 s54, s17, 8
    s_lshl_b32 s48, s16, 19
    s_lshl_b32 s39, s17, 15
    s_add_u32 s53, s48, s39
    s_lshl_b32 s39, s20, 11
    s_add_u32 s53, s53, s39
    s_lshl_b32 s39, s19, 14
    s_add_u32 s53, s53, s39
    s_lshl_b32 s51, s16, 7
    s_lshl_b32 s38, s18, 5
    s_add_u32 s51, s51, s38
    s_lshl_b32 s57, s51, 3
    s_add_u32 s57, s57, 9453568
    s_lshl_b32 s56, s51, 11
    s_lshl_b32 s39, s17, 7
    s_add_u32 s56, s56, s39
    v_lshlrev_b32 v220, 11, v25
    v_lshl_add_u32 v220, v26, 3, v220
    v_and_b32 v221, 31, v24
    v_lshlrev_b32 v221, 3, v221
    v_lshl_add_u32 v222, v26, 3, s39
    s_not_b32 s39, s93
    v_mov_b32 v60, s39
    v_mov_b32 v61, s39
    v_mov_b32 v62, s39
    v_mov_b32 v63, s39
    v_lshlrev_b32 v59, 2, v24
    s_mul_hi_u32 s8, s2, 76695845
    s_mul_i32 s9, s8, 56
    s_sub_u32 s9, s2, s9
    s_lshl_b32 s10, s9, 10
    s_lshl_b32 s11, s8, 8
    s_add_u32 s10, s10, s11
    s_add_u32 s10, s10, 9568256
    s_lshl_b32 s11, s8, 14
    s_lshl_b32 s9, s9, 8
    s_add_u32 s11, s11, s9
    s_add_u32 s11, s11, 9633792
    s_lshl_b32 s9, s16, 12
    s_lshl_b32 s38, s17, 8
    s_add_u32 s9, s9, s38
    s_add_u32 s9, s9, 9502720
    s_cmp_ge_u32 s2, 224
    s_cselect_b32 s10, s9, s10
    s_cselect_b32 s11, s9, s11
    s_cmp_eq_u32 s18, 1
    s_cselect_b32 s9, s10, s9
    s_cmp_eq_u32 s18, 3
    s_cselect_b32 s9, s11, s9
    s_mov_b32 exec_hi, 0
    buffer_store_dword v60, v59, s[12:15], s9 offen sc1
    buffer_store_dwordx4 v[60:63], v27, s[24:27], 0 offen sc1
    s_mov_b32 exec_hi, -1
    s_lshl_b32 s39, s18, 13
    s_add_u32 s39, s39, 65536
    v_and_b32 v4, 7, v24
    v_lshlrev_b32 v4, 9, v4
    v_bfe_u32 v5, v24, 3, 1
    v_lshl_add_u32 v4, v5, 6, v4
    v_lshl_add_u32 v4, v25, 4, v4
    v_add_u32 v4, s39, v4
    v_and_b32 v7, 1, v24
    v_lshlrev_b32 v5, 9, v7
    v_bfe_u32 v6, v24, 1, 1
    v_lshl_add_u32 v5, v6, 6, v5
    v_lshl_add_u32 v5, v25, 4, v5
    v_add_u32 v5, s39, v5
    v_lshrrev_b32 v6, 1, v25
    v_lshlrev_b32 v6, 6, v6
    v_lshl_add_u32 v6, v7, 5, v6
    v_and_b32 v7, 1, v25
    v_lshl_add_u32 v6, v7, 4, v6
    s_lshl_b32 s39, s18, 7
    s_add_u32 s39, s39, 97792
    v_add_u32 v6, s39, v6
    s_waitcnt vmcnt(9)
    v_lshlrev_b32 v224, 16, v224
    v_lshlrev_b32 v225, 16, v225
    v_lshlrev_b32 v226, 16, v226
    v_lshlrev_b32 v227, 16, v227
    v_lshlrev_b32 v228, 16, v228
    v_lshlrev_b32 v229, 16, v229
    v_mul_f32 v230, 1069066811, v228
    v_mul_f32 v231, 1069066811, v229
    v_exp_f32 v230, v230
    v_exp_f32 v231, v231
    s_nop 0
    v_cvt_pk_bf16_f32 v230, v230, v230
    v_lshlrev_b32 v230, 16, v230
    v_cvt_pk_bf16_f32 v231, v231, v231
    v_lshlrev_b32 v231, 16, v231
    v_pk_mul_f32 v[232:233], v[230:231], v[224:225] op_sel:[0,0] op_sel_hi:[1,1]
    v_pk_mul_f32 v[234:235], v[230:231], v[226:227] op_sel:[0,0] op_sel_hi:[1,1]
    v_mul_f32 v232, 1069066811, v232
    v_mul_f32 v234, 1042479491, v234
    v_mul_f32 v233, 1069066811, v233
    v_mul_f32 v235, 1042479491, v235
    v_exp_f32 v232, v232
    v_rndne_f32 v236, v234
    v_exp_f32 v233, v233
    v_rndne_f32 v237, v235
    v_sub_f32 v234, v234, v236
    v_sub_f32 v235, v235, v237
    v_cos_f32 v236, v234
    v_sin_f32 v238, v234
    v_cos_f32 v237, v235
    v_sin_f32 v239, v235
    v_pk_mul_f32 v[240:241], v[224:225], v[224:225] op_sel:[0,0] op_sel_hi:[1,1]
    v_pk_fma_f32 v[240:241], v[226:227], v[226:227], v[240:241] op_sel:[0,0,0] op_sel_hi:[1,1,1]
    v_pk_mul_f32 v[28:29], v[232:233], v[236:237] op_sel:[0,0] op_sel_hi:[1,1]
    v_pk_mul_f32 v[30:31], v[232:233], v[238:239] op_sel:[0,0] op_sel_hi:[1,1]
    v_rcp_f32 v240, v240
    v_rcp_f32 v241, v241
    v_add_f32 v230, -1.0, v28
    v_add_f32 v231, -1.0, v29
    v_pk_add_f32 v[240:241], v[240:241], v[240:241]
    v_pk_mul_f32 v[232:233], v[230:231], v[224:225] op_sel:[0,0] op_sel_hi:[1,1]
    v_pk_fma_f32 v[232:233], v[30:31], v[226:227], v[232:233] op_sel:[0,0,0] op_sel_hi:[1,1,1]
    v_pk_mul_f32 v[234:235], v[30:31], v[224:225] op_sel:[0,0] op_sel_hi:[1,1]
    v_pk_fma_f32 v[234:235], v[230:231], v[226:227], v[234:235] op_sel:[0,0,0] op_sel_hi:[1,1,1] neg_lo:[1,0,0] neg_hi:[1,0,0]
    v_pk_mul_f32 v[32:33], v[232:233], v[240:241] op_sel:[0,0] op_sel_hi:[1,1]
    v_pk_mul_f32 v[34:35], v[234:235], v[240:241] op_sel:[0,0] op_sel_hi:[1,1]
    v_pk_mul_f32 v[224:225], v[28:29], v[28:29] op_sel:[0,0] op_sel_hi:[1,1]
    v_pk_mul_f32 v[226:227], v[28:29], v[30:31] op_sel:[0,0] op_sel_hi:[1,1]
    v_pk_fma_f32 v[224:225], v[30:31], v[30:31], v[224:225] op_sel:[0,0,0] op_sel_hi:[1,1,1] neg_lo:[1,0,0] neg_hi:[1,0,0]
    v_pk_add_f32 v[226:227], v[226:227], v[226:227]
    v_pk_mul_f32 v[228:229], v[224:225], v[224:225] op_sel:[0,0] op_sel_hi:[1,1]
    v_pk_mul_f32 v[230:231], v[224:225], v[226:227] op_sel:[0,0] op_sel_hi:[1,1]
    v_pk_fma_f32 v[228:229], v[226:227], v[226:227], v[228:229] op_sel:[0,0,0] op_sel_hi:[1,1,1] neg_lo:[1,0,0] neg_hi:[1,0,0]
    v_pk_add_f32 v[230:231], v[230:231], v[230:231]
    v_pk_mul_f32 v[36:37], v[228:229], v[228:229] op_sel:[0,0] op_sel_hi:[1,1]
    v_pk_mul_f32 v[38:39], v[228:229], v[230:231] op_sel:[0,0] op_sel_hi:[1,1]
    v_pk_fma_f32 v[36:37], v[230:231], v[230:231], v[36:37] op_sel:[0,0,0] op_sel_hi:[1,1,1] neg_lo:[1,0,0] neg_hi:[1,0,0]
    v_pk_add_f32 v[38:39], v[38:39], v[38:39]
    v_pk_mul_f32 v[40:41], v[36:37], v[36:37] op_sel:[0,0] op_sel_hi:[1,1]
    v_pk_mul_f32 v[42:43], v[36:37], v[38:39] op_sel:[0,0] op_sel_hi:[1,1]
    v_pk_fma_f32 v[40:41], v[38:39], v[38:39], v[40:41] op_sel:[0,0,0] op_sel_hi:[1,1,1] neg_lo:[1,0,0] neg_hi:[1,0,0]
    v_pk_add_f32 v[42:43], v[42:43], v[42:43]
    v_pk_mul_f32 v[224:225], v[40:41], v[40:41] op_sel:[0,0] op_sel_hi:[1,1]
    v_pk_mul_f32 v[226:227], v[40:41], v[42:43] op_sel:[0,0] op_sel_hi:[1,1]
    v_pk_fma_f32 v[224:225], v[42:43], v[42:43], v[224:225] op_sel:[0,0,0] op_sel_hi:[1,1,1] neg_lo:[1,0,0] neg_hi:[1,0,0]
    v_pk_add_f32 v[226:227], v[226:227], v[226:227]
    v_pk_mul_f32 v[228:229], v[224:225], v[224:225] op_sel:[0,0] op_sel_hi:[1,1]
    v_pk_mul_f32 v[230:231], v[224:225], v[226:227] op_sel:[0,0] op_sel_hi:[1,1]
    v_pk_fma_f32 v[228:229], v[226:227], v[226:227], v[228:229] op_sel:[0,0,0] op_sel_hi:[1,1,1] neg_lo:[1,0,0] neg_hi:[1,0,0]
    v_pk_add_f32 v[230:231], v[230:231], v[230:231]
    v_and_b32 v240, 1, v25
    v_cmp_eq_u32 s[84:85], 1, v240
    v_cmp_lt_u32 s[86:87], 1, v25
    s_nop 0
    v_cndmask_b32 v232, 1.0, v40, s[84:85]
    v_cndmask_b32 v234, 0, v42, s[84:85]
    v_cndmask_b32 v233, 1.0, v41, s[84:85]
    v_cndmask_b32 v235, 0, v43, s[84:85]
    v_cndmask_b32 v236, 1.0, v224, s[86:87]
    v_cndmask_b32 v238, 0, v226, s[86:87]
    v_cndmask_b32 v237, 1.0, v225, s[86:87]
    v_cndmask_b32 v239, 0, v227, s[86:87]
    v_pk_mul_f32 v[242:243], v[232:233], v[236:237] op_sel:[0,0] op_sel_hi:[1,1]
    v_pk_mul_f32 v[244:245], v[232:233], v[238:239] op_sel:[0,0] op_sel_hi:[1,1]
    v_pk_fma_f32 v[242:243], v[234:235], v[238:239], v[242:243] op_sel:[0,0,0] op_sel_hi:[1,1,1] neg_lo:[1,0,0] neg_hi:[1,0,0]
    v_pk_fma_f32 v[244:245], v[234:235], v[236:237], v[244:245] op_sel:[0,0,0] op_sel_hi:[1,1,1]
    v_cndmask_b32 v232, 1.0, v228, s[98:99]
    v_cndmask_b32 v234, 0, v230, s[98:99]
    v_cndmask_b32 v233, 1.0, v229, s[98:99]
    v_cndmask_b32 v235, 0, v231, s[98:99]
    v_pk_mul_f32 v[52:53], v[242:243], v[232:233] op_sel:[0,0] op_sel_hi:[1,1]
    v_pk_mul_f32 v[54:55], v[242:243], v[234:235] op_sel:[0,0] op_sel_hi:[1,1]
    v_pk_fma_f32 v[52:53], v[244:245], v[234:235], v[52:53] op_sel:[0,0,0] op_sel_hi:[1,1,1] neg_lo:[1,0,0] neg_hi:[1,0,0]
    v_pk_fma_f32 v[54:55], v[244:245], v[232:233], v[54:55] op_sel:[0,0,0] op_sel_hi:[1,1,1]
    v_pk_mul_f32 v[224:225], v[228:229], v[228:229] op_sel:[0,0] op_sel_hi:[1,1]
    v_pk_mul_f32 v[226:227], v[228:229], v[230:231] op_sel:[0,0] op_sel_hi:[1,1]
    v_pk_fma_f32 v[224:225], v[230:231], v[230:231], v[224:225] op_sel:[0,0,0] op_sel_hi:[1,1,1] neg_lo:[1,0,0] neg_hi:[1,0,0]
    v_pk_add_f32 v[226:227], v[226:227], v[226:227]
    v_pk_mul_f32 v[228:229], v[224:225], v[224:225] op_sel:[0,0] op_sel_hi:[1,1]
    v_pk_mul_f32 v[230:231], v[224:225], v[226:227] op_sel:[0,0] op_sel_hi:[1,1]
    v_pk_fma_f32 v[228:229], v[226:227], v[226:227], v[228:229] op_sel:[0,0,0] op_sel_hi:[1,1,1] neg_lo:[1,0,0] neg_hi:[1,0,0]
    v_pk_add_f32 v[230:231], v[230:231], v[230:231]
    v_pk_mul_f32 v[44:45], v[228:229], v[228:229] op_sel:[0,0] op_sel_hi:[1,1]
    v_pk_mul_f32 v[46:47], v[228:229], v[230:231] op_sel:[0,0] op_sel_hi:[1,1]
    v_pk_fma_f32 v[44:45], v[230:231], v[230:231], v[44:45] op_sel:[0,0,0] op_sel_hi:[1,1,1] neg_lo:[1,0,0] neg_hi:[1,0,0]
    v_pk_add_f32 v[46:47], v[46:47], v[46:47]
    v_cndmask_b32 v232, 1.0, v224, s[84:85]
    v_cndmask_b32 v234, 0, v226, s[84:85]
    v_cndmask_b32 v233, 1.0, v225, s[84:85]
    v_cndmask_b32 v235, 0, v227, s[84:85]
    v_cndmask_b32 v236, 1.0, v228, s[86:87]
    v_cndmask_b32 v238, 0, v230, s[86:87]
    v_cndmask_b32 v237, 1.0, v229, s[86:87]
    v_cndmask_b32 v239, 0, v231, s[86:87]
    v_pk_mul_f32 v[48:49], v[232:233], v[236:237] op_sel:[0,0] op_sel_hi:[1,1]
    v_pk_mul_f32 v[50:51], v[232:233], v[238:239] op_sel:[0,0] op_sel_hi:[1,1]
    v_pk_fma_f32 v[48:49], v[234:235], v[238:239], v[48:49] op_sel:[0,0,0] op_sel_hi:[1,1,1] neg_lo:[1,0,0] neg_hi:[1,0,0]
    v_pk_fma_f32 v[50:51], v[234:235], v[236:237], v[50:51] op_sel:[0,0,0] op_sel_hi:[1,1,1]
    v_mov_b32 v224, v52
    v_mov_b32 v226, v54
    v_mul_f32 v225, v36, v52
    v_mul_f32 v227, v36, v54
    v_fma_f32 v225, -v38, v54, v225
    v_fma_f32 v227, v38, v52, v227
    v_pk_mul_f32 v[206:207], v[32:33], v[224:225] op_sel:[0,0] op_sel_hi:[0,1]
    v_pk_mul_f32 v[208:209], v[32:33], v[226:227] op_sel:[0,0] op_sel_hi:[0,1]
    v_pk_fma_f32 v[206:207], v[34:35], v[226:227], v[206:207] op_sel:[0,0,0] op_sel_hi:[0,1,1] neg_lo:[1,0,0] neg_hi:[1,0,0]
    v_pk_fma_f32 v[208:209], v[34:35], v[224:225], v[208:209] op_sel:[0,0,0] op_sel_hi:[0,1,1]
    v_mov_b32 v224, v53
    v_mov_b32 v226, v55
    v_mul_f32 v225, v37, v53
    v_mul_f32 v227, v37, v55
    v_fma_f32 v225, -v39, v55, v225
    v_fma_f32 v227, v39, v53, v227
    v_pk_mul_f32 v[210:211], v[32:33], v[224:225] op_sel:[1,0] op_sel_hi:[1,1]
    v_pk_mul_f32 v[212:213], v[32:33], v[226:227] op_sel:[1,0] op_sel_hi:[1,1]
    v_pk_fma_f32 v[210:211], v[34:35], v[226:227], v[210:211] op_sel:[1,0,0] op_sel_hi:[1,1,1] neg_lo:[1,0,0] neg_hi:[1,0,0]
    v_pk_fma_f32 v[212:213], v[34:35], v[224:225], v[212:213] op_sel:[1,0,0] op_sel_hi:[1,1,1]
    s_waitcnt vmcnt(4)
    ds_read_b128 v[224:227], v4 offset:0
    ds_read_b128 v[240:243], v5 offset:4096
    ds_read_b128 v[228:231], v4 offset:128
    ds_read_b128 v[244:247], v5 offset:4224
    ds_read_b128 v[232:235], v4 offset:256
    ds_read_b128 v[248:251], v5 offset:4352
    ds_read_b128 v[236:239], v4 offset:384
    ds_read_b128 v[252:255], v5 offset:4480
    s_waitcnt lgkmcnt(0)
    v_mfma_f32_16x16x32_bf16 v[12:15], v[224:227], v[240:243], 0
    v_mfma_f32_16x16x32_bf16 v[12:15], v[228:231], v[244:247], v[12:15]
    v_mfma_f32_16x16x32_bf16 v[12:15], v[232:235], v[248:251], v[12:15]
    v_mfma_f32_16x16x32_bf16 v[12:15], v[236:239], v[252:255], v[12:15]
    s_lshl_b32 s39, s18, 2
    s_add_u32 s39, s39, 97776
    v_mov_b32 v4, s39
    v_mov_b32 v5, s93
    v_mov_b32 v7, 97776
    s_nop 3
    s_mov_b32 exec_lo, 0x00030003
    s_mov_b32 exec_hi, 0x000c000c
    ds_write_b128 v6, v[12:15]
    s_mov_b64 exec, -1
    ds_write_b32 v4, v5
    v_lshl_add_u32 v6, v26, 2, v7
    v_and_b32 v138, 7, v24
    s_lshl_b32 s38, s3, 8
    s_lshr_b32 s39, s2, 3
    s_lshl_b32 s39, s39, 3
    s_add_u32 s8, s38, s39
    s_sub_u32 s38, 2047, s8
    v_sub_u32 v139, s38, v138
    v_lshlrev_b32 v138, 3, v138
    v_bfe_u32 v140, v24, 3, 1
    v_lshl_add_u32 v138, v140, 14, v138
    s_lshl_b32 s8, s8, 3
    s_add_u32 s8, s8, 9437184
    s_mov_b32 s9, 0xffff0000
    s_cmp_lg_u32 s18, 0
    s_cbranch_scc1 L_nokey
L_rgw:
    ds_read_b128 v[144:147], v7
    ds_read_b32 v128, v6 offset:16
    ds_read_b32 v129, v6 offset:80
    ds_read_b32 v130, v6 offset:144
    ds_read_b32 v131, v6 offset:208
    ds_read_b32 v132, v6 offset:272
    ds_read_b32 v133, v6 offset:336
    ds_read_b32 v134, v6 offset:400
    ds_read_b32 v135, v6 offset:464
    s_waitcnt lgkmcnt(0)
    v_xor_b32 v144, s93, v144
    v_xor_b32 v145, s93, v145
    v_xor_b32 v146, s93, v146
    v_xor_b32 v147, s93, v147
    v_or3_b32 v144, v144, v145, v146
    v_or_b32 v144, v144, v147
    v_cmp_ne_u32 vcc, 0, v144
    s_nop 1
    s_cmp_eq_u64 vcc, 0
    s_cbranch_scc1 L_rgo
    s_sub_u32 s96, s96, 1
    s_cbranch_scc1 L_rgo
    s_branch L_rgw
L_rgo:
    v_not_b32 v144, s93
    v_not_b32 v145, s93
    v_not_b32 v146, s93
    v_not_b32 v147, s93
    ds_write_b128 v7, v[144:147]
    v_pk_add_f32 v[128:129], v[128:129], v[130:131]
    v_pk_add_f32 v[132:133], v[132:133], v[134:135]
    v_pk_add_f32 v[128:129], v[128:129], v[132:133]
    v_add_f32 v128, v128, v129
    v_cvt_pk_bf16_f32 v128, v128, v128
    v_lshlrev_b32 v128, 16, v128
    v_mul_f32 v130, 0xbfb8aa3b, v128
    v_exp_f32 v130, v130
    s_nop 0
    v_add_f32 v130, 1.0, v130
    v_rcp_f32 v130, v130
    s_nop 0
    v_cvt_pk_bf16_f32 v130, v130, v130
    v_lshlrev_b32 v130, 16, v130
    v_cmp_eq_u32 vcc, 1, v140
    v_ashrrev_i32 v129, 31, v128
    v_or_b32 v129, 0x80000000, v129
    v_xor_b32 v128, v128, v129
    v_and_or_b32 v128, v128, s9, v139
    v_cndmask_b32 v4, v128, v130, vcc
L_nokey:
    s_waitcnt lgkmcnt(0)
    s_barrier
    s_cmp_lg_u32 s18, 0
    s_cbranch_scc1 L_nokey2
    s_mov_b64 exec, 0xffff
    buffer_store_dwordx2 v[4:5], v138, s[12:15], s8 offen sc1
    s_mov_b64 exec, -1
L_nokey2:
    ds_read_b128 v[128:131], v16 offset:0
    ds_read_b128 v[144:147], v18 offset:16384
    ds_read_b128 v[148:151], v18 offset:18432
    ds_read_b128 v[152:155], v18 offset:20480
    ds_read_b128 v[156:159], v18 offset:22528
    ds_read_b128 v[132:135], v16 offset:2048
    ds_read_b128 v[136:139], v16 offset:4096
    ds_read_b128 v[140:143], v16 offset:6144
    s_waitcnt lgkmcnt(0)
    v_mfma_f32_16x16x32_bf16 v[64:67], v[128:131], v[144:147], 0
    ds_read_b128 v[160:163], v17 offset:0
    v_mfma_f32_16x16x32_bf16 v[68:71], v[128:131], v[148:151], 0
    ds_read_b128 v[176:179], v19 offset:16384
    v_mfma_f32_16x16x32_bf16 v[72:75], v[128:131], v[152:155], 0
    v_mfma_f32_16x16x32_bf16 v[76:79], v[128:131], v[156:159], 0
    ds_read_b128 v[180:183], v19 offset:18432
    v_mfma_f32_16x16x32_bf16 v[80:83], v[132:135], v[144:147], 0
    ds_read_b128 v[184:187], v19 offset:20480
    v_mfma_f32_16x16x32_bf16 v[84:87], v[132:135], v[148:151], 0
    v_mfma_f32_16x16x32_bf16 v[88:91], v[132:135], v[152:155], 0
    ds_read_b128 v[188:191], v19 offset:22528
    v_mfma_f32_16x16x32_bf16 v[92:95], v[132:135], v[156:159], 0
    ds_read_b128 v[164:167], v17 offset:2048
    v_mfma_f32_16x16x32_bf16 v[96:99], v[136:139], v[144:147], 0
    v_mfma_f32_16x16x32_bf16 v[100:103], v[136:139], v[148:151], 0
    ds_read_b128 v[168:171], v17 offset:4096
    v_mfma_f32_16x16x32_bf16 v[104:107], v[136:139], v[152:155], 0
    ds_read_b128 v[172:175], v17 offset:6144
    v_mfma_f32_16x16x32_bf16 v[108:111], v[136:139], v[156:159], 0
    v_mfma_f32_16x16x32_bf16 v[112:115], v[140:143], v[144:147], 0
    v_mfma_f32_16x16x32_bf16 v[116:119], v[140:143], v[148:151], 0
    v_mfma_f32_16x16x32_bf16 v[120:123], v[140:143], v[152:155], 0
    v_mfma_f32_16x16x32_bf16 v[124:127], v[140:143], v[156:159], 0
    s_waitcnt lgkmcnt(0)
    s_barrier
    v_mfma_f32_16x16x32_bf16 v[64:67], v[160:163], v[176:179], v[64:67]
    ds_read_b128 v[128:131], v16 offset:32768
    v_mfma_f32_16x16x32_bf16 v[68:71], v[160:163], v[180:183], v[68:71]
    ds_read_b128 v[144:147], v18 offset:49152
    v_mfma_f32_16x16x32_bf16 v[72:75], v[160:163], v[184:187], v[72:75]
    v_mfma_f32_16x16x32_bf16 v[76:79], v[160:163], v[188:191], v[76:79]
    ds_read_b128 v[148:151], v18 offset:51200
    v_mfma_f32_16x16x32_bf16 v[80:83], v[164:167], v[176:179], v[80:83]
    ds_read_b128 v[152:155], v18 offset:53248
    v_mfma_f32_16x16x32_bf16 v[84:87], v[164:167], v[180:183], v[84:87]
    v_mfma_f32_16x16x32_bf16 v[88:91], v[164:167], v[184:187], v[88:91]
    ds_read_b128 v[156:159], v18 offset:55296
    v_mfma_f32_16x16x32_bf16 v[92:95], v[164:167], v[188:191], v[92:95]
    ds_read_b128 v[132:135], v16 offset:34816
    v_mfma_f32_16x16x32_bf16 v[96:99], v[168:171], v[176:179], v[96:99]
    v_mfma_f32_16x16x32_bf16 v[100:103], v[168:171], v[180:183], v[100:103]
    ds_read_b128 v[136:139], v16 offset:36864
    v_mfma_f32_16x16x32_bf16 v[104:107], v[168:171], v[184:187], v[104:107]
    ds_read_b128 v[140:143], v16 offset:38912
    v_mfma_f32_16x16x32_bf16 v[108:111], v[168:171], v[188:191], v[108:111]
    v_mfma_f32_16x16x32_bf16 v[112:115], v[172:175], v[176:179], v[112:115]
    v_mfma_f32_16x16x32_bf16 v[116:119], v[172:175], v[180:183], v[116:119]
    v_mfma_f32_16x16x32_bf16 v[120:123], v[172:175], v[184:187], v[120:123]
    v_mfma_f32_16x16x32_bf16 v[124:127], v[172:175], v[188:191], v[124:127]
    s_waitcnt lgkmcnt(0)
    v_mfma_f32_16x16x32_bf16 v[64:67], v[128:131], v[144:147], v[64:67]
    ds_read_b128 v[160:163], v17 offset:32768
    v_mfma_f32_16x16x32_bf16 v[68:71], v[128:131], v[148:151], v[68:71]
    ds_read_b128 v[176:179], v19 offset:49152
    v_mfma_f32_16x16x32_bf16 v[72:75], v[128:131], v[152:155], v[72:75]
    v_mfma_f32_16x16x32_bf16 v[76:79], v[128:131], v[156:159], v[76:79]
    ds_read_b128 v[180:183], v19 offset:51200
    v_mfma_f32_16x16x32_bf16 v[80:83], v[132:135], v[144:147], v[80:83]
    ds_read_b128 v[184:187], v19 offset:53248
    v_mfma_f32_16x16x32_bf16 v[84:87], v[132:135], v[148:151], v[84:87]
    v_mfma_f32_16x16x32_bf16 v[88:91], v[132:135], v[152:155], v[88:91]
    ds_read_b128 v[188:191], v19 offset:55296
    v_mfma_f32_16x16x32_bf16 v[92:95], v[132:135], v[156:159], v[92:95]
    ds_read_b128 v[164:167], v17 offset:34816
    v_mfma_f32_16x16x32_bf16 v[96:99], v[136:139], v[144:147], v[96:99]
    v_mfma_f32_16x16x32_bf16 v[100:103], v[136:139], v[148:151], v[100:103]
    ds_read_b128 v[168:171], v17 offset:36864
    v_mfma_f32_16x16x32_bf16 v[104:107], v[136:139], v[152:155], v[104:107]
    ds_read_b128 v[172:175], v17 offset:38912
    v_mfma_f32_16x16x32_bf16 v[108:111], v[136:139], v[156:159], v[108:111]
    v_mfma_f32_16x16x32_bf16 v[112:115], v[140:143], v[144:147], v[112:115]
    v_mfma_f32_16x16x32_bf16 v[116:119], v[140:143], v[148:151], v[116:119]
    v_mfma_f32_16x16x32_bf16 v[120:123], v[140:143], v[152:155], v[120:123]
    v_mfma_f32_16x16x32_bf16 v[124:127], v[140:143], v[156:159], v[124:127]
    s_waitcnt lgkmcnt(0)
    s_barrier
    v_mfma_f32_16x16x32_bf16 v[64:67], v[160:163], v[176:179], v[64:67]
    ds_read_b128 v[128:131], v20 offset:0
    v_mfma_f32_16x16x32_bf16 v[68:71], v[160:163], v[180:183], v[68:71]
    ds_read_b128 v[144:147], v22 offset:16384
    v_mfma_f32_16x16x32_bf16 v[72:75], v[160:163], v[184:187], v[72:75]
    v_mfma_f32_16x16x32_bf16 v[76:79], v[160:163], v[188:191], v[76:79]
    ds_read_b128 v[148:151], v22 offset:18432
    v_mfma_f32_16x16x32_bf16 v[80:83], v[164:167], v[176:179], v[80:83]
    ds_read_b128 v[152:155], v22 offset:20480
    v_mfma_f32_16x16x32_bf16 v[84:87], v[164:167], v[180:183], v[84:87]
    v_mfma_f32_16x16x32_bf16 v[88:91], v[164:167], v[184:187], v[88:91]
    ds_read_b128 v[156:159], v22 offset:22528
    v_mfma_f32_16x16x32_bf16 v[92:95], v[164:167], v[188:191], v[92:95]
    ds_read_b128 v[132:135], v20 offset:2048
    v_mfma_f32_16x16x32_bf16 v[96:99], v[168:171], v[176:179], v[96:99]
    v_mfma_f32_16x16x32_bf16 v[100:103], v[168:171], v[180:183], v[100:103]
    ds_read_b128 v[136:139], v20 offset:4096
    v_mfma_f32_16x16x32_bf16 v[104:107], v[168:171], v[184:187], v[104:107]
    ds_read_b128 v[140:143], v20 offset:6144
    v_mfma_f32_16x16x32_bf16 v[108:111], v[168:171], v[188:191], v[108:111]
    v_mfma_f32_16x16x32_bf16 v[112:115], v[172:175], v[176:179], v[112:115]
    v_mfma_f32_16x16x32_bf16 v[116:119], v[172:175], v[180:183], v[116:119]
    v_mfma_f32_16x16x32_bf16 v[120:123], v[172:175], v[184:187], v[120:123]
    v_mfma_f32_16x16x32_bf16 v[124:127], v[172:175], v[188:191], v[124:127]
    s_waitcnt lgkmcnt(0)
    v_mfma_f32_16x16x32_bf16 v[64:67], v[128:131], v[144:147], v[64:67]
    ds_read_b128 v[160:163], v21 offset:0
    v_mfma_f32_16x16x32_bf16 v[68:71], v[128:131], v[148:151], v[68:71]
    ds_read_b128 v[176:179], v23 offset:16384
    v_mfma_f32_16x16x32_bf16 v[72:75], v[128:131], v[152:155], v[72:75]
    v_mfma_f32_16x16x32_bf16 v[76:79], v[128:131], v[156:159], v[76:79]
    ds_read_b128 v[180:183], v23 offset:18432
    v_mfma_f32_16x16x32_bf16 v[80:83], v[132:135], v[144:147], v[80:83]
    ds_read_b128 v[184:187], v23 offset:20480
    v_mfma_f32_16x16x32_bf16 v[84:87], v[132:135], v[148:151], v[84:87]
    v_mfma_f32_16x16x32_bf16 v[88:91], v[132:135], v[152:155], v[88:91]
    ds_read_b128 v[188:191], v23 offset:22528
    v_mfma_f32_16x16x32_bf16 v[92:95], v[132:135], v[156:159], v[92:95]
    ds_read_b128 v[164:167], v21 offset:2048
    v_mfma_f32_16x16x32_bf16 v[96:99], v[136:139], v[144:147], v[96:99]
    v_mfma_f32_16x16x32_bf16 v[100:103], v[136:139], v[148:151], v[100:103]
    ds_read_b128 v[168:171], v21 offset:4096
    v_mfma_f32_16x16x32_bf16 v[104:107], v[136:139], v[152:155], v[104:107]
    ds_read_b128 v[172:175], v21 offset:6144
    v_mfma_f32_16x16x32_bf16 v[108:111], v[136:139], v[156:159], v[108:111]
    v_mfma_f32_16x16x32_bf16 v[112:115], v[140:143], v[144:147], v[112:115]
    v_mfma_f32_16x16x32_bf16 v[116:119], v[140:143], v[148:151], v[116:119]
    v_mfma_f32_16x16x32_bf16 v[120:123], v[140:143], v[152:155], v[120:123]
    v_mfma_f32_16x16x32_bf16 v[124:127], v[140:143], v[156:159], v[124:127]
    s_waitcnt lgkmcnt(0)
    s_barrier
    v_mfma_f32_16x16x32_bf16 v[64:67], v[160:163], v[176:179], v[64:67]
    ds_read_b128 v[128:131], v16 offset:0
    v_mfma_f32_16x16x32_bf16 v[68:71], v[160:163], v[180:183], v[68:71]
    ds_read_b128 v[144:147], v18 offset:16384
    v_mfma_f32_16x16x32_bf16 v[72:75], v[160:163], v[184:187], v[72:75]
    v_mfma_f32_16x16x32_bf16 v[76:79], v[160:163], v[188:191], v[76:79]
    ds_read_b128 v[148:151], v18 offset:18432
    v_mfma_f32_16x16x32_bf16 v[80:83], v[164:167], v[176:179], v[80:83]
    ds_read_b128 v[152:155], v18 offset:20480
    v_mfma_f32_16x16x32_bf16 v[84:87], v[164:167], v[180:183], v[84:87]
    v_mfma_f32_16x16x32_bf16 v[88:91], v[164:167], v[184:187], v[88:91]
    ds_read_b128 v[156:159], v18 offset:22528
    v_mfma_f32_16x16x32_bf16 v[92:95], v[164:167], v[188:191], v[92:95]
    ds_read_b128 v[132:135], v16 offset:2048
    v_mfma_f32_16x16x32_bf16 v[96:99], v[168:171], v[176:179], v[96:99]
    v_mfma_f32_16x16x32_bf16 v[100:103], v[168:171], v[180:183], v[100:103]
    ds_read_b128 v[136:139], v16 offset:4096
    v_mfma_f32_16x16x32_bf16 v[104:107], v[168:171], v[184:187], v[104:107]
    ds_read_b128 v[140:143], v16 offset:6144
    v_mfma_f32_16x16x32_bf16 v[108:111], v[168:171], v[188:191], v[108:111]
    v_mfma_f32_16x16x32_bf16 v[112:115], v[172:175], v[176:179], v[112:115]
    v_mfma_f32_16x16x32_bf16 v[116:119], v[172:175], v[180:183], v[116:119]
    v_mfma_f32_16x16x32_bf16 v[120:123], v[172:175], v[184:187], v[120:123]
    v_mfma_f32_16x16x32_bf16 v[124:127], v[172:175], v[188:191], v[124:127]
    s_waitcnt lgkmcnt(0)
    v_mfma_f32_16x16x32_bf16 v[64:67], v[128:131], v[144:147], v[64:67]
    ds_read_b128 v[160:163], v17 offset:0
    v_mfma_f32_16x16x32_bf16 v[68:71], v[128:131], v[148:151], v[68:71]
    ds_read_b128 v[176:179], v19 offset:16384
    v_mfma_f32_16x16x32_bf16 v[72:75], v[128:131], v[152:155], v[72:75]
    v_mfma_f32_16x16x32_bf16 v[76:79], v[128:131], v[156:159], v[76:79]
    ds_read_b128 v[180:183], v19 offset:18432
    v_mfma_f32_16x16x32_bf16 v[80:83], v[132:135], v[144:147], v[80:83]
    ds_read_b128 v[184:187], v19 offset:20480
    v_mfma_f32_16x16x32_bf16 v[84:87], v[132:135], v[148:151], v[84:87]
    v_mfma_f32_16x16x32_bf16 v[88:91], v[132:135], v[152:155], v[88:91]
    ds_read_b128 v[188:191], v19 offset:22528
    v_mfma_f32_16x16x32_bf16 v[92:95], v[132:135], v[156:159], v[92:95]
    ds_read_b128 v[164:167], v17 offset:2048
    v_mfma_f32_16x16x32_bf16 v[96:99], v[136:139], v[144:147], v[96:99]
    v_mfma_f32_16x16x32_bf16 v[100:103], v[136:139], v[148:151], v[100:103]
    ds_read_b128 v[168:171], v17 offset:4096
    v_mfma_f32_16x16x32_bf16 v[104:107], v[136:139], v[152:155], v[104:107]
    ds_read_b128 v[172:175], v17 offset:6144
    v_mfma_f32_16x16x32_bf16 v[108:111], v[136:139], v[156:159], v[108:111]
    v_mfma_f32_16x16x32_bf16 v[112:115], v[140:143], v[144:147], v[112:115]
    v_mfma_f32_16x16x32_bf16 v[116:119], v[140:143], v[148:151], v[116:119]
    v_mfma_f32_16x16x32_bf16 v[120:123], v[140:143], v[152:155], v[120:123]
    v_mfma_f32_16x16x32_bf16 v[124:127], v[140:143], v[156:159], v[124:127]
    s_waitcnt lgkmcnt(0)
    s_barrier
    v_mfma_f32_16x16x32_bf16 v[64:67], v[160:163], v[176:179], v[64:67]
    ds_read_b128 v[128:131], v16 offset:32768
    v_mfma_f32_16x16x32_bf16 v[68:71], v[160:163], v[180:183], v[68:71]
    ds_read_b128 v[144:147], v18 offset:49152
    v_mfma_f32_16x16x32_bf16 v[72:75], v[160:163], v[184:187], v[72:75]
    v_mfma_f32_16x16x32_bf16 v[76:79], v[160:163], v[188:191], v[76:79]
    ds_read_b128 v[148:151], v18 offset:51200
    v_mfma_f32_16x16x32_bf16 v[80:83], v[164:167], v[176:179], v[80:83]
    ds_read_b128 v[152:155], v18 offset:53248
    v_mfma_f32_16x16x32_bf16 v[84:87], v[164:167], v[180:183], v[84:87]
    v_mfma_f32_16x16x32_bf16 v[88:91], v[164:167], v[184:187], v[88:91]
    ds_read_b128 v[156:159], v18 offset:55296
    v_mfma_f32_16x16x32_bf16 v[92:95], v[164:167], v[188:191], v[92:95]
    ds_read_b128 v[132:135], v16 offset:34816
    v_mfma_f32_16x16x32_bf16 v[96:99], v[168:171], v[176:179], v[96:99]
    v_mfma_f32_16x16x32_bf16 v[100:103], v[168:171], v[180:183], v[100:103]
    ds_read_b128 v[136:139], v16 offset:36864
    v_mfma_f32_16x16x32_bf16 v[104:107], v[168:171], v[184:187], v[104:107]
    ds_read_b128 v[140:143], v16 offset:38912
    v_mfma_f32_16x16x32_bf16 v[108:111], v[168:171], v[188:191], v[108:111]
    v_mfma_f32_16x16x32_bf16 v[112:115], v[172:175], v[176:179], v[112:115]
    v_mfma_f32_16x16x32_bf16 v[116:119], v[172:175], v[180:183], v[116:119]
    v_mfma_f32_16x16x32_bf16 v[120:123], v[172:175], v[184:187], v[120:123]
    v_mfma_f32_16x16x32_bf16 v[124:127], v[172:175], v[188:191], v[124:127]
    s_waitcnt lgkmcnt(0)
    v_mfma_f32_16x16x32_bf16 v[64:67], v[128:131], v[144:147], v[64:67]
    ds_read_b128 v[160:163], v17 offset:32768
    v_mfma_f32_16x16x32_bf16 v[68:71], v[128:131], v[148:151], v[68:71]
    ds_read_b128 v[176:179], v19 offset:49152
    v_mfma_f32_16x16x32_bf16 v[72:75], v[128:131], v[152:155], v[72:75]
    v_mfma_f32_16x16x32_bf16 v[76:79], v[128:131], v[156:159], v[76:79]
    ds_read_b128 v[180:183], v19 offset:51200
    v_mfma_f32_16x16x32_bf16 v[80:83], v[132:135], v[144:147], v[80:83]
    ds_read_b128 v[184:187], v19 offset:53248
    v_mfma_f32_16x16x32_bf16 v[84:87], v[132:135], v[148:151], v[84:87]
    v_mfma_f32_16x16x32_bf16 v[88:91], v[132:135], v[152:155], v[88:91]
    ds_read_b128 v[188:191], v19 offset:55296
    v_mfma_f32_16x16x32_bf16 v[92:95], v[132:135], v[156:159], v[92:95]
    ds_read_b128 v[164:167], v17 offset:34816
    v_mfma_f32_16x16x32_bf16 v[96:99], v[136:139], v[144:147], v[96:99]
    v_mfma_f32_16x16x32_bf16 v[100:103], v[136:139], v[148:151], v[100:103]
    ds_read_b128 v[168:171], v17 offset:36864
    v_mfma_f32_16x16x32_bf16 v[104:107], v[136:139], v[152:155], v[104:107]
    ds_read_b128 v[172:175], v17 offset:38912
    v_mfma_f32_16x16x32_bf16 v[108:111], v[136:139], v[156:159], v[108:111]
    v_mfma_f32_16x16x32_bf16 v[112:115], v[140:143], v[144:147], v[112:115]
    v_mfma_f32_16x16x32_bf16 v[116:119], v[140:143], v[148:151], v[116:119]
    v_mfma_f32_16x16x32_bf16 v[120:123], v[140:143], v[152:155], v[120:123]
    v_mfma_f32_16x16x32_bf16 v[124:127], v[140:143], v[156:159], v[124:127]
    s_waitcnt lgkmcnt(0)
    s_barrier
    v_mfma_f32_16x16x32_bf16 v[64:67], v[160:163], v[176:179], v[64:67]
    ds_read_b128 v[128:131], v20 offset:0
    v_mfma_f32_16x16x32_bf16 v[68:71], v[160:163], v[180:183], v[68:71]
    ds_read_b128 v[144:147], v22 offset:16384
    v_mfma_f32_16x16x32_bf16 v[72:75], v[160:163], v[184:187], v[72:75]
    v_mfma_f32_16x16x32_bf16 v[76:79], v[160:163], v[188:191], v[76:79]
    ds_read_b128 v[148:151], v22 offset:18432
    v_mfma_f32_16x16x32_bf16 v[80:83], v[164:167], v[176:179], v[80:83]
    ds_read_b128 v[152:155], v22 offset:20480
    v_mfma_f32_16x16x32_bf16 v[84:87], v[164:167], v[180:183], v[84:87]
    v_mfma_f32_16x16x32_bf16 v[88:91], v[164:167], v[184:187], v[88:91]
    ds_read_b128 v[156:159], v22 offset:22528
    v_mfma_f32_16x16x32_bf16 v[92:95], v[164:167], v[188:191], v[92:95]
    ds_read_b128 v[132:135], v20 offset:2048
    v_mfma_f32_16x16x32_bf16 v[96:99], v[168:171], v[176:179], v[96:99]
    v_mfma_f32_16x16x32_bf16 v[100:103], v[168:171], v[180:183], v[100:103]
    ds_read_b128 v[136:139], v20 offset:4096
    v_mfma_f32_16x16x32_bf16 v[104:107], v[168:171], v[184:187], v[104:107]
    ds_read_b128 v[140:143], v20 offset:6144
    v_mfma_f32_16x16x32_bf16 v[108:111], v[168:171], v[188:191], v[108:111]
    v_mfma_f32_16x16x32_bf16 v[112:115], v[172:175], v[176:179], v[112:115]
    v_mfma_f32_16x16x32_bf16 v[116:119], v[172:175], v[180:183], v[116:119]
    v_mfma_f32_16x16x32_bf16 v[120:123], v[172:175], v[184:187], v[120:123]
    v_mfma_f32_16x16x32_bf16 v[124:127], v[172:175], v[188:191], v[124:127]
    s_waitcnt lgkmcnt(0)
    v_mfma_f32_16x16x32_bf16 v[64:67], v[128:131], v[144:147], v[64:67]
    ds_read_b128 v[160:163], v21 offset:0
    v_mfma_f32_16x16x32_bf16 v[68:71], v[128:131], v[148:151], v[68:71]
    ds_read_b128 v[176:179], v23 offset:16384
    v_mfma_f32_16x16x32_bf16 v[72:75], v[128:131], v[152:155], v[72:75]
    v_mfma_f32_16x16x32_bf16 v[76:79], v[128:131], v[156:159], v[76:79]
    ds_read_b128 v[180:183], v23 offset:18432
    v_mfma_f32_16x16x32_bf16 v[80:83], v[132:135], v[144:147], v[80:83]
    ds_read_b128 v[184:187], v23 offset:20480
    v_mfma_f32_16x16x32_bf16 v[84:87], v[132:135], v[148:151], v[84:87]
    v_mfma_f32_16x16x32_bf16 v[88:91], v[132:135], v[152:155], v[88:91]
    ds_read_b128 v[188:191], v23 offset:22528
    v_mfma_f32_16x16x32_bf16 v[92:95], v[132:135], v[156:159], v[92:95]
    ds_read_b128 v[164:167], v21 offset:2048
    v_mfma_f32_16x16x32_bf16 v[96:99], v[136:139], v[144:147], v[96:99]
    v_mfma_f32_16x16x32_bf16 v[100:103], v[136:139], v[148:151], v[100:103]
    ds_read_b128 v[168:171], v21 offset:4096
    v_mfma_f32_16x16x32_bf16 v[104:107], v[136:139], v[152:155], v[104:107]
    ds_read_b128 v[172:175], v21 offset:6144
    v_mfma_f32_16x16x32_bf16 v[108:111], v[136:139], v[156:159], v[108:111]
    v_mfma_f32_16x16x32_bf16 v[112:115], v[140:143], v[144:147], v[112:115]
    v_mfma_f32_16x16x32_bf16 v[116:119], v[140:143], v[148:151], v[116:119]
    v_mfma_f32_16x16x32_bf16 v[120:123], v[140:143], v[152:155], v[120:123]
    v_mfma_f32_16x16x32_bf16 v[124:127], v[140:143], v[156:159], v[124:127]
    s_waitcnt lgkmcnt(0)
    s_barrier
    v_mfma_f32_16x16x32_bf16 v[64:67], v[160:163], v[176:179], v[64:67]
    ds_read_b128 v[128:131], v16 offset:0
    v_mfma_f32_16x16x32_bf16 v[68:71], v[160:163], v[180:183], v[68:71]
    ds_read_b128 v[144:147], v18 offset:16384
    v_mfma_f32_16x16x32_bf16 v[72:75], v[160:163], v[184:187], v[72:75]
    v_mfma_f32_16x16x32_bf16 v[76:79], v[160:163], v[188:191], v[76:79]
    ds_read_b128 v[148:151], v18 offset:18432
    v_mfma_f32_16x16x32_bf16 v[80:83], v[164:167], v[176:179], v[80:83]
    ds_read_b128 v[152:155], v18 offset:20480
    v_mfma_f32_16x16x32_bf16 v[84:87], v[164:167], v[180:183], v[84:87]
    v_mfma_f32_16x16x32_bf16 v[88:91], v[164:167], v[184:187], v[88:91]
    ds_read_b128 v[156:159], v18 offset:22528
    v_mfma_f32_16x16x32_bf16 v[92:95], v[164:167], v[188:191], v[92:95]
    ds_read_b128 v[132:135], v16 offset:2048
    v_mfma_f32_16x16x32_bf16 v[96:99], v[168:171], v[176:179], v[96:99]
    v_mfma_f32_16x16x32_bf16 v[100:103], v[168:171], v[180:183], v[100:103]
    ds_read_b128 v[136:139], v16 offset:4096
    v_mfma_f32_16x16x32_bf16 v[104:107], v[168:171], v[184:187], v[104:107]
    ds_read_b128 v[140:143], v16 offset:6144
    v_mfma_f32_16x16x32_bf16 v[108:111], v[168:171], v[188:191], v[108:111]
    v_mfma_f32_16x16x32_bf16 v[112:115], v[172:175], v[176:179], v[112:115]
    v_mfma_f32_16x16x32_bf16 v[116:119], v[172:175], v[180:183], v[116:119]
    v_mfma_f32_16x16x32_bf16 v[120:123], v[172:175], v[184:187], v[120:123]
    v_mfma_f32_16x16x32_bf16 v[124:127], v[172:175], v[188:191], v[124:127]
    s_waitcnt lgkmcnt(0)
    v_mfma_f32_16x16x32_bf16 v[64:67], v[128:131], v[144:147], v[64:67]
    ds_read_b128 v[160:163], v17 offset:0
    v_mfma_f32_16x16x32_bf16 v[68:71], v[128:131], v[148:151], v[68:71]
    ds_read_b128 v[176:179], v19 offset:16384
    v_mfma_f32_16x16x32_bf16 v[72:75], v[128:131], v[152:155], v[72:75]
    v_mfma_f32_16x16x32_bf16 v[76:79], v[128:131], v[156:159], v[76:79]
    ds_read_b128 v[180:183], v19 offset:18432
    v_mfma_f32_16x16x32_bf16 v[80:83], v[132:135], v[144:147], v[80:83]
    ds_read_b128 v[184:187], v19 offset:20480
    v_mfma_f32_16x16x32_bf16 v[84:87], v[132:135], v[148:151], v[84:87]
    v_mfma_f32_16x16x32_bf16 v[88:91], v[132:135], v[152:155], v[88:91]
    ds_read_b128 v[188:191], v19 offset:22528
    v_mfma_f32_16x16x32_bf16 v[92:95], v[132:135], v[156:159], v[92:95]
    ds_read_b128 v[164:167], v17 offset:2048
    v_mfma_f32_16x16x32_bf16 v[96:99], v[136:139], v[144:147], v[96:99]
    v_mfma_f32_16x16x32_bf16 v[100:103], v[136:139], v[148:151], v[100:103]
    ds_read_b128 v[168:171], v17 offset:4096
    v_mfma_f32_16x16x32_bf16 v[104:107], v[136:139], v[152:155], v[104:107]
    ds_read_b128 v[172:175], v17 offset:6144
    v_mfma_f32_16x16x32_bf16 v[108:111], v[136:139], v[156:159], v[108:111]
    v_mfma_f32_16x16x32_bf16 v[112:115], v[140:143], v[144:147], v[112:115]
    v_mfma_f32_16x16x32_bf16 v[116:119], v[140:143], v[148:151], v[116:119]
    v_mfma_f32_16x16x32_bf16 v[120:123], v[140:143], v[152:155], v[120:123]
    v_mfma_f32_16x16x32_bf16 v[124:127], v[140:143], v[156:159], v[124:127]
    s_waitcnt lgkmcnt(0)
    s_barrier
    v_mfma_f32_16x16x32_bf16 v[64:67], v[160:163], v[176:179], v[64:67]
    ds_read_b128 v[128:131], v16 offset:32768
    v_mfma_f32_16x16x32_bf16 v[68:71], v[160:163], v[180:183], v[68:71]
    ds_read_b128 v[144:147], v18 offset:49152
    v_mfma_f32_16x16x32_bf16 v[72:75], v[160:163], v[184:187], v[72:75]
    v_mfma_f32_16x16x32_bf16 v[76:79], v[160:163], v[188:191], v[76:79]
    ds_read_b128 v[148:151], v18 offset:51200
    v_mfma_f32_16x16x32_bf16 v[80:83], v[164:167], v[176:179], v[80:83]
    ds_read_b128 v[152:155], v18 offset:53248
    v_mfma_f32_16x16x32_bf16 v[84:87], v[164:167], v[180:183], v[84:87]
    v_mfma_f32_16x16x32_bf16 v[88:91], v[164:167], v[184:187], v[88:91]
    ds_read_b128 v[156:159], v18 offset:55296
    v_mfma_f32_16x16x32_bf16 v[92:95], v[164:167], v[188:191], v[92:95]
    ds_read_b128 v[132:135], v16 offset:34816
    v_mfma_f32_16x16x32_bf16 v[96:99], v[168:171], v[176:179], v[96:99]
    v_mfma_f32_16x16x32_bf16 v[100:103], v[168:171], v[180:183], v[100:103]
    ds_read_b128 v[136:139], v16 offset:36864
    v_mfma_f32_16x16x32_bf16 v[104:107], v[168:171], v[184:187], v[104:107]
    ds_read_b128 v[140:143], v16 offset:38912
    v_mfma_f32_16x16x32_bf16 v[108:111], v[168:171], v[188:191], v[108:111]
    v_mfma_f32_16x16x32_bf16 v[112:115], v[172:175], v[176:179], v[112:115]
    v_mfma_f32_16x16x32_bf16 v[116:119], v[172:175], v[180:183], v[116:119]
    v_mfma_f32_16x16x32_bf16 v[120:123], v[172:175], v[184:187], v[120:123]
    v_mfma_f32_16x16x32_bf16 v[124:127], v[172:175], v[188:191], v[124:127]
    s_waitcnt lgkmcnt(0)
    v_mfma_f32_16x16x32_bf16 v[64:67], v[128:131], v[144:147], v[64:67]
    ds_read_b128 v[160:163], v17 offset:32768
    v_mfma_f32_16x16x32_bf16 v[68:71], v[128:131], v[148:151], v[68:71]
    ds_read_b128 v[176:179], v19 offset:49152
    v_mfma_f32_16x16x32_bf16 v[72:75], v[128:131], v[152:155], v[72:75]
    v_mfma_f32_16x16x32_bf16 v[76:79], v[128:131], v[156:159], v[76:79]
    ds_read_b128 v[180:183], v19 offset:51200
    v_mfma_f32_16x16x32_bf16 v[80:83], v[132:135], v[144:147], v[80:83]
    ds_read_b128 v[184:187], v19 offset:53248
    v_mfma_f32_16x16x32_bf16 v[84:87], v[132:135], v[148:151], v[84:87]
    v_mfma_f32_16x16x32_bf16 v[88:91], v[132:135], v[152:155], v[88:91]
    ds_read_b128 v[188:191], v19 offset:55296
    v_mfma_f32_16x16x32_bf16 v[92:95], v[132:135], v[156:159], v[92:95]
    ds_read_b128 v[164:167], v17 offset:34816
    v_mfma_f32_16x16x32_bf16 v[96:99], v[136:139], v[144:147], v[96:99]
    v_mfma_f32_16x16x32_bf16 v[100:103], v[136:139], v[148:151], v[100:103]
    ds_read_b128 v[168:171], v17 offset:36864
    v_mfma_f32_16x16x32_bf16 v[104:107], v[136:139], v[152:155], v[104:107]
    ds_read_b128 v[172:175], v17 offset:38912
    v_mfma_f32_16x16x32_bf16 v[108:111], v[136:139], v[156:159], v[108:111]
    v_mfma_f32_16x16x32_bf16 v[112:115], v[140:143], v[144:147], v[112:115]
    v_mfma_f32_16x16x32_bf16 v[116:119], v[140:143], v[148:151], v[116:119]
    v_mfma_f32_16x16x32_bf16 v[120:123], v[140:143], v[152:155], v[120:123]
    v_mfma_f32_16x16x32_bf16 v[124:127], v[140:143], v[156:159], v[124:127]
    s_waitcnt lgkmcnt(0)
    s_barrier
    v_mfma_f32_16x16x32_bf16 v[64:67], v[160:163], v[176:179], v[64:67]
    ds_read_b128 v[128:131], v20 offset:0
    v_mfma_f32_16x16x32_bf16 v[68:71], v[160:163], v[180:183], v[68:71]
    ds_read_b128 v[144:147], v22 offset:16384
    v_mfma_f32_16x16x32_bf16 v[72:75], v[160:163], v[184:187], v[72:75]
    v_mfma_f32_16x16x32_bf16 v[76:79], v[160:163], v[188:191], v[76:79]
    ds_read_b128 v[148:151], v22 offset:18432
    v_mfma_f32_16x16x32_bf16 v[80:83], v[164:167], v[176:179], v[80:83]
    ds_read_b128 v[152:155], v22 offset:20480
    v_mfma_f32_16x16x32_bf16 v[84:87], v[164:167], v[180:183], v[84:87]
    v_mfma_f32_16x16x32_bf16 v[88:91], v[164:167], v[184:187], v[88:91]
    ds_read_b128 v[156:159], v22 offset:22528
    v_mfma_f32_16x16x32_bf16 v[92:95], v[164:167], v[188:191], v[92:95]
    ds_read_b128 v[132:135], v20 offset:2048
    v_mfma_f32_16x16x32_bf16 v[96:99], v[168:171], v[176:179], v[96:99]
    v_mfma_f32_16x16x32_bf16 v[100:103], v[168:171], v[180:183], v[100:103]
    ds_read_b128 v[136:139], v20 offset:4096
    v_mfma_f32_16x16x32_bf16 v[104:107], v[168:171], v[184:187], v[104:107]
    ds_read_b128 v[140:143], v20 offset:6144
    v_mfma_f32_16x16x32_bf16 v[108:111], v[168:171], v[188:191], v[108:111]
    v_mfma_f32_16x16x32_bf16 v[112:115], v[172:175], v[176:179], v[112:115]
    v_mfma_f32_16x16x32_bf16 v[116:119], v[172:175], v[180:183], v[116:119]
    v_mfma_f32_16x16x32_bf16 v[120:123], v[172:175], v[184:187], v[120:123]
    v_mfma_f32_16x16x32_bf16 v[124:127], v[172:175], v[188:191], v[124:127]
    s_waitcnt lgkmcnt(0)
    v_mfma_f32_16x16x32_bf16 v[64:67], v[128:131], v[144:147], v[64:67]
    ds_read_b128 v[160:163], v21 offset:0
    v_mfma_f32_16x16x32_bf16 v[68:71], v[128:131], v[148:151], v[68:71]
    ds_read_b128 v[176:179], v23 offset:16384
    v_mfma_f32_16x16x32_bf16 v[72:75], v[128:131], v[152:155], v[72:75]
    v_mfma_f32_16x16x32_bf16 v[76:79], v[128:131], v[156:159], v[76:79]
    ds_read_b128 v[180:183], v23 offset:18432
    v_mfma_f32_16x16x32_bf16 v[80:83], v[132:135], v[144:147], v[80:83]
    ds_read_b128 v[184:187], v23 offset:20480
    v_mfma_f32_16x16x32_bf16 v[84:87], v[132:135], v[148:151], v[84:87]
    v_mfma_f32_16x16x32_bf16 v[88:91], v[132:135], v[152:155], v[88:91]
    ds_read_b128 v[188:191], v23 offset:22528
    v_mfma_f32_16x16x32_bf16 v[92:95], v[132:135], v[156:159], v[92:95]
    ds_read_b128 v[164:167], v21 offset:2048
    v_mfma_f32_16x16x32_bf16 v[96:99], v[136:139], v[144:147], v[96:99]
    v_mfma_f32_16x16x32_bf16 v[100:103], v[136:139], v[148:151], v[100:103]
    ds_read_b128 v[168:171], v21 offset:4096
    v_mfma_f32_16x16x32_bf16 v[104:107], v[136:139], v[152:155], v[104:107]
    ds_read_b128 v[172:175], v21 offset:6144
    v_mfma_f32_16x16x32_bf16 v[108:111], v[136:139], v[156:159], v[108:111]
    v_mfma_f32_16x16x32_bf16 v[112:115], v[140:143], v[144:147], v[112:115]
    v_mfma_f32_16x16x32_bf16 v[116:119], v[140:143], v[148:151], v[116:119]
    v_mfma_f32_16x16x32_bf16 v[120:123], v[140:143], v[152:155], v[120:123]
    v_mfma_f32_16x16x32_bf16 v[124:127], v[140:143], v[156:159], v[124:127]
    s_waitcnt lgkmcnt(0)
    s_barrier
    v_mfma_f32_16x16x32_bf16 v[64:67], v[160:163], v[176:179], v[64:67]
    ds_read_b128 v[128:131], v16 offset:0
    v_mfma_f32_16x16x32_bf16 v[68:71], v[160:163], v[180:183], v[68:71]
    ds_read_b128 v[144:147], v18 offset:16384
    v_mfma_f32_16x16x32_bf16 v[72:75], v[160:163], v[184:187], v[72:75]
    v_mfma_f32_16x16x32_bf16 v[76:79], v[160:163], v[188:191], v[76:79]
    ds_read_b128 v[148:151], v18 offset:18432
    v_mfma_f32_16x16x32_bf16 v[80:83], v[164:167], v[176:179], v[80:83]
    ds_read_b128 v[152:155], v18 offset:20480
    v_mfma_f32_16x16x32_bf16 v[84:87], v[164:167], v[180:183], v[84:87]
    v_mfma_f32_16x16x32_bf16 v[88:91], v[164:167], v[184:187], v[88:91]
    ds_read_b128 v[156:159], v18 offset:22528
    v_mfma_f32_16x16x32_bf16 v[92:95], v[164:167], v[188:191], v[92:95]
    ds_read_b128 v[132:135], v16 offset:2048
    v_mfma_f32_16x16x32_bf16 v[96:99], v[168:171], v[176:179], v[96:99]
    v_mfma_f32_16x16x32_bf16 v[100:103], v[168:171], v[180:183], v[100:103]
    ds_read_b128 v[136:139], v16 offset:4096
    v_mfma_f32_16x16x32_bf16 v[104:107], v[168:171], v[184:187], v[104:107]
    ds_read_b128 v[140:143], v16 offset:6144
    v_mfma_f32_16x16x32_bf16 v[108:111], v[168:171], v[188:191], v[108:111]
    v_mfma_f32_16x16x32_bf16 v[112:115], v[172:175], v[176:179], v[112:115]
    v_mfma_f32_16x16x32_bf16 v[116:119], v[172:175], v[180:183], v[116:119]
    v_mfma_f32_16x16x32_bf16 v[120:123], v[172:175], v[184:187], v[120:123]
    v_mfma_f32_16x16x32_bf16 v[124:127], v[172:175], v[188:191], v[124:127]
    s_waitcnt lgkmcnt(0)
    v_mfma_f32_16x16x32_bf16 v[64:67], v[128:131], v[144:147], v[64:67]
    ds_read_b128 v[160:163], v17 offset:0
    v_mfma_f32_16x16x32_bf16 v[68:71], v[128:131], v[148:151], v[68:71]
    ds_read_b128 v[176:179], v19 offset:16384
    v_mfma_f32_16x16x32_bf16 v[72:75], v[128:131], v[152:155], v[72:75]
    v_mfma_f32_16x16x32_bf16 v[76:79], v[128:131], v[156:159], v[76:79]
    ds_read_b128 v[180:183], v19 offset:18432
    v_mfma_f32_16x16x32_bf16 v[80:83], v[132:135], v[144:147], v[80:83]
    ds_read_b128 v[184:187], v19 offset:20480
    v_mfma_f32_16x16x32_bf16 v[84:87], v[132:135], v[148:151], v[84:87]
    v_mfma_f32_16x16x32_bf16 v[88:91], v[132:135], v[152:155], v[88:91]
    ds_read_b128 v[188:191], v19 offset:22528
    v_mfma_f32_16x16x32_bf16 v[92:95], v[132:135], v[156:159], v[92:95]
    ds_read_b128 v[164:167], v17 offset:2048
    v_mfma_f32_16x16x32_bf16 v[96:99], v[136:139], v[144:147], v[96:99]
    v_mfma_f32_16x16x32_bf16 v[100:103], v[136:139], v[148:151], v[100:103]
    ds_read_b128 v[168:171], v17 offset:4096
    v_mfma_f32_16x16x32_bf16 v[104:107], v[136:139], v[152:155], v[104:107]
    ds_read_b128 v[172:175], v17 offset:6144
    v_mfma_f32_16x16x32_bf16 v[108:111], v[136:139], v[156:159], v[108:111]
    v_mfma_f32_16x16x32_bf16 v[112:115], v[140:143], v[144:147], v[112:115]
    v_mfma_f32_16x16x32_bf16 v[116:119], v[140:143], v[148:151], v[116:119]
    v_mfma_f32_16x16x32_bf16 v[120:123], v[140:143], v[152:155], v[120:123]
    v_mfma_f32_16x16x32_bf16 v[124:127], v[140:143], v[156:159], v[124:127]
    s_waitcnt lgkmcnt(0)
    s_barrier
    v_mfma_f32_16x16x32_bf16 v[64:67], v[160:163], v[176:179], v[64:67]
    ds_read_b128 v[128:131], v16 offset:32768
    v_mfma_f32_16x16x32_bf16 v[68:71], v[160:163], v[180:183], v[68:71]
    ds_read_b128 v[144:147], v18 offset:49152
    v_mfma_f32_16x16x32_bf16 v[72:75], v[160:163], v[184:187], v[72:75]
    v_mfma_f32_16x16x32_bf16 v[76:79], v[160:163], v[188:191], v[76:79]
    ds_read_b128 v[148:151], v18 offset:51200
    v_mfma_f32_16x16x32_bf16 v[80:83], v[164:167], v[176:179], v[80:83]
    ds_read_b128 v[152:155], v18 offset:53248
    v_mfma_f32_16x16x32_bf16 v[84:87], v[164:167], v[180:183], v[84:87]
    v_mfma_f32_16x16x32_bf16 v[88:91], v[164:167], v[184:187], v[88:91]
    ds_read_b128 v[156:159], v18 offset:55296
    v_mfma_f32_16x16x32_bf16 v[92:95], v[164:167], v[188:191], v[92:95]
    ds_read_b128 v[132:135], v16 offset:34816
    v_mfma_f32_16x16x32_bf16 v[96:99], v[168:171], v[176:179], v[96:99]
    v_mfma_f32_16x16x32_bf16 v[100:103], v[168:171], v[180:183], v[100:103]
    ds_read_b128 v[136:139], v16 offset:36864
    v_mfma_f32_16x16x32_bf16 v[104:107], v[168:171], v[184:187], v[104:107]
    ds_read_b128 v[140:143], v16 offset:38912
    v_mfma_f32_16x16x32_bf16 v[108:111], v[168:171], v[188:191], v[108:111]
    v_mfma_f32_16x16x32_bf16 v[112:115], v[172:175], v[176:179], v[112:115]
    v_mfma_f32_16x16x32_bf16 v[116:119], v[172:175], v[180:183], v[116:119]
    v_mfma_f32_16x16x32_bf16 v[120:123], v[172:175], v[184:187], v[120:123]
    v_mfma_f32_16x16x32_bf16 v[124:127], v[172:175], v[188:191], v[124:127]
    s_waitcnt lgkmcnt(0)
    v_mfma_f32_16x16x32_bf16 v[64:67], v[128:131], v[144:147], v[64:67]
    ds_read_b128 v[160:163], v17 offset:32768
    v_mfma_f32_16x16x32_bf16 v[68:71], v[128:131], v[148:151], v[68:71]
    ds_read_b128 v[176:179], v19 offset:49152
    v_mfma_f32_16x16x32_bf16 v[72:75], v[128:131], v[152:155], v[72:75]
    v_mfma_f32_16x16x32_bf16 v[76:79], v[128:131], v[156:159], v[76:79]
    ds_read_b128 v[180:183], v19 offset:51200
    v_mfma_f32_16x16x32_bf16 v[80:83], v[132:135], v[144:147], v[80:83]
    ds_read_b128 v[184:187], v19 offset:53248
    v_mfma_f32_16x16x32_bf16 v[84:87], v[132:135], v[148:151], v[84:87]
    v_mfma_f32_16x16x32_bf16 v[88:91], v[132:135], v[152:155], v[88:91]
    ds_read_b128 v[188:191], v19 offset:55296
    v_mfma_f32_16x16x32_bf16 v[92:95], v[132:135], v[156:159], v[92:95]
    ds_read_b128 v[164:167], v17 offset:34816
    v_mfma_f32_16x16x32_bf16 v[96:99], v[136:139], v[144:147], v[96:99]
    v_mfma_f32_16x16x32_bf16 v[100:103], v[136:139], v[148:151], v[100:103]
    ds_read_b128 v[168:171], v17 offset:36864
    v_mfma_f32_16x16x32_bf16 v[104:107], v[136:139], v[152:155], v[104:107]
    ds_read_b128 v[172:175], v17 offset:38912
    v_mfma_f32_16x16x32_bf16 v[108:111], v[136:139], v[156:159], v[108:111]
    v_mfma_f32_16x16x32_bf16 v[112:115], v[140:143], v[144:147], v[112:115]
    v_mfma_f32_16x16x32_bf16 v[116:119], v[140:143], v[148:151], v[116:119]
    v_mfma_f32_16x16x32_bf16 v[120:123], v[140:143], v[152:155], v[120:123]
    v_mfma_f32_16x16x32_bf16 v[124:127], v[140:143], v[156:159], v[124:127]
    s_waitcnt lgkmcnt(0)
    s_barrier
    v_mfma_f32_16x16x32_bf16 v[64:67], v[160:163], v[176:179], v[64:67]
    ds_read_b128 v[128:131], v20 offset:0
    v_mfma_f32_16x16x32_bf16 v[68:71], v[160:163], v[180:183], v[68:71]
    ds_read_b128 v[144:147], v22 offset:16384
    v_mfma_f32_16x16x32_bf16 v[72:75], v[160:163], v[184:187], v[72:75]
    v_mfma_f32_16x16x32_bf16 v[76:79], v[160:163], v[188:191], v[76:79]
    ds_read_b128 v[148:151], v22 offset:18432
    v_mfma_f32_16x16x32_bf16 v[80:83], v[164:167], v[176:179], v[80:83]
    ds_read_b128 v[152:155], v22 offset:20480
    v_mfma_f32_16x16x32_bf16 v[84:87], v[164:167], v[180:183], v[84:87]
    v_mfma_f32_16x16x32_bf16 v[88:91], v[164:167], v[184:187], v[88:91]
    ds_read_b128 v[156:159], v22 offset:22528
    v_mfma_f32_16x16x32_bf16 v[92:95], v[164:167], v[188:191], v[92:95]
    ds_read_b128 v[132:135], v20 offset:2048
    v_mfma_f32_16x16x32_bf16 v[96:99], v[168:171], v[176:179], v[96:99]
    v_mfma_f32_16x16x32_bf16 v[100:103], v[168:171], v[180:183], v[100:103]
    ds_read_b128 v[136:139], v20 offset:4096
    v_mfma_f32_16x16x32_bf16 v[104:107], v[168:171], v[184:187], v[104:107]
    ds_read_b128 v[140:143], v20 offset:6144
    v_mfma_f32_16x16x32_bf16 v[108:111], v[168:171], v[188:191], v[108:111]
    v_mfma_f32_16x16x32_bf16 v[112:115], v[172:175], v[176:179], v[112:115]
    v_mfma_f32_16x16x32_bf16 v[116:119], v[172:175], v[180:183], v[116:119]
    v_mfma_f32_16x16x32_bf16 v[120:123], v[172:175], v[184:187], v[120:123]
    v_mfma_f32_16x16x32_bf16 v[124:127], v[172:175], v[188:191], v[124:127]
    s_waitcnt lgkmcnt(0)
    v_mfma_f32_16x16x32_bf16 v[64:67], v[128:131], v[144:147], v[64:67]
    ds_read_b128 v[160:163], v21 offset:0
    v_mfma_f32_16x16x32_bf16 v[68:71], v[128:131], v[148:151], v[68:71]
    ds_read_b128 v[176:179], v23 offset:16384
    v_mfma_f32_16x16x32_bf16 v[72:75], v[128:131], v[152:155], v[72:75]
    v_mfma_f32_16x16x32_bf16 v[76:79], v[128:131], v[156:159], v[76:79]
    ds_read_b128 v[180:183], v23 offset:18432
    v_mfma_f32_16x16x32_bf16 v[80:83], v[132:135], v[144:147], v[80:83]
    ds_read_b128 v[184:187], v23 offset:20480
    v_mfma_f32_16x16x32_bf16 v[84:87], v[132:135], v[148:151], v[84:87]
    v_mfma_f32_16x16x32_bf16 v[88:91], v[132:135], v[152:155], v[88:91]
    ds_read_b128 v[188:191], v23 offset:22528
    v_mfma_f32_16x16x32_bf16 v[92:95], v[132:135], v[156:159], v[92:95]
    ds_read_b128 v[164:167], v21 offset:2048
    v_mfma_f32_16x16x32_bf16 v[96:99], v[136:139], v[144:147], v[96:99]
    v_mfma_f32_16x16x32_bf16 v[100:103], v[136:139], v[148:151], v[100:103]
    ds_read_b128 v[168:171], v21 offset:4096
    v_mfma_f32_16x16x32_bf16 v[104:107], v[136:139], v[152:155], v[104:107]
    ds_read_b128 v[172:175], v21 offset:6144
    v_mfma_f32_16x16x32_bf16 v[108:111], v[136:139], v[156:159], v[108:111]
    v_mfma_f32_16x16x32_bf16 v[112:115], v[140:143], v[144:147], v[112:115]
    v_mfma_f32_16x16x32_bf16 v[116:119], v[140:143], v[148:151], v[116:119]
    v_mfma_f32_16x16x32_bf16 v[120:123], v[140:143], v[152:155], v[120:123]
    v_mfma_f32_16x16x32_bf16 v[124:127], v[140:143], v[156:159], v[124:127]
    s_waitcnt lgkmcnt(0)
    s_barrier
    v_mfma_f32_16x16x32_bf16 v[64:67], v[160:163], v[176:179], v[64:67]
    ds_read_b128 v[128:131], v16 offset:0
    v_mfma_f32_16x16x32_bf16 v[68:71], v[160:163], v[180:183], v[68:71]
    ds_read_b128 v[144:147], v18 offset:16384
    v_mfma_f32_16x16x32_bf16 v[72:75], v[160:163], v[184:187], v[72:75]
    v_mfma_f32_16x16x32_bf16 v[76:79], v[160:163], v[188:191], v[76:79]
    ds_read_b128 v[148:151], v18 offset:18432
    v_mfma_f32_16x16x32_bf16 v[80:83], v[164:167], v[176:179], v[80:83]
    ds_read_b128 v[152:155], v18 offset:20480
    v_mfma_f32_16x16x32_bf16 v[84:87], v[164:167], v[180:183], v[84:87]
    v_mfma_f32_16x16x32_bf16 v[88:91], v[164:167], v[184:187], v[88:91]
    ds_read_b128 v[156:159], v18 offset:22528
    v_mfma_f32_16x16x32_bf16 v[92:95], v[164:167], v[188:191], v[92:95]
    ds_read_b128 v[132:135], v16 offset:2048
    v_mfma_f32_16x16x32_bf16 v[96:99], v[168:171], v[176:179], v[96:99]
    v_mfma_f32_16x16x32_bf16 v[100:103], v[168:171], v[180:183], v[100:103]
    ds_read_b128 v[136:139], v16 offset:4096
    v_mfma_f32_16x16x32_bf16 v[104:107], v[168:171], v[184:187], v[104:107]
    ds_read_b128 v[140:143], v16 offset:6144
    v_mfma_f32_16x16x32_bf16 v[108:111], v[168:171], v[188:191], v[108:111]
    v_mfma_f32_16x16x32_bf16 v[112:115], v[172:175], v[176:179], v[112:115]
    v_mfma_f32_16x16x32_bf16 v[116:119], v[172:175], v[180:183], v[116:119]
    v_mfma_f32_16x16x32_bf16 v[120:123], v[172:175], v[184:187], v[120:123]
    v_mfma_f32_16x16x32_bf16 v[124:127], v[172:175], v[188:191], v[124:127]
    s_waitcnt lgkmcnt(0)
    v_mfma_f32_16x16x32_bf16 v[64:67], v[128:131], v[144:147], v[64:67]
    ds_read_b128 v[160:163], v17 offset:0
    v_mfma_f32_16x16x32_bf16 v[68:71], v[128:131], v[148:151], v[68:71]
    ds_read_b128 v[176:179], v19 offset:16384
    v_mfma_f32_16x16x32_bf16 v[72:75], v[128:131], v[152:155], v[72:75]
    v_mfma_f32_16x16x32_bf16 v[76:79], v[128:131], v[156:159], v[76:79]
    ds_read_b128 v[180:183], v19 offset:18432
    v_mfma_f32_16x16x32_bf16 v[80:83], v[132:135], v[144:147], v[80:83]
    ds_read_b128 v[184:187], v19 offset:20480
    v_mfma_f32_16x16x32_bf16 v[84:87], v[132:135], v[148:151], v[84:87]
    v_mfma_f32_16x16x32_bf16 v[88:91], v[132:135], v[152:155], v[88:91]
    ds_read_b128 v[188:191], v19 offset:22528
    v_mfma_f32_16x16x32_bf16 v[92:95], v[132:135], v[156:159], v[92:95]
    ds_read_b128 v[164:167], v17 offset:2048
    v_mfma_f32_16x16x32_bf16 v[96:99], v[136:139], v[144:147], v[96:99]
    v_mfma_f32_16x16x32_bf16 v[100:103], v[136:139], v[148:151], v[100:103]
    ds_read_b128 v[168:171], v17 offset:4096
    v_mfma_f32_16x16x32_bf16 v[104:107], v[136:139], v[152:155], v[104:107]
    ds_read_b128 v[172:175], v17 offset:6144
    v_mfma_f32_16x16x32_bf16 v[108:111], v[136:139], v[156:159], v[108:111]
    v_mfma_f32_16x16x32_bf16 v[112:115], v[140:143], v[144:147], v[112:115]
    v_mfma_f32_16x16x32_bf16 v[116:119], v[140:143], v[148:151], v[116:119]
    v_mfma_f32_16x16x32_bf16 v[120:123], v[140:143], v[152:155], v[120:123]
    v_mfma_f32_16x16x32_bf16 v[124:127], v[140:143], v[156:159], v[124:127]
    s_waitcnt lgkmcnt(0)
    s_barrier
    v_mfma_f32_16x16x32_bf16 v[64:67], v[160:163], v[176:179], v[64:67]
    ds_read_b128 v[128:131], v16 offset:32768
    v_mfma_f32_16x16x32_bf16 v[68:71], v[160:163], v[180:183], v[68:71]
    ds_read_b128 v[144:147], v18 offset:49152
    v_mfma_f32_16x16x32_bf16 v[72:75], v[160:163], v[184:187], v[72:75]
    v_mfma_f32_16x16x32_bf16 v[76:79], v[160:163], v[188:191], v[76:79]
    ds_read_b128 v[148:151], v18 offset:51200
    v_mfma_f32_16x16x32_bf16 v[80:83], v[164:167], v[176:179], v[80:83]
    ds_read_b128 v[152:155], v18 offset:53248
    v_mfma_f32_16x16x32_bf16 v[84:87], v[164:167], v[180:183], v[84:87]
    v_mfma_f32_16x16x32_bf16 v[88:91], v[164:167], v[184:187], v[88:91]
    ds_read_b128 v[156:159], v18 offset:55296
    v_mfma_f32_16x16x32_bf16 v[92:95], v[164:167], v[188:191], v[92:95]
    ds_read_b128 v[132:135], v16 offset:34816
    v_mfma_f32_16x16x32_bf16 v[96:99], v[168:171], v[176:179], v[96:99]
    v_mfma_f32_16x16x32_bf16 v[100:103], v[168:171], v[180:183], v[100:103]
    ds_read_b128 v[136:139], v16 offset:36864
    v_mfma_f32_16x16x32_bf16 v[104:107], v[168:171], v[184:187], v[104:107]
    ds_read_b128 v[140:143], v16 offset:38912
    v_mfma_f32_16x16x32_bf16 v[108:111], v[168:171], v[188:191], v[108:111]
    v_mfma_f32_16x16x32_bf16 v[112:115], v[172:175], v[176:179], v[112:115]
    v_mfma_f32_16x16x32_bf16 v[116:119], v[172:175], v[180:183], v[116:119]
    v_mfma_f32_16x16x32_bf16 v[120:123], v[172:175], v[184:187], v[120:123]
    v_mfma_f32_16x16x32_bf16 v[124:127], v[172:175], v[188:191], v[124:127]
    s_waitcnt lgkmcnt(0)
    v_mfma_f32_16x16x32_bf16 v[64:67], v[128:131], v[144:147], v[64:67]
    ds_read_b128 v[160:163], v17 offset:32768
    v_mfma_f32_16x16x32_bf16 v[68:71], v[128:131], v[148:151], v[68:71]
    ds_read_b128 v[176:179], v19 offset:49152
    v_mfma_f32_16x16x32_bf16 v[72:75], v[128:131], v[152:155], v[72:75]
    v_mfma_f32_16x16x32_bf16 v[76:79], v[128:131], v[156:159], v[76:79]
    ds_read_b128 v[180:183], v19 offset:51200
    v_mfma_f32_16x16x32_bf16 v[80:83], v[132:135], v[144:147], v[80:83]
    ds_read_b128 v[184:187], v19 offset:53248
    v_mfma_f32_16x16x32_bf16 v[84:87], v[132:135], v[148:151], v[84:87]
    v_mfma_f32_16x16x32_bf16 v[88:91], v[132:135], v[152:155], v[88:91]
    ds_read_b128 v[188:191], v19 offset:55296
    v_mfma_f32_16x16x32_bf16 v[92:95], v[132:135], v[156:159], v[92:95]
    ds_read_b128 v[164:167], v17 offset:34816
    v_mfma_f32_16x16x32_bf16 v[96:99], v[136:139], v[144:147], v[96:99]
    v_mfma_f32_16x16x32_bf16 v[100:103], v[136:139], v[148:151], v[100:103]
    ds_read_b128 v[168:171], v17 offset:36864
    v_mfma_f32_16x16x32_bf16 v[104:107], v[136:139], v[152:155], v[104:107]
    ds_read_b128 v[172:175], v17 offset:38912
    v_mfma_f32_16x16x32_bf16 v[108:111], v[136:139], v[156:159], v[108:111]
    v_mfma_f32_16x16x32_bf16 v[112:115], v[140:143], v[144:147], v[112:115]
    v_mfma_f32_16x16x32_bf16 v[116:119], v[140:143], v[148:151], v[116:119]
    v_mfma_f32_16x16x32_bf16 v[120:123], v[140:143], v[152:155], v[120:123]
    v_mfma_f32_16x16x32_bf16 v[124:127], v[140:143], v[156:159], v[124:127]
    s_waitcnt lgkmcnt(0)
    s_barrier
    v_mfma_f32_16x16x32_bf16 v[64:67], v[160:163], v[176:179], v[64:67]
    ds_read_b128 v[128:131], v20 offset:0
    v_mfma_f32_16x16x32_bf16 v[68:71], v[160:163], v[180:183], v[68:71]
    ds_read_b128 v[144:147], v22 offset:16384
    v_mfma_f32_16x16x32_bf16 v[72:75], v[160:163], v[184:187], v[72:75]
    v_mfma_f32_16x16x32_bf16 v[76:79], v[160:163], v[188:191], v[76:79]
    ds_read_b128 v[148:151], v22 offset:18432
    v_mfma_f32_16x16x32_bf16 v[80:83], v[164:167], v[176:179], v[80:83]
    ds_read_b128 v[152:155], v22 offset:20480
    v_mfma_f32_16x16x32_bf16 v[84:87], v[164:167], v[180:183], v[84:87]
    v_mfma_f32_16x16x32_bf16 v[88:91], v[164:167], v[184:187], v[88:91]
    ds_read_b128 v[156:159], v22 offset:22528
    v_mfma_f32_16x16x32_bf16 v[92:95], v[164:167], v[188:191], v[92:95]
    ds_read_b128 v[132:135], v20 offset:2048
    v_mfma_f32_16x16x32_bf16 v[96:99], v[168:171], v[176:179], v[96:99]
    v_mfma_f32_16x16x32_bf16 v[100:103], v[168:171], v[180:183], v[100:103]
    ds_read_b128 v[136:139], v20 offset:4096
    v_mfma_f32_16x16x32_bf16 v[104:107], v[168:171], v[184:187], v[104:107]
    ds_read_b128 v[140:143], v20 offset:6144
    v_mfma_f32_16x16x32_bf16 v[108:111], v[168:171], v[188:191], v[108:111]
    v_mfma_f32_16x16x32_bf16 v[112:115], v[172:175], v[176:179], v[112:115]
    v_mfma_f32_16x16x32_bf16 v[116:119], v[172:175], v[180:183], v[116:119]
    v_mfma_f32_16x16x32_bf16 v[120:123], v[172:175], v[184:187], v[120:123]
    v_mfma_f32_16x16x32_bf16 v[124:127], v[172:175], v[188:191], v[124:127]
    s_waitcnt lgkmcnt(0)
    v_mfma_f32_16x16x32_bf16 v[64:67], v[128:131], v[144:147], v[64:67]
    ds_read_b128 v[160:163], v21 offset:0
    v_mfma_f32_16x16x32_bf16 v[68:71], v[128:131], v[148:151], v[68:71]
    ds_read_b128 v[176:179], v23 offset:16384
    v_mfma_f32_16x16x32_bf16 v[72:75], v[128:131], v[152:155], v[72:75]
    v_mfma_f32_16x16x32_bf16 v[76:79], v[128:131], v[156:159], v[76:79]
    ds_read_b128 v[180:183], v23 offset:18432
    v_mfma_f32_16x16x32_bf16 v[80:83], v[132:135], v[144:147], v[80:83]
    ds_read_b128 v[184:187], v23 offset:20480
    v_mfma_f32_16x16x32_bf16 v[84:87], v[132:135], v[148:151], v[84:87]
    v_mfma_f32_16x16x32_bf16 v[88:91], v[132:135], v[152:155], v[88:91]
    ds_read_b128 v[188:191], v23 offset:22528
    v_mfma_f32_16x16x32_bf16 v[92:95], v[132:135], v[156:159], v[92:95]
    ds_read_b128 v[164:167], v21 offset:2048
    v_mfma_f32_16x16x32_bf16 v[96:99], v[136:139], v[144:147], v[96:99]
    v_mfma_f32_16x16x32_bf16 v[100:103], v[136:139], v[148:151], v[100:103]
    ds_read_b128 v[168:171], v21 offset:4096
    v_mfma_f32_16x16x32_bf16 v[104:107], v[136:139], v[152:155], v[104:107]
    ds_read_b128 v[172:175], v21 offset:6144
    v_mfma_f32_16x16x32_bf16 v[108:111], v[136:139], v[156:159], v[108:111]
    v_mfma_f32_16x16x32_bf16 v[112:115], v[140:143], v[144:147], v[112:115]
    v_mfma_f32_16x16x32_bf16 v[116:119], v[140:143], v[148:151], v[116:119]
    v_mfma_f32_16x16x32_bf16 v[120:123], v[140:143], v[152:155], v[120:123]
    v_mfma_f32_16x16x32_bf16 v[124:127], v[140:143], v[156:159], v[124:127]
    s_waitcnt lgkmcnt(0)
    s_barrier
    v_mfma_f32_16x16x32_bf16 v[64:67], v[160:163], v[176:179], v[64:67]
    ds_read_b128 v[128:131], v16 offset:0
    v_mfma_f32_16x16x32_bf16 v[68:71], v[160:163], v[180:183], v[68:71]
    ds_read_b128 v[144:147], v18 offset:16384
    v_mfma_f32_16x16x32_bf16 v[72:75], v[160:163], v[184:187], v[72:75]
    v_mfma_f32_16x16x32_bf16 v[76:79], v[160:163], v[188:191], v[76:79]
    ds_read_b128 v[148:151], v18 offset:18432
    v_mfma_f32_16x16x32_bf16 v[80:83], v[164:167], v[176:179], v[80:83]
    ds_read_b128 v[152:155], v18 offset:20480
    v_mfma_f32_16x16x32_bf16 v[84:87], v[164:167], v[180:183], v[84:87]
    v_mfma_f32_16x16x32_bf16 v[88:91], v[164:167], v[184:187], v[88:91]
    ds_read_b128 v[156:159], v18 offset:22528
    v_mfma_f32_16x16x32_bf16 v[92:95], v[164:167], v[188:191], v[92:95]
    ds_read_b128 v[132:135], v16 offset:2048
    v_mfma_f32_16x16x32_bf16 v[96:99], v[168:171], v[176:179], v[96:99]
    v_mfma_f32_16x16x32_bf16 v[100:103], v[168:171], v[180:183], v[100:103]
    ds_read_b128 v[136:139], v16 offset:4096
    v_mfma_f32_16x16x32_bf16 v[104:107], v[168:171], v[184:187], v[104:107]
    ds_read_b128 v[140:143], v16 offset:6144
    v_mfma_f32_16x16x32_bf16 v[108:111], v[168:171], v[188:191], v[108:111]
    v_mfma_f32_16x16x32_bf16 v[112:115], v[172:175], v[176:179], v[112:115]
    v_mfma_f32_16x16x32_bf16 v[116:119], v[172:175], v[180:183], v[116:119]
    v_mfma_f32_16x16x32_bf16 v[120:123], v[172:175], v[184:187], v[120:123]
    v_mfma_f32_16x16x32_bf16 v[124:127], v[172:175], v[188:191], v[124:127]
    s_waitcnt lgkmcnt(0)
    v_mfma_f32_16x16x32_bf16 v[64:67], v[128:131], v[144:147], v[64:67]
    ds_read_b128 v[160:163], v17 offset:0
    v_mfma_f32_16x16x32_bf16 v[68:71], v[128:131], v[148:151], v[68:71]
    ds_read_b128 v[176:179], v19 offset:16384
    v_mfma_f32_16x16x32_bf16 v[72:75], v[128:131], v[152:155], v[72:75]
    v_mfma_f32_16x16x32_bf16 v[76:79], v[128:131], v[156:159], v[76:79]
    ds_read_b128 v[180:183], v19 offset:18432
    v_mfma_f32_16x16x32_bf16 v[80:83], v[132:135], v[144:147], v[80:83]
    ds_read_b128 v[184:187], v19 offset:20480
    v_mfma_f32_16x16x32_bf16 v[84:87], v[132:135], v[148:151], v[84:87]
    v_mfma_f32_16x16x32_bf16 v[88:91], v[132:135], v[152:155], v[88:91]
    ds_read_b128 v[188:191], v19 offset:22528
    v_mfma_f32_16x16x32_bf16 v[92:95], v[132:135], v[156:159], v[92:95]
    ds_read_b128 v[164:167], v17 offset:2048
    v_mfma_f32_16x16x32_bf16 v[96:99], v[136:139], v[144:147], v[96:99]
    v_mfma_f32_16x16x32_bf16 v[100:103], v[136:139], v[148:151], v[100:103]
    ds_read_b128 v[168:171], v17 offset:4096
    v_mfma_f32_16x16x32_bf16 v[104:107], v[136:139], v[152:155], v[104:107]
    ds_read_b128 v[172:175], v17 offset:6144
    v_mfma_f32_16x16x32_bf16 v[108:111], v[136:139], v[156:159], v[108:111]
    v_mfma_f32_16x16x32_bf16 v[112:115], v[140:143], v[144:147], v[112:115]
    v_mfma_f32_16x16x32_bf16 v[116:119], v[140:143], v[148:151], v[116:119]
    v_mfma_f32_16x16x32_bf16 v[120:123], v[140:143], v[152:155], v[120:123]
    v_mfma_f32_16x16x32_bf16 v[124:127], v[140:143], v[156:159], v[124:127]
    s_waitcnt lgkmcnt(0) vmcnt(0)
    v_mfma_f32_16x16x32_bf16 v[64:67], v[160:163], v[176:179], v[64:67]
    v_mfma_f32_16x16x32_bf16 v[68:71], v[160:163], v[180:183], v[68:71]
    v_mfma_f32_16x16x32_bf16 v[72:75], v[160:163], v[184:187], v[72:75]
    v_mfma_f32_16x16x32_bf16 v[76:79], v[160:163], v[188:191], v[76:79]
    v_mfma_f32_16x16x32_bf16 v[80:83], v[164:167], v[176:179], v[80:83]
    v_mfma_f32_16x16x32_bf16 v[84:87], v[164:167], v[180:183], v[84:87]
    v_mfma_f32_16x16x32_bf16 v[88:91], v[164:167], v[184:187], v[88:91]
    v_mfma_f32_16x16x32_bf16 v[92:95], v[164:167], v[188:191], v[92:95]
    v_mfma_f32_16x16x32_bf16 v[96:99], v[168:171], v[176:179], v[96:99]
    v_mfma_f32_16x16x32_bf16 v[100:103], v[168:171], v[180:183], v[100:103]
    v_mfma_f32_16x16x32_bf16 v[104:107], v[168:171], v[184:187], v[104:107]
    v_mfma_f32_16x16x32_bf16 v[108:111], v[168:171], v[188:191], v[108:111]
    v_mfma_f32_16x16x32_bf16 v[112:115], v[172:175], v[176:179], v[112:115]
    v_mfma_f32_16x16x32_bf16 v[116:119], v[172:175], v[180:183], v[116:119]
    v_mfma_f32_16x16x32_bf16 v[120:123], v[172:175], v[184:187], v[120:123]
    v_mfma_f32_16x16x32_bf16 v[124:127], v[172:175], v[188:191], v[124:127]
    s_mov_b32 s44, 0
    s_mov_b32 s45, 4096
    s_mov_b32 s46, 8192
    s_mov_b32 s47, 12288
    v_mov_b32 v61, s93
    v_mov_b32 v63, s93
    v_and_b32 v216, 31, v24
    v_lshlrev_b32 v216, 2, v216
    v_add_u32 v216, 73728, v216
    v_mov_b32 v218, 0
    ds_write_b32 v216, v218
    v_pk_fma_f32 v[16:17], v[30:31], v[72:73], v[66:67] op_sel:[0,0,0] op_sel_hi:[0,1,1] neg_lo:[1,0,0] neg_hi:[1,0,0]
    v_pk_fma_f32 v[18:19], v[30:31], v[64:65], v[74:75] op_sel:[0,0,0] op_sel_hi:[0,1,1]
    v_pk_fma_f32 v[8:9], v[28:29], v[64:65], v[16:17] op_sel:[0,0,0] op_sel_hi:[0,1,1]
    v_pk_fma_f32 v[10:11], v[28:29], v[72:73], v[18:19] op_sel:[0,0,0] op_sel_hi:[0,1,1]
    v_pk_fma_f32 v[20:21], v[30:31], v[76:77], v[70:71] op_sel:[1,0,0] op_sel_hi:[1,1,1] neg_lo:[1,0,0] neg_hi:[1,0,0]
    v_pk_fma_f32 v[22:23], v[30:31], v[68:69], v[78:79] op_sel:[1,0,0] op_sel_hi:[1,1,1]
    v_pk_fma_f32 v[12:13], v[28:29], v[68:69], v[20:21] op_sel:[1,0,0] op_sel_hi:[1,1,1]
    v_pk_fma_f32 v[14:15], v[28:29], v[76:77], v[22:23] op_sel:[1,0,0] op_sel_hi:[1,1,1]
    v_pk_fma_f32 v[16:17], v[30:31], v[10:11], v[80:81] op_sel:[0,0,0] op_sel_hi:[0,1,1] neg_lo:[1,0,0] neg_hi:[1,0,0]
    v_pk_fma_f32 v[18:19], v[30:31], v[8:9], v[88:89] op_sel:[0,0,0] op_sel_hi:[0,1,1]
    v_pk_fma_f32 v[8:9], v[28:29], v[8:9], v[16:17] op_sel:[0,0,0] op_sel_hi:[0,1,1]
    v_pk_fma_f32 v[10:11], v[28:29], v[10:11], v[18:19] op_sel:[0,0,0] op_sel_hi:[0,1,1]
    v_pk_fma_f32 v[20:21], v[30:31], v[14:15], v[84:85] op_sel:[1,0,0] op_sel_hi:[1,1,1] neg_lo:[1,0,0] neg_hi:[1,0,0]
    v_pk_fma_f32 v[22:23], v[30:31], v[12:13], v[92:93] op_sel:[1,0,0] op_sel_hi:[1,1,1]
    v_pk_fma_f32 v[12:13], v[28:29], v[12:13], v[20:21] op_sel:[1,0,0] op_sel_hi:[1,1,1]
    v_pk_fma_f32 v[14:15], v[28:29], v[14:15], v[22:23] op_sel:[1,0,0] op_sel_hi:[1,1,1]
    v_pk_fma_f32 v[16:17], v[30:31], v[10:11], v[82:83] op_sel:[0,0,0] op_sel_hi:[0,1,1] neg_lo:[1,0,0] neg_hi:[1,0,0]
    v_pk_fma_f32 v[18:19], v[30:31], v[8:9], v[90:91] op_sel:[0,0,0] op_sel_hi:[0,1,1]
    v_pk_fma_f32 v[8:9], v[28:29], v[8:9], v[16:17] op_sel:[0,0,0] op_sel_hi:[0,1,1]
    v_pk_fma_f32 v[10:11], v[28:29], v[10:11], v[18:19] op_sel:[0,0,0] op_sel_hi:[0,1,1]
    v_pk_fma_f32 v[20:21], v[30:31], v[14:15], v[86:87] op_sel:[1,0,0] op_sel_hi:[1,1,1] neg_lo:[1,0,0] neg_hi:[1,0,0]
    v_pk_fma_f32 v[22:23], v[30:31], v[12:13], v[94:95] op_sel:[1,0,0] op_sel_hi:[1,1,1]
    v_pk_fma_f32 v[12:13], v[28:29], v[12:13], v[20:21] op_sel:[1,0,0] op_sel_hi:[1,1,1]
    v_pk_fma_f32 v[14:15], v[28:29], v[14:15], v[22:23] op_sel:[1,0,0] op_sel_hi:[1,1,1]
    v_pk_fma_f32 v[16:17], v[30:31], v[10:11], v[96:97] op_sel:[0,0,0] op_sel_hi:[0,1,1] neg_lo:[1,0,0] neg_hi:[1,0,0]
    v_pk_fma_f32 v[18:19], v[30:31], v[8:9], v[104:105] op_sel:[0,0,0] op_sel_hi:[0,1,1]
    v_pk_fma_f32 v[8:9], v[28:29], v[8:9], v[16:17] op_sel:[0,0,0] op_sel_hi:[0,1,1]
    v_pk_fma_f32 v[10:11], v[28:29], v[10:11], v[18:19] op_sel:[0,0,0] op_sel_hi:[0,1,1]
    v_pk_fma_f32 v[20:21], v[30:31], v[14:15], v[100:101] op_sel:[1,0,0] op_sel_hi:[1,1,1] neg_lo:[1,0,0] neg_hi:[1,0,0]
    v_pk_fma_f32 v[22:23], v[30:31], v[12:13], v[108:109] op_sel:[1,0,0] op_sel_hi:[1,1,1]
    v_pk_fma_f32 v[12:13], v[28:29], v[12:13], v[20:21] op_sel:[1,0,0] op_sel_hi:[1,1,1]
    v_pk_fma_f32 v[14:15], v[28:29], v[14:15], v[22:23] op_sel:[1,0,0] op_sel_hi:[1,1,1]
    v_pk_fma_f32 v[16:17], v[30:31], v[10:11], v[98:99] op_sel:[0,0,0] op_sel_hi:[0,1,1] neg_lo:[1,0,0] neg_hi:[1,0,0]
    v_pk_fma_f32 v[18:19], v[30:31], v[8:9], v[106:107] op_sel:[0,0,0] op_sel_hi:[0,1,1]
    v_pk_fma_f32 v[8:9], v[28:29], v[8:9], v[16:17] op_sel:[0,0,0] op_sel_hi:[0,1,1]
    v_pk_fma_f32 v[10:11], v[28:29], v[10:11], v[18:19] op_sel:[0,0,0] op_sel_hi:[0,1,1]
    v_pk_fma_f32 v[20:21], v[30:31], v[14:15], v[102:103] op_sel:[1,0,0] op_sel_hi:[1,1,1] neg_lo:[1,0,0] neg_hi:[1,0,0]
    v_pk_fma_f32 v[22:23], v[30:31], v[12:13], v[110:111] op_sel:[1,0,0] op_sel_hi:[1,1,1]
    v_pk_fma_f32 v[12:13], v[28:29], v[12:13], v[20:21] op_sel:[1,0,0] op_sel_hi:[1,1,1]
    v_pk_fma_f32 v[14:15], v[28:29], v[14:15], v[22:23] op_sel:[1,0,0] op_sel_hi:[1,1,1]
    v_pk_fma_f32 v[16:17], v[30:31], v[10:11], v[112:113] op_sel:[0,0,0] op_sel_hi:[0,1,1] neg_lo:[1,0,0] neg_hi:[1,0,0]
    v_pk_fma_f32 v[18:19], v[30:31], v[8:9], v[120:121] op_sel:[0,0,0] op_sel_hi:[0,1,1]
    v_pk_fma_f32 v[8:9], v[28:29], v[8:9], v[16:17] op_sel:[0,0,0] op_sel_hi:[0,1,1]
    v_pk_fma_f32 v[10:11], v[28:29], v[10:11], v[18:19] op_sel:[0,0,0] op_sel_hi:[0,1,1]
    v_pk_fma_f32 v[20:21], v[30:31], v[14:15], v[116:117] op_sel:[1,0,0] op_sel_hi:[1,1,1] neg_lo:[1,0,0] neg_hi:[1,0,0]
    v_pk_fma_f32 v[22:23], v[30:31], v[12:13], v[124:125] op_sel:[1,0,0] op_sel_hi:[1,1,1]
    v_pk_fma_f32 v[12:13], v[28:29], v[12:13], v[20:21] op_sel:[1,0,0] op_sel_hi:[1,1,1]
    v_pk_fma_f32 v[14:15], v[28:29], v[14:15], v[22:23] op_sel:[1,0,0] op_sel_hi:[1,1,1]
    v_pk_fma_f32 v[16:17], v[30:31], v[10:11], v[114:115] op_sel:[0,0,0] op_sel_hi:[0,1,1] neg_lo:[1,0,0] neg_hi:[1,0,0]
    v_pk_fma_f32 v[18:19], v[30:31], v[8:9], v[122:123] op_sel:[0,0,0] op_sel_hi:[0,1,1]
    v_pk_fma_f32 v[8:9], v[28:29], v[8:9], v[16:17] op_sel:[0,0,0] op_sel_hi:[0,1,1]
    v_pk_fma_f32 v[10:11], v[28:29], v[10:11], v[18:19] op_sel:[0,0,0] op_sel_hi:[0,1,1]
    v_pk_fma_f32 v[20:21], v[30:31], v[14:15], v[118:119] op_sel:[1,0,0] op_sel_hi:[1,1,1] neg_lo:[1,0,0] neg_hi:[1,0,0]
    v_pk_fma_f32 v[22:23], v[30:31], v[12:13], v[126:127] op_sel:[1,0,0] op_sel_hi:[1,1,1]
    v_pk_fma_f32 v[12:13], v[28:29], v[12:13], v[20:21] op_sel:[1,0,0] op_sel_hi:[1,1,1]
    v_pk_fma_f32 v[14:15], v[28:29], v[14:15], v[22:23] op_sel:[1,0,0] op_sel_hi:[1,1,1]
    v_fma_f32 v56, -v38, v10, v9
    v_fma_f32 v58, v38, v8, v11
    v_fma_f32 v57, -v39, v14, v13
    v_fma_f32 v59, v39, v12, v15
    v_fma_f32 v56, v36, v8, v56
    v_fma_f32 v58, v36, v10, v58
    v_fma_f32 v57, v37, v12, v57
    v_fma_f32 v59, v37, v14, v59
    ds_write_b128 v192, v[56:59]
    s_waitcnt lgkmcnt(0)
    s_barrier
    ds_read_b128 v[160:163], v193 offset:0
    ds_read_b128 v[164:167], v193 offset:512
    ds_read_b128 v[168:171], v193 offset:1024
    ds_read_b128 v[172:175], v193 offset:1536
    ds_read_b128 v[176:179], v193 offset:2048
    ds_read_b128 v[180:183], v193 offset:2560
    ds_read_b128 v[184:187], v193 offset:3072
    ds_read_b128 v[188:191], v193 offset:3584
    s_waitcnt lgkmcnt(6)
    v_pk_fma_f32 v[164:165], v[42:43], v[162:163], v[164:165] op_sel:[0,0,0] op_sel_hi:[1,1,1] neg_lo:[1,0,0] neg_hi:[1,0,0]
    v_pk_fma_f32 v[166:167], v[42:43], v[160:161], v[166:167] op_sel:[0,0,0] op_sel_hi:[1,1,1]
    v_pk_fma_f32 v[164:165], v[40:41], v[160:161], v[164:165] op_sel:[0,0,0] op_sel_hi:[1,1,1]
    v_pk_fma_f32 v[166:167], v[40:41], v[162:163], v[166:167] op_sel:[0,0,0] op_sel_hi:[1,1,1]
    s_waitcnt lgkmcnt(5)
    v_pk_fma_f32 v[168:169], v[42:43], v[166:167], v[168:169] op_sel:[0,0,0] op_sel_hi:[1,1,1] neg_lo:[1,0,0] neg_hi:[1,0,0]
    v_pk_fma_f32 v[170:171], v[42:43], v[164:165], v[170:171] op_sel:[0,0,0] op_sel_hi:[1,1,1]
    v_pk_fma_f32 v[168:169], v[40:41], v[164:165], v[168:169] op_sel:[0,0,0] op_sel_hi:[1,1,1]
    v_pk_fma_f32 v[170:171], v[40:41], v[166:167], v[170:171] op_sel:[0,0,0] op_sel_hi:[1,1,1]
    s_waitcnt lgkmcnt(4)
    v_pk_fma_f32 v[172:173], v[42:43], v[170:171], v[172:173] op_sel:[0,0,0] op_sel_hi:[1,1,1] neg_lo:[1,0,0] neg_hi:[1,0,0]
    v_pk_fma_f32 v[174:175], v[42:43], v[168:169], v[174:175] op_sel:[0,0,0] op_sel_hi:[1,1,1]
    v_pk_fma_f32 v[172:173], v[40:41], v[168:169], v[172:173] op_sel:[0,0,0] op_sel_hi:[1,1,1]
    v_pk_fma_f32 v[174:175], v[40:41], v[170:171], v[174:175] op_sel:[0,0,0] op_sel_hi:[1,1,1]
    s_waitcnt lgkmcnt(3)
    v_pk_fma_f32 v[176:177], v[42:43], v[174:175], v[176:177] op_sel:[0,0,0] op_sel_hi:[1,1,1] neg_lo:[1,0,0] neg_hi:[1,0,0]
    v_pk_fma_f32 v[178:179], v[42:43], v[172:173], v[178:179] op_sel:[0,0,0] op_sel_hi:[1,1,1]
    v_pk_fma_f32 v[176:177], v[40:41], v[172:173], v[176:177] op_sel:[0,0,0] op_sel_hi:[1,1,1]
    v_pk_fma_f32 v[178:179], v[40:41], v[174:175], v[178:179] op_sel:[0,0,0] op_sel_hi:[1,1,1]
    s_waitcnt lgkmcnt(2)
    v_pk_fma_f32 v[180:181], v[42:43], v[178:179], v[180:181] op_sel:[0,0,0] op_sel_hi:[1,1,1] neg_lo:[1,0,0] neg_hi:[1,0,0]
    v_pk_fma_f32 v[182:183], v[42:43], v[176:177], v[182:183] op_sel:[0,0,0] op_sel_hi:[1,1,1]
    v_pk_fma_f32 v[180:181], v[40:41], v[176:177], v[180:181] op_sel:[0,0,0] op_sel_hi:[1,1,1]
    v_pk_fma_f32 v[182:183], v[40:41], v[178:179], v[182:183] op_sel:[0,0,0] op_sel_hi:[1,1,1]
    s_waitcnt lgkmcnt(1)
    v_pk_fma_f32 v[184:185], v[42:43], v[182:183], v[184:185] op_sel:[0,0,0] op_sel_hi:[1,1,1] neg_lo:[1,0,0] neg_hi:[1,0,0]
    v_pk_fma_f32 v[186:187], v[42:43], v[180:181], v[186:187] op_sel:[0,0,0] op_sel_hi:[1,1,1]
    v_pk_fma_f32 v[184:185], v[40:41], v[180:181], v[184:185] op_sel:[0,0,0] op_sel_hi:[1,1,1]
    v_pk_fma_f32 v[186:187], v[40:41], v[182:183], v[186:187] op_sel:[0,0,0] op_sel_hi:[1,1,1]
    s_waitcnt lgkmcnt(0)
    v_pk_fma_f32 v[188:189], v[42:43], v[186:187], v[188:189] op_sel:[0,0,0] op_sel_hi:[1,1,1] neg_lo:[1,0,0] neg_hi:[1,0,0]
    v_pk_fma_f32 v[190:191], v[42:43], v[184:185], v[190:191] op_sel:[0,0,0] op_sel_hi:[1,1,1]
    v_pk_fma_f32 v[188:189], v[40:41], v[184:185], v[188:189] op_sel:[0,0,0] op_sel_hi:[1,1,1]
    v_pk_fma_f32 v[190:191], v[40:41], v[186:187], v[190:191] op_sel:[0,0,0] op_sel_hi:[1,1,1]
    v_cndmask_b32 v60, v188, v189, s[84:85]
    v_cndmask_b32 v62, v190, v191, s[84:85]
    s_cmp_lg_u32 s19, 0
    s_cbranch_scc1 L_nopub
    s_mov_b32 exec_hi, 0
    buffer_store_dwordx4 v[60:63], v27, s[24:27], 0 offen sc1
    s_mov_b32 exec_hi, -1
L_nopub:
    v_cndmask_b32 v16, 0, v172, s[98:99]
    v_cndmask_b32 v17, v160, v176, s[98:99]
    v_cndmask_b32 v18, v164, v180, s[98:99]
    v_cndmask_b32 v19, v168, v184, s[98:99]
    v_cndmask_b32 v16, v16, v17, s[84:85]
    v_cndmask_b32 v18, v18, v19, s[84:85]
    v_cndmask_b32 v216, v16, v18, s[86:87]
    v_cndmask_b32 v16, 0, v173, s[98:99]
    v_cndmask_b32 v17, v161, v177, s[98:99]
    v_cndmask_b32 v18, v165, v181, s[98:99]
    v_cndmask_b32 v19, v169, v185, s[98:99]
    v_cndmask_b32 v16, v16, v17, s[84:85]
    v_cndmask_b32 v18, v18, v19, s[84:85]
    v_cndmask_b32 v217, v16, v18, s[86:87]
    v_cndmask_b32 v16, 0, v174, s[98:99]
    v_cndmask_b32 v17, v162, v178, s[98:99]
    v_cndmask_b32 v18, v166, v182, s[98:99]
    v_cndmask_b32 v19, v170, v186, s[98:99]
    v_cndmask_b32 v16, v16, v17, s[84:85]
    v_cndmask_b32 v18, v18, v19, s[84:85]
    v_cndmask_b32 v218, v16, v18, s[86:87]
    v_cndmask_b32 v16, 0, v175, s[98:99]
    v_cndmask_b32 v17, v163, v179, s[98:99]
    v_cndmask_b32 v18, v167, v183, s[98:99]
    v_cndmask_b32 v19, v171, v187, s[98:99]
    v_cndmask_b32 v16, v16, v17, s[84:85]
    v_cndmask_b32 v18, v18, v19, s[84:85]
    v_cndmask_b32 v219, v16, v18, s[86:87]
    v_mov_b32 v16, v216
    v_mov_b32 v18, v218
    v_fma_f32 v17, -v38, v218, v8
    v_fma_f32 v19, v38, v216, v10
    v_fma_f32 v17, v36, v216, v17
    v_fma_f32 v19, v36, v218, v19
    v_pk_mul_f32 v[56:57], v[32:33], v[16:17] op_sel:[0,0] op_sel_hi:[0,1]
    v_pk_mul_f32 v[58:59], v[32:33], v[18:19] op_sel:[0,0] op_sel_hi:[0,1]
    v_pk_fma_f32 v[56:57], v[34:35], v[18:19], v[56:57] op_sel:[0,0,0] op_sel_hi:[0,1,1] neg_lo:[1,0,0] neg_hi:[1,0,0]
    v_pk_fma_f32 v[58:59], v[34:35], v[16:17], v[58:59] op_sel:[0,0,0] op_sel_hi:[0,1,1]
    v_mov_b32 v16, v217
    v_mov_b32 v18, v219
    v_fma_f32 v17, -v39, v219, v12
    v_fma_f32 v19, v39, v217, v14
    v_fma_f32 v17, v37, v217, v17
    v_fma_f32 v19, v37, v219, v19
    v_pk_mul_f32 v[60:61], v[32:33], v[16:17] op_sel:[1,0] op_sel_hi:[1,1]
    v_pk_mul_f32 v[62:63], v[32:33], v[18:19] op_sel:[1,0] op_sel_hi:[1,1]
    v_pk_fma_f32 v[60:61], v[34:35], v[18:19], v[60:61] op_sel:[1,0,0] op_sel_hi:[1,1,1] neg_lo:[1,0,0] neg_hi:[1,0,0]
    v_pk_fma_f32 v[62:63], v[34:35], v[16:17], v[62:63] op_sel:[1,0,0] op_sel_hi:[1,1,1]
    v_pk_mul_f32 v[128:129], v[32:33], v[72:73] op_sel:[0,0] op_sel_hi:[0,1]
    v_pk_fma_f32 v[128:129], v[34:35], v[64:65], v[128:129] op_sel:[0,0,0] op_sel_hi:[0,1,1]
    v_pk_mul_f32 v[64:65], v[32:33], v[64:65] op_sel:[0,0] op_sel_hi:[0,1]
    v_pk_fma_f32 v[64:65], v[34:35], v[72:73], v[64:65] op_sel:[0,0,0] op_sel_hi:[0,1,1] neg_lo:[1,0,0] neg_hi:[1,0,0]
    v_pk_mul_f32 v[144:145], v[32:33], v[76:77] op_sel:[1,0] op_sel_hi:[1,1]
    v_pk_fma_f32 v[144:145], v[34:35], v[68:69], v[144:145] op_sel:[1,0,0] op_sel_hi:[1,1,1]
    v_pk_mul_f32 v[68:69], v[32:33], v[68:69] op_sel:[1,0] op_sel_hi:[1,1]
    v_pk_fma_f32 v[68:69], v[34:35], v[76:77], v[68:69] op_sel:[1,0,0] op_sel_hi:[1,1,1] neg_lo:[1,0,0] neg_hi:[1,0,0]
    v_pk_mul_f32 v[130:131], v[32:33], v[74:75] op_sel:[0,0] op_sel_hi:[0,1]
    v_pk_fma_f32 v[130:131], v[34:35], v[66:67], v[130:131] op_sel:[0,0,0] op_sel_hi:[0,1,1]
    v_pk_mul_f32 v[66:67], v[32:33], v[66:67] op_sel:[0,0] op_sel_hi:[0,1]
    v_pk_fma_f32 v[66:67], v[34:35], v[74:75], v[66:67] op_sel:[0,0,0] op_sel_hi:[0,1,1] neg_lo:[1,0,0] neg_hi:[1,0,0]
    v_pk_mul_f32 v[146:147], v[32:33], v[78:79] op_sel:[1,0] op_sel_hi:[1,1]
    v_pk_fma_f32 v[146:147], v[34:35], v[70:71], v[146:147] op_sel:[1,0,0] op_sel_hi:[1,1,1]
    v_pk_mul_f32 v[70:71], v[32:33], v[70:71] op_sel:[1,0] op_sel_hi:[1,1]
    v_pk_fma_f32 v[70:71], v[34:35], v[78:79], v[70:71] op_sel:[1,0,0] op_sel_hi:[1,1,1] neg_lo:[1,0,0] neg_hi:[1,0,0]
    v_pk_mul_f32 v[132:133], v[32:33], v[88:89] op_sel:[0,0] op_sel_hi:[0,1]
    v_pk_fma_f32 v[132:133], v[34:35], v[80:81], v[132:133] op_sel:[0,0,0] op_sel_hi:[0,1,1]
    v_pk_mul_f32 v[80:81], v[32:33], v[80:81] op_sel:[0,0] op_sel_hi:[0,1]
    v_pk_fma_f32 v[80:81], v[34:35], v[88:89], v[80:81] op_sel:[0,0,0] op_sel_hi:[0,1,1] neg_lo:[1,0,0] neg_hi:[1,0,0]
    v_pk_mul_f32 v[148:149], v[32:33], v[92:93] op_sel:[1,0] op_sel_hi:[1,1]
    v_pk_fma_f32 v[148:149], v[34:35], v[84:85], v[148:149] op_sel:[1,0,0] op_sel_hi:[1,1,1]
    v_pk_mul_f32 v[84:85], v[32:33], v[84:85] op_sel:[1,0] op_sel_hi:[1,1]
    v_pk_fma_f32 v[84:85], v[34:35], v[92:93], v[84:85] op_sel:[1,0,0] op_sel_hi:[1,1,1] neg_lo:[1,0,0] neg_hi:[1,0,0]
    v_pk_mul_f32 v[134:135], v[32:33], v[90:91] op_sel:[0,0] op_sel_hi:[0,1]
    v_pk_fma_f32 v[134:135], v[34:35], v[82:83], v[134:135] op_sel:[0,0,0] op_sel_hi:[0,1,1]
    v_pk_mul_f32 v[82:83], v[32:33], v[82:83] op_sel:[0,0] op_sel_hi:[0,1]
    v_pk_fma_f32 v[82:83], v[34:35], v[90:91], v[82:83] op_sel:[0,0,0] op_sel_hi:[0,1,1] neg_lo:[1,0,0] neg_hi:[1,0,0]
    v_pk_mul_f32 v[150:151], v[32:33], v[94:95] op_sel:[1,0] op_sel_hi:[1,1]
    v_pk_fma_f32 v[150:151], v[34:35], v[86:87], v[150:151] op_sel:[1,0,0] op_sel_hi:[1,1,1]
    v_pk_mul_f32 v[86:87], v[32:33], v[86:87] op_sel:[1,0] op_sel_hi:[1,1]
    v_pk_fma_f32 v[86:87], v[34:35], v[94:95], v[86:87] op_sel:[1,0,0] op_sel_hi:[1,1,1] neg_lo:[1,0,0] neg_hi:[1,0,0]
    v_pk_mul_f32 v[136:137], v[32:33], v[104:105] op_sel:[0,0] op_sel_hi:[0,1]
    v_pk_fma_f32 v[136:137], v[34:35], v[96:97], v[136:137] op_sel:[0,0,0] op_sel_hi:[0,1,1]
    v_pk_mul_f32 v[96:97], v[32:33], v[96:97] op_sel:[0,0] op_sel_hi:[0,1]
    v_pk_fma_f32 v[96:97], v[34:35], v[104:105], v[96:97] op_sel:[0,0,0] op_sel_hi:[0,1,1] neg_lo:[1,0,0] neg_hi:[1,0,0]
    v_pk_mul_f32 v[152:153], v[32:33], v[108:109] op_sel:[1,0] op_sel_hi:[1,1]
    v_pk_fma_f32 v[152:153], v[34:35], v[100:101], v[152:153] op_sel:[1,0,0] op_sel_hi:[1,1,1]
    v_pk_mul_f32 v[100:101], v[32:33], v[100:101] op_sel:[1,0] op_sel_hi:[1,1]
    v_pk_fma_f32 v[100:101], v[34:35], v[108:109], v[100:101] op_sel:[1,0,0] op_sel_hi:[1,1,1] neg_lo:[1,0,0] neg_hi:[1,0,0]
    v_pk_mul_f32 v[138:139], v[32:33], v[106:107] op_sel:[0,0] op_sel_hi:[0,1]
    v_pk_fma_f32 v[138:139], v[34:35], v[98:99], v[138:139] op_sel:[0,0,0] op_sel_hi:[0,1,1]
    v_pk_mul_f32 v[98:99], v[32:33], v[98:99] op_sel:[0,0] op_sel_hi:[0,1]
    v_pk_fma_f32 v[98:99], v[34:35], v[106:107], v[98:99] op_sel:[0,0,0] op_sel_hi:[0,1,1] neg_lo:[1,0,0] neg_hi:[1,0,0]
    v_pk_mul_f32 v[154:155], v[32:33], v[110:111] op_sel:[1,0] op_sel_hi:[1,1]
    v_pk_fma_f32 v[154:155], v[34:35], v[102:103], v[154:155] op_sel:[1,0,0] op_sel_hi:[1,1,1]
    v_pk_mul_f32 v[102:103], v[32:33], v[102:103] op_sel:[1,0] op_sel_hi:[1,1]
    v_pk_fma_f32 v[102:103], v[34:35], v[110:111], v[102:103] op_sel:[1,0,0] op_sel_hi:[1,1,1] neg_lo:[1,0,0] neg_hi:[1,0,0]
    v_pk_mul_f32 v[140:141], v[32:33], v[120:121] op_sel:[0,0] op_sel_hi:[0,1]
    v_pk_fma_f32 v[140:141], v[34:35], v[112:113], v[140:141] op_sel:[0,0,0] op_sel_hi:[0,1,1]
    v_pk_mul_f32 v[112:113], v[32:33], v[112:113] op_sel:[0,0] op_sel_hi:[0,1]
    v_pk_fma_f32 v[112:113], v[34:35], v[120:121], v[112:113] op_sel:[0,0,0] op_sel_hi:[0,1,1] neg_lo:[1,0,0] neg_hi:[1,0,0]
    buffer_load_dwordx4 v[160:163], v194, s[24:27], s44 offen offset:0 sc1
    buffer_load_dwordx4 v[164:167], v194, s[24:27], s45 offen offset:0 sc1
    buffer_load_dwordx4 v[168:171], v194, s[24:27], s46 offen offset:0 sc1
    buffer_load_dwordx4 v[172:175], v194, s[24:27], s47 offen offset:0 sc1
    buffer_load_dwordx4 v[176:179], v194, s[24:27], s44 offen offset:256 sc1
    buffer_load_dwordx4 v[180:183], v194, s[24:27], s45 offen offset:256 sc1
    buffer_load_dwordx4 v[184:187], v194, s[24:27], s46 offen offset:256 sc1
    buffer_load_dwordx4 v[188:191], v194, s[24:27], s47 offen offset:256 sc1
    v_pk_mul_f32 v[156:157], v[32:33], v[124:125] op_sel:[1,0] op_sel_hi:[1,1]
    v_pk_fma_f32 v[156:157], v[34:35], v[116:117], v[156:157] op_sel:[1,0,0] op_sel_hi:[1,1,1]
    v_pk_mul_f32 v[116:117], v[32:33], v[116:117] op_sel:[1,0] op_sel_hi:[1,1]
    v_pk_fma_f32 v[116:117], v[34:35], v[124:125], v[116:117] op_sel:[1,0,0] op_sel_hi:[1,1,1] neg_lo:[1,0,0] neg_hi:[1,0,0]
    v_pk_mul_f32 v[142:143], v[32:33], v[122:123] op_sel:[0,0] op_sel_hi:[0,1]
    v_pk_fma_f32 v[142:143], v[34:35], v[114:115], v[142:143] op_sel:[0,0,0] op_sel_hi:[0,1,1]
    v_pk_mul_f32 v[114:115], v[32:33], v[114:115] op_sel:[0,0] op_sel_hi:[0,1]
    v_pk_fma_f32 v[114:115], v[34:35], v[122:123], v[114:115] op_sel:[0,0,0] op_sel_hi:[0,1,1] neg_lo:[1,0,0] neg_hi:[1,0,0]
    v_pk_mul_f32 v[158:159], v[32:33], v[126:127] op_sel:[1,0] op_sel_hi:[1,1]
    v_pk_fma_f32 v[158:159], v[34:35], v[118:119], v[158:159] op_sel:[1,0,0] op_sel_hi:[1,1,1]
    v_pk_mul_f32 v[118:119], v[32:33], v[118:119] op_sel:[1,0] op_sel_hi:[1,1]
    v_pk_fma_f32 v[118:119], v[34:35], v[126:127], v[118:119] op_sel:[1,0,0] op_sel_hi:[1,1,1] neg_lo:[1,0,0] neg_hi:[1,0,0]
    buffer_load_dwordx2 v[240:241], v221, s[12:15], s57 offen sc1
    global_load_dwordx2 v[242:243], v222, s[58:59]
    buffer_load_dwordx2 v[224:225], v220, s[4:7], s56 offen
    s_add_u32 s56, s56, 8192
    buffer_load_dwordx2 v[226:227], v220, s[4:7], s56 offen
    s_add_u32 s56, s56, 8192
    buffer_load_dwordx2 v[228:229], v220, s[4:7], s56 offen
    s_add_u32 s56, s56, 8192
    buffer_load_dwordx2 v[230:231], v220, s[4:7], s56 offen
    s_add_u32 s56, s56, 8192
    buffer_load_dwordx2 v[232:233], v220, s[4:7], s56 offen
    s_add_u32 s56, s56, 8192
    buffer_load_dwordx2 v[234:235], v220, s[4:7], s56 offen
    s_add_u32 s56, s56, 8192
    buffer_load_dwordx2 v[236:237], v220, s[4:7], s56 offen
    s_add_u32 s56, s56, 8192
    buffer_load_dwordx2 v[238:239], v220, s[4:7], s56 offen
    s_add_u32 s56, s56, 8192
    s_waitcnt vmcnt(10)
L_poll:
    v_xor_b32 v161, v161, v198
    v_xor_b32 v163, v163, v198
    v_xor_b32 v165, v165, v199
    v_xor_b32 v167, v167, v199
    v_xor_b32 v169, v169, v200
    v_xor_b32 v171, v171, v200
    v_xor_b32 v173, v173, v201
    v_xor_b32 v175, v175, v201
    v_xor_b32 v177, v177, v198
    v_xor_b32 v179, v179, v198
    v_xor_b32 v181, v181, v199
    v_xor_b32 v183, v183, v199
    v_xor_b32 v185, v185, v200
    v_xor_b32 v187, v187, v200
    v_xor_b32 v189, v189, v201
    v_xor_b32 v191, v191, v201
    v_or3_b32 v214, v161, v163, v165
    v_or3_b32 v214, v214, v167, v169
    v_or3_b32 v214, v214, v171, v173
    v_or3_b32 v214, v214, v175, v177
    v_or3_b32 v214, v214, v179, v181
    v_or3_b32 v214, v214, v183, v185
    v_or3_b32 v214, v214, v187, v189
    v_or_b32 v214, v214, v191
    v_cmp_ne_u32 vcc, 0, v214
    s_nop 1
    s_cmp_eq_u64 vcc, 0
    s_cbranch_scc1 L_got
    s_sub_u32 s96, s96, 1
    s_cbranch_scc1 L_got
    s_sleep 1
    buffer_load_dwordx4 v[160:163], v194, s[24:27], s44 offen offset:0 sc1
    buffer_load_dwordx4 v[164:167], v194, s[24:27], s45 offen offset:0 sc1
    buffer_load_dwordx4 v[168:171], v194, s[24:27], s46 offen offset:0 sc1
    buffer_load_dwordx4 v[172:175], v194, s[24:27], s47 offen offset:0 sc1
    buffer_load_dwordx4 v[176:179], v194, s[24:27], s44 offen offset:256 sc1
    buffer_load_dwordx4 v[180:183], v194, s[24:27], s45 offen offset:256 sc1
    buffer_load_dwordx4 v[184:187], v194, s[24:27], s46 offen offset:256 sc1
    buffer_load_dwordx4 v[188:191], v194, s[24:27], s47 offen offset:256 sc1
    s_waitcnt vmcnt(0)
    s_branch L_poll
L_got:
    v_fma_f32 v168, -v46, v174, v168
    v_fma_f32 v170, v46, v172, v170
    v_fma_f32 v168, v44, v172, v168
    v_fma_f32 v170, v44, v174, v170
    v_fma_f32 v184, -v47, v190, v184
    v_fma_f32 v186, v47, v188, v186
    v_fma_f32 v184, v45, v188, v184
    v_fma_f32 v186, v45, v190, v186
    v_fma_f32 v164, -v46, v170, v164
    v_fma_f32 v166, v46, v168, v166
    v_fma_f32 v164, v44, v168, v164
    v_fma_f32 v166, v44, v170, v166
    v_fma_f32 v180, -v47, v186, v180
    v_fma_f32 v182, v47, v184, v182
    v_fma_f32 v180, v45, v184, v180
    v_fma_f32 v182, v45, v186, v182
    v_fma_f32 v160, -v46, v166, v160
    v_fma_f32 v162, v46, v164, v162
    v_fma_f32 v160, v44, v164, v160
    v_fma_f32 v162, v44, v166, v162
    v_fma_f32 v176, -v47, v182, v176
    v_fma_f32 v178, v47, v180, v178
    v_fma_f32 v176, v45, v180, v176
    v_fma_f32 v178, v45, v182, v178
    v_mul_f32 v16, v48, v160
    v_mul_f32 v17, v48, v162
    v_fma_f32 v16, -v50, v162, v16
    v_fma_f32 v17, v50, v160, v17
    v_mul_f32 v18, v49, v176
    v_mul_f32 v19, v49, v178
    v_fma_f32 v18, -v51, v178, v18
    v_fma_f32 v19, v51, v176, v19
    v_mov_b32 v20, v16
    v_mov_b32 v21, v17
    v_mov_b32 v22, v18
    v_mov_b32 v23, v19
    s_nop 1
    v_permlane16_swap_b32 v16, v20
    v_permlane16_swap_b32 v17, v21
    v_permlane16_swap_b32 v18, v22
    v_permlane16_swap_b32 v19, v23
    s_nop 1
    v_add_f32 v16, v16, v20
    v_add_f32 v17, v17, v21
    v_add_f32 v18, v18, v22
    v_add_f32 v19, v19, v23
    v_mov_b32 v20, v16
    v_mov_b32 v21, v17
    v_mov_b32 v22, v18
    v_mov_b32 v23, v19
    s_nop 1
    v_permlane32_swap_b32 v16, v20
    v_permlane32_swap_b32 v17, v21
    v_permlane32_swap_b32 v18, v22
    v_permlane32_swap_b32 v19, v23
    s_nop 1
    v_add_f32 v16, v16, v20
    v_add_f32 v17, v17, v21
    v_add_f32 v18, v18, v22
    v_add_f32 v19, v19, v23
    v_pk_fma_f32 v[56:57], v[16:17], v[206:207], v[56:57] op_sel:[0,0,0] op_sel_hi:[0,1,1]
    v_pk_fma_f32 v[58:59], v[16:17], v[208:209], v[58:59] op_sel:[0,0,0] op_sel_hi:[0,1,1]
    v_pk_fma_f32 v[56:57], v[16:17], v[208:209], v[56:57] op_sel:[1,0,0] op_sel_hi:[1,1,1] neg_lo:[1,0,0] neg_hi:[1,0,0]
    v_pk_fma_f32 v[58:59], v[16:17], v[206:207], v[58:59] op_sel:[1,0,0] op_sel_hi:[1,1,1]
    v_pk_fma_f32 v[60:61], v[18:19], v[210:211], v[60:61] op_sel:[0,0,0] op_sel_hi:[0,1,1]
    v_pk_fma_f32 v[62:63], v[18:19], v[212:213], v[62:63] op_sel:[0,0,0] op_sel_hi:[0,1,1]
    v_pk_fma_f32 v[60:61], v[18:19], v[212:213], v[60:61] op_sel:[1,0,0] op_sel_hi:[1,1,1] neg_lo:[1,0,0] neg_hi:[1,0,0]
    v_pk_fma_f32 v[62:63], v[18:19], v[210:211], v[62:63] op_sel:[1,0,0] op_sel_hi:[1,1,1]
    v_pk_fma_f32 v[64:65], v[30:31], v[58:59], v[64:65] op_sel:[0,0,0] op_sel_hi:[0,1,1] neg_lo:[1,0,0] neg_hi:[1,0,0]
    v_pk_fma_f32 v[128:129], v[30:31], v[56:57], v[128:129] op_sel:[0,0,0] op_sel_hi:[0,1,1]
    v_pk_fma_f32 v[64:65], v[28:29], v[56:57], v[64:65] op_sel:[0,0,0] op_sel_hi:[0,1,1]
    v_pk_fma_f32 v[128:129], v[28:29], v[58:59], v[128:129] op_sel:[0,0,0] op_sel_hi:[0,1,1]
    v_pk_fma_f32 v[68:69], v[30:31], v[62:63], v[68:69] op_sel:[1,0,0] op_sel_hi:[1,1,1] neg_lo:[1,0,0] neg_hi:[1,0,0]
    v_pk_fma_f32 v[144:145], v[30:31], v[60:61], v[144:145] op_sel:[1,0,0] op_sel_hi:[1,1,1]
    v_pk_fma_f32 v[68:69], v[28:29], v[60:61], v[68:69] op_sel:[1,0,0] op_sel_hi:[1,1,1]
    v_pk_fma_f32 v[144:145], v[28:29], v[62:63], v[144:145] op_sel:[1,0,0] op_sel_hi:[1,1,1]
    v_pk_fma_f32 v[66:67], v[30:31], v[128:129], v[66:67] op_sel:[0,0,0] op_sel_hi:[0,1,1] neg_lo:[1,0,0] neg_hi:[1,0,0]
    v_pk_fma_f32 v[130:131], v[30:31], v[64:65], v[130:131] op_sel:[0,0,0] op_sel_hi:[0,1,1]
    v_pk_fma_f32 v[66:67], v[28:29], v[64:65], v[66:67] op_sel:[0,0,0] op_sel_hi:[0,1,1]
    v_pk_fma_f32 v[130:131], v[28:29], v[128:129], v[130:131] op_sel:[0,0,0] op_sel_hi:[0,1,1]
    v_pk_fma_f32 v[70:71], v[30:31], v[144:145], v[70:71] op_sel:[1,0,0] op_sel_hi:[1,1,1] neg_lo:[1,0,0] neg_hi:[1,0,0]
    v_pk_fma_f32 v[146:147], v[30:31], v[68:69], v[146:147] op_sel:[1,0,0] op_sel_hi:[1,1,1]
    v_pk_fma_f32 v[70:71], v[28:29], v[68:69], v[70:71] op_sel:[1,0,0] op_sel_hi:[1,1,1]
    v_pk_fma_f32 v[146:147], v[28:29], v[144:145], v[146:147] op_sel:[1,0,0] op_sel_hi:[1,1,1]
    v_cvt_pk_bf16_f32 v160, v64, v66
    v_cvt_pk_bf16_f32 v168, -v128, -v130
    v_cvt_pk_bf16_f32 v164, v65, v67
    v_cvt_pk_bf16_f32 v172, -v129, -v131
    v_cvt_pk_bf16_f32 v176, v68, v70
    v_cvt_pk_bf16_f32 v184, -v144, -v146
    v_cvt_pk_bf16_f32 v180, v69, v71
    v_cvt_pk_bf16_f32 v188, -v145, -v147
    v_pk_fma_f32 v[80:81], v[30:31], v[130:131], v[80:81] op_sel:[0,0,0] op_sel_hi:[0,1,1] neg_lo:[1,0,0] neg_hi:[1,0,0]
    v_pk_fma_f32 v[132:133], v[30:31], v[66:67], v[132:133] op_sel:[0,0,0] op_sel_hi:[0,1,1]
    v_pk_fma_f32 v[80:81], v[28:29], v[66:67], v[80:81] op_sel:[0,0,0] op_sel_hi:[0,1,1]
    v_pk_fma_f32 v[132:133], v[28:29], v[130:131], v[132:133] op_sel:[0,0,0] op_sel_hi:[0,1,1]
    v_pk_fma_f32 v[84:85], v[30:31], v[146:147], v[84:85] op_sel:[1,0,0] op_sel_hi:[1,1,1] neg_lo:[1,0,0] neg_hi:[1,0,0]
    v_pk_fma_f32 v[148:149], v[30:31], v[70:71], v[148:149] op_sel:[1,0,0] op_sel_hi:[1,1,1]
    v_pk_fma_f32 v[84:85], v[28:29], v[70:71], v[84:85] op_sel:[1,0,0] op_sel_hi:[1,1,1]
    v_pk_fma_f32 v[148:149], v[28:29], v[146:147], v[148:149] op_sel:[1,0,0] op_sel_hi:[1,1,1]
    v_pk_fma_f32 v[82:83], v[30:31], v[132:133], v[82:83] op_sel:[0,0,0] op_sel_hi:[0,1,1] neg_lo:[1,0,0] neg_hi:[1,0,0]
    v_pk_fma_f32 v[134:135], v[30:31], v[80:81], v[134:135] op_sel:[0,0,0] op_sel_hi:[0,1,1]
    v_pk_fma_f32 v[82:83], v[28:29], v[80:81], v[82:83] op_sel:[0,0,0] op_sel_hi:[0,1,1]
    v_pk_fma_f32 v[134:135], v[28:29], v[132:133], v[134:135] op_sel:[0,0,0] op_sel_hi:[0,1,1]
    v_pk_fma_f32 v[86:87], v[30:31], v[148:149], v[86:87] op_sel:[1,0,0] op_sel_hi:[1,1,1] neg_lo:[1,0,0] neg_hi:[1,0,0]
    v_pk_fma_f32 v[150:151], v[30:31], v[84:85], v[150:151] op_sel:[1,0,0] op_sel_hi:[1,1,1]
    v_pk_fma_f32 v[86:87], v[28:29], v[84:85], v[86:87] op_sel:[1,0,0] op_sel_hi:[1,1,1]
    v_pk_fma_f32 v[150:151], v[28:29], v[148:149], v[150:151] op_sel:[1,0,0] op_sel_hi:[1,1,1]
    v_cvt_pk_bf16_f32 v161, v80, v82
    v_cvt_pk_bf16_f32 v169, -v132, -v134
    v_cvt_pk_bf16_f32 v165, v81, v83
    v_cvt_pk_bf16_f32 v173, -v133, -v135
    v_cvt_pk_bf16_f32 v177, v84, v86
    v_cvt_pk_bf16_f32 v185, -v148, -v150
    v_cvt_pk_bf16_f32 v181, v85, v87
    v_cvt_pk_bf16_f32 v189, -v149, -v151
    v_pk_fma_f32 v[96:97], v[30:31], v[134:135], v[96:97] op_sel:[0,0,0] op_sel_hi:[0,1,1] neg_lo:[1,0,0] neg_hi:[1,0,0]
    v_pk_fma_f32 v[136:137], v[30:31], v[82:83], v[136:137] op_sel:[0,0,0] op_sel_hi:[0,1,1]
    v_pk_fma_f32 v[96:97], v[28:29], v[82:83], v[96:97] op_sel:[0,0,0] op_sel_hi:[0,1,1]
    v_pk_fma_f32 v[136:137], v[28:29], v[134:135], v[136:137] op_sel:[0,0,0] op_sel_hi:[0,1,1]
    v_pk_fma_f32 v[100:101], v[30:31], v[150:151], v[100:101] op_sel:[1,0,0] op_sel_hi:[1,1,1] neg_lo:[1,0,0] neg_hi:[1,0,0]
    v_pk_fma_f32 v[152:153], v[30:31], v[86:87], v[152:153] op_sel:[1,0,0] op_sel_hi:[1,1,1]
    v_pk_fma_f32 v[100:101], v[28:29], v[86:87], v[100:101] op_sel:[1,0,0] op_sel_hi:[1,1,1]
    v_pk_fma_f32 v[152:153], v[28:29], v[150:151], v[152:153] op_sel:[1,0,0] op_sel_hi:[1,1,1]
    v_pk_fma_f32 v[98:99], v[30:31], v[136:137], v[98:99] op_sel:[0,0,0] op_sel_hi:[0,1,1] neg_lo:[1,0,0] neg_hi:[1,0,0]
    v_pk_fma_f32 v[138:139], v[30:31], v[96:97], v[138:139] op_sel:[0,0,0] op_sel_hi:[0,1,1]
    v_pk_fma_f32 v[98:99], v[28:29], v[96:97], v[98:99] op_sel:[0,0,0] op_sel_hi:[0,1,1]
    v_pk_fma_f32 v[138:139], v[28:29], v[136:137], v[138:139] op_sel:[0,0,0] op_sel_hi:[0,1,1]
    v_pk_fma_f32 v[102:103], v[30:31], v[152:153], v[102:103] op_sel:[1,0,0] op_sel_hi:[1,1,1] neg_lo:[1,0,0] neg_hi:[1,0,0]
    v_pk_fma_f32 v[154:155], v[30:31], v[100:101], v[154:155] op_sel:[1,0,0] op_sel_hi:[1,1,1]
    v_pk_fma_f32 v[102:103], v[28:29], v[100:101], v[102:103] op_sel:[1,0,0] op_sel_hi:[1,1,1]
    v_pk_fma_f32 v[154:155], v[28:29], v[152:153], v[154:155] op_sel:[1,0,0] op_sel_hi:[1,1,1]
    v_cvt_pk_bf16_f32 v162, v96, v98
    v_cvt_pk_bf16_f32 v170, -v136, -v138
    v_cvt_pk_bf16_f32 v166, v97, v99
    v_cvt_pk_bf16_f32 v174, -v137, -v139
    v_cvt_pk_bf16_f32 v178, v100, v102
    v_cvt_pk_bf16_f32 v186, -v152, -v154
    v_cvt_pk_bf16_f32 v182, v101, v103
    v_cvt_pk_bf16_f32 v190, -v153, -v155
    v_pk_fma_f32 v[112:113], v[30:31], v[138:139], v[112:113] op_sel:[0,0,0] op_sel_hi:[0,1,1] neg_lo:[1,0,0] neg_hi:[1,0,0]
    v_pk_fma_f32 v[140:141], v[30:31], v[98:99], v[140:141] op_sel:[0,0,0] op_sel_hi:[0,1,1]
    v_pk_fma_f32 v[112:113], v[28:29], v[98:99], v[112:113] op_sel:[0,0,0] op_sel_hi:[0,1,1]
    v_pk_fma_f32 v[140:141], v[28:29], v[138:139], v[140:141] op_sel:[0,0,0] op_sel_hi:[0,1,1]
    v_pk_fma_f32 v[116:117], v[30:31], v[154:155], v[116:117] op_sel:[1,0,0] op_sel_hi:[1,1,1] neg_lo:[1,0,0] neg_hi:[1,0,0]
    v_pk_fma_f32 v[156:157], v[30:31], v[102:103], v[156:157] op_sel:[1,0,0] op_sel_hi:[1,1,1]
    v_pk_fma_f32 v[116:117], v[28:29], v[102:103], v[116:117] op_sel:[1,0,0] op_sel_hi:[1,1,1]
    v_pk_fma_f32 v[156:157], v[28:29], v[154:155], v[156:157] op_sel:[1,0,0] op_sel_hi:[1,1,1]
    v_pk_fma_f32 v[114:115], v[30:31], v[140:141], v[114:115] op_sel:[0,0,0] op_sel_hi:[0,1,1] neg_lo:[1,0,0] neg_hi:[1,0,0]
    v_pk_fma_f32 v[142:143], v[30:31], v[112:113], v[142:143] op_sel:[0,0,0] op_sel_hi:[0,1,1]
    v_pk_fma_f32 v[114:115], v[28:29], v[112:113], v[114:115] op_sel:[0,0,0] op_sel_hi:[0,1,1]
    v_pk_fma_f32 v[142:143], v[28:29], v[140:141], v[142:143] op_sel:[0,0,0] op_sel_hi:[0,1,1]
    v_pk_fma_f32 v[118:119], v[30:31], v[156:157], v[118:119] op_sel:[1,0,0] op_sel_hi:[1,1,1] neg_lo:[1,0,0] neg_hi:[1,0,0]
    v_pk_fma_f32 v[158:159], v[30:31], v[116:117], v[158:159] op_sel:[1,0,0] op_sel_hi:[1,1,1]
    v_pk_fma_f32 v[118:119], v[28:29], v[116:117], v[118:119] op_sel:[1,0,0] op_sel_hi:[1,1,1]
    v_pk_fma_f32 v[158:159], v[28:29], v[156:157], v[158:159] op_sel:[1,0,0] op_sel_hi:[1,1,1]
    v_cvt_pk_bf16_f32 v163, v112, v114
    v_cvt_pk_bf16_f32 v171, -v140, -v142
    v_cvt_pk_bf16_f32 v167, v113, v115
    v_cvt_pk_bf16_f32 v175, -v141, -v143
    v_cvt_pk_bf16_f32 v179, v116, v118
    v_cvt_pk_bf16_f32 v187, -v156, -v158
    v_cvt_pk_bf16_f32 v183, v117, v119
    v_cvt_pk_bf16_f32 v191, -v157, -v159
    ds_write_b128 v195, v[160:163] offset:0
    ds_write_b128 v195, v[164:167] offset:16
    ds_write_b128 v195, v[176:179] offset:2304
    ds_write_b128 v195, v[180:183] offset:2320
    ds_write_b128 v195, v[168:171] offset:4608
    ds_write_b128 v195, v[172:175] offset:4624
    ds_write_b128 v195, v[184:187] offset:6912
    ds_write_b128 v195, v[188:191] offset:6928
    s_waitcnt lgkmcnt(4)
    ds_read_b64_tr_b16 v[128:129], v196 offset:0
    ds_read_b64_tr_b16 v[130:131], v196 offset:576
    ds_read_b64_tr_b16 v[132:133], v196 offset:32
    ds_read_b64_tr_b16 v[134:135], v196 offset:608
    ds_read_b64_tr_b16 v[136:137], v196 offset:64
    ds_read_b64_tr_b16 v[138:139], v196 offset:640
    ds_read_b64_tr_b16 v[140:141], v196 offset:96
    ds_read_b64_tr_b16 v[142:143], v196 offset:672
    s_waitcnt lgkmcnt(8)
    ds_read_b64_tr_b16 v[144:145], v196 offset:4608
    ds_read_b64_tr_b16 v[146:147], v196 offset:5184
    ds_read_b64_tr_b16 v[148:149], v196 offset:4640
    ds_read_b64_tr_b16 v[150:151], v196 offset:5216
    ds_read_b64_tr_b16 v[152:153], v196 offset:4672
    ds_read_b64_tr_b16 v[154:155], v196 offset:5248
    ds_read_b64_tr_b16 v[156:157], v196 offset:4704
    ds_read_b64_tr_b16 v[158:159], v196 offset:5280
    s_add_u32 s39, s53, 0
    s_waitcnt lgkmcnt(14)
    buffer_store_dwordx4 v[128:131], v197, s[12:15], s39 offen offset:0 sc1
    s_waitcnt lgkmcnt(12)
    buffer_store_dwordx4 v[132:135], v197, s[12:15], s39 offen offset:1024 sc1
    s_add_u32 s39, s53, 8192
    s_waitcnt lgkmcnt(10)
    buffer_store_dwordx4 v[136:139], v197, s[12:15], s39 offen offset:0 sc1
    s_waitcnt lgkmcnt(8)
    buffer_store_dwordx4 v[140:143], v197, s[12:15], s39 offen offset:1024 sc1
    s_add_u32 s39, s53, 4096
    s_waitcnt lgkmcnt(6)
    buffer_store_dwordx4 v[144:147], v197, s[12:15], s39 offen offset:0 sc1
    s_waitcnt lgkmcnt(4)
    buffer_store_dwordx4 v[148:151], v197, s[12:15], s39 offen offset:1024 sc1
    s_add_u32 s39, s53, 12288
    s_waitcnt lgkmcnt(2)
    buffer_store_dwordx4 v[152:155], v197, s[12:15], s39 offen offset:0 sc1
    s_waitcnt lgkmcnt(0)
    buffer_store_dwordx4 v[156:159], v197, s[12:15], s39 offen offset:1024 sc1
    s_waitcnt vmcnt(8)
L_gchk:
    v_cmp_ne_u32 vcc, s93, v241
    s_nop 1
    s_cmp_eq_u64 vcc, 0
    s_cbranch_scc1 L_gok
    s_sub_u32 s96, s96, 1
    s_cbranch_scc1 L_gok
    buffer_load_dwordx2 v[240:241], v221, s[12:15], s57 offen sc1
    s_waitcnt vmcnt(0)
    s_branch L_gchk
L_gok:
    v_lshlrev_b32 v6, 2, v25
    ds_bpermute_b32 v36, v6, v240 offset:0
    ds_bpermute_b32 v37, v6, v240 offset:16
    ds_bpermute_b32 v38, v6, v240 offset:32
    ds_bpermute_b32 v39, v6, v240 offset:48
    ds_bpermute_b32 v40, v6, v240 offset:64
    ds_bpermute_b32 v41, v6, v240 offset:80
    ds_bpermute_b32 v42, v6, v240 offset:96
    ds_bpermute_b32 v43, v6, v240 offset:112
    s_mov_b32 s10, 0xffff0000
    s_add_u32 m0, s23, 81920
    s_mov_b32 s21, s17
    s_lshl_b32 s21, s21, 7
    buffer_load_dwordx4 v202, s[28:31], s21 offen offset:0  lds
    v_lshlrev_b32 v252, 16, v242
    v_and_b32 v253, s10, v242
    v_lshlrev_b32 v254, 16, v243
    v_and_b32 v255, s10, v243
    s_waitcnt lgkmcnt(0)
    v_sub_f32 v12, 1.0, v36
    buffer_load_dwordx4 v203, s[28:31], s21 offen offset:1024  lds
    v_cvt_pk_bf16_f32 v12, v12, v12
    v_lshlrev_b32 v12, 16, v12
    v_lshlrev_b32 v8, 16, v224
    v_and_b32 v9, s10, v224
    v_mul_f32 v10, v8, v252
    v_mul_f32 v11, v9, v253
    buffer_load_dwordx4 v204, s[28:31], s21 offen offset:2048  lds
    v_cvt_pk_bf16_f32 v10, v10, v11
    v_mul_f32 v8, v8, v12
    v_mul_f32 v9, v9, v12
    v_cvt_pk_bf16_f32 v8, v8, v9
    v_and_b32 v11, s10, v10
    v_lshlrev_b32 v10, 16, v10
    buffer_load_dwordx4 v205, s[28:31], s21 offen offset:3072  lds
    v_and_b32 v9, s10, v8
    v_lshlrev_b32 v8, 16, v8
    v_fma_f32 v72, v36, v10, v8
    v_fma_f32 v73, v36, v11, v9
    v_lshlrev_b32 v8, 16, v225
    v_and_b32 v9, s10, v225
    s_add_u32 m0, s23, 0
    s_cmp_le_u32 s55, 0
    s_cselect_b32 s21, 1, 0
    s_or_b32 s21, s21, s54
    s_lshl_b32 s21, s21, 7
    buffer_load_dwordx4 v202, s[28:31], s21 offen offset:0  lds
    v_mul_f32 v10, v8, v254
    v_mul_f32 v11, v9, v255
    v_cvt_pk_bf16_f32 v10, v10, v11
    v_mul_f32 v8, v8, v12
    v_mul_f32 v9, v9, v12
    v_cvt_pk_bf16_f32 v8, v8, v9
    buffer_load_dwordx4 v203, s[28:31], s21 offen offset:1024  lds
    v_and_b32 v11, s10, v10
    v_lshlrev_b32 v10, 16, v10
    v_and_b32 v9, s10, v8
    v_lshlrev_b32 v8, 16, v8
    v_fma_f32 v74, v36, v10, v8
    v_fma_f32 v75, v36, v11, v9
    buffer_load_dwordx4 v204, s[28:31], s21 offen offset:2048  lds
    v_sub_f32 v12, 1.0, v37
    v_cvt_pk_bf16_f32 v12, v12, v12
    v_lshlrev_b32 v12, 16, v12
    v_lshlrev_b32 v8, 16, v226
    v_and_b32 v9, s10, v226
    v_mul_f32 v10, v8, v252
    buffer_load_dwordx4 v205, s[28:31], s21 offen offset:3072  lds
    v_mul_f32 v11, v9, v253
    v_cvt_pk_bf16_f32 v10, v10, v11
    v_mul_f32 v8, v8, v12
    v_mul_f32 v9, v9, v12
    v_cvt_pk_bf16_f32 v8, v8, v9
    v_and_b32 v11, s10, v10
    s_add_u32 m0, s23, 16384
    s_cmp_le_u32 s55, 1
    s_cselect_b32 s21, 2, 1
    s_or_b32 s21, s21, s54
    s_lshl_b32 s21, s21, 7
    buffer_load_dwordx4 v202, s[28:31], s21 offen offset:0  lds
    v_lshlrev_b32 v10, 16, v10
    v_and_b32 v9, s10, v8
    v_lshlrev_b32 v8, 16, v8
    v_fma_f32 v76, v37, v10, v8
    v_fma_f32 v77, v37, v11, v9
    v_lshlrev_b32 v8, 16, v227
    buffer_load_dwordx4 v203, s[28:31], s21 offen offset:1024  lds
    v_and_b32 v9, s10, v227
    v_mul_f32 v10, v8, v254
    v_mul_f32 v11, v9, v255
    v_cvt_pk_bf16_f32 v10, v10, v11
    v_mul_f32 v8, v8, v12
    v_mul_f32 v9, v9, v12
    buffer_load_dwordx4 v204, s[28:31], s21 offen offset:2048  lds
    v_cvt_pk_bf16_f32 v8, v8, v9
    v_and_b32 v11, s10, v10
    v_lshlrev_b32 v10, 16, v10
    v_and_b32 v9, s10, v8
    v_lshlrev_b32 v8, 16, v8
    v_fma_f32 v78, v37, v10, v8
    buffer_load_dwordx4 v205, s[28:31], s21 offen offset:3072  lds
    v_fma_f32 v79, v37, v11, v9
    v_sub_f32 v12, 1.0, v38
    v_cvt_pk_bf16_f32 v12, v12, v12
    v_lshlrev_b32 v12, 16, v12
    v_lshlrev_b32 v8, 16, v228
    v_and_b32 v9, s10, v228
    v_mul_f32 v10, v8, v252
    v_mul_f32 v11, v9, v253
    v_cvt_pk_bf16_f32 v10, v10, v11
    v_mul_f32 v8, v8, v12
    v_mul_f32 v9, v9, v12
    v_cvt_pk_bf16_f32 v8, v8, v9
    v_and_b32 v11, s10, v10
    v_lshlrev_b32 v10, 16, v10
    v_and_b32 v9, s10, v8
    v_lshlrev_b32 v8, 16, v8
    v_fma_f32 v88, v38, v10, v8
    v_fma_f32 v89, v38, v11, v9
    v_lshlrev_b32 v8, 16, v229
    v_and_b32 v9, s10, v229
    v_mul_f32 v10, v8, v254
    v_mul_f32 v11, v9, v255
    v_cvt_pk_bf16_f32 v10, v10, v11
    v_mul_f32 v8, v8, v12
    v_mul_f32 v9, v9, v12
    v_cvt_pk_bf16_f32 v8, v8, v9
    v_and_b32 v11, s10, v10
    v_lshlrev_b32 v10, 16, v10
    v_and_b32 v9, s10, v8
    v_lshlrev_b32 v8, 16, v8
    v_fma_f32 v90, v38, v10, v8
    v_fma_f32 v91, v38, v11, v9
    v_sub_f32 v12, 1.0, v39
    v_cvt_pk_bf16_f32 v12, v12, v12
    v_lshlrev_b32 v12, 16, v12
    v_lshlrev_b32 v8, 16, v230
    v_and_b32 v9, s10, v230
    v_mul_f32 v10, v8, v252
    v_mul_f32 v11, v9, v253
    v_cvt_pk_bf16_f32 v10, v10, v11
    v_mul_f32 v8, v8, v12
    v_mul_f32 v9, v9, v12
    v_cvt_pk_bf16_f32 v8, v8, v9
    v_and_b32 v11, s10, v10
    v_lshlrev_b32 v10, 16, v10
    v_and_b32 v9, s10, v8
    v_lshlrev_b32 v8, 16, v8
    v_fma_f32 v92, v39, v10, v8
    v_fma_f32 v93, v39, v11, v9
    v_lshlrev_b32 v8, 16, v231
    v_and_b32 v9, s10, v231
    v_mul_f32 v10, v8, v254
    v_mul_f32 v11, v9, v255
    v_cvt_pk_bf16_f32 v10, v10, v11
    v_mul_f32 v8, v8, v12
    v_mul_f32 v9, v9, v12
    v_cvt_pk_bf16_f32 v8, v8, v9
    v_and_b32 v11, s10, v10
    v_lshlrev_b32 v10, 16, v10
    v_and_b32 v9, s10, v8
    v_lshlrev_b32 v8, 16, v8
    v_fma_f32 v94, v39, v10, v8
    v_fma_f32 v95, v39, v11, v9
    v_sub_f32 v12, 1.0, v40
    v_cvt_pk_bf16_f32 v12, v12, v12
    v_lshlrev_b32 v12, 16, v12
    v_lshlrev_b32 v8, 16, v232
    v_and_b32 v9, s10, v232
    v_mul_f32 v10, v8, v252
    v_mul_f32 v11, v9, v253
    v_cvt_pk_bf16_f32 v10, v10, v11
    v_mul_f32 v8, v8, v12
    v_mul_f32 v9, v9, v12
    v_cvt_pk_bf16_f32 v8, v8, v9
    v_and_b32 v11, s10, v10
    v_lshlrev_b32 v10, 16, v10
    v_and_b32 v9, s10, v8
    v_lshlrev_b32 v8, 16, v8
    v_fma_f32 v104, v40, v10, v8
    v_fma_f32 v105, v40, v11, v9
    v_lshlrev_b32 v8, 16, v233
    v_and_b32 v9, s10, v233
    v_mul_f32 v10, v8, v254
    v_mul_f32 v11, v9, v255
    v_cvt_pk_bf16_f32 v10, v10, v11
    v_mul_f32 v8, v8, v12
    v_mul_f32 v9, v9, v12
    v_cvt_pk_bf16_f32 v8, v8, v9
    v_and_b32 v11, s10, v10
    v_lshlrev_b32 v10, 16, v10
    v_and_b32 v9, s10, v8
    v_lshlrev_b32 v8, 16, v8
    v_fma_f32 v106, v40, v10, v8
    v_fma_f32 v107, v40, v11, v9
    v_sub_f32 v12, 1.0, v41
    v_cvt_pk_bf16_f32 v12, v12, v12
    v_lshlrev_b32 v12, 16, v12
    v_lshlrev_b32 v8, 16, v234
    v_and_b32 v9, s10, v234
    v_mul_f32 v10, v8, v252
    v_mul_f32 v11, v9, v253
    v_cvt_pk_bf16_f32 v10, v10, v11
    v_mul_f32 v8, v8, v12
    v_mul_f32 v9, v9, v12
    v_cvt_pk_bf16_f32 v8, v8, v9
    v_and_b32 v11, s10, v10
    v_lshlrev_b32 v10, 16, v10
    v_and_b32 v9, s10, v8
    v_lshlrev_b32 v8, 16, v8
    v_fma_f32 v108, v41, v10, v8
    v_fma_f32 v109, v41, v11, v9
    v_lshlrev_b32 v8, 16, v235
    v_and_b32 v9, s10, v235
    v_mul_f32 v10, v8, v254
    v_mul_f32 v11, v9, v255
    v_cvt_pk_bf16_f32 v10, v10, v11
    v_mul_f32 v8, v8, v12
    v_mul_f32 v9, v9, v12
    v_cvt_pk_bf16_f32 v8, v8, v9
    v_and_b32 v11, s10, v10
    v_lshlrev_b32 v10, 16, v10
    v_and_b32 v9, s10, v8
    v_lshlrev_b32 v8, 16, v8
    v_fma_f32 v110, v41, v10, v8
    v_fma_f32 v111, v41, v11, v9
    v_sub_f32 v12, 1.0, v42
    v_cvt_pk_bf16_f32 v12, v12, v12
    v_lshlrev_b32 v12, 16, v12
    v_lshlrev_b32 v8, 16, v236
    v_and_b32 v9, s10, v236
    v_mul_f32 v10, v8, v252
    v_mul_f32 v11, v9, v253
    v_cvt_pk_bf16_f32 v10, v10, v11
    v_mul_f32 v8, v8, v12
    v_mul_f32 v9, v9, v12
    v_cvt_pk_bf16_f32 v8, v8, v9
    v_and_b32 v11, s10, v10
    v_lshlrev_b32 v10, 16, v10
    v_and_b32 v9, s10, v8
    v_lshlrev_b32 v8, 16, v8
    v_fma_f32 v120, v42, v10, v8
    v_fma_f32 v121, v42, v11, v9
    v_lshlrev_b32 v8, 16, v237
    v_and_b32 v9, s10, v237
    v_mul_f32 v10, v8, v254
    v_mul_f32 v11, v9, v255
    v_cvt_pk_bf16_f32 v10, v10, v11
    v_mul_f32 v8, v8, v12
    v_mul_f32 v9, v9, v12
    v_cvt_pk_bf16_f32 v8, v8, v9
    v_and_b32 v11, s10, v10
    v_lshlrev_b32 v10, 16, v10
    v_and_b32 v9, s10, v8
    v_lshlrev_b32 v8, 16, v8
    v_fma_f32 v122, v42, v10, v8
    v_fma_f32 v123, v42, v11, v9
    v_sub_f32 v12, 1.0, v43
    v_cvt_pk_bf16_f32 v12, v12, v12
    v_lshlrev_b32 v12, 16, v12
    v_lshlrev_b32 v8, 16, v238
    v_and_b32 v9, s10, v238
    v_mul_f32 v10, v8, v252
    v_mul_f32 v11, v9, v253
    v_cvt_pk_bf16_f32 v10, v10, v11
    v_mul_f32 v8, v8, v12
    v_mul_f32 v9, v9, v12
    v_cvt_pk_bf16_f32 v8, v8, v9
    v_and_b32 v11, s10, v10
    v_lshlrev_b32 v10, 16, v10
    v_and_b32 v9, s10, v8
    v_lshlrev_b32 v8, 16, v8
    v_fma_f32 v124, v43, v10, v8
    v_fma_f32 v125, v43, v11, v9
    v_lshlrev_b32 v8, 16, v239
    v_and_b32 v9, s10, v239
    v_mul_f32 v10, v8, v254
    v_mul_f32 v11, v9, v255
    v_cvt_pk_bf16_f32 v10, v10, v11
    v_mul_f32 v8, v8, v12
    v_mul_f32 v9, v9, v12
    v_cvt_pk_bf16_f32 v8, v8, v9
    v_and_b32 v11, s10, v10
    v_lshlrev_b32 v10, 16, v10
    v_and_b32 v9, s10, v8
    v_lshlrev_b32 v8, 16, v8
    v_fma_f32 v126, v43, v10, v8
    v_fma_f32 v127, v43, v11, v9
    v_mov_b32 v16, v202
    v_mov_b32 v17, v203
    v_mov_b32 v18, v204
    v_mov_b32 v19, v205
    v_mov_b32 v28, v197
    v_add_u32 v29, 4096, v197
    s_lshl_b32 s38, s18, 13
    s_add_u32 s50, s48, s38
    v_mov_b32 v32, 73728
    v_mov_b32 v33, 1
    v_bfe_u32 v59, v24, 1, 3
    v_xor_b32 v59, v59, v25
    v_lshlrev_b32 v59, 4, v59
    v_lshl_add_u32 v59, v26, 7, v59
    v_xor_b32 v20, 0, v59
    v_add_u32 v22, 0x10000, v20
    v_xor_b32 v21, 64, v59
    v_add_u32 v23, 0x10000, v21
    v_xor_b32 v30, s54, v26
    v_lshlrev_b32 v30, 8, v30
    v_mov_b32 v58, s93
    v_lshlrev_b32 v59, 2, v24
    s_lshl_b32 s52, s16, 12
    s_add_u32 s52, s52, 9502720
    s_lshl_b32 s46, s17, 8
    s_add_u32 s46, s46, s52
    s_mul_i32 s38, s18, 8704
    v_mul_u32_u24 v44, 272, v26
    v_lshl_add_u32 v44, v25, 4, v44
    v_add_u32 v44, s38, v44
    v_mul_u32_u24 v45, 272, v25
    v_lshl_add_u32 v45, v26, 4, v45
    v_add_u32 v45, s38, v45
    v_lshlrev_b32 v46, 12, v25
    v_lshl_add_u32 v46, v26, 4, v46
    v_lshlrev_b32 v47, 2, v24
    v_add_u32 v47, 73984, v47
    s_lshl_b32 s56, s51, 12
    s_lshl_b32 s39, s17, 8
    s_add_u32 s56, s56, s39
    s_sub_u32 s38, s20, s18
    s_mul_i32 s38, s38, 9216
    s_lshl_b32 s39, s19, 6
    s_add_u32 s38, s38, s39
    v_add_u32 v35, s38, v196
    s_waitcnt vmcnt(12)
    v_mov_b32 v57, 1
    s_mov_b64 exec, 1
    ds_add_rtn_u32 v57, v32, v57 offset:12
    s_mov_b64 exec, -1
    s_waitcnt lgkmcnt(0)
    v_readfirstlane_b32 s39, v57
    s_nop 1
    s_cmp_lg_u32 s39, 3
    s_cbranch_scc1 L_nohf
    s_mov_b32 exec_hi, 0
    buffer_store_dword v58, v59, s[12:15], s46 offen sc1
    s_mov_b32 exec_hi, -1
    s_waitcnt vmcnt(1)
    s_branch L_hfd
L_nohf:
    s_waitcnt vmcnt(0)
L_hfd:
    s_mov_b64 exec, 1
    ds_add_u32 v32, v33 offset:4
    s_mov_b64 exec, -1
    s_mov_b64 exec, 255
    buffer_load_dword v31, v30, s[12:15], s52 offen sc1
    s_mov_b64 exec, -1
L_sync0:
    ds_read_b32 v34, v32 offset:4
    s_waitcnt lgkmcnt(0)
    v_readfirstlane_b32 s38, v34
    s_nop 1
    s_cmp_ge_u32 s38, 4
    s_cbranch_scc1 L_sync0_ok
    s_sub_u32 s96, s96, 1
    s_cbranch_scc1 L_sync0_ok
    s_sleep 0
    s_branch L_sync0
L_sync0_ok:
    ds_read_b64_tr_b16 v[160:161], v35 offset:0
    ds_read_b64_tr_b16 v[162:163], v35 offset:576
    ds_read_b64_tr_b16 v[164:165], v35 offset:32
    ds_read_b64_tr_b16 v[166:167], v35 offset:608
    ds_read_b64_tr_b16 v[168:169], v35 offset:18432
    ds_read_b64_tr_b16 v[170:171], v35 offset:19008
    ds_read_b64_tr_b16 v[172:173], v35 offset:18464
    ds_read_b64_tr_b16 v[174:175], v35 offset:19040
    s_waitcnt lgkmcnt(4)
    ds_read_b64_tr_b16 v[176:177], v35 offset:4608
    ds_read_b64_tr_b16 v[178:179], v35 offset:5184
    ds_read_b64_tr_b16 v[180:181], v35 offset:4640
    ds_read_b64_tr_b16 v[182:183], v35 offset:5216
    ds_read_b64_tr_b16 v[184:185], v35 offset:23040
    ds_read_b64_tr_b16 v[186:187], v35 offset:23616
    ds_read_b64_tr_b16 v[188:189], v35 offset:23072
    ds_read_b64_tr_b16 v[190:191], v35 offset:23648
    s_mov_b64 exec, 1
    ds_add_u32 v32, v33 offset:72
    s_mov_b64 exec, -1
    s_waitcnt lgkmcnt(4)
    ds_read_b128 v[224:227], v22 offset:16384
    ds_read_b128 v[228:231], v22 offset:18432
    ds_read_b128 v[232:235], v22 offset:20480
    ds_read_b128 v[236:239], v22 offset:22528
    ds_read_b128 v[240:243], v23 offset:16384
    ds_read_b128 v[244:247], v23 offset:18432
    ds_read_b128 v[248:251], v23 offset:20480
    ds_read_b128 v[252:255], v23 offset:22528
    s_waitcnt lgkmcnt(4)
    v_mfma_f32_16x16x32_bf16 v[128:131], v[224:227], v[160:163], 0
    v_mfma_f32_16x16x32_bf16 v[132:135], v[228:231], v[160:163], 0
    v_mfma_f32_16x16x32_bf16 v[136:139], v[232:235], v[160:163], 0
    v_mfma_f32_16x16x32_bf16 v[140:143], v[236:239], v[160:163], 0
    v_mfma_f32_16x16x32_bf16 v[144:147], v[224:227], v[164:167], 0
    v_mfma_f32_16x16x32_bf16 v[148:151], v[228:231], v[164:167], 0
    v_mfma_f32_16x16x32_bf16 v[152:155], v[232:235], v[164:167], 0
    v_mfma_f32_16x16x32_bf16 v[156:159], v[236:239], v[164:167], 0
    ds_read_b128 v[224:227], v22 offset:24576
    ds_read_b128 v[228:231], v22 offset:26624
    ds_read_b128 v[232:235], v22 offset:28672
    ds_read_b128 v[236:239], v22 offset:30720
    s_waitcnt lgkmcnt(4)
    v_mfma_f32_16x16x32_bf16 v[128:131], v[240:243], v[168:171], v[128:131]
    v_mfma_f32_16x16x32_bf16 v[132:135], v[244:247], v[168:171], v[132:135]
    v_mfma_f32_16x16x32_bf16 v[136:139], v[248:251], v[168:171], v[136:139]
    v_mfma_f32_16x16x32_bf16 v[140:143], v[252:255], v[168:171], v[140:143]
    v_mfma_f32_16x16x32_bf16 v[144:147], v[240:243], v[172:175], v[144:147]
    v_mfma_f32_16x16x32_bf16 v[148:151], v[244:247], v[172:175], v[148:151]
    v_mfma_f32_16x16x32_bf16 v[152:155], v[248:251], v[172:175], v[152:155]
    v_mfma_f32_16x16x32_bf16 v[156:159], v[252:255], v[172:175], v[156:159]
    ds_read_b128 v[240:243], v23 offset:24576
    ds_read_b128 v[244:247], v23 offset:26624
    ds_read_b128 v[248:251], v23 offset:28672
    ds_read_b128 v[252:255], v23 offset:30720
    s_waitcnt lgkmcnt(4)
    v_mfma_f32_16x16x32_bf16 v[128:131], v[224:227], v[176:179], v[128:131]
    v_mfma_f32_16x16x32_bf16 v[132:135], v[228:231], v[176:179], v[132:135]
    v_mfma_f32_16x16x32_bf16 v[136:139], v[232:235], v[176:179], v[136:139]
    v_mfma_f32_16x16x32_bf16 v[140:143], v[236:239], v[176:179], v[140:143]
    v_mfma_f32_16x16x32_bf16 v[144:147], v[224:227], v[180:183], v[144:147]
    v_mfma_f32_16x16x32_bf16 v[148:151], v[228:231], v[180:183], v[148:151]
    v_mfma_f32_16x16x32_bf16 v[152:155], v[232:235], v[180:183], v[152:155]
    v_mfma_f32_16x16x32_bf16 v[156:159], v[236:239], v[180:183], v[156:159]
    ds_read_b128 v[224:227], v20 offset:0
    ds_read_b128 v[228:231], v20 offset:2048
    ds_read_b128 v[232:235], v20 offset:4096
    ds_read_b128 v[236:239], v20 offset:6144
    s_waitcnt lgkmcnt(4)
    v_mfma_f32_16x16x32_bf16 v[128:131], v[240:243], v[184:187], v[128:131]
    v_mfma_f32_16x16x32_bf16 v[132:135], v[244:247], v[184:187], v[132:135]
    v_mfma_f32_16x16x32_bf16 v[136:139], v[248:251], v[184:187], v[136:139]
    v_mfma_f32_16x16x32_bf16 v[140:143], v[252:255], v[184:187], v[140:143]
    v_mfma_f32_16x16x32_bf16 v[144:147], v[240:243], v[188:191], v[144:147]
    v_mfma_f32_16x16x32_bf16 v[148:151], v[244:247], v[188:191], v[148:151]
    v_mfma_f32_16x16x32_bf16 v[152:155], v[248:251], v[188:191], v[152:155]
    v_mfma_f32_16x16x32_bf16 v[156:159], v[252:255], v[188:191], v[156:159]
L_hpoll:
    s_waitcnt vmcnt(0)
    v_cmp_ne_u32 vcc, s93, v31
    s_nop 1
    s_and_b32 s38, vcc_lo, 255
    s_cbranch_scc0 L_hgo
    s_sub_u32 s96, s96, 1
    s_cbranch_scc1 L_hgo
    s_sleep 1
    s_mov_b64 exec, 255
    buffer_load_dword v31, v30, s[12:15], s52 offen sc1
    s_mov_b64 exec, -1
    s_branch L_hpoll
L_hgo:
    s_cmp_le_u32 s55, 0
    s_cselect_b32 s49, 1, 0
    s_or_b32 s49, s49, s54
    s_lshl_b32 s49, s49, 15
    s_add_u32 s49, s49, s50
    buffer_load_dwordx4 v[192:195], v28, s[12:15], s49 offen offset:0 sc1
    buffer_load_dwordx4 v[196:199], v28, s[12:15], s49 offen offset:1024 sc1
    buffer_load_dwordx4 v[200:203], v28, s[12:15], s49 offen offset:2048 sc1
    buffer_load_dwordx4 v[204:207], v28, s[12:15], s49 offen offset:3072 sc1
    buffer_load_dwordx4 v[208:211], v29, s[12:15], s49 offen offset:0 sc1
    buffer_load_dwordx4 v[212:215], v29, s[12:15], s49 offen offset:1024 sc1
    buffer_load_dwordx4 v[216:219], v29, s[12:15], s49 offen offset:2048 sc1
    buffer_load_dwordx4 v[220:223], v29, s[12:15], s49 offen offset:3072 sc1
L_sync1:
    ds_read_b32 v34, v32 offset:72
    s_waitcnt lgkmcnt(0)
    v_readfirstlane_b32 s38, v34
    s_nop 1
    s_cmp_ge_u32 s38, 4
    s_cbranch_scc1 L_sync1_ok
    s_sub_u32 s96, s96, 1
    s_cbranch_scc1 L_sync1_ok
    s_sleep 0
    s_branch L_sync1
L_sync1_ok:
    s_cmp_le_u32 s55, 1
    s_cselect_b32 s49, 2, 1
    s_or_b32 s49, s49, s54
    s_lshl_b32 s49, s49, 15
    s_add_u32 s49, s49, s50
    buffer_load_dwordx4 v[160:163], v28, s[12:15], s49 offen offset:0 sc1
    buffer_load_dwordx4 v[164:167], v28, s[12:15], s49 offen offset:1024 sc1
    buffer_load_dwordx4 v[168:171], v28, s[12:15], s49 offen offset:2048 sc1
    buffer_load_dwordx4 v[172:175], v28, s[12:15], s49 offen offset:3072 sc1
    buffer_load_dwordx4 v[176:179], v29, s[12:15], s49 offen offset:0 sc1
    buffer_load_dwordx4 v[180:183], v29, s[12:15], s49 offen offset:1024 sc1
    buffer_load_dwordx4 v[184:187], v29, s[12:15], s49 offen offset:2048 sc1
    buffer_load_dwordx4 v[188:191], v29, s[12:15], s49 offen offset:3072 sc1
    ds_read_b128 v[240:243], v21 offset:0
    ds_read_b128 v[244:247], v21 offset:2048
    ds_read_b128 v[248:251], v21 offset:4096
    ds_read_b128 v[252:255], v21 offset:6144
    s_waitcnt vmcnt(14) lgkmcnt(4)
    v_mfma_f32_16x16x32_bf16 v[128:131], v[224:227], v[192:195], v[128:131]
    v_mfma_f32_16x16x32_bf16 v[132:135], v[228:231], v[192:195], v[132:135]
    v_mfma_f32_16x16x32_bf16 v[136:139], v[232:235], v[192:195], v[136:139]
    v_mfma_f32_16x16x32_bf16 v[140:143], v[236:239], v[192:195], v[140:143]
    s_cmp_le_u32 s55, 2
    s_cselect_b32 s49, 3, 2
    s_or_b32 s49, s49, s54
    s_lshl_b32 s49, s49, 15
    s_add_u32 s49, s49, s50
    buffer_load_dwordx4 v[192:195], v28, s[12:15], s49 offen offset:0 sc1
    s_add_u32 m0, s23, 32768
    s_cmp_le_u32 s55, 2
    s_cselect_b32 s21, 3, 2
    s_or_b32 s21, s21, s54
    s_lshl_b32 s21, s21, 7
    buffer_load_dwordx4 v16, s[28:31], s21 offen offset:0  lds
    v_mfma_f32_16x16x32_bf16 v[144:147], v[224:227], v[196:199], v[144:147]
    v_mfma_f32_16x16x32_bf16 v[148:151], v[228:231], v[196:199], v[148:151]
    v_mfma_f32_16x16x32_bf16 v[152:155], v[232:235], v[196:199], v[152:155]
    v_mfma_f32_16x16x32_bf16 v[156:159], v[236:239], v[196:199], v[156:159]
    buffer_load_dwordx4 v[196:199], v28, s[12:15], s49 offen offset:1024 sc1
    buffer_load_dwordx4 v17, s[28:31], s21 offen offset:1024  lds
    ds_read_b128 v[224:227], v20 offset:8192
    ds_read_b128 v[228:231], v20 offset:10240
    ds_read_b128 v[232:235], v20 offset:12288
    ds_read_b128 v[236:239], v20 offset:14336
    s_waitcnt vmcnt(16) lgkmcnt(4)
    s_mov_b64 exec, 1
    ds_add_u32 v32, v33 offset:16
    s_mov_b64 exec, -1
    v_mfma_f32_16x16x32_bf16 v[128:131], v[240:243], v[200:203], v[128:131]
    v_mfma_f32_16x16x32_bf16 v[132:135], v[244:247], v[200:203], v[132:135]
    v_mfma_f32_16x16x32_bf16 v[136:139], v[248:251], v[200:203], v[136:139]
    v_mfma_f32_16x16x32_bf16 v[140:143], v[252:255], v[200:203], v[140:143]
    buffer_load_dwordx4 v[200:203], v28, s[12:15], s49 offen offset:2048 sc1
    buffer_load_dwordx4 v18, s[28:31], s21 offen offset:2048  lds
    v_mfma_f32_16x16x32_bf16 v[144:147], v[240:243], v[204:207], v[144:147]
    v_mfma_f32_16x16x32_bf16 v[148:151], v[244:247], v[204:207], v[148:151]
    v_mfma_f32_16x16x32_bf16 v[152:155], v[248:251], v[204:207], v[152:155]
    v_mfma_f32_16x16x32_bf16 v[156:159], v[252:255], v[204:207], v[156:159]
    buffer_load_dwordx4 v[204:207], v28, s[12:15], s49 offen offset:3072 sc1
    buffer_load_dwordx4 v19, s[28:31], s21 offen offset:3072  lds
    ds_read_b128 v[240:243], v21 offset:8192
    ds_read_b128 v[244:247], v21 offset:10240
    ds_read_b128 v[248:251], v21 offset:12288
    ds_read_b128 v[252:255], v21 offset:14336
    s_waitcnt vmcnt(18) lgkmcnt(4)
    v_mfma_f32_16x16x32_bf16 v[128:131], v[224:227], v[208:211], v[128:131]
    v_mfma_f32_16x16x32_bf16 v[132:135], v[228:231], v[208:211], v[132:135]
    v_mfma_f32_16x16x32_bf16 v[136:139], v[232:235], v[208:211], v[136:139]
    v_mfma_f32_16x16x32_bf16 v[140:143], v[236:239], v[208:211], v[140:143]
    ds_read_b32 v34, v32 offset:16
    buffer_load_dwordx4 v[208:211], v29, s[12:15], s49 offen offset:0 sc1
    s_add_u32 m0, s23, 49152
    s_cmp_le_u32 s55, 3
    s_cselect_b32 s21, 4, 3
    s_or_b32 s21, s21, s54
    s_lshl_b32 s21, s21, 7
    buffer_load_dwordx4 v16, s[28:31], s21 offen offset:0  lds
    v_mfma_f32_16x16x32_bf16 v[144:147], v[224:227], v[212:215], v[144:147]
    v_mfma_f32_16x16x32_bf16 v[148:151], v[228:231], v[212:215], v[148:151]
    v_mfma_f32_16x16x32_bf16 v[152:155], v[232:235], v[212:215], v[152:155]
    v_mfma_f32_16x16x32_bf16 v[156:159], v[236:239], v[212:215], v[156:159]
    buffer_load_dwordx4 v[212:215], v29, s[12:15], s49 offen offset:1024 sc1
    s_waitcnt lgkmcnt(0)
    v_readfirstlane_b32 s38, v34
    s_nop 1
    s_cmp_ge_u32 s38, 4
    s_cbranch_scc1 L_st1_ok
L_st1:
    ds_read_b32 v34, v32 offset:16
    s_waitcnt lgkmcnt(0)
    v_readfirstlane_b32 s38, v34
    s_nop 1
    s_cmp_ge_u32 s38, 4
    s_cbranch_scc1 L_st1_ok
    s_sub_u32 s96, s96, 1
    s_cbranch_scc1 L_st1_ok
    s_sleep 0
    s_branch L_st1
L_st1_ok:
    ds_read_b128 v[224:227], v20 offset:16384
    ds_read_b128 v[228:231], v20 offset:18432
    ds_read_b128 v[232:235], v20 offset:20480
    ds_read_b128 v[236:239], v20 offset:22528
    s_waitcnt vmcnt(19)
    v_mfma_f32_16x16x32_bf16 v[128:131], v[240:243], v[216:219], v[128:131]
    v_mfma_f32_16x16x32_bf16 v[132:135], v[244:247], v[216:219], v[132:135]
    v_mfma_f32_16x16x32_bf16 v[136:139], v[248:251], v[216:219], v[136:139]
    v_mfma_f32_16x16x32_bf16 v[140:143], v[252:255], v[216:219], v[140:143]
    buffer_load_dwordx4 v[216:219], v29, s[12:15], s49 offen offset:2048 sc1
    buffer_load_dwordx4 v17, s[28:31], s21 offen offset:1024  lds
    v_mfma_f32_16x16x32_bf16 v[144:147], v[240:243], v[220:223], v[144:147]
    v_mfma_f32_16x16x32_bf16 v[148:151], v[244:247], v[220:223], v[148:151]
    v_mfma_f32_16x16x32_bf16 v[152:155], v[248:251], v[220:223], v[152:155]
    v_mfma_f32_16x16x32_bf16 v[156:159], v[252:255], v[220:223], v[156:159]
    buffer_load_dwordx4 v[220:223], v29, s[12:15], s49 offen offset:3072 sc1
    buffer_load_dwordx4 v18, s[28:31], s21 offen offset:2048  lds
    ds_read_b128 v[240:243], v21 offset:16384
    ds_read_b128 v[244:247], v21 offset:18432
    ds_read_b128 v[248:251], v21 offset:20480
    ds_read_b128 v[252:255], v21 offset:22528
    s_waitcnt vmcnt(21) lgkmcnt(4)
    v_mfma_f32_16x16x32_bf16 v[128:131], v[224:227], v[160:163], v[128:131]
    v_mfma_f32_16x16x32_bf16 v[132:135], v[228:231], v[160:163], v[132:135]
    v_mfma_f32_16x16x32_bf16 v[136:139], v[232:235], v[160:163], v[136:139]
    v_mfma_f32_16x16x32_bf16 v[140:143], v[236:239], v[160:163], v[140:143]
    s_cmp_le_u32 s55, 3
    s_cselect_b32 s49, 4, 3
    s_or_b32 s49, s49, s54
    s_lshl_b32 s49, s49, 15
    s_add_u32 s49, s49, s50
    buffer_load_dwordx4 v[160:163], v28, s[12:15], s49 offen offset:0 sc1
    buffer_load_dwordx4 v19, s[28:31], s21 offen offset:3072  lds
    v_mfma_f32_16x16x32_bf16 v[144:147], v[224:227], v[164:167], v[144:147]
    v_mfma_f32_16x16x32_bf16 v[148:151], v[228:231], v[164:167], v[148:151]
    v_mfma_f32_16x16x32_bf16 v[152:155], v[232:235], v[164:167], v[152:155]
    v_mfma_f32_16x16x32_bf16 v[156:159], v[236:239], v[164:167], v[156:159]
    buffer_load_dwordx4 v[164:167], v28, s[12:15], s49 offen offset:1024 sc1
    ds_read_b128 v[224:227], v20 offset:24576
    ds_read_b128 v[228:231], v20 offset:26624
    ds_read_b128 v[232:235], v20 offset:28672
    ds_read_b128 v[236:239], v20 offset:30720
    s_waitcnt vmcnt(10) lgkmcnt(4)
    s_mov_b64 exec, 1
    ds_add_u32 v32, v33 offset:16
    s_mov_b64 exec, -1
    v_mfma_f32_16x16x32_bf16 v[128:131], v[240:243], v[168:171], v[128:131]
    v_mfma_f32_16x16x32_bf16 v[132:135], v[244:247], v[168:171], v[132:135]
    v_mfma_f32_16x16x32_bf16 v[136:139], v[248:251], v[168:171], v[136:139]
    v_mfma_f32_16x16x32_bf16 v[140:143], v[252:255], v[168:171], v[140:143]
    buffer_load_dwordx4 v[168:171], v28, s[12:15], s49 offen offset:2048 sc1
    s_add_u32 m0, s23, 81920
    s_cmp_le_u32 s55, 4
    s_cselect_b32 s21, 5, 4
    s_or_b32 s21, s21, s54
    s_lshl_b32 s21, s21, 7
    buffer_load_dwordx4 v16, s[28:31], s21 offen offset:0  lds
    v_mfma_f32_16x16x32_bf16 v[144:147], v[240:243], v[172:175], v[144:147]
    v_mfma_f32_16x16x32_bf16 v[148:151], v[244:247], v[172:175], v[148:151]
    v_mfma_f32_16x16x32_bf16 v[152:155], v[248:251], v[172:175], v[152:155]
    v_mfma_f32_16x16x32_bf16 v[156:159], v[252:255], v[172:175], v[156:159]
    buffer_load_dwordx4 v[172:175], v28, s[12:15], s49 offen offset:3072 sc1
    ds_read_b128 v[240:243], v21 offset:24576
    ds_read_b128 v[244:247], v21 offset:26624
    ds_read_b128 v[248:251], v21 offset:28672
    ds_read_b128 v[252:255], v21 offset:30720
    s_waitcnt vmcnt(23) lgkmcnt(4)
    v_mfma_f32_16x16x32_bf16 v[128:131], v[224:227], v[176:179], v[128:131]
    v_mfma_f32_16x16x32_bf16 v[132:135], v[228:231], v[176:179], v[132:135]
    v_mfma_f32_16x16x32_bf16 v[136:139], v[232:235], v[176:179], v[136:139]
    v_mfma_f32_16x16x32_bf16 v[140:143], v[236:239], v[176:179], v[140:143]
    ds_read_b32 v34, v32 offset:16
    buffer_load_dwordx4 v[176:179], v29, s[12:15], s49 offen offset:0 sc1
    buffer_load_dwordx4 v17, s[28:31], s21 offen offset:1024  lds
    v_mfma_f32_16x16x32_bf16 v[144:147], v[224:227], v[180:183], v[144:147]
    v_mfma_f32_16x16x32_bf16 v[148:151], v[228:231], v[180:183], v[148:151]
    v_mfma_f32_16x16x32_bf16 v[152:155], v[232:235], v[180:183], v[152:155]
    v_mfma_f32_16x16x32_bf16 v[156:159], v[236:239], v[180:183], v[156:159]
    buffer_load_dwordx4 v[180:183], v29, s[12:15], s49 offen offset:1024 sc1
    s_waitcnt lgkmcnt(0)
    v_readfirstlane_b32 s38, v34
    s_nop 1
    s_cmp_ge_u32 s38, 8
    s_cbranch_scc1 L_st2_ok
L_st2:
    ds_read_b32 v34, v32 offset:16
    s_waitcnt lgkmcnt(0)
    v_readfirstlane_b32 s38, v34
    s_nop 1
    s_cmp_ge_u32 s38, 8
    s_cbranch_scc1 L_st2_ok
    s_sub_u32 s96, s96, 1
    s_cbranch_scc1 L_st2_ok
    s_sleep 0
    s_branch L_st2
L_st2_ok:
    ds_read_b128 v[224:227], v20 offset:32768
    ds_read_b128 v[228:231], v20 offset:34816
    ds_read_b128 v[232:235], v20 offset:36864
    ds_read_b128 v[236:239], v20 offset:38912
    s_waitcnt vmcnt(24)
    v_mfma_f32_16x16x32_bf16 v[128:131], v[240:243], v[184:187], v[128:131]
    v_mfma_f32_16x16x32_bf16 v[132:135], v[244:247], v[184:187], v[132:135]
    v_mfma_f32_16x16x32_bf16 v[136:139], v[248:251], v[184:187], v[136:139]
    v_mfma_f32_16x16x32_bf16 v[140:143], v[252:255], v[184:187], v[140:143]
    buffer_load_dwordx4 v[184:187], v29, s[12:15], s49 offen offset:2048 sc1
    buffer_load_dwordx4 v18, s[28:31], s21 offen offset:2048  lds
    v_mfma_f32_16x16x32_bf16 v[144:147], v[240:243], v[188:191], v[144:147]
    v_mfma_f32_16x16x32_bf16 v[148:151], v[244:247], v[188:191], v[148:151]
    v_mfma_f32_16x16x32_bf16 v[152:155], v[248:251], v[188:191], v[152:155]
    v_mfma_f32_16x16x32_bf16 v[156:159], v[252:255], v[188:191], v[156:159]
    buffer_load_dwordx4 v[188:191], v29, s[12:15], s49 offen offset:3072 sc1
    buffer_load_dwordx4 v19, s[28:31], s21 offen offset:3072  lds
    ds_read_b128 v[240:243], v21 offset:32768
    ds_read_b128 v[244:247], v21 offset:34816
    ds_read_b128 v[248:251], v21 offset:36864
    ds_read_b128 v[252:255], v21 offset:38912
    s_waitcnt vmcnt(25) lgkmcnt(4)
    v_mfma_f32_16x16x32_bf16 v[128:131], v[224:227], v[192:195], v[128:131]
    v_mfma_f32_16x16x32_bf16 v[132:135], v[228:231], v[192:195], v[132:135]
    v_mfma_f32_16x16x32_bf16 v[136:139], v[232:235], v[192:195], v[136:139]
    v_mfma_f32_16x16x32_bf16 v[140:143], v[236:239], v[192:195], v[140:143]
    s_cmp_le_u32 s55, 4
    s_cselect_b32 s49, 5, 4
    s_or_b32 s49, s49, s54
    s_lshl_b32 s49, s49, 15
    s_add_u32 s49, s49, s50
    buffer_load_dwordx4 v[192:195], v28, s[12:15], s49 offen offset:0 sc1
    s_add_u32 m0, s23, 0
    s_cmp_le_u32 s55, 5
    s_cselect_b32 s21, 6, 5
    s_or_b32 s21, s21, s54
    s_lshl_b32 s21, s21, 7
    buffer_load_dwordx4 v16, s[28:31], s21 offen offset:0  lds
    v_mfma_f32_16x16x32_bf16 v[144:147], v[224:227], v[196:199], v[144:147]
    v_mfma_f32_16x16x32_bf16 v[148:151], v[228:231], v[196:199], v[148:151]
    v_mfma_f32_16x16x32_bf16 v[152:155], v[232:235], v[196:199], v[152:155]
    v_mfma_f32_16x16x32_bf16 v[156:159], v[236:239], v[196:199], v[156:159]
    buffer_load_dwordx4 v[196:199], v28, s[12:15], s49 offen offset:1024 sc1
    ds_read_b128 v[224:227], v20 offset:40960
    ds_read_b128 v[228:231], v20 offset:43008
    ds_read_b128 v[232:235], v20 offset:45056
    ds_read_b128 v[236:239], v20 offset:47104
    s_waitcnt vmcnt(14) lgkmcnt(4)
    s_mov_b64 exec, 1
    ds_add_u32 v32, v33 offset:16
    s_mov_b64 exec, -1
    v_mfma_f32_16x16x32_bf16 v[128:131], v[240:243], v[200:203], v[128:131]
    v_mfma_f32_16x16x32_bf16 v[132:135], v[244:247], v[200:203], v[132:135]
    v_mfma_f32_16x16x32_bf16 v[136:139], v[248:251], v[200:203], v[136:139]
    v_mfma_f32_16x16x32_bf16 v[140:143], v[252:255], v[200:203], v[140:143]
    buffer_load_dwordx4 v[200:203], v28, s[12:15], s49 offen offset:2048 sc1
    buffer_load_dwordx4 v17, s[28:31], s21 offen offset:1024  lds
    v_mfma_f32_16x16x32_bf16 v[144:147], v[240:243], v[204:207], v[144:147]
    v_mfma_f32_16x16x32_bf16 v[148:151], v[244:247], v[204:207], v[148:151]
    v_mfma_f32_16x16x32_bf16 v[152:155], v[248:251], v[204:207], v[152:155]
    v_mfma_f32_16x16x32_bf16 v[156:159], v[252:255], v[204:207], v[156:159]
    buffer_load_dwordx4 v[204:207], v28, s[12:15], s49 offen offset:3072 sc1
    ds_read_b128 v[240:243], v21 offset:40960
    ds_read_b128 v[244:247], v21 offset:43008
    ds_read_b128 v[248:251], v21 offset:45056
    ds_read_b128 v[252:255], v21 offset:47104
    s_waitcnt vmcnt(23) lgkmcnt(4)
    v_mfma_f32_16x16x32_bf16 v[128:131], v[224:227], v[208:211], v[128:131]
    v_mfma_f32_16x16x32_bf16 v[132:135], v[228:231], v[208:211], v[132:135]
    v_mfma_f32_16x16x32_bf16 v[136:139], v[232:235], v[208:211], v[136:139]
    v_mfma_f32_16x16x32_bf16 v[140:143], v[236:239], v[208:211], v[140:143]
    ds_read_b32 v34, v32 offset:16
    buffer_load_dwordx4 v[208:211], v29, s[12:15], s49 offen offset:0 sc1
    buffer_load_dwordx4 v18, s[28:31], s21 offen offset:2048  lds
    v_mfma_f32_16x16x32_bf16 v[144:147], v[224:227], v[212:215], v[144:147]
    v_mfma_f32_16x16x32_bf16 v[148:151], v[228:231], v[212:215], v[148:151]
    v_mfma_f32_16x16x32_bf16 v[152:155], v[232:235], v[212:215], v[152:155]
    v_mfma_f32_16x16x32_bf16 v[156:159], v[236:239], v[212:215], v[156:159]
    buffer_load_dwordx4 v[212:215], v29, s[12:15], s49 offen offset:1024 sc1
    s_waitcnt lgkmcnt(0)
    v_readfirstlane_b32 s38, v34
    s_nop 1
    s_cmp_ge_u32 s38, 12
    s_cbranch_scc1 L_st3_ok
L_st3:
    ds_read_b32 v34, v32 offset:16
    s_waitcnt lgkmcnt(0)
    v_readfirstlane_b32 s38, v34
    s_nop 1
    s_cmp_ge_u32 s38, 12
    s_cbranch_scc1 L_st3_ok
    s_sub_u32 s96, s96, 1
    s_cbranch_scc1 L_st3_ok
    s_sleep 0
    s_branch L_st3
L_st3_ok:
    ds_read_b128 v[224:227], v20 offset:49152
    ds_read_b128 v[228:231], v20 offset:51200
    ds_read_b128 v[232:235], v20 offset:53248
    ds_read_b128 v[236:239], v20 offset:55296
    s_waitcnt vmcnt(23)
    v_mfma_f32_16x16x32_bf16 v[128:131], v[240:243], v[216:219], v[128:131]
    v_mfma_f32_16x16x32_bf16 v[132:135], v[244:247], v[216:219], v[132:135]
    v_mfma_f32_16x16x32_bf16 v[136:139], v[248:251], v[216:219], v[136:139]
    v_mfma_f32_16x16x32_bf16 v[140:143], v[252:255], v[216:219], v[140:143]
    buffer_load_dwordx4 v[216:219], v29, s[12:15], s49 offen offset:2048 sc1
    buffer_load_dwordx4 v19, s[28:31], s21 offen offset:3072  lds
    v_mfma_f32_16x16x32_bf16 v[144:147], v[240:243], v[220:223], v[144:147]
    v_mfma_f32_16x16x32_bf16 v[148:151], v[244:247], v[220:223], v[148:151]
    v_mfma_f32_16x16x32_bf16 v[152:155], v[248:251], v[220:223], v[152:155]
    v_mfma_f32_16x16x32_bf16 v[156:159], v[252:255], v[220:223], v[156:159]
    buffer_load_dwordx4 v[220:223], v29, s[12:15], s49 offen offset:3072 sc1
    ds_read_b128 v[240:243], v21 offset:49152
    ds_read_b128 v[244:247], v21 offset:51200
    ds_read_b128 v[248:251], v21 offset:53248
    ds_read_b128 v[252:255], v21 offset:55296
    s_waitcnt vmcnt(22) lgkmcnt(4)
    v_mfma_f32_16x16x32_bf16 v[128:131], v[224:227], v[160:163], v[128:131]
    v_mfma_f32_16x16x32_bf16 v[132:135], v[228:231], v[160:163], v[132:135]
    v_mfma_f32_16x16x32_bf16 v[136:139], v[232:235], v[160:163], v[136:139]
    v_mfma_f32_16x16x32_bf16 v[140:143], v[236:239], v[160:163], v[140:143]
    s_cmp_le_u32 s55, 5
    s_cselect_b32 s49, 6, 5
    s_or_b32 s49, s49, s54
    s_lshl_b32 s49, s49, 15
    s_add_u32 s49, s49, s50
    buffer_load_dwordx4 v[160:163], v28, s[12:15], s49 offen offset:0 sc1
    s_add_u32 m0, s23, 16384
    s_cmp_le_u32 s55, 6
    s_cselect_b32 s21, 7, 6
    s_or_b32 s21, s21, s54
    s_lshl_b32 s21, s21, 7
    buffer_load_dwordx4 v16, s[28:31], s21 offen offset:0  lds
    v_mfma_f32_16x16x32_bf16 v[144:147], v[224:227], v[164:167], v[144:147]
    v_mfma_f32_16x16x32_bf16 v[148:151], v[228:231], v[164:167], v[148:151]
    v_mfma_f32_16x16x32_bf16 v[152:155], v[232:235], v[164:167], v[152:155]
    v_mfma_f32_16x16x32_bf16 v[156:159], v[236:239], v[164:167], v[156:159]
    buffer_load_dwordx4 v[164:167], v28, s[12:15], s49 offen offset:1024 sc1
    ds_read_b128 v[224:227], v20 offset:57344
    ds_read_b128 v[228:231], v20 offset:59392
    ds_read_b128 v[232:235], v20 offset:61440
    ds_read_b128 v[236:239], v20 offset:63488
    s_waitcnt vmcnt(15) lgkmcnt(4)
    s_mov_b64 exec, 1
    ds_add_u32 v32, v33 offset:16
    s_mov_b64 exec, -1
    v_mfma_f32_16x16x32_bf16 v[128:131], v[240:243], v[168:171], v[128:131]
    v_mfma_f32_16x16x32_bf16 v[132:135], v[244:247], v[168:171], v[132:135]
    v_mfma_f32_16x16x32_bf16 v[136:139], v[248:251], v[168:171], v[136:139]
    v_mfma_f32_16x16x32_bf16 v[140:143], v[252:255], v[168:171], v[140:143]
    buffer_load_dwordx4 v[168:171], v28, s[12:15], s49 offen offset:2048 sc1
    buffer_load_dwordx4 v17, s[28:31], s21 offen offset:1024  lds
    v_mfma_f32_16x16x32_bf16 v[144:147], v[240:243], v[172:175], v[144:147]
    v_mfma_f32_16x16x32_bf16 v[148:151], v[244:247], v[172:175], v[148:151]
    v_mfma_f32_16x16x32_bf16 v[152:155], v[248:251], v[172:175], v[152:155]
    v_mfma_f32_16x16x32_bf16 v[156:159], v[252:255], v[172:175], v[156:159]
    buffer_load_dwordx4 v[172:175], v28, s[12:15], s49 offen offset:3072 sc1
    ds_read_b128 v[240:243], v21 offset:57344
    ds_read_b128 v[244:247], v21 offset:59392
    ds_read_b128 v[248:251], v21 offset:61440
    ds_read_b128 v[252:255], v21 offset:63488
    s_waitcnt vmcnt(22) lgkmcnt(4)
    v_mfma_f32_16x16x32_bf16 v[128:131], v[224:227], v[176:179], v[128:131]
    v_mfma_f32_16x16x32_bf16 v[132:135], v[228:231], v[176:179], v[132:135]
    v_mfma_f32_16x16x32_bf16 v[136:139], v[232:235], v[176:179], v[136:139]
    v_mfma_f32_16x16x32_bf16 v[140:143], v[236:239], v[176:179], v[140:143]
    ds_read_b32 v34, v32 offset:16
    buffer_load_dwordx4 v[176:179], v29, s[12:15], s49 offen offset:0 sc1
    buffer_load_dwordx4 v18, s[28:31], s21 offen offset:2048  lds
    v_mfma_f32_16x16x32_bf16 v[144:147], v[224:227], v[180:183], v[144:147]
    v_mfma_f32_16x16x32_bf16 v[148:151], v[228:231], v[180:183], v[148:151]
    v_mfma_f32_16x16x32_bf16 v[152:155], v[232:235], v[180:183], v[152:155]
    v_mfma_f32_16x16x32_bf16 v[156:159], v[236:239], v[180:183], v[156:159]
    buffer_load_dwordx4 v[180:183], v29, s[12:15], s49 offen offset:1024 sc1
    s_waitcnt lgkmcnt(0)
    v_readfirstlane_b32 s38, v34
    s_nop 1
    s_cmp_ge_u32 s38, 16
    s_cbranch_scc1 L_st4_ok
L_st4:
    ds_read_b32 v34, v32 offset:16
    s_waitcnt lgkmcnt(0)
    v_readfirstlane_b32 s38, v34
    s_nop 1
    s_cmp_ge_u32 s38, 16
    s_cbranch_scc1 L_st4_ok
    s_sub_u32 s96, s96, 1
    s_cbranch_scc1 L_st4_ok
    s_sleep 0
    s_branch L_st4
L_st4_ok:
    ds_read_b128 v[224:227], v22 offset:16384
    ds_read_b128 v[228:231], v22 offset:18432
    ds_read_b128 v[232:235], v22 offset:20480
    ds_read_b128 v[236:239], v22 offset:22528
    s_waitcnt vmcnt(22)
    v_mfma_f32_16x16x32_bf16 v[128:131], v[240:243], v[184:187], v[128:131]
    v_mfma_f32_16x16x32_bf16 v[132:135], v[244:247], v[184:187], v[132:135]
    v_mfma_f32_16x16x32_bf16 v[136:139], v[248:251], v[184:187], v[136:139]
    v_mfma_f32_16x16x32_bf16 v[140:143], v[252:255], v[184:187], v[140:143]
    buffer_load_dwordx4 v[184:187], v29, s[12:15], s49 offen offset:2048 sc1
    buffer_load_dwordx4 v19, s[28:31], s21 offen offset:3072  lds
    v_mfma_f32_16x16x32_bf16 v[144:147], v[240:243], v[188:191], v[144:147]
    v_mfma_f32_16x16x32_bf16 v[148:151], v[244:247], v[188:191], v[148:151]
    v_mfma_f32_16x16x32_bf16 v[152:155], v[248:251], v[188:191], v[152:155]
    v_mfma_f32_16x16x32_bf16 v[156:159], v[252:255], v[188:191], v[156:159]
    buffer_load_dwordx4 v[188:191], v29, s[12:15], s49 offen offset:3072 sc1
    ds_read_b128 v[240:243], v23 offset:16384
    ds_read_b128 v[244:247], v23 offset:18432
    ds_read_b128 v[248:251], v23 offset:20480
    ds_read_b128 v[252:255], v23 offset:22528
    s_waitcnt vmcnt(21) lgkmcnt(4)
    v_mfma_f32_16x16x32_bf16 v[128:131], v[224:227], v[192:195], v[128:131]
    v_mfma_f32_16x16x32_bf16 v[132:135], v[228:231], v[192:195], v[132:135]
    v_mfma_f32_16x16x32_bf16 v[136:139], v[232:235], v[192:195], v[136:139]
    v_mfma_f32_16x16x32_bf16 v[140:143], v[236:239], v[192:195], v[140:143]
    s_cmp_le_u32 s55, 6
    s_cselect_b32 s49, 7, 6
    s_or_b32 s49, s49, s54
    s_lshl_b32 s49, s49, 15
    s_add_u32 s49, s49, s50
    buffer_load_dwordx4 v[192:195], v28, s[12:15], s49 offen offset:0 sc1
    s_add_u32 m0, s23, 32768
    s_xor_b32 s21, s54, 8
    s_lshl_b32 s21, s21, 7
    buffer_load_dwordx4 v16, s[28:31], s21 offen offset:0  lds
    v_mfma_f32_16x16x32_bf16 v[144:147], v[224:227], v[196:199], v[144:147]
    v_mfma_f32_16x16x32_bf16 v[148:151], v[228:231], v[196:199], v[148:151]
    v_mfma_f32_16x16x32_bf16 v[152:155], v[232:235], v[196:199], v[152:155]
    v_mfma_f32_16x16x32_bf16 v[156:159], v[236:239], v[196:199], v[156:159]
    buffer_load_dwordx4 v[196:199], v28, s[12:15], s49 offen offset:1024 sc1
    s_mov_b64 exec, 0xff00
    buffer_load_dword v31, v30, s[12:15], s52 offen sc1
    s_mov_b64 exec, -1
    ds_read_b128 v[224:227], v22 offset:24576
    ds_read_b128 v[228:231], v22 offset:26624
    ds_read_b128 v[232:235], v22 offset:28672
    ds_read_b128 v[236:239], v22 offset:30720
    s_waitcnt vmcnt(17) lgkmcnt(4)
    s_mov_b64 exec, 1
    ds_add_u32 v32, v33 offset:16
    s_mov_b64 exec, -1
    v_mfma_f32_16x16x32_bf16 v[128:131], v[240:243], v[200:203], v[128:131]
    v_mfma_f32_16x16x32_bf16 v[132:135], v[244:247], v[200:203], v[132:135]
    v_mfma_f32_16x16x32_bf16 v[136:139], v[248:251], v[200:203], v[136:139]
    v_mfma_f32_16x16x32_bf16 v[140:143], v[252:255], v[200:203], v[140:143]
    buffer_load_dwordx4 v[200:203], v28, s[12:15], s49 offen offset:2048 sc1
    buffer_load_dwordx4 v17, s[28:31], s21 offen offset:1024  lds
    v_mfma_f32_16x16x32_bf16 v[144:147], v[240:243], v[204:207], v[144:147]
    v_mfma_f32_16x16x32_bf16 v[148:151], v[244:247], v[204:207], v[148:151]
    v_mfma_f32_16x16x32_bf16 v[152:155], v[248:251], v[204:207], v[152:155]
    v_mfma_f32_16x16x32_bf16 v[156:159], v[252:255], v[204:207], v[156:159]
    buffer_load_dwordx4 v[204:207], v28, s[12:15], s49 offen offset:3072 sc1
    ds_read_b128 v[240:243], v23 offset:24576
    ds_read_b128 v[244:247], v23 offset:26624
    ds_read_b128 v[248:251], v23 offset:28672
    ds_read_b128 v[252:255], v23 offset:30720
    s_waitcnt vmcnt(22) lgkmcnt(4)
    v_mfma_f32_16x16x32_bf16 v[128:131], v[224:227], v[208:211], v[128:131]
    v_mfma_f32_16x16x32_bf16 v[132:135], v[228:231], v[208:211], v[132:135]
    v_mfma_f32_16x16x32_bf16 v[136:139], v[232:235], v[208:211], v[136:139]
    v_mfma_f32_16x16x32_bf16 v[140:143], v[236:239], v[208:211], v[140:143]
    ds_read_b32 v34, v32 offset:16
    buffer_load_dwordx4 v[208:211], v29, s[12:15], s49 offen offset:0 sc1
    buffer_load_dwordx4 v18, s[28:31], s21 offen offset:2048  lds
    v_mfma_f32_16x16x32_bf16 v[144:147], v[224:227], v[212:215], v[144:147]
    v_mfma_f32_16x16x32_bf16 v[148:151], v[228:231], v[212:215], v[148:151]
    v_mfma_f32_16x16x32_bf16 v[152:155], v[232:235], v[212:215], v[152:155]
    v_mfma_f32_16x16x32_bf16 v[156:159], v[236:239], v[212:215], v[156:159]
    buffer_load_dwordx4 v[212:215], v29, s[12:15], s49 offen offset:1024 sc1
    s_waitcnt lgkmcnt(0)
    v_readfirstlane_b32 s38, v34
    s_nop 1
    s_cmp_ge_u32 s38, 20
    s_cbranch_scc1 L_st5_ok
L_st5:
    ds_read_b32 v34, v32 offset:16
    s_waitcnt lgkmcnt(0)
    v_readfirstlane_b32 s38, v34
    s_nop 1
    s_cmp_ge_u32 s38, 20
    s_cbranch_scc1 L_st5_ok
    s_sub_u32 s96, s96, 1
    s_cbranch_scc1 L_st5_ok
    s_sleep 0
    s_branch L_st5
L_st5_ok:
    ds_read_b128 v[224:227], v20 offset:0
    ds_read_b128 v[228:231], v20 offset:2048
    ds_read_b128 v[232:235], v20 offset:4096
    ds_read_b128 v[236:239], v20 offset:6144
    s_waitcnt vmcnt(22)
    v_mfma_f32_16x16x32_bf16 v[128:131], v[240:243], v[216:219], v[128:131]
    v_mfma_f32_16x16x32_bf16 v[132:135], v[244:247], v[216:219], v[132:135]
    v_mfma_f32_16x16x32_bf16 v[136:139], v[248:251], v[216:219], v[136:139]
    v_mfma_f32_16x16x32_bf16 v[140:143], v[252:255], v[216:219], v[140:143]
    buffer_load_dwordx4 v[216:219], v29, s[12:15], s49 offen offset:2048 sc1
    buffer_load_dwordx4 v19, s[28:31], s21 offen offset:3072  lds
    v_mfma_f32_16x16x32_bf16 v[144:147], v[240:243], v[220:223], v[144:147]
    v_mfma_f32_16x16x32_bf16 v[148:151], v[244:247], v[220:223], v[148:151]
    v_mfma_f32_16x16x32_bf16 v[152:155], v[248:251], v[220:223], v[152:155]
    v_mfma_f32_16x16x32_bf16 v[156:159], v[252:255], v[220:223], v[156:159]
    buffer_load_dwordx4 v[220:223], v29, s[12:15], s49 offen offset:3072 sc1
    s_waitcnt vmcnt(9)
L_h2poll:
    v_cmp_ne_u32 vcc, s93, v31
    s_nop 1
    s_and_b32 s38, vcc_lo, 0xff00
    s_cbranch_scc0 L_h2go
    s_sub_u32 s96, s96, 1
    s_cbranch_scc1 L_h2go
    s_sleep 2
    s_mov_b64 exec, 0xff00
    buffer_load_dword v31, v30, s[12:15], s52 offen sc1
    s_mov_b64 exec, -1
    s_waitcnt vmcnt(0)
    s_branch L_h2poll
L_h2go:
    ds_read_b128 v[240:243], v21 offset:0
    ds_read_b128 v[244:247], v21 offset:2048
    ds_read_b128 v[248:251], v21 offset:4096
    ds_read_b128 v[252:255], v21 offset:6144
    s_waitcnt vmcnt(22) lgkmcnt(4)
    v_mfma_f32_16x16x32_bf16 v[128:131], v[224:227], v[160:163], v[128:131]
    v_mfma_f32_16x16x32_bf16 v[132:135], v[228:231], v[160:163], v[132:135]
    v_mfma_f32_16x16x32_bf16 v[136:139], v[232:235], v[160:163], v[136:139]
    v_mfma_f32_16x16x32_bf16 v[140:143], v[236:239], v[160:163], v[140:143]
    s_xor_b32 s49, s54, 8
    s_lshl_b32 s49, s49, 15
    s_add_u32 s49, s49, s50
    buffer_load_dwordx4 v[160:163], v28, s[12:15], s49 offen offset:0 sc1
    s_add_u32 m0, s23, 49152
    s_xor_b32 s21, s54, 9
    s_lshl_b32 s21, s21, 7
    buffer_load_dwordx4 v16, s[28:31], s21 offen offset:0  lds
    v_mfma_f32_16x16x32_bf16 v[144:147], v[224:227], v[164:167], v[144:147]
    v_mfma_f32_16x16x32_bf16 v[148:151], v[228:231], v[164:167], v[148:151]
    v_mfma_f32_16x16x32_bf16 v[152:155], v[232:235], v[164:167], v[152:155]
    v_mfma_f32_16x16x32_bf16 v[156:159], v[236:239], v[164:167], v[156:159]
    buffer_load_dwordx4 v[164:167], v28, s[12:15], s49 offen offset:1024 sc1
    ds_read_b128 v[224:227], v20 offset:8192
    ds_read_b128 v[228:231], v20 offset:10240
    ds_read_b128 v[232:235], v20 offset:12288
    ds_read_b128 v[236:239], v20 offset:14336
    s_waitcnt vmcnt(17) lgkmcnt(4)
    s_mov_b64 exec, 1
    ds_add_u32 v32, v33 offset:16
    s_mov_b64 exec, -1
    v_mfma_f32_16x16x32_bf16 v[128:131], v[240:243], v[168:171], v[128:131]
    v_mfma_f32_16x16x32_bf16 v[132:135], v[244:247], v[168:171], v[132:135]
    v_mfma_f32_16x16x32_bf16 v[136:139], v[248:251], v[168:171], v[136:139]
    v_mfma_f32_16x16x32_bf16 v[140:143], v[252:255], v[168:171], v[140:143]
    buffer_load_dwordx4 v[168:171], v28, s[12:15], s49 offen offset:2048 sc1
    buffer_load_dwordx4 v17, s[28:31], s21 offen offset:1024  lds
    v_mfma_f32_16x16x32_bf16 v[144:147], v[240:243], v[172:175], v[144:147]
    v_mfma_f32_16x16x32_bf16 v[148:151], v[244:247], v[172:175], v[148:151]
    v_mfma_f32_16x16x32_bf16 v[152:155], v[248:251], v[172:175], v[152:155]
    v_mfma_f32_16x16x32_bf16 v[156:159], v[252:255], v[172:175], v[156:159]
    buffer_load_dwordx4 v[172:175], v28, s[12:15], s49 offen offset:3072 sc1
    ds_read_b128 v[240:243], v21 offset:8192
    ds_read_b128 v[244:247], v21 offset:10240
    ds_read_b128 v[248:251], v21 offset:12288
    ds_read_b128 v[252:255], v21 offset:14336
    s_waitcnt vmcnt(22) lgkmcnt(4)
    v_mfma_f32_16x16x32_bf16 v[128:131], v[224:227], v[176:179], v[128:131]
    v_mfma_f32_16x16x32_bf16 v[132:135], v[228:231], v[176:179], v[132:135]
    v_mfma_f32_16x16x32_bf16 v[136:139], v[232:235], v[176:179], v[136:139]
    v_mfma_f32_16x16x32_bf16 v[140:143], v[236:239], v[176:179], v[140:143]
    ds_read_b32 v34, v32 offset:16
    buffer_load_dwordx4 v[176:179], v29, s[12:15], s49 offen offset:0 sc1
    buffer_load_dwordx4 v18, s[28:31], s21 offen offset:2048  lds
    v_mfma_f32_16x16x32_bf16 v[144:147], v[224:227], v[180:183], v[144:147]
    v_mfma_f32_16x16x32_bf16 v[148:151], v[228:231], v[180:183], v[148:151]
    v_mfma_f32_16x16x32_bf16 v[152:155], v[232:235], v[180:183], v[152:155]
    v_mfma_f32_16x16x32_bf16 v[156:159], v[236:239], v[180:183], v[156:159]
    buffer_load_dwordx4 v[180:183], v29, s[12:15], s49 offen offset:1024 sc1
    s_waitcnt lgkmcnt(0)
    v_readfirstlane_b32 s38, v34
    s_nop 1
    s_cmp_ge_u32 s38, 24
    s_cbranch_scc1 L_st6_ok
L_st6:
    ds_read_b32 v34, v32 offset:16
    s_waitcnt lgkmcnt(0)
    v_readfirstlane_b32 s38, v34
    s_nop 1
    s_cmp_ge_u32 s38, 24
    s_cbranch_scc1 L_st6_ok
    s_sub_u32 s96, s96, 1
    s_cbranch_scc1 L_st6_ok
    s_sleep 0
    s_branch L_st6
L_st6_ok:
    ds_read_b128 v[224:227], v20 offset:16384
    ds_read_b128 v[228:231], v20 offset:18432
    ds_read_b128 v[232:235], v20 offset:20480
    ds_read_b128 v[236:239], v20 offset:22528
    s_waitcnt vmcnt(22)
    v_mfma_f32_16x16x32_bf16 v[128:131], v[240:243], v[184:187], v[128:131]
    v_mfma_f32_16x16x32_bf16 v[132:135], v[244:247], v[184:187], v[132:135]
    v_mfma_f32_16x16x32_bf16 v[136:139], v[248:251], v[184:187], v[136:139]
    v_mfma_f32_16x16x32_bf16 v[140:143], v[252:255], v[184:187], v[140:143]
    buffer_load_dwordx4 v[184:187], v29, s[12:15], s49 offen offset:2048 sc1
    buffer_load_dwordx4 v19, s[28:31], s21 offen offset:3072  lds
    v_mfma_f32_16x16x32_bf16 v[144:147], v[240:243], v[188:191], v[144:147]
    v_mfma_f32_16x16x32_bf16 v[148:151], v[244:247], v[188:191], v[148:151]
    v_mfma_f32_16x16x32_bf16 v[152:155], v[248:251], v[188:191], v[152:155]
    v_mfma_f32_16x16x32_bf16 v[156:159], v[252:255], v[188:191], v[156:159]
    buffer_load_dwordx4 v[188:191], v29, s[12:15], s49 offen offset:3072 sc1
    ds_read_b128 v[240:243], v21 offset:16384
    ds_read_b128 v[244:247], v21 offset:18432
    ds_read_b128 v[248:251], v21 offset:20480
    ds_read_b128 v[252:255], v21 offset:22528
    s_waitcnt vmcnt(22) lgkmcnt(4)
    v_mfma_f32_16x16x32_bf16 v[128:131], v[224:227], v[192:195], v[128:131]
    v_mfma_f32_16x16x32_bf16 v[132:135], v[228:231], v[192:195], v[132:135]
    v_mfma_f32_16x16x32_bf16 v[136:139], v[232:235], v[192:195], v[136:139]
    v_mfma_f32_16x16x32_bf16 v[140:143], v[236:239], v[192:195], v[140:143]
    s_xor_b32 s49, s54, 9
    s_lshl_b32 s49, s49, 15
    s_add_u32 s49, s49, s50
    buffer_load_dwordx4 v[192:195], v28, s[12:15], s49 offen offset:0 sc1
    s_add_u32 m0, s23, 81920
    s_xor_b32 s21, s54, 10
    s_lshl_b32 s21, s21, 7
    buffer_load_dwordx4 v16, s[28:31], s21 offen offset:0  lds
    v_mfma_f32_16x16x32_bf16 v[144:147], v[224:227], v[196:199], v[144:147]
    v_mfma_f32_16x16x32_bf16 v[148:151], v[228:231], v[196:199], v[148:151]
    v_mfma_f32_16x16x32_bf16 v[152:155], v[232:235], v[196:199], v[152:155]
    v_mfma_f32_16x16x32_bf16 v[156:159], v[236:239], v[196:199], v[156:159]
    buffer_load_dwordx4 v[196:199], v28, s[12:15], s49 offen offset:1024 sc1
    ds_read_b128 v[224:227], v20 offset:24576
    ds_read_b128 v[228:231], v20 offset:26624
    ds_read_b128 v[232:235], v20 offset:28672
    ds_read_b128 v[236:239], v20 offset:30720
    s_waitcnt vmcnt(16) lgkmcnt(4)
    s_mov_b64 exec, 1
    ds_add_u32 v32, v33 offset:16
    s_mov_b64 exec, -1
    v_mfma_f32_16x16x32_bf16 v[128:131], v[240:243], v[200:203], v[128:131]
    v_mfma_f32_16x16x32_bf16 v[132:135], v[244:247], v[200:203], v[132:135]
    v_mfma_f32_16x16x32_bf16 v[136:139], v[248:251], v[200:203], v[136:139]
    v_mfma_f32_16x16x32_bf16 v[140:143], v[252:255], v[200:203], v[140:143]
    buffer_load_dwordx4 v[200:203], v28, s[12:15], s49 offen offset:2048 sc1
    buffer_load_dwordx4 v17, s[28:31], s21 offen offset:1024  lds
    v_mfma_f32_16x16x32_bf16 v[144:147], v[240:243], v[204:207], v[144:147]
    v_mfma_f32_16x16x32_bf16 v[148:151], v[244:247], v[204:207], v[148:151]
    v_mfma_f32_16x16x32_bf16 v[152:155], v[248:251], v[204:207], v[152:155]
    v_mfma_f32_16x16x32_bf16 v[156:159], v[252:255], v[204:207], v[156:159]
    buffer_load_dwordx4 v[204:207], v28, s[12:15], s49 offen offset:3072 sc1
    ds_read_b128 v[240:243], v21 offset:24576
    ds_read_b128 v[244:247], v21 offset:26624
    ds_read_b128 v[248:251], v21 offset:28672
    ds_read_b128 v[252:255], v21 offset:30720
    s_waitcnt vmcnt(21) lgkmcnt(4)
    v_mfma_f32_16x16x32_bf16 v[128:131], v[224:227], v[208:211], v[128:131]
    v_mfma_f32_16x16x32_bf16 v[132:135], v[228:231], v[208:211], v[132:135]
    v_mfma_f32_16x16x32_bf16 v[136:139], v[232:235], v[208:211], v[136:139]
    v_mfma_f32_16x16x32_bf16 v[140:143], v[236:239], v[208:211], v[140:143]
    ds_read_b32 v34, v32 offset:16
    buffer_load_dwordx4 v[208:211], v29, s[12:15], s49 offen offset:0 sc1
    buffer_load_dwordx4 v18, s[28:31], s21 offen offset:2048  lds
    v_mfma_f32_16x16x32_bf16 v[144:147], v[224:227], v[212:215], v[144:147]
    v_mfma_f32_16x16x32_bf16 v[148:151], v[228:231], v[212:215], v[148:151]
    v_mfma_f32_16x16x32_bf16 v[152:155], v[232:235], v[212:215], v[152:155]
    v_mfma_f32_16x16x32_bf16 v[156:159], v[236:239], v[212:215], v[156:159]
    buffer_load_dwordx4 v[212:215], v29, s[12:15], s49 offen offset:1024 sc1
    s_waitcnt lgkmcnt(0)
    v_readfirstlane_b32 s38, v34
    s_nop 1
    s_cmp_ge_u32 s38, 28
    s_cbranch_scc1 L_st7_ok
L_st7:
    ds_read_b32 v34, v32 offset:16
    s_waitcnt lgkmcnt(0)
    v_readfirstlane_b32 s38, v34
    s_nop 1
    s_cmp_ge_u32 s38, 28
    s_cbranch_scc1 L_st7_ok
    s_sub_u32 s96, s96, 1
    s_cbranch_scc1 L_st7_ok
    s_sleep 0
    s_branch L_st7
L_st7_ok:
    ds_read_b128 v[224:227], v20 offset:32768
    ds_read_b128 v[228:231], v20 offset:34816
    ds_read_b128 v[232:235], v20 offset:36864
    ds_read_b128 v[236:239], v20 offset:38912
    s_waitcnt vmcnt(21)
    v_mfma_f32_16x16x32_bf16 v[128:131], v[240:243], v[216:219], v[128:131]
    v_mfma_f32_16x16x32_bf16 v[132:135], v[244:247], v[216:219], v[132:135]
    v_mfma_f32_16x16x32_bf16 v[136:139], v[248:251], v[216:219], v[136:139]
    v_mfma_f32_16x16x32_bf16 v[140:143], v[252:255], v[216:219], v[140:143]
    buffer_load_dwordx4 v[216:219], v29, s[12:15], s49 offen offset:2048 sc1
    buffer_load_dwordx4 v19, s[28:31], s21 offen offset:3072  lds
    v_mfma_f32_16x16x32_bf16 v[144:147], v[240:243], v[220:223], v[144:147]
    v_mfma_f32_16x16x32_bf16 v[148:151], v[244:247], v[220:223], v[148:151]
    v_mfma_f32_16x16x32_bf16 v[152:155], v[248:251], v[220:223], v[152:155]
    v_mfma_f32_16x16x32_bf16 v[156:159], v[252:255], v[220:223], v[156:159]
    buffer_load_dwordx4 v[220:223], v29, s[12:15], s49 offen offset:3072 sc1
    ds_read_b128 v[240:243], v21 offset:32768
    ds_read_b128 v[244:247], v21 offset:34816
    ds_read_b128 v[248:251], v21 offset:36864
    ds_read_b128 v[252:255], v21 offset:38912
    s_waitcnt vmcnt(21) lgkmcnt(4)
    v_mfma_f32_16x16x32_bf16 v[128:131], v[224:227], v[160:163], v[128:131]
    v_mfma_f32_16x16x32_bf16 v[132:135], v[228:231], v[160:163], v[132:135]
    v_mfma_f32_16x16x32_bf16 v[136:139], v[232:235], v[160:163], v[136:139]
    v_mfma_f32_16x16x32_bf16 v[140:143], v[236:239], v[160:163], v[140:143]
    s_xor_b32 s49, s54, 10
    s_lshl_b32 s49, s49, 15
    s_add_u32 s49, s49, s50
    buffer_load_dwordx4 v[160:163], v28, s[12:15], s49 offen offset:0 sc1
    s_add_u32 m0, s23, 0
    s_xor_b32 s21, s54, 11
    s_lshl_b32 s21, s21, 7
    buffer_load_dwordx4 v16, s[28:31], s21 offen offset:0  lds
    v_mfma_f32_16x16x32_bf16 v[144:147], v[224:227], v[164:167], v[144:147]
    v_mfma_f32_16x16x32_bf16 v[148:151], v[228:231], v[164:167], v[148:151]
    v_mfma_f32_16x16x32_bf16 v[152:155], v[232:235], v[164:167], v[152:155]
    v_mfma_f32_16x16x32_bf16 v[156:159], v[236:239], v[164:167], v[156:159]
    buffer_load_dwordx4 v[164:167], v28, s[12:15], s49 offen offset:1024 sc1
    ds_read_b128 v[224:227], v20 offset:40960
    ds_read_b128 v[228:231], v20 offset:43008
    ds_read_b128 v[232:235], v20 offset:45056
    ds_read_b128 v[236:239], v20 offset:47104
    s_waitcnt vmcnt(16) lgkmcnt(4)
    s_mov_b64 exec, 1
    ds_add_u32 v32, v33 offset:16
    s_mov_b64 exec, -1
    v_mfma_f32_16x16x32_bf16 v[128:131], v[240:243], v[168:171], v[128:131]
    v_mfma_f32_16x16x32_bf16 v[132:135], v[244:247], v[168:171], v[132:135]
    v_mfma_f32_16x16x32_bf16 v[136:139], v[248:251], v[168:171], v[136:139]
    v_mfma_f32_16x16x32_bf16 v[140:143], v[252:255], v[168:171], v[140:143]
    buffer_load_dwordx4 v[168:171], v28, s[12:15], s49 offen offset:2048 sc1
    buffer_load_dwordx4 v17, s[28:31], s21 offen offset:1024  lds
    v_mfma_f32_16x16x32_bf16 v[144:147], v[240:243], v[172:175], v[144:147]
    v_mfma_f32_16x16x32_bf16 v[148:151], v[244:247], v[172:175], v[148:151]
    v_mfma_f32_16x16x32_bf16 v[152:155], v[248:251], v[172:175], v[152:155]
    v_mfma_f32_16x16x32_bf16 v[156:159], v[252:255], v[172:175], v[156:159]
    buffer_load_dwordx4 v[172:175], v28, s[12:15], s49 offen offset:3072 sc1
    ds_read_b128 v[240:243], v21 offset:40960
    ds_read_b128 v[244:247], v21 offset:43008
    ds_read_b128 v[248:251], v21 offset:45056
    ds_read_b128 v[252:255], v21 offset:47104
    s_waitcnt vmcnt(21) lgkmcnt(4)
    v_mfma_f32_16x16x32_bf16 v[128:131], v[224:227], v[176:179], v[128:131]
    v_mfma_f32_16x16x32_bf16 v[132:135], v[228:231], v[176:179], v[132:135]
    v_mfma_f32_16x16x32_bf16 v[136:139], v[232:235], v[176:179], v[136:139]
    v_mfma_f32_16x16x32_bf16 v[140:143], v[236:239], v[176:179], v[140:143]
    ds_read_b32 v34, v32 offset:16
    buffer_load_dwordx4 v[176:179], v29, s[12:15], s49 offen offset:0 sc1
    buffer_load_dwordx4 v18, s[28:31], s21 offen offset:2048  lds
    v_mfma_f32_16x16x32_bf16 v[144:147], v[224:227], v[180:183], v[144:147]
    v_mfma_f32_16x16x32_bf16 v[148:151], v[228:231], v[180:183], v[148:151]
    v_mfma_f32_16x16x32_bf16 v[152:155], v[232:235], v[180:183], v[152:155]
    v_mfma_f32_16x16x32_bf16 v[156:159], v[236:239], v[180:183], v[156:159]
    buffer_load_dwordx4 v[180:183], v29, s[12:15], s49 offen offset:1024 sc1
    s_waitcnt lgkmcnt(0)
    v_readfirstlane_b32 s38, v34
    s_nop 1
    s_cmp_ge_u32 s38, 32
    s_cbranch_scc1 L_st8_ok
L_st8:
    ds_read_b32 v34, v32 offset:16
    s_waitcnt lgkmcnt(0)
    v_readfirstlane_b32 s38, v34
    s_nop 1
    s_cmp_ge_u32 s38, 32
    s_cbranch_scc1 L_st8_ok
    s_sub_u32 s96, s96, 1
    s_cbranch_scc1 L_st8_ok
    s_sleep 0
    s_branch L_st8
L_st8_ok:
    ds_read_b128 v[224:227], v20 offset:49152
    ds_read_b128 v[228:231], v20 offset:51200
    ds_read_b128 v[232:235], v20 offset:53248
    ds_read_b128 v[236:239], v20 offset:55296
    s_waitcnt vmcnt(21)
    v_mfma_f32_16x16x32_bf16 v[128:131], v[240:243], v[184:187], v[128:131]
    v_mfma_f32_16x16x32_bf16 v[132:135], v[244:247], v[184:187], v[132:135]
    v_mfma_f32_16x16x32_bf16 v[136:139], v[248:251], v[184:187], v[136:139]
    v_mfma_f32_16x16x32_bf16 v[140:143], v[252:255], v[184:187], v[140:143]
    buffer_load_dwordx4 v[184:187], v29, s[12:15], s49 offen offset:2048 sc1
    buffer_load_dwordx4 v19, s[28:31], s21 offen offset:3072  lds
    v_mfma_f32_16x16x32_bf16 v[144:147], v[240:243], v[188:191], v[144:147]
    v_mfma_f32_16x16x32_bf16 v[148:151], v[244:247], v[188:191], v[148:151]
    v_mfma_f32_16x16x32_bf16 v[152:155], v[248:251], v[188:191], v[152:155]
    v_mfma_f32_16x16x32_bf16 v[156:159], v[252:255], v[188:191], v[156:159]
    buffer_load_dwordx4 v[188:191], v29, s[12:15], s49 offen offset:3072 sc1
    ds_read_b128 v[240:243], v21 offset:49152
    ds_read_b128 v[244:247], v21 offset:51200
    ds_read_b128 v[248:251], v21 offset:53248
    ds_read_b128 v[252:255], v21 offset:55296
    s_waitcnt vmcnt(21) lgkmcnt(4)
    v_mfma_f32_16x16x32_bf16 v[128:131], v[224:227], v[192:195], v[128:131]
    v_mfma_f32_16x16x32_bf16 v[132:135], v[228:231], v[192:195], v[132:135]
    v_mfma_f32_16x16x32_bf16 v[136:139], v[232:235], v[192:195], v[136:139]
    v_mfma_f32_16x16x32_bf16 v[140:143], v[236:239], v[192:195], v[140:143]
    s_xor_b32 s49, s54, 11
    s_lshl_b32 s49, s49, 15
    s_add_u32 s49, s49, s50
    buffer_load_dwordx4 v[192:195], v28, s[12:15], s49 offen offset:0 sc1
    s_add_u32 m0, s23, 16384
    s_xor_b32 s21, s54, 12
    s_lshl_b32 s21, s21, 7
    buffer_load_dwordx4 v16, s[28:31], s21 offen offset:0  lds
    v_mfma_f32_16x16x32_bf16 v[144:147], v[224:227], v[196:199], v[144:147]
    v_mfma_f32_16x16x32_bf16 v[148:151], v[228:231], v[196:199], v[148:151]
    v_mfma_f32_16x16x32_bf16 v[152:155], v[232:235], v[196:199], v[152:155]
    v_mfma_f32_16x16x32_bf16 v[156:159], v[236:239], v[196:199], v[156:159]
    buffer_load_dwordx4 v[196:199], v28, s[12:15], s49 offen offset:1024 sc1
    ds_read_b128 v[224:227], v20 offset:57344
    ds_read_b128 v[228:231], v20 offset:59392
    ds_read_b128 v[232:235], v20 offset:61440
    ds_read_b128 v[236:239], v20 offset:63488
    s_waitcnt vmcnt(16) lgkmcnt(4)
    s_mov_b64 exec, 1
    ds_add_u32 v32, v33 offset:16
    s_mov_b64 exec, -1
    v_mfma_f32_16x16x32_bf16 v[128:131], v[240:243], v[200:203], v[128:131]
    v_mfma_f32_16x16x32_bf16 v[132:135], v[244:247], v[200:203], v[132:135]
    v_mfma_f32_16x16x32_bf16 v[136:139], v[248:251], v[200:203], v[136:139]
    v_mfma_f32_16x16x32_bf16 v[140:143], v[252:255], v[200:203], v[140:143]
    buffer_load_dwordx4 v[200:203], v28, s[12:15], s49 offen offset:2048 sc1
    buffer_load_dwordx4 v17, s[28:31], s21 offen offset:1024  lds
    v_mfma_f32_16x16x32_bf16 v[144:147], v[240:243], v[204:207], v[144:147]
    v_mfma_f32_16x16x32_bf16 v[148:151], v[244:247], v[204:207], v[148:151]
    v_mfma_f32_16x16x32_bf16 v[152:155], v[248:251], v[204:207], v[152:155]
    v_mfma_f32_16x16x32_bf16 v[156:159], v[252:255], v[204:207], v[156:159]
    buffer_load_dwordx4 v[204:207], v28, s[12:15], s49 offen offset:3072 sc1
    ds_read_b128 v[240:243], v21 offset:57344
    ds_read_b128 v[244:247], v21 offset:59392
    ds_read_b128 v[248:251], v21 offset:61440
    ds_read_b128 v[252:255], v21 offset:63488
    s_waitcnt vmcnt(21) lgkmcnt(4)
    v_mfma_f32_16x16x32_bf16 v[128:131], v[224:227], v[208:211], v[128:131]
    v_mfma_f32_16x16x32_bf16 v[132:135], v[228:231], v[208:211], v[132:135]
    v_mfma_f32_16x16x32_bf16 v[136:139], v[232:235], v[208:211], v[136:139]
    v_mfma_f32_16x16x32_bf16 v[140:143], v[236:239], v[208:211], v[140:143]
    ds_read_b32 v34, v32 offset:16
    buffer_load_dwordx4 v[208:211], v29, s[12:15], s49 offen offset:0 sc1
    buffer_load_dwordx4 v18, s[28:31], s21 offen offset:2048  lds
    v_mfma_f32_16x16x32_bf16 v[144:147], v[224:227], v[212:215], v[144:147]
    v_mfma_f32_16x16x32_bf16 v[148:151], v[228:231], v[212:215], v[148:151]
    v_mfma_f32_16x16x32_bf16 v[152:155], v[232:235], v[212:215], v[152:155]
    v_mfma_f32_16x16x32_bf16 v[156:159], v[236:239], v[212:215], v[156:159]
    buffer_load_dwordx4 v[212:215], v29, s[12:15], s49 offen offset:1024 sc1
    s_waitcnt lgkmcnt(0)
    v_readfirstlane_b32 s38, v34
    s_nop 1
    s_cmp_ge_u32 s38, 36
    s_cbranch_scc1 L_st9_ok
L_st9:
    ds_read_b32 v34, v32 offset:16
    s_waitcnt lgkmcnt(0)
    v_readfirstlane_b32 s38, v34
    s_nop 1
    s_cmp_ge_u32 s38, 36
    s_cbranch_scc1 L_st9_ok
    s_sub_u32 s96, s96, 1
    s_cbranch_scc1 L_st9_ok
    s_sleep 0
    s_branch L_st9
L_st9_ok:
    ds_read_b128 v[224:227], v22 offset:16384
    ds_read_b128 v[228:231], v22 offset:18432
    ds_read_b128 v[232:235], v22 offset:20480
    ds_read_b128 v[236:239], v22 offset:22528
    s_waitcnt vmcnt(21)
    v_mfma_f32_16x16x32_bf16 v[128:131], v[240:243], v[216:219], v[128:131]
    v_mfma_f32_16x16x32_bf16 v[132:135], v[244:247], v[216:219], v[132:135]
    v_mfma_f32_16x16x32_bf16 v[136:139], v[248:251], v[216:219], v[136:139]
    v_mfma_f32_16x16x32_bf16 v[140:143], v[252:255], v[216:219], v[140:143]
    buffer_load_dwordx4 v[216:219], v29, s[12:15], s49 offen offset:2048 sc1
    buffer_load_dwordx4 v19, s[28:31], s21 offen offset:3072  lds
    v_mfma_f32_16x16x32_bf16 v[144:147], v[240:243], v[220:223], v[144:147]
    v_mfma_f32_16x16x32_bf16 v[148:151], v[244:247], v[220:223], v[148:151]
    v_mfma_f32_16x16x32_bf16 v[152:155], v[248:251], v[220:223], v[152:155]
    v_mfma_f32_16x16x32_bf16 v[156:159], v[252:255], v[220:223], v[156:159]
    buffer_load_dwordx4 v[220:223], v29, s[12:15], s49 offen offset:3072 sc1
    ds_read_b128 v[240:243], v23 offset:16384
    ds_read_b128 v[244:247], v23 offset:18432
    ds_read_b128 v[248:251], v23 offset:20480
    ds_read_b128 v[252:255], v23 offset:22528
    s_waitcnt vmcnt(21) lgkmcnt(4)
    v_mfma_f32_16x16x32_bf16 v[128:131], v[224:227], v[160:163], v[128:131]
    v_mfma_f32_16x16x32_bf16 v[132:135], v[228:231], v[160:163], v[132:135]
    v_mfma_f32_16x16x32_bf16 v[136:139], v[232:235], v[160:163], v[136:139]
    v_mfma_f32_16x16x32_bf16 v[140:143], v[236:239], v[160:163], v[140:143]
    s_xor_b32 s49, s54, 12
    s_lshl_b32 s49, s49, 15
    s_add_u32 s49, s49, s50
    buffer_load_dwordx4 v[160:163], v28, s[12:15], s49 offen offset:0 sc1
    s_add_u32 m0, s23, 32768
    s_xor_b32 s21, s54, 13
    s_lshl_b32 s21, s21, 7
    buffer_load_dwordx4 v16, s[28:31], s21 offen offset:0  lds
    v_mfma_f32_16x16x32_bf16 v[144:147], v[224:227], v[164:167], v[144:147]
    v_mfma_f32_16x16x32_bf16 v[148:151], v[228:231], v[164:167], v[148:151]
    v_mfma_f32_16x16x32_bf16 v[152:155], v[232:235], v[164:167], v[152:155]
    v_mfma_f32_16x16x32_bf16 v[156:159], v[236:239], v[164:167], v[156:159]
    buffer_load_dwordx4 v[164:167], v28, s[12:15], s49 offen offset:1024 sc1
    ds_read_b128 v[224:227], v22 offset:24576
    ds_read_b128 v[228:231], v22 offset:26624
    ds_read_b128 v[232:235], v22 offset:28672
    ds_read_b128 v[236:239], v22 offset:30720
    s_waitcnt vmcnt(16) lgkmcnt(4)
    s_mov_b64 exec, 1
    ds_add_u32 v32, v33 offset:16
    s_mov_b64 exec, -1
    v_mfma_f32_16x16x32_bf16 v[128:131], v[240:243], v[168:171], v[128:131]
    v_mfma_f32_16x16x32_bf16 v[132:135], v[244:247], v[168:171], v[132:135]
    v_mfma_f32_16x16x32_bf16 v[136:139], v[248:251], v[168:171], v[136:139]
    v_mfma_f32_16x16x32_bf16 v[140:143], v[252:255], v[168:171], v[140:143]
    buffer_load_dwordx4 v[168:171], v28, s[12:15], s49 offen offset:2048 sc1
    buffer_load_dwordx4 v17, s[28:31], s21 offen offset:1024  lds
    v_mfma_f32_16x16x32_bf16 v[144:147], v[240:243], v[172:175], v[144:147]
    v_mfma_f32_16x16x32_bf16 v[148:151], v[244:247], v[172:175], v[148:151]
    v_mfma_f32_16x16x32_bf16 v[152:155], v[248:251], v[172:175], v[152:155]
    v_mfma_f32_16x16x32_bf16 v[156:159], v[252:255], v[172:175], v[156:159]
    buffer_load_dwordx4 v[172:175], v28, s[12:15], s49 offen offset:3072 sc1
    ds_read_b128 v[240:243], v23 offset:24576
    ds_read_b128 v[244:247], v23 offset:26624
    ds_read_b128 v[248:251], v23 offset:28672
    ds_read_b128 v[252:255], v23 offset:30720
    s_waitcnt vmcnt(21) lgkmcnt(4)
    v_mfma_f32_16x16x32_bf16 v[128:131], v[224:227], v[176:179], v[128:131]
    v_mfma_f32_16x16x32_bf16 v[132:135], v[228:231], v[176:179], v[132:135]
    v_mfma_f32_16x16x32_bf16 v[136:139], v[232:235], v[176:179], v[136:139]
    v_mfma_f32_16x16x32_bf16 v[140:143], v[236:239], v[176:179], v[140:143]
    ds_read_b32 v34, v32 offset:16
    buffer_load_dwordx4 v[176:179], v29, s[12:15], s49 offen offset:0 sc1
    buffer_load_dwordx4 v18, s[28:31], s21 offen offset:2048  lds
    v_mfma_f32_16x16x32_bf16 v[144:147], v[224:227], v[180:183], v[144:147]
    v_mfma_f32_16x16x32_bf16 v[148:151], v[228:231], v[180:183], v[148:151]
    v_mfma_f32_16x16x32_bf16 v[152:155], v[232:235], v[180:183], v[152:155]
    v_mfma_f32_16x16x32_bf16 v[156:159], v[236:239], v[180:183], v[156:159]
    buffer_load_dwordx4 v[180:183], v29, s[12:15], s49 offen offset:1024 sc1
    s_waitcnt lgkmcnt(0)
    v_readfirstlane_b32 s38, v34
    s_nop 1
    s_cmp_ge_u32 s38, 40
    s_cbranch_scc1 L_st10_ok
L_st10:
    ds_read_b32 v34, v32 offset:16
    s_waitcnt lgkmcnt(0)
    v_readfirstlane_b32 s38, v34
    s_nop 1
    s_cmp_ge_u32 s38, 40
    s_cbranch_scc1 L_st10_ok
    s_sub_u32 s96, s96, 1
    s_cbranch_scc1 L_st10_ok
    s_sleep 0
    s_branch L_st10
L_st10_ok:
    ds_read_b128 v[224:227], v20 offset:0
    ds_read_b128 v[228:231], v20 offset:2048
    ds_read_b128 v[232:235], v20 offset:4096
    ds_read_b128 v[236:239], v20 offset:6144
    s_waitcnt vmcnt(21)
    v_mfma_f32_16x16x32_bf16 v[128:131], v[240:243], v[184:187], v[128:131]
    v_mfma_f32_16x16x32_bf16 v[132:135], v[244:247], v[184:187], v[132:135]
    v_mfma_f32_16x16x32_bf16 v[136:139], v[248:251], v[184:187], v[136:139]
    v_mfma_f32_16x16x32_bf16 v[140:143], v[252:255], v[184:187], v[140:143]
    buffer_load_dwordx4 v[184:187], v29, s[12:15], s49 offen offset:2048 sc1
    buffer_load_dwordx4 v19, s[28:31], s21 offen offset:3072  lds
    v_mfma_f32_16x16x32_bf16 v[144:147], v[240:243], v[188:191], v[144:147]
    v_mfma_f32_16x16x32_bf16 v[148:151], v[244:247], v[188:191], v[148:151]
    v_mfma_f32_16x16x32_bf16 v[152:155], v[248:251], v[188:191], v[152:155]
    v_mfma_f32_16x16x32_bf16 v[156:159], v[252:255], v[188:191], v[156:159]
    buffer_load_dwordx4 v[188:191], v29, s[12:15], s49 offen offset:3072 sc1
    ds_read_b128 v[240:243], v21 offset:0
    ds_read_b128 v[244:247], v21 offset:2048
    ds_read_b128 v[248:251], v21 offset:4096
    ds_read_b128 v[252:255], v21 offset:6144
    s_waitcnt vmcnt(21) lgkmcnt(4)
    v_mfma_f32_16x16x32_bf16 v[128:131], v[224:227], v[192:195], v[128:131]
    v_mfma_f32_16x16x32_bf16 v[132:135], v[228:231], v[192:195], v[132:135]
    v_mfma_f32_16x16x32_bf16 v[136:139], v[232:235], v[192:195], v[136:139]
    v_mfma_f32_16x16x32_bf16 v[140:143], v[236:239], v[192:195], v[140:143]
    s_xor_b32 s49, s54, 13
    s_lshl_b32 s49, s49, 15
    s_add_u32 s49, s49, s50
    buffer_load_dwordx4 v[192:195], v28, s[12:15], s49 offen offset:0 sc1
    s_add_u32 m0, s23, 49152
    s_xor_b32 s21, s54, 14
    s_lshl_b32 s21, s21, 7
    buffer_load_dwordx4 v16, s[28:31], s21 offen offset:0  lds
    v_mfma_f32_16x16x32_bf16 v[144:147], v[224:227], v[196:199], v[144:147]
    v_mfma_f32_16x16x32_bf16 v[148:151], v[228:231], v[196:199], v[148:151]
    v_mfma_f32_16x16x32_bf16 v[152:155], v[232:235], v[196:199], v[152:155]
    v_mfma_f32_16x16x32_bf16 v[156:159], v[236:239], v[196:199], v[156:159]
    buffer_load_dwordx4 v[196:199], v28, s[12:15], s49 offen offset:1024 sc1
    ds_read_b128 v[224:227], v20 offset:8192
    ds_read_b128 v[228:231], v20 offset:10240
    ds_read_b128 v[232:235], v20 offset:12288
    ds_read_b128 v[236:239], v20 offset:14336
    s_waitcnt vmcnt(16) lgkmcnt(4)
    s_mov_b64 exec, 1
    ds_add_u32 v32, v33 offset:16
    s_mov_b64 exec, -1
    v_mfma_f32_16x16x32_bf16 v[128:131], v[240:243], v[200:203], v[128:131]
    v_mfma_f32_16x16x32_bf16 v[132:135], v[244:247], v[200:203], v[132:135]
    v_mfma_f32_16x16x32_bf16 v[136:139], v[248:251], v[200:203], v[136:139]
    v_mfma_f32_16x16x32_bf16 v[140:143], v[252:255], v[200:203], v[140:143]
    buffer_load_dwordx4 v[200:203], v28, s[12:15], s49 offen offset:2048 sc1
    buffer_load_dwordx4 v17, s[28:31], s21 offen offset:1024  lds
    v_mfma_f32_16x16x32_bf16 v[144:147], v[240:243], v[204:207], v[144:147]
    v_mfma_f32_16x16x32_bf16 v[148:151], v[244:247], v[204:207], v[148:151]
    v_mfma_f32_16x16x32_bf16 v[152:155], v[248:251], v[204:207], v[152:155]
    v_mfma_f32_16x16x32_bf16 v[156:159], v[252:255], v[204:207], v[156:159]
    buffer_load_dwordx4 v[204:207], v28, s[12:15], s49 offen offset:3072 sc1
    ds_read_b128 v[240:243], v21 offset:8192
    ds_read_b128 v[244:247], v21 offset:10240
    ds_read_b128 v[248:251], v21 offset:12288
    ds_read_b128 v[252:255], v21 offset:14336
    s_waitcnt vmcnt(21) lgkmcnt(4)
    v_mfma_f32_16x16x32_bf16 v[128:131], v[224:227], v[208:211], v[128:131]
    v_mfma_f32_16x16x32_bf16 v[132:135], v[228:231], v[208:211], v[132:135]
    v_mfma_f32_16x16x32_bf16 v[136:139], v[232:235], v[208:211], v[136:139]
    v_mfma_f32_16x16x32_bf16 v[140:143], v[236:239], v[208:211], v[140:143]
    ds_read_b32 v34, v32 offset:16
    buffer_load_dwordx4 v[208:211], v29, s[12:15], s49 offen offset:0 sc1
    buffer_load_dwordx4 v18, s[28:31], s21 offen offset:2048  lds
    v_mfma_f32_16x16x32_bf16 v[144:147], v[224:227], v[212:215], v[144:147]
    v_mfma_f32_16x16x32_bf16 v[148:151], v[228:231], v[212:215], v[148:151]
    v_mfma_f32_16x16x32_bf16 v[152:155], v[232:235], v[212:215], v[152:155]
    v_mfma_f32_16x16x32_bf16 v[156:159], v[236:239], v[212:215], v[156:159]
    buffer_load_dwordx4 v[212:215], v29, s[12:15], s49 offen offset:1024 sc1
    s_waitcnt lgkmcnt(0)
    v_readfirstlane_b32 s38, v34
    s_nop 1
    s_cmp_ge_u32 s38, 44
    s_cbranch_scc1 L_st11_ok
L_st11:
    ds_read_b32 v34, v32 offset:16
    s_waitcnt lgkmcnt(0)
    v_readfirstlane_b32 s38, v34
    s_nop 1
    s_cmp_ge_u32 s38, 44
    s_cbranch_scc1 L_st11_ok
    s_sub_u32 s96, s96, 1
    s_cbranch_scc1 L_st11_ok
    s_sleep 0
    s_branch L_st11
L_st11_ok:
    ds_read_b128 v[224:227], v20 offset:16384
    ds_read_b128 v[228:231], v20 offset:18432
    ds_read_b128 v[232:235], v20 offset:20480
    ds_read_b128 v[236:239], v20 offset:22528
    s_waitcnt vmcnt(21)
    v_mfma_f32_16x16x32_bf16 v[128:131], v[240:243], v[216:219], v[128:131]
    v_mfma_f32_16x16x32_bf16 v[132:135], v[244:247], v[216:219], v[132:135]
    v_mfma_f32_16x16x32_bf16 v[136:139], v[248:251], v[216:219], v[136:139]
    v_mfma_f32_16x16x32_bf16 v[140:143], v[252:255], v[216:219], v[140:143]
    buffer_load_dwordx4 v[216:219], v29, s[12:15], s49 offen offset:2048 sc1
    buffer_load_dwordx4 v19, s[28:31], s21 offen offset:3072  lds
    v_mfma_f32_16x16x32_bf16 v[144:147], v[240:243], v[220:223], v[144:147]
    v_mfma_f32_16x16x32_bf16 v[148:151], v[244:247], v[220:223], v[148:151]
    v_mfma_f32_16x16x32_bf16 v[152:155], v[248:251], v[220:223], v[152:155]
    v_mfma_f32_16x16x32_bf16 v[156:159], v[252:255], v[220:223], v[156:159]
    buffer_load_dwordx4 v[220:223], v29, s[12:15], s49 offen offset:3072 sc1
    ds_read_b128 v[240:243], v21 offset:16384
    ds_read_b128 v[244:247], v21 offset:18432
    ds_read_b128 v[248:251], v21 offset:20480
    ds_read_b128 v[252:255], v21 offset:22528
    s_waitcnt vmcnt(21) lgkmcnt(4)
    v_mfma_f32_16x16x32_bf16 v[128:131], v[224:227], v[160:163], v[128:131]
    v_mfma_f32_16x16x32_bf16 v[132:135], v[228:231], v[160:163], v[132:135]
    v_mfma_f32_16x16x32_bf16 v[136:139], v[232:235], v[160:163], v[136:139]
    v_mfma_f32_16x16x32_bf16 v[140:143], v[236:239], v[160:163], v[140:143]
    s_xor_b32 s49, s54, 14
    s_lshl_b32 s49, s49, 15
    s_add_u32 s49, s49, s50
    buffer_load_dwordx4 v[160:163], v28, s[12:15], s49 offen offset:0 sc1
    s_add_u32 m0, s23, 81920
    s_xor_b32 s21, s54, 15
    s_lshl_b32 s21, s21, 7
    buffer_load_dwordx4 v16, s[28:31], s21 offen offset:0  lds
    v_mfma_f32_16x16x32_bf16 v[144:147], v[224:227], v[164:167], v[144:147]
    v_mfma_f32_16x16x32_bf16 v[148:151], v[228:231], v[164:167], v[148:151]
    v_mfma_f32_16x16x32_bf16 v[152:155], v[232:235], v[164:167], v[152:155]
    v_mfma_f32_16x16x32_bf16 v[156:159], v[236:239], v[164:167], v[156:159]
    buffer_load_dwordx4 v[164:167], v28, s[12:15], s49 offen offset:1024 sc1
    ds_read_b128 v[224:227], v20 offset:24576
    ds_read_b128 v[228:231], v20 offset:26624
    ds_read_b128 v[232:235], v20 offset:28672
    ds_read_b128 v[236:239], v20 offset:30720
    s_waitcnt vmcnt(16) lgkmcnt(4)
    s_mov_b64 exec, 1
    ds_add_u32 v32, v33 offset:16
    s_mov_b64 exec, -1
    v_mfma_f32_16x16x32_bf16 v[128:131], v[240:243], v[168:171], v[128:131]
    v_mfma_f32_16x16x32_bf16 v[132:135], v[244:247], v[168:171], v[132:135]
    v_mfma_f32_16x16x32_bf16 v[136:139], v[248:251], v[168:171], v[136:139]
    v_mfma_f32_16x16x32_bf16 v[140:143], v[252:255], v[168:171], v[140:143]
    buffer_load_dwordx4 v[168:171], v28, s[12:15], s49 offen offset:2048 sc1
    buffer_load_dwordx4 v17, s[28:31], s21 offen offset:1024  lds
    v_mfma_f32_16x16x32_bf16 v[144:147], v[240:243], v[172:175], v[144:147]
    v_mfma_f32_16x16x32_bf16 v[148:151], v[244:247], v[172:175], v[148:151]
    v_mfma_f32_16x16x32_bf16 v[152:155], v[248:251], v[172:175], v[152:155]
    v_mfma_f32_16x16x32_bf16 v[156:159], v[252:255], v[172:175], v[156:159]
    buffer_load_dwordx4 v[172:175], v28, s[12:15], s49 offen offset:3072 sc1
    ds_read_b128 v[240:243], v21 offset:24576
    ds_read_b128 v[244:247], v21 offset:26624
    ds_read_b128 v[248:251], v21 offset:28672
    ds_read_b128 v[252:255], v21 offset:30720
    s_waitcnt vmcnt(21) lgkmcnt(4)
    v_mfma_f32_16x16x32_bf16 v[128:131], v[224:227], v[176:179], v[128:131]
    v_mfma_f32_16x16x32_bf16 v[132:135], v[228:231], v[176:179], v[132:135]
    v_mfma_f32_16x16x32_bf16 v[136:139], v[232:235], v[176:179], v[136:139]
    v_mfma_f32_16x16x32_bf16 v[140:143], v[236:239], v[176:179], v[140:143]
    ds_read_b32 v34, v32 offset:16
    buffer_load_dwordx4 v[176:179], v29, s[12:15], s49 offen offset:0 sc1
    buffer_load_dwordx4 v18, s[28:31], s21 offen offset:2048  lds
    v_mfma_f32_16x16x32_bf16 v[144:147], v[224:227], v[180:183], v[144:147]
    v_mfma_f32_16x16x32_bf16 v[148:151], v[228:231], v[180:183], v[148:151]
    v_mfma_f32_16x16x32_bf16 v[152:155], v[232:235], v[180:183], v[152:155]
    v_mfma_f32_16x16x32_bf16 v[156:159], v[236:239], v[180:183], v[156:159]
    buffer_load_dwordx4 v[180:183], v29, s[12:15], s49 offen offset:1024 sc1
    s_waitcnt lgkmcnt(0)
    v_readfirstlane_b32 s38, v34
    s_nop 1
    s_cmp_ge_u32 s38, 48
    s_cbranch_scc1 L_st12_ok
L_st12:
    ds_read_b32 v34, v32 offset:16
    s_waitcnt lgkmcnt(0)
    v_readfirstlane_b32 s38, v34
    s_nop 1
    s_cmp_ge_u32 s38, 48
    s_cbranch_scc1 L_st12_ok
    s_sub_u32 s96, s96, 1
    s_cbranch_scc1 L_st12_ok
    s_sleep 0
    s_branch L_st12
L_st12_ok:
    ds_read_b128 v[224:227], v20 offset:32768
    ds_read_b128 v[228:231], v20 offset:34816
    ds_read_b128 v[232:235], v20 offset:36864
    ds_read_b128 v[236:239], v20 offset:38912
    s_waitcnt vmcnt(21)
    v_mfma_f32_16x16x32_bf16 v[128:131], v[240:243], v[184:187], v[128:131]
    v_mfma_f32_16x16x32_bf16 v[132:135], v[244:247], v[184:187], v[132:135]
    v_mfma_f32_16x16x32_bf16 v[136:139], v[248:251], v[184:187], v[136:139]
    v_mfma_f32_16x16x32_bf16 v[140:143], v[252:255], v[184:187], v[140:143]
    buffer_load_dwordx4 v[184:187], v29, s[12:15], s49 offen offset:2048 sc1
    buffer_load_dwordx4 v19, s[28:31], s21 offen offset:3072  lds
    v_mfma_f32_16x16x32_bf16 v[144:147], v[240:243], v[188:191], v[144:147]
    v_mfma_f32_16x16x32_bf16 v[148:151], v[244:247], v[188:191], v[148:151]
    v_mfma_f32_16x16x32_bf16 v[152:155], v[248:251], v[188:191], v[152:155]
    v_mfma_f32_16x16x32_bf16 v[156:159], v[252:255], v[188:191], v[156:159]
    buffer_load_dwordx4 v[188:191], v29, s[12:15], s49 offen offset:3072 sc1
    ds_read_b128 v[240:243], v21 offset:32768
    ds_read_b128 v[244:247], v21 offset:34816
    ds_read_b128 v[248:251], v21 offset:36864
    ds_read_b128 v[252:255], v21 offset:38912
    s_waitcnt vmcnt(21) lgkmcnt(4)
    v_mfma_f32_16x16x32_bf16 v[128:131], v[224:227], v[192:195], v[128:131]
    v_mfma_f32_16x16x32_bf16 v[132:135], v[228:231], v[192:195], v[132:135]
    v_mfma_f32_16x16x32_bf16 v[136:139], v[232:235], v[192:195], v[136:139]
    v_mfma_f32_16x16x32_bf16 v[140:143], v[236:239], v[192:195], v[140:143]
    s_xor_b32 s49, s54, 15
    s_lshl_b32 s49, s49, 15
    s_add_u32 s49, s49, s50
    buffer_load_dwordx4 v[192:195], v28, s[12:15], s49 offen offset:0 sc1
    v_mfma_f32_16x16x32_bf16 v[144:147], v[224:227], v[196:199], v[144:147]
    v_mfma_f32_16x16x32_bf16 v[148:151], v[228:231], v[196:199], v[148:151]
    v_mfma_f32_16x16x32_bf16 v[152:155], v[232:235], v[196:199], v[152:155]
    v_mfma_f32_16x16x32_bf16 v[156:159], v[236:239], v[196:199], v[156:159]
    buffer_load_dwordx4 v[196:199], v28, s[12:15], s49 offen offset:1024 sc1
    ds_read_b128 v[224:227], v20 offset:40960
    ds_read_b128 v[228:231], v20 offset:43008
    ds_read_b128 v[232:235], v20 offset:45056
    ds_read_b128 v[236:239], v20 offset:47104
    s_waitcnt vmcnt(15) lgkmcnt(4)
    s_mov_b64 exec, 1
    ds_add_u32 v32, v33 offset:16
    s_mov_b64 exec, -1
    v_mfma_f32_16x16x32_bf16 v[128:131], v[240:243], v[200:203], v[128:131]
    v_mfma_f32_16x16x32_bf16 v[132:135], v[244:247], v[200:203], v[132:135]
    v_mfma_f32_16x16x32_bf16 v[136:139], v[248:251], v[200:203], v[136:139]
    v_mfma_f32_16x16x32_bf16 v[140:143], v[252:255], v[200:203], v[140:143]
    buffer_load_dwordx4 v[200:203], v28, s[12:15], s49 offen offset:2048 sc1
    v_mfma_f32_16x16x32_bf16 v[144:147], v[240:243], v[204:207], v[144:147]
    v_mfma_f32_16x16x32_bf16 v[148:151], v[244:247], v[204:207], v[148:151]
    v_mfma_f32_16x16x32_bf16 v[152:155], v[248:251], v[204:207], v[152:155]
    v_mfma_f32_16x16x32_bf16 v[156:159], v[252:255], v[204:207], v[156:159]
    buffer_load_dwordx4 v[204:207], v28, s[12:15], s49 offen offset:3072 sc1
    ds_read_b128 v[240:243], v21 offset:40960
    ds_read_b128 v[244:247], v21 offset:43008
    ds_read_b128 v[248:251], v21 offset:45056
    ds_read_b128 v[252:255], v21 offset:47104
    s_waitcnt vmcnt(19) lgkmcnt(4)
    v_mfma_f32_16x16x32_bf16 v[128:131], v[224:227], v[208:211], v[128:131]
    v_mfma_f32_16x16x32_bf16 v[132:135], v[228:231], v[208:211], v[132:135]
    v_mfma_f32_16x16x32_bf16 v[136:139], v[232:235], v[208:211], v[136:139]
    v_mfma_f32_16x16x32_bf16 v[140:143], v[236:239], v[208:211], v[140:143]
    ds_read_b32 v34, v32 offset:16
    buffer_load_dwordx4 v[208:211], v29, s[12:15], s49 offen offset:0 sc1
    v_mfma_f32_16x16x32_bf16 v[144:147], v[224:227], v[212:215], v[144:147]
    v_mfma_f32_16x16x32_bf16 v[148:151], v[228:231], v[212:215], v[148:151]
    v_mfma_f32_16x16x32_bf16 v[152:155], v[232:235], v[212:215], v[152:155]
    v_mfma_f32_16x16x32_bf16 v[156:159], v[236:239], v[212:215], v[156:159]
    buffer_load_dwordx4 v[212:215], v29, s[12:15], s49 offen offset:1024 sc1
    s_waitcnt lgkmcnt(0)
    v_readfirstlane_b32 s38, v34
    s_nop 1
    s_cmp_ge_u32 s38, 52
    s_cbranch_scc1 L_st13_ok
L_st13:
    ds_read_b32 v34, v32 offset:16
    s_waitcnt lgkmcnt(0)
    v_readfirstlane_b32 s38, v34
    s_nop 1
    s_cmp_ge_u32 s38, 52
    s_cbranch_scc1 L_st13_ok
    s_sub_u32 s96, s96, 1
    s_cbranch_scc1 L_st13_ok
    s_sleep 0
    s_branch L_st13
L_st13_ok:
    ds_read_b128 v[224:227], v20 offset:49152
    ds_read_b128 v[228:231], v20 offset:51200
    ds_read_b128 v[232:235], v20 offset:53248
    ds_read_b128 v[236:239], v20 offset:55296
    s_waitcnt vmcnt(18)
    v_mfma_f32_16x16x32_bf16 v[128:131], v[240:243], v[216:219], v[128:131]
    v_mfma_f32_16x16x32_bf16 v[132:135], v[244:247], v[216:219], v[132:135]
    v_mfma_f32_16x16x32_bf16 v[136:139], v[248:251], v[216:219], v[136:139]
    v_mfma_f32_16x16x32_bf16 v[140:143], v[252:255], v[216:219], v[140:143]
    buffer_load_dwordx4 v[216:219], v29, s[12:15], s49 offen offset:2048 sc1
    v_mfma_f32_16x16x32_bf16 v[144:147], v[240:243], v[220:223], v[144:147]
    v_mfma_f32_16x16x32_bf16 v[148:151], v[244:247], v[220:223], v[148:151]
    v_mfma_f32_16x16x32_bf16 v[152:155], v[248:251], v[220:223], v[152:155]
    v_mfma_f32_16x16x32_bf16 v[156:159], v[252:255], v[220:223], v[156:159]
    buffer_load_dwordx4 v[220:223], v29, s[12:15], s49 offen offset:3072 sc1
    ds_read_b128 v[240:243], v21 offset:49152
    ds_read_b128 v[244:247], v21 offset:51200
    ds_read_b128 v[248:251], v21 offset:53248
    ds_read_b128 v[252:255], v21 offset:55296
    s_waitcnt vmcnt(17) lgkmcnt(4)
    v_mfma_f32_16x16x32_bf16 v[128:131], v[224:227], v[160:163], v[128:131]
    v_mfma_f32_16x16x32_bf16 v[132:135], v[228:231], v[160:163], v[132:135]
    v_mfma_f32_16x16x32_bf16 v[136:139], v[232:235], v[160:163], v[136:139]
    v_mfma_f32_16x16x32_bf16 v[140:143], v[236:239], v[160:163], v[140:143]
    v_mfma_f32_16x16x32_bf16 v[144:147], v[224:227], v[164:167], v[144:147]
    v_mfma_f32_16x16x32_bf16 v[148:151], v[228:231], v[164:167], v[148:151]
    v_mfma_f32_16x16x32_bf16 v[152:155], v[232:235], v[164:167], v[152:155]
    v_mfma_f32_16x16x32_bf16 v[156:159], v[236:239], v[164:167], v[156:159]
    ds_read_b128 v[224:227], v20 offset:57344
    ds_read_b128 v[228:231], v20 offset:59392
    ds_read_b128 v[232:235], v20 offset:61440
    ds_read_b128 v[236:239], v20 offset:63488
    s_waitcnt vmcnt(9) lgkmcnt(4)
    s_mov_b64 exec, 1
    ds_add_u32 v32, v33 offset:16
    s_mov_b64 exec, -1
    v_mfma_f32_16x16x32_bf16 v[128:131], v[240:243], v[168:171], v[128:131]
    v_mfma_f32_16x16x32_bf16 v[132:135], v[244:247], v[168:171], v[132:135]
    v_mfma_f32_16x16x32_bf16 v[136:139], v[248:251], v[168:171], v[136:139]
    v_mfma_f32_16x16x32_bf16 v[140:143], v[252:255], v[168:171], v[140:143]
    v_mfma_f32_16x16x32_bf16 v[144:147], v[240:243], v[172:175], v[144:147]
    v_mfma_f32_16x16x32_bf16 v[148:151], v[244:247], v[172:175], v[148:151]
    v_mfma_f32_16x16x32_bf16 v[152:155], v[248:251], v[172:175], v[152:155]
    v_mfma_f32_16x16x32_bf16 v[156:159], v[252:255], v[172:175], v[156:159]
    ds_read_b128 v[240:243], v21 offset:57344
    ds_read_b128 v[244:247], v21 offset:59392
    ds_read_b128 v[248:251], v21 offset:61440
    ds_read_b128 v[252:255], v21 offset:63488
    s_waitcnt vmcnt(11) lgkmcnt(4)
    v_mfma_f32_16x16x32_bf16 v[128:131], v[224:227], v[176:179], v[128:131]
    v_mfma_f32_16x16x32_bf16 v[132:135], v[228:231], v[176:179], v[132:135]
    v_mfma_f32_16x16x32_bf16 v[136:139], v[232:235], v[176:179], v[136:139]
    v_mfma_f32_16x16x32_bf16 v[140:143], v[236:239], v[176:179], v[140:143]
    ds_read_b32 v34, v32 offset:16
    v_mfma_f32_16x16x32_bf16 v[144:147], v[224:227], v[180:183], v[144:147]
    v_mfma_f32_16x16x32_bf16 v[148:151], v[228:231], v[180:183], v[148:151]
    v_mfma_f32_16x16x32_bf16 v[152:155], v[232:235], v[180:183], v[152:155]
    v_mfma_f32_16x16x32_bf16 v[156:159], v[236:239], v[180:183], v[156:159]
    s_waitcnt lgkmcnt(0)
    v_readfirstlane_b32 s38, v34
    s_nop 1
    s_cmp_ge_u32 s38, 56
    s_cbranch_scc1 L_st14_ok
L_st14:
    ds_read_b32 v34, v32 offset:16
    s_waitcnt lgkmcnt(0)
    v_readfirstlane_b32 s38, v34
    s_nop 1
    s_cmp_ge_u32 s38, 56
    s_cbranch_scc1 L_st14_ok
    s_sub_u32 s96, s96, 1
    s_cbranch_scc1 L_st14_ok
    s_sleep 0
    s_branch L_st14
L_st14_ok:
    ds_read_b128 v[224:227], v22 offset:16384
    ds_read_b128 v[228:231], v22 offset:18432
    ds_read_b128 v[232:235], v22 offset:20480
    ds_read_b128 v[236:239], v22 offset:22528
    s_waitcnt vmcnt(8)
    v_mfma_f32_16x16x32_bf16 v[128:131], v[240:243], v[184:187], v[128:131]
    v_mfma_f32_16x16x32_bf16 v[132:135], v[244:247], v[184:187], v[132:135]
    v_mfma_f32_16x16x32_bf16 v[136:139], v[248:251], v[184:187], v[136:139]
    v_mfma_f32_16x16x32_bf16 v[140:143], v[252:255], v[184:187], v[140:143]
    v_mfma_f32_16x16x32_bf16 v[144:147], v[240:243], v[188:191], v[144:147]
    v_mfma_f32_16x16x32_bf16 v[148:151], v[244:247], v[188:191], v[148:151]
    v_mfma_f32_16x16x32_bf16 v[152:155], v[248:251], v[188:191], v[152:155]
    v_mfma_f32_16x16x32_bf16 v[156:159], v[252:255], v[188:191], v[156:159]
    ds_read_b128 v[240:243], v23 offset:16384
    ds_read_b128 v[244:247], v23 offset:18432
    ds_read_b128 v[248:251], v23 offset:20480
    ds_read_b128 v[252:255], v23 offset:22528
    s_waitcnt vmcnt(6) lgkmcnt(4)
    v_mfma_f32_16x16x32_bf16 v[128:131], v[224:227], v[192:195], v[128:131]
    v_mfma_f32_16x16x32_bf16 v[132:135], v[228:231], v[192:195], v[132:135]
    v_mfma_f32_16x16x32_bf16 v[136:139], v[232:235], v[192:195], v[136:139]
    v_mfma_f32_16x16x32_bf16 v[140:143], v[236:239], v[192:195], v[140:143]
    v_mfma_f32_16x16x32_bf16 v[144:147], v[224:227], v[196:199], v[144:147]
    v_mfma_f32_16x16x32_bf16 v[148:151], v[228:231], v[196:199], v[148:151]
    v_mfma_f32_16x16x32_bf16 v[152:155], v[232:235], v[196:199], v[152:155]
    v_mfma_f32_16x16x32_bf16 v[156:159], v[236:239], v[196:199], v[156:159]
    ds_read_b128 v[224:227], v22 offset:24576
    ds_read_b128 v[228:231], v22 offset:26624
    ds_read_b128 v[232:235], v22 offset:28672
    ds_read_b128 v[236:239], v22 offset:30720
    s_waitcnt vmcnt(4) lgkmcnt(4)
    v_mfma_f32_16x16x32_bf16 v[128:131], v[240:243], v[200:203], v[128:131]
    v_mfma_f32_16x16x32_bf16 v[132:135], v[244:247], v[200:203], v[132:135]
    v_mfma_f32_16x16x32_bf16 v[136:139], v[248:251], v[200:203], v[136:139]
    v_mfma_f32_16x16x32_bf16 v[140:143], v[252:255], v[200:203], v[140:143]
    v_mfma_f32_16x16x32_bf16 v[144:147], v[240:243], v[204:207], v[144:147]
    v_mfma_f32_16x16x32_bf16 v[148:151], v[244:247], v[204:207], v[148:151]
    v_mfma_f32_16x16x32_bf16 v[152:155], v[248:251], v[204:207], v[152:155]
    v_mfma_f32_16x16x32_bf16 v[156:159], v[252:255], v[204:207], v[156:159]
    ds_read_b128 v[240:243], v23 offset:24576
    ds_read_b128 v[244:247], v23 offset:26624
    ds_read_b128 v[248:251], v23 offset:28672
    ds_read_b128 v[252:255], v23 offset:30720
    s_waitcnt vmcnt(2) lgkmcnt(4)
    v_mfma_f32_16x16x32_bf16 v[128:131], v[224:227], v[208:211], v[128:131]
    v_mfma_f32_16x16x32_bf16 v[132:135], v[228:231], v[208:211], v[132:135]
    v_mfma_f32_16x16x32_bf16 v[136:139], v[232:235], v[208:211], v[136:139]
    v_mfma_f32_16x16x32_bf16 v[140:143], v[236:239], v[208:211], v[140:143]
    v_mfma_f32_16x16x32_bf16 v[144:147], v[224:227], v[212:215], v[144:147]
    v_mfma_f32_16x16x32_bf16 v[148:151], v[228:231], v[212:215], v[148:151]
    v_mfma_f32_16x16x32_bf16 v[152:155], v[232:235], v[212:215], v[152:155]
    v_mfma_f32_16x16x32_bf16 v[156:159], v[236:239], v[212:215], v[156:159]
L_topw:
    ds_read_b32 v34, v32 offset:32
    s_waitcnt lgkmcnt(0)
    v_readfirstlane_b32 s38, v34
    s_nop 1
    s_cmp_ge_u32 s38, 1
    s_cbranch_scc1 L_topw_ok
    s_sub_u32 s96, s96, 1
    s_cbranch_scc1 L_topw_ok
    s_sleep 1
    s_branch L_topw
L_topw_ok:
    ds_read_b32 v60, v47
    s_sub_u32 s38, 2047, s51
    s_waitcnt lgkmcnt(0)
    v_and_b32 v60, 0x7ff, v60
    v_sub_u32 v60, s38, v60
    v_cmp_gt_u32 vcc, 32, v60
    s_nop 1
    s_and_b32 s57, vcc_lo, 0xff
L_fix:
    s_cmp_eq_u32 s57, 0
    s_cbranch_scc1 L_fixd
    s_ff1_i32_b32 s8, s57
    s_bitset0_b32 s57, s8
    v_readlane_b32 s9, v60, s8
    v_lshl_add_u32 v52, s8, 2, v32
L_dfw:
    ds_read_b32 v53, v52 offset:36
    s_waitcnt lgkmcnt(0)
    v_readfirstlane_b32 s38, v53
    s_nop 1
    s_cmp_ge_u32 s38, 1
    s_cbranch_scc1 L_dfw_ok
    s_sub_u32 s96, s96, 1
    s_cbranch_scc1 L_dfw_ok
    s_sleep 2
    s_branch L_dfw
L_dfw_ok:
    s_lshl_b32 s38, s8, 8
    s_add_u32 s38, s38, 75776
    v_lshl_add_u32 v52, v26, 4, s38
    ds_read_b128 v[48:51], v52
    s_and_b32 s38, s9, 3
    s_lshl_b32 s38, s38, 4
    s_lshl_b64 s[10:11], 0xffff, s38
    s_lshr_b32 s9, s9, 2
    s_waitcnt lgkmcnt(0)
    s_mov_b64 exec, s[10:11]
    s_cmp_lg_u32 s9, 0
    s_cbranch_scc1 L_fx0
    v_pk_add_f32 v[72:73], v[72:73], v[48:49]
    v_pk_add_f32 v[74:75], v[74:75], v[50:51]
L_fx0:
    s_cmp_lg_u32 s9, 1
    s_cbranch_scc1 L_fx1
    v_pk_add_f32 v[76:77], v[76:77], v[48:49]
    v_pk_add_f32 v[78:79], v[78:79], v[50:51]
L_fx1:
    s_cmp_lg_u32 s9, 2
    s_cbranch_scc1 L_fx2
    v_pk_add_f32 v[88:89], v[88:89], v[48:49]
    v_pk_add_f32 v[90:91], v[90:91], v[50:51]
L_fx2:
    s_cmp_lg_u32 s9, 3
    s_cbranch_scc1 L_fx3
    v_pk_add_f32 v[92:93], v[92:93], v[48:49]
    v_pk_add_f32 v[94:95], v[94:95], v[50:51]
L_fx3:
    s_cmp_lg_u32 s9, 4
    s_cbranch_scc1 L_fx4
    v_pk_add_f32 v[104:105], v[104:105], v[48:49]
    v_pk_add_f32 v[106:107], v[106:107], v[50:51]
L_fx4:
    s_cmp_lg_u32 s9, 5
    s_cbranch_scc1 L_fx5
    v_pk_add_f32 v[108:109], v[108:109], v[48:49]
    v_pk_add_f32 v[110:111], v[110:111], v[50:51]
L_fx5:
    s_cmp_lg_u32 s9, 6
    s_cbranch_scc1 L_fx6
    v_pk_add_f32 v[120:121], v[120:121], v[48:49]
    v_pk_add_f32 v[122:123], v[122:123], v[50:51]
L_fx6:
    s_cmp_lg_u32 s9, 7
    s_cbranch_scc1 L_fx7
    v_pk_add_f32 v[124:125], v[124:125], v[48:49]
    v_pk_add_f32 v[126:127], v[126:127], v[50:51]
L_fx7:
    s_mov_b64 exec, -1
    s_branch L_fix
L_fixd:
    s_waitcnt vmcnt(0) lgkmcnt(0)
    v_mfma_f32_16x16x32_bf16 v[128:131], v[240:243], v[216:219], v[128:131]
    v_mfma_f32_16x16x32_bf16 v[132:135], v[244:247], v[216:219], v[132:135]
    v_mfma_f32_16x16x32_bf16 v[136:139], v[248:251], v[216:219], v[136:139]
    v_mfma_f32_16x16x32_bf16 v[140:143], v[252:255], v[216:219], v[140:143]
    v_mfma_f32_16x16x32_bf16 v[144:147], v[240:243], v[220:223], v[144:147]
    v_mfma_f32_16x16x32_bf16 v[148:151], v[244:247], v[220:223], v[148:151]
    v_mfma_f32_16x16x32_bf16 v[152:155], v[248:251], v[220:223], v[152:155]
    v_mfma_f32_16x16x32_bf16 v[156:159], v[252:255], v[220:223], v[156:159]
    s_nop 3
    ds_write_b128 v44, v[128:131] offset:0
    ds_write_b128 v44, v[132:135] offset:64
    ds_write_b128 v44, v[136:139] offset:128
    ds_write_b128 v44, v[140:143] offset:192
    ds_read_b128 v[160:163], v45 offset:0
    ds_read_b128 v[164:167], v45 offset:1088
    ds_read_b128 v[168:171], v45 offset:2176
    ds_read_b128 v[172:175], v45 offset:3264
    ds_write_b128 v44, v[144:147] offset:4352
    ds_write_b128 v44, v[148:151] offset:4416
    ds_write_b128 v44, v[152:155] offset:4480
    ds_write_b128 v44, v[156:159] offset:4544
    ds_read_b128 v[176:179], v45 offset:4352
    ds_read_b128 v[180:183], v45 offset:5440
    ds_read_b128 v[184:187], v45 offset:6528
    ds_read_b128 v[188:191], v45 offset:7616
    s_waitcnt lgkmcnt(11)
    v_pk_fma_f32 v[160:161], v[36:37], v[160:161], v[72:73] op_sel:[0,0,0] op_sel_hi:[0,1,1]
    v_pk_fma_f32 v[162:163], v[36:37], v[162:163], v[74:75] op_sel:[0,0,0] op_sel_hi:[0,1,1]
    buffer_store_dwordx4 v[160:163], v46, s[32:35], s56 offen sc1 nt
    s_add_u32 s56, s56, 16384
    s_waitcnt lgkmcnt(10)
    v_pk_fma_f32 v[164:165], v[36:37], v[164:165], v[76:77] op_sel:[1,0,0] op_sel_hi:[1,1,1]
    v_pk_fma_f32 v[166:167], v[36:37], v[166:167], v[78:79] op_sel:[1,0,0] op_sel_hi:[1,1,1]
    buffer_store_dwordx4 v[164:167], v46, s[32:35], s56 offen sc1 nt
    s_add_u32 s56, s56, 16384
    s_waitcnt lgkmcnt(9)
    v_pk_fma_f32 v[168:169], v[38:39], v[168:169], v[88:89] op_sel:[0,0,0] op_sel_hi:[0,1,1]
    v_pk_fma_f32 v[170:171], v[38:39], v[170:171], v[90:91] op_sel:[0,0,0] op_sel_hi:[0,1,1]
    buffer_store_dwordx4 v[168:171], v46, s[32:35], s56 offen sc1 nt
    s_add_u32 s56, s56, 16384
    s_waitcnt lgkmcnt(8)
    v_pk_fma_f32 v[172:173], v[38:39], v[172:173], v[92:93] op_sel:[1,0,0] op_sel_hi:[1,1,1]
    v_pk_fma_f32 v[174:175], v[38:39], v[174:175], v[94:95] op_sel:[1,0,0] op_sel_hi:[1,1,1]
    buffer_store_dwordx4 v[172:175], v46, s[32:35], s56 offen sc1 nt
    s_add_u32 s56, s56, 16384
    s_waitcnt lgkmcnt(3)
    v_pk_fma_f32 v[176:177], v[40:41], v[176:177], v[104:105] op_sel:[0,0,0] op_sel_hi:[0,1,1]
    v_pk_fma_f32 v[178:179], v[40:41], v[178:179], v[106:107] op_sel:[0,0,0] op_sel_hi:[0,1,1]
    buffer_store_dwordx4 v[176:179], v46, s[32:35], s56 offen sc1 nt
    s_add_u32 s56, s56, 16384
    s_waitcnt lgkmcnt(2)
    v_pk_fma_f32 v[180:181], v[40:41], v[180:181], v[108:109] op_sel:[1,0,0] op_sel_hi:[1,1,1]
    v_pk_fma_f32 v[182:183], v[40:41], v[182:183], v[110:111] op_sel:[1,0,0] op_sel_hi:[1,1,1]
    buffer_store_dwordx4 v[180:183], v46, s[32:35], s56 offen sc1 nt
    s_add_u32 s56, s56, 16384
    s_waitcnt lgkmcnt(1)
    v_pk_fma_f32 v[184:185], v[42:43], v[184:185], v[120:121] op_sel:[0,0,0] op_sel_hi:[0,1,1]
    v_pk_fma_f32 v[186:187], v[42:43], v[186:187], v[122:123] op_sel:[0,0,0] op_sel_hi:[0,1,1]
    buffer_store_dwordx4 v[184:187], v46, s[32:35], s56 offen sc1 nt
    s_add_u32 s56, s56, 16384
    s_waitcnt lgkmcnt(0)
    v_pk_fma_f32 v[188:189], v[42:43], v[188:189], v[124:125] op_sel:[1,0,0] op_sel_hi:[1,1,1]
    v_pk_fma_f32 v[190:191], v[42:43], v[190:191], v[126:127] op_sel:[1,0,0] op_sel_hi:[1,1,1]
    buffer_store_dwordx4 v[188:191], v46, s[32:35], s56 offen sc1 nt
    s_add_u32 s56, s56, 16384
    s_endpgm
L_code_end:
.section .rodata,"a"
.p2align 6
.amdhsa_kernel gated_mix__ssm_conv_s5__moe_arch_mod__prompt_kernel
  .amdhsa_next_free_vgpr 256
  .amdhsa_next_free_sgpr 102
  .amdhsa_accum_offset 256
  .amdhsa_group_segment_fixed_size 0
  .amdhsa_kernarg_size 144
  .amdhsa_user_sgpr_count 2
  .amdhsa_user_sgpr_kernarg_segment_ptr 1
  .amdhsa_system_sgpr_workgroup_id_x 1
  .amdhsa_float_denorm_mode_32 3
.end_amdhsa_kernel
```

```asm
; @launch grid=(256,1,1) block=(512,1,1) lds=163840
.amdgcn_target "amdgcn-amd-amdhsa--gfx950"
.text
.globl gated_mix__ssm_conv_s5__moe_arch_mod__prompt_kernel
.p2align 8
.type gated_mix__ssm_conv_s5__moe_arch_mod__prompt_kernel,@function
gated_mix__ssm_conv_s5__moe_arch_mod__prompt_kernel:
L_code_start:
    s_getpc_b64 s[32:33]
    s_load_dwordx2 s[40:41], s[0:1], 0
    s_load_dwordx16 s[64:79], s[0:1], 8
    s_load_dwordx8 s[44:51], s[0:1], 80
    s_load_dwordx4 s[80:83], s[0:1], 112
    s_load_dwordx2 s[42:43], s[0:1], 136
    v_lshrrev_b32 v1, 6, v0
    s_cmp_ge_u32 s2, 256
    s_cbranch_scc1 L_exit
    s_sub_u32 s32, s32, 4
    s_subb_u32 s33, s33, 0
    s_mov_b32 s34, L_code_end-L_code_start
    s_mov_b32 s35, 0x20000
    s_lshr_b32 s59, s2, 3
    s_lshl_b32 s59, s59, 11
    v_lshlrev_b32 v2, 2, v0
    buffer_load_dword v9, v2, s[32:35], s59 offen
    v_readfirstlane_b32 s18, v1
    s_mov_b32 s96, 1048576
    s_and_b32 s3, s2, 7
    s_lshr_b32 s39, s3, 2
    s_lshl_b32 s39, s39, 1
    s_xor_b32 s3, s3, s39
    s_lshr_b32 s38, s2, 3
    s_lshr_b32 s16, s3, 1
    s_lshl_b32 s16, s16, 2
    s_and_b32 s39, s38, 3
    s_add_u32 s16, s16, s39
    s_and_b32 s17, s3, 1
    s_lshl_b32 s17, s17, 3
    s_lshr_b32 s39, s38, 2
    s_add_u32 s17, s17, s39
    s_cmp_ge_u32 s18, 4
    s_cbranch_scc1 L_side
    v_and_b32 v26, 15, v0
    v_bfe_u32 v4, v0, 7, 1
    v_lshl_add_u32 v4, v4, 5, v26
    s_lshl_b32 s39, s17, 6
    v_add_lshl_u32 v255, s39, v4, 1
    s_waitcnt lgkmcnt(0)
    global_load_ushort v224, v255, s[64:65] offset:0
    global_load_ushort v226, v255, s[66:67] offset:0
    global_load_ushort v228, v255, s[76:77] offset:0
    global_load_ushort v225, v255, s[64:65] offset:32
    global_load_ushort v227, v255, s[66:67] offset:32
    global_load_ushort v229, v255, s[76:77] offset:32
    s_branch L_gemm
L_side:
    s_sub_u32 s18, s18, 4
    v_and_b32 v2, 63, v0
    s_lshl_b32 s19, s3, 8
    s_lshl_b32 s39, s38, 3
    s_add_u32 s19, s19, s39
    s_mov_b32 s56, 0
    s_lshl_b32 s58, s18, 12
    v_lshrrev_b32 v4, 3, v2
    v_and_b32 v5, 7, v2
    v_lshrrev_b32 v6, 4, v2
    v_xor_b32 v5, v5, v6
    v_lshlrev_b32 v5, 4, v5
    v_lshrrev_b32 v7, 1, v2
    v_and_b32 v7, 16, v7
    v_and_or_b32 v7, v2, 8, v7
    v_and_or_b32 v6, v6, 1, v7
    s_lshr_b32 s20, s18, 1
    s_and_b32 s21, s18, 1
    s_lshl_b32 s38, s20, 6
    s_lshl_b32 s39, s21, 2
    s_add_u32 s38, s38, s39
    s_lshl_b32 s39, s16, 7
    s_add_u32 s38, s38, s39
    v_add_u32 v6, s38, v6
    v_lshl_add_u32 v6, v6, 11, v5
    v_xor_b32 v7, 64, v6
    v_add_u32 v100, 3072, v6
    v_add_u32 v101, 67584, v7
    v_add_u32 v102, 5120, v6
    v_add_u32 v103, 69632, v7
    s_lshl_b32 s38, s17, 6
    s_lshl_b32 s39, s20, 5
    s_add_u32 s38, s38, s39
    v_add_u32 v6, s38, v4
    v_lshl_add_u32 v6, v6, 11, v5
    v_xor_b32 v7, 64, v6
    v_add_u32 v104, 3072, v6
    v_add_u32 v105, 18432, v7
    v_add_u32 v106, 33792, v6
    v_add_u32 v107, 49152, v7
    s_waitcnt lgkmcnt(0)
    s_sub_u32 s8, s40, 3072
    s_subb_u32 s9, s41, 0
    s_mov_b32 s10, 4197376
    s_mov_b32 s11, 0x20000
    s_add_u32 m0, s58, 0
    s_add_u32 s57, s56, 0
    s_and_b32 s57, s57, 2047
    buffer_load_dwordx4 v100, s[8:11], s57 offen offset:0  lds
    buffer_load_dwordx4 v101, s[8:11], s57 offen offset:1024  lds
    buffer_load_dwordx4 v102, s[8:11], s57 offen offset:2048  lds
    buffer_load_dwordx4 v103, s[8:11], s57 offen offset:3072  lds
    s_cmp_eq_u32 s21, 0
    s_cselect_b32 s24, s68, s70
    s_cselect_b32 s25, s69, s71
    s_sub_u32 s24, s24, 3072
    s_subb_u32 s25, s25, 0
    s_mov_b32 s26, 2100224
    s_mov_b32 s27, 0x20000
    s_add_u32 m0, s58, 16384
    s_nop 0
    buffer_load_dwordx4 v104, s[24:27], s57 offen offset:0  lds
    buffer_load_dwordx4 v105, s[24:27], s57 offen offset:1024  lds
    buffer_load_dwordx4 v106, s[24:27], s57 offen offset:2048  lds
    buffer_load_dwordx4 v107, s[24:27], s57 offen offset:3072  lds
    s_add_u32 s94, s42, 9469952
    s_addc_u32 s95, s43, 0
    s_load_dword s93, s[94:95], 0
    s_mov_b32 s12, s42
    s_mov_b32 s13, s43
    s_mov_b32 s14, 25165824
    s_mov_b32 s15, 0x20000
    s_mov_b32 s21, 0xffff0000
    v_and_b32 v11, 15, v2
    s_bfe_u32 s38, s2, 0x30003
    s_min_u32 s39, s38, 6
    s_and_b32 s36, s38, 1
    s_cmp_eq_u32 s18, 0
    s_cselect_b64 s[98:99], s[82:83], s[46:47]
    s_cselect_b64 s[100:101], s[42:43], s[48:49]
    s_cselect_b32 s39, s38, s39
    s_mov_b32 s37, s39
    s_cmp_eq_u32 s18, 2
    s_cselect_b64 s[98:99], s[50:51], s[98:99]
    s_cselect_b64 s[100:101], s[42:43], s[100:101]
    s_cselect_b32 s38, 8, 0
    s_add_u32 s37, s37, s38
    s_cmp_eq_u32 s18, 3
    s_cselect_b64 s[98:99], s[72:73], s[98:99]
    s_cselect_b64 s[100:101], s[74:75], s[100:101]
    s_cselect_b32 s39, s36, s39
    s_cselect_b32 s37, s36, s37
    s_lshl_b32 s39, s39, 20
    s_lshl_b32 s37, s37, 20
    s_load_dword s97, s[98:99], s39
    s_load_dword s97, s[100:101], s37
    s_add_u32 m0, s58, 32768
    s_add_u32 s57, s56, 128
    s_and_b32 s57, s57, 2047
    buffer_load_dwordx4 v100, s[8:11], s57 offen offset:0  lds
    buffer_load_dwordx4 v101, s[8:11], s57 offen offset:1024  lds
    buffer_load_dwordx4 v102, s[8:11], s57 offen offset:2048  lds
    buffer_load_dwordx4 v103, s[8:11], s57 offen offset:3072  lds
    s_add_u32 m0, s58, 49152
    s_nop 0
    buffer_load_dwordx4 v104, s[24:27], s57 offen offset:0  lds
    buffer_load_dwordx4 v105, s[24:27], s57 offen offset:1024  lds
    buffer_load_dwordx4 v106, s[24:27], s57 offen offset:2048  lds
    buffer_load_dwordx4 v107, s[24:27], s57 offen offset:3072  lds
    v_lshlrev_b32 v3, 4, v2
    s_mul_hi_u32 s23, s2, 76695845
    s_mul_i32 s38, s23, 56
    s_sub_u32 s22, s2, s38
    v_lshrrev_b32 v5, 3, v2
    v_and_b32 v8, 7, v2
    v_and_b32 v12, 3, v5
    v_lshlrev_b32 v12, 1, v12
    v_xor_b32 v8, v8, v12
    v_mul_u32_u24 v4, 7168, v5
    v_lshl_add_u32 v4, v8, 4, v4
    s_lshl_b32 s38, s18, 6
    s_lshl_b32 s39, s23, 8
    s_add_u32 s44, s38, s39
    s_mul_i32 s45, s44, 7168
    s_lshl_b32 s39, s22, 7
    s_add_u32 s45, s45, s39
    s_lshl_b32 s92, s18, 14
    s_add_u32 s92, s92, 98304
    s_mov_b32 s52, s46
    s_mov_b32 s53, s47
    s_mov_b32 s54, 7340032
    s_mov_b32 s55, 0x20000
    s_mov_b32 s28, s48
    s_mov_b32 s29, s49
    s_mov_b32 s30, 7340032
    s_mov_b32 s31, 0x20000
    s_mov_b32 s46, s92
    s_cmp_ge_u32 s2, 224
    s_cselect_b32 s54, 0, s54
    s_cselect_b32 s30, 0, s30
    s_and_b32 s39, s3, 1
    s_lshl_b32 s36, s39, 9
    s_lshr_b32 s39, s3, 1
    s_lshl_b32 s39, s39, 7
    s_add_u32 s36, s36, s39
    s_lshr_b32 s39, s2, 3
    s_lshl_b32 s39, s39, 2
    s_add_u32 s36, s36, s39
    s_add_u32 s36, s36, s18
    s_lshl_b32 s36, s36, 11
    s_add_u32 s84, s72, s36
    s_addc_u32 s85, s73, 0
    s_add_u32 s86, s74, s36
    s_addc_u32 s87, s75, 0
    s_lshr_b32 s37, s2, 3
    s_mul_i32 s37, s37, 12
    s_lshr_b32 s37, s37, 5
    s_mul_i32 s37, s37, 1
    s_add_u32 s37, s37, 0
    v_lshlrev_b32 v5, 11, v5
    v_lshl_add_u32 v5, v8, 4, v5
    s_lshl_b32 s47, s22, 17
    s_lshl_b32 s39, s23, 9
    s_add_u32 s47, s47, s39
    s_lshl_b32 s39, s18, 7
    s_add_u32 s47, s47, s39
    s_mov_b32 s4, s50
    s_mov_b32 s5, s51
    s_mov_b32 s6, 7340032
    s_mov_b32 s7, 0x20000
    s_cmp_ge_u32 s2, 224
    s_cselect_b32 s6, 0, s6
    v_lshrrev_b32 v10, 4, v2
    v_mov_b32 v23, 1
    s_mov_b32 s98, 0
    s_mov_b32 s99, 0
    s_cmp_lg_u32 s37, 0
    s_cbranch_scc1 L_s_nb0
    s_add_u32 m0, s46, 0
    s_add_u32 s39, s45, 0
    buffer_load_dwordx4 v4, s[52:55], s39 offen nt lds
    s_add_u32 m0, s46, 1024
    s_add_u32 s39, s45, 57344
    buffer_load_dwordx4 v4, s[52:55], s39 offen nt lds
    s_add_u32 m0, s46, 2048
    s_add_u32 s39, s45, 114688
    buffer_load_dwordx4 v4, s[52:55], s39 offen nt lds
    s_add_u32 m0, s46, 3072
    s_add_u32 s39, s45, 172032
    buffer_load_dwordx4 v4, s[52:55], s39 offen nt lds
    s_add_u32 m0, s46, 4096
    s_add_u32 s39, s45, 229376
    buffer_load_dwordx4 v4, s[52:55], s39 offen nt lds
    s_add_u32 m0, s46, 5120
    s_add_u32 s39, s45, 286720
    buffer_load_dwordx4 v4, s[52:55], s39 offen nt lds
    s_add_u32 m0, s46, 6144
    s_add_u32 s39, s45, 344064
    buffer_load_dwordx4 v4, s[52:55], s39 offen nt lds
    s_add_u32 m0, s46, 7168
    s_add_u32 s39, s45, 401408
    buffer_load_dwordx4 v4, s[52:55], s39 offen nt lds
    s_add_u32 m0, s46, 8192
    s_add_u32 s39, s45, 0
    buffer_load_dwordx4 v4, s[28:31], s39 offen nt lds
    s_add_u32 m0, s46, 9216
    s_add_u32 s39, s45, 57344
    buffer_load_dwordx4 v4, s[28:31], s39 offen nt lds
    s_add_u32 m0, s46, 10240
    s_add_u32 s39, s45, 114688
    buffer_load_dwordx4 v4, s[28:31], s39 offen nt lds
    s_add_u32 m0, s46, 11264
    s_add_u32 s39, s45, 172032
    buffer_load_dwordx4 v4, s[28:31], s39 offen nt lds
    s_add_u32 m0, s46, 12288
    s_add_u32 s39, s45, 229376
    buffer_load_dwordx4 v4, s[28:31], s39 offen nt lds
    s_add_u32 m0, s46, 13312
    s_add_u32 s39, s45, 286720
    buffer_load_dwordx4 v4, s[28:31], s39 offen nt lds
    s_add_u32 m0, s46, 14336
    s_add_u32 s39, s45, 344064
    buffer_load_dwordx4 v4, s[28:31], s39 offen nt lds
    s_add_u32 m0, s46, 15360
    s_add_u32 s39, s45, 401408
    buffer_load_dwordx4 v4, s[28:31], s39 offen nt lds
    s_mov_b32 s37, 13
    s_mov_b32 s99, 1
    s_mov_b32 s98, 1
    s_waitcnt vmcnt(24) lgkmcnt(0)
    s_branch L_s_b0
L_s_nb0:
    s_waitcnt vmcnt(8) lgkmcnt(0)
L_s_b0:
    s_barrier
    s_add_u32 m0, s58, 65536
    s_add_u32 s57, s56, 256
    s_and_b32 s57, s57, 2047
    buffer_load_dwordx4 v100, s[8:11], s57 offen offset:0  lds
    buffer_load_dwordx4 v101, s[8:11], s57 offen offset:1024  lds
    buffer_load_dwordx4 v102, s[8:11], s57 offen offset:2048  lds
    buffer_load_dwordx4 v103, s[8:11], s57 offen offset:3072  lds
    s_add_u32 m0, s58, 81920
    s_nop 0
    buffer_load_dwordx4 v104, s[24:27], s57 offen offset:0  lds
    buffer_load_dwordx4 v105, s[24:27], s57 offen offset:1024  lds
    buffer_load_dwordx4 v106, s[24:27], s57 offen offset:2048  lds
    buffer_load_dwordx4 v107, s[24:27], s57 offen offset:3072  lds
    s_mul_i32 s93, s93, 1664525
    s_add_u32 s93, s93, 1013904223
    s_lshl_b32 s94, s18, 12
    s_add_u32 s94, s94, 9437184
    s_mov_b32 s20, 1
    s_mov_b32 s19, s58
    s_add_u32 s92, s58, 98304
    s_add_u32 s95, s57, 128
    s_and_b32 s95, s95, 2047
    s_add_u32 s97, s37, 1
    s_min_u32 s97, s97, 14
L_s_loop:
    s_mov_b32 m0, s19
    s_mov_b32 s57, s95
    s_waitcnt vmcnt(24)
    s_sub_u32 s98, s98, 1
    s_cbranch_scc0 L_s_lw
    s_mov_b32 s98, 0
    s_waitcnt vmcnt(8)
L_s_lw:
    s_barrier
    buffer_load_dwordx4 v100, s[8:11], s57 offen offset:0 lds
    s_load_dword s36, s[84:85], 0
    s_load_dword s36, s[84:85], 64
    buffer_load_dwordx4 v101, s[8:11], s57 offen offset:1024 lds
    s_load_dword s36, s[86:87], 0
    s_load_dword s36, s[86:87], 64
    buffer_load_dwordx4 v102, s[8:11], s57 offen offset:2048 lds
    s_add_u32 s84, s84, 128
    s_addc_u32 s85, s85, 0
    s_add_u32 s86, s86, 128
    s_addc_u32 s87, s87, 0
    buffer_load_dwordx4 v103, s[8:11], s57 offen offset:3072 lds
    s_add_u32 s95, s57, 128
    s_and_b32 s95, s95, 2047
    s_add_u32 m0, m0, 16384
    s_nop 0
    buffer_load_dwordx4 v104, s[24:27], s57 offen offset:0 lds
    s_add_u32 s19, s19, 32768
    s_cmp_eq_u32 s19, s92
    s_cselect_b32 s19, s58, s19
    buffer_load_dwordx4 v105, s[24:27], s57 offen offset:1024 lds
    s_add_u32 s20, s20, 1
    buffer_load_dwordx4 v106, s[24:27], s57 offen offset:2048 lds
    s_cmp_lg_u32 s20, s97
    buffer_load_dwordx4 v107, s[24:27], s57 offen offset:3072 lds
    s_cbranch_scc1 L_s_loop
    s_cmp_eq_u32 s20, 14
    s_cbranch_scc1 L_s_loopend
    s_add_u32 m0, s46, 0
    s_add_u32 s39, s45, 0
    buffer_load_dwordx4 v4, s[52:55], s39 offen nt lds
    s_add_u32 m0, s46, 1024
    s_add_u32 s39, s45, 57344
    buffer_load_dwordx4 v4, s[52:55], s39 offen nt lds
    s_add_u32 m0, s46, 2048
    s_add_u32 s39, s45, 114688
    buffer_load_dwordx4 v4, s[52:55], s39 offen nt lds
    s_add_u32 m0, s46, 3072
    s_add_u32 s39, s45, 172032
    buffer_load_dwordx4 v4, s[52:55], s39 offen nt lds
    s_add_u32 m0, s46, 4096
    s_add_u32 s39, s45, 229376
    buffer_load_dwordx4 v4, s[52:55], s39 offen nt lds
    s_add_u32 m0, s46, 5120
    s_add_u32 s39, s45, 286720
    buffer_load_dwordx4 v4, s[52:55], s39 offen nt lds
    s_add_u32 m0, s46, 6144
    s_add_u32 s39, s45, 344064
    buffer_load_dwordx4 v4, s[52:55], s39 offen nt lds
    s_add_u32 m0, s46, 7168
    s_add_u32 s39, s45, 401408
    buffer_load_dwordx4 v4, s[52:55], s39 offen nt lds
    s_add_u32 m0, s46, 8192
    s_add_u32 s39, s45, 0
    buffer_load_dwordx4 v4, s[28:31], s39 offen nt lds
    s_add_u32 m0, s46, 9216
    s_add_u32 s39, s45, 57344
    buffer_load_dwordx4 v4, s[28:31], s39 offen nt lds
    s_add_u32 m0, s46, 10240
    s_add_u32 s39, s45, 114688
    buffer_load_dwordx4 v4, s[28:31], s39 offen nt lds
    s_add_u32 m0, s46, 11264
    s_add_u32 s39, s45, 172032
    buffer_load_dwordx4 v4, s[28:31], s39 offen nt lds
    s_add_u32 m0, s46, 12288
    s_add_u32 s39, s45, 229376
    buffer_load_dwordx4 v4, s[28:31], s39 offen nt lds
    s_add_u32 m0, s46, 13312
    s_add_u32 s39, s45, 286720
    buffer_load_dwordx4 v4, s[28:31], s39 offen nt lds
    s_add_u32 m0, s46, 14336
    s_add_u32 s39, s45, 344064
    buffer_load_dwordx4 v4, s[28:31], s39 offen nt lds
    s_add_u32 m0, s46, 15360
    s_add_u32 s39, s45, 401408
    buffer_load_dwordx4 v4, s[28:31], s39 offen nt lds
    v_lshlrev_b32 v9, 5, v2
    s_mov_b32 s98, 2
    s_mov_b32 s97, 14
    s_branch L_s_loop
L_s_loopend:
    buffer_load_dwordx4 v[80:83], v3, s[12:15], s94 offen offset:0 sc1
    buffer_load_dwordx4 v[84:87], v3, s[12:15], s94 offen offset:1024 sc1
    buffer_load_dwordx4 v[88:91], v3, s[12:15], s94 offen offset:2048 sc1
    buffer_load_dwordx4 v[92:95], v3, s[12:15], s94 offen offset:3072 sc1
    s_load_dword s36, s[84:85], 0
    s_load_dword s36, s[84:85], 64
    s_load_dword s36, s[86:87], 0
    s_load_dword s36, s[86:87], 64
    s_add_u32 s84, s84, 128
    s_addc_u32 s85, s85, 0
    s_add_u32 s86, s86, 128
    s_addc_u32 s87, s87, 0
    s_waitcnt vmcnt(12)
    s_barrier
    buffer_load_dwordx4 v[200:203], v5, s[4:7], s47 offen nt
    s_add_u32 s47, s47, 16384
    buffer_load_dwordx4 v[204:207], v5, s[4:7], s47 offen nt
    s_add_u32 s47, s47, 16384
    buffer_load_dwordx4 v[208:211], v5, s[4:7], s47 offen nt
    s_add_u32 s47, s47, 16384
    buffer_load_dwordx4 v[212:215], v5, s[4:7], s47 offen nt
    s_add_u32 s47, s47, 16384
    buffer_load_dwordx4 v[216:219], v5, s[4:7], s47 offen nt
    s_add_u32 s47, s47, 16384
    buffer_load_dwordx4 v[220:223], v5, s[4:7], s47 offen nt
    s_add_u32 s47, s47, 16384
    buffer_load_dwordx4 v[224:227], v5, s[4:7], s47 offen nt
    s_add_u32 s47, s47, 16384
    buffer_load_dwordx4 v[228:231], v5, s[4:7], s47 offen nt
    s_add_u32 s47, s47, 16384
    v_bfe_u32 v12, v2, 2, 2
    v_lshl_add_u32 v13, v10, 3, v12
    v_lshlrev_b32 v13, 7, v13
    v_and_b32 v14, 3, v2
    v_lshl_add_u32 v13, v14, 3, v13
    v_add_u32 v13, s46, v13
    v_xor_b32 v14, 0, v12
    v_lshl_add_u32 v16, v14, 5, v13
    v_xor_b32 v14, 1, v12
    v_lshl_add_u32 v17, v14, 5, v13
    v_xor_b32 v14, 2, v12
    v_lshl_add_u32 v18, v14, 5, v13
    v_xor_b32 v14, 3, v12
    v_lshl_add_u32 v19, v14, 5, v13
    s_mov_b32 s8, s40
    s_mov_b32 s9, s41
    s_mov_b32 s10, 4194304
    s_mov_b32 s11, 0x20000
    v_mov_b32 v22, 73728
    s_waitcnt vmcnt(12)
    s_barrier
    s_load_dword s36, s[84:85], 0
    s_load_dword s36, s[84:85], 64
    s_load_dword s36, s[86:87], 0
    s_load_dword s36, s[86:87], 64
    s_add_u32 s84, s84, 128
    s_addc_u32 s85, s85, 0
    s_add_u32 s86, s86, 128
    s_addc_u32 s87, s87, 0
    s_load_dword s36, s[84:85], 0
    s_load_dword s36, s[84:85], 64
    s_load_dword s36, s[86:87], 0
    s_load_dword s36, s[86:87], 64
    s_add_u32 s84, s84, 128
    s_addc_u32 s85, s85, 0
    s_add_u32 s86, s86, 128
    s_addc_u32 s87, s87, 0
    s_barrier
    v_mov_b32 v8, 0
    s_mov_b32 s95, -1
    s_waitcnt vmcnt(8)
L_s_poll:
    v_xor_b32 v81, s93, v81
    v_xor_b32 v83, s93, v83
    v_xor_b32 v85, s93, v85
    v_xor_b32 v87, s93, v87
    v_xor_b32 v89, s93, v89
    v_xor_b32 v91, s93, v91
    v_xor_b32 v93, s93, v93
    v_xor_b32 v95, s93, v95
    v_or3_b32 v9, v81, v83, v85
    v_or3_b32 v9, v9, v87, v89
    v_or3_b32 v9, v9, v91, v93
    v_or_b32 v9, v9, v95
    v_cmp_ne_u32 vcc, 0, v9
    s_nop 1
    s_cmp_eq_u64 vcc, 0
    s_cbranch_scc1 L_s_go
    s_sub_u32 s96, s96, 1
    s_cbranch_scc1 L_s_go
    buffer_load_dwordx4 v[80:83], v3, s[12:15], s94 offen offset:0 sc1
    buffer_load_dwordx4 v[84:87], v3, s[12:15], s94 offen offset:1024 sc1
    buffer_load_dwordx4 v[88:91], v3, s[12:15], s94 offen offset:2048 sc1
    buffer_load_dwordx4 v[92:95], v3, s[12:15], s94 offen offset:3072 sc1
    s_waitcnt vmcnt(0)
    s_branch L_s_poll
L_s_go:
    v_sub_u32 v72, s95, v80
    v_sub_u32 v73, s95, v82
    v_sub_u32 v74, s95, v84
    v_sub_u32 v75, s95, v86
    v_sub_u32 v76, s95, v88
    v_sub_u32 v77, s95, v90
    v_sub_u32 v78, s95, v92
    v_sub_u32 v79, s95, v94
    v_min3_u32 v9, v72, v73, v74
    v_min3_u32 v15, v75, v76, v77
    v_min3_u32 v9, v9, v78, v79
    v_min_u32 v9, v9, v15
    s_nop 1
    v_min_u32_dpp v9, v9, v9 row_ror:8 row_mask:0xf bank_mask:0xf
    s_nop 1
    v_min_u32_dpp v9, v9, v9 row_ror:4 row_mask:0xf bank_mask:0xf
    s_nop 1
    v_min_u32_dpp v9, v9, v9 row_ror:2 row_mask:0xf bank_mask:0xf
    s_nop 1
    v_min_u32_dpp v9, v9, v9 row_ror:1 row_mask:0xf bank_mask:0xf
    s_nop 0
    v_readlane_b32 s48, v9, 0
    v_readlane_b32 s49, v9, 16
    v_readlane_b32 s50, v9, 32
    v_readlane_b32 s51, v9, 48
    s_nop 0
    s_min_u32 s48, s48, s49
    s_min_u32 s50, s50, s51
    s_min_u32 s48, s48, s50
    s_sub_u32 s95, s95, s48
    v_writelane_b32 v8, s95, 0
    s_sub_u32 s95, s95, 1
    v_sub_u32 v72, s95, v80
    v_sub_u32 v73, s95, v82
    v_sub_u32 v74, s95, v84
    v_sub_u32 v75, s95, v86
    v_sub_u32 v76, s95, v88
    v_sub_u32 v77, s95, v90
    v_sub_u32 v78, s95, v92
    v_sub_u32 v79, s95, v94
    v_min3_u32 v9, v72, v73, v74
    v_min3_u32 v15, v75, v76, v77
    v_min3_u32 v9, v9, v78, v79
    v_min_u32 v9, v9, v15
    s_nop 1
    v_min_u32_dpp v9, v9, v9 row_ror:8 row_mask:0xf bank_mask:0xf
    s_nop 1
    v_min_u32_dpp v9, v9, v9 row_ror:4 row_mask:0xf bank_mask:0xf
    s_nop 1
    v_min_u32_dpp v9, v9, v9 row_ror:2 row_mask:0xf bank_mask:0xf
    s_nop 1
    v_min_u32_dpp v9, v9, v9 row_ror:1 row_mask:0xf bank_mask:0xf
    s_nop 0
    v_readlane_b32 s48, v9, 0
    v_readlane_b32 s49, v9, 16
    v_readlane_b32 s50, v9, 32
    v_readlane_b32 s51, v9, 48
    s_nop 0
    s_min_u32 s48, s48, s49
    s_min_u32 s50, s50, s51
    s_min_u32 s48, s48, s50
    s_sub_u32 s95, s95, s48
    v_writelane_b32 v8, s95, 1
    s_sub_u32 s95, s95, 1
    v_sub_u32 v72, s95, v80
    v_sub_u32 v73, s95, v82
    v_sub_u32 v74, s95, v84
    v_sub_u32 v75, s95, v86
    v_sub_u32 v76, s95, v88
    v_sub_u32 v77, s95, v90
    v_sub_u32 v78, s95, v92
    v_sub_u32 v79, s95, v94
    v_min3_u32 v9, v72, v73, v74
    v_min3_u32 v15, v75, v76, v77
    v_min3_u32 v9, v9, v78, v79
    v_min_u32 v9, v9, v15
    s_nop 1
    v_min_u32_dpp v9, v9, v9 row_ror:8 row_mask:0xf bank_mask:0xf
    s_nop 1
    v_min_u32_dpp v9, v9, v9 row_ror:4 row_mask:0xf bank_mask:0xf
    s_nop 1
    v_min_u32_dpp v9, v9, v9 row_ror:2 row_mask:0xf bank_mask:0xf
    s_nop 1
    v_min_u32_dpp v9, v9, v9 row_ror:1 row_mask:0xf bank_mask:0xf
    s_nop 0
    v_readlane_b32 s48, v9, 0
    v_readlane_b32 s49, v9, 16
    v_readlane_b32 s50, v9, 32
    v_readlane_b32 s51, v9, 48
    s_nop 0
    s_min_u32 s48, s48, s49
    s_min_u32 s50, s50, s51
    s_min_u32 s48, s48, s50
    s_sub_u32 s95, s95, s48
    v_writelane_b32 v8, s95, 2
    s_sub_u32 s95, s95, 1
    v_sub_u32 v72, s95, v80
    v_sub_u32 v73, s95, v82
    v_sub_u32 v74, s95, v84
    v_sub_u32 v75, s95, v86
    v_sub_u32 v76, s95, v88
    v_sub_u32 v77, s95, v90
    v_sub_u32 v78, s95, v92
    v_sub_u32 v79, s95, v94
    v_min3_u32 v9, v72, v73, v74
    v_min3_u32 v15, v75, v76, v77
    v_min3_u32 v9, v9, v78, v79
    v_min_u32 v9, v9, v15
    s_nop 1
    v_min_u32_dpp v9, v9, v9 row_ror:8 row_mask:0xf bank_mask:0xf
    s_nop 1
    v_min_u32_dpp v9, v9, v9 row_ror:4 row_mask:0xf bank_mask:0xf
    s_nop 1
    v_min_u32_dpp v9, v9, v9 row_ror:2 row_mask:0xf bank_mask:0xf
    s_nop 1
    v_min_u32_dpp v9, v9, v9 row_ror:1 row_mask:0xf bank_mask:0xf
    s_nop 0
    v_readlane_b32 s48, v9, 0
    v_readlane_b32 s49, v9, 16
    v_readlane_b32 s50, v9, 32
    v_readlane_b32 s51, v9, 48
    s_nop 0
    s_min_u32 s48, s48, s49
    s_min_u32 s50, s50, s51
    s_min_u32 s48, s48, s50
    s_sub_u32 s95, s95, s48
    v_writelane_b32 v8, s95, 3
    s_sub_u32 s95, s95, 1
    v_sub_u32 v72, s95, v80
    v_sub_u32 v73, s95, v82
    v_sub_u32 v74, s95, v84
    v_sub_u32 v75, s95, v86
    v_sub_u32 v76, s95, v88
    v_sub_u32 v77, s95, v90
    v_sub_u32 v78, s95, v92
    v_sub_u32 v79, s95, v94
    v_min3_u32 v9, v72, v73, v74
    v_min3_u32 v15, v75, v76, v77
    v_min3_u32 v9, v9, v78, v79
    v_min_u32 v9, v9, v15
    s_nop 1
    v_min_u32_dpp v9, v9, v9 row_ror:8 row_mask:0xf bank_mask:0xf
    s_nop 1
    v_min_u32_dpp v9, v9, v9 row_ror:4 row_mask:0xf bank_mask:0xf
    s_nop 1
    v_min_u32_dpp v9, v9, v9 row_ror:2 row_mask:0xf bank_mask:0xf
    s_nop 1
    v_min_u32_dpp v9, v9, v9 row_ror:1 row_mask:0xf bank_mask:0xf
    s_nop 0
    v_readlane_b32 s48, v9, 0
    v_readlane_b32 s49, v9, 16
    v_readlane_b32 s50, v9, 32
    v_readlane_b32 s51, v9, 48
    s_nop 0
    s_min_u32 s48, s48, s49
    s_min_u32 s50, s50, s51
    s_min_u32 s48, s48, s50
    s_sub_u32 s95, s95, s48
    v_writelane_b32 v8, s95, 4
    s_sub_u32 s95, s95, 1
    v_sub_u32 v72, s95, v80
    v_sub_u32 v73, s95, v82
    v_sub_u32 v74, s95, v84
    v_sub_u32 v75, s95, v86
    v_sub_u32 v76, s95, v88
    v_sub_u32 v77, s95, v90
    v_sub_u32 v78, s95, v92
    v_sub_u32 v79, s95, v94
    v_min3_u32 v9, v72, v73, v74
    v_min3_u32 v15, v75, v76, v77
    v_min3_u32 v9, v9, v78, v79
    v_min_u32 v9, v9, v15
    s_nop 1
    v_min_u32_dpp v9, v9, v9 row_ror:8 row_mask:0xf bank_mask:0xf
    s_nop 1
    v_min_u32_dpp v9, v9, v9 row_ror:4 row_mask:0xf bank_mask:0xf
    s_nop 1
    v_min_u32_dpp v9, v9, v9 row_ror:2 row_mask:0xf bank_mask:0xf
    s_nop 1
    v_min_u32_dpp v9, v9, v9 row_ror:1 row_mask:0xf bank_mask:0xf
    s_nop 0
    v_readlane_b32 s48, v9, 0
    v_readlane_b32 s49, v9, 16
    v_readlane_b32 s50, v9, 32
    v_readlane_b32 s51, v9, 48
    s_nop 0
    s_min_u32 s48, s48, s49
    s_min_u32 s50, s50, s51
    s_min_u32 s48, s48, s50
    s_sub_u32 s95, s95, s48
    v_writelane_b32 v8, s95, 5
    s_sub_u32 s95, s95, 1
    v_sub_u32 v72, s95, v80
    v_sub_u32 v73, s95, v82
    v_sub_u32 v74, s95, v84
    v_sub_u32 v75, s95, v86
    v_sub_u32 v76, s95, v88
    v_sub_u32 v77, s95, v90
    v_sub_u32 v78, s95, v92
    v_sub_u32 v79, s95, v94
    v_min3_u32 v9, v72, v73, v74
    v_min3_u32 v15, v75, v76, v77
    v_min3_u32 v9, v9, v78, v79
    v_min_u32 v9, v9, v15
    s_nop 1
    v_min_u32_dpp v9, v9, v9 row_ror:8 row_mask:0xf bank_mask:0xf
    s_nop 1
    v_min_u32_dpp v9, v9, v9 row_ror:4 row_mask:0xf bank_mask:0xf
    s_nop 1
    v_min_u32_dpp v9, v9, v9 row_ror:2 row_mask:0xf bank_mask:0xf
    s_nop 1
    v_min_u32_dpp v9, v9, v9 row_ror:1 row_mask:0xf bank_mask:0xf
    s_nop 0
    v_readlane_b32 s48, v9, 0
    v_readlane_b32 s49, v9, 16
    v_readlane_b32 s50, v9, 32
    v_readlane_b32 s51, v9, 48
    s_nop 0
    s_min_u32 s48, s48, s49
    s_min_u32 s50, s50, s51
    s_min_u32 s48, s48, s50
    s_sub_u32 s95, s95, s48
    v_writelane_b32 v8, s95, 6
    s_sub_u32 s95, s95, 1
    v_sub_u32 v72, s95, v80
    v_sub_u32 v73, s95, v82
    v_sub_u32 v74, s95, v84
    v_sub_u32 v75, s95, v86
    v_sub_u32 v76, s95, v88
    v_sub_u32 v77, s95, v90
    v_sub_u32 v78, s95, v92
    v_sub_u32 v79, s95, v94
    v_min3_u32 v9, v72, v73, v74
    v_min3_u32 v15, v75, v76, v77
    v_min3_u32 v9, v9, v78, v79
    v_min_u32 v9, v9, v15
    s_nop 1
    v_min_u32_dpp v9, v9, v9 row_ror:8 row_mask:0xf bank_mask:0xf
    s_nop 1
    v_min_u32_dpp v9, v9, v9 row_ror:4 row_mask:0xf bank_mask:0xf
    s_nop 1
    v_min_u32_dpp v9, v9, v9 row_ror:2 row_mask:0xf bank_mask:0xf
    s_nop 1
    v_min_u32_dpp v9, v9, v9 row_ror:1 row_mask:0xf bank_mask:0xf
    s_nop 0
    v_readlane_b32 s48, v9, 0
    v_readlane_b32 s49, v9, 16
    v_readlane_b32 s50, v9, 32
    v_readlane_b32 s51, v9, 48
    s_nop 0
    s_min_u32 s48, s48, s49
    s_min_u32 s50, s50, s51
    s_min_u32 s48, s48, s50
    s_sub_u32 s95, s95, s48
    v_writelane_b32 v8, s95, 7
    s_sub_u32 s95, s95, 1
    s_lshl_b32 s38, s18, 5
    s_add_u32 s38, s38, 73856
    v_lshl_add_u32 v9, v2, 2, s38
    v_mov_b32 v15, 73856
    s_mov_b64 exec, 0xff
    ds_write_b32 v9, v8
    s_mov_b64 exec, 1
    ds_add_u32 v22, v23 offset:8
    s_mov_b64 exec, -1
L_s_cw:
    ds_read_b32 v14, v22 offset:8
    s_waitcnt lgkmcnt(0)
    v_readfirstlane_b32 s38, v14
    s_nop 1
    s_cmp_ge_u32 s38, 4
    s_cbranch_scc1 L_s_cw_ok
    s_sub_u32 s96, s96, 1
    s_cbranch_scc1 L_s_cw_ok
    s_sleep 0
    s_branch L_s_cw
L_s_cw_ok:
    v_and_b32 v9, 31, v2
    v_lshl_add_u32 v9, v9, 2, v15
    ds_read_b32 v14, v9
    ds_read_b128 v[64:67], v15 offset:0
    ds_read_b128 v[68:71], v15 offset:16
    ds_read_b128 v[72:75], v15 offset:32
    ds_read_b128 v[76:79], v15 offset:48
    ds_read_b128 v[80:83], v15 offset:64
    ds_read_b128 v[84:87], v15 offset:80
    ds_read_b128 v[88:91], v15 offset:96
    ds_read_b128 v[92:95], v15 offset:112
    v_mov_b32 v12, 0
    s_waitcnt lgkmcnt(0)
    v_cmp_gt_u32 s[48:49], v64, v14
    v_cmp_gt_u32 s[50:51], v65, v14
    s_nop 0
    v_addc_co_u32 v12, vcc, 0, v12, s[48:49]
    v_addc_co_u32 v12, vcc, 0, v12, s[50:51]
    v_cmp_gt_u32 s[48:49], v66, v14
    v_cmp_gt_u32 s[50:51], v67, v14
    s_nop 0
    v_addc_co_u32 v12, vcc, 0, v12, s[48:49]
    v_addc_co_u32 v12, vcc, 0, v12, s[50:51]
    v_cmp_gt_u32 s[48:49], v68, v14
    v_cmp_gt_u32 s[50:51], v69, v14
    s_nop 0
    v_addc_co_u32 v12, vcc, 0, v12, s[48:49]
    v_addc_co_u32 v12, vcc, 0, v12, s[50:51]
    v_cmp_gt_u32 s[48:49], v70, v14
    v_cmp_gt_u32 s[50:51], v71, v14
    s_nop 0
    v_addc_co_u32 v12, vcc, 0, v12, s[48:49]
    v_addc_co_u32 v12, vcc, 0, v12, s[50:51]
    v_cmp_gt_u32 s[48:49], v72, v14
    v_cmp_gt_u32 s[50:51], v73, v14
    s_nop 0
    v_addc_co_u32 v12, vcc, 0, v12, s[48:49]
    v_addc_co_u32 v12, vcc, 0, v12, s[50:51]
    v_cmp_gt_u32 s[48:49], v74, v14
    v_cmp_gt_u32 s[50:51], v75, v14
    s_nop 0
    v_addc_co_u32 v12, vcc, 0, v12, s[48:49]
    v_addc_co_u32 v12, vcc, 0, v12, s[50:51]
    v_cmp_gt_u32 s[48:49], v76, v14
    v_cmp_gt_u32 s[50:51], v77, v14
    s_nop 0
    v_addc_co_u32 v12, vcc, 0, v12, s[48:49]
    v_addc_co_u32 v12, vcc, 0, v12, s[50:51]
    v_cmp_gt_u32 s[48:49], v78, v14
    v_cmp_gt_u32 s[50:51], v79, v14
    s_nop 0
    v_addc_co_u32 v12, vcc, 0, v12, s[48:49]
    v_addc_co_u32 v12, vcc, 0, v12, s[50:51]
    v_cmp_gt_u32 s[48:49], v80, v14
    v_cmp_gt_u32 s[50:51], v81, v14
    s_nop 0
    v_addc_co_u32 v12, vcc, 0, v12, s[48:49]
    v_addc_co_u32 v12, vcc, 0, v12, s[50:51]
    v_cmp_gt_u32 s[48:49], v82, v14
    v_cmp_gt_u32 s[50:51], v83, v14
    s_nop 0
    v_addc_co_u32 v12, vcc, 0, v12, s[48:49]
    v_addc_co_u32 v12, vcc, 0, v12, s[50:51]
    v_cmp_gt_u32 s[48:49], v84, v14
    v_cmp_gt_u32 s[50:51], v85, v14
    s_nop 0
    v_addc_co_u32 v12, vcc, 0, v12, s[48:49]
    v_addc_co_u32 v12, vcc, 0, v12, s[50:51]
    v_cmp_gt_u32 s[48:49], v86, v14
    v_cmp_gt_u32 s[50:51], v87, v14
    s_nop 0
    v_addc_co_u32 v12, vcc, 0, v12, s[48:49]
    v_addc_co_u32 v12, vcc, 0, v12, s[50:51]
    v_cmp_gt_u32 s[48:49], v88, v14
    v_cmp_gt_u32 s[50:51], v89, v14
    s_nop 0
    v_addc_co_u32 v12, vcc, 0, v12, s[48:49]
    v_addc_co_u32 v12, vcc, 0, v12, s[50:51]
    v_cmp_gt_u32 s[48:49], v90, v14
    v_cmp_gt_u32 s[50:51], v91, v14
    s_nop 0
    v_addc_co_u32 v12, vcc, 0, v12, s[48:49]
    v_addc_co_u32 v12, vcc, 0, v12, s[50:51]
    v_cmp_gt_u32 s[48:49], v92, v14
    v_cmp_gt_u32 s[50:51], v93, v14
    s_nop 0
    v_addc_co_u32 v12, vcc, 0, v12, s[48:49]
    v_addc_co_u32 v12, vcc, 0, v12, s[50:51]
    v_cmp_gt_u32 s[48:49], v94, v14
    v_cmp_gt_u32 s[50:51], v95, v14
    s_nop 0
    v_addc_co_u32 v12, vcc, 0, v12, s[48:49]
    v_addc_co_u32 v12, vcc, 0, v12, s[50:51]
    v_lshlrev_b32 v12, 2, v12
    s_mov_b32 exec_hi, 0
    ds_permute_b32 v13, v12, v14
    s_mov_b64 exec, -1
    v_and_b32 v12, 7, v2
    v_lshlrev_b32 v12, 2, v12
    s_waitcnt lgkmcnt(0)
    ds_bpermute_b32 v8, v12, v13
    s_lshl_b32 s38, s44, 1
    s_and_b32 s38, s38, 2047
    s_waitcnt lgkmcnt(0)
    v_not_b32 v9, v8
    v_and_b32 v9, 0x7ff, v9
    v_lshlrev_b32 v9, 11, v9
    v_lshl_add_u32 v9, v10, 4, v9
    buffer_load_dwordx4 v[56:59], v9, s[8:11], s38 offen offset:0
    buffer_load_dwordx4 v[60:63], v9, s[8:11], s38 offen offset:64
    v_lshlrev_b32 v9, 2, v2
    v_add_u32 v9, 73984, v9
    s_mov_b64 exec, 0xff
    ds_write_b32 v9, v8
    s_mov_b64 exec, 1
    ds_add_u32 v22, v23 offset:32
    s_mov_b64 exec, -1
    s_or_b32 s38, s2, s18
    s_cbranch_scc1 L_s_noep
    s_mov_b64 exec, 1
    s_mov_b32 s38, 9469952
    v_mov_b32 v13, s93
    v_mov_b32 v9, 0
    buffer_store_dword v13, v9, s[12:15], s38 offen
    s_mov_b64 exec, -1
L_s_noep:
    s_cmp_ge_u32 s2, 224
    s_cbranch_scc1 L_s_cons
    s_waitcnt vmcnt(0)
    s_setprio 2
    ds_read_b64_tr_b16 v[100:101], v16 offset:0
    ds_read_b64_tr_b16 v[102:103], v16 offset:512
    ds_read_b64_tr_b16 v[104:105], v16 offset:4096
    ds_read_b64_tr_b16 v[106:107], v16 offset:4608
    ds_read_b64_tr_b16 v[108:109], v17 offset:0
    ds_read_b64_tr_b16 v[110:111], v17 offset:512
    ds_read_b64_tr_b16 v[112:113], v17 offset:4096
    ds_read_b64_tr_b16 v[114:115], v17 offset:4608
    ds_read_b64_tr_b16 v[116:117], v18 offset:0
    ds_read_b64_tr_b16 v[118:119], v18 offset:512
    ds_read_b64_tr_b16 v[120:121], v18 offset:4096
    ds_read_b64_tr_b16 v[122:123], v18 offset:4608
    ds_read_b64_tr_b16 v[124:125], v19 offset:0
    ds_read_b64_tr_b16 v[126:127], v19 offset:512
    ds_read_b64_tr_b16 v[128:129], v19 offset:4096
    ds_read_b64_tr_b16 v[130:131], v19 offset:4608
    s_waitcnt lgkmcnt(0)
    ds_read_b64_tr_b16 v[132:133], v16 offset:8192
    ds_read_b64_tr_b16 v[134:135], v16 offset:8704
    ds_read_b64_tr_b16 v[136:137], v16 offset:12288
    ds_read_b64_tr_b16 v[138:139], v16 offset:12800
    ds_read_b64_tr_b16 v[140:141], v17 offset:8192
    ds_read_b64_tr_b16 v[142:143], v17 offset:8704
    ds_read_b64_tr_b16 v[144:145], v17 offset:12288
    ds_read_b64_tr_b16 v[146:147], v17 offset:12800
    ds_read_b64_tr_b16 v[148:149], v18 offset:8192
    ds_read_b64_tr_b16 v[150:151], v18 offset:8704
    ds_read_b64_tr_b16 v[152:153], v18 offset:12288
    ds_read_b64_tr_b16 v[154:155], v18 offset:12800
    ds_read_b64_tr_b16 v[156:157], v19 offset:8192
    ds_read_b64_tr_b16 v[158:159], v19 offset:8704
    ds_read_b64_tr_b16 v[160:161], v19 offset:12288
    ds_read_b64_tr_b16 v[162:163], v19 offset:12800
    s_waitcnt lgkmcnt(0)
    v_mfma_f32_16x16x32_bf16 v[24:27], v[100:103], v[56:59], 0
    v_mfma_f32_16x16x32_bf16 v[28:31], v[108:111], v[56:59], 0
    v_mfma_f32_16x16x32_bf16 v[32:35], v[116:119], v[56:59], 0
    v_mfma_f32_16x16x32_bf16 v[36:39], v[124:127], v[56:59], 0
    v_mfma_f32_16x16x32_bf16 v[40:43], v[132:135], v[56:59], 0
    v_mfma_f32_16x16x32_bf16 v[44:47], v[140:143], v[56:59], 0
    v_mfma_f32_16x16x32_bf16 v[48:51], v[148:151], v[56:59], 0
    v_mfma_f32_16x16x32_bf16 v[52:55], v[156:159], v[56:59], 0
    v_mfma_f32_16x16x32_bf16 v[24:27], v[104:107], v[60:63], v[24:27]
    v_mfma_f32_16x16x32_bf16 v[28:31], v[112:115], v[60:63], v[28:31]
    v_mfma_f32_16x16x32_bf16 v[32:35], v[120:123], v[60:63], v[32:35]
    v_mfma_f32_16x16x32_bf16 v[36:39], v[128:131], v[60:63], v[36:39]
    v_mfma_f32_16x16x32_bf16 v[40:43], v[136:139], v[60:63], v[40:43]
    v_mfma_f32_16x16x32_bf16 v[44:47], v[144:147], v[60:63], v[44:47]
    v_mfma_f32_16x16x32_bf16 v[48:51], v[152:155], v[60:63], v[48:51]
    v_mfma_f32_16x16x32_bf16 v[52:55], v[160:163], v[60:63], v[52:55]
    v_add_u32 v13, s46, v3
    s_nop 7
    ds_write_b128 v13, v[24:27] offset:0
    ds_write_b128 v13, v[28:31] offset:1024
    ds_write_b128 v13, v[32:35] offset:2048
    ds_write_b128 v13, v[36:39] offset:3072
    ds_write_b128 v13, v[40:43] offset:4096
    ds_write_b128 v13, v[44:47] offset:5120
    ds_write_b128 v13, v[48:51] offset:6144
    ds_write_b128 v13, v[52:55] offset:7168
    s_mov_b64 exec, 1
    ds_add_u32 v22, v23 offset:0
    s_mov_b64 exec, -1
    v_and_b32 v14, 8, v2
    v_lshl_add_u32 v13, v14, 7, v3
    s_lshl_b32 s38, s18, 11
    s_add_u32 s38, s38, 98304
    v_add_u32 v13, s38, v13
    v_and_b32 v12, 7, v2
    v_mul_u32_u24 v12, 14336, v12
    v_lshl_add_u32 v12, v10, 4, v12
    v_lshl_add_u32 v12, v14, 3, v12
    s_mul_i32 s56, s23, 229376
    s_lshl_b32 s39, s22, 8
    s_add_u32 s56, s56, s39
    s_lshr_b32 s39, s18, 1
    s_mul_i32 s39, s39, 114688
    s_add_u32 s56, s56, s39
    s_and_b32 s39, s18, 1
    s_lshl_b32 s39, s39, 7
    s_add_u32 s56, s56, s39
    s_add_u32 s56, s56, 10485760
L_s_guw:
    ds_read_b32 v15, v22 offset:0
    s_waitcnt lgkmcnt(0)
    v_readfirstlane_b32 s38, v15
    s_nop 1
    s_cmp_ge_u32 s38, 4
    s_cbranch_scc1 L_s_guw_ok
    s_sub_u32 s96, s96, 1
    s_cbranch_scc1 L_s_guw_ok
    s_sleep 0
    s_branch L_s_guw
L_s_guw_ok:
    ds_read_b128 v[64:67], v13 offset:0
    ds_read_b128 v[68:71], v13 offset:16384
    ds_read_b128 v[72:75], v13 offset:32768
    ds_read_b128 v[76:79], v13 offset:49152
    s_lshl_b32 s58, s22, 10
    s_lshl_b32 s39, s23, 8
    s_add_u32 s58, s58, s39
    s_add_u32 s58, s58, 9568256
    s_waitcnt lgkmcnt(0)
    v_pk_add_f32 v[64:65], v[64:65], v[68:69]
    v_pk_add_f32 v[72:73], v[72:73], v[76:77]
    v_pk_add_f32 v[64:65], v[64:65], v[72:73]
    v_pk_add_f32 v[66:67], v[66:67], v[70:71]
    v_pk_add_f32 v[74:75], v[74:75], v[78:79]
    v_pk_add_f32 v[66:67], v[66:67], v[74:75]
    buffer_store_dwordx4 v[64:67], v12, s[12:15], s56 offen sc1
    v_mov_b32 v13, s93
    v_lshlrev_b32 v14, 2, v2
    s_waitcnt vmcnt(0)
    v_mov_b32 v15, 1
    s_mov_b64 exec, 1
    ds_add_rtn_u32 v15, v22, v15 offset:28
    s_mov_b64 exec, -1
    s_waitcnt lgkmcnt(0)
    v_readfirstlane_b32 s39, v15
    s_nop 1
    s_cmp_lg_u32 s39, 3
    s_cbranch_scc1 L_s_nogf
    s_mov_b32 exec_hi, 0
    buffer_store_dword v13, v14, s[12:15], s58 offen sc1
    s_mov_b32 exec_hi, -1
L_s_nogf:
    v_add_u32 v13, s46, v3
    ds_write_b128 v13, v[200:203] offset:8192
    ds_write_b128 v13, v[204:207] offset:9216
    ds_write_b128 v13, v[208:211] offset:10240
    ds_write_b128 v13, v[212:215] offset:11264
    ds_write_b128 v13, v[216:219] offset:12288
    ds_write_b128 v13, v[220:223] offset:13312
    ds_write_b128 v13, v[224:227] offset:14336
    ds_write_b128 v13, v[228:231] offset:15360
    s_lshl_b32 s56, s22, 10
    s_add_u32 s56, s56, 9568256
    v_and_b32 v13, 3, v2
    v_lshlrev_b32 v13, 8, v13
    v_lshrrev_b32 v6, 5, v2
    v_lshl_add_u32 v6, s18, 1, v6
    v_and_b32 v7, 1, v10
    v_lshl_add_u32 v9, v7, 3, v6
    v_mul_u32_u24 v9, 14336, v9
    v_lshl_add_u32 v9, v11, 4, v9
    s_cmp_lg_u32 s18, 0
    s_cbranch_scc1 L_s_gw
L_s_gpoll:
    s_mov_b64 exec, 0xf
    buffer_load_dword v14, v13, s[12:15], s56 offen sc1
    s_waitcnt vmcnt(0)
    v_cmp_ne_u32 vcc, s93, v14
    s_mov_b64 exec, -1
    s_nop 0
    s_cmp_eq_u64 vcc, 0
    s_cbranch_scc1 L_s_ggo
    s_sub_u32 s96, s96, 1
    s_cbranch_scc1 L_s_ggo
    s_sleep 6
    s_branch L_s_gpoll
L_s_ggo:
    s_mov_b64 exec, 1
    ds_add_u32 v22, v23 offset:68
    s_mov_b64 exec, -1
L_s_gw:
    ds_read_b32 v15, v22 offset:68
    s_waitcnt lgkmcnt(0)
    v_readfirstlane_b32 s38, v15
    s_nop 1
    s_cmp_ge_u32 s38, 1
    s_cbranch_scc1 L_s_gw_ok
    s_sub_u32 s96, s96, 1
    s_cbranch_scc1 L_s_gw_ok
    s_sleep 2
    s_branch L_s_gw
L_s_gw_ok:
    s_lshl_b32 s38, s22, 8
    s_add_u32 s38, s38, 10485760
    buffer_load_dwordx4 v[24:27], v9, s[12:15], s38 offen sc1
    s_add_u32 s38, s38, 229376
    buffer_load_dwordx4 v[28:31], v9, s[12:15], s38 offen sc1
    s_add_u32 s38, s38, 229376
    buffer_load_dwordx4 v[32:35], v9, s[12:15], s38 offen sc1
    s_add_u32 s38, s38, 229376
    buffer_load_dwordx4 v[36:39], v9, s[12:15], s38 offen sc1
    s_add_u32 s38, s38, 229376
    ds_read_b64_tr_b16 v[64:65], v16 offset:8192
    ds_read_b64_tr_b16 v[66:67], v16 offset:8704
    ds_read_b64_tr_b16 v[68:69], v16 offset:12288
    ds_read_b64_tr_b16 v[70:71], v16 offset:12800
    ds_read_b64_tr_b16 v[72:73], v17 offset:8192
    ds_read_b64_tr_b16 v[74:75], v17 offset:8704
    ds_read_b64_tr_b16 v[76:77], v17 offset:12288
    ds_read_b64_tr_b16 v[78:79], v17 offset:12800
    ds_read_b64_tr_b16 v[80:81], v18 offset:8192
    ds_read_b64_tr_b16 v[82:83], v18 offset:8704
    ds_read_b64_tr_b16 v[84:85], v18 offset:12288
    ds_read_b64_tr_b16 v[86:87], v18 offset:12800
    ds_read_b64_tr_b16 v[88:89], v19 offset:8192
    ds_read_b64_tr_b16 v[90:91], v19 offset:8704
    ds_read_b64_tr_b16 v[92:93], v19 offset:12288
    ds_read_b64_tr_b16 v[94:95], v19 offset:12800
    s_waitcnt vmcnt(0)
    v_pk_add_f32 v[24:25], v[24:25], v[28:29]
    v_pk_add_f32 v[32:33], v[32:33], v[36:37]
    v_pk_add_f32 v[24:25], v[24:25], v[32:33]
    v_pk_add_f32 v[26:27], v[26:27], v[30:31]
    v_pk_add_f32 v[34:35], v[34:35], v[38:39]
    v_pk_add_f32 v[26:27], v[26:27], v[34:35]
    v_cvt_pk_bf16_f32 v24, v24, v24
    v_lshlrev_b32 v24, 16, v24
    v_mov_b32 v28, v24
    v_cvt_pk_bf16_f32 v25, v25, v25
    v_lshlrev_b32 v25, 16, v25
    v_mov_b32 v29, v25
    v_cvt_pk_bf16_f32 v26, v26, v26
    v_lshlrev_b32 v26, 16, v26
    v_mov_b32 v30, v26
    v_cvt_pk_bf16_f32 v27, v27, v27
    v_lshlrev_b32 v27, 16, v27
    v_mov_b32 v31, v27
    s_nop 1
    v_permlane16_swap_b32 v24, v28
    v_permlane16_swap_b32 v25, v29
    v_permlane16_swap_b32 v26, v30
    v_permlane16_swap_b32 v27, v31
    s_nop 1
    v_mul_f32 v40, 0xbfb8aa3b, v24
    v_exp_f32 v40, v40
    s_nop 0
    v_add_f32 v40, 1.0, v40
    v_rcp_f32 v40, v40
    s_nop 0
    v_mul_f32 v40, v40, v24
    v_cvt_pk_bf16_f32 v40, v40, v40
    v_lshlrev_b32 v40, 16, v40
    v_mul_f32 v40, v40, v28
    v_mul_f32 v41, 0xbfb8aa3b, v25
    v_exp_f32 v41, v41
    s_nop 0
    v_add_f32 v41, 1.0, v41
    v_rcp_f32 v41, v41
    s_nop 0
    v_mul_f32 v41, v41, v25
    v_cvt_pk_bf16_f32 v41, v41, v41
    v_lshlrev_b32 v41, 16, v41
    v_mul_f32 v41, v41, v29
    v_mul_f32 v42, 0xbfb8aa3b, v26
    v_exp_f32 v42, v42
    s_nop 0
    v_add_f32 v42, 1.0, v42
    v_rcp_f32 v42, v42
    s_nop 0
    v_mul_f32 v42, v42, v26
    v_cvt_pk_bf16_f32 v42, v42, v42
    v_lshlrev_b32 v42, 16, v42
    v_mul_f32 v42, v42, v30
    v_mul_f32 v43, 0xbfb8aa3b, v27
    v_exp_f32 v43, v43
    s_nop 0
    v_add_f32 v43, 1.0, v43
    v_rcp_f32 v43, v43
    s_nop 0
    v_mul_f32 v43, v43, v27
    v_cvt_pk_bf16_f32 v43, v43, v43
    v_lshlrev_b32 v43, 16, v43
    v_mul_f32 v43, v43, v31
    v_cvt_pk_bf16_f32 v40, v40, v41
    v_cvt_pk_bf16_f32 v41, v42, v43
    v_mul_u32_u24 v9, 144, v6
    v_lshl_add_u32 v9, v11, 3, v9
    v_add_u32 v9, 74240, v9
    ds_write_b64 v9, v[40:41]
    s_mov_b64 exec, 1
    ds_add_u32 v22, v23 offset:20
    s_mov_b64 exec, -1
    v_and_b32 v9, 7, v2
    v_mul_u32_u24 v9, 144, v9
    v_lshl_add_u32 v9, v10, 4, v9
    v_add_u32 v9, 74240, v9
L_s_aw:
    ds_read_b32 v15, v22 offset:20
    s_waitcnt lgkmcnt(0)
    v_readfirstlane_b32 s38, v15
    s_nop 1
    s_cmp_ge_u32 s38, 4
    s_cbranch_scc1 L_s_aw_ok
    s_sub_u32 s96, s96, 1
    s_cbranch_scc1 L_s_aw_ok
    s_sleep 1
    s_branch L_s_aw
L_s_aw_ok:
    ds_read_b128 v[40:43], v9
    ds_read_b128 v[44:47], v9 offset:64
    s_mov_b32 s38, 229376
    v_and_b32 v15, 7, v2
    v_mul_lo_u32 v15, v15, s38
    v_lshl_add_u32 v15, v10, 4, v15
    v_and_b32 v14, 8, v2
    v_lshl_add_u32 v15, v14, 3, v15
    s_lshl_b32 s38, s22, 12
    s_lshl_b32 s39, s23, 10
    s_add_u32 s38, s38, s39
    s_lshl_b32 s39, s18, 8
    s_add_u32 s38, s38, s39
    s_add_u32 s38, s38, 13631488
    v_cmp_eq_u32 vcc, 8, v14
    s_waitcnt lgkmcnt(0)
    v_mfma_f32_16x16x32_bf16 v[48:51], v[64:67], v[40:43], 0
    v_mfma_f32_16x16x32_bf16 v[52:55], v[72:75], v[40:43], 0
    v_mfma_f32_16x16x32_bf16 v[56:59], v[80:83], v[40:43], 0
    v_mfma_f32_16x16x32_bf16 v[60:63], v[88:91], v[40:43], 0
    v_mfma_f32_16x16x32_bf16 v[48:51], v[68:71], v[44:47], v[48:51]
    v_mfma_f32_16x16x32_bf16 v[52:55], v[76:79], v[44:47], v[52:55]
    v_mfma_f32_16x16x32_bf16 v[56:59], v[84:87], v[44:47], v[56:59]
    v_mfma_f32_16x16x32_bf16 v[60:63], v[92:95], v[44:47], v[60:63]
    s_nop 7
    v_cndmask_b32 v48, v48, v52, vcc
    v_cndmask_b32 v49, v49, v53, vcc
    v_cndmask_b32 v50, v50, v54, vcc
    v_cndmask_b32 v51, v51, v55, vcc
    buffer_store_dwordx4 v[48:51], v15, s[12:15], s38 offen offset:0 sc1
    v_cndmask_b32 v56, v56, v60, vcc
    v_cndmask_b32 v57, v57, v61, vcc
    v_cndmask_b32 v58, v58, v62, vcc
    v_cndmask_b32 v59, v59, v63, vcc
    buffer_store_dwordx4 v[56:59], v15, s[12:15], s38 offen offset:128 sc1
    s_lshl_b32 s58, s23, 14
    s_lshl_b32 s39, s22, 8
    s_add_u32 s58, s58, s39
    s_add_u32 s58, s58, 9633792
    v_mov_b32 v13, s93
    v_lshlrev_b32 v14, 2, v2
    s_waitcnt vmcnt(0)
    v_mov_b32 v15, 1
    s_mov_b64 exec, 1
    ds_add_rtn_u32 v15, v22, v15 offset:24
    s_mov_b64 exec, -1
    s_waitcnt lgkmcnt(0)
    v_readfirstlane_b32 s39, v15
    s_nop 1
    s_cmp_lg_u32 s39, 3
    s_cbranch_scc1 L_s_cons
    s_mov_b32 exec_hi, 0
    buffer_store_dword v13, v14, s[12:15], s58 offen sc1
    s_mov_b32 exec_hi, -1
L_s_cons:
    s_add_u32 s38, s18, 4
    v_readlane_b32 s24, v8, s18
    v_readlane_b32 s25, v8, s38
    s_lshl_b32 s45, s16, 7
    s_and_b32 s26, s24, 0x7ff
    s_sub_u32 s26, 2047, s26
    s_sub_u32 s56, s26, s45
    s_and_b32 s27, s25, 0x7ff
    s_sub_u32 s27, 2047, s27
    s_sub_u32 s57, s27, s45
    s_waitcnt lgkmcnt(0)
    s_min_u32 s38, s56, s57
    s_cmp_ge_u32 s38, 128
    s_cbranch_scc1 L_s_end
L_s_pw:
    ds_read_b32 v15, v22 offset:16
    s_waitcnt lgkmcnt(0)
    v_readfirstlane_b32 s38, v15
    s_nop 1
    s_cmp_ge_u32 s38, 28
    s_cbranch_scc1 L_s_pw_ok
    s_sub_u32 s96, s96, 1
    s_cbranch_scc1 L_s_pw_ok
    s_sleep 8
    s_branch L_s_pw
L_s_pw_ok:
    s_lshr_b32 s58, s17, 2
    s_lshl_b32 s58, s58, 14
    s_add_u32 s58, s58, 9633792
    v_min_u32 v4, 55, v2
    v_lshlrev_b32 v4, 8, v4
    v_lshlrev_b32 v6, 12, v10
    v_lshl_add_u32 v6, v11, 4, v6
    v_lshlrev_b32 v9, 3, v11
    v_mov_b32 v7, 0
L_s_ypoll:
    buffer_load_dword v5, v4, s[12:15], s58 offen sc1
    s_waitcnt vmcnt(0)
    v_cmp_ne_u32 vcc, s93, v5
    s_nop 1
    s_cmp_eq_u64 vcc, 0
    s_cbranch_scc1 L_s_ygo
    s_sub_u32 s96, s96, 1
    s_cbranch_scc1 L_s_ygo
    s_sleep 6
    s_branch L_s_ypoll
L_s_ygo:
    s_cmp_ge_u32 s56, 128
    s_cbranch_scc1 L_s_sk0
    s_add_u32 s39, s18, 0
    s_mul_i32 s39, s39, 229376
    s_lshl_b32 s3, s17, 8
    s_add_u32 s39, s39, s3
    s_add_u32 s39, s39, 13631488
    buffer_load_dwordx4 v[24:27], v6, s[12:15], s39 offen sc1
    s_add_u32 s39, s39, 16384
    buffer_load_dwordx4 v[28:31], v6, s[12:15], s39 offen sc1
    s_add_u32 s39, s39, 16384
    buffer_load_dwordx4 v[32:35], v6, s[12:15], s39 offen sc1
    s_add_u32 s39, s39, 16384
    buffer_load_dwordx4 v[36:39], v6, s[12:15], s39 offen sc1
    s_add_u32 s39, s39, 16384
    buffer_load_dwordx4 v[40:43], v6, s[12:15], s39 offen sc1
    s_add_u32 s39, s39, 16384
    buffer_load_dwordx4 v[44:47], v6, s[12:15], s39 offen sc1
    s_add_u32 s39, s39, 16384
    buffer_load_dwordx4 v[48:51], v6, s[12:15], s39 offen sc1
    s_add_u32 s39, s39, 16384
    buffer_load_dwordx4 v[52:55], v6, s[12:15], s39 offen sc1
    s_add_u32 s39, s39, 16384
    buffer_load_dwordx4 v[56:59], v6, s[12:15], s39 offen sc1
    s_add_u32 s39, s39, 16384
    buffer_load_dwordx4 v[60:63], v6, s[12:15], s39 offen sc1
    s_add_u32 s39, s39, 16384
    buffer_load_dwordx4 v[64:67], v6, s[12:15], s39 offen sc1
    s_add_u32 s39, s39, 16384
    buffer_load_dwordx4 v[68:71], v6, s[12:15], s39 offen sc1
    s_add_u32 s39, s39, 16384
    buffer_load_dwordx4 v[72:75], v6, s[12:15], s39 offen sc1
    s_add_u32 s39, s39, 16384
    buffer_load_dwordx4 v[76:79], v6, s[12:15], s39 offen sc1
    s_add_u32 s39, s39, 16384
    s_lshl_b32 s39, s26, 11
    s_lshl_b32 s3, s17, 7
    s_add_u32 s39, s39, s3
    buffer_load_dwordx2 v[80:81], v9, s[8:11], s39 offen
    s_lshl_b32 s39, s26, 3
    s_add_u32 s39, s39, 9453568
    buffer_load_dword v82, v7, s[12:15], s39 offen sc1
L_s_sk0:
    s_cmp_ge_u32 s57, 128
    s_cbranch_scc1 L_s_sk1
    s_add_u32 s39, s18, 4
    s_mul_i32 s39, s39, 229376
    s_lshl_b32 s3, s17, 8
    s_add_u32 s39, s39, s3
    s_add_u32 s39, s39, 13631488
    buffer_load_dwordx4 v[88:91], v6, s[12:15], s39 offen sc1
    s_add_u32 s39, s39, 16384
    buffer_load_dwordx4 v[92:95], v6, s[12:15], s39 offen sc1
    s_add_u32 s39, s39, 16384
    buffer_load_dwordx4 v[96:99], v6, s[12:15], s39 offen sc1
    s_add_u32 s39, s39, 16384
    buffer_load_dwordx4 v[100:103], v6, s[12:15], s39 offen sc1
    s_add_u32 s39, s39, 16384
    buffer_load_dwordx4 v[104:107], v6, s[12:15], s39 offen sc1
    s_add_u32 s39, s39, 16384
    buffer_load_dwordx4 v[108:111], v6, s[12:15], s39 offen sc1
    s_add_u32 s39, s39, 16384
    buffer_load_dwordx4 v[112:115], v6, s[12:15], s39 offen sc1
    s_add_u32 s39, s39, 16384
    buffer_load_dwordx4 v[116:119], v6, s[12:15], s39 offen sc1
    s_add_u32 s39, s39, 16384
    buffer_load_dwordx4 v[120:123], v6, s[12:15], s39 offen sc1
    s_add_u32 s39, s39, 16384
    buffer_load_dwordx4 v[124:127], v6, s[12:15], s39 offen sc1
    s_add_u32 s39, s39, 16384
    buffer_load_dwordx4 v[128:131], v6, s[12:15], s39 offen sc1
    s_add_u32 s39, s39, 16384
    buffer_load_dwordx4 v[132:135], v6, s[12:15], s39 offen sc1
    s_add_u32 s39, s39, 16384
    buffer_load_dwordx4 v[136:139], v6, s[12:15], s39 offen sc1
    s_add_u32 s39, s39, 16384
    buffer_load_dwordx4 v[140:143], v6, s[12:15], s39 offen sc1
    s_add_u32 s39, s39, 16384
    s_lshl_b32 s39, s27, 11
    s_lshl_b32 s3, s17, 7
    s_add_u32 s39, s39, s3
    buffer_load_dwordx2 v[144:145], v9, s[8:11], s39 offen
    s_lshl_b32 s39, s27, 3
    s_add_u32 s39, s39, 9453568
    buffer_load_dword v146, v7, s[12:15], s39 offen sc1
L_s_sk1:
    s_waitcnt vmcnt(0)
    s_cmp_ge_u32 s56, 128
    s_cbranch_scc1 L_s_sc0
    s_ashr_i32 s39, s24, 31
    s_not_b32 s39, s39
    s_or_b32 s39, s39, 0x80000000
    s_xor_b32 s39, s24, s39
    s_and_b32 s39, s39, 0xffff0000
    v_mov_b32 v86, s39
    v_mul_f32 v83, 0xbfb8aa3b, v86
    v_exp_f32 v83, v83
    s_nop 0
    v_add_f32 v83, 1.0, v83
    v_rcp_f32 v83, v83
    s_nop 0
    v_cvt_pk_bf16_f32 v83, v83, v83
    v_lshlrev_b32 v83, 16, v83
    v_pk_add_f32 v[24:25], v[24:25], v[28:29]
    v_pk_add_f32 v[26:27], v[26:27], v[30:31]
    v_pk_add_f32 v[24:25], v[24:25], v[32:33]
    v_pk_add_f32 v[26:27], v[26:27], v[34:35]
    v_pk_add_f32 v[24:25], v[24:25], v[36:37]
    v_pk_add_f32 v[26:27], v[26:27], v[38:39]
    v_pk_add_f32 v[24:25], v[24:25], v[40:41]
    v_pk_add_f32 v[26:27], v[26:27], v[42:43]
    v_pk_add_f32 v[24:25], v[24:25], v[44:45]
    v_pk_add_f32 v[26:27], v[26:27], v[46:47]
    v_pk_add_f32 v[24:25], v[24:25], v[48:49]
    v_pk_add_f32 v[26:27], v[26:27], v[50:51]
    v_pk_add_f32 v[24:25], v[24:25], v[52:53]
    v_pk_add_f32 v[26:27], v[26:27], v[54:55]
    v_pk_add_f32 v[24:25], v[24:25], v[56:57]
    v_pk_add_f32 v[26:27], v[26:27], v[58:59]
    v_pk_add_f32 v[24:25], v[24:25], v[60:61]
    v_pk_add_f32 v[26:27], v[26:27], v[62:63]
    v_pk_add_f32 v[24:25], v[24:25], v[64:65]
    v_pk_add_f32 v[26:27], v[26:27], v[66:67]
    v_pk_add_f32 v[24:25], v[24:25], v[68:69]
    v_pk_add_f32 v[26:27], v[26:27], v[70:71]
    v_pk_add_f32 v[24:25], v[24:25], v[72:73]
    v_pk_add_f32 v[26:27], v[26:27], v[74:75]
    v_pk_add_f32 v[24:25], v[24:25], v[76:77]
    v_pk_add_f32 v[26:27], v[26:27], v[78:79]
    v_mov_b32 v28, v24
    v_mov_b32 v29, v25
    v_mov_b32 v30, v26
    v_mov_b32 v31, v27
    s_nop 1
    v_permlane16_swap_b32 v24, v28
    v_permlane16_swap_b32 v25, v29
    v_permlane16_swap_b32 v26, v30
    v_permlane16_swap_b32 v27, v31
    s_nop 1
    v_add_f32 v24, v24, v28
    v_add_f32 v25, v25, v29
    v_add_f32 v26, v26, v30
    v_add_f32 v27, v27, v31
    v_mov_b32 v28, v24
    v_mov_b32 v29, v25
    v_mov_b32 v30, v26
    v_mov_b32 v31, v27
    s_nop 1
    v_permlane32_swap_b32 v24, v28
    v_permlane32_swap_b32 v25, v29
    v_permlane32_swap_b32 v26, v30
    v_permlane32_swap_b32 v27, v31
    s_nop 1
    v_add_f32 v24, v24, v28
    v_add_f32 v25, v25, v29
    v_add_f32 v26, v26, v30
    v_add_f32 v27, v27, v31
    v_sub_f32 v82, 1.0, v82
    v_cvt_pk_bf16_f32 v82, v82, v82
    v_lshlrev_b32 v82, 16, v82
    v_lshlrev_b32 v32, 16, v80
    v_and_b32 v33, s21, v80
    v_lshlrev_b32 v34, 16, v81
    v_and_b32 v35, s21, v81
    v_cvt_pk_bf16_f32 v24, v24, v24
    v_lshlrev_b32 v24, 16, v24
    v_mul_f32 v24, v24, v83
    v_cvt_pk_bf16_f32 v24, v24, v24
    v_lshlrev_b32 v24, 16, v24
    v_add_f32 v24, v24, v32
    v_cvt_pk_bf16_f32 v24, v24, v24
    v_lshlrev_b32 v24, 16, v24
    v_mul_f32 v24, v24, v82
    v_cvt_pk_bf16_f32 v24, v24, v24
    v_lshlrev_b32 v24, 16, v24
    v_mul_f32 v32, v32, v82
    v_cvt_pk_bf16_f32 v32, v32, v32
    v_lshlrev_b32 v32, 16, v32
    v_sub_f32 v24, v24, v32
    v_cvt_pk_bf16_f32 v25, v25, v25
    v_lshlrev_b32 v25, 16, v25
    v_mul_f32 v25, v25, v83
    v_cvt_pk_bf16_f32 v25, v25, v25
    v_lshlrev_b32 v25, 16, v25
    v_add_f32 v25, v25, v33
    v_cvt_pk_bf16_f32 v25, v25, v25
    v_lshlrev_b32 v25, 16, v25
    v_mul_f32 v25, v25, v82
    v_cvt_pk_bf16_f32 v25, v25, v25
    v_lshlrev_b32 v25, 16, v25
    v_mul_f32 v33, v33, v82
    v_cvt_pk_bf16_f32 v33, v33, v33
    v_lshlrev_b32 v33, 16, v33
    v_sub_f32 v25, v25, v33
    v_cvt_pk_bf16_f32 v26, v26, v26
    v_lshlrev_b32 v26, 16, v26
    v_mul_f32 v26, v26, v83
    v_cvt_pk_bf16_f32 v26, v26, v26
    v_lshlrev_b32 v26, 16, v26
    v_add_f32 v26, v26, v34
    v_cvt_pk_bf16_f32 v26, v26, v26
    v_lshlrev_b32 v26, 16, v26
    v_mul_f32 v26, v26, v82
    v_cvt_pk_bf16_f32 v26, v26, v26
    v_lshlrev_b32 v26, 16, v26
    v_mul_f32 v34, v34, v82
    v_cvt_pk_bf16_f32 v34, v34, v34
    v_lshlrev_b32 v34, 16, v34
    v_sub_f32 v26, v26, v34
    v_cvt_pk_bf16_f32 v27, v27, v27
    v_lshlrev_b32 v27, 16, v27
    v_mul_f32 v27, v27, v83
    v_cvt_pk_bf16_f32 v27, v27, v27
    v_lshlrev_b32 v27, 16, v27
    v_add_f32 v27, v27, v35
    v_cvt_pk_bf16_f32 v27, v27, v27
    v_lshlrev_b32 v27, 16, v27
    v_mul_f32 v27, v27, v82
    v_cvt_pk_bf16_f32 v27, v27, v27
    v_lshlrev_b32 v27, 16, v27
    v_mul_f32 v35, v35, v82
    v_cvt_pk_bf16_f32 v35, v35, v35
    v_lshlrev_b32 v35, 16, v35
    v_sub_f32 v27, v27, v35
    s_lshl_b32 s39, s18, 8
    s_add_u32 s39, s39, 75776
    v_lshl_add_u32 v84, v11, 4, s39
    ds_write_b128 v84, v[24:27]
    v_lshl_add_u32 v85, s18, 2, v22
    s_mov_b64 exec, 1
    ds_add_u32 v85, v23 offset:36
    s_mov_b64 exec, -1
L_s_sc0:
    s_cmp_ge_u32 s57, 128
    s_cbranch_scc1 L_s_sc1
    s_ashr_i32 s39, s25, 31
    s_not_b32 s39, s39
    s_or_b32 s39, s39, 0x80000000
    s_xor_b32 s39, s25, s39
    s_and_b32 s39, s39, 0xffff0000
    v_mov_b32 v150, s39
    v_mul_f32 v147, 0xbfb8aa3b, v150
    v_exp_f32 v147, v147
    s_nop 0
    v_add_f32 v147, 1.0, v147
    v_rcp_f32 v147, v147
    s_nop 0
    v_cvt_pk_bf16_f32 v147, v147, v147
    v_lshlrev_b32 v147, 16, v147
    v_pk_add_f32 v[88:89], v[88:89], v[92:93]
    v_pk_add_f32 v[90:91], v[90:91], v[94:95]
    v_pk_add_f32 v[88:89], v[88:89], v[96:97]
    v_pk_add_f32 v[90:91], v[90:91], v[98:99]
    v_pk_add_f32 v[88:89], v[88:89], v[100:101]
    v_pk_add_f32 v[90:91], v[90:91], v[102:103]
    v_pk_add_f32 v[88:89], v[88:89], v[104:105]
    v_pk_add_f32 v[90:91], v[90:91], v[106:107]
    v_pk_add_f32 v[88:89], v[88:89], v[108:109]
    v_pk_add_f32 v[90:91], v[90:91], v[110:111]
    v_pk_add_f32 v[88:89], v[88:89], v[112:113]
    v_pk_add_f32 v[90:91], v[90:91], v[114:115]
    v_pk_add_f32 v[88:89], v[88:89], v[116:117]
    v_pk_add_f32 v[90:91], v[90:91], v[118:119]
    v_pk_add_f32 v[88:89], v[88:89], v[120:121]
    v_pk_add_f32 v[90:91], v[90:91], v[122:123]
    v_pk_add_f32 v[88:89], v[88:89], v[124:125]
    v_pk_add_f32 v[90:91], v[90:91], v[126:127]
    v_pk_add_f32 v[88:89], v[88:89], v[128:129]
    v_pk_add_f32 v[90:91], v[90:91], v[130:131]
    v_pk_add_f32 v[88:89], v[88:89], v[132:133]
    v_pk_add_f32 v[90:91], v[90:91], v[134:135]
    v_pk_add_f32 v[88:89], v[88:89], v[136:137]
    v_pk_add_f32 v[90:91], v[90:91], v[138:139]
    v_pk_add_f32 v[88:89], v[88:89], v[140:141]
    v_pk_add_f32 v[90:91], v[90:91], v[142:143]
    v_mov_b32 v92, v88
    v_mov_b32 v93, v89
    v_mov_b32 v94, v90
    v_mov_b32 v95, v91
    s_nop 1
    v_permlane16_swap_b32 v88, v92
    v_permlane16_swap_b32 v89, v93
    v_permlane16_swap_b32 v90, v94
    v_permlane16_swap_b32 v91, v95
    s_nop 1
    v_add_f32 v88, v88, v92
    v_add_f32 v89, v89, v93
    v_add_f32 v90, v90, v94
    v_add_f32 v91, v91, v95
    v_mov_b32 v92, v88
    v_mov_b32 v93, v89
    v_mov_b32 v94, v90
    v_mov_b32 v95, v91
    s_nop 1
    v_permlane32_swap_b32 v88, v92
    v_permlane32_swap_b32 v89, v93
    v_permlane32_swap_b32 v90, v94
    v_permlane32_swap_b32 v91, v95
    s_nop 1
    v_add_f32 v88, v88, v92
    v_add_f32 v89, v89, v93
    v_add_f32 v90, v90, v94
    v_add_f32 v91, v91, v95
    v_sub_f32 v146, 1.0, v146
    v_cvt_pk_bf16_f32 v146, v146, v146
    v_lshlrev_b32 v146, 16, v146
    v_lshlrev_b32 v96, 16, v144
    v_and_b32 v97, s21, v144
    v_lshlrev_b32 v98, 16, v145
    v_and_b32 v99, s21, v145
    v_cvt_pk_bf16_f32 v88, v88, v88
    v_lshlrev_b32 v88, 16, v88
    v_mul_f32 v88, v88, v147
    v_cvt_pk_bf16_f32 v88, v88, v88
    v_lshlrev_b32 v88, 16, v88
    v_add_f32 v88, v88, v96
    v_cvt_pk_bf16_f32 v88, v88, v88
    v_lshlrev_b32 v88, 16, v88
    v_mul_f32 v88, v88, v146
    v_cvt_pk_bf16_f32 v88, v88, v88
    v_lshlrev_b32 v88, 16, v88
    v_mul_f32 v96, v96, v146
    v_cvt_pk_bf16_f32 v96, v96, v96
    v_lshlrev_b32 v96, 16, v96
    v_sub_f32 v88, v88, v96
    v_cvt_pk_bf16_f32 v89, v89, v89
    v_lshlrev_b32 v89, 16, v89
    v_mul_f32 v89, v89, v147
    v_cvt_pk_bf16_f32 v89, v89, v89
    v_lshlrev_b32 v89, 16, v89
    v_add_f32 v89, v89, v97
    v_cvt_pk_bf16_f32 v89, v89, v89
    v_lshlrev_b32 v89, 16, v89
    v_mul_f32 v89, v89, v146
    v_cvt_pk_bf16_f32 v89, v89, v89
    v_lshlrev_b32 v89, 16, v89
    v_mul_f32 v97, v97, v146
    v_cvt_pk_bf16_f32 v97, v97, v97
    v_lshlrev_b32 v97, 16, v97
    v_sub_f32 v89, v89, v97
    v_cvt_pk_bf16_f32 v90, v90, v90
    v_lshlrev_b32 v90, 16, v90
    v_mul_f32 v90, v90, v147
    v_cvt_pk_bf16_f32 v90, v90, v90
    v_lshlrev_b32 v90, 16, v90
    v_add_f32 v90, v90, v98
    v_cvt_pk_bf16_f32 v90, v90, v90
    v_lshlrev_b32 v90, 16, v90
    v_mul_f32 v90, v90, v146
    v_cvt_pk_bf16_f32 v90, v90, v90
    v_lshlrev_b32 v90, 16, v90
    v_mul_f32 v98, v98, v146
    v_cvt_pk_bf16_f32 v98, v98, v98
    v_lshlrev_b32 v98, 16, v98
    v_sub_f32 v90, v90, v98
    v_cvt_pk_bf16_f32 v91, v91, v91
    v_lshlrev_b32 v91, 16, v91
    v_mul_f32 v91, v91, v147
    v_cvt_pk_bf16_f32 v91, v91, v91
    v_lshlrev_b32 v91, 16, v91
    v_add_f32 v91, v91, v99
    v_cvt_pk_bf16_f32 v91, v91, v91
    v_lshlrev_b32 v91, 16, v91
    v_mul_f32 v91, v91, v146
    v_cvt_pk_bf16_f32 v91, v91, v91
    v_lshlrev_b32 v91, 16, v91
    v_mul_f32 v99, v99, v146
    v_cvt_pk_bf16_f32 v99, v99, v99
    v_lshlrev_b32 v99, 16, v99
    v_sub_f32 v91, v91, v99
    s_lshl_b32 s39, s18, 8
    s_add_u32 s39, s39, 76800
    v_lshl_add_u32 v148, v11, 4, s39
    ds_write_b128 v148, v[88:91]
    v_lshl_add_u32 v149, s18, 2, v22
    s_mov_b64 exec, 1
    ds_add_u32 v149, v23 offset:52
    s_mov_b64 exec, -1
L_s_sc1:
L_s_end:
    s_endpgm
L_exit:
    s_endpgm
L_gemm:
    s_add_u32 s94, s42, 9469952
    s_addc_u32 s95, s43, 0
    s_load_dword s93, s[94:95], 0
    s_lshr_b32 s20, s18, 1
    s_lshl_b32 s50, s3, 8
    s_lshl_b32 s39, s38, 3
    s_add_u32 s50, s50, s39
    s_lshl_b32 s50, s50, 11
    s_lshl_b32 s51, s18, 9
    s_add_u32 s50, s50, s51
    s_lshl_b32 s39, s18, 13
    s_add_u32 m0, s39, 65536
    v_and_b32 v4, 31, v0
    v_lshlrev_b32 v4, 4, v4
    v_bfe_u32 v5, v0, 5, 1
    v_lshl_add_u32 v5, v5, 11, v4
    v_add_u32 v4, s51, v4
    v_mov_b32 v6, s44
    v_mov_b32 v7, s45
    s_mov_b32 exec_lo, 0
    v_mov_b32 v6, s80
    v_mov_b32 v7, s81
    s_mov_b32 exec_lo, -1
    v_add_co_u32 v6, vcc, v6, v4
    s_mov_b32 s4, s40
    s_mov_b32 s5, s41
    s_mov_b32 s6, 4194304
    s_mov_b32 s7, 0x20000
    v_addc_co_u32 v7, vcc, 0, v7, vcc
    buffer_load_dwordx4 v5, s[4:7], s50 offen  lds
    s_add_u32 m0, m0, 1024
    s_add_u32 s50, s50, 4096
    buffer_load_dwordx4 v5, s[4:7], s50 offen  lds
    s_add_u32 m0, m0, 1024
    s_add_u32 s50, s50, 4096
    buffer_load_dwordx4 v5, s[4:7], s50 offen  lds
    s_add_u32 m0, m0, 1024
    s_add_u32 s50, s50, 4096
    buffer_load_dwordx4 v5, s[4:7], s50 offen  lds
    s_add_u32 m0, m0, 1024
    s_add_u32 s50, s50, 4096
    global_load_lds_dwordx4 v[6:7], off
    s_and_b32 s39, s3, 1
    s_lshl_b32 s50, s39, 9
    s_lshr_b32 s39, s3, 1
    s_lshl_b32 s39, s39, 7
    s_add_u32 s50, s50, s39
    s_lshl_b32 s39, s38, 2
    s_add_u32 s50, s50, s39
    s_add_u32 s50, s50, s18
    s_lshl_b32 s50, s50, 11
    v_and_b32 v4, 63, v0
    v_lshl_add_u32 v3, v4, 5, s50
    global_load_dword v10, v3, s[68:69]
    global_load_dword v11, v3, s[70:71]
    s_mov_b64 s[8:9], s[72:73]
    s_mov_b64 s[10:11], s[74:75]
    s_mov_b64 s[52:53], s[72:73]
    s_mov_b64 s[54:55], s[74:75]
    s_mov_b64 s[58:59], s[78:79]
    s_mov_b64 s[36:37], s[82:83]
    v_and_b32 v24, 63, v0
    s_and_b32 s19, s18, 1
    s_lshl_b32 s23, s18, 12
    v_lshrrev_b32 v25, 4, v24
    v_lshrrev_b32 v56, 3, v24
    v_and_b32 v57, 7, v24
    v_lshrrev_b32 v58, 1, v56
    v_xor_b32 v57, v57, v58
    v_lshlrev_b32 v57, 4, v57
    s_mov_b32 s12, s42
    s_mov_b32 s13, s43
    s_mov_b32 s14, 25165824
    s_mov_b32 s15, 0x20000
    s_lshl_b32 s38, s17, 14
    s_add_u32 s38, s38, 8388608
    s_add_u32 s24, s42, s38
    s_addc_u32 s25, s43, 0
    s_mov_b32 s26, 16384
    s_mov_b32 s27, 0x20000
    s_cmp_lt_u32 s18, 2
    s_cselect_b32 s28, s52, s54
    s_cselect_b32 s29, s53, s55
    s_sub_u32 s28, s28, 3072
    s_subb_u32 s29, s29, 0
    s_mov_b32 s30, 2100224
    s_mov_b32 s31, 0x20000
    s_mov_b32 s32, s36
    s_mov_b32 s33, s37
    s_mov_b32 s34, 8388608
    s_mov_b32 s35, 0x20000
    v_bfe_u32 v59, v24, 1, 3
    v_xor_b32 v59, v59, v25
    v_lshlrev_b32 v59, 4, v59
    v_lshl_add_u32 v59, v26, 7, v59
    s_lshl_b32 s38, s19, 13
    s_lshl_b32 s39, s20, 13
    v_xor_b32 v58, 0, v59
    v_add_u32 v16, s38, v58
    v_add_u32 v18, s39, v58
    v_add_u32 v20, 0x10000, v16
    v_add_u32 v22, 0x10000, v18
    v_xor_b32 v58, 64, v59
    v_add_u32 v17, s38, v58
    v_add_u32 v19, s39, v58
    v_add_u32 v21, 0x10000, v17
    v_add_u32 v23, 0x10000, v19
    v_and_b32 v58, 31, v24
    v_lshlrev_b32 v27, 4, v58
    s_sub_u32 s38, 15, s16
    s_lshl_b32 s38, s38, 10
    s_lshl_b32 s39, s20, 9
    s_add_u32 s92, s38, s39
    v_add_u32 v27, s92, v27
    s_cmp_eq_u32 s19, 1
    s_cselect_b64 s[98:99], -1, 0
    s_waitcnt lgkmcnt(0)
    s_mul_i32 s93, s93, 1664525
    s_add_u32 s93, s93, 1013904223
    s_lshl_b32 s38, s20, 8
    s_add_u32 s38, s38, 32768
    v_lshl_add_u32 v193, v26, 4, s38
    s_lshl_b32 s39, s19, 11
    v_lshl_add_u32 v192, v25, 9, v193
    v_add_u32 v192, s39, v192
    v_lshlrev_b32 v194, 10, v25
    v_lshl_add_u32 v194, v26, 4, v194
    s_add_u32 s38, s92, 1024
    v_add_u32 v194, s38, v194
    v_sub_u32 v58, s16, v25
    v_mov_b32 v59, s93
    v_cmp_lt_i32 vcc, 0, v58
    s_nop 1
    v_cndmask_b32 v198, 0, v59, vcc
    v_cmp_lt_i32 vcc, 4, v58
    s_nop 1
    v_cndmask_b32 v199, 0, v59, vcc
    v_cmp_lt_i32 vcc, 8, v58
    s_nop 1
    v_cndmask_b32 v200, 0, v59, vcc
    v_cmp_lt_i32 vcc, 12, v58
    s_nop 1
    v_cndmask_b32 v201, 0, v59, vcc
    s_mul_i32 s38, s18, 9216
    s_add_u32 s38, s38, 36864
    v_mul_u32_u24 v195, 144, v26
    v_lshl_add_u32 v195, v25, 5, v195
    v_add_u32 v195, s38, v195
    v_bfe_u32 v196, v24, 2, 2
    v_lshl_add_u32 v196, v25, 3, v196
    v_mul_u32_u24 v196, 144, v196
    v_and_b32 v58, 3, v24
    v_lshl_add_u32 v196, v58, 3, v196
    v_add_u32 v196, s38, v196
    v_lshlrev_b32 v197, 4, v24
    s_lshl_b32 s38, s17, 6
    s_lshl_b32 s39, s19, 5
    s_add_u32 s38, s38, s39
    v_add_u32 v58, s38, v56
    v_lshl_add_u32 v58, v58, 11, v57
    v_xor_b32 v59, 64, v58
    v_add_u32 v202, 3072, v58
    v_add_u32 v203, 18432, v59
    v_add_u32 v204, 33792, v58
    v_add_u32 v205, 49152, v59
    s_and_b32 s55, s17, 7
    s_and_b32 s54, s17, 8
    s_lshl_b32 s48, s16, 19
    s_lshl_b32 s39, s17, 15
    s_add_u32 s53, s48, s39
    s_lshl_b32 s39, s20, 11
    s_add_u32 s53, s53, s39
    s_lshl_b32 s39, s19, 14
    s_add_u32 s53, s53, s39
    s_lshl_b32 s51, s16, 7
    s_lshl_b32 s38, s18, 5
    s_add_u32 s51, s51, s38
    s_lshl_b32 s57, s51, 3
    s_add_u32 s57, s57, 9453568
    s_lshl_b32 s56, s51, 11
    s_lshl_b32 s39, s17, 7
    s_add_u32 s56, s56, s39
    v_lshlrev_b32 v220, 11, v25
    v_lshl_add_u32 v220, v26, 3, v220
    v_and_b32 v221, 31, v24
    v_lshlrev_b32 v221, 3, v221
    v_lshl_add_u32 v222, v26, 3, s39
    s_not_b32 s39, s93
    v_mov_b32 v60, s39
    v_mov_b32 v61, s39
    v_mov_b32 v62, s39
    v_mov_b32 v63, s39
    v_lshlrev_b32 v59, 2, v24
    s_mul_hi_u32 s8, s2, 76695845
    s_mul_i32 s9, s8, 56
    s_sub_u32 s9, s2, s9
    s_lshl_b32 s10, s9, 10
    s_lshl_b32 s11, s8, 8
    s_add_u32 s10, s10, s11
    s_add_u32 s10, s10, 9568256
    s_lshl_b32 s11, s8, 14
    s_lshl_b32 s9, s9, 8
    s_add_u32 s11, s11, s9
    s_add_u32 s11, s11, 9633792
    s_lshl_b32 s9, s16, 12
    s_lshl_b32 s38, s17, 8
    s_add_u32 s9, s9, s38
    s_add_u32 s9, s9, 9502720
    s_cmp_ge_u32 s2, 224
    s_cselect_b32 s10, s9, s10
    s_cselect_b32 s11, s9, s11
    s_cmp_eq_u32 s18, 1
    s_cselect_b32 s9, s10, s9
    s_cmp_eq_u32 s18, 3
    s_cselect_b32 s9, s11, s9
    s_mov_b32 exec_hi, 0
    buffer_store_dword v60, v59, s[12:15], s9 offen sc1
    buffer_store_dwordx4 v[60:63], v27, s[24:27], 0 offen sc1
    s_mov_b32 exec_hi, -1
    s_lshl_b32 s39, s18, 13
    s_add_u32 s39, s39, 65536
    v_and_b32 v4, 7, v24
    v_lshlrev_b32 v4, 9, v4
    v_bfe_u32 v5, v24, 3, 1
    v_lshl_add_u32 v4, v5, 6, v4
    v_lshl_add_u32 v4, v25, 4, v4
    v_add_u32 v4, s39, v4
    v_and_b32 v7, 1, v24
    v_lshlrev_b32 v5, 9, v7
    v_bfe_u32 v6, v24, 1, 1
    v_lshl_add_u32 v5, v6, 6, v5
    v_lshl_add_u32 v5, v25, 4, v5
    v_add_u32 v5, s39, v5
    v_lshrrev_b32 v6, 1, v25
    v_lshlrev_b32 v6, 6, v6
    v_lshl_add_u32 v6, v7, 5, v6
    v_and_b32 v7, 1, v25
    v_lshl_add_u32 v6, v7, 4, v6
    s_lshl_b32 s39, s18, 7
    s_add_u32 s39, s39, 97792
    v_add_u32 v6, s39, v6
    s_waitcnt vmcnt(9)
    v_lshlrev_b32 v224, 16, v224
    v_lshlrev_b32 v225, 16, v225
    v_lshlrev_b32 v226, 16, v226
    v_lshlrev_b32 v227, 16, v227
    v_lshlrev_b32 v228, 16, v228
    v_lshlrev_b32 v229, 16, v229
    v_mul_f32 v230, 1069066811, v228
    v_mul_f32 v231, 1069066811, v229
    v_exp_f32 v230, v230
    v_exp_f32 v231, v231
    s_nop 0
    v_cvt_pk_bf16_f32 v230, v230, v230
    v_lshlrev_b32 v230, 16, v230
    v_cvt_pk_bf16_f32 v231, v231, v231
    v_lshlrev_b32 v231, 16, v231
    v_pk_mul_f32 v[232:233], v[230:231], v[224:225] op_sel:[0,0] op_sel_hi:[1,1]
    v_pk_mul_f32 v[234:235], v[230:231], v[226:227] op_sel:[0,0] op_sel_hi:[1,1]
    v_mul_f32 v232, 1069066811, v232
    v_mul_f32 v234, 1042479491, v234
    v_mul_f32 v233, 1069066811, v233
    v_mul_f32 v235, 1042479491, v235
    v_exp_f32 v232, v232
    v_rndne_f32 v236, v234
    v_exp_f32 v233, v233
    v_rndne_f32 v237, v235
    v_sub_f32 v234, v234, v236
    v_sub_f32 v235, v235, v237
    v_cos_f32 v236, v234
    v_sin_f32 v238, v234
    v_cos_f32 v237, v235
    v_sin_f32 v239, v235
    v_pk_mul_f32 v[240:241], v[224:225], v[224:225] op_sel:[0,0] op_sel_hi:[1,1]
    v_pk_fma_f32 v[240:241], v[226:227], v[226:227], v[240:241] op_sel:[0,0,0] op_sel_hi:[1,1,1]
    v_pk_mul_f32 v[28:29], v[232:233], v[236:237] op_sel:[0,0] op_sel_hi:[1,1]
    v_pk_mul_f32 v[30:31], v[232:233], v[238:239] op_sel:[0,0] op_sel_hi:[1,1]
    v_rcp_f32 v240, v240
    v_rcp_f32 v241, v241
    v_add_f32 v230, -1.0, v28
    v_add_f32 v231, -1.0, v29
    v_pk_add_f32 v[240:241], v[240:241], v[240:241]
    v_pk_mul_f32 v[232:233], v[230:231], v[224:225] op_sel:[0,0] op_sel_hi:[1,1]
    v_pk_fma_f32 v[232:233], v[30:31], v[226:227], v[232:233] op_sel:[0,0,0] op_sel_hi:[1,1,1]
    v_pk_mul_f32 v[234:235], v[30:31], v[224:225] op_sel:[0,0] op_sel_hi:[1,1]
    v_pk_fma_f32 v[234:235], v[230:231], v[226:227], v[234:235] op_sel:[0,0,0] op_sel_hi:[1,1,1] neg_lo:[1,0,0] neg_hi:[1,0,0]
    v_pk_mul_f32 v[32:33], v[232:233], v[240:241] op_sel:[0,0] op_sel_hi:[1,1]
    v_pk_mul_f32 v[34:35], v[234:235], v[240:241] op_sel:[0,0] op_sel_hi:[1,1]
    v_pk_mul_f32 v[224:225], v[28:29], v[28:29] op_sel:[0,0] op_sel_hi:[1,1]
    v_pk_mul_f32 v[226:227], v[28:29], v[30:31] op_sel:[0,0] op_sel_hi:[1,1]
    v_pk_fma_f32 v[224:225], v[30:31], v[30:31], v[224:225] op_sel:[0,0,0] op_sel_hi:[1,1,1] neg_lo:[1,0,0] neg_hi:[1,0,0]
    v_pk_add_f32 v[226:227], v[226:227], v[226:227]
    v_pk_mul_f32 v[228:229], v[224:225], v[224:225] op_sel:[0,0] op_sel_hi:[1,1]
    v_pk_mul_f32 v[230:231], v[224:225], v[226:227] op_sel:[0,0] op_sel_hi:[1,1]
    v_pk_fma_f32 v[228:229], v[226:227], v[226:227], v[228:229] op_sel:[0,0,0] op_sel_hi:[1,1,1] neg_lo:[1,0,0] neg_hi:[1,0,0]
    v_pk_add_f32 v[230:231], v[230:231], v[230:231]
    v_pk_mul_f32 v[36:37], v[228:229], v[228:229] op_sel:[0,0] op_sel_hi:[1,1]
    v_pk_mul_f32 v[38:39], v[228:229], v[230:231] op_sel:[0,0] op_sel_hi:[1,1]
    v_pk_fma_f32 v[36:37], v[230:231], v[230:231], v[36:37] op_sel:[0,0,0] op_sel_hi:[1,1,1] neg_lo:[1,0,0] neg_hi:[1,0,0]
    v_pk_add_f32 v[38:39], v[38:39], v[38:39]
    v_pk_mul_f32 v[40:41], v[36:37], v[36:37] op_sel:[0,0] op_sel_hi:[1,1]
    v_pk_mul_f32 v[42:43], v[36:37], v[38:39] op_sel:[0,0] op_sel_hi:[1,1]
    v_pk_fma_f32 v[40:41], v[38:39], v[38:39], v[40:41] op_sel:[0,0,0] op_sel_hi:[1,1,1] neg_lo:[1,0,0] neg_hi:[1,0,0]
    v_pk_add_f32 v[42:43], v[42:43], v[42:43]
    v_pk_mul_f32 v[224:225], v[40:41], v[40:41] op_sel:[0,0] op_sel_hi:[1,1]
    v_pk_mul_f32 v[226:227], v[40:41], v[42:43] op_sel:[0,0] op_sel_hi:[1,1]
    v_pk_fma_f32 v[224:225], v[42:43], v[42:43], v[224:225] op_sel:[0,0,0] op_sel_hi:[1,1,1] neg_lo:[1,0,0] neg_hi:[1,0,0]
    v_pk_add_f32 v[226:227], v[226:227], v[226:227]
    v_pk_mul_f32 v[228:229], v[224:225], v[224:225] op_sel:[0,0] op_sel_hi:[1,1]
    v_pk_mul_f32 v[230:231], v[224:225], v[226:227] op_sel:[0,0] op_sel_hi:[1,1]
    v_pk_fma_f32 v[228:229], v[226:227], v[226:227], v[228:229] op_sel:[0,0,0] op_sel_hi:[1,1,1] neg_lo:[1,0,0] neg_hi:[1,0,0]
    v_pk_add_f32 v[230:231], v[230:231], v[230:231]
    v_and_b32 v240, 1, v25
    v_cmp_eq_u32 s[84:85], 1, v240
    v_cmp_lt_u32 s[86:87], 1, v25
    s_nop 0
    v_cndmask_b32 v232, 1.0, v40, s[84:85]
    v_cndmask_b32 v234, 0, v42, s[84:85]
    v_cndmask_b32 v233, 1.0, v41, s[84:85]
    v_cndmask_b32 v235, 0, v43, s[84:85]
    v_cndmask_b32 v236, 1.0, v224, s[86:87]
    v_cndmask_b32 v238, 0, v226, s[86:87]
    v_cndmask_b32 v237, 1.0, v225, s[86:87]
    v_cndmask_b32 v239, 0, v227, s[86:87]
    v_pk_mul_f32 v[242:243], v[232:233], v[236:237] op_sel:[0,0] op_sel_hi:[1,1]
    v_pk_mul_f32 v[244:245], v[232:233], v[238:239] op_sel:[0,0] op_sel_hi:[1,1]
    v_pk_fma_f32 v[242:243], v[234:235], v[238:239], v[242:243] op_sel:[0,0,0] op_sel_hi:[1,1,1] neg_lo:[1,0,0] neg_hi:[1,0,0]
    v_pk_fma_f32 v[244:245], v[234:235], v[236:237], v[244:245] op_sel:[0,0,0] op_sel_hi:[1,1,1]
    v_cndmask_b32 v232, 1.0, v228, s[98:99]
    v_cndmask_b32 v234, 0, v230, s[98:99]
    v_cndmask_b32 v233, 1.0, v229, s[98:99]
    v_cndmask_b32 v235, 0, v231, s[98:99]
    v_pk_mul_f32 v[52:53], v[242:243], v[232:233] op_sel:[0,0] op_sel_hi:[1,1]
    v_pk_mul_f32 v[54:55], v[242:243], v[234:235] op_sel:[0,0] op_sel_hi:[1,1]
    v_pk_fma_f32 v[52:53], v[244:245], v[234:235], v[52:53] op_sel:[0,0,0] op_sel_hi:[1,1,1] neg_lo:[1,0,0] neg_hi:[1,0,0]
    v_pk_fma_f32 v[54:55], v[244:245], v[232:233], v[54:55] op_sel:[0,0,0] op_sel_hi:[1,1,1]
    v_pk_mul_f32 v[224:225], v[228:229], v[228:229] op_sel:[0,0] op_sel_hi:[1,1]
    v_pk_mul_f32 v[226:227], v[228:229], v[230:231] op_sel:[0,0] op_sel_hi:[1,1]
    v_pk_fma_f32 v[224:225], v[230:231], v[230:231], v[224:225] op_sel:[0,0,0] op_sel_hi:[1,1,1] neg_lo:[1,0,0] neg_hi:[1,0,0]
    v_pk_add_f32 v[226:227], v[226:227], v[226:227]
    v_pk_mul_f32 v[228:229], v[224:225], v[224:225] op_sel:[0,0] op_sel_hi:[1,1]
    v_pk_mul_f32 v[230:231], v[224:225], v[226:227] op_sel:[0,0] op_sel_hi:[1,1]
    v_pk_fma_f32 v[228:229], v[226:227], v[226:227], v[228:229] op_sel:[0,0,0] op_sel_hi:[1,1,1] neg_lo:[1,0,0] neg_hi:[1,0,0]
    v_pk_add_f32 v[230:231], v[230:231], v[230:231]
    v_pk_mul_f32 v[44:45], v[228:229], v[228:229] op_sel:[0,0] op_sel_hi:[1,1]
    v_pk_mul_f32 v[46:47], v[228:229], v[230:231] op_sel:[0,0] op_sel_hi:[1,1]
    v_pk_fma_f32 v[44:45], v[230:231], v[230:231], v[44:45] op_sel:[0,0,0] op_sel_hi:[1,1,1] neg_lo:[1,0,0] neg_hi:[1,0,0]
    v_pk_add_f32 v[46:47], v[46:47], v[46:47]
    v_cndmask_b32 v232, 1.0, v224, s[84:85]
    v_cndmask_b32 v234, 0, v226, s[84:85]
    v_cndmask_b32 v233, 1.0, v225, s[84:85]
    v_cndmask_b32 v235, 0, v227, s[84:85]
    v_cndmask_b32 v236, 1.0, v228, s[86:87]
    v_cndmask_b32 v238, 0, v230, s[86:87]
    v_cndmask_b32 v237, 1.0, v229, s[86:87]
    v_cndmask_b32 v239, 0, v231, s[86:87]
    v_pk_mul_f32 v[48:49], v[232:233], v[236:237] op_sel:[0,0] op_sel_hi:[1,1]
    v_pk_mul_f32 v[50:51], v[232:233], v[238:239] op_sel:[0,0] op_sel_hi:[1,1]
    v_pk_fma_f32 v[48:49], v[234:235], v[238:239], v[48:49] op_sel:[0,0,0] op_sel_hi:[1,1,1] neg_lo:[1,0,0] neg_hi:[1,0,0]
    v_pk_fma_f32 v[50:51], v[234:235], v[236:237], v[50:51] op_sel:[0,0,0] op_sel_hi:[1,1,1]
    v_mov_b32 v224, v52
    v_mov_b32 v226, v54
    v_mul_f32 v225, v36, v52
    v_mul_f32 v227, v36, v54
    v_fma_f32 v225, -v38, v54, v225
    v_fma_f32 v227, v38, v52, v227
    v_pk_mul_f32 v[206:207], v[32:33], v[224:225] op_sel:[0,0] op_sel_hi:[0,1]
    v_pk_mul_f32 v[208:209], v[32:33], v[226:227] op_sel:[0,0] op_sel_hi:[0,1]
    v_pk_fma_f32 v[206:207], v[34:35], v[226:227], v[206:207] op_sel:[0,0,0] op_sel_hi:[0,1,1] neg_lo:[1,0,0] neg_hi:[1,0,0]
    v_pk_fma_f32 v[208:209], v[34:35], v[224:225], v[208:209] op_sel:[0,0,0] op_sel_hi:[0,1,1]
    v_mov_b32 v224, v53
    v_mov_b32 v226, v55
    v_mul_f32 v225, v37, v53
    v_mul_f32 v227, v37, v55
    v_fma_f32 v225, -v39, v55, v225
    v_fma_f32 v227, v39, v53, v227
    v_pk_mul_f32 v[210:211], v[32:33], v[224:225] op_sel:[1,0] op_sel_hi:[1,1]
    v_pk_mul_f32 v[212:213], v[32:33], v[226:227] op_sel:[1,0] op_sel_hi:[1,1]
    v_pk_fma_f32 v[210:211], v[34:35], v[226:227], v[210:211] op_sel:[1,0,0] op_sel_hi:[1,1,1] neg_lo:[1,0,0] neg_hi:[1,0,0]
    v_pk_fma_f32 v[212:213], v[34:35], v[224:225], v[212:213] op_sel:[1,0,0] op_sel_hi:[1,1,1]
    s_waitcnt vmcnt(4)
    ds_read_b128 v[224:227], v4 offset:0
    ds_read_b128 v[240:243], v5 offset:4096
    ds_read_b128 v[228:231], v4 offset:128
    ds_read_b128 v[244:247], v5 offset:4224
    ds_read_b128 v[232:235], v4 offset:256
    ds_read_b128 v[248:251], v5 offset:4352
    ds_read_b128 v[236:239], v4 offset:384
    ds_read_b128 v[252:255], v5 offset:4480
    s_waitcnt lgkmcnt(0)
    v_mfma_f32_16x16x32_bf16 v[12:15], v[224:227], v[240:243], 0
    v_mfma_f32_16x16x32_bf16 v[12:15], v[228:231], v[244:247], v[12:15]
    v_mfma_f32_16x16x32_bf16 v[12:15], v[232:235], v[248:251], v[12:15]
    v_mfma_f32_16x16x32_bf16 v[12:15], v[236:239], v[252:255], v[12:15]
    s_lshl_b32 s39, s18, 2
    s_add_u32 s39, s39, 97776
    v_mov_b32 v4, s39
    v_mov_b32 v5, s93
    v_mov_b32 v7, 97776
    s_nop 3
    s_mov_b32 exec_lo, 0x00030003
    s_mov_b32 exec_hi, 0x000c000c
    ds_write_b128 v6, v[12:15]
    s_mov_b64 exec, -1
    ds_write_b32 v4, v5
    v_lshl_add_u32 v6, v26, 2, v7
    v_and_b32 v138, 7, v24
    s_lshl_b32 s38, s3, 8
    s_lshr_b32 s39, s2, 3
    s_lshl_b32 s39, s39, 3
    s_add_u32 s8, s38, s39
    s_sub_u32 s38, 2047, s8
    v_sub_u32 v139, s38, v138
    v_lshlrev_b32 v138, 3, v138
    v_bfe_u32 v140, v24, 3, 1
    v_lshl_add_u32 v138, v140, 14, v138
    s_lshl_b32 s8, s8, 3
    s_add_u32 s8, s8, 9437184
    s_mov_b32 s9, 0xffff0000
    s_cmp_lg_u32 s18, 0
    s_cbranch_scc1 L_nokey
L_rgw:
    ds_read_b128 v[144:147], v7
    ds_read_b32 v128, v6 offset:16
    ds_read_b32 v129, v6 offset:80
    ds_read_b32 v130, v6 offset:144
    ds_read_b32 v131, v6 offset:208
    ds_read_b32 v132, v6 offset:272
    ds_read_b32 v133, v6 offset:336
    ds_read_b32 v134, v6 offset:400
    ds_read_b32 v135, v6 offset:464
    s_waitcnt lgkmcnt(0)
    v_xor_b32 v144, s93, v144
    v_xor_b32 v145, s93, v145
    v_xor_b32 v146, s93, v146
    v_xor_b32 v147, s93, v147
    v_or3_b32 v144, v144, v145, v146
    v_or_b32 v144, v144, v147
    v_cmp_ne_u32 vcc, 0, v144
    s_nop 1
    s_cmp_eq_u64 vcc, 0
    s_cbranch_scc1 L_rgo
    s_sub_u32 s96, s96, 1
    s_cbranch_scc1 L_rgo
    s_branch L_rgw
L_rgo:
    v_not_b32 v144, s93
    v_not_b32 v145, s93
    v_not_b32 v146, s93
    v_not_b32 v147, s93
    ds_write_b128 v7, v[144:147]
    v_pk_add_f32 v[128:129], v[128:129], v[130:131]
    v_pk_add_f32 v[132:133], v[132:133], v[134:135]
    v_pk_add_f32 v[128:129], v[128:129], v[132:133]
    v_add_f32 v128, v128, v129
    v_cvt_pk_bf16_f32 v128, v128, v128
    v_lshlrev_b32 v128, 16, v128
    v_mul_f32 v130, 0xbfb8aa3b, v128
    v_exp_f32 v130, v130
    s_nop 0
    v_add_f32 v130, 1.0, v130
    v_rcp_f32 v130, v130
    s_nop 0
    v_cvt_pk_bf16_f32 v130, v130, v130
    v_lshlrev_b32 v130, 16, v130
    v_cmp_eq_u32 vcc, 1, v140
    v_ashrrev_i32 v129, 31, v128
    v_or_b32 v129, 0x80000000, v129
    v_xor_b32 v128, v128, v129
    v_and_or_b32 v128, v128, s9, v139
    v_cndmask_b32 v4, v128, v130, vcc
L_nokey:
    s_waitcnt lgkmcnt(0)
    s_barrier
    s_cmp_lg_u32 s18, 0
    s_cbranch_scc1 L_nokey2
    s_mov_b64 exec, 0xffff
    buffer_store_dwordx2 v[4:5], v138, s[12:15], s8 offen sc1
    s_mov_b64 exec, -1
L_nokey2:
    ds_read_b128 v[128:131], v16 offset:0
    ds_read_b128 v[144:147], v18 offset:16384
    ds_read_b128 v[148:151], v18 offset:18432
    ds_read_b128 v[152:155], v18 offset:20480
    ds_read_b128 v[156:159], v18 offset:22528
    ds_read_b128 v[132:135], v16 offset:2048
    ds_read_b128 v[136:139], v16 offset:4096
    ds_read_b128 v[140:143], v16 offset:6144
    s_waitcnt lgkmcnt(0)
    v_mfma_f32_16x16x32_bf16 v[64:67], v[128:131], v[144:147], 0
    ds_read_b128 v[160:163], v17 offset:0
    v_mfma_f32_16x16x32_bf16 v[68:71], v[128:131], v[148:151], 0
    ds_read_b128 v[176:179], v19 offset:16384
    v_mfma_f32_16x16x32_bf16 v[72:75], v[128:131], v[152:155], 0
    v_mfma_f32_16x16x32_bf16 v[76:79], v[128:131], v[156:159], 0
    ds_read_b128 v[180:183], v19 offset:18432
    v_mfma_f32_16x16x32_bf16 v[80:83], v[132:135], v[144:147], 0
    ds_read_b128 v[184:187], v19 offset:20480
    v_mfma_f32_16x16x32_bf16 v[84:87], v[132:135], v[148:151], 0
    v_mfma_f32_16x16x32_bf16 v[88:91], v[132:135], v[152:155], 0
    ds_read_b128 v[188:191], v19 offset:22528
    v_mfma_f32_16x16x32_bf16 v[92:95], v[132:135], v[156:159], 0
    ds_read_b128 v[164:167], v17 offset:2048
    v_mfma_f32_16x16x32_bf16 v[96:99], v[136:139], v[144:147], 0
    v_mfma_f32_16x16x32_bf16 v[100:103], v[136:139], v[148:151], 0
    ds_read_b128 v[168:171], v17 offset:4096
    v_mfma_f32_16x16x32_bf16 v[104:107], v[136:139], v[152:155], 0
    ds_read_b128 v[172:175], v17 offset:6144
    v_mfma_f32_16x16x32_bf16 v[108:111], v[136:139], v[156:159], 0
    v_mfma_f32_16x16x32_bf16 v[112:115], v[140:143], v[144:147], 0
    v_mfma_f32_16x16x32_bf16 v[116:119], v[140:143], v[148:151], 0
    v_mfma_f32_16x16x32_bf16 v[120:123], v[140:143], v[152:155], 0
    v_mfma_f32_16x16x32_bf16 v[124:127], v[140:143], v[156:159], 0
    s_waitcnt lgkmcnt(0)
    s_barrier
    v_mfma_f32_16x16x32_bf16 v[64:67], v[160:163], v[176:179], v[64:67]
    ds_read_b128 v[128:131], v16 offset:32768
    v_mfma_f32_16x16x32_bf16 v[68:71], v[160:163], v[180:183], v[68:71]
    ds_read_b128 v[144:147], v18 offset:49152
    v_mfma_f32_16x16x32_bf16 v[72:75], v[160:163], v[184:187], v[72:75]
    v_mfma_f32_16x16x32_bf16 v[76:79], v[160:163], v[188:191], v[76:79]
    ds_read_b128 v[148:151], v18 offset:51200
    v_mfma_f32_16x16x32_bf16 v[80:83], v[164:167], v[176:179], v[80:83]
    ds_read_b128 v[152:155], v18 offset:53248
    v_mfma_f32_16x16x32_bf16 v[84:87], v[164:167], v[180:183], v[84:87]
    v_mfma_f32_16x16x32_bf16 v[88:91], v[164:167], v[184:187], v[88:91]
    ds_read_b128 v[156:159], v18 offset:55296
    v_mfma_f32_16x16x32_bf16 v[92:95], v[164:167], v[188:191], v[92:95]
    ds_read_b128 v[132:135], v16 offset:34816
    v_mfma_f32_16x16x32_bf16 v[96:99], v[168:171], v[176:179], v[96:99]
    v_mfma_f32_16x16x32_bf16 v[100:103], v[168:171], v[180:183], v[100:103]
    ds_read_b128 v[136:139], v16 offset:36864
    v_mfma_f32_16x16x32_bf16 v[104:107], v[168:171], v[184:187], v[104:107]
    ds_read_b128 v[140:143], v16 offset:38912
    v_mfma_f32_16x16x32_bf16 v[108:111], v[168:171], v[188:191], v[108:111]
    v_mfma_f32_16x16x32_bf16 v[112:115], v[172:175], v[176:179], v[112:115]
    v_mfma_f32_16x16x32_bf16 v[116:119], v[172:175], v[180:183], v[116:119]
    v_mfma_f32_16x16x32_bf16 v[120:123], v[172:175], v[184:187], v[120:123]
    v_mfma_f32_16x16x32_bf16 v[124:127], v[172:175], v[188:191], v[124:127]
    s_waitcnt lgkmcnt(0)
    v_mfma_f32_16x16x32_bf16 v[64:67], v[128:131], v[144:147], v[64:67]
    ds_read_b128 v[160:163], v17 offset:32768
    v_mfma_f32_16x16x32_bf16 v[68:71], v[128:131], v[148:151], v[68:71]
    ds_read_b128 v[176:179], v19 offset:49152
    v_mfma_f32_16x16x32_bf16 v[72:75], v[128:131], v[152:155], v[72:75]
    v_mfma_f32_16x16x32_bf16 v[76:79], v[128:131], v[156:159], v[76:79]
    ds_read_b128 v[180:183], v19 offset:51200
    v_mfma_f32_16x16x32_bf16 v[80:83], v[132:135], v[144:147], v[80:83]
    ds_read_b128 v[184:187], v19 offset:53248
    v_mfma_f32_16x16x32_bf16 v[84:87], v[132:135], v[148:151], v[84:87]
    v_mfma_f32_16x16x32_bf16 v[88:91], v[132:135], v[152:155], v[88:91]
    ds_read_b128 v[188:191], v19 offset:55296
    v_mfma_f32_16x16x32_bf16 v[92:95], v[132:135], v[156:159], v[92:95]
    ds_read_b128 v[164:167], v17 offset:34816
    v_mfma_f32_16x16x32_bf16 v[96:99], v[136:139], v[144:147], v[96:99]
    v_mfma_f32_16x16x32_bf16 v[100:103], v[136:139], v[148:151], v[100:103]
    ds_read_b128 v[168:171], v17 offset:36864
    v_mfma_f32_16x16x32_bf16 v[104:107], v[136:139], v[152:155], v[104:107]
    ds_read_b128 v[172:175], v17 offset:38912
    v_mfma_f32_16x16x32_bf16 v[108:111], v[136:139], v[156:159], v[108:111]
    v_mfma_f32_16x16x32_bf16 v[112:115], v[140:143], v[144:147], v[112:115]
    v_mfma_f32_16x16x32_bf16 v[116:119], v[140:143], v[148:151], v[116:119]
    v_mfma_f32_16x16x32_bf16 v[120:123], v[140:143], v[152:155], v[120:123]
    v_mfma_f32_16x16x32_bf16 v[124:127], v[140:143], v[156:159], v[124:127]
    s_waitcnt lgkmcnt(0)
    s_barrier
    v_mfma_f32_16x16x32_bf16 v[64:67], v[160:163], v[176:179], v[64:67]
    ds_read_b128 v[128:131], v20 offset:0
    v_mfma_f32_16x16x32_bf16 v[68:71], v[160:163], v[180:183], v[68:71]
    ds_read_b128 v[144:147], v22 offset:16384
    v_mfma_f32_16x16x32_bf16 v[72:75], v[160:163], v[184:187], v[72:75]
    v_mfma_f32_16x16x32_bf16 v[76:79], v[160:163], v[188:191], v[76:79]
    ds_read_b128 v[148:151], v22 offset:18432
    v_mfma_f32_16x16x32_bf16 v[80:83], v[164:167], v[176:179], v[80:83]
    ds_read_b128 v[152:155], v22 offset:20480
    v_mfma_f32_16x16x32_bf16 v[84:87], v[164:167], v[180:183], v[84:87]
    v_mfma_f32_16x16x32_bf16 v[88:91], v[164:167], v[184:187], v[88:91]
    ds_read_b128 v[156:159], v22 offset:22528
    v_mfma_f32_16x16x32_bf16 v[92:95], v[164:167], v[188:191], v[92:95]
    ds_read_b128 v[132:135], v20 offset:2048
    v_mfma_f32_16x16x32_bf16 v[96:99], v[168:171], v[176:179], v[96:99]
    v_mfma_f32_16x16x32_bf16 v[100:103], v[168:171], v[180:183], v[100:103]
    ds_read_b128 v[136:139], v20 offset:4096
    v_mfma_f32_16x16x32_bf16 v[104:107], v[168:171], v[184:187], v[104:107]
    ds_read_b128 v[140:143], v20 offset:6144
    v_mfma_f32_16x16x32_bf16 v[108:111], v[168:171], v[188:191], v[108:111]
    v_mfma_f32_16x16x32_bf16 v[112:115], v[172:175], v[176:179], v[112:115]
    v_mfma_f32_16x16x32_bf16 v[116:119], v[172:175], v[180:183], v[116:119]
    v_mfma_f32_16x16x32_bf16 v[120:123], v[172:175], v[184:187], v[120:123]
    v_mfma_f32_16x16x32_bf16 v[124:127], v[172:175], v[188:191], v[124:127]
    s_waitcnt lgkmcnt(0)
    v_mfma_f32_16x16x32_bf16 v[64:67], v[128:131], v[144:147], v[64:67]
    ds_read_b128 v[160:163], v21 offset:0
    v_mfma_f32_16x16x32_bf16 v[68:71], v[128:131], v[148:151], v[68:71]
    ds_read_b128 v[176:179], v23 offset:16384
    v_mfma_f32_16x16x32_bf16 v[72:75], v[128:131], v[152:155], v[72:75]
    v_mfma_f32_16x16x32_bf16 v[76:79], v[128:131], v[156:159], v[76:79]
    ds_read_b128 v[180:183], v23 offset:18432
    v_mfma_f32_16x16x32_bf16 v[80:83], v[132:135], v[144:147], v[80:83]
    ds_read_b128 v[184:187], v23 offset:20480
    v_mfma_f32_16x16x32_bf16 v[84:87], v[132:135], v[148:151], v[84:87]
    v_mfma_f32_16x16x32_bf16 v[88:91], v[132:135], v[152:155], v[88:91]
    ds_read_b128 v[188:191], v23 offset:22528
    v_mfma_f32_16x16x32_bf16 v[92:95], v[132:135], v[156:159], v[92:95]
    ds_read_b128 v[164:167], v21 offset:2048
    v_mfma_f32_16x16x32_bf16 v[96:99], v[136:139], v[144:147], v[96:99]
    v_mfma_f32_16x16x32_bf16 v[100:103], v[136:139], v[148:151], v[100:103]
    ds_read_b128 v[168:171], v21 offset:4096
    v_mfma_f32_16x16x32_bf16 v[104:107], v[136:139], v[152:155], v[104:107]
    ds_read_b128 v[172:175], v21 offset:6144
    v_mfma_f32_16x16x32_bf16 v[108:111], v[136:139], v[156:159], v[108:111]
    v_mfma_f32_16x16x32_bf16 v[112:115], v[140:143], v[144:147], v[112:115]
    v_mfma_f32_16x16x32_bf16 v[116:119], v[140:143], v[148:151], v[116:119]
    v_mfma_f32_16x16x32_bf16 v[120:123], v[140:143], v[152:155], v[120:123]
    v_mfma_f32_16x16x32_bf16 v[124:127], v[140:143], v[156:159], v[124:127]
    s_waitcnt lgkmcnt(0)
    s_barrier
    v_mfma_f32_16x16x32_bf16 v[64:67], v[160:163], v[176:179], v[64:67]
    ds_read_b128 v[128:131], v16 offset:0
    v_mfma_f32_16x16x32_bf16 v[68:71], v[160:163], v[180:183], v[68:71]
    ds_read_b128 v[144:147], v18 offset:16384
    v_mfma_f32_16x16x32_bf16 v[72:75], v[160:163], v[184:187], v[72:75]
    v_mfma_f32_16x16x32_bf16 v[76:79], v[160:163], v[188:191], v[76:79]
    ds_read_b128 v[148:151], v18 offset:18432
    v_mfma_f32_16x16x32_bf16 v[80:83], v[164:167], v[176:179], v[80:83]
    ds_read_b128 v[152:155], v18 offset:20480
    v_mfma_f32_16x16x32_bf16 v[84:87], v[164:167], v[180:183], v[84:87]
    v_mfma_f32_16x16x32_bf16 v[88:91], v[164:167], v[184:187], v[88:91]
    ds_read_b128 v[156:159], v18 offset:22528
    v_mfma_f32_16x16x32_bf16 v[92:95], v[164:167], v[188:191], v[92:95]
    ds_read_b128 v[132:135], v16 offset:2048
    v_mfma_f32_16x16x32_bf16 v[96:99], v[168:171], v[176:179], v[96:99]
    v_mfma_f32_16x16x32_bf16 v[100:103], v[168:171], v[180:183], v[100:103]
    ds_read_b128 v[136:139], v16 offset:4096
    v_mfma_f32_16x16x32_bf16 v[104:107], v[168:171], v[184:187], v[104:107]
    ds_read_b128 v[140:143], v16 offset:6144
    v_mfma_f32_16x16x32_bf16 v[108:111], v[168:171], v[188:191], v[108:111]
    v_mfma_f32_16x16x32_bf16 v[112:115], v[172:175], v[176:179], v[112:115]
    v_mfma_f32_16x16x32_bf16 v[116:119], v[172:175], v[180:183], v[116:119]
    v_mfma_f32_16x16x32_bf16 v[120:123], v[172:175], v[184:187], v[120:123]
    v_mfma_f32_16x16x32_bf16 v[124:127], v[172:175], v[188:191], v[124:127]
    s_waitcnt lgkmcnt(0)
    v_mfma_f32_16x16x32_bf16 v[64:67], v[128:131], v[144:147], v[64:67]
    ds_read_b128 v[160:163], v17 offset:0
    v_mfma_f32_16x16x32_bf16 v[68:71], v[128:131], v[148:151], v[68:71]
    ds_read_b128 v[176:179], v19 offset:16384
    v_mfma_f32_16x16x32_bf16 v[72:75], v[128:131], v[152:155], v[72:75]
    v_mfma_f32_16x16x32_bf16 v[76:79], v[128:131], v[156:159], v[76:79]
    ds_read_b128 v[180:183], v19 offset:18432
    v_mfma_f32_16x16x32_bf16 v[80:83], v[132:135], v[144:147], v[80:83]
    ds_read_b128 v[184:187], v19 offset:20480
    v_mfma_f32_16x16x32_bf16 v[84:87], v[132:135], v[148:151], v[84:87]
    v_mfma_f32_16x16x32_bf16 v[88:91], v[132:135], v[152:155], v[88:91]
    ds_read_b128 v[188:191], v19 offset:22528
    v_mfma_f32_16x16x32_bf16 v[92:95], v[132:135], v[156:159], v[92:95]
    ds_read_b128 v[164:167], v17 offset:2048
    v_mfma_f32_16x16x32_bf16 v[96:99], v[136:139], v[144:147], v[96:99]
    v_mfma_f32_16x16x32_bf16 v[100:103], v[136:139], v[148:151], v[100:103]
    ds_read_b128 v[168:171], v17 offset:4096
    v_mfma_f32_16x16x32_bf16 v[104:107], v[136:139], v[152:155], v[104:107]
    ds_read_b128 v[172:175], v17 offset:6144
    v_mfma_f32_16x16x32_bf16 v[108:111], v[136:139], v[156:159], v[108:111]
    v_mfma_f32_16x16x32_bf16 v[112:115], v[140:143], v[144:147], v[112:115]
    v_mfma_f32_16x16x32_bf16 v[116:119], v[140:143], v[148:151], v[116:119]
    v_mfma_f32_16x16x32_bf16 v[120:123], v[140:143], v[152:155], v[120:123]
    v_mfma_f32_16x16x32_bf16 v[124:127], v[140:143], v[156:159], v[124:127]
    s_waitcnt lgkmcnt(0)
    s_barrier
    v_mfma_f32_16x16x32_bf16 v[64:67], v[160:163], v[176:179], v[64:67]
    ds_read_b128 v[128:131], v16 offset:32768
    v_mfma_f32_16x16x32_bf16 v[68:71], v[160:163], v[180:183], v[68:71]
    ds_read_b128 v[144:147], v18 offset:49152
    v_mfma_f32_16x16x32_bf16 v[72:75], v[160:163], v[184:187], v[72:75]
    v_mfma_f32_16x16x32_bf16 v[76:79], v[160:163], v[188:191], v[76:79]
    ds_read_b128 v[148:151], v18 offset:51200
    v_mfma_f32_16x16x32_bf16 v[80:83], v[164:167], v[176:179], v[80:83]
    ds_read_b128 v[152:155], v18 offset:53248
    v_mfma_f32_16x16x32_bf16 v[84:87], v[164:167], v[180:183], v[84:87]
    v_mfma_f32_16x16x32_bf16 v[88:91], v[164:167], v[184:187], v[88:91]
    ds_read_b128 v[156:159], v18 offset:55296
    v_mfma_f32_16x16x32_bf16 v[92:95], v[164:167], v[188:191], v[92:95]
    ds_read_b128 v[132:135], v16 offset:34816
    v_mfma_f32_16x16x32_bf16 v[96:99], v[168:171], v[176:179], v[96:99]
    v_mfma_f32_16x16x32_bf16 v[100:103], v[168:171], v[180:183], v[100:103]
    ds_read_b128 v[136:139], v16 offset:36864
    v_mfma_f32_16x16x32_bf16 v[104:107], v[168:171], v[184:187], v[104:107]
    ds_read_b128 v[140:143], v16 offset:38912
    v_mfma_f32_16x16x32_bf16 v[108:111], v[168:171], v[188:191], v[108:111]
    v_mfma_f32_16x16x32_bf16 v[112:115], v[172:175], v[176:179], v[112:115]
    v_mfma_f32_16x16x32_bf16 v[116:119], v[172:175], v[180:183], v[116:119]
    v_mfma_f32_16x16x32_bf16 v[120:123], v[172:175], v[184:187], v[120:123]
    v_mfma_f32_16x16x32_bf16 v[124:127], v[172:175], v[188:191], v[124:127]
    s_waitcnt lgkmcnt(0)
    v_mfma_f32_16x16x32_bf16 v[64:67], v[128:131], v[144:147], v[64:67]
    ds_read_b128 v[160:163], v17 offset:32768
    v_mfma_f32_16x16x32_bf16 v[68:71], v[128:131], v[148:151], v[68:71]
    ds_read_b128 v[176:179], v19 offset:49152
    v_mfma_f32_16x16x32_bf16 v[72:75], v[128:131], v[152:155], v[72:75]
    v_mfma_f32_16x16x32_bf16 v[76:79], v[128:131], v[156:159], v[76:79]
    ds_read_b128 v[180:183], v19 offset:51200
    v_mfma_f32_16x16x32_bf16 v[80:83], v[132:135], v[144:147], v[80:83]
    ds_read_b128 v[184:187], v19 offset:53248
    v_mfma_f32_16x16x32_bf16 v[84:87], v[132:135], v[148:151], v[84:87]
    v_mfma_f32_16x16x32_bf16 v[88:91], v[132:135], v[152:155], v[88:91]
    ds_read_b128 v[188:191], v19 offset:55296
    v_mfma_f32_16x16x32_bf16 v[92:95], v[132:135], v[156:159], v[92:95]
    ds_read_b128 v[164:167], v17 offset:34816
    v_mfma_f32_16x16x32_bf16 v[96:99], v[136:139], v[144:147], v[96:99]
    v_mfma_f32_16x16x32_bf16 v[100:103], v[136:139], v[148:151], v[100:103]
    ds_read_b128 v[168:171], v17 offset:36864
    v_mfma_f32_16x16x32_bf16 v[104:107], v[136:139], v[152:155], v[104:107]
    ds_read_b128 v[172:175], v17 offset:38912
    v_mfma_f32_16x16x32_bf16 v[108:111], v[136:139], v[156:159], v[108:111]
    v_mfma_f32_16x16x32_bf16 v[112:115], v[140:143], v[144:147], v[112:115]
    v_mfma_f32_16x16x32_bf16 v[116:119], v[140:143], v[148:151], v[116:119]
    v_mfma_f32_16x16x32_bf16 v[120:123], v[140:143], v[152:155], v[120:123]
    v_mfma_f32_16x16x32_bf16 v[124:127], v[140:143], v[156:159], v[124:127]
    s_waitcnt lgkmcnt(0)
    s_barrier
    v_mfma_f32_16x16x32_bf16 v[64:67], v[160:163], v[176:179], v[64:67]
    ds_read_b128 v[128:131], v20 offset:0
    v_mfma_f32_16x16x32_bf16 v[68:71], v[160:163], v[180:183], v[68:71]
    ds_read_b128 v[144:147], v22 offset:16384
    v_mfma_f32_16x16x32_bf16 v[72:75], v[160:163], v[184:187], v[72:75]
    v_mfma_f32_16x16x32_bf16 v[76:79], v[160:163], v[188:191], v[76:79]
    ds_read_b128 v[148:151], v22 offset:18432
    v_mfma_f32_16x16x32_bf16 v[80:83], v[164:167], v[176:179], v[80:83]
    ds_read_b128 v[152:155], v22 offset:20480
    v_mfma_f32_16x16x32_bf16 v[84:87], v[164:167], v[180:183], v[84:87]
    v_mfma_f32_16x16x32_bf16 v[88:91], v[164:167], v[184:187], v[88:91]
    ds_read_b128 v[156:159], v22 offset:22528
    v_mfma_f32_16x16x32_bf16 v[92:95], v[164:167], v[188:191], v[92:95]
    ds_read_b128 v[132:135], v20 offset:2048
    v_mfma_f32_16x16x32_bf16 v[96:99], v[168:171], v[176:179], v[96:99]
    v_mfma_f32_16x16x32_bf16 v[100:103], v[168:171], v[180:183], v[100:103]
    ds_read_b128 v[136:139], v20 offset:4096
    v_mfma_f32_16x16x32_bf16 v[104:107], v[168:171], v[184:187], v[104:107]
    ds_read_b128 v[140:143], v20 offset:6144
    v_mfma_f32_16x16x32_bf16 v[108:111], v[168:171], v[188:191], v[108:111]
    v_mfma_f32_16x16x32_bf16 v[112:115], v[172:175], v[176:179], v[112:115]
    v_mfma_f32_16x16x32_bf16 v[116:119], v[172:175], v[180:183], v[116:119]
    v_mfma_f32_16x16x32_bf16 v[120:123], v[172:175], v[184:187], v[120:123]
    v_mfma_f32_16x16x32_bf16 v[124:127], v[172:175], v[188:191], v[124:127]
    s_waitcnt lgkmcnt(0)
    v_mfma_f32_16x16x32_bf16 v[64:67], v[128:131], v[144:147], v[64:67]
    ds_read_b128 v[160:163], v21 offset:0
    v_mfma_f32_16x16x32_bf16 v[68:71], v[128:131], v[148:151], v[68:71]
    ds_read_b128 v[176:179], v23 offset:16384
    v_mfma_f32_16x16x32_bf16 v[72:75], v[128:131], v[152:155], v[72:75]
    v_mfma_f32_16x16x32_bf16 v[76:79], v[128:131], v[156:159], v[76:79]
    ds_read_b128 v[180:183], v23 offset:18432
    v_mfma_f32_16x16x32_bf16 v[80:83], v[132:135], v[144:147], v[80:83]
    ds_read_b128 v[184:187], v23 offset:20480
    v_mfma_f32_16x16x32_bf16 v[84:87], v[132:135], v[148:151], v[84:87]
    v_mfma_f32_16x16x32_bf16 v[88:91], v[132:135], v[152:155], v[88:91]
    ds_read_b128 v[188:191], v23 offset:22528
    v_mfma_f32_16x16x32_bf16 v[92:95], v[132:135], v[156:159], v[92:95]
    ds_read_b128 v[164:167], v21 offset:2048
    v_mfma_f32_16x16x32_bf16 v[96:99], v[136:139], v[144:147], v[96:99]
    v_mfma_f32_16x16x32_bf16 v[100:103], v[136:139], v[148:151], v[100:103]
    ds_read_b128 v[168:171], v21 offset:4096
    v_mfma_f32_16x16x32_bf16 v[104:107], v[136:139], v[152:155], v[104:107]
    ds_read_b128 v[172:175], v21 offset:6144
    v_mfma_f32_16x16x32_bf16 v[108:111], v[136:139], v[156:159], v[108:111]
    v_mfma_f32_16x16x32_bf16 v[112:115], v[140:143], v[144:147], v[112:115]
    v_mfma_f32_16x16x32_bf16 v[116:119], v[140:143], v[148:151], v[116:119]
    v_mfma_f32_16x16x32_bf16 v[120:123], v[140:143], v[152:155], v[120:123]
    v_mfma_f32_16x16x32_bf16 v[124:127], v[140:143], v[156:159], v[124:127]
    s_waitcnt lgkmcnt(0)
    s_barrier
    v_mfma_f32_16x16x32_bf16 v[64:67], v[160:163], v[176:179], v[64:67]
    ds_read_b128 v[128:131], v16 offset:0
    v_mfma_f32_16x16x32_bf16 v[68:71], v[160:163], v[180:183], v[68:71]
    ds_read_b128 v[144:147], v18 offset:16384
    v_mfma_f32_16x16x32_bf16 v[72:75], v[160:163], v[184:187], v[72:75]
    v_mfma_f32_16x16x32_bf16 v[76:79], v[160:163], v[188:191], v[76:79]
    ds_read_b128 v[148:151], v18 offset:18432
    v_mfma_f32_16x16x32_bf16 v[80:83], v[164:167], v[176:179], v[80:83]
    ds_read_b128 v[152:155], v18 offset:20480
    v_mfma_f32_16x16x32_bf16 v[84:87], v[164:167], v[180:183], v[84:87]
    v_mfma_f32_16x16x32_bf16 v[88:91], v[164:167], v[184:187], v[88:91]
    ds_read_b128 v[156:159], v18 offset:22528
    v_mfma_f32_16x16x32_bf16 v[92:95], v[164:167], v[188:191], v[92:95]
    ds_read_b128 v[132:135], v16 offset:2048
    v_mfma_f32_16x16x32_bf16 v[96:99], v[168:171], v[176:179], v[96:99]
    v_mfma_f32_16x16x32_bf16 v[100:103], v[168:171], v[180:183], v[100:103]
    ds_read_b128 v[136:139], v16 offset:4096
    v_mfma_f32_16x16x32_bf16 v[104:107], v[168:171], v[184:187], v[104:107]
    ds_read_b128 v[140:143], v16 offset:6144
    v_mfma_f32_16x16x32_bf16 v[108:111], v[168:171], v[188:191], v[108:111]
    v_mfma_f32_16x16x32_bf16 v[112:115], v[172:175], v[176:179], v[112:115]
    v_mfma_f32_16x16x32_bf16 v[116:119], v[172:175], v[180:183], v[116:119]
    v_mfma_f32_16x16x32_bf16 v[120:123], v[172:175], v[184:187], v[120:123]
    v_mfma_f32_16x16x32_bf16 v[124:127], v[172:175], v[188:191], v[124:127]
    s_waitcnt lgkmcnt(0)
    v_mfma_f32_16x16x32_bf16 v[64:67], v[128:131], v[144:147], v[64:67]
    ds_read_b128 v[160:163], v17 offset:0
    v_mfma_f32_16x16x32_bf16 v[68:71], v[128:131], v[148:151], v[68:71]
    ds_read_b128 v[176:179], v19 offset:16384
    v_mfma_f32_16x16x32_bf16 v[72:75], v[128:131], v[152:155], v[72:75]
    v_mfma_f32_16x16x32_bf16 v[76:79], v[128:131], v[156:159], v[76:79]
    ds_read_b128 v[180:183], v19 offset:18432
    v_mfma_f32_16x16x32_bf16 v[80:83], v[132:135], v[144:147], v[80:83]
    ds_read_b128 v[184:187], v19 offset:20480
    v_mfma_f32_16x16x32_bf16 v[84:87], v[132:135], v[148:151], v[84:87]
    v_mfma_f32_16x16x32_bf16 v[88:91], v[132:135], v[152:155], v[88:91]
    ds_read_b128 v[188:191], v19 offset:22528
    v_mfma_f32_16x16x32_bf16 v[92:95], v[132:135], v[156:159], v[92:95]
    ds_read_b128 v[164:167], v17 offset:2048
    v_mfma_f32_16x16x32_bf16 v[96:99], v[136:139], v[144:147], v[96:99]
    v_mfma_f32_16x16x32_bf16 v[100:103], v[136:139], v[148:151], v[100:103]
    ds_read_b128 v[168:171], v17 offset:4096
    v_mfma_f32_16x16x32_bf16 v[104:107], v[136:139], v[152:155], v[104:107]
    ds_read_b128 v[172:175], v17 offset:6144
    v_mfma_f32_16x16x32_bf16 v[108:111], v[136:139], v[156:159], v[108:111]
    v_mfma_f32_16x16x32_bf16 v[112:115], v[140:143], v[144:147], v[112:115]
    v_mfma_f32_16x16x32_bf16 v[116:119], v[140:143], v[148:151], v[116:119]
    v_mfma_f32_16x16x32_bf16 v[120:123], v[140:143], v[152:155], v[120:123]
    v_mfma_f32_16x16x32_bf16 v[124:127], v[140:143], v[156:159], v[124:127]
    s_waitcnt lgkmcnt(0)
    s_barrier
    v_mfma_f32_16x16x32_bf16 v[64:67], v[160:163], v[176:179], v[64:67]
    ds_read_b128 v[128:131], v16 offset:32768
    v_mfma_f32_16x16x32_bf16 v[68:71], v[160:163], v[180:183], v[68:71]
    ds_read_b128 v[144:147], v18 offset:49152
    v_mfma_f32_16x16x32_bf16 v[72:75], v[160:163], v[184:187], v[72:75]
    v_mfma_f32_16x16x32_bf16 v[76:79], v[160:163], v[188:191], v[76:79]
    ds_read_b128 v[148:151], v18 offset:51200
    v_mfma_f32_16x16x32_bf16 v[80:83], v[164:167], v[176:179], v[80:83]
    ds_read_b128 v[152:155], v18 offset:53248
    v_mfma_f32_16x16x32_bf16 v[84:87], v[164:167], v[180:183], v[84:87]
    v_mfma_f32_16x16x32_bf16 v[88:91], v[164:167], v[184:187], v[88:91]
    ds_read_b128 v[156:159], v18 offset:55296
    v_mfma_f32_16x16x32_bf16 v[92:95], v[164:167], v[188:191], v[92:95]
    ds_read_b128 v[132:135], v16 offset:34816
    v_mfma_f32_16x16x32_bf16 v[96:99], v[168:171], v[176:179], v[96:99]
    v_mfma_f32_16x16x32_bf16 v[100:103], v[168:171], v[180:183], v[100:103]
    ds_read_b128 v[136:139], v16 offset:36864
    v_mfma_f32_16x16x32_bf16 v[104:107], v[168:171], v[184:187], v[104:107]
    ds_read_b128 v[140:143], v16 offset:38912
    v_mfma_f32_16x16x32_bf16 v[108:111], v[168:171], v[188:191], v[108:111]
    v_mfma_f32_16x16x32_bf16 v[112:115], v[172:175], v[176:179], v[112:115]
    v_mfma_f32_16x16x32_bf16 v[116:119], v[172:175], v[180:183], v[116:119]
    v_mfma_f32_16x16x32_bf16 v[120:123], v[172:175], v[184:187], v[120:123]
    v_mfma_f32_16x16x32_bf16 v[124:127], v[172:175], v[188:191], v[124:127]
    s_waitcnt lgkmcnt(0)
    v_mfma_f32_16x16x32_bf16 v[64:67], v[128:131], v[144:147], v[64:67]
    ds_read_b128 v[160:163], v17 offset:32768
    v_mfma_f32_16x16x32_bf16 v[68:71], v[128:131], v[148:151], v[68:71]
    ds_read_b128 v[176:179], v19 offset:49152
    v_mfma_f32_16x16x32_bf16 v[72:75], v[128:131], v[152:155], v[72:75]
    v_mfma_f32_16x16x32_bf16 v[76:79], v[128:131], v[156:159], v[76:79]
    ds_read_b128 v[180:183], v19 offset:51200
    v_mfma_f32_16x16x32_bf16 v[80:83], v[132:135], v[144:147], v[80:83]
    ds_read_b128 v[184:187], v19 offset:53248
    v_mfma_f32_16x16x32_bf16 v[84:87], v[132:135], v[148:151], v[84:87]
    v_mfma_f32_16x16x32_bf16 v[88:91], v[132:135], v[152:155], v[88:91]
    ds_read_b128 v[188:191], v19 offset:55296
    v_mfma_f32_16x16x32_bf16 v[92:95], v[132:135], v[156:159], v[92:95]
    ds_read_b128 v[164:167], v17 offset:34816
    v_mfma_f32_16x16x32_bf16 v[96:99], v[136:139], v[144:147], v[96:99]
    v_mfma_f32_16x16x32_bf16 v[100:103], v[136:139], v[148:151], v[100:103]
    ds_read_b128 v[168:171], v17 offset:36864
    v_mfma_f32_16x16x32_bf16 v[104:107], v[136:139], v[152:155], v[104:107]
    ds_read_b128 v[172:175], v17 offset:38912
    v_mfma_f32_16x16x32_bf16 v[108:111], v[136:139], v[156:159], v[108:111]
    v_mfma_f32_16x16x32_bf16 v[112:115], v[140:143], v[144:147], v[112:115]
    v_mfma_f32_16x16x32_bf16 v[116:119], v[140:143], v[148:151], v[116:119]
    v_mfma_f32_16x16x32_bf16 v[120:123], v[140:143], v[152:155], v[120:123]
    v_mfma_f32_16x16x32_bf16 v[124:127], v[140:143], v[156:159], v[124:127]
    s_waitcnt lgkmcnt(0)
    s_barrier
    v_mfma_f32_16x16x32_bf16 v[64:67], v[160:163], v[176:179], v[64:67]
    ds_read_b128 v[128:131], v20 offset:0
    v_mfma_f32_16x16x32_bf16 v[68:71], v[160:163], v[180:183], v[68:71]
    ds_read_b128 v[144:147], v22 offset:16384
    v_mfma_f32_16x16x32_bf16 v[72:75], v[160:163], v[184:187], v[72:75]
    v_mfma_f32_16x16x32_bf16 v[76:79], v[160:163], v[188:191], v[76:79]
    ds_read_b128 v[148:151], v22 offset:18432
    v_mfma_f32_16x16x32_bf16 v[80:83], v[164:167], v[176:179], v[80:83]
    ds_read_b128 v[152:155], v22 offset:20480
    v_mfma_f32_16x16x32_bf16 v[84:87], v[164:167], v[180:183], v[84:87]
    v_mfma_f32_16x16x32_bf16 v[88:91], v[164:167], v[184:187], v[88:91]
    ds_read_b128 v[156:159], v22 offset:22528
    v_mfma_f32_16x16x32_bf16 v[92:95], v[164:167], v[188:191], v[92:95]
    ds_read_b128 v[132:135], v20 offset:2048
    v_mfma_f32_16x16x32_bf16 v[96:99], v[168:171], v[176:179], v[96:99]
    v_mfma_f32_16x16x32_bf16 v[100:103], v[168:171], v[180:183], v[100:103]
    ds_read_b128 v[136:139], v20 offset:4096
    v_mfma_f32_16x16x32_bf16 v[104:107], v[168:171], v[184:187], v[104:107]
    ds_read_b128 v[140:143], v20 offset:6144
    v_mfma_f32_16x16x32_bf16 v[108:111], v[168:171], v[188:191], v[108:111]
    v_mfma_f32_16x16x32_bf16 v[112:115], v[172:175], v[176:179], v[112:115]
    v_mfma_f32_16x16x32_bf16 v[116:119], v[172:175], v[180:183], v[116:119]
    v_mfma_f32_16x16x32_bf16 v[120:123], v[172:175], v[184:187], v[120:123]
    v_mfma_f32_16x16x32_bf16 v[124:127], v[172:175], v[188:191], v[124:127]
    s_waitcnt lgkmcnt(0)
    v_mfma_f32_16x16x32_bf16 v[64:67], v[128:131], v[144:147], v[64:67]
    ds_read_b128 v[160:163], v21 offset:0
    v_mfma_f32_16x16x32_bf16 v[68:71], v[128:131], v[148:151], v[68:71]
    ds_read_b128 v[176:179], v23 offset:16384
    v_mfma_f32_16x16x32_bf16 v[72:75], v[128:131], v[152:155], v[72:75]
    v_mfma_f32_16x16x32_bf16 v[76:79], v[128:131], v[156:159], v[76:79]
    ds_read_b128 v[180:183], v23 offset:18432
    v_mfma_f32_16x16x32_bf16 v[80:83], v[132:135], v[144:147], v[80:83]
    ds_read_b128 v[184:187], v23 offset:20480
    v_mfma_f32_16x16x32_bf16 v[84:87], v[132:135], v[148:151], v[84:87]
    v_mfma_f32_16x16x32_bf16 v[88:91], v[132:135], v[152:155], v[88:91]
    ds_read_b128 v[188:191], v23 offset:22528
    v_mfma_f32_16x16x32_bf16 v[92:95], v[132:135], v[156:159], v[92:95]
    ds_read_b128 v[164:167], v21 offset:2048
    v_mfma_f32_16x16x32_bf16 v[96:99], v[136:139], v[144:147], v[96:99]
    v_mfma_f32_16x16x32_bf16 v[100:103], v[136:139], v[148:151], v[100:103]
    ds_read_b128 v[168:171], v21 offset:4096
    v_mfma_f32_16x16x32_bf16 v[104:107], v[136:139], v[152:155], v[104:107]
    ds_read_b128 v[172:175], v21 offset:6144
    v_mfma_f32_16x16x32_bf16 v[108:111], v[136:139], v[156:159], v[108:111]
    v_mfma_f32_16x16x32_bf16 v[112:115], v[140:143], v[144:147], v[112:115]
    v_mfma_f32_16x16x32_bf16 v[116:119], v[140:143], v[148:151], v[116:119]
    v_mfma_f32_16x16x32_bf16 v[120:123], v[140:143], v[152:155], v[120:123]
    v_mfma_f32_16x16x32_bf16 v[124:127], v[140:143], v[156:159], v[124:127]
    s_waitcnt lgkmcnt(0)
    s_barrier
    v_mfma_f32_16x16x32_bf16 v[64:67], v[160:163], v[176:179], v[64:67]
    ds_read_b128 v[128:131], v16 offset:0
    v_mfma_f32_16x16x32_bf16 v[68:71], v[160:163], v[180:183], v[68:71]
    ds_read_b128 v[144:147], v18 offset:16384
    v_mfma_f32_16x16x32_bf16 v[72:75], v[160:163], v[184:187], v[72:75]
    v_mfma_f32_16x16x32_bf16 v[76:79], v[160:163], v[188:191], v[76:79]
    ds_read_b128 v[148:151], v18 offset:18432
    v_mfma_f32_16x16x32_bf16 v[80:83], v[164:167], v[176:179], v[80:83]
    ds_read_b128 v[152:155], v18 offset:20480
    v_mfma_f32_16x16x32_bf16 v[84:87], v[164:167], v[180:183], v[84:87]
    v_mfma_f32_16x16x32_bf16 v[88:91], v[164:167], v[184:187], v[88:91]
    ds_read_b128 v[156:159], v18 offset:22528
    v_mfma_f32_16x16x32_bf16 v[92:95], v[164:167], v[188:191], v[92:95]
    ds_read_b128 v[132:135], v16 offset:2048
    v_mfma_f32_16x16x32_bf16 v[96:99], v[168:171], v[176:179], v[96:99]
    v_mfma_f32_16x16x32_bf16 v[100:103], v[168:171], v[180:183], v[100:103]
    ds_read_b128 v[136:139], v16 offset:4096
    v_mfma_f32_16x16x32_bf16 v[104:107], v[168:171], v[184:187], v[104:107]
    ds_read_b128 v[140:143], v16 offset:6144
    v_mfma_f32_16x16x32_bf16 v[108:111], v[168:171], v[188:191], v[108:111]
    v_mfma_f32_16x16x32_bf16 v[112:115], v[172:175], v[176:179], v[112:115]
    v_mfma_f32_16x16x32_bf16 v[116:119], v[172:175], v[180:183], v[116:119]
    v_mfma_f32_16x16x32_bf16 v[120:123], v[172:175], v[184:187], v[120:123]
    v_mfma_f32_16x16x32_bf16 v[124:127], v[172:175], v[188:191], v[124:127]
    s_waitcnt lgkmcnt(0)
    v_mfma_f32_16x16x32_bf16 v[64:67], v[128:131], v[144:147], v[64:67]
    ds_read_b128 v[160:163], v17 offset:0
    v_mfma_f32_16x16x32_bf16 v[68:71], v[128:131], v[148:151], v[68:71]
    ds_read_b128 v[176:179], v19 offset:16384
    v_mfma_f32_16x16x32_bf16 v[72:75], v[128:131], v[152:155], v[72:75]
    v_mfma_f32_16x16x32_bf16 v[76:79], v[128:131], v[156:159], v[76:79]
    ds_read_b128 v[180:183], v19 offset:18432
    v_mfma_f32_16x16x32_bf16 v[80:83], v[132:135], v[144:147], v[80:83]
    ds_read_b128 v[184:187], v19 offset:20480
    v_mfma_f32_16x16x32_bf16 v[84:87], v[132:135], v[148:151], v[84:87]
    v_mfma_f32_16x16x32_bf16 v[88:91], v[132:135], v[152:155], v[88:91]
    ds_read_b128 v[188:191], v19 offset:22528
    v_mfma_f32_16x16x32_bf16 v[92:95], v[132:135], v[156:159], v[92:95]
    ds_read_b128 v[164:167], v17 offset:2048
    v_mfma_f32_16x16x32_bf16 v[96:99], v[136:139], v[144:147], v[96:99]
    v_mfma_f32_16x16x32_bf16 v[100:103], v[136:139], v[148:151], v[100:103]
    ds_read_b128 v[168:171], v17 offset:4096
    v_mfma_f32_16x16x32_bf16 v[104:107], v[136:139], v[152:155], v[104:107]
    ds_read_b128 v[172:175], v17 offset:6144
    v_mfma_f32_16x16x32_bf16 v[108:111], v[136:139], v[156:159], v[108:111]
    v_mfma_f32_16x16x32_bf16 v[112:115], v[140:143], v[144:147], v[112:115]
    v_mfma_f32_16x16x32_bf16 v[116:119], v[140:143], v[148:151], v[116:119]
    v_mfma_f32_16x16x32_bf16 v[120:123], v[140:143], v[152:155], v[120:123]
    v_mfma_f32_16x16x32_bf16 v[124:127], v[140:143], v[156:159], v[124:127]
    s_waitcnt lgkmcnt(0)
    s_barrier
    v_mfma_f32_16x16x32_bf16 v[64:67], v[160:163], v[176:179], v[64:67]
    ds_read_b128 v[128:131], v16 offset:32768
    v_mfma_f32_16x16x32_bf16 v[68:71], v[160:163], v[180:183], v[68:71]
    ds_read_b128 v[144:147], v18 offset:49152
    v_mfma_f32_16x16x32_bf16 v[72:75], v[160:163], v[184:187], v[72:75]
    v_mfma_f32_16x16x32_bf16 v[76:79], v[160:163], v[188:191], v[76:79]
    ds_read_b128 v[148:151], v18 offset:51200
    v_mfma_f32_16x16x32_bf16 v[80:83], v[164:167], v[176:179], v[80:83]
    ds_read_b128 v[152:155], v18 offset:53248
    v_mfma_f32_16x16x32_bf16 v[84:87], v[164:167], v[180:183], v[84:87]
    v_mfma_f32_16x16x32_bf16 v[88:91], v[164:167], v[184:187], v[88:91]
    ds_read_b128 v[156:159], v18 offset:55296
    v_mfma_f32_16x16x32_bf16 v[92:95], v[164:167], v[188:191], v[92:95]
    ds_read_b128 v[132:135], v16 offset:34816
    v_mfma_f32_16x16x32_bf16 v[96:99], v[168:171], v[176:179], v[96:99]
    v_mfma_f32_16x16x32_bf16 v[100:103], v[168:171], v[180:183], v[100:103]
    ds_read_b128 v[136:139], v16 offset:36864
    v_mfma_f32_16x16x32_bf16 v[104:107], v[168:171], v[184:187], v[104:107]
    ds_read_b128 v[140:143], v16 offset:38912
    v_mfma_f32_16x16x32_bf16 v[108:111], v[168:171], v[188:191], v[108:111]
    v_mfma_f32_16x16x32_bf16 v[112:115], v[172:175], v[176:179], v[112:115]
    v_mfma_f32_16x16x32_bf16 v[116:119], v[172:175], v[180:183], v[116:119]
    v_mfma_f32_16x16x32_bf16 v[120:123], v[172:175], v[184:187], v[120:123]
    v_mfma_f32_16x16x32_bf16 v[124:127], v[172:175], v[188:191], v[124:127]
    s_waitcnt lgkmcnt(0)
    v_mfma_f32_16x16x32_bf16 v[64:67], v[128:131], v[144:147], v[64:67]
    ds_read_b128 v[160:163], v17 offset:32768
    v_mfma_f32_16x16x32_bf16 v[68:71], v[128:131], v[148:151], v[68:71]
    ds_read_b128 v[176:179], v19 offset:49152
    v_mfma_f32_16x16x32_bf16 v[72:75], v[128:131], v[152:155], v[72:75]
    v_mfma_f32_16x16x32_bf16 v[76:79], v[128:131], v[156:159], v[76:79]
    ds_read_b128 v[180:183], v19 offset:51200
    v_mfma_f32_16x16x32_bf16 v[80:83], v[132:135], v[144:147], v[80:83]
    ds_read_b128 v[184:187], v19 offset:53248
    v_mfma_f32_16x16x32_bf16 v[84:87], v[132:135], v[148:151], v[84:87]
    v_mfma_f32_16x16x32_bf16 v[88:91], v[132:135], v[152:155], v[88:91]
    ds_read_b128 v[188:191], v19 offset:55296
    v_mfma_f32_16x16x32_bf16 v[92:95], v[132:135], v[156:159], v[92:95]
    ds_read_b128 v[164:167], v17 offset:34816
    v_mfma_f32_16x16x32_bf16 v[96:99], v[136:139], v[144:147], v[96:99]
    v_mfma_f32_16x16x32_bf16 v[100:103], v[136:139], v[148:151], v[100:103]
    ds_read_b128 v[168:171], v17 offset:36864
    v_mfma_f32_16x16x32_bf16 v[104:107], v[136:139], v[152:155], v[104:107]
    ds_read_b128 v[172:175], v17 offset:38912
    v_mfma_f32_16x16x32_bf16 v[108:111], v[136:139], v[156:159], v[108:111]
    v_mfma_f32_16x16x32_bf16 v[112:115], v[140:143], v[144:147], v[112:115]
    v_mfma_f32_16x16x32_bf16 v[116:119], v[140:143], v[148:151], v[116:119]
    v_mfma_f32_16x16x32_bf16 v[120:123], v[140:143], v[152:155], v[120:123]
    v_mfma_f32_16x16x32_bf16 v[124:127], v[140:143], v[156:159], v[124:127]
    s_waitcnt lgkmcnt(0)
    s_barrier
    v_mfma_f32_16x16x32_bf16 v[64:67], v[160:163], v[176:179], v[64:67]
    ds_read_b128 v[128:131], v20 offset:0
    v_mfma_f32_16x16x32_bf16 v[68:71], v[160:163], v[180:183], v[68:71]
    ds_read_b128 v[144:147], v22 offset:16384
    v_mfma_f32_16x16x32_bf16 v[72:75], v[160:163], v[184:187], v[72:75]
    v_mfma_f32_16x16x32_bf16 v[76:79], v[160:163], v[188:191], v[76:79]
    ds_read_b128 v[148:151], v22 offset:18432
    v_mfma_f32_16x16x32_bf16 v[80:83], v[164:167], v[176:179], v[80:83]
    ds_read_b128 v[152:155], v22 offset:20480
    v_mfma_f32_16x16x32_bf16 v[84:87], v[164:167], v[180:183], v[84:87]
    v_mfma_f32_16x16x32_bf16 v[88:91], v[164:167], v[184:187], v[88:91]
    ds_read_b128 v[156:159], v22 offset:22528
    v_mfma_f32_16x16x32_bf16 v[92:95], v[164:167], v[188:191], v[92:95]
    ds_read_b128 v[132:135], v20 offset:2048
    v_mfma_f32_16x16x32_bf16 v[96:99], v[168:171], v[176:179], v[96:99]
    v_mfma_f32_16x16x32_bf16 v[100:103], v[168:171], v[180:183], v[100:103]
    ds_read_b128 v[136:139], v20 offset:4096
    v_mfma_f32_16x16x32_bf16 v[104:107], v[168:171], v[184:187], v[104:107]
    ds_read_b128 v[140:143], v20 offset:6144
    v_mfma_f32_16x16x32_bf16 v[108:111], v[168:171], v[188:191], v[108:111]
    v_mfma_f32_16x16x32_bf16 v[112:115], v[172:175], v[176:179], v[112:115]
    v_mfma_f32_16x16x32_bf16 v[116:119], v[172:175], v[180:183], v[116:119]
    v_mfma_f32_16x16x32_bf16 v[120:123], v[172:175], v[184:187], v[120:123]
    v_mfma_f32_16x16x32_bf16 v[124:127], v[172:175], v[188:191], v[124:127]
    s_waitcnt lgkmcnt(0)
    v_mfma_f32_16x16x32_bf16 v[64:67], v[128:131], v[144:147], v[64:67]
    ds_read_b128 v[160:163], v21 offset:0
    v_mfma_f32_16x16x32_bf16 v[68:71], v[128:131], v[148:151], v[68:71]
    ds_read_b128 v[176:179], v23 offset:16384
    v_mfma_f32_16x16x32_bf16 v[72:75], v[128:131], v[152:155], v[72:75]
    v_mfma_f32_16x16x32_bf16 v[76:79], v[128:131], v[156:159], v[76:79]
    ds_read_b128 v[180:183], v23 offset:18432
    v_mfma_f32_16x16x32_bf16 v[80:83], v[132:135], v[144:147], v[80:83]
    ds_read_b128 v[184:187], v23 offset:20480
    v_mfma_f32_16x16x32_bf16 v[84:87], v[132:135], v[148:151], v[84:87]
    v_mfma_f32_16x16x32_bf16 v[88:91], v[132:135], v[152:155], v[88:91]
    ds_read_b128 v[188:191], v23 offset:22528
    v_mfma_f32_16x16x32_bf16 v[92:95], v[132:135], v[156:159], v[92:95]
    ds_read_b128 v[164:167], v21 offset:2048
    v_mfma_f32_16x16x32_bf16 v[96:99], v[136:139], v[144:147], v[96:99]
    v_mfma_f32_16x16x32_bf16 v[100:103], v[136:139], v[148:151], v[100:103]
    ds_read_b128 v[168:171], v21 offset:4096
    v_mfma_f32_16x16x32_bf16 v[104:107], v[136:139], v[152:155], v[104:107]
    ds_read_b128 v[172:175], v21 offset:6144
    v_mfma_f32_16x16x32_bf16 v[108:111], v[136:139], v[156:159], v[108:111]
    v_mfma_f32_16x16x32_bf16 v[112:115], v[140:143], v[144:147], v[112:115]
    v_mfma_f32_16x16x32_bf16 v[116:119], v[140:143], v[148:151], v[116:119]
    v_mfma_f32_16x16x32_bf16 v[120:123], v[140:143], v[152:155], v[120:123]
    v_mfma_f32_16x16x32_bf16 v[124:127], v[140:143], v[156:159], v[124:127]
    s_waitcnt lgkmcnt(0)
    s_barrier
    v_mfma_f32_16x16x32_bf16 v[64:67], v[160:163], v[176:179], v[64:67]
    ds_read_b128 v[128:131], v16 offset:0
    v_mfma_f32_16x16x32_bf16 v[68:71], v[160:163], v[180:183], v[68:71]
    ds_read_b128 v[144:147], v18 offset:16384
    v_mfma_f32_16x16x32_bf16 v[72:75], v[160:163], v[184:187], v[72:75]
    v_mfma_f32_16x16x32_bf16 v[76:79], v[160:163], v[188:191], v[76:79]
    ds_read_b128 v[148:151], v18 offset:18432
    v_mfma_f32_16x16x32_bf16 v[80:83], v[164:167], v[176:179], v[80:83]
    ds_read_b128 v[152:155], v18 offset:20480
    v_mfma_f32_16x16x32_bf16 v[84:87], v[164:167], v[180:183], v[84:87]
    v_mfma_f32_16x16x32_bf16 v[88:91], v[164:167], v[184:187], v[88:91]
    ds_read_b128 v[156:159], v18 offset:22528
    v_mfma_f32_16x16x32_bf16 v[92:95], v[164:167], v[188:191], v[92:95]
    ds_read_b128 v[132:135], v16 offset:2048
    v_mfma_f32_16x16x32_bf16 v[96:99], v[168:171], v[176:179], v[96:99]
    v_mfma_f32_16x16x32_bf16 v[100:103], v[168:171], v[180:183], v[100:103]
    ds_read_b128 v[136:139], v16 offset:4096
    v_mfma_f32_16x16x32_bf16 v[104:107], v[168:171], v[184:187], v[104:107]
    ds_read_b128 v[140:143], v16 offset:6144
    v_mfma_f32_16x16x32_bf16 v[108:111], v[168:171], v[188:191], v[108:111]
    v_mfma_f32_16x16x32_bf16 v[112:115], v[172:175], v[176:179], v[112:115]
    v_mfma_f32_16x16x32_bf16 v[116:119], v[172:175], v[180:183], v[116:119]
    v_mfma_f32_16x16x32_bf16 v[120:123], v[172:175], v[184:187], v[120:123]
    v_mfma_f32_16x16x32_bf16 v[124:127], v[172:175], v[188:191], v[124:127]
    s_waitcnt lgkmcnt(0)
    v_mfma_f32_16x16x32_bf16 v[64:67], v[128:131], v[144:147], v[64:67]
    ds_read_b128 v[160:163], v17 offset:0
    v_mfma_f32_16x16x32_bf16 v[68:71], v[128:131], v[148:151], v[68:71]
    ds_read_b128 v[176:179], v19 offset:16384
    v_mfma_f32_16x16x32_bf16 v[72:75], v[128:131], v[152:155], v[72:75]
    v_mfma_f32_16x16x32_bf16 v[76:79], v[128:131], v[156:159], v[76:79]
    ds_read_b128 v[180:183], v19 offset:18432
    v_mfma_f32_16x16x32_bf16 v[80:83], v[132:135], v[144:147], v[80:83]
    ds_read_b128 v[184:187], v19 offset:20480
    v_mfma_f32_16x16x32_bf16 v[84:87], v[132:135], v[148:151], v[84:87]
    v_mfma_f32_16x16x32_bf16 v[88:91], v[132:135], v[152:155], v[88:91]
    ds_read_b128 v[188:191], v19 offset:22528
    v_mfma_f32_16x16x32_bf16 v[92:95], v[132:135], v[156:159], v[92:95]
    ds_read_b128 v[164:167], v17 offset:2048
    v_mfma_f32_16x16x32_bf16 v[96:99], v[136:139], v[144:147], v[96:99]
    v_mfma_f32_16x16x32_bf16 v[100:103], v[136:139], v[148:151], v[100:103]
    ds_read_b128 v[168:171], v17 offset:4096
    v_mfma_f32_16x16x32_bf16 v[104:107], v[136:139], v[152:155], v[104:107]
    ds_read_b128 v[172:175], v17 offset:6144
    v_mfma_f32_16x16x32_bf16 v[108:111], v[136:139], v[156:159], v[108:111]
    v_mfma_f32_16x16x32_bf16 v[112:115], v[140:143], v[144:147], v[112:115]
    v_mfma_f32_16x16x32_bf16 v[116:119], v[140:143], v[148:151], v[116:119]
    v_mfma_f32_16x16x32_bf16 v[120:123], v[140:143], v[152:155], v[120:123]
    v_mfma_f32_16x16x32_bf16 v[124:127], v[140:143], v[156:159], v[124:127]
    s_waitcnt lgkmcnt(0)
    s_barrier
    v_mfma_f32_16x16x32_bf16 v[64:67], v[160:163], v[176:179], v[64:67]
    ds_read_b128 v[128:131], v16 offset:32768
    v_mfma_f32_16x16x32_bf16 v[68:71], v[160:163], v[180:183], v[68:71]
    ds_read_b128 v[144:147], v18 offset:49152
    v_mfma_f32_16x16x32_bf16 v[72:75], v[160:163], v[184:187], v[72:75]
    v_mfma_f32_16x16x32_bf16 v[76:79], v[160:163], v[188:191], v[76:79]
    ds_read_b128 v[148:151], v18 offset:51200
    v_mfma_f32_16x16x32_bf16 v[80:83], v[164:167], v[176:179], v[80:83]
    ds_read_b128 v[152:155], v18 offset:53248
    v_mfma_f32_16x16x32_bf16 v[84:87], v[164:167], v[180:183], v[84:87]
    v_mfma_f32_16x16x32_bf16 v[88:91], v[164:167], v[184:187], v[88:91]
    ds_read_b128 v[156:159], v18 offset:55296
    v_mfma_f32_16x16x32_bf16 v[92:95], v[164:167], v[188:191], v[92:95]
    ds_read_b128 v[132:135], v16 offset:34816
    v_mfma_f32_16x16x32_bf16 v[96:99], v[168:171], v[176:179], v[96:99]
    v_mfma_f32_16x16x32_bf16 v[100:103], v[168:171], v[180:183], v[100:103]
    ds_read_b128 v[136:139], v16 offset:36864
    v_mfma_f32_16x16x32_bf16 v[104:107], v[168:171], v[184:187], v[104:107]
    ds_read_b128 v[140:143], v16 offset:38912
    v_mfma_f32_16x16x32_bf16 v[108:111], v[168:171], v[188:191], v[108:111]
    v_mfma_f32_16x16x32_bf16 v[112:115], v[172:175], v[176:179], v[112:115]
    v_mfma_f32_16x16x32_bf16 v[116:119], v[172:175], v[180:183], v[116:119]
    v_mfma_f32_16x16x32_bf16 v[120:123], v[172:175], v[184:187], v[120:123]
    v_mfma_f32_16x16x32_bf16 v[124:127], v[172:175], v[188:191], v[124:127]
    s_waitcnt lgkmcnt(0)
    v_mfma_f32_16x16x32_bf16 v[64:67], v[128:131], v[144:147], v[64:67]
    ds_read_b128 v[160:163], v17 offset:32768
    v_mfma_f32_16x16x32_bf16 v[68:71], v[128:131], v[148:151], v[68:71]
    ds_read_b128 v[176:179], v19 offset:49152
    v_mfma_f32_16x16x32_bf16 v[72:75], v[128:131], v[152:155], v[72:75]
    v_mfma_f32_16x16x32_bf16 v[76:79], v[128:131], v[156:159], v[76:79]
    ds_read_b128 v[180:183], v19 offset:51200
    v_mfma_f32_16x16x32_bf16 v[80:83], v[132:135], v[144:147], v[80:83]
    ds_read_b128 v[184:187], v19 offset:53248
    v_mfma_f32_16x16x32_bf16 v[84:87], v[132:135], v[148:151], v[84:87]
    v_mfma_f32_16x16x32_bf16 v[88:91], v[132:135], v[152:155], v[88:91]
    ds_read_b128 v[188:191], v19 offset:55296
    v_mfma_f32_16x16x32_bf16 v[92:95], v[132:135], v[156:159], v[92:95]
    ds_read_b128 v[164:167], v17 offset:34816
    v_mfma_f32_16x16x32_bf16 v[96:99], v[136:139], v[144:147], v[96:99]
    v_mfma_f32_16x16x32_bf16 v[100:103], v[136:139], v[148:151], v[100:103]
    ds_read_b128 v[168:171], v17 offset:36864
    v_mfma_f32_16x16x32_bf16 v[104:107], v[136:139], v[152:155], v[104:107]
    ds_read_b128 v[172:175], v17 offset:38912
    v_mfma_f32_16x16x32_bf16 v[108:111], v[136:139], v[156:159], v[108:111]
    v_mfma_f32_16x16x32_bf16 v[112:115], v[140:143], v[144:147], v[112:115]
    v_mfma_f32_16x16x32_bf16 v[116:119], v[140:143], v[148:151], v[116:119]
    v_mfma_f32_16x16x32_bf16 v[120:123], v[140:143], v[152:155], v[120:123]
    v_mfma_f32_16x16x32_bf16 v[124:127], v[140:143], v[156:159], v[124:127]
    s_waitcnt lgkmcnt(0)
    s_barrier
    v_mfma_f32_16x16x32_bf16 v[64:67], v[160:163], v[176:179], v[64:67]
    ds_read_b128 v[128:131], v20 offset:0
    v_mfma_f32_16x16x32_bf16 v[68:71], v[160:163], v[180:183], v[68:71]
    ds_read_b128 v[144:147], v22 offset:16384
    v_mfma_f32_16x16x32_bf16 v[72:75], v[160:163], v[184:187], v[72:75]
    v_mfma_f32_16x16x32_bf16 v[76:79], v[160:163], v[188:191], v[76:79]
    ds_read_b128 v[148:151], v22 offset:18432
    v_mfma_f32_16x16x32_bf16 v[80:83], v[164:167], v[176:179], v[80:83]
    ds_read_b128 v[152:155], v22 offset:20480
    v_mfma_f32_16x16x32_bf16 v[84:87], v[164:167], v[180:183], v[84:87]
    v_mfma_f32_16x16x32_bf16 v[88:91], v[164:167], v[184:187], v[88:91]
    ds_read_b128 v[156:159], v22 offset:22528
    v_mfma_f32_16x16x32_bf16 v[92:95], v[164:167], v[188:191], v[92:95]
    ds_read_b128 v[132:135], v20 offset:2048
    v_mfma_f32_16x16x32_bf16 v[96:99], v[168:171], v[176:179], v[96:99]
    v_mfma_f32_16x16x32_bf16 v[100:103], v[168:171], v[180:183], v[100:103]
    ds_read_b128 v[136:139], v20 offset:4096
    v_mfma_f32_16x16x32_bf16 v[104:107], v[168:171], v[184:187], v[104:107]
    ds_read_b128 v[140:143], v20 offset:6144
    v_mfma_f32_16x16x32_bf16 v[108:111], v[168:171], v[188:191], v[108:111]
    v_mfma_f32_16x16x32_bf16 v[112:115], v[172:175], v[176:179], v[112:115]
    v_mfma_f32_16x16x32_bf16 v[116:119], v[172:175], v[180:183], v[116:119]
    v_mfma_f32_16x16x32_bf16 v[120:123], v[172:175], v[184:187], v[120:123]
    v_mfma_f32_16x16x32_bf16 v[124:127], v[172:175], v[188:191], v[124:127]
    s_waitcnt lgkmcnt(0)
    v_mfma_f32_16x16x32_bf16 v[64:67], v[128:131], v[144:147], v[64:67]
    ds_read_b128 v[160:163], v21 offset:0
    v_mfma_f32_16x16x32_bf16 v[68:71], v[128:131], v[148:151], v[68:71]
    ds_read_b128 v[176:179], v23 offset:16384
    v_mfma_f32_16x16x32_bf16 v[72:75], v[128:131], v[152:155], v[72:75]
    v_mfma_f32_16x16x32_bf16 v[76:79], v[128:131], v[156:159], v[76:79]
    ds_read_b128 v[180:183], v23 offset:18432
    v_mfma_f32_16x16x32_bf16 v[80:83], v[132:135], v[144:147], v[80:83]
    ds_read_b128 v[184:187], v23 offset:20480
    v_mfma_f32_16x16x32_bf16 v[84:87], v[132:135], v[148:151], v[84:87]
    v_mfma_f32_16x16x32_bf16 v[88:91], v[132:135], v[152:155], v[88:91]
    ds_read_b128 v[188:191], v23 offset:22528
    v_mfma_f32_16x16x32_bf16 v[92:95], v[132:135], v[156:159], v[92:95]
    ds_read_b128 v[164:167], v21 offset:2048
    v_mfma_f32_16x16x32_bf16 v[96:99], v[136:139], v[144:147], v[96:99]
    v_mfma_f32_16x16x32_bf16 v[100:103], v[136:139], v[148:151], v[100:103]
    ds_read_b128 v[168:171], v21 offset:4096
    v_mfma_f32_16x16x32_bf16 v[104:107], v[136:139], v[152:155], v[104:107]
    ds_read_b128 v[172:175], v21 offset:6144
    v_mfma_f32_16x16x32_bf16 v[108:111], v[136:139], v[156:159], v[108:111]
    v_mfma_f32_16x16x32_bf16 v[112:115], v[140:143], v[144:147], v[112:115]
    v_mfma_f32_16x16x32_bf16 v[116:119], v[140:143], v[148:151], v[116:119]
    v_mfma_f32_16x16x32_bf16 v[120:123], v[140:143], v[152:155], v[120:123]
    v_mfma_f32_16x16x32_bf16 v[124:127], v[140:143], v[156:159], v[124:127]
    s_waitcnt lgkmcnt(0)
    s_barrier
    v_mfma_f32_16x16x32_bf16 v[64:67], v[160:163], v[176:179], v[64:67]
    ds_read_b128 v[128:131], v16 offset:0
    v_mfma_f32_16x16x32_bf16 v[68:71], v[160:163], v[180:183], v[68:71]
    ds_read_b128 v[144:147], v18 offset:16384
    v_mfma_f32_16x16x32_bf16 v[72:75], v[160:163], v[184:187], v[72:75]
    v_mfma_f32_16x16x32_bf16 v[76:79], v[160:163], v[188:191], v[76:79]
    ds_read_b128 v[148:151], v18 offset:18432
    v_mfma_f32_16x16x32_bf16 v[80:83], v[164:167], v[176:179], v[80:83]
    ds_read_b128 v[152:155], v18 offset:20480
    v_mfma_f32_16x16x32_bf16 v[84:87], v[164:167], v[180:183], v[84:87]
    v_mfma_f32_16x16x32_bf16 v[88:91], v[164:167], v[184:187], v[88:91]
    ds_read_b128 v[156:159], v18 offset:22528
    v_mfma_f32_16x16x32_bf16 v[92:95], v[164:167], v[188:191], v[92:95]
    ds_read_b128 v[132:135], v16 offset:2048
    v_mfma_f32_16x16x32_bf16 v[96:99], v[168:171], v[176:179], v[96:99]
    v_mfma_f32_16x16x32_bf16 v[100:103], v[168:171], v[180:183], v[100:103]
    ds_read_b128 v[136:139], v16 offset:4096
    v_mfma_f32_16x16x32_bf16 v[104:107], v[168:171], v[184:187], v[104:107]
    ds_read_b128 v[140:143], v16 offset:6144
    v_mfma_f32_16x16x32_bf16 v[108:111], v[168:171], v[188:191], v[108:111]
    v_mfma_f32_16x16x32_bf16 v[112:115], v[172:175], v[176:179], v[112:115]
    v_mfma_f32_16x16x32_bf16 v[116:119], v[172:175], v[180:183], v[116:119]
    v_mfma_f32_16x16x32_bf16 v[120:123], v[172:175], v[184:187], v[120:123]
    v_mfma_f32_16x16x32_bf16 v[124:127], v[172:175], v[188:191], v[124:127]
    s_waitcnt lgkmcnt(0)
    v_mfma_f32_16x16x32_bf16 v[64:67], v[128:131], v[144:147], v[64:67]
    ds_read_b128 v[160:163], v17 offset:0
    v_mfma_f32_16x16x32_bf16 v[68:71], v[128:131], v[148:151], v[68:71]
    ds_read_b128 v[176:179], v19 offset:16384
    v_mfma_f32_16x16x32_bf16 v[72:75], v[128:131], v[152:155], v[72:75]
    v_mfma_f32_16x16x32_bf16 v[76:79], v[128:131], v[156:159], v[76:79]
    ds_read_b128 v[180:183], v19 offset:18432
    v_mfma_f32_16x16x32_bf16 v[80:83], v[132:135], v[144:147], v[80:83]
    ds_read_b128 v[184:187], v19 offset:20480
    v_mfma_f32_16x16x32_bf16 v[84:87], v[132:135], v[148:151], v[84:87]
    v_mfma_f32_16x16x32_bf16 v[88:91], v[132:135], v[152:155], v[88:91]
    ds_read_b128 v[188:191], v19 offset:22528
    v_mfma_f32_16x16x32_bf16 v[92:95], v[132:135], v[156:159], v[92:95]
    ds_read_b128 v[164:167], v17 offset:2048
    v_mfma_f32_16x16x32_bf16 v[96:99], v[136:139], v[144:147], v[96:99]
    v_mfma_f32_16x16x32_bf16 v[100:103], v[136:139], v[148:151], v[100:103]
    ds_read_b128 v[168:171], v17 offset:4096
    v_mfma_f32_16x16x32_bf16 v[104:107], v[136:139], v[152:155], v[104:107]
    ds_read_b128 v[172:175], v17 offset:6144
    v_mfma_f32_16x16x32_bf16 v[108:111], v[136:139], v[156:159], v[108:111]
    v_mfma_f32_16x16x32_bf16 v[112:115], v[140:143], v[144:147], v[112:115]
    v_mfma_f32_16x16x32_bf16 v[116:119], v[140:143], v[148:151], v[116:119]
    v_mfma_f32_16x16x32_bf16 v[120:123], v[140:143], v[152:155], v[120:123]
    v_mfma_f32_16x16x32_bf16 v[124:127], v[140:143], v[156:159], v[124:127]
    s_waitcnt lgkmcnt(0) vmcnt(0)
    v_mfma_f32_16x16x32_bf16 v[64:67], v[160:163], v[176:179], v[64:67]
    v_mfma_f32_16x16x32_bf16 v[68:71], v[160:163], v[180:183], v[68:71]
    v_mfma_f32_16x16x32_bf16 v[72:75], v[160:163], v[184:187], v[72:75]
    v_mfma_f32_16x16x32_bf16 v[76:79], v[160:163], v[188:191], v[76:79]
    v_mfma_f32_16x16x32_bf16 v[80:83], v[164:167], v[176:179], v[80:83]
    v_mfma_f32_16x16x32_bf16 v[84:87], v[164:167], v[180:183], v[84:87]
    v_mfma_f32_16x16x32_bf16 v[88:91], v[164:167], v[184:187], v[88:91]
    v_mfma_f32_16x16x32_bf16 v[92:95], v[164:167], v[188:191], v[92:95]
    v_mfma_f32_16x16x32_bf16 v[96:99], v[168:171], v[176:179], v[96:99]
    v_mfma_f32_16x16x32_bf16 v[100:103], v[168:171], v[180:183], v[100:103]
    v_mfma_f32_16x16x32_bf16 v[104:107], v[168:171], v[184:187], v[104:107]
    v_mfma_f32_16x16x32_bf16 v[108:111], v[168:171], v[188:191], v[108:111]
    v_mfma_f32_16x16x32_bf16 v[112:115], v[172:175], v[176:179], v[112:115]
    v_mfma_f32_16x16x32_bf16 v[116:119], v[172:175], v[180:183], v[116:119]
    v_mfma_f32_16x16x32_bf16 v[120:123], v[172:175], v[184:187], v[120:123]
    v_mfma_f32_16x16x32_bf16 v[124:127], v[172:175], v[188:191], v[124:127]
    s_mov_b32 s44, 0
    s_mov_b32 s45, 4096
    s_mov_b32 s46, 8192
    s_mov_b32 s47, 12288
    v_mov_b32 v61, s93
    v_mov_b32 v63, s93
    v_and_b32 v216, 31, v24
    v_lshlrev_b32 v216, 2, v216
    v_add_u32 v216, 73728, v216
    v_mov_b32 v218, 0
    ds_write_b32 v216, v218
    v_pk_fma_f32 v[16:17], v[30:31], v[72:73], v[66:67] op_sel:[0,0,0] op_sel_hi:[0,1,1] neg_lo:[1,0,0] neg_hi:[1,0,0]
    v_pk_fma_f32 v[18:19], v[30:31], v[64:65], v[74:75] op_sel:[0,0,0] op_sel_hi:[0,1,1]
    v_pk_fma_f32 v[8:9], v[28:29], v[64:65], v[16:17] op_sel:[0,0,0] op_sel_hi:[0,1,1]
    v_pk_fma_f32 v[10:11], v[28:29], v[72:73], v[18:19] op_sel:[0,0,0] op_sel_hi:[0,1,1]
    v_pk_fma_f32 v[20:21], v[30:31], v[76:77], v[70:71] op_sel:[1,0,0] op_sel_hi:[1,1,1] neg_lo:[1,0,0] neg_hi:[1,0,0]
    v_pk_fma_f32 v[22:23], v[30:31], v[68:69], v[78:79] op_sel:[1,0,0] op_sel_hi:[1,1,1]
    v_pk_fma_f32 v[12:13], v[28:29], v[68:69], v[20:21] op_sel:[1,0,0] op_sel_hi:[1,1,1]
    v_pk_fma_f32 v[14:15], v[28:29], v[76:77], v[22:23] op_sel:[1,0,0] op_sel_hi:[1,1,1]
    v_pk_fma_f32 v[16:17], v[30:31], v[10:11], v[80:81] op_sel:[0,0,0] op_sel_hi:[0,1,1] neg_lo:[1,0,0] neg_hi:[1,0,0]
    v_pk_fma_f32 v[18:19], v[30:31], v[8:9], v[88:89] op_sel:[0,0,0] op_sel_hi:[0,1,1]
    v_pk_fma_f32 v[8:9], v[28:29], v[8:9], v[16:17] op_sel:[0,0,0] op_sel_hi:[0,1,1]
    v_pk_fma_f32 v[10:11], v[28:29], v[10:11], v[18:19] op_sel:[0,0,0] op_sel_hi:[0,1,1]
    v_pk_fma_f32 v[20:21], v[30:31], v[14:15], v[84:85] op_sel:[1,0,0] op_sel_hi:[1,1,1] neg_lo:[1,0,0] neg_hi:[1,0,0]
    v_pk_fma_f32 v[22:23], v[30:31], v[12:13], v[92:93] op_sel:[1,0,0] op_sel_hi:[1,1,1]
    v_pk_fma_f32 v[12:13], v[28:29], v[12:13], v[20:21] op_sel:[1,0,0] op_sel_hi:[1,1,1]
    v_pk_fma_f32 v[14:15], v[28:29], v[14:15], v[22:23] op_sel:[1,0,0] op_sel_hi:[1,1,1]
    v_pk_fma_f32 v[16:17], v[30:31], v[10:11], v[82:83] op_sel:[0,0,0] op_sel_hi:[0,1,1] neg_lo:[1,0,0] neg_hi:[1,0,0]
    v_pk_fma_f32 v[18:19], v[30:31], v[8:9], v[90:91] op_sel:[0,0,0] op_sel_hi:[0,1,1]
    v_pk_fma_f32 v[8:9], v[28:29], v[8:9], v[16:17] op_sel:[0,0,0] op_sel_hi:[0,1,1]
    v_pk_fma_f32 v[10:11], v[28:29], v[10:11], v[18:19] op_sel:[0,0,0] op_sel_hi:[0,1,1]
    v_pk_fma_f32 v[20:21], v[30:31], v[14:15], v[86:87] op_sel:[1,0,0] op_sel_hi:[1,1,1] neg_lo:[1,0,0] neg_hi:[1,0,0]
    v_pk_fma_f32 v[22:23], v[30:31], v[12:13], v[94:95] op_sel:[1,0,0] op_sel_hi:[1,1,1]
    v_pk_fma_f32 v[12:13], v[28:29], v[12:13], v[20:21] op_sel:[1,0,0] op_sel_hi:[1,1,1]
    v_pk_fma_f32 v[14:15], v[28:29], v[14:15], v[22:23] op_sel:[1,0,0] op_sel_hi:[1,1,1]
    v_pk_fma_f32 v[16:17], v[30:31], v[10:11], v[96:97] op_sel:[0,0,0] op_sel_hi:[0,1,1] neg_lo:[1,0,0] neg_hi:[1,0,0]
    v_pk_fma_f32 v[18:19], v[30:31], v[8:9], v[104:105] op_sel:[0,0,0] op_sel_hi:[0,1,1]
    v_pk_fma_f32 v[8:9], v[28:29], v[8:9], v[16:17] op_sel:[0,0,0] op_sel_hi:[0,1,1]
    v_pk_fma_f32 v[10:11], v[28:29], v[10:11], v[18:19] op_sel:[0,0,0] op_sel_hi:[0,1,1]
    v_pk_fma_f32 v[20:21], v[30:31], v[14:15], v[100:101] op_sel:[1,0,0] op_sel_hi:[1,1,1] neg_lo:[1,0,0] neg_hi:[1,0,0]
    v_pk_fma_f32 v[22:23], v[30:31], v[12:13], v[108:109] op_sel:[1,0,0] op_sel_hi:[1,1,1]
    v_pk_fma_f32 v[12:13], v[28:29], v[12:13], v[20:21] op_sel:[1,0,0] op_sel_hi:[1,1,1]
    v_pk_fma_f32 v[14:15], v[28:29], v[14:15], v[22:23] op_sel:[1,0,0] op_sel_hi:[1,1,1]
    v_pk_fma_f32 v[16:17], v[30:31], v[10:11], v[98:99] op_sel:[0,0,0] op_sel_hi:[0,1,1] neg_lo:[1,0,0] neg_hi:[1,0,0]
    v_pk_fma_f32 v[18:19], v[30:31], v[8:9], v[106:107] op_sel:[0,0,0] op_sel_hi:[0,1,1]
    v_pk_fma_f32 v[8:9], v[28:29], v[8:9], v[16:17] op_sel:[0,0,0] op_sel_hi:[0,1,1]
    v_pk_fma_f32 v[10:11], v[28:29], v[10:11], v[18:19] op_sel:[0,0,0] op_sel_hi:[0,1,1]
    v_pk_fma_f32 v[20:21], v[30:31], v[14:15], v[102:103] op_sel:[1,0,0] op_sel_hi:[1,1,1] neg_lo:[1,0,0] neg_hi:[1,0,0]
    v_pk_fma_f32 v[22:23], v[30:31], v[12:13], v[110:111] op_sel:[1,0,0] op_sel_hi:[1,1,1]
    v_pk_fma_f32 v[12:13], v[28:29], v[12:13], v[20:21] op_sel:[1,0,0] op_sel_hi:[1,1,1]
    v_pk_fma_f32 v[14:15], v[28:29], v[14:15], v[22:23] op_sel:[1,0,0] op_sel_hi:[1,1,1]
    v_pk_fma_f32 v[16:17], v[30:31], v[10:11], v[112:113] op_sel:[0,0,0] op_sel_hi:[0,1,1] neg_lo:[1,0,0] neg_hi:[1,0,0]
    v_pk_fma_f32 v[18:19], v[30:31], v[8:9], v[120:121] op_sel:[0,0,0] op_sel_hi:[0,1,1]
    v_pk_fma_f32 v[8:9], v[28:29], v[8:9], v[16:17] op_sel:[0,0,0] op_sel_hi:[0,1,1]
    v_pk_fma_f32 v[10:11], v[28:29], v[10:11], v[18:19] op_sel:[0,0,0] op_sel_hi:[0,1,1]
    v_pk_fma_f32 v[20:21], v[30:31], v[14:15], v[116:117] op_sel:[1,0,0] op_sel_hi:[1,1,1] neg_lo:[1,0,0] neg_hi:[1,0,0]
    v_pk_fma_f32 v[22:23], v[30:31], v[12:13], v[124:125] op_sel:[1,0,0] op_sel_hi:[1,1,1]
    v_pk_fma_f32 v[12:13], v[28:29], v[12:13], v[20:21] op_sel:[1,0,0] op_sel_hi:[1,1,1]
    v_pk_fma_f32 v[14:15], v[28:29], v[14:15], v[22:23] op_sel:[1,0,0] op_sel_hi:[1,1,1]
    v_pk_fma_f32 v[16:17], v[30:31], v[10:11], v[114:115] op_sel:[0,0,0] op_sel_hi:[0,1,1] neg_lo:[1,0,0] neg_hi:[1,0,0]
    v_pk_fma_f32 v[18:19], v[30:31], v[8:9], v[122:123] op_sel:[0,0,0] op_sel_hi:[0,1,1]
    v_pk_fma_f32 v[8:9], v[28:29], v[8:9], v[16:17] op_sel:[0,0,0] op_sel_hi:[0,1,1]
    v_pk_fma_f32 v[10:11], v[28:29], v[10:11], v[18:19] op_sel:[0,0,0] op_sel_hi:[0,1,1]
    v_pk_fma_f32 v[20:21], v[30:31], v[14:15], v[118:119] op_sel:[1,0,0] op_sel_hi:[1,1,1] neg_lo:[1,0,0] neg_hi:[1,0,0]
    v_pk_fma_f32 v[22:23], v[30:31], v[12:13], v[126:127] op_sel:[1,0,0] op_sel_hi:[1,1,1]
    v_pk_fma_f32 v[12:13], v[28:29], v[12:13], v[20:21] op_sel:[1,0,0] op_sel_hi:[1,1,1]
    v_pk_fma_f32 v[14:15], v[28:29], v[14:15], v[22:23] op_sel:[1,0,0] op_sel_hi:[1,1,1]
    v_fma_f32 v56, -v38, v10, v9
    v_fma_f32 v58, v38, v8, v11
    v_fma_f32 v57, -v39, v14, v13
    v_fma_f32 v59, v39, v12, v15
    v_fma_f32 v56, v36, v8, v56
    v_fma_f32 v58, v36, v10, v58
    v_fma_f32 v57, v37, v12, v57
    v_fma_f32 v59, v37, v14, v59
    ds_write_b128 v192, v[56:59]
    s_waitcnt lgkmcnt(0)
    s_barrier
    ds_read_b128 v[160:163], v193 offset:0
    ds_read_b128 v[164:167], v193 offset:512
    ds_read_b128 v[168:171], v193 offset:1024
    ds_read_b128 v[172:175], v193 offset:1536
    ds_read_b128 v[176:179], v193 offset:2048
    ds_read_b128 v[180:183], v193 offset:2560
    ds_read_b128 v[184:187], v193 offset:3072
    ds_read_b128 v[188:191], v193 offset:3584
    s_waitcnt lgkmcnt(6)
    v_pk_fma_f32 v[164:165], v[42:43], v[162:163], v[164:165] op_sel:[0,0,0] op_sel_hi:[1,1,1] neg_lo:[1,0,0] neg_hi:[1,0,0]
    v_pk_fma_f32 v[166:167], v[42:43], v[160:161], v[166:167] op_sel:[0,0,0] op_sel_hi:[1,1,1]
    v_pk_fma_f32 v[164:165], v[40:41], v[160:161], v[164:165] op_sel:[0,0,0] op_sel_hi:[1,1,1]
    v_pk_fma_f32 v[166:167], v[40:41], v[162:163], v[166:167] op_sel:[0,0,0] op_sel_hi:[1,1,1]
    s_waitcnt lgkmcnt(5)
    v_pk_fma_f32 v[168:169], v[42:43], v[166:167], v[168:169] op_sel:[0,0,0] op_sel_hi:[1,1,1] neg_lo:[1,0,0] neg_hi:[1,0,0]
    v_pk_fma_f32 v[170:171], v[42:43], v[164:165], v[170:171] op_sel:[0,0,0] op_sel_hi:[1,1,1]
    v_pk_fma_f32 v[168:169], v[40:41], v[164:165], v[168:169] op_sel:[0,0,0] op_sel_hi:[1,1,1]
    v_pk_fma_f32 v[170:171], v[40:41], v[166:167], v[170:171] op_sel:[0,0,0] op_sel_hi:[1,1,1]
    s_waitcnt lgkmcnt(4)
    v_pk_fma_f32 v[172:173], v[42:43], v[170:171], v[172:173] op_sel:[0,0,0] op_sel_hi:[1,1,1] neg_lo:[1,0,0] neg_hi:[1,0,0]
    v_pk_fma_f32 v[174:175], v[42:43], v[168:169], v[174:175] op_sel:[0,0,0] op_sel_hi:[1,1,1]
    v_pk_fma_f32 v[172:173], v[40:41], v[168:169], v[172:173] op_sel:[0,0,0] op_sel_hi:[1,1,1]
    v_pk_fma_f32 v[174:175], v[40:41], v[170:171], v[174:175] op_sel:[0,0,0] op_sel_hi:[1,1,1]
    s_waitcnt lgkmcnt(3)
    v_pk_fma_f32 v[176:177], v[42:43], v[174:175], v[176:177] op_sel:[0,0,0] op_sel_hi:[1,1,1] neg_lo:[1,0,0] neg_hi:[1,0,0]
    v_pk_fma_f32 v[178:179], v[42:43], v[172:173], v[178:179] op_sel:[0,0,0] op_sel_hi:[1,1,1]
    v_pk_fma_f32 v[176:177], v[40:41], v[172:173], v[176:177] op_sel:[0,0,0] op_sel_hi:[1,1,1]
    v_pk_fma_f32 v[178:179], v[40:41], v[174:175], v[178:179] op_sel:[0,0,0] op_sel_hi:[1,1,1]
    s_waitcnt lgkmcnt(2)
    v_pk_fma_f32 v[180:181], v[42:43], v[178:179], v[180:181] op_sel:[0,0,0] op_sel_hi:[1,1,1] neg_lo:[1,0,0] neg_hi:[1,0,0]
    v_pk_fma_f32 v[182:183], v[42:43], v[176:177], v[182:183] op_sel:[0,0,0] op_sel_hi:[1,1,1]
    v_pk_fma_f32 v[180:181], v[40:41], v[176:177], v[180:181] op_sel:[0,0,0] op_sel_hi:[1,1,1]
    v_pk_fma_f32 v[182:183], v[40:41], v[178:179], v[182:183] op_sel:[0,0,0] op_sel_hi:[1,1,1]
    s_waitcnt lgkmcnt(1)
    v_pk_fma_f32 v[184:185], v[42:43], v[182:183], v[184:185] op_sel:[0,0,0] op_sel_hi:[1,1,1] neg_lo:[1,0,0] neg_hi:[1,0,0]
    v_pk_fma_f32 v[186:187], v[42:43], v[180:181], v[186:187] op_sel:[0,0,0] op_sel_hi:[1,1,1]
    v_pk_fma_f32 v[184:185], v[40:41], v[180:181], v[184:185] op_sel:[0,0,0] op_sel_hi:[1,1,1]
    v_pk_fma_f32 v[186:187], v[40:41], v[182:183], v[186:187] op_sel:[0,0,0] op_sel_hi:[1,1,1]
    s_waitcnt lgkmcnt(0)
    v_pk_fma_f32 v[188:189], v[42:43], v[186:187], v[188:189] op_sel:[0,0,0] op_sel_hi:[1,1,1] neg_lo:[1,0,0] neg_hi:[1,0,0]
    v_pk_fma_f32 v[190:191], v[42:43], v[184:185], v[190:191] op_sel:[0,0,0] op_sel_hi:[1,1,1]
    v_pk_fma_f32 v[188:189], v[40:41], v[184:185], v[188:189] op_sel:[0,0,0] op_sel_hi:[1,1,1]
    v_pk_fma_f32 v[190:191], v[40:41], v[186:187], v[190:191] op_sel:[0,0,0] op_sel_hi:[1,1,1]
    v_cndmask_b32 v60, v188, v189, s[84:85]
    v_cndmask_b32 v62, v190, v191, s[84:85]
    s_cmp_lg_u32 s19, 0
    s_cbranch_scc1 L_nopub
    s_mov_b32 exec_hi, 0
    buffer_store_dwordx4 v[60:63], v27, s[24:27], 0 offen sc1
    s_mov_b32 exec_hi, -1
L_nopub:
    v_cndmask_b32 v16, 0, v172, s[98:99]
    v_cndmask_b32 v17, v160, v176, s[98:99]
    v_cndmask_b32 v18, v164, v180, s[98:99]
    v_cndmask_b32 v19, v168, v184, s[98:99]
    v_cndmask_b32 v16, v16, v17, s[84:85]
    v_cndmask_b32 v18, v18, v19, s[84:85]
    v_cndmask_b32 v216, v16, v18, s[86:87]
    v_cndmask_b32 v16, 0, v173, s[98:99]
    v_cndmask_b32 v17, v161, v177, s[98:99]
    v_cndmask_b32 v18, v165, v181, s[98:99]
    v_cndmask_b32 v19, v169, v185, s[98:99]
    v_cndmask_b32 v16, v16, v17, s[84:85]
    v_cndmask_b32 v18, v18, v19, s[84:85]
    v_cndmask_b32 v217, v16, v18, s[86:87]
    v_cndmask_b32 v16, 0, v174, s[98:99]
    v_cndmask_b32 v17, v162, v178, s[98:99]
    v_cndmask_b32 v18, v166, v182, s[98:99]
    v_cndmask_b32 v19, v170, v186, s[98:99]
    v_cndmask_b32 v16, v16, v17, s[84:85]
    v_cndmask_b32 v18, v18, v19, s[84:85]
    v_cndmask_b32 v218, v16, v18, s[86:87]
    v_cndmask_b32 v16, 0, v175, s[98:99]
    v_cndmask_b32 v17, v163, v179, s[98:99]
    v_cndmask_b32 v18, v167, v183, s[98:99]
    v_cndmask_b32 v19, v171, v187, s[98:99]
    v_cndmask_b32 v16, v16, v17, s[84:85]
    v_cndmask_b32 v18, v18, v19, s[84:85]
    v_cndmask_b32 v219, v16, v18, s[86:87]
    v_mov_b32 v16, v216
    v_mov_b32 v18, v218
    v_fma_f32 v17, -v38, v218, v8
    v_fma_f32 v19, v38, v216, v10
    v_fma_f32 v17, v36, v216, v17
    v_fma_f32 v19, v36, v218, v19
    v_pk_mul_f32 v[56:57], v[32:33], v[16:17] op_sel:[0,0] op_sel_hi:[0,1]
    v_pk_mul_f32 v[58:59], v[32:33], v[18:19] op_sel:[0,0] op_sel_hi:[0,1]
    v_pk_fma_f32 v[56:57], v[34:35], v[18:19], v[56:57] op_sel:[0,0,0] op_sel_hi:[0,1,1] neg_lo:[1,0,0] neg_hi:[1,0,0]
    v_pk_fma_f32 v[58:59], v[34:35], v[16:17], v[58:59] op_sel:[0,0,0] op_sel_hi:[0,1,1]
    v_mov_b32 v16, v217
    v_mov_b32 v18, v219
    v_fma_f32 v17, -v39, v219, v12
    v_fma_f32 v19, v39, v217, v14
    v_fma_f32 v17, v37, v217, v17
    v_fma_f32 v19, v37, v219, v19
    v_pk_mul_f32 v[60:61], v[32:33], v[16:17] op_sel:[1,0] op_sel_hi:[1,1]
    v_pk_mul_f32 v[62:63], v[32:33], v[18:19] op_sel:[1,0] op_sel_hi:[1,1]
    v_pk_fma_f32 v[60:61], v[34:35], v[18:19], v[60:61] op_sel:[1,0,0] op_sel_hi:[1,1,1] neg_lo:[1,0,0] neg_hi:[1,0,0]
    v_pk_fma_f32 v[62:63], v[34:35], v[16:17], v[62:63] op_sel:[1,0,0] op_sel_hi:[1,1,1]
    v_pk_mul_f32 v[128:129], v[32:33], v[72:73] op_sel:[0,0] op_sel_hi:[0,1]
    v_pk_fma_f32 v[128:129], v[34:35], v[64:65], v[128:129] op_sel:[0,0,0] op_sel_hi:[0,1,1]
    v_pk_mul_f32 v[64:65], v[32:33], v[64:65] op_sel:[0,0] op_sel_hi:[0,1]
    v_pk_fma_f32 v[64:65], v[34:35], v[72:73], v[64:65] op_sel:[0,0,0] op_sel_hi:[0,1,1] neg_lo:[1,0,0] neg_hi:[1,0,0]
    v_pk_mul_f32 v[144:145], v[32:33], v[76:77] op_sel:[1,0] op_sel_hi:[1,1]
    v_pk_fma_f32 v[144:145], v[34:35], v[68:69], v[144:145] op_sel:[1,0,0] op_sel_hi:[1,1,1]
    v_pk_mul_f32 v[68:69], v[32:33], v[68:69] op_sel:[1,0] op_sel_hi:[1,1]
    v_pk_fma_f32 v[68:69], v[34:35], v[76:77], v[68:69] op_sel:[1,0,0] op_sel_hi:[1,1,1] neg_lo:[1,0,0] neg_hi:[1,0,0]
    v_pk_mul_f32 v[130:131], v[32:33], v[74:75] op_sel:[0,0] op_sel_hi:[0,1]
    v_pk_fma_f32 v[130:131], v[34:35], v[66:67], v[130:131] op_sel:[0,0,0] op_sel_hi:[0,1,1]
    v_pk_mul_f32 v[66:67], v[32:33], v[66:67] op_sel:[0,0] op_sel_hi:[0,1]
    v_pk_fma_f32 v[66:67], v[34:35], v[74:75], v[66:67] op_sel:[0,0,0] op_sel_hi:[0,1,1] neg_lo:[1,0,0] neg_hi:[1,0,0]
    v_pk_mul_f32 v[146:147], v[32:33], v[78:79] op_sel:[1,0] op_sel_hi:[1,1]
    v_pk_fma_f32 v[146:147], v[34:35], v[70:71], v[146:147] op_sel:[1,0,0] op_sel_hi:[1,1,1]
    v_pk_mul_f32 v[70:71], v[32:33], v[70:71] op_sel:[1,0] op_sel_hi:[1,1]
    v_pk_fma_f32 v[70:71], v[34:35], v[78:79], v[70:71] op_sel:[1,0,0] op_sel_hi:[1,1,1] neg_lo:[1,0,0] neg_hi:[1,0,0]
    v_pk_mul_f32 v[132:133], v[32:33], v[88:89] op_sel:[0,0] op_sel_hi:[0,1]
    v_pk_fma_f32 v[132:133], v[34:35], v[80:81], v[132:133] op_sel:[0,0,0] op_sel_hi:[0,1,1]
    v_pk_mul_f32 v[80:81], v[32:33], v[80:81] op_sel:[0,0] op_sel_hi:[0,1]
    v_pk_fma_f32 v[80:81], v[34:35], v[88:89], v[80:81] op_sel:[0,0,0] op_sel_hi:[0,1,1] neg_lo:[1,0,0] neg_hi:[1,0,0]
    v_pk_mul_f32 v[148:149], v[32:33], v[92:93] op_sel:[1,0] op_sel_hi:[1,1]
    v_pk_fma_f32 v[148:149], v[34:35], v[84:85], v[148:149] op_sel:[1,0,0] op_sel_hi:[1,1,1]
    v_pk_mul_f32 v[84:85], v[32:33], v[84:85] op_sel:[1,0] op_sel_hi:[1,1]
    v_pk_fma_f32 v[84:85], v[34:35], v[92:93], v[84:85] op_sel:[1,0,0] op_sel_hi:[1,1,1] neg_lo:[1,0,0] neg_hi:[1,0,0]
    v_pk_mul_f32 v[134:135], v[32:33], v[90:91] op_sel:[0,0] op_sel_hi:[0,1]
    v_pk_fma_f32 v[134:135], v[34:35], v[82:83], v[134:135] op_sel:[0,0,0] op_sel_hi:[0,1,1]
    v_pk_mul_f32 v[82:83], v[32:33], v[82:83] op_sel:[0,0] op_sel_hi:[0,1]
    v_pk_fma_f32 v[82:83], v[34:35], v[90:91], v[82:83] op_sel:[0,0,0] op_sel_hi:[0,1,1] neg_lo:[1,0,0] neg_hi:[1,0,0]
    v_pk_mul_f32 v[150:151], v[32:33], v[94:95] op_sel:[1,0] op_sel_hi:[1,1]
    v_pk_fma_f32 v[150:151], v[34:35], v[86:87], v[150:151] op_sel:[1,0,0] op_sel_hi:[1,1,1]
    v_pk_mul_f32 v[86:87], v[32:33], v[86:87] op_sel:[1,0] op_sel_hi:[1,1]
    v_pk_fma_f32 v[86:87], v[34:35], v[94:95], v[86:87] op_sel:[1,0,0] op_sel_hi:[1,1,1] neg_lo:[1,0,0] neg_hi:[1,0,0]
    v_pk_mul_f32 v[136:137], v[32:33], v[104:105] op_sel:[0,0] op_sel_hi:[0,1]
    v_pk_fma_f32 v[136:137], v[34:35], v[96:97], v[136:137] op_sel:[0,0,0] op_sel_hi:[0,1,1]
    v_pk_mul_f32 v[96:97], v[32:33], v[96:97] op_sel:[0,0] op_sel_hi:[0,1]
    v_pk_fma_f32 v[96:97], v[34:35], v[104:105], v[96:97] op_sel:[0,0,0] op_sel_hi:[0,1,1] neg_lo:[1,0,0] neg_hi:[1,0,0]
    v_pk_mul_f32 v[152:153], v[32:33], v[108:109] op_sel:[1,0] op_sel_hi:[1,1]
    v_pk_fma_f32 v[152:153], v[34:35], v[100:101], v[152:153] op_sel:[1,0,0] op_sel_hi:[1,1,1]
    v_pk_mul_f32 v[100:101], v[32:33], v[100:101] op_sel:[1,0] op_sel_hi:[1,1]
    v_pk_fma_f32 v[100:101], v[34:35], v[108:109], v[100:101] op_sel:[1,0,0] op_sel_hi:[1,1,1] neg_lo:[1,0,0] neg_hi:[1,0,0]
    v_pk_mul_f32 v[138:139], v[32:33], v[106:107] op_sel:[0,0] op_sel_hi:[0,1]
    v_pk_fma_f32 v[138:139], v[34:35], v[98:99], v[138:139] op_sel:[0,0,0] op_sel_hi:[0,1,1]
    v_pk_mul_f32 v[98:99], v[32:33], v[98:99] op_sel:[0,0] op_sel_hi:[0,1]
    v_pk_fma_f32 v[98:99], v[34:35], v[106:107], v[98:99] op_sel:[0,0,0] op_sel_hi:[0,1,1] neg_lo:[1,0,0] neg_hi:[1,0,0]
    v_pk_mul_f32 v[154:155], v[32:33], v[110:111] op_sel:[1,0] op_sel_hi:[1,1]
    v_pk_fma_f32 v[154:155], v[34:35], v[102:103], v[154:155] op_sel:[1,0,0] op_sel_hi:[1,1,1]
    v_pk_mul_f32 v[102:103], v[32:33], v[102:103] op_sel:[1,0] op_sel_hi:[1,1]
    v_pk_fma_f32 v[102:103], v[34:35], v[110:111], v[102:103] op_sel:[1,0,0] op_sel_hi:[1,1,1] neg_lo:[1,0,0] neg_hi:[1,0,0]
    v_pk_mul_f32 v[140:141], v[32:33], v[120:121] op_sel:[0,0] op_sel_hi:[0,1]
    v_pk_fma_f32 v[140:141], v[34:35], v[112:113], v[140:141] op_sel:[0,0,0] op_sel_hi:[0,1,1]
    v_pk_mul_f32 v[112:113], v[32:33], v[112:113] op_sel:[0,0] op_sel_hi:[0,1]
    v_pk_fma_f32 v[112:113], v[34:35], v[120:121], v[112:113] op_sel:[0,0,0] op_sel_hi:[0,1,1] neg_lo:[1,0,0] neg_hi:[1,0,0]
    buffer_load_dwordx4 v[160:163], v194, s[24:27], s44 offen offset:0 sc1
    buffer_load_dwordx4 v[164:167], v194, s[24:27], s45 offen offset:0 sc1
    buffer_load_dwordx4 v[168:171], v194, s[24:27], s46 offen offset:0 sc1
    buffer_load_dwordx4 v[172:175], v194, s[24:27], s47 offen offset:0 sc1
    buffer_load_dwordx4 v[176:179], v194, s[24:27], s44 offen offset:256 sc1
    buffer_load_dwordx4 v[180:183], v194, s[24:27], s45 offen offset:256 sc1
    buffer_load_dwordx4 v[184:187], v194, s[24:27], s46 offen offset:256 sc1
    buffer_load_dwordx4 v[188:191], v194, s[24:27], s47 offen offset:256 sc1
    v_pk_mul_f32 v[156:157], v[32:33], v[124:125] op_sel:[1,0] op_sel_hi:[1,1]
    v_pk_fma_f32 v[156:157], v[34:35], v[116:117], v[156:157] op_sel:[1,0,0] op_sel_hi:[1,1,1]
    v_pk_mul_f32 v[116:117], v[32:33], v[116:117] op_sel:[1,0] op_sel_hi:[1,1]
    v_pk_fma_f32 v[116:117], v[34:35], v[124:125], v[116:117] op_sel:[1,0,0] op_sel_hi:[1,1,1] neg_lo:[1,0,0] neg_hi:[1,0,0]
    v_pk_mul_f32 v[142:143], v[32:33], v[122:123] op_sel:[0,0] op_sel_hi:[0,1]
    v_pk_fma_f32 v[142:143], v[34:35], v[114:115], v[142:143] op_sel:[0,0,0] op_sel_hi:[0,1,1]
    v_pk_mul_f32 v[114:115], v[32:33], v[114:115] op_sel:[0,0] op_sel_hi:[0,1]
    v_pk_fma_f32 v[114:115], v[34:35], v[122:123], v[114:115] op_sel:[0,0,0] op_sel_hi:[0,1,1] neg_lo:[1,0,0] neg_hi:[1,0,0]
    v_pk_mul_f32 v[158:159], v[32:33], v[126:127] op_sel:[1,0] op_sel_hi:[1,1]
    v_pk_fma_f32 v[158:159], v[34:35], v[118:119], v[158:159] op_sel:[1,0,0] op_sel_hi:[1,1,1]
    v_pk_mul_f32 v[118:119], v[32:33], v[118:119] op_sel:[1,0] op_sel_hi:[1,1]
    v_pk_fma_f32 v[118:119], v[34:35], v[126:127], v[118:119] op_sel:[1,0,0] op_sel_hi:[1,1,1] neg_lo:[1,0,0] neg_hi:[1,0,0]
    buffer_load_dwordx2 v[240:241], v221, s[12:15], s57 offen sc1
    global_load_dwordx2 v[242:243], v222, s[58:59]
    buffer_load_dwordx2 v[224:225], v220, s[4:7], s56 offen
    s_add_u32 s56, s56, 8192
    buffer_load_dwordx2 v[226:227], v220, s[4:7], s56 offen
    s_add_u32 s56, s56, 8192
    buffer_load_dwordx2 v[228:229], v220, s[4:7], s56 offen
    s_add_u32 s56, s56, 8192
    buffer_load_dwordx2 v[230:231], v220, s[4:7], s56 offen
    s_add_u32 s56, s56, 8192
    buffer_load_dwordx2 v[232:233], v220, s[4:7], s56 offen
    s_add_u32 s56, s56, 8192
    buffer_load_dwordx2 v[234:235], v220, s[4:7], s56 offen
    s_add_u32 s56, s56, 8192
    buffer_load_dwordx2 v[236:237], v220, s[4:7], s56 offen
    s_add_u32 s56, s56, 8192
    buffer_load_dwordx2 v[238:239], v220, s[4:7], s56 offen
    s_add_u32 s56, s56, 8192
    s_waitcnt vmcnt(10)
L_poll:
    v_xor_b32 v161, v161, v198
    v_xor_b32 v163, v163, v198
    v_xor_b32 v165, v165, v199
    v_xor_b32 v167, v167, v199
    v_xor_b32 v169, v169, v200
    v_xor_b32 v171, v171, v200
    v_xor_b32 v173, v173, v201
    v_xor_b32 v175, v175, v201
    v_xor_b32 v177, v177, v198
    v_xor_b32 v179, v179, v198
    v_xor_b32 v181, v181, v199
    v_xor_b32 v183, v183, v199
    v_xor_b32 v185, v185, v200
    v_xor_b32 v187, v187, v200
    v_xor_b32 v189, v189, v201
    v_xor_b32 v191, v191, v201
    v_or3_b32 v214, v161, v163, v165
    v_or3_b32 v214, v214, v167, v169
    v_or3_b32 v214, v214, v171, v173
    v_or3_b32 v214, v214, v175, v177
    v_or3_b32 v214, v214, v179, v181
    v_or3_b32 v214, v214, v183, v185
    v_or3_b32 v214, v214, v187, v189
    v_or_b32 v214, v214, v191
    v_cmp_ne_u32 vcc, 0, v214
    s_nop 1
    s_cmp_eq_u64 vcc, 0
    s_cbranch_scc1 L_got
    s_sub_u32 s96, s96, 1
    s_cbranch_scc1 L_got
    s_sleep 1
    buffer_load_dwordx4 v[160:163], v194, s[24:27], s44 offen offset:0 sc1
    buffer_load_dwordx4 v[164:167], v194, s[24:27], s45 offen offset:0 sc1
    buffer_load_dwordx4 v[168:171], v194, s[24:27], s46 offen offset:0 sc1
    buffer_load_dwordx4 v[172:175], v194, s[24:27], s47 offen offset:0 sc1
    buffer_load_dwordx4 v[176:179], v194, s[24:27], s44 offen offset:256 sc1
    buffer_load_dwordx4 v[180:183], v194, s[24:27], s45 offen offset:256 sc1
    buffer_load_dwordx4 v[184:187], v194, s[24:27], s46 offen offset:256 sc1
    buffer_load_dwordx4 v[188:191], v194, s[24:27], s47 offen offset:256 sc1
    s_waitcnt vmcnt(0)
    s_branch L_poll
L_got:
    v_fma_f32 v168, -v46, v174, v168
    v_fma_f32 v170, v46, v172, v170
    v_fma_f32 v168, v44, v172, v168
    v_fma_f32 v170, v44, v174, v170
    v_fma_f32 v184, -v47, v190, v184
    v_fma_f32 v186, v47, v188, v186
    v_fma_f32 v184, v45, v188, v184
    v_fma_f32 v186, v45, v190, v186
    v_fma_f32 v164, -v46, v170, v164
    v_fma_f32 v166, v46, v168, v166
    v_fma_f32 v164, v44, v168, v164
    v_fma_f32 v166, v44, v170, v166
    v_fma_f32 v180, -v47, v186, v180
    v_fma_f32 v182, v47, v184, v182
    v_fma_f32 v180, v45, v184, v180
    v_fma_f32 v182, v45, v186, v182
    v_fma_f32 v160, -v46, v166, v160
    v_fma_f32 v162, v46, v164, v162
    v_fma_f32 v160, v44, v164, v160
    v_fma_f32 v162, v44, v166, v162
    v_fma_f32 v176, -v47, v182, v176
    v_fma_f32 v178, v47, v180, v178
    v_fma_f32 v176, v45, v180, v176
    v_fma_f32 v178, v45, v182, v178
    v_mul_f32 v16, v48, v160
    v_mul_f32 v17, v48, v162
    v_fma_f32 v16, -v50, v162, v16
    v_fma_f32 v17, v50, v160, v17
    v_mul_f32 v18, v49, v176
    v_mul_f32 v19, v49, v178
    v_fma_f32 v18, -v51, v178, v18
    v_fma_f32 v19, v51, v176, v19
    v_mov_b32 v20, v16
    v_mov_b32 v21, v17
    v_mov_b32 v22, v18
    v_mov_b32 v23, v19
    s_nop 1
    v_permlane16_swap_b32 v16, v20
    v_permlane16_swap_b32 v17, v21
    v_permlane16_swap_b32 v18, v22
    v_permlane16_swap_b32 v19, v23
    s_nop 1
    v_add_f32 v16, v16, v20
    v_add_f32 v17, v17, v21
    v_add_f32 v18, v18, v22
    v_add_f32 v19, v19, v23
    v_mov_b32 v20, v16
    v_mov_b32 v21, v17
    v_mov_b32 v22, v18
    v_mov_b32 v23, v19
    s_nop 1
    v_permlane32_swap_b32 v16, v20
    v_permlane32_swap_b32 v17, v21
    v_permlane32_swap_b32 v18, v22
    v_permlane32_swap_b32 v19, v23
    s_nop 1
    v_add_f32 v16, v16, v20
    v_add_f32 v17, v17, v21
    v_add_f32 v18, v18, v22
    v_add_f32 v19, v19, v23
    v_pk_fma_f32 v[56:57], v[16:17], v[206:207], v[56:57] op_sel:[0,0,0] op_sel_hi:[0,1,1]
    v_pk_fma_f32 v[58:59], v[16:17], v[208:209], v[58:59] op_sel:[0,0,0] op_sel_hi:[0,1,1]
    v_pk_fma_f32 v[56:57], v[16:17], v[208:209], v[56:57] op_sel:[1,0,0] op_sel_hi:[1,1,1] neg_lo:[1,0,0] neg_hi:[1,0,0]
    v_pk_fma_f32 v[58:59], v[16:17], v[206:207], v[58:59] op_sel:[1,0,0] op_sel_hi:[1,1,1]
    v_pk_fma_f32 v[60:61], v[18:19], v[210:211], v[60:61] op_sel:[0,0,0] op_sel_hi:[0,1,1]
    v_pk_fma_f32 v[62:63], v[18:19], v[212:213], v[62:63] op_sel:[0,0,0] op_sel_hi:[0,1,1]
    v_pk_fma_f32 v[60:61], v[18:19], v[212:213], v[60:61] op_sel:[1,0,0] op_sel_hi:[1,1,1] neg_lo:[1,0,0] neg_hi:[1,0,0]
    v_pk_fma_f32 v[62:63], v[18:19], v[210:211], v[62:63] op_sel:[1,0,0] op_sel_hi:[1,1,1]
    v_pk_fma_f32 v[64:65], v[30:31], v[58:59], v[64:65] op_sel:[0,0,0] op_sel_hi:[0,1,1] neg_lo:[1,0,0] neg_hi:[1,0,0]
    v_pk_fma_f32 v[128:129], v[30:31], v[56:57], v[128:129] op_sel:[0,0,0] op_sel_hi:[0,1,1]
    v_pk_fma_f32 v[64:65], v[28:29], v[56:57], v[64:65] op_sel:[0,0,0] op_sel_hi:[0,1,1]
    v_pk_fma_f32 v[128:129], v[28:29], v[58:59], v[128:129] op_sel:[0,0,0] op_sel_hi:[0,1,1]
    v_pk_fma_f32 v[68:69], v[30:31], v[62:63], v[68:69] op_sel:[1,0,0] op_sel_hi:[1,1,1] neg_lo:[1,0,0] neg_hi:[1,0,0]
    v_pk_fma_f32 v[144:145], v[30:31], v[60:61], v[144:145] op_sel:[1,0,0] op_sel_hi:[1,1,1]
    v_pk_fma_f32 v[68:69], v[28:29], v[60:61], v[68:69] op_sel:[1,0,0] op_sel_hi:[1,1,1]
    v_pk_fma_f32 v[144:145], v[28:29], v[62:63], v[144:145] op_sel:[1,0,0] op_sel_hi:[1,1,1]
    v_pk_fma_f32 v[66:67], v[30:31], v[128:129], v[66:67] op_sel:[0,0,0] op_sel_hi:[0,1,1] neg_lo:[1,0,0] neg_hi:[1,0,0]
    v_pk_fma_f32 v[130:131], v[30:31], v[64:65], v[130:131] op_sel:[0,0,0] op_sel_hi:[0,1,1]
    v_pk_fma_f32 v[66:67], v[28:29], v[64:65], v[66:67] op_sel:[0,0,0] op_sel_hi:[0,1,1]
    v_pk_fma_f32 v[130:131], v[28:29], v[128:129], v[130:131] op_sel:[0,0,0] op_sel_hi:[0,1,1]
    v_pk_fma_f32 v[70:71], v[30:31], v[144:145], v[70:71] op_sel:[1,0,0] op_sel_hi:[1,1,1] neg_lo:[1,0,0] neg_hi:[1,0,0]
    v_pk_fma_f32 v[146:147], v[30:31], v[68:69], v[146:147] op_sel:[1,0,0] op_sel_hi:[1,1,1]
    v_pk_fma_f32 v[70:71], v[28:29], v[68:69], v[70:71] op_sel:[1,0,0] op_sel_hi:[1,1,1]
    v_pk_fma_f32 v[146:147], v[28:29], v[144:145], v[146:147] op_sel:[1,0,0] op_sel_hi:[1,1,1]
    v_cvt_pk_bf16_f32 v160, v64, v66
    v_cvt_pk_bf16_f32 v168, -v128, -v130
    v_cvt_pk_bf16_f32 v164, v65, v67
    v_cvt_pk_bf16_f32 v172, -v129, -v131
    v_cvt_pk_bf16_f32 v176, v68, v70
    v_cvt_pk_bf16_f32 v184, -v144, -v146
    v_cvt_pk_bf16_f32 v180, v69, v71
    v_cvt_pk_bf16_f32 v188, -v145, -v147
    v_pk_fma_f32 v[80:81], v[30:31], v[130:131], v[80:81] op_sel:[0,0,0] op_sel_hi:[0,1,1] neg_lo:[1,0,0] neg_hi:[1,0,0]
    v_pk_fma_f32 v[132:133], v[30:31], v[66:67], v[132:133] op_sel:[0,0,0] op_sel_hi:[0,1,1]
    v_pk_fma_f32 v[80:81], v[28:29], v[66:67], v[80:81] op_sel:[0,0,0] op_sel_hi:[0,1,1]
    v_pk_fma_f32 v[132:133], v[28:29], v[130:131], v[132:133] op_sel:[0,0,0] op_sel_hi:[0,1,1]
    v_pk_fma_f32 v[84:85], v[30:31], v[146:147], v[84:85] op_sel:[1,0,0] op_sel_hi:[1,1,1] neg_lo:[1,0,0] neg_hi:[1,0,0]
    v_pk_fma_f32 v[148:149], v[30:31], v[70:71], v[148:149] op_sel:[1,0,0] op_sel_hi:[1,1,1]
    v_pk_fma_f32 v[84:85], v[28:29], v[70:71], v[84:85] op_sel:[1,0,0] op_sel_hi:[1,1,1]
    v_pk_fma_f32 v[148:149], v[28:29], v[146:147], v[148:149] op_sel:[1,0,0] op_sel_hi:[1,1,1]
    v_pk_fma_f32 v[82:83], v[30:31], v[132:133], v[82:83] op_sel:[0,0,0] op_sel_hi:[0,1,1] neg_lo:[1,0,0] neg_hi:[1,0,0]
    v_pk_fma_f32 v[134:135], v[30:31], v[80:81], v[134:135] op_sel:[0,0,0] op_sel_hi:[0,1,1]
    v_pk_fma_f32 v[82:83], v[28:29], v[80:81], v[82:83] op_sel:[0,0,0] op_sel_hi:[0,1,1]
    v_pk_fma_f32 v[134:135], v[28:29], v[132:133], v[134:135] op_sel:[0,0,0] op_sel_hi:[0,1,1]
    v_pk_fma_f32 v[86:87], v[30:31], v[148:149], v[86:87] op_sel:[1,0,0] op_sel_hi:[1,1,1] neg_lo:[1,0,0] neg_hi:[1,0,0]
    v_pk_fma_f32 v[150:151], v[30:31], v[84:85], v[150:151] op_sel:[1,0,0] op_sel_hi:[1,1,1]
    v_pk_fma_f32 v[86:87], v[28:29], v[84:85], v[86:87] op_sel:[1,0,0] op_sel_hi:[1,1,1]
    v_pk_fma_f32 v[150:151], v[28:29], v[148:149], v[150:151] op_sel:[1,0,0] op_sel_hi:[1,1,1]
    v_cvt_pk_bf16_f32 v161, v80, v82
    v_cvt_pk_bf16_f32 v169, -v132, -v134
    v_cvt_pk_bf16_f32 v165, v81, v83
    v_cvt_pk_bf16_f32 v173, -v133, -v135
    v_cvt_pk_bf16_f32 v177, v84, v86
    v_cvt_pk_bf16_f32 v185, -v148, -v150
    v_cvt_pk_bf16_f32 v181, v85, v87
    v_cvt_pk_bf16_f32 v189, -v149, -v151
    v_pk_fma_f32 v[96:97], v[30:31], v[134:135], v[96:97] op_sel:[0,0,0] op_sel_hi:[0,1,1] neg_lo:[1,0,0] neg_hi:[1,0,0]
    v_pk_fma_f32 v[136:137], v[30:31], v[82:83], v[136:137] op_sel:[0,0,0] op_sel_hi:[0,1,1]
    v_pk_fma_f32 v[96:97], v[28:29], v[82:83], v[96:97] op_sel:[0,0,0] op_sel_hi:[0,1,1]
    v_pk_fma_f32 v[136:137], v[28:29], v[134:135], v[136:137] op_sel:[0,0,0] op_sel_hi:[0,1,1]
    v_pk_fma_f32 v[100:101], v[30:31], v[150:151], v[100:101] op_sel:[1,0,0] op_sel_hi:[1,1,1] neg_lo:[1,0,0] neg_hi:[1,0,0]
    v_pk_fma_f32 v[152:153], v[30:31], v[86:87], v[152:153] op_sel:[1,0,0] op_sel_hi:[1,1,1]
    v_pk_fma_f32 v[100:101], v[28:29], v[86:87], v[100:101] op_sel:[1,0,0] op_sel_hi:[1,1,1]
    v_pk_fma_f32 v[152:153], v[28:29], v[150:151], v[152:153] op_sel:[1,0,0] op_sel_hi:[1,1,1]
    v_pk_fma_f32 v[98:99], v[30:31], v[136:137], v[98:99] op_sel:[0,0,0] op_sel_hi:[0,1,1] neg_lo:[1,0,0] neg_hi:[1,0,0]
    v_pk_fma_f32 v[138:139], v[30:31], v[96:97], v[138:139] op_sel:[0,0,0] op_sel_hi:[0,1,1]
    v_pk_fma_f32 v[98:99], v[28:29], v[96:97], v[98:99] op_sel:[0,0,0] op_sel_hi:[0,1,1]
    v_pk_fma_f32 v[138:139], v[28:29], v[136:137], v[138:139] op_sel:[0,0,0] op_sel_hi:[0,1,1]
    v_pk_fma_f32 v[102:103], v[30:31], v[152:153], v[102:103] op_sel:[1,0,0] op_sel_hi:[1,1,1] neg_lo:[1,0,0] neg_hi:[1,0,0]
    v_pk_fma_f32 v[154:155], v[30:31], v[100:101], v[154:155] op_sel:[1,0,0] op_sel_hi:[1,1,1]
    v_pk_fma_f32 v[102:103], v[28:29], v[100:101], v[102:103] op_sel:[1,0,0] op_sel_hi:[1,1,1]
    v_pk_fma_f32 v[154:155], v[28:29], v[152:153], v[154:155] op_sel:[1,0,0] op_sel_hi:[1,1,1]
    v_cvt_pk_bf16_f32 v162, v96, v98
    v_cvt_pk_bf16_f32 v170, -v136, -v138
    v_cvt_pk_bf16_f32 v166, v97, v99
    v_cvt_pk_bf16_f32 v174, -v137, -v139
    v_cvt_pk_bf16_f32 v178, v100, v102
    v_cvt_pk_bf16_f32 v186, -v152, -v154
    v_cvt_pk_bf16_f32 v182, v101, v103
    v_cvt_pk_bf16_f32 v190, -v153, -v155
    v_pk_fma_f32 v[112:113], v[30:31], v[138:139], v[112:113] op_sel:[0,0,0] op_sel_hi:[0,1,1] neg_lo:[1,0,0] neg_hi:[1,0,0]
    v_pk_fma_f32 v[140:141], v[30:31], v[98:99], v[140:141] op_sel:[0,0,0] op_sel_hi:[0,1,1]
    v_pk_fma_f32 v[112:113], v[28:29], v[98:99], v[112:113] op_sel:[0,0,0] op_sel_hi:[0,1,1]
    v_pk_fma_f32 v[140:141], v[28:29], v[138:139], v[140:141] op_sel:[0,0,0] op_sel_hi:[0,1,1]
    v_pk_fma_f32 v[116:117], v[30:31], v[154:155], v[116:117] op_sel:[1,0,0] op_sel_hi:[1,1,1] neg_lo:[1,0,0] neg_hi:[1,0,0]
    v_pk_fma_f32 v[156:157], v[30:31], v[102:103], v[156:157] op_sel:[1,0,0] op_sel_hi:[1,1,1]
    v_pk_fma_f32 v[116:117], v[28:29], v[102:103], v[116:117] op_sel:[1,0,0] op_sel_hi:[1,1,1]
    v_pk_fma_f32 v[156:157], v[28:29], v[154:155], v[156:157] op_sel:[1,0,0] op_sel_hi:[1,1,1]
    v_pk_fma_f32 v[114:115], v[30:31], v[140:141], v[114:115] op_sel:[0,0,0] op_sel_hi:[0,1,1] neg_lo:[1,0,0] neg_hi:[1,0,0]
    v_pk_fma_f32 v[142:143], v[30:31], v[112:113], v[142:143] op_sel:[0,0,0] op_sel_hi:[0,1,1]
    v_pk_fma_f32 v[114:115], v[28:29], v[112:113], v[114:115] op_sel:[0,0,0] op_sel_hi:[0,1,1]
    v_pk_fma_f32 v[142:143], v[28:29], v[140:141], v[142:143] op_sel:[0,0,0] op_sel_hi:[0,1,1]
    v_pk_fma_f32 v[118:119], v[30:31], v[156:157], v[118:119] op_sel:[1,0,0] op_sel_hi:[1,1,1] neg_lo:[1,0,0] neg_hi:[1,0,0]
    v_pk_fma_f32 v[158:159], v[30:31], v[116:117], v[158:159] op_sel:[1,0,0] op_sel_hi:[1,1,1]
    v_pk_fma_f32 v[118:119], v[28:29], v[116:117], v[118:119] op_sel:[1,0,0] op_sel_hi:[1,1,1]
    v_pk_fma_f32 v[158:159], v[28:29], v[156:157], v[158:159] op_sel:[1,0,0] op_sel_hi:[1,1,1]
    v_cvt_pk_bf16_f32 v163, v112, v114
    v_cvt_pk_bf16_f32 v171, -v140, -v142
    v_cvt_pk_bf16_f32 v167, v113, v115
    v_cvt_pk_bf16_f32 v175, -v141, -v143
    v_cvt_pk_bf16_f32 v179, v116, v118
    v_cvt_pk_bf16_f32 v187, -v156, -v158
    v_cvt_pk_bf16_f32 v183, v117, v119
    v_cvt_pk_bf16_f32 v191, -v157, -v159
    ds_write_b128 v195, v[160:163] offset:0
    ds_write_b128 v195, v[164:167] offset:16
    ds_write_b128 v195, v[176:179] offset:2304
    ds_write_b128 v195, v[180:183] offset:2320
    ds_write_b128 v195, v[168:171] offset:4608
    ds_write_b128 v195, v[172:175] offset:4624
    ds_write_b128 v195, v[184:187] offset:6912
    ds_write_b128 v195, v[188:191] offset:6928
    s_waitcnt lgkmcnt(4)
    ds_read_b64_tr_b16 v[128:129], v196 offset:0
    ds_read_b64_tr_b16 v[130:131], v196 offset:576
    ds_read_b64_tr_b16 v[132:133], v196 offset:32
    ds_read_b64_tr_b16 v[134:135], v196 offset:608
    ds_read_b64_tr_b16 v[136:137], v196 offset:64
    ds_read_b64_tr_b16 v[138:139], v196 offset:640
    ds_read_b64_tr_b16 v[140:141], v196 offset:96
    ds_read_b64_tr_b16 v[142:143], v196 offset:672
    s_waitcnt lgkmcnt(8)
    ds_read_b64_tr_b16 v[144:145], v196 offset:4608
    ds_read_b64_tr_b16 v[146:147], v196 offset:5184
    ds_read_b64_tr_b16 v[148:149], v196 offset:4640
    ds_read_b64_tr_b16 v[150:151], v196 offset:5216
    ds_read_b64_tr_b16 v[152:153], v196 offset:4672
    ds_read_b64_tr_b16 v[154:155], v196 offset:5248
    ds_read_b64_tr_b16 v[156:157], v196 offset:4704
    ds_read_b64_tr_b16 v[158:159], v196 offset:5280
    s_add_u32 s39, s53, 0
    s_waitcnt lgkmcnt(14)
    buffer_store_dwordx4 v[128:131], v197, s[12:15], s39 offen offset:0 sc1
    s_waitcnt lgkmcnt(12)
    buffer_store_dwordx4 v[132:135], v197, s[12:15], s39 offen offset:1024 sc1
    s_add_u32 s39, s53, 8192
    s_waitcnt lgkmcnt(10)
    buffer_store_dwordx4 v[136:139], v197, s[12:15], s39 offen offset:0 sc1
    s_waitcnt lgkmcnt(8)
    buffer_store_dwordx4 v[140:143], v197, s[12:15], s39 offen offset:1024 sc1
    s_add_u32 s39, s53, 4096
    s_waitcnt lgkmcnt(6)
    buffer_store_dwordx4 v[144:147], v197, s[12:15], s39 offen offset:0 sc1
    s_waitcnt lgkmcnt(4)
    buffer_store_dwordx4 v[148:151], v197, s[12:15], s39 offen offset:1024 sc1
    s_add_u32 s39, s53, 12288
    s_waitcnt lgkmcnt(2)
    buffer_store_dwordx4 v[152:155], v197, s[12:15], s39 offen offset:0 sc1
    s_waitcnt lgkmcnt(0)
    buffer_store_dwordx4 v[156:159], v197, s[12:15], s39 offen offset:1024 sc1
    s_waitcnt vmcnt(8)
L_gchk:
    v_cmp_ne_u32 vcc, s93, v241
    s_nop 1
    s_cmp_eq_u64 vcc, 0
    s_cbranch_scc1 L_gok
    s_sub_u32 s96, s96, 1
    s_cbranch_scc1 L_gok
    buffer_load_dwordx2 v[240:241], v221, s[12:15], s57 offen sc1
    s_waitcnt vmcnt(0)
    s_branch L_gchk
L_gok:
    v_lshlrev_b32 v6, 2, v25
    ds_bpermute_b32 v36, v6, v240 offset:0
    ds_bpermute_b32 v37, v6, v240 offset:16
    ds_bpermute_b32 v38, v6, v240 offset:32
    ds_bpermute_b32 v39, v6, v240 offset:48
    ds_bpermute_b32 v40, v6, v240 offset:64
    ds_bpermute_b32 v41, v6, v240 offset:80
    ds_bpermute_b32 v42, v6, v240 offset:96
    ds_bpermute_b32 v43, v6, v240 offset:112
    s_mov_b32 s10, 0xffff0000
    s_add_u32 m0, s23, 81920
    s_mov_b32 s21, s17
    s_lshl_b32 s21, s21, 7
    buffer_load_dwordx4 v202, s[28:31], s21 offen offset:0  lds
    v_lshlrev_b32 v252, 16, v242
    v_and_b32 v253, s10, v242
    v_lshlrev_b32 v254, 16, v243
    v_and_b32 v255, s10, v243
    s_waitcnt lgkmcnt(0)
    v_sub_f32 v12, 1.0, v36
    buffer_load_dwordx4 v203, s[28:31], s21 offen offset:1024  lds
    v_cvt_pk_bf16_f32 v12, v12, v12
    v_lshlrev_b32 v12, 16, v12
    v_lshlrev_b32 v8, 16, v224
    v_and_b32 v9, s10, v224
    v_mul_f32 v10, v8, v252
    v_mul_f32 v11, v9, v253
    buffer_load_dwordx4 v204, s[28:31], s21 offen offset:2048  lds
    v_cvt_pk_bf16_f32 v10, v10, v11
    v_mul_f32 v8, v8, v12
    v_mul_f32 v9, v9, v12
    v_cvt_pk_bf16_f32 v8, v8, v9
    v_and_b32 v11, s10, v10
    v_lshlrev_b32 v10, 16, v10
    buffer_load_dwordx4 v205, s[28:31], s21 offen offset:3072  lds
    v_and_b32 v9, s10, v8
    v_lshlrev_b32 v8, 16, v8
    v_fma_f32 v72, v36, v10, v8
    v_fma_f32 v73, v36, v11, v9
    v_lshlrev_b32 v8, 16, v225
    v_and_b32 v9, s10, v225
    s_add_u32 m0, s23, 0
    s_cmp_le_u32 s55, 0
    s_cselect_b32 s21, 1, 0
    s_or_b32 s21, s21, s54
    s_lshl_b32 s21, s21, 7
    buffer_load_dwordx4 v202, s[28:31], s21 offen offset:0  lds
    v_mul_f32 v10, v8, v254
    v_mul_f32 v11, v9, v255
    v_cvt_pk_bf16_f32 v10, v10, v11
    v_mul_f32 v8, v8, v12
    v_mul_f32 v9, v9, v12
    v_cvt_pk_bf16_f32 v8, v8, v9
    buffer_load_dwordx4 v203, s[28:31], s21 offen offset:1024  lds
    v_and_b32 v11, s10, v10
    v_lshlrev_b32 v10, 16, v10
    v_and_b32 v9, s10, v8
    v_lshlrev_b32 v8, 16, v8
    v_fma_f32 v74, v36, v10, v8
    v_fma_f32 v75, v36, v11, v9
    buffer_load_dwordx4 v204, s[28:31], s21 offen offset:2048  lds
    v_sub_f32 v12, 1.0, v37
    v_cvt_pk_bf16_f32 v12, v12, v12
    v_lshlrev_b32 v12, 16, v12
    v_lshlrev_b32 v8, 16, v226
    v_and_b32 v9, s10, v226
    v_mul_f32 v10, v8, v252
    buffer_load_dwordx4 v205, s[28:31], s21 offen offset:3072  lds
    v_mul_f32 v11, v9, v253
    v_cvt_pk_bf16_f32 v10, v10, v11
    v_mul_f32 v8, v8, v12
    v_mul_f32 v9, v9, v12
    v_cvt_pk_bf16_f32 v8, v8, v9
    v_and_b32 v11, s10, v10
    s_add_u32 m0, s23, 16384
    s_cmp_le_u32 s55, 1
    s_cselect_b32 s21, 2, 1
    s_or_b32 s21, s21, s54
    s_lshl_b32 s21, s21, 7
    buffer_load_dwordx4 v202, s[28:31], s21 offen offset:0  lds
    v_lshlrev_b32 v10, 16, v10
    v_and_b32 v9, s10, v8
    v_lshlrev_b32 v8, 16, v8
    v_fma_f32 v76, v37, v10, v8
    v_fma_f32 v77, v37, v11, v9
    v_lshlrev_b32 v8, 16, v227
    buffer_load_dwordx4 v203, s[28:31], s21 offen offset:1024  lds
    v_and_b32 v9, s10, v227
    v_mul_f32 v10, v8, v254
    v_mul_f32 v11, v9, v255
    v_cvt_pk_bf16_f32 v10, v10, v11
    v_mul_f32 v8, v8, v12
    v_mul_f32 v9, v9, v12
    buffer_load_dwordx4 v204, s[28:31], s21 offen offset:2048  lds
    v_cvt_pk_bf16_f32 v8, v8, v9
    v_and_b32 v11, s10, v10
    v_lshlrev_b32 v10, 16, v10
    v_and_b32 v9, s10, v8
    v_lshlrev_b32 v8, 16, v8
    v_fma_f32 v78, v37, v10, v8
    buffer_load_dwordx4 v205, s[28:31], s21 offen offset:3072  lds
    v_fma_f32 v79, v37, v11, v9
    v_sub_f32 v12, 1.0, v38
    v_cvt_pk_bf16_f32 v12, v12, v12
    v_lshlrev_b32 v12, 16, v12
    v_lshlrev_b32 v8, 16, v228
    v_and_b32 v9, s10, v228
    v_mul_f32 v10, v8, v252
    v_mul_f32 v11, v9, v253
    v_cvt_pk_bf16_f32 v10, v10, v11
    v_mul_f32 v8, v8, v12
    v_mul_f32 v9, v9, v12
    v_cvt_pk_bf16_f32 v8, v8, v9
    v_and_b32 v11, s10, v10
    v_lshlrev_b32 v10, 16, v10
    v_and_b32 v9, s10, v8
    v_lshlrev_b32 v8, 16, v8
    v_fma_f32 v88, v38, v10, v8
    v_fma_f32 v89, v38, v11, v9
    v_lshlrev_b32 v8, 16, v229
    v_and_b32 v9, s10, v229
    v_mul_f32 v10, v8, v254
    v_mul_f32 v11, v9, v255
    v_cvt_pk_bf16_f32 v10, v10, v11
    v_mul_f32 v8, v8, v12
    v_mul_f32 v9, v9, v12
    v_cvt_pk_bf16_f32 v8, v8, v9
    v_and_b32 v11, s10, v10
    v_lshlrev_b32 v10, 16, v10
    v_and_b32 v9, s10, v8
    v_lshlrev_b32 v8, 16, v8
    v_fma_f32 v90, v38, v10, v8
    v_fma_f32 v91, v38, v11, v9
    v_sub_f32 v12, 1.0, v39
    v_cvt_pk_bf16_f32 v12, v12, v12
    v_lshlrev_b32 v12, 16, v12
    v_lshlrev_b32 v8, 16, v230
    v_and_b32 v9, s10, v230
    v_mul_f32 v10, v8, v252
    v_mul_f32 v11, v9, v253
    v_cvt_pk_bf16_f32 v10, v10, v11
    v_mul_f32 v8, v8, v12
    v_mul_f32 v9, v9, v12
    v_cvt_pk_bf16_f32 v8, v8, v9
    v_and_b32 v11, s10, v10
    v_lshlrev_b32 v10, 16, v10
    v_and_b32 v9, s10, v8
    v_lshlrev_b32 v8, 16, v8
    v_fma_f32 v92, v39, v10, v8
    v_fma_f32 v93, v39, v11, v9
    v_lshlrev_b32 v8, 16, v231
    v_and_b32 v9, s10, v231
    v_mul_f32 v10, v8, v254
    v_mul_f32 v11, v9, v255
    v_cvt_pk_bf16_f32 v10, v10, v11
    v_mul_f32 v8, v8, v12
    v_mul_f32 v9, v9, v12
    v_cvt_pk_bf16_f32 v8, v8, v9
    v_and_b32 v11, s10, v10
    v_lshlrev_b32 v10, 16, v10
    v_and_b32 v9, s10, v8
    v_lshlrev_b32 v8, 16, v8
    v_fma_f32 v94, v39, v10, v8
    v_fma_f32 v95, v39, v11, v9
    v_sub_f32 v12, 1.0, v40
    v_cvt_pk_bf16_f32 v12, v12, v12
    v_lshlrev_b32 v12, 16, v12
    v_lshlrev_b32 v8, 16, v232
    v_and_b32 v9, s10, v232
    v_mul_f32 v10, v8, v252
    v_mul_f32 v11, v9, v253
    v_cvt_pk_bf16_f32 v10, v10, v11
    v_mul_f32 v8, v8, v12
    v_mul_f32 v9, v9, v12
    v_cvt_pk_bf16_f32 v8, v8, v9
    v_and_b32 v11, s10, v10
    v_lshlrev_b32 v10, 16, v10
    v_and_b32 v9, s10, v8
    v_lshlrev_b32 v8, 16, v8
    v_fma_f32 v104, v40, v10, v8
    v_fma_f32 v105, v40, v11, v9
    v_lshlrev_b32 v8, 16, v233
    v_and_b32 v9, s10, v233
    v_mul_f32 v10, v8, v254
    v_mul_f32 v11, v9, v255
    v_cvt_pk_bf16_f32 v10, v10, v11
    v_mul_f32 v8, v8, v12
    v_mul_f32 v9, v9, v12
    v_cvt_pk_bf16_f32 v8, v8, v9
    v_and_b32 v11, s10, v10
    v_lshlrev_b32 v10, 16, v10
    v_and_b32 v9, s10, v8
    v_lshlrev_b32 v8, 16, v8
    v_fma_f32 v106, v40, v10, v8
    v_fma_f32 v107, v40, v11, v9
    v_sub_f32 v12, 1.0, v41
    v_cvt_pk_bf16_f32 v12, v12, v12
    v_lshlrev_b32 v12, 16, v12
    v_lshlrev_b32 v8, 16, v234
    v_and_b32 v9, s10, v234
    v_mul_f32 v10, v8, v252
    v_mul_f32 v11, v9, v253
    v_cvt_pk_bf16_f32 v10, v10, v11
    v_mul_f32 v8, v8, v12
    v_mul_f32 v9, v9, v12
    v_cvt_pk_bf16_f32 v8, v8, v9
    v_and_b32 v11, s10, v10
    v_lshlrev_b32 v10, 16, v10
    v_and_b32 v9, s10, v8
    v_lshlrev_b32 v8, 16, v8
    v_fma_f32 v108, v41, v10, v8
    v_fma_f32 v109, v41, v11, v9
    v_lshlrev_b32 v8, 16, v235
    v_and_b32 v9, s10, v235
    v_mul_f32 v10, v8, v254
    v_mul_f32 v11, v9, v255
    v_cvt_pk_bf16_f32 v10, v10, v11
    v_mul_f32 v8, v8, v12
    v_mul_f32 v9, v9, v12
    v_cvt_pk_bf16_f32 v8, v8, v9
    v_and_b32 v11, s10, v10
    v_lshlrev_b32 v10, 16, v10
    v_and_b32 v9, s10, v8
    v_lshlrev_b32 v8, 16, v8
    v_fma_f32 v110, v41, v10, v8
    v_fma_f32 v111, v41, v11, v9
    v_sub_f32 v12, 1.0, v42
    v_cvt_pk_bf16_f32 v12, v12, v12
    v_lshlrev_b32 v12, 16, v12
    v_lshlrev_b32 v8, 16, v236
    v_and_b32 v9, s10, v236
    v_mul_f32 v10, v8, v252
    v_mul_f32 v11, v9, v253
    v_cvt_pk_bf16_f32 v10, v10, v11
    v_mul_f32 v8, v8, v12
    v_mul_f32 v9, v9, v12
    v_cvt_pk_bf16_f32 v8, v8, v9
    v_and_b32 v11, s10, v10
    v_lshlrev_b32 v10, 16, v10
    v_and_b32 v9, s10, v8
    v_lshlrev_b32 v8, 16, v8
    v_fma_f32 v120, v42, v10, v8
    v_fma_f32 v121, v42, v11, v9
    v_lshlrev_b32 v8, 16, v237
    v_and_b32 v9, s10, v237
    v_mul_f32 v10, v8, v254
    v_mul_f32 v11, v9, v255
    v_cvt_pk_bf16_f32 v10, v10, v11
    v_mul_f32 v8, v8, v12
    v_mul_f32 v9, v9, v12
    v_cvt_pk_bf16_f32 v8, v8, v9
    v_and_b32 v11, s10, v10
    v_lshlrev_b32 v10, 16, v10
    v_and_b32 v9, s10, v8
    v_lshlrev_b32 v8, 16, v8
    v_fma_f32 v122, v42, v10, v8
    v_fma_f32 v123, v42, v11, v9
    v_sub_f32 v12, 1.0, v43
    v_cvt_pk_bf16_f32 v12, v12, v12
    v_lshlrev_b32 v12, 16, v12
    v_lshlrev_b32 v8, 16, v238
    v_and_b32 v9, s10, v238
    v_mul_f32 v10, v8, v252
    v_mul_f32 v11, v9, v253
    v_cvt_pk_bf16_f32 v10, v10, v11
    v_mul_f32 v8, v8, v12
    v_mul_f32 v9, v9, v12
    v_cvt_pk_bf16_f32 v8, v8, v9
    v_and_b32 v11, s10, v10
    v_lshlrev_b32 v10, 16, v10
    v_and_b32 v9, s10, v8
    v_lshlrev_b32 v8, 16, v8
    v_fma_f32 v124, v43, v10, v8
    v_fma_f32 v125, v43, v11, v9
    v_lshlrev_b32 v8, 16, v239
    v_and_b32 v9, s10, v239
    v_mul_f32 v10, v8, v254
    v_mul_f32 v11, v9, v255
    v_cvt_pk_bf16_f32 v10, v10, v11
    v_mul_f32 v8, v8, v12
    v_mul_f32 v9, v9, v12
    v_cvt_pk_bf16_f32 v8, v8, v9
    v_and_b32 v11, s10, v10
    v_lshlrev_b32 v10, 16, v10
    v_and_b32 v9, s10, v8
    v_lshlrev_b32 v8, 16, v8
    v_fma_f32 v126, v43, v10, v8
    v_fma_f32 v127, v43, v11, v9
    v_mov_b32 v16, v202
    v_mov_b32 v17, v203
    v_mov_b32 v18, v204
    v_mov_b32 v19, v205
    v_mov_b32 v28, v197
    v_add_u32 v29, 4096, v197
    s_lshl_b32 s38, s18, 13
    s_add_u32 s50, s48, s38
    v_mov_b32 v32, 73728
    v_mov_b32 v33, 1
    v_bfe_u32 v59, v24, 1, 3
    v_xor_b32 v59, v59, v25
    v_lshlrev_b32 v59, 4, v59
    v_lshl_add_u32 v59, v26, 7, v59
    v_xor_b32 v20, 0, v59
    v_add_u32 v22, 0x10000, v20
    v_xor_b32 v21, 64, v59
    v_add_u32 v23, 0x10000, v21
    v_xor_b32 v30, s54, v26
    v_lshlrev_b32 v30, 8, v30
    v_mov_b32 v58, s93
    v_lshlrev_b32 v59, 2, v24
    s_lshl_b32 s52, s16, 12
    s_add_u32 s52, s52, 9502720
    s_lshl_b32 s46, s17, 8
    s_add_u32 s46, s46, s52
    s_mul_i32 s38, s18, 8704
    v_mul_u32_u24 v44, 272, v26
    v_lshl_add_u32 v44, v25, 4, v44
    v_add_u32 v44, s38, v44
    v_mul_u32_u24 v45, 272, v25
    v_lshl_add_u32 v45, v26, 4, v45
    v_add_u32 v45, s38, v45
    v_lshlrev_b32 v46, 12, v25
    v_lshl_add_u32 v46, v26, 4, v46
    v_lshlrev_b32 v47, 2, v24
    v_add_u32 v47, 73984, v47
    s_lshl_b32 s56, s51, 12
    s_lshl_b32 s39, s17, 8
    s_add_u32 s56, s56, s39
    s_sub_u32 s38, s20, s18
    s_mul_i32 s38, s38, 9216
    s_lshl_b32 s39, s19, 6
    s_add_u32 s38, s38, s39
    v_add_u32 v35, s38, v196
    s_waitcnt vmcnt(12)
    v_mov_b32 v57, 1
    s_mov_b64 exec, 1
    ds_add_rtn_u32 v57, v32, v57 offset:12
    s_mov_b64 exec, -1
    s_waitcnt lgkmcnt(0)
    v_readfirstlane_b32 s39, v57
    s_nop 1
    s_cmp_lg_u32 s39, 3
    s_cbranch_scc1 L_nohf
    s_mov_b32 exec_hi, 0
    buffer_store_dword v58, v59, s[12:15], s46 offen sc1
    s_mov_b32 exec_hi, -1
    s_waitcnt vmcnt(1)
    s_branch L_hfd
L_nohf:
    s_waitcnt vmcnt(0)
L_hfd:
    s_mov_b64 exec, 1
    ds_add_u32 v32, v33 offset:4
    s_mov_b64 exec, -1
    s_mov_b64 exec, 255
    buffer_load_dword v31, v30, s[12:15], s52 offen sc1
    s_mov_b64 exec, -1
L_sync0:
    ds_read_b32 v34, v32 offset:4
    s_waitcnt lgkmcnt(0)
    v_readfirstlane_b32 s38, v34
    s_nop 1
    s_cmp_ge_u32 s38, 4
    s_cbranch_scc1 L_sync0_ok
    s_sub_u32 s96, s96, 1
    s_cbranch_scc1 L_sync0_ok
    s_sleep 0
    s_branch L_sync0
L_sync0_ok:
    ds_read_b64_tr_b16 v[160:161], v35 offset:0
    ds_read_b64_tr_b16 v[162:163], v35 offset:576
    ds_read_b64_tr_b16 v[164:165], v35 offset:32
    ds_read_b64_tr_b16 v[166:167], v35 offset:608
    ds_read_b64_tr_b16 v[168:169], v35 offset:18432
    ds_read_b64_tr_b16 v[170:171], v35 offset:19008
    ds_read_b64_tr_b16 v[172:173], v35 offset:18464
    ds_read_b64_tr_b16 v[174:175], v35 offset:19040
    s_waitcnt lgkmcnt(4)
    ds_read_b64_tr_b16 v[176:177], v35 offset:4608
    ds_read_b64_tr_b16 v[178:179], v35 offset:5184
    ds_read_b64_tr_b16 v[180:181], v35 offset:4640
    ds_read_b64_tr_b16 v[182:183], v35 offset:5216
    ds_read_b64_tr_b16 v[184:185], v35 offset:23040
    ds_read_b64_tr_b16 v[186:187], v35 offset:23616
    ds_read_b64_tr_b16 v[188:189], v35 offset:23072
    ds_read_b64_tr_b16 v[190:191], v35 offset:23648
    s_mov_b64 exec, 1
    ds_add_u32 v32, v33 offset:72
    s_mov_b64 exec, -1
    s_waitcnt lgkmcnt(4)
    ds_read_b128 v[224:227], v22 offset:16384
    ds_read_b128 v[228:231], v22 offset:18432
    ds_read_b128 v[232:235], v22 offset:20480
    ds_read_b128 v[236:239], v22 offset:22528
    ds_read_b128 v[240:243], v23 offset:16384
    ds_read_b128 v[244:247], v23 offset:18432
    ds_read_b128 v[248:251], v23 offset:20480
    ds_read_b128 v[252:255], v23 offset:22528
    s_waitcnt lgkmcnt(4)
    v_mfma_f32_16x16x32_bf16 v[128:131], v[224:227], v[160:163], 0
    v_mfma_f32_16x16x32_bf16 v[132:135], v[228:231], v[160:163], 0
    v_mfma_f32_16x16x32_bf16 v[136:139], v[232:235], v[160:163], 0
    v_mfma_f32_16x16x32_bf16 v[140:143], v[236:239], v[160:163], 0
    v_mfma_f32_16x16x32_bf16 v[144:147], v[224:227], v[164:167], 0
    v_mfma_f32_16x16x32_bf16 v[148:151], v[228:231], v[164:167], 0
    v_mfma_f32_16x16x32_bf16 v[152:155], v[232:235], v[164:167], 0
    v_mfma_f32_16x16x32_bf16 v[156:159], v[236:239], v[164:167], 0
    ds_read_b128 v[224:227], v22 offset:24576
    ds_read_b128 v[228:231], v22 offset:26624
    ds_read_b128 v[232:235], v22 offset:28672
    ds_read_b128 v[236:239], v22 offset:30720
    s_waitcnt lgkmcnt(4)
    v_mfma_f32_16x16x32_bf16 v[128:131], v[240:243], v[168:171], v[128:131]
    v_mfma_f32_16x16x32_bf16 v[132:135], v[244:247], v[168:171], v[132:135]
    v_mfma_f32_16x16x32_bf16 v[136:139], v[248:251], v[168:171], v[136:139]
    v_mfma_f32_16x16x32_bf16 v[140:143], v[252:255], v[168:171], v[140:143]
    v_mfma_f32_16x16x32_bf16 v[144:147], v[240:243], v[172:175], v[144:147]
    v_mfma_f32_16x16x32_bf16 v[148:151], v[244:247], v[172:175], v[148:151]
    v_mfma_f32_16x16x32_bf16 v[152:155], v[248:251], v[172:175], v[152:155]
    v_mfma_f32_16x16x32_bf16 v[156:159], v[252:255], v[172:175], v[156:159]
    ds_read_b128 v[240:243], v23 offset:24576
    ds_read_b128 v[244:247], v23 offset:26624
    ds_read_b128 v[248:251], v23 offset:28672
    ds_read_b128 v[252:255], v23 offset:30720
    s_waitcnt lgkmcnt(4)
    v_mfma_f32_16x16x32_bf16 v[128:131], v[224:227], v[176:179], v[128:131]
    v_mfma_f32_16x16x32_bf16 v[132:135], v[228:231], v[176:179], v[132:135]
    v_mfma_f32_16x16x32_bf16 v[136:139], v[232:235], v[176:179], v[136:139]
    v_mfma_f32_16x16x32_bf16 v[140:143], v[236:239], v[176:179], v[140:143]
    v_mfma_f32_16x16x32_bf16 v[144:147], v[224:227], v[180:183], v[144:147]
    v_mfma_f32_16x16x32_bf16 v[148:151], v[228:231], v[180:183], v[148:151]
    v_mfma_f32_16x16x32_bf16 v[152:155], v[232:235], v[180:183], v[152:155]
    v_mfma_f32_16x16x32_bf16 v[156:159], v[236:239], v[180:183], v[156:159]
    ds_read_b128 v[224:227], v20 offset:0
    ds_read_b128 v[228:231], v20 offset:2048
    ds_read_b128 v[232:235], v20 offset:4096
    ds_read_b128 v[236:239], v20 offset:6144
    s_waitcnt lgkmcnt(4)
    v_mfma_f32_16x16x32_bf16 v[128:131], v[240:243], v[184:187], v[128:131]
    v_mfma_f32_16x16x32_bf16 v[132:135], v[244:247], v[184:187], v[132:135]
    v_mfma_f32_16x16x32_bf16 v[136:139], v[248:251], v[184:187], v[136:139]
    v_mfma_f32_16x16x32_bf16 v[140:143], v[252:255], v[184:187], v[140:143]
    v_mfma_f32_16x16x32_bf16 v[144:147], v[240:243], v[188:191], v[144:147]
    v_mfma_f32_16x16x32_bf16 v[148:151], v[244:247], v[188:191], v[148:151]
    v_mfma_f32_16x16x32_bf16 v[152:155], v[248:251], v[188:191], v[152:155]
    v_mfma_f32_16x16x32_bf16 v[156:159], v[252:255], v[188:191], v[156:159]
L_hpoll:
    s_waitcnt vmcnt(0)
    v_cmp_ne_u32 vcc, s93, v31
    s_nop 1
    s_and_b32 s38, vcc_lo, 255
    s_cbranch_scc0 L_hgo
    s_sub_u32 s96, s96, 1
    s_cbranch_scc1 L_hgo
    s_sleep 1
    s_mov_b64 exec, 255
    buffer_load_dword v31, v30, s[12:15], s52 offen sc1
    s_mov_b64 exec, -1
    s_branch L_hpoll
L_hgo:
    s_cmp_le_u32 s55, 0
    s_cselect_b32 s49, 1, 0
    s_or_b32 s49, s49, s54
    s_lshl_b32 s49, s49, 15
    s_add_u32 s49, s49, s50
    buffer_load_dwordx4 v[192:195], v28, s[12:15], s49 offen offset:0 sc1
    buffer_load_dwordx4 v[196:199], v28, s[12:15], s49 offen offset:1024 sc1
    buffer_load_dwordx4 v[200:203], v28, s[12:15], s49 offen offset:2048 sc1
    buffer_load_dwordx4 v[204:207], v28, s[12:15], s49 offen offset:3072 sc1
    buffer_load_dwordx4 v[208:211], v29, s[12:15], s49 offen offset:0 sc1
    buffer_load_dwordx4 v[212:215], v29, s[12:15], s49 offen offset:1024 sc1
    buffer_load_dwordx4 v[216:219], v29, s[12:15], s49 offen offset:2048 sc1
    buffer_load_dwordx4 v[220:223], v29, s[12:15], s49 offen offset:3072 sc1
L_sync1:
    ds_read_b32 v34, v32 offset:72
    s_waitcnt lgkmcnt(0)
    v_readfirstlane_b32 s38, v34
    s_nop 1
    s_cmp_ge_u32 s38, 4
    s_cbranch_scc1 L_sync1_ok
    s_sub_u32 s96, s96, 1
    s_cbranch_scc1 L_sync1_ok
    s_sleep 0
    s_branch L_sync1
L_sync1_ok:
    s_cmp_le_u32 s55, 1
    s_cselect_b32 s49, 2, 1
    s_or_b32 s49, s49, s54
    s_lshl_b32 s49, s49, 15
    s_add_u32 s49, s49, s50
    buffer_load_dwordx4 v[160:163], v28, s[12:15], s49 offen offset:0 sc1
    buffer_load_dwordx4 v[164:167], v28, s[12:15], s49 offen offset:1024 sc1
    buffer_load_dwordx4 v[168:171], v28, s[12:15], s49 offen offset:2048 sc1
    buffer_load_dwordx4 v[172:175], v28, s[12:15], s49 offen offset:3072 sc1
    buffer_load_dwordx4 v[176:179], v29, s[12:15], s49 offen offset:0 sc1
    buffer_load_dwordx4 v[180:183], v29, s[12:15], s49 offen offset:1024 sc1
    buffer_load_dwordx4 v[184:187], v29, s[12:15], s49 offen offset:2048 sc1
    buffer_load_dwordx4 v[188:191], v29, s[12:15], s49 offen offset:3072 sc1
    ds_read_b128 v[240:243], v21 offset:0
    ds_read_b128 v[244:247], v21 offset:2048
    ds_read_b128 v[248:251], v21 offset:4096
    ds_read_b128 v[252:255], v21 offset:6144
    s_waitcnt vmcnt(14) lgkmcnt(4)
    v_mfma_f32_16x16x32_bf16 v[128:131], v[224:227], v[192:195], v[128:131]
    v_mfma_f32_16x16x32_bf16 v[132:135], v[228:231], v[192:195], v[132:135]
    v_mfma_f32_16x16x32_bf16 v[136:139], v[232:235], v[192:195], v[136:139]
    v_mfma_f32_16x16x32_bf16 v[140:143], v[236:239], v[192:195], v[140:143]
    s_cmp_le_u32 s55, 2
    s_cselect_b32 s49, 3, 2
    s_or_b32 s49, s49, s54
    s_lshl_b32 s49, s49, 15
    s_add_u32 s49, s49, s50
    buffer_load_dwordx4 v[192:195], v28, s[12:15], s49 offen offset:0 sc1
    s_add_u32 m0, s23, 32768
    s_cmp_le_u32 s55, 2
    s_cselect_b32 s21, 3, 2
    s_or_b32 s21, s21, s54
    s_lshl_b32 s21, s21, 7
    buffer_load_dwordx4 v16, s[28:31], s21 offen offset:0  lds
    v_mfma_f32_16x16x32_bf16 v[144:147], v[224:227], v[196:199], v[144:147]
    v_mfma_f32_16x16x32_bf16 v[148:151], v[228:231], v[196:199], v[148:151]
    v_mfma_f32_16x16x32_bf16 v[152:155], v[232:235], v[196:199], v[152:155]
    v_mfma_f32_16x16x32_bf16 v[156:159], v[236:239], v[196:199], v[156:159]
    buffer_load_dwordx4 v[196:199], v28, s[12:15], s49 offen offset:1024 sc1
    buffer_load_dwordx4 v17, s[28:31], s21 offen offset:1024  lds
    ds_read_b128 v[224:227], v20 offset:8192
    ds_read_b128 v[228:231], v20 offset:10240
    ds_read_b128 v[232:235], v20 offset:12288
    ds_read_b128 v[236:239], v20 offset:14336
    s_waitcnt vmcnt(16) lgkmcnt(4)
    s_mov_b64 exec, 1
    ds_add_u32 v32, v33 offset:16
    s_mov_b64 exec, -1
    v_mfma_f32_16x16x32_bf16 v[128:131], v[240:243], v[200:203], v[128:131]
    v_mfma_f32_16x16x32_bf16 v[132:135], v[244:247], v[200:203], v[132:135]
    v_mfma_f32_16x16x32_bf16 v[136:139], v[248:251], v[200:203], v[136:139]
    v_mfma_f32_16x16x32_bf16 v[140:143], v[252:255], v[200:203], v[140:143]
    buffer_load_dwordx4 v[200:203], v28, s[12:15], s49 offen offset:2048 sc1
    buffer_load_dwordx4 v18, s[28:31], s21 offen offset:2048  lds
    v_mfma_f32_16x16x32_bf16 v[144:147], v[240:243], v[204:207], v[144:147]
    v_mfma_f32_16x16x32_bf16 v[148:151], v[244:247], v[204:207], v[148:151]
    v_mfma_f32_16x16x32_bf16 v[152:155], v[248:251], v[204:207], v[152:155]
    v_mfma_f32_16x16x32_bf16 v[156:159], v[252:255], v[204:207], v[156:159]
    buffer_load_dwordx4 v[204:207], v28, s[12:15], s49 offen offset:3072 sc1
    buffer_load_dwordx4 v19, s[28:31], s21 offen offset:3072  lds
    ds_read_b128 v[240:243], v21 offset:8192
    ds_read_b128 v[244:247], v21 offset:10240
    ds_read_b128 v[248:251], v21 offset:12288
    ds_read_b128 v[252:255], v21 offset:14336
    s_waitcnt vmcnt(18) lgkmcnt(4)
    v_mfma_f32_16x16x32_bf16 v[128:131], v[224:227], v[208:211], v[128:131]
    v_mfma_f32_16x16x32_bf16 v[132:135], v[228:231], v[208:211], v[132:135]
    v_mfma_f32_16x16x32_bf16 v[136:139], v[232:235], v[208:211], v[136:139]
    v_mfma_f32_16x16x32_bf16 v[140:143], v[236:239], v[208:211], v[140:143]
    ds_read_b32 v34, v32 offset:16
    buffer_load_dwordx4 v[208:211], v29, s[12:15], s49 offen offset:0 sc1
    s_add_u32 m0, s23, 49152
    s_cmp_le_u32 s55, 3
    s_cselect_b32 s21, 4, 3
    s_or_b32 s21, s21, s54
    s_lshl_b32 s21, s21, 7
    buffer_load_dwordx4 v16, s[28:31], s21 offen offset:0  lds
    v_mfma_f32_16x16x32_bf16 v[144:147], v[224:227], v[212:215], v[144:147]
    v_mfma_f32_16x16x32_bf16 v[148:151], v[228:231], v[212:215], v[148:151]
    v_mfma_f32_16x16x32_bf16 v[152:155], v[232:235], v[212:215], v[152:155]
    v_mfma_f32_16x16x32_bf16 v[156:159], v[236:239], v[212:215], v[156:159]
    buffer_load_dwordx4 v[212:215], v29, s[12:15], s49 offen offset:1024 sc1
    s_waitcnt lgkmcnt(0)
    v_readfirstlane_b32 s38, v34
    s_nop 1
    s_cmp_ge_u32 s38, 4
    s_cbranch_scc1 L_st1_ok
L_st1:
    ds_read_b32 v34, v32 offset:16
    s_waitcnt lgkmcnt(0)
    v_readfirstlane_b32 s38, v34
    s_nop 1
    s_cmp_ge_u32 s38, 4
    s_cbranch_scc1 L_st1_ok
    s_sub_u32 s96, s96, 1
    s_cbranch_scc1 L_st1_ok
    s_sleep 0
    s_branch L_st1
L_st1_ok:
    ds_read_b128 v[224:227], v20 offset:16384
    ds_read_b128 v[228:231], v20 offset:18432
    ds_read_b128 v[232:235], v20 offset:20480
    ds_read_b128 v[236:239], v20 offset:22528
    s_waitcnt vmcnt(19)
    v_mfma_f32_16x16x32_bf16 v[128:131], v[240:243], v[216:219], v[128:131]
    v_mfma_f32_16x16x32_bf16 v[132:135], v[244:247], v[216:219], v[132:135]
    v_mfma_f32_16x16x32_bf16 v[136:139], v[248:251], v[216:219], v[136:139]
    v_mfma_f32_16x16x32_bf16 v[140:143], v[252:255], v[216:219], v[140:143]
    buffer_load_dwordx4 v[216:219], v29, s[12:15], s49 offen offset:2048 sc1
    buffer_load_dwordx4 v17, s[28:31], s21 offen offset:1024  lds
    v_mfma_f32_16x16x32_bf16 v[144:147], v[240:243], v[220:223], v[144:147]
    v_mfma_f32_16x16x32_bf16 v[148:151], v[244:247], v[220:223], v[148:151]
    v_mfma_f32_16x16x32_bf16 v[152:155], v[248:251], v[220:223], v[152:155]
    v_mfma_f32_16x16x32_bf16 v[156:159], v[252:255], v[220:223], v[156:159]
    buffer_load_dwordx4 v[220:223], v29, s[12:15], s49 offen offset:3072 sc1
    buffer_load_dwordx4 v18, s[28:31], s21 offen offset:2048  lds
    ds_read_b128 v[240:243], v21 offset:16384
    ds_read_b128 v[244:247], v21 offset:18432
    ds_read_b128 v[248:251], v21 offset:20480
    ds_read_b128 v[252:255], v21 offset:22528
    s_waitcnt vmcnt(21) lgkmcnt(4)
    v_mfma_f32_16x16x32_bf16 v[128:131], v[224:227], v[160:163], v[128:131]
    v_mfma_f32_16x16x32_bf16 v[132:135], v[228:231], v[160:163], v[132:135]
    v_mfma_f32_16x16x32_bf16 v[136:139], v[232:235], v[160:163], v[136:139]
    v_mfma_f32_16x16x32_bf16 v[140:143], v[236:239], v[160:163], v[140:143]
    s_cmp_le_u32 s55, 3
    s_cselect_b32 s49, 4, 3
    s_or_b32 s49, s49, s54
    s_lshl_b32 s49, s49, 15
    s_add_u32 s49, s49, s50
    buffer_load_dwordx4 v[160:163], v28, s[12:15], s49 offen offset:0 sc1
    buffer_load_dwordx4 v19, s[28:31], s21 offen offset:3072  lds
    v_mfma_f32_16x16x32_bf16 v[144:147], v[224:227], v[164:167], v[144:147]
    v_mfma_f32_16x16x32_bf16 v[148:151], v[228:231], v[164:167], v[148:151]
    v_mfma_f32_16x16x32_bf16 v[152:155], v[232:235], v[164:167], v[152:155]
    v_mfma_f32_16x16x32_bf16 v[156:159], v[236:239], v[164:167], v[156:159]
    buffer_load_dwordx4 v[164:167], v28, s[12:15], s49 offen offset:1024 sc1
    ds_read_b128 v[224:227], v20 offset:24576
    ds_read_b128 v[228:231], v20 offset:26624
    ds_read_b128 v[232:235], v20 offset:28672
    ds_read_b128 v[236:239], v20 offset:30720
    s_waitcnt vmcnt(10) lgkmcnt(4)
    s_mov_b64 exec, 1
    ds_add_u32 v32, v33 offset:16
    s_mov_b64 exec, -1
    v_mfma_f32_16x16x32_bf16 v[128:131], v[240:243], v[168:171], v[128:131]
    v_mfma_f32_16x16x32_bf16 v[132:135], v[244:247], v[168:171], v[132:135]
    v_mfma_f32_16x16x32_bf16 v[136:139], v[248:251], v[168:171], v[136:139]
    v_mfma_f32_16x16x32_bf16 v[140:143], v[252:255], v[168:171], v[140:143]
    buffer_load_dwordx4 v[168:171], v28, s[12:15], s49 offen offset:2048 sc1
    s_add_u32 m0, s23, 81920
    s_cmp_le_u32 s55, 4
    s_cselect_b32 s21, 5, 4
    s_or_b32 s21, s21, s54
    s_lshl_b32 s21, s21, 7
    buffer_load_dwordx4 v16, s[28:31], s21 offen offset:0  lds
    v_mfma_f32_16x16x32_bf16 v[144:147], v[240:243], v[172:175], v[144:147]
    v_mfma_f32_16x16x32_bf16 v[148:151], v[244:247], v[172:175], v[148:151]
    v_mfma_f32_16x16x32_bf16 v[152:155], v[248:251], v[172:175], v[152:155]
    v_mfma_f32_16x16x32_bf16 v[156:159], v[252:255], v[172:175], v[156:159]
    buffer_load_dwordx4 v[172:175], v28, s[12:15], s49 offen offset:3072 sc1
    ds_read_b128 v[240:243], v21 offset:24576
    ds_read_b128 v[244:247], v21 offset:26624
    ds_read_b128 v[248:251], v21 offset:28672
    ds_read_b128 v[252:255], v21 offset:30720
    s_waitcnt vmcnt(23) lgkmcnt(4)
    v_mfma_f32_16x16x32_bf16 v[128:131], v[224:227], v[176:179], v[128:131]
    v_mfma_f32_16x16x32_bf16 v[132:135], v[228:231], v[176:179], v[132:135]
    v_mfma_f32_16x16x32_bf16 v[136:139], v[232:235], v[176:179], v[136:139]
    v_mfma_f32_16x16x32_bf16 v[140:143], v[236:239], v[176:179], v[140:143]
    ds_read_b32 v34, v32 offset:16
    buffer_load_dwordx4 v[176:179], v29, s[12:15], s49 offen offset:0 sc1
    buffer_load_dwordx4 v17, s[28:31], s21 offen offset:1024  lds
    v_mfma_f32_16x16x32_bf16 v[144:147], v[224:227], v[180:183], v[144:147]
    v_mfma_f32_16x16x32_bf16 v[148:151], v[228:231], v[180:183], v[148:151]
    v_mfma_f32_16x16x32_bf16 v[152:155], v[232:235], v[180:183], v[152:155]
    v_mfma_f32_16x16x32_bf16 v[156:159], v[236:239], v[180:183], v[156:159]
    buffer_load_dwordx4 v[180:183], v29, s[12:15], s49 offen offset:1024 sc1
    s_waitcnt lgkmcnt(0)
    v_readfirstlane_b32 s38, v34
    s_nop 1
    s_cmp_ge_u32 s38, 8
    s_cbranch_scc1 L_st2_ok
L_st2:
    ds_read_b32 v34, v32 offset:16
    s_waitcnt lgkmcnt(0)
    v_readfirstlane_b32 s38, v34
    s_nop 1
    s_cmp_ge_u32 s38, 8
    s_cbranch_scc1 L_st2_ok
    s_sub_u32 s96, s96, 1
    s_cbranch_scc1 L_st2_ok
    s_sleep 0
    s_branch L_st2
L_st2_ok:
    ds_read_b128 v[224:227], v20 offset:32768
    ds_read_b128 v[228:231], v20 offset:34816
    ds_read_b128 v[232:235], v20 offset:36864
    ds_read_b128 v[236:239], v20 offset:38912
    s_waitcnt vmcnt(24)
    v_mfma_f32_16x16x32_bf16 v[128:131], v[240:243], v[184:187], v[128:131]
    v_mfma_f32_16x16x32_bf16 v[132:135], v[244:247], v[184:187], v[132:135]
    v_mfma_f32_16x16x32_bf16 v[136:139], v[248:251], v[184:187], v[136:139]
    v_mfma_f32_16x16x32_bf16 v[140:143], v[252:255], v[184:187], v[140:143]
    buffer_load_dwordx4 v[184:187], v29, s[12:15], s49 offen offset:2048 sc1
    buffer_load_dwordx4 v18, s[28:31], s21 offen offset:2048  lds
    v_mfma_f32_16x16x32_bf16 v[144:147], v[240:243], v[188:191], v[144:147]
    v_mfma_f32_16x16x32_bf16 v[148:151], v[244:247], v[188:191], v[148:151]
    v_mfma_f32_16x16x32_bf16 v[152:155], v[248:251], v[188:191], v[152:155]
    v_mfma_f32_16x16x32_bf16 v[156:159], v[252:255], v[188:191], v[156:159]
    buffer_load_dwordx4 v[188:191], v29, s[12:15], s49 offen offset:3072 sc1
    buffer_load_dwordx4 v19, s[28:31], s21 offen offset:3072  lds
    ds_read_b128 v[240:243], v21 offset:32768
    ds_read_b128 v[244:247], v21 offset:34816
    ds_read_b128 v[248:251], v21 offset:36864
    ds_read_b128 v[252:255], v21 offset:38912
    s_waitcnt vmcnt(25) lgkmcnt(4)
    v_mfma_f32_16x16x32_bf16 v[128:131], v[224:227], v[192:195], v[128:131]
    v_mfma_f32_16x16x32_bf16 v[132:135], v[228:231], v[192:195], v[132:135]
    v_mfma_f32_16x16x32_bf16 v[136:139], v[232:235], v[192:195], v[136:139]
    v_mfma_f32_16x16x32_bf16 v[140:143], v[236:239], v[192:195], v[140:143]
    s_cmp_le_u32 s55, 4
    s_cselect_b32 s49, 5, 4
    s_or_b32 s49, s49, s54
    s_lshl_b32 s49, s49, 15
    s_add_u32 s49, s49, s50
    buffer_load_dwordx4 v[192:195], v28, s[12:15], s49 offen offset:0 sc1
    s_add_u32 m0, s23, 0
    s_cmp_le_u32 s55, 5
    s_cselect_b32 s21, 6, 5
    s_or_b32 s21, s21, s54
    s_lshl_b32 s21, s21, 7
    buffer_load_dwordx4 v16, s[28:31], s21 offen offset:0  lds
    v_mfma_f32_16x16x32_bf16 v[144:147], v[224:227], v[196:199], v[144:147]
    v_mfma_f32_16x16x32_bf16 v[148:151], v[228:231], v[196:199], v[148:151]
    v_mfma_f32_16x16x32_bf16 v[152:155], v[232:235], v[196:199], v[152:155]
    v_mfma_f32_16x16x32_bf16 v[156:159], v[236:239], v[196:199], v[156:159]
    buffer_load_dwordx4 v[196:199], v28, s[12:15], s49 offen offset:1024 sc1
    ds_read_b128 v[224:227], v20 offset:40960
    ds_read_b128 v[228:231], v20 offset:43008
    ds_read_b128 v[232:235], v20 offset:45056
    ds_read_b128 v[236:239], v20 offset:47104
    s_waitcnt vmcnt(14) lgkmcnt(4)
    s_mov_b64 exec, 1
    ds_add_u32 v32, v33 offset:16
    s_mov_b64 exec, -1
    v_mfma_f32_16x16x32_bf16 v[128:131], v[240:243], v[200:203], v[128:131]
    v_mfma_f32_16x16x32_bf16 v[132:135], v[244:247], v[200:203], v[132:135]
    v_mfma_f32_16x16x32_bf16 v[136:139], v[248:251], v[200:203], v[136:139]
    v_mfma_f32_16x16x32_bf16 v[140:143], v[252:255], v[200:203], v[140:143]
    buffer_load_dwordx4 v[200:203], v28, s[12:15], s49 offen offset:2048 sc1
    buffer_load_dwordx4 v17, s[28:31], s21 offen offset:1024  lds
    v_mfma_f32_16x16x32_bf16 v[144:147], v[240:243], v[204:207], v[144:147]
    v_mfma_f32_16x16x32_bf16 v[148:151], v[244:247], v[204:207], v[148:151]
    v_mfma_f32_16x16x32_bf16 v[152:155], v[248:251], v[204:207], v[152:155]
    v_mfma_f32_16x16x32_bf16 v[156:159], v[252:255], v[204:207], v[156:159]
    buffer_load_dwordx4 v[204:207], v28, s[12:15], s49 offen offset:3072 sc1
    ds_read_b128 v[240:243], v21 offset:40960
    ds_read_b128 v[244:247], v21 offset:43008
    ds_read_b128 v[248:251], v21 offset:45056
    ds_read_b128 v[252:255], v21 offset:47104
    s_waitcnt vmcnt(23) lgkmcnt(4)
    v_mfma_f32_16x16x32_bf16 v[128:131], v[224:227], v[208:211], v[128:131]
    v_mfma_f32_16x16x32_bf16 v[132:135], v[228:231], v[208:211], v[132:135]
    v_mfma_f32_16x16x32_bf16 v[136:139], v[232:235], v[208:211], v[136:139]
    v_mfma_f32_16x16x32_bf16 v[140:143], v[236:239], v[208:211], v[140:143]
    ds_read_b32 v34, v32 offset:16
    buffer_load_dwordx4 v[208:211], v29, s[12:15], s49 offen offset:0 sc1
    buffer_load_dwordx4 v18, s[28:31], s21 offen offset:2048  lds
    v_mfma_f32_16x16x32_bf16 v[144:147], v[224:227], v[212:215], v[144:147]
    v_mfma_f32_16x16x32_bf16 v[148:151], v[228:231], v[212:215], v[148:151]
    v_mfma_f32_16x16x32_bf16 v[152:155], v[232:235], v[212:215], v[152:155]
    v_mfma_f32_16x16x32_bf16 v[156:159], v[236:239], v[212:215], v[156:159]
    buffer_load_dwordx4 v[212:215], v29, s[12:15], s49 offen offset:1024 sc1
    s_waitcnt lgkmcnt(0)
    v_readfirstlane_b32 s38, v34
    s_nop 1
    s_cmp_ge_u32 s38, 12
    s_cbranch_scc1 L_st3_ok
L_st3:
    ds_read_b32 v34, v32 offset:16
    s_waitcnt lgkmcnt(0)
    v_readfirstlane_b32 s38, v34
    s_nop 1
    s_cmp_ge_u32 s38, 12
    s_cbranch_scc1 L_st3_ok
    s_sub_u32 s96, s96, 1
    s_cbranch_scc1 L_st3_ok
    s_sleep 0
    s_branch L_st3
L_st3_ok:
    ds_read_b128 v[224:227], v20 offset:49152
    ds_read_b128 v[228:231], v20 offset:51200
    ds_read_b128 v[232:235], v20 offset:53248
    ds_read_b128 v[236:239], v20 offset:55296
    s_waitcnt vmcnt(23)
    v_mfma_f32_16x16x32_bf16 v[128:131], v[240:243], v[216:219], v[128:131]
    v_mfma_f32_16x16x32_bf16 v[132:135], v[244:247], v[216:219], v[132:135]
    v_mfma_f32_16x16x32_bf16 v[136:139], v[248:251], v[216:219], v[136:139]
    v_mfma_f32_16x16x32_bf16 v[140:143], v[252:255], v[216:219], v[140:143]
    buffer_load_dwordx4 v[216:219], v29, s[12:15], s49 offen offset:2048 sc1
    buffer_load_dwordx4 v19, s[28:31], s21 offen offset:3072  lds
    v_mfma_f32_16x16x32_bf16 v[144:147], v[240:243], v[220:223], v[144:147]
    v_mfma_f32_16x16x32_bf16 v[148:151], v[244:247], v[220:223], v[148:151]
    v_mfma_f32_16x16x32_bf16 v[152:155], v[248:251], v[220:223], v[152:155]
    v_mfma_f32_16x16x32_bf16 v[156:159], v[252:255], v[220:223], v[156:159]
    buffer_load_dwordx4 v[220:223], v29, s[12:15], s49 offen offset:3072 sc1
    ds_read_b128 v[240:243], v21 offset:49152
    ds_read_b128 v[244:247], v21 offset:51200
    ds_read_b128 v[248:251], v21 offset:53248
    ds_read_b128 v[252:255], v21 offset:55296
    s_waitcnt vmcnt(22) lgkmcnt(4)
    v_mfma_f32_16x16x32_bf16 v[128:131], v[224:227], v[160:163], v[128:131]
    v_mfma_f32_16x16x32_bf16 v[132:135], v[228:231], v[160:163], v[132:135]
    v_mfma_f32_16x16x32_bf16 v[136:139], v[232:235], v[160:163], v[136:139]
    v_mfma_f32_16x16x32_bf16 v[140:143], v[236:239], v[160:163], v[140:143]
    s_cmp_le_u32 s55, 5
    s_cselect_b32 s49, 6, 5
    s_or_b32 s49, s49, s54
    s_lshl_b32 s49, s49, 15
    s_add_u32 s49, s49, s50
    buffer_load_dwordx4 v[160:163], v28, s[12:15], s49 offen offset:0 sc1
    s_add_u32 m0, s23, 16384
    s_cmp_le_u32 s55, 6
    s_cselect_b32 s21, 7, 6
    s_or_b32 s21, s21, s54
    s_lshl_b32 s21, s21, 7
    buffer_load_dwordx4 v16, s[28:31], s21 offen offset:0  lds
    v_mfma_f32_16x16x32_bf16 v[144:147], v[224:227], v[164:167], v[144:147]
    v_mfma_f32_16x16x32_bf16 v[148:151], v[228:231], v[164:167], v[148:151]
    v_mfma_f32_16x16x32_bf16 v[152:155], v[232:235], v[164:167], v[152:155]
    v_mfma_f32_16x16x32_bf16 v[156:159], v[236:239], v[164:167], v[156:159]
    buffer_load_dwordx4 v[164:167], v28, s[12:15], s49 offen offset:1024 sc1
    ds_read_b128 v[224:227], v20 offset:57344
    ds_read_b128 v[228:231], v20 offset:59392
    ds_read_b128 v[232:235], v20 offset:61440
    ds_read_b128 v[236:239], v20 offset:63488
    s_waitcnt vmcnt(15) lgkmcnt(4)
    s_mov_b64 exec, 1
    ds_add_u32 v32, v33 offset:16
    s_mov_b64 exec, -1
    v_mfma_f32_16x16x32_bf16 v[128:131], v[240:243], v[168:171], v[128:131]
    v_mfma_f32_16x16x32_bf16 v[132:135], v[244:247], v[168:171], v[132:135]
    v_mfma_f32_16x16x32_bf16 v[136:139], v[248:251], v[168:171], v[136:139]
    v_mfma_f32_16x16x32_bf16 v[140:143], v[252:255], v[168:171], v[140:143]
    buffer_load_dwordx4 v[168:171], v28, s[12:15], s49 offen offset:2048 sc1
    buffer_load_dwordx4 v17, s[28:31], s21 offen offset:1024  lds
    v_mfma_f32_16x16x32_bf16 v[144:147], v[240:243], v[172:175], v[144:147]
    v_mfma_f32_16x16x32_bf16 v[148:151], v[244:247], v[172:175], v[148:151]
    v_mfma_f32_16x16x32_bf16 v[152:155], v[248:251], v[172:175], v[152:155]
    v_mfma_f32_16x16x32_bf16 v[156:159], v[252:255], v[172:175], v[156:159]
    buffer_load_dwordx4 v[172:175], v28, s[12:15], s49 offen offset:3072 sc1
    ds_read_b128 v[240:243], v21 offset:57344
    ds_read_b128 v[244:247], v21 offset:59392
    ds_read_b128 v[248:251], v21 offset:61440
    ds_read_b128 v[252:255], v21 offset:63488
    s_waitcnt vmcnt(22) lgkmcnt(4)
    v_mfma_f32_16x16x32_bf16 v[128:131], v[224:227], v[176:179], v[128:131]
    v_mfma_f32_16x16x32_bf16 v[132:135], v[228:231], v[176:179], v[132:135]
    v_mfma_f32_16x16x32_bf16 v[136:139], v[232:235], v[176:179], v[136:139]
    v_mfma_f32_16x16x32_bf16 v[140:143], v[236:239], v[176:179], v[140:143]
    ds_read_b32 v34, v32 offset:16
    buffer_load_dwordx4 v[176:179], v29, s[12:15], s49 offen offset:0 sc1
    buffer_load_dwordx4 v18, s[28:31], s21 offen offset:2048  lds
    v_mfma_f32_16x16x32_bf16 v[144:147], v[224:227], v[180:183], v[144:147]
    v_mfma_f32_16x16x32_bf16 v[148:151], v[228:231], v[180:183], v[148:151]
    v_mfma_f32_16x16x32_bf16 v[152:155], v[232:235], v[180:183], v[152:155]
    v_mfma_f32_16x16x32_bf16 v[156:159], v[236:239], v[180:183], v[156:159]
    buffer_load_dwordx4 v[180:183], v29, s[12:15], s49 offen offset:1024 sc1
    s_waitcnt lgkmcnt(0)
    v_readfirstlane_b32 s38, v34
    s_nop 1
    s_cmp_ge_u32 s38, 16
    s_cbranch_scc1 L_st4_ok
L_st4:
    ds_read_b32 v34, v32 offset:16
    s_waitcnt lgkmcnt(0)
    v_readfirstlane_b32 s38, v34
    s_nop 1
    s_cmp_ge_u32 s38, 16
    s_cbranch_scc1 L_st4_ok
    s_sub_u32 s96, s96, 1
    s_cbranch_scc1 L_st4_ok
    s_sleep 0
    s_branch L_st4
L_st4_ok:
    ds_read_b128 v[224:227], v22 offset:16384
    ds_read_b128 v[228:231], v22 offset:18432
    ds_read_b128 v[232:235], v22 offset:20480
    ds_read_b128 v[236:239], v22 offset:22528
    s_waitcnt vmcnt(22)
    v_mfma_f32_16x16x32_bf16 v[128:131], v[240:243], v[184:187], v[128:131]
    v_mfma_f32_16x16x32_bf16 v[132:135], v[244:247], v[184:187], v[132:135]
    v_mfma_f32_16x16x32_bf16 v[136:139], v[248:251], v[184:187], v[136:139]
    v_mfma_f32_16x16x32_bf16 v[140:143], v[252:255], v[184:187], v[140:143]
    buffer_load_dwordx4 v[184:187], v29, s[12:15], s49 offen offset:2048 sc1
    buffer_load_dwordx4 v19, s[28:31], s21 offen offset:3072  lds
    v_mfma_f32_16x16x32_bf16 v[144:147], v[240:243], v[188:191], v[144:147]
    v_mfma_f32_16x16x32_bf16 v[148:151], v[244:247], v[188:191], v[148:151]
    v_mfma_f32_16x16x32_bf16 v[152:155], v[248:251], v[188:191], v[152:155]
    v_mfma_f32_16x16x32_bf16 v[156:159], v[252:255], v[188:191], v[156:159]
    buffer_load_dwordx4 v[188:191], v29, s[12:15], s49 offen offset:3072 sc1
    ds_read_b128 v[240:243], v23 offset:16384
    ds_read_b128 v[244:247], v23 offset:18432
    ds_read_b128 v[248:251], v23 offset:20480
    ds_read_b128 v[252:255], v23 offset:22528
    s_waitcnt vmcnt(21) lgkmcnt(4)
    v_mfma_f32_16x16x32_bf16 v[128:131], v[224:227], v[192:195], v[128:131]
    v_mfma_f32_16x16x32_bf16 v[132:135], v[228:231], v[192:195], v[132:135]
    v_mfma_f32_16x16x32_bf16 v[136:139], v[232:235], v[192:195], v[136:139]
    v_mfma_f32_16x16x32_bf16 v[140:143], v[236:239], v[192:195], v[140:143]
    s_cmp_le_u32 s55, 6
    s_cselect_b32 s49, 7, 6
    s_or_b32 s49, s49, s54
    s_lshl_b32 s49, s49, 15
    s_add_u32 s49, s49, s50
    buffer_load_dwordx4 v[192:195], v28, s[12:15], s49 offen offset:0 sc1
    s_add_u32 m0, s23, 32768
    s_xor_b32 s21, s54, 8
    s_lshl_b32 s21, s21, 7
    buffer_load_dwordx4 v16, s[28:31], s21 offen offset:0  lds
    v_mfma_f32_16x16x32_bf16 v[144:147], v[224:227], v[196:199], v[144:147]
    v_mfma_f32_16x16x32_bf16 v[148:151], v[228:231], v[196:199], v[148:151]
    v_mfma_f32_16x16x32_bf16 v[152:155], v[232:235], v[196:199], v[152:155]
    v_mfma_f32_16x16x32_bf16 v[156:159], v[236:239], v[196:199], v[156:159]
    buffer_load_dwordx4 v[196:199], v28, s[12:15], s49 offen offset:1024 sc1
    s_mov_b64 exec, 0xff00
    buffer_load_dword v31, v30, s[12:15], s52 offen sc1
    s_mov_b64 exec, -1
    ds_read_b128 v[224:227], v22 offset:24576
    ds_read_b128 v[228:231], v22 offset:26624
    ds_read_b128 v[232:235], v22 offset:28672
    ds_read_b128 v[236:239], v22 offset:30720
    s_waitcnt vmcnt(17) lgkmcnt(4)
    s_mov_b64 exec, 1
    ds_add_u32 v32, v33 offset:16
    s_mov_b64 exec, -1
    v_mfma_f32_16x16x32_bf16 v[128:131], v[240:243], v[200:203], v[128:131]
    v_mfma_f32_16x16x32_bf16 v[132:135], v[244:247], v[200:203], v[132:135]
    v_mfma_f32_16x16x32_bf16 v[136:139], v[248:251], v[200:203], v[136:139]
    v_mfma_f32_16x16x32_bf16 v[140:143], v[252:255], v[200:203], v[140:143]
    buffer_load_dwordx4 v[200:203], v28, s[12:15], s49 offen offset:2048 sc1
    buffer_load_dwordx4 v17, s[28:31], s21 offen offset:1024  lds
    v_mfma_f32_16x16x32_bf16 v[144:147], v[240:243], v[204:207], v[144:147]
    v_mfma_f32_16x16x32_bf16 v[148:151], v[244:247], v[204:207], v[148:151]
    v_mfma_f32_16x16x32_bf16 v[152:155], v[248:251], v[204:207], v[152:155]
    v_mfma_f32_16x16x32_bf16 v[156:159], v[252:255], v[204:207], v[156:159]
    buffer_load_dwordx4 v[204:207], v28, s[12:15], s49 offen offset:3072 sc1
    ds_read_b128 v[240:243], v23 offset:24576
    ds_read_b128 v[244:247], v23 offset:26624
    ds_read_b128 v[248:251], v23 offset:28672
    ds_read_b128 v[252:255], v23 offset:30720
    s_waitcnt vmcnt(22) lgkmcnt(4)
    v_mfma_f32_16x16x32_bf16 v[128:131], v[224:227], v[208:211], v[128:131]
    v_mfma_f32_16x16x32_bf16 v[132:135], v[228:231], v[208:211], v[132:135]
    v_mfma_f32_16x16x32_bf16 v[136:139], v[232:235], v[208:211], v[136:139]
    v_mfma_f32_16x16x32_bf16 v[140:143], v[236:239], v[208:211], v[140:143]
    ds_read_b32 v34, v32 offset:16
    buffer_load_dwordx4 v[208:211], v29, s[12:15], s49 offen offset:0 sc1
    buffer_load_dwordx4 v18, s[28:31], s21 offen offset:2048  lds
    v_mfma_f32_16x16x32_bf16 v[144:147], v[224:227], v[212:215], v[144:147]
    v_mfma_f32_16x16x32_bf16 v[148:151], v[228:231], v[212:215], v[148:151]
    v_mfma_f32_16x16x32_bf16 v[152:155], v[232:235], v[212:215], v[152:155]
    v_mfma_f32_16x16x32_bf16 v[156:159], v[236:239], v[212:215], v[156:159]
    buffer_load_dwordx4 v[212:215], v29, s[12:15], s49 offen offset:1024 sc1
    s_waitcnt lgkmcnt(0)
    v_readfirstlane_b32 s38, v34
    s_nop 1
    s_cmp_ge_u32 s38, 20
    s_cbranch_scc1 L_st5_ok
L_st5:
    ds_read_b32 v34, v32 offset:16
    s_waitcnt lgkmcnt(0)
    v_readfirstlane_b32 s38, v34
    s_nop 1
    s_cmp_ge_u32 s38, 20
    s_cbranch_scc1 L_st5_ok
    s_sub_u32 s96, s96, 1
    s_cbranch_scc1 L_st5_ok
    s_sleep 0
    s_branch L_st5
L_st5_ok:
    ds_read_b128 v[224:227], v20 offset:0
    ds_read_b128 v[228:231], v20 offset:2048
    ds_read_b128 v[232:235], v20 offset:4096
    ds_read_b128 v[236:239], v20 offset:6144
    s_waitcnt vmcnt(22)
    v_mfma_f32_16x16x32_bf16 v[128:131], v[240:243], v[216:219], v[128:131]
    v_mfma_f32_16x16x32_bf16 v[132:135], v[244:247], v[216:219], v[132:135]
    v_mfma_f32_16x16x32_bf16 v[136:139], v[248:251], v[216:219], v[136:139]
    v_mfma_f32_16x16x32_bf16 v[140:143], v[252:255], v[216:219], v[140:143]
    buffer_load_dwordx4 v[216:219], v29, s[12:15], s49 offen offset:2048 sc1
    buffer_load_dwordx4 v19, s[28:31], s21 offen offset:3072  lds
    v_mfma_f32_16x16x32_bf16 v[144:147], v[240:243], v[220:223], v[144:147]
    v_mfma_f32_16x16x32_bf16 v[148:151], v[244:247], v[220:223], v[148:151]
    v_mfma_f32_16x16x32_bf16 v[152:155], v[248:251], v[220:223], v[152:155]
    v_mfma_f32_16x16x32_bf16 v[156:159], v[252:255], v[220:223], v[156:159]
    buffer_load_dwordx4 v[220:223], v29, s[12:15], s49 offen offset:3072 sc1
    s_waitcnt vmcnt(9)
L_h2poll:
    v_cmp_ne_u32 vcc, s93, v31
    s_nop 1
    s_and_b32 s38, vcc_lo, 0xff00
    s_cbranch_scc0 L_h2go
    s_sub_u32 s96, s96, 1
    s_cbranch_scc1 L_h2go
    s_sleep 2
    s_mov_b64 exec, 0xff00
    buffer_load_dword v31, v30, s[12:15], s52 offen sc1
    s_mov_b64 exec, -1
    s_waitcnt vmcnt(0)
    s_branch L_h2poll
L_h2go:
    ds_read_b128 v[240:243], v21 offset:0
    ds_read_b128 v[244:247], v21 offset:2048
    ds_read_b128 v[248:251], v21 offset:4096
    ds_read_b128 v[252:255], v21 offset:6144
    s_waitcnt vmcnt(22) lgkmcnt(4)
    v_mfma_f32_16x16x32_bf16 v[128:131], v[224:227], v[160:163], v[128:131]
    v_mfma_f32_16x16x32_bf16 v[132:135], v[228:231], v[160:163], v[132:135]
    v_mfma_f32_16x16x32_bf16 v[136:139], v[232:235], v[160:163], v[136:139]
    v_mfma_f32_16x16x32_bf16 v[140:143], v[236:239], v[160:163], v[140:143]
    s_xor_b32 s49, s54, 8
    s_lshl_b32 s49, s49, 15
    s_add_u32 s49, s49, s50
    buffer_load_dwordx4 v[160:163], v28, s[12:15], s49 offen offset:0 sc1
    s_add_u32 m0, s23, 49152
    s_xor_b32 s21, s54, 9
    s_lshl_b32 s21, s21, 7
    buffer_load_dwordx4 v16, s[28:31], s21 offen offset:0  lds
    v_mfma_f32_16x16x32_bf16 v[144:147], v[224:227], v[164:167], v[144:147]
    v_mfma_f32_16x16x32_bf16 v[148:151], v[228:231], v[164:167], v[148:151]
    v_mfma_f32_16x16x32_bf16 v[152:155], v[232:235], v[164:167], v[152:155]
    v_mfma_f32_16x16x32_bf16 v[156:159], v[236:239], v[164:167], v[156:159]
    buffer_load_dwordx4 v[164:167], v28, s[12:15], s49 offen offset:1024 sc1
    ds_read_b128 v[224:227], v20 offset:8192
    ds_read_b128 v[228:231], v20 offset:10240
    ds_read_b128 v[232:235], v20 offset:12288
    ds_read_b128 v[236:239], v20 offset:14336
    s_waitcnt vmcnt(17) lgkmcnt(4)
    s_mov_b64 exec, 1
    ds_add_u32 v32, v33 offset:16
    s_mov_b64 exec, -1
    v_mfma_f32_16x16x32_bf16 v[128:131], v[240:243], v[168:171], v[128:131]
    v_mfma_f32_16x16x32_bf16 v[132:135], v[244:247], v[168:171], v[132:135]
    v_mfma_f32_16x16x32_bf16 v[136:139], v[248:251], v[168:171], v[136:139]
    v_mfma_f32_16x16x32_bf16 v[140:143], v[252:255], v[168:171], v[140:143]
    buffer_load_dwordx4 v[168:171], v28, s[12:15], s49 offen offset:2048 sc1
    buffer_load_dwordx4 v17, s[28:31], s21 offen offset:1024  lds
    v_mfma_f32_16x16x32_bf16 v[144:147], v[240:243], v[172:175], v[144:147]
    v_mfma_f32_16x16x32_bf16 v[148:151], v[244:247], v[172:175], v[148:151]
    v_mfma_f32_16x16x32_bf16 v[152:155], v[248:251], v[172:175], v[152:155]
    v_mfma_f32_16x16x32_bf16 v[156:159], v[252:255], v[172:175], v[156:159]
    buffer_load_dwordx4 v[172:175], v28, s[12:15], s49 offen offset:3072 sc1
    ds_read_b128 v[240:243], v21 offset:8192
    ds_read_b128 v[244:247], v21 offset:10240
    ds_read_b128 v[248:251], v21 offset:12288
    ds_read_b128 v[252:255], v21 offset:14336
    s_waitcnt vmcnt(22) lgkmcnt(4)
    v_mfma_f32_16x16x32_bf16 v[128:131], v[224:227], v[176:179], v[128:131]
    v_mfma_f32_16x16x32_bf16 v[132:135], v[228:231], v[176:179], v[132:135]
    v_mfma_f32_16x16x32_bf16 v[136:139], v[232:235], v[176:179], v[136:139]
    v_mfma_f32_16x16x32_bf16 v[140:143], v[236:239], v[176:179], v[140:143]
    ds_read_b32 v34, v32 offset:16
    buffer_load_dwordx4 v[176:179], v29, s[12:15], s49 offen offset:0 sc1
    buffer_load_dwordx4 v18, s[28:31], s21 offen offset:2048  lds
    v_mfma_f32_16x16x32_bf16 v[144:147], v[224:227], v[180:183], v[144:147]
    v_mfma_f32_16x16x32_bf16 v[148:151], v[228:231], v[180:183], v[148:151]
    v_mfma_f32_16x16x32_bf16 v[152:155], v[232:235], v[180:183], v[152:155]
    v_mfma_f32_16x16x32_bf16 v[156:159], v[236:239], v[180:183], v[156:159]
    buffer_load_dwordx4 v[180:183], v29, s[12:15], s49 offen offset:1024 sc1
    s_waitcnt lgkmcnt(0)
    v_readfirstlane_b32 s38, v34
    s_nop 1
    s_cmp_ge_u32 s38, 24
    s_cbranch_scc1 L_st6_ok
L_st6:
    ds_read_b32 v34, v32 offset:16
    s_waitcnt lgkmcnt(0)
    v_readfirstlane_b32 s38, v34
    s_nop 1
    s_cmp_ge_u32 s38, 24
    s_cbranch_scc1 L_st6_ok
    s_sub_u32 s96, s96, 1
    s_cbranch_scc1 L_st6_ok
    s_sleep 0
    s_branch L_st6
L_st6_ok:
    ds_read_b128 v[224:227], v20 offset:16384
    ds_read_b128 v[228:231], v20 offset:18432
    ds_read_b128 v[232:235], v20 offset:20480
    ds_read_b128 v[236:239], v20 offset:22528
    s_waitcnt vmcnt(22)
    v_mfma_f32_16x16x32_bf16 v[128:131], v[240:243], v[184:187], v[128:131]
    v_mfma_f32_16x16x32_bf16 v[132:135], v[244:247], v[184:187], v[132:135]
    v_mfma_f32_16x16x32_bf16 v[136:139], v[248:251], v[184:187], v[136:139]
    v_mfma_f32_16x16x32_bf16 v[140:143], v[252:255], v[184:187], v[140:143]
    buffer_load_dwordx4 v[184:187], v29, s[12:15], s49 offen offset:2048 sc1
    buffer_load_dwordx4 v19, s[28:31], s21 offen offset:3072  lds
    v_mfma_f32_16x16x32_bf16 v[144:147], v[240:243], v[188:191], v[144:147]
    v_mfma_f32_16x16x32_bf16 v[148:151], v[244:247], v[188:191], v[148:151]
    v_mfma_f32_16x16x32_bf16 v[152:155], v[248:251], v[188:191], v[152:155]
    v_mfma_f32_16x16x32_bf16 v[156:159], v[252:255], v[188:191], v[156:159]
    buffer_load_dwordx4 v[188:191], v29, s[12:15], s49 offen offset:3072 sc1
    ds_read_b128 v[240:243], v21 offset:16384
    ds_read_b128 v[244:247], v21 offset:18432
    ds_read_b128 v[248:251], v21 offset:20480
    ds_read_b128 v[252:255], v21 offset:22528
    s_waitcnt vmcnt(22) lgkmcnt(4)
    v_mfma_f32_16x16x32_bf16 v[128:131], v[224:227], v[192:195], v[128:131]
    v_mfma_f32_16x16x32_bf16 v[132:135], v[228:231], v[192:195], v[132:135]
    v_mfma_f32_16x16x32_bf16 v[136:139], v[232:235], v[192:195], v[136:139]
    v_mfma_f32_16x16x32_bf16 v[140:143], v[236:239], v[192:195], v[140:143]
    s_xor_b32 s49, s54, 9
    s_lshl_b32 s49, s49, 15
    s_add_u32 s49, s49, s50
    buffer_load_dwordx4 v[192:195], v28, s[12:15], s49 offen offset:0 sc1
    s_add_u32 m0, s23, 81920
    s_xor_b32 s21, s54, 10
    s_lshl_b32 s21, s21, 7
    buffer_load_dwordx4 v16, s[28:31], s21 offen offset:0  lds
    v_mfma_f32_16x16x32_bf16 v[144:147], v[224:227], v[196:199], v[144:147]
    v_mfma_f32_16x16x32_bf16 v[148:151], v[228:231], v[196:199], v[148:151]
    v_mfma_f32_16x16x32_bf16 v[152:155], v[232:235], v[196:199], v[152:155]
    v_mfma_f32_16x16x32_bf16 v[156:159], v[236:239], v[196:199], v[156:159]
    buffer_load_dwordx4 v[196:199], v28, s[12:15], s49 offen offset:1024 sc1
    ds_read_b128 v[224:227], v20 offset:24576
    ds_read_b128 v[228:231], v20 offset:26624
    ds_read_b128 v[232:235], v20 offset:28672
    ds_read_b128 v[236:239], v20 offset:30720
    s_waitcnt vmcnt(16) lgkmcnt(4)
    s_mov_b64 exec, 1
    ds_add_u32 v32, v33 offset:16
    s_mov_b64 exec, -1
    v_mfma_f32_16x16x32_bf16 v[128:131], v[240:243], v[200:203], v[128:131]
    v_mfma_f32_16x16x32_bf16 v[132:135], v[244:247], v[200:203], v[132:135]
    v_mfma_f32_16x16x32_bf16 v[136:139], v[248:251], v[200:203], v[136:139]
    v_mfma_f32_16x16x32_bf16 v[140:143], v[252:255], v[200:203], v[140:143]
    buffer_load_dwordx4 v[200:203], v28, s[12:15], s49 offen offset:2048 sc1
    buffer_load_dwordx4 v17, s[28:31], s21 offen offset:1024  lds
    v_mfma_f32_16x16x32_bf16 v[144:147], v[240:243], v[204:207], v[144:147]
    v_mfma_f32_16x16x32_bf16 v[148:151], v[244:247], v[204:207], v[148:151]
    v_mfma_f32_16x16x32_bf16 v[152:155], v[248:251], v[204:207], v[152:155]
    v_mfma_f32_16x16x32_bf16 v[156:159], v[252:255], v[204:207], v[156:159]
    buffer_load_dwordx4 v[204:207], v28, s[12:15], s49 offen offset:3072 sc1
    ds_read_b128 v[240:243], v21 offset:24576
    ds_read_b128 v[244:247], v21 offset:26624
    ds_read_b128 v[248:251], v21 offset:28672
    ds_read_b128 v[252:255], v21 offset:30720
    s_waitcnt vmcnt(21) lgkmcnt(4)
    v_mfma_f32_16x16x32_bf16 v[128:131], v[224:227], v[208:211], v[128:131]
    v_mfma_f32_16x16x32_bf16 v[132:135], v[228:231], v[208:211], v[132:135]
    v_mfma_f32_16x16x32_bf16 v[136:139], v[232:235], v[208:211], v[136:139]
    v_mfma_f32_16x16x32_bf16 v[140:143], v[236:239], v[208:211], v[140:143]
    ds_read_b32 v34, v32 offset:16
    buffer_load_dwordx4 v[208:211], v29, s[12:15], s49 offen offset:0 sc1
    buffer_load_dwordx4 v18, s[28:31], s21 offen offset:2048  lds
    v_mfma_f32_16x16x32_bf16 v[144:147], v[224:227], v[212:215], v[144:147]
    v_mfma_f32_16x16x32_bf16 v[148:151], v[228:231], v[212:215], v[148:151]
    v_mfma_f32_16x16x32_bf16 v[152:155], v[232:235], v[212:215], v[152:155]
    v_mfma_f32_16x16x32_bf16 v[156:159], v[236:239], v[212:215], v[156:159]
    buffer_load_dwordx4 v[212:215], v29, s[12:15], s49 offen offset:1024 sc1
    s_waitcnt lgkmcnt(0)
    v_readfirstlane_b32 s38, v34
    s_nop 1
    s_cmp_ge_u32 s38, 28
    s_cbranch_scc1 L_st7_ok
L_st7:
    ds_read_b32 v34, v32 offset:16
    s_waitcnt lgkmcnt(0)
    v_readfirstlane_b32 s38, v34
    s_nop 1
    s_cmp_ge_u32 s38, 28
    s_cbranch_scc1 L_st7_ok
    s_sub_u32 s96, s96, 1
    s_cbranch_scc1 L_st7_ok
    s_sleep 0
    s_branch L_st7
L_st7_ok:
    ds_read_b128 v[224:227], v20 offset:32768
    ds_read_b128 v[228:231], v20 offset:34816
    ds_read_b128 v[232:235], v20 offset:36864
    ds_read_b128 v[236:239], v20 offset:38912
    s_waitcnt vmcnt(21)
    v_mfma_f32_16x16x32_bf16 v[128:131], v[240:243], v[216:219], v[128:131]
    v_mfma_f32_16x16x32_bf16 v[132:135], v[244:247], v[216:219], v[132:135]
    v_mfma_f32_16x16x32_bf16 v[136:139], v[248:251], v[216:219], v[136:139]
    v_mfma_f32_16x16x32_bf16 v[140:143], v[252:255], v[216:219], v[140:143]
    buffer_load_dwordx4 v[216:219], v29, s[12:15], s49 offen offset:2048 sc1
    buffer_load_dwordx4 v19, s[28:31], s21 offen offset:3072  lds
    v_mfma_f32_16x16x32_bf16 v[144:147], v[240:243], v[220:223], v[144:147]
    v_mfma_f32_16x16x32_bf16 v[148:151], v[244:247], v[220:223], v[148:151]
    v_mfma_f32_16x16x32_bf16 v[152:155], v[248:251], v[220:223], v[152:155]
    v_mfma_f32_16x16x32_bf16 v[156:159], v[252:255], v[220:223], v[156:159]
    buffer_load_dwordx4 v[220:223], v29, s[12:15], s49 offen offset:3072 sc1
    ds_read_b128 v[240:243], v21 offset:32768
    ds_read_b128 v[244:247], v21 offset:34816
    ds_read_b128 v[248:251], v21 offset:36864
    ds_read_b128 v[252:255], v21 offset:38912
    s_waitcnt vmcnt(21) lgkmcnt(4)
    v_mfma_f32_16x16x32_bf16 v[128:131], v[224:227], v[160:163], v[128:131]
    v_mfma_f32_16x16x32_bf16 v[132:135], v[228:231], v[160:163], v[132:135]
    v_mfma_f32_16x16x32_bf16 v[136:139], v[232:235], v[160:163], v[136:139]
    v_mfma_f32_16x16x32_bf16 v[140:143], v[236:239], v[160:163], v[140:143]
    s_xor_b32 s49, s54, 10
    s_lshl_b32 s49, s49, 15
    s_add_u32 s49, s49, s50
    buffer_load_dwordx4 v[160:163], v28, s[12:15], s49 offen offset:0 sc1
    s_add_u32 m0, s23, 0
    s_xor_b32 s21, s54, 11
    s_lshl_b32 s21, s21, 7
    buffer_load_dwordx4 v16, s[28:31], s21 offen offset:0  lds
    v_mfma_f32_16x16x32_bf16 v[144:147], v[224:227], v[164:167], v[144:147]
    v_mfma_f32_16x16x32_bf16 v[148:151], v[228:231], v[164:167], v[148:151]
    v_mfma_f32_16x16x32_bf16 v[152:155], v[232:235], v[164:167], v[152:155]
    v_mfma_f32_16x16x32_bf16 v[156:159], v[236:239], v[164:167], v[156:159]
    buffer_load_dwordx4 v[164:167], v28, s[12:15], s49 offen offset:1024 sc1
    ds_read_b128 v[224:227], v20 offset:40960
    ds_read_b128 v[228:231], v20 offset:43008
    ds_read_b128 v[232:235], v20 offset:45056
    ds_read_b128 v[236:239], v20 offset:47104
    s_waitcnt vmcnt(16) lgkmcnt(4)
    s_mov_b64 exec, 1
    ds_add_u32 v32, v33 offset:16
    s_mov_b64 exec, -1
    v_mfma_f32_16x16x32_bf16 v[128:131], v[240:243], v[168:171], v[128:131]
    v_mfma_f32_16x16x32_bf16 v[132:135], v[244:247], v[168:171], v[132:135]
    v_mfma_f32_16x16x32_bf16 v[136:139], v[248:251], v[168:171], v[136:139]
    v_mfma_f32_16x16x32_bf16 v[140:143], v[252:255], v[168:171], v[140:143]
    buffer_load_dwordx4 v[168:171], v28, s[12:15], s49 offen offset:2048 sc1
    buffer_load_dwordx4 v17, s[28:31], s21 offen offset:1024  lds
    v_mfma_f32_16x16x32_bf16 v[144:147], v[240:243], v[172:175], v[144:147]
    v_mfma_f32_16x16x32_bf16 v[148:151], v[244:247], v[172:175], v[148:151]
    v_mfma_f32_16x16x32_bf16 v[152:155], v[248:251], v[172:175], v[152:155]
    v_mfma_f32_16x16x32_bf16 v[156:159], v[252:255], v[172:175], v[156:159]
    buffer_load_dwordx4 v[172:175], v28, s[12:15], s49 offen offset:3072 sc1
    ds_read_b128 v[240:243], v21 offset:40960
    ds_read_b128 v[244:247], v21 offset:43008
    ds_read_b128 v[248:251], v21 offset:45056
    ds_read_b128 v[252:255], v21 offset:47104
    s_waitcnt vmcnt(21) lgkmcnt(4)
    v_mfma_f32_16x16x32_bf16 v[128:131], v[224:227], v[176:179], v[128:131]
    v_mfma_f32_16x16x32_bf16 v[132:135], v[228:231], v[176:179], v[132:135]
    v_mfma_f32_16x16x32_bf16 v[136:139], v[232:235], v[176:179], v[136:139]
    v_mfma_f32_16x16x32_bf16 v[140:143], v[236:239], v[176:179], v[140:143]
    ds_read_b32 v34, v32 offset:16
    buffer_load_dwordx4 v[176:179], v29, s[12:15], s49 offen offset:0 sc1
    buffer_load_dwordx4 v18, s[28:31], s21 offen offset:2048  lds
    v_mfma_f32_16x16x32_bf16 v[144:147], v[224:227], v[180:183], v[144:147]
    v_mfma_f32_16x16x32_bf16 v[148:151], v[228:231], v[180:183], v[148:151]
    v_mfma_f32_16x16x32_bf16 v[152:155], v[232:235], v[180:183], v[152:155]
    v_mfma_f32_16x16x32_bf16 v[156:159], v[236:239], v[180:183], v[156:159]
    buffer_load_dwordx4 v[180:183], v29, s[12:15], s49 offen offset:1024 sc1
    s_waitcnt lgkmcnt(0)
    v_readfirstlane_b32 s38, v34
    s_nop 1
    s_cmp_ge_u32 s38, 32
    s_cbranch_scc1 L_st8_ok
L_st8:
    ds_read_b32 v34, v32 offset:16
    s_waitcnt lgkmcnt(0)
    v_readfirstlane_b32 s38, v34
    s_nop 1
    s_cmp_ge_u32 s38, 32
    s_cbranch_scc1 L_st8_ok
    s_sub_u32 s96, s96, 1
    s_cbranch_scc1 L_st8_ok
    s_sleep 0
    s_branch L_st8
L_st8_ok:
    ds_read_b128 v[224:227], v20 offset:49152
    ds_read_b128 v[228:231], v20 offset:51200
    ds_read_b128 v[232:235], v20 offset:53248
    ds_read_b128 v[236:239], v20 offset:55296
    s_waitcnt vmcnt(21)
    v_mfma_f32_16x16x32_bf16 v[128:131], v[240:243], v[184:187], v[128:131]
    v_mfma_f32_16x16x32_bf16 v[132:135], v[244:247], v[184:187], v[132:135]
    v_mfma_f32_16x16x32_bf16 v[136:139], v[248:251], v[184:187], v[136:139]
    v_mfma_f32_16x16x32_bf16 v[140:143], v[252:255], v[184:187], v[140:143]
    buffer_load_dwordx4 v[184:187], v29, s[12:15], s49 offen offset:2048 sc1
    buffer_load_dwordx4 v19, s[28:31], s21 offen offset:3072  lds
    v_mfma_f32_16x16x32_bf16 v[144:147], v[240:243], v[188:191], v[144:147]
    v_mfma_f32_16x16x32_bf16 v[148:151], v[244:247], v[188:191], v[148:151]
    v_mfma_f32_16x16x32_bf16 v[152:155], v[248:251], v[188:191], v[152:155]
    v_mfma_f32_16x16x32_bf16 v[156:159], v[252:255], v[188:191], v[156:159]
    buffer_load_dwordx4 v[188:191], v29, s[12:15], s49 offen offset:3072 sc1
    ds_read_b128 v[240:243], v21 offset:49152
    ds_read_b128 v[244:247], v21 offset:51200
    ds_read_b128 v[248:251], v21 offset:53248
    ds_read_b128 v[252:255], v21 offset:55296
    s_waitcnt vmcnt(21) lgkmcnt(4)
    v_mfma_f32_16x16x32_bf16 v[128:131], v[224:227], v[192:195], v[128:131]
    v_mfma_f32_16x16x32_bf16 v[132:135], v[228:231], v[192:195], v[132:135]
    v_mfma_f32_16x16x32_bf16 v[136:139], v[232:235], v[192:195], v[136:139]
    v_mfma_f32_16x16x32_bf16 v[140:143], v[236:239], v[192:195], v[140:143]
    s_xor_b32 s49, s54, 11
    s_lshl_b32 s49, s49, 15
    s_add_u32 s49, s49, s50
    buffer_load_dwordx4 v[192:195], v28, s[12:15], s49 offen offset:0 sc1
    s_add_u32 m0, s23, 16384
    s_xor_b32 s21, s54, 12
    s_lshl_b32 s21, s21, 7
    buffer_load_dwordx4 v16, s[28:31], s21 offen offset:0  lds
    v_mfma_f32_16x16x32_bf16 v[144:147], v[224:227], v[196:199], v[144:147]
    v_mfma_f32_16x16x32_bf16 v[148:151], v[228:231], v[196:199], v[148:151]
    v_mfma_f32_16x16x32_bf16 v[152:155], v[232:235], v[196:199], v[152:155]
    v_mfma_f32_16x16x32_bf16 v[156:159], v[236:239], v[196:199], v[156:159]
    buffer_load_dwordx4 v[196:199], v28, s[12:15], s49 offen offset:1024 sc1
    ds_read_b128 v[224:227], v20 offset:57344
    ds_read_b128 v[228:231], v20 offset:59392
    ds_read_b128 v[232:235], v20 offset:61440
    ds_read_b128 v[236:239], v20 offset:63488
    s_waitcnt vmcnt(16) lgkmcnt(4)
    s_mov_b64 exec, 1
    ds_add_u32 v32, v33 offset:16
    s_mov_b64 exec, -1
    v_mfma_f32_16x16x32_bf16 v[128:131], v[240:243], v[200:203], v[128:131]
    v_mfma_f32_16x16x32_bf16 v[132:135], v[244:247], v[200:203], v[132:135]
    v_mfma_f32_16x16x32_bf16 v[136:139], v[248:251], v[200:203], v[136:139]
    v_mfma_f32_16x16x32_bf16 v[140:143], v[252:255], v[200:203], v[140:143]
    buffer_load_dwordx4 v[200:203], v28, s[12:15], s49 offen offset:2048 sc1
    buffer_load_dwordx4 v17, s[28:31], s21 offen offset:1024  lds
    v_mfma_f32_16x16x32_bf16 v[144:147], v[240:243], v[204:207], v[144:147]
    v_mfma_f32_16x16x32_bf16 v[148:151], v[244:247], v[204:207], v[148:151]
    v_mfma_f32_16x16x32_bf16 v[152:155], v[248:251], v[204:207], v[152:155]
    v_mfma_f32_16x16x32_bf16 v[156:159], v[252:255], v[204:207], v[156:159]
    buffer_load_dwordx4 v[204:207], v28, s[12:15], s49 offen offset:3072 sc1
    ds_read_b128 v[240:243], v21 offset:57344
    ds_read_b128 v[244:247], v21 offset:59392
    ds_read_b128 v[248:251], v21 offset:61440
    ds_read_b128 v[252:255], v21 offset:63488
    s_waitcnt vmcnt(21) lgkmcnt(4)
    v_mfma_f32_16x16x32_bf16 v[128:131], v[224:227], v[208:211], v[128:131]
    v_mfma_f32_16x16x32_bf16 v[132:135], v[228:231], v[208:211], v[132:135]
    v_mfma_f32_16x16x32_bf16 v[136:139], v[232:235], v[208:211], v[136:139]
    v_mfma_f32_16x16x32_bf16 v[140:143], v[236:239], v[208:211], v[140:143]
    ds_read_b32 v34, v32 offset:16
    buffer_load_dwordx4 v[208:211], v29, s[12:15], s49 offen offset:0 sc1
    buffer_load_dwordx4 v18, s[28:31], s21 offen offset:2048  lds
    v_mfma_f32_16x16x32_bf16 v[144:147], v[224:227], v[212:215], v[144:147]
    v_mfma_f32_16x16x32_bf16 v[148:151], v[228:231], v[212:215], v[148:151]
    v_mfma_f32_16x16x32_bf16 v[152:155], v[232:235], v[212:215], v[152:155]
    v_mfma_f32_16x16x32_bf16 v[156:159], v[236:239], v[212:215], v[156:159]
    buffer_load_dwordx4 v[212:215], v29, s[12:15], s49 offen offset:1024 sc1
    s_waitcnt lgkmcnt(0)
    v_readfirstlane_b32 s38, v34
    s_nop 1
    s_cmp_ge_u32 s38, 36
    s_cbranch_scc1 L_st9_ok
L_st9:
    ds_read_b32 v34, v32 offset:16
    s_waitcnt lgkmcnt(0)
    v_readfirstlane_b32 s38, v34
    s_nop 1
    s_cmp_ge_u32 s38, 36
    s_cbranch_scc1 L_st9_ok
    s_sub_u32 s96, s96, 1
    s_cbranch_scc1 L_st9_ok
    s_sleep 0
    s_branch L_st9
L_st9_ok:
    ds_read_b128 v[224:227], v22 offset:16384
    ds_read_b128 v[228:231], v22 offset:18432
    ds_read_b128 v[232:235], v22 offset:20480
    ds_read_b128 v[236:239], v22 offset:22528
    s_waitcnt vmcnt(21)
    v_mfma_f32_16x16x32_bf16 v[128:131], v[240:243], v[216:219], v[128:131]
    v_mfma_f32_16x16x32_bf16 v[132:135], v[244:247], v[216:219], v[132:135]
    v_mfma_f32_16x16x32_bf16 v[136:139], v[248:251], v[216:219], v[136:139]
    v_mfma_f32_16x16x32_bf16 v[140:143], v[252:255], v[216:219], v[140:143]
    buffer_load_dwordx4 v[216:219], v29, s[12:15], s49 offen offset:2048 sc1
    buffer_load_dwordx4 v19, s[28:31], s21 offen offset:3072  lds
    v_mfma_f32_16x16x32_bf16 v[144:147], v[240:243], v[220:223], v[144:147]
    v_mfma_f32_16x16x32_bf16 v[148:151], v[244:247], v[220:223], v[148:151]
    v_mfma_f32_16x16x32_bf16 v[152:155], v[248:251], v[220:223], v[152:155]
    v_mfma_f32_16x16x32_bf16 v[156:159], v[252:255], v[220:223], v[156:159]
    buffer_load_dwordx4 v[220:223], v29, s[12:15], s49 offen offset:3072 sc1
    ds_read_b128 v[240:243], v23 offset:16384
    ds_read_b128 v[244:247], v23 offset:18432
    ds_read_b128 v[248:251], v23 offset:20480
    ds_read_b128 v[252:255], v23 offset:22528
    s_waitcnt vmcnt(21) lgkmcnt(4)
    v_mfma_f32_16x16x32_bf16 v[128:131], v[224:227], v[160:163], v[128:131]
    v_mfma_f32_16x16x32_bf16 v[132:135], v[228:231], v[160:163], v[132:135]
    v_mfma_f32_16x16x32_bf16 v[136:139], v[232:235], v[160:163], v[136:139]
    v_mfma_f32_16x16x32_bf16 v[140:143], v[236:239], v[160:163], v[140:143]
    s_xor_b32 s49, s54, 12
    s_lshl_b32 s49, s49, 15
    s_add_u32 s49, s49, s50
    buffer_load_dwordx4 v[160:163], v28, s[12:15], s49 offen offset:0 sc1
    s_add_u32 m0, s23, 32768
    s_xor_b32 s21, s54, 13
    s_lshl_b32 s21, s21, 7
    buffer_load_dwordx4 v16, s[28:31], s21 offen offset:0  lds
    v_mfma_f32_16x16x32_bf16 v[144:147], v[224:227], v[164:167], v[144:147]
    v_mfma_f32_16x16x32_bf16 v[148:151], v[228:231], v[164:167], v[148:151]
    v_mfma_f32_16x16x32_bf16 v[152:155], v[232:235], v[164:167], v[152:155]
    v_mfma_f32_16x16x32_bf16 v[156:159], v[236:239], v[164:167], v[156:159]
    buffer_load_dwordx4 v[164:167], v28, s[12:15], s49 offen offset:1024 sc1
    ds_read_b128 v[224:227], v22 offset:24576
    ds_read_b128 v[228:231], v22 offset:26624
    ds_read_b128 v[232:235], v22 offset:28672
    ds_read_b128 v[236:239], v22 offset:30720
    s_waitcnt vmcnt(16) lgkmcnt(4)
    s_mov_b64 exec, 1
    ds_add_u32 v32, v33 offset:16
    s_mov_b64 exec, -1
    v_mfma_f32_16x16x32_bf16 v[128:131], v[240:243], v[168:171], v[128:131]
    v_mfma_f32_16x16x32_bf16 v[132:135], v[244:247], v[168:171], v[132:135]
    v_mfma_f32_16x16x32_bf16 v[136:139], v[248:251], v[168:171], v[136:139]
    v_mfma_f32_16x16x32_bf16 v[140:143], v[252:255], v[168:171], v[140:143]
    buffer_load_dwordx4 v[168:171], v28, s[12:15], s49 offen offset:2048 sc1
    buffer_load_dwordx4 v17, s[28:31], s21 offen offset:1024  lds
    v_mfma_f32_16x16x32_bf16 v[144:147], v[240:243], v[172:175], v[144:147]
    v_mfma_f32_16x16x32_bf16 v[148:151], v[244:247], v[172:175], v[148:151]
    v_mfma_f32_16x16x32_bf16 v[152:155], v[248:251], v[172:175], v[152:155]
    v_mfma_f32_16x16x32_bf16 v[156:159], v[252:255], v[172:175], v[156:159]
    buffer_load_dwordx4 v[172:175], v28, s[12:15], s49 offen offset:3072 sc1
    ds_read_b128 v[240:243], v23 offset:24576
    ds_read_b128 v[244:247], v23 offset:26624
    ds_read_b128 v[248:251], v23 offset:28672
    ds_read_b128 v[252:255], v23 offset:30720
    s_waitcnt vmcnt(21) lgkmcnt(4)
    v_mfma_f32_16x16x32_bf16 v[128:131], v[224:227], v[176:179], v[128:131]
    v_mfma_f32_16x16x32_bf16 v[132:135], v[228:231], v[176:179], v[132:135]
    v_mfma_f32_16x16x32_bf16 v[136:139], v[232:235], v[176:179], v[136:139]
    v_mfma_f32_16x16x32_bf16 v[140:143], v[236:239], v[176:179], v[140:143]
    ds_read_b32 v34, v32 offset:16
    buffer_load_dwordx4 v[176:179], v29, s[12:15], s49 offen offset:0 sc1
    buffer_load_dwordx4 v18, s[28:31], s21 offen offset:2048  lds
    v_mfma_f32_16x16x32_bf16 v[144:147], v[224:227], v[180:183], v[144:147]
    v_mfma_f32_16x16x32_bf16 v[148:151], v[228:231], v[180:183], v[148:151]
    v_mfma_f32_16x16x32_bf16 v[152:155], v[232:235], v[180:183], v[152:155]
    v_mfma_f32_16x16x32_bf16 v[156:159], v[236:239], v[180:183], v[156:159]
    buffer_load_dwordx4 v[180:183], v29, s[12:15], s49 offen offset:1024 sc1
    s_waitcnt lgkmcnt(0)
    v_readfirstlane_b32 s38, v34
    s_nop 1
    s_cmp_ge_u32 s38, 40
    s_cbranch_scc1 L_st10_ok
L_st10:
    ds_read_b32 v34, v32 offset:16
    s_waitcnt lgkmcnt(0)
    v_readfirstlane_b32 s38, v34
    s_nop 1
    s_cmp_ge_u32 s38, 40
    s_cbranch_scc1 L_st10_ok
    s_sub_u32 s96, s96, 1
    s_cbranch_scc1 L_st10_ok
    s_sleep 0
    s_branch L_st10
L_st10_ok:
    ds_read_b128 v[224:227], v20 offset:0
    ds_read_b128 v[228:231], v20 offset:2048
    ds_read_b128 v[232:235], v20 offset:4096
    ds_read_b128 v[236:239], v20 offset:6144
    s_waitcnt vmcnt(21)
    v_mfma_f32_16x16x32_bf16 v[128:131], v[240:243], v[184:187], v[128:131]
    v_mfma_f32_16x16x32_bf16 v[132:135], v[244:247], v[184:187], v[132:135]
    v_mfma_f32_16x16x32_bf16 v[136:139], v[248:251], v[184:187], v[136:139]
    v_mfma_f32_16x16x32_bf16 v[140:143], v[252:255], v[184:187], v[140:143]
    buffer_load_dwordx4 v[184:187], v29, s[12:15], s49 offen offset:2048 sc1
    buffer_load_dwordx4 v19, s[28:31], s21 offen offset:3072  lds
    v_mfma_f32_16x16x32_bf16 v[144:147], v[240:243], v[188:191], v[144:147]
    v_mfma_f32_16x16x32_bf16 v[148:151], v[244:247], v[188:191], v[148:151]
    v_mfma_f32_16x16x32_bf16 v[152:155], v[248:251], v[188:191], v[152:155]
    v_mfma_f32_16x16x32_bf16 v[156:159], v[252:255], v[188:191], v[156:159]
    buffer_load_dwordx4 v[188:191], v29, s[12:15], s49 offen offset:3072 sc1
    ds_read_b128 v[240:243], v21 offset:0
    ds_read_b128 v[244:247], v21 offset:2048
    ds_read_b128 v[248:251], v21 offset:4096
    ds_read_b128 v[252:255], v21 offset:6144
    s_waitcnt vmcnt(21) lgkmcnt(4)
    v_mfma_f32_16x16x32_bf16 v[128:131], v[224:227], v[192:195], v[128:131]
    v_mfma_f32_16x16x32_bf16 v[132:135], v[228:231], v[192:195], v[132:135]
    v_mfma_f32_16x16x32_bf16 v[136:139], v[232:235], v[192:195], v[136:139]
    v_mfma_f32_16x16x32_bf16 v[140:143], v[236:239], v[192:195], v[140:143]
    s_xor_b32 s49, s54, 13
    s_lshl_b32 s49, s49, 15
    s_add_u32 s49, s49, s50
    buffer_load_dwordx4 v[192:195], v28, s[12:15], s49 offen offset:0 sc1
    s_add_u32 m0, s23, 49152
    s_xor_b32 s21, s54, 14
    s_lshl_b32 s21, s21, 7
    buffer_load_dwordx4 v16, s[28:31], s21 offen offset:0  lds
    v_mfma_f32_16x16x32_bf16 v[144:147], v[224:227], v[196:199], v[144:147]
    v_mfma_f32_16x16x32_bf16 v[148:151], v[228:231], v[196:199], v[148:151]
    v_mfma_f32_16x16x32_bf16 v[152:155], v[232:235], v[196:199], v[152:155]
    v_mfma_f32_16x16x32_bf16 v[156:159], v[236:239], v[196:199], v[156:159]
    buffer_load_dwordx4 v[196:199], v28, s[12:15], s49 offen offset:1024 sc1
    ds_read_b128 v[224:227], v20 offset:8192
    ds_read_b128 v[228:231], v20 offset:10240
    ds_read_b128 v[232:235], v20 offset:12288
    ds_read_b128 v[236:239], v20 offset:14336
    s_waitcnt vmcnt(16) lgkmcnt(4)
    s_mov_b64 exec, 1
    ds_add_u32 v32, v33 offset:16
    s_mov_b64 exec, -1
    v_mfma_f32_16x16x32_bf16 v[128:131], v[240:243], v[200:203], v[128:131]
    v_mfma_f32_16x16x32_bf16 v[132:135], v[244:247], v[200:203], v[132:135]
    v_mfma_f32_16x16x32_bf16 v[136:139], v[248:251], v[200:203], v[136:139]
    v_mfma_f32_16x16x32_bf16 v[140:143], v[252:255], v[200:203], v[140:143]
    buffer_load_dwordx4 v[200:203], v28, s[12:15], s49 offen offset:2048 sc1
    buffer_load_dwordx4 v17, s[28:31], s21 offen offset:1024  lds
    v_mfma_f32_16x16x32_bf16 v[144:147], v[240:243], v[204:207], v[144:147]
    v_mfma_f32_16x16x32_bf16 v[148:151], v[244:247], v[204:207], v[148:151]
    v_mfma_f32_16x16x32_bf16 v[152:155], v[248:251], v[204:207], v[152:155]
    v_mfma_f32_16x16x32_bf16 v[156:159], v[252:255], v[204:207], v[156:159]
    buffer_load_dwordx4 v[204:207], v28, s[12:15], s49 offen offset:3072 sc1
    ds_read_b128 v[240:243], v21 offset:8192
    ds_read_b128 v[244:247], v21 offset:10240
    ds_read_b128 v[248:251], v21 offset:12288
    ds_read_b128 v[252:255], v21 offset:14336
    s_waitcnt vmcnt(21) lgkmcnt(4)
    v_mfma_f32_16x16x32_bf16 v[128:131], v[224:227], v[208:211], v[128:131]
    v_mfma_f32_16x16x32_bf16 v[132:135], v[228:231], v[208:211], v[132:135]
    v_mfma_f32_16x16x32_bf16 v[136:139], v[232:235], v[208:211], v[136:139]
    v_mfma_f32_16x16x32_bf16 v[140:143], v[236:239], v[208:211], v[140:143]
    ds_read_b32 v34, v32 offset:16
    buffer_load_dwordx4 v[208:211], v29, s[12:15], s49 offen offset:0 sc1
    buffer_load_dwordx4 v18, s[28:31], s21 offen offset:2048  lds
    v_mfma_f32_16x16x32_bf16 v[144:147], v[224:227], v[212:215], v[144:147]
    v_mfma_f32_16x16x32_bf16 v[148:151], v[228:231], v[212:215], v[148:151]
    v_mfma_f32_16x16x32_bf16 v[152:155], v[232:235], v[212:215], v[152:155]
    v_mfma_f32_16x16x32_bf16 v[156:159], v[236:239], v[212:215], v[156:159]
    buffer_load_dwordx4 v[212:215], v29, s[12:15], s49 offen offset:1024 sc1
    s_waitcnt lgkmcnt(0)
    v_readfirstlane_b32 s38, v34
    s_nop 1
    s_cmp_ge_u32 s38, 44
    s_cbranch_scc1 L_st11_ok
L_st11:
    ds_read_b32 v34, v32 offset:16
    s_waitcnt lgkmcnt(0)
    v_readfirstlane_b32 s38, v34
    s_nop 1
    s_cmp_ge_u32 s38, 44
    s_cbranch_scc1 L_st11_ok
    s_sub_u32 s96, s96, 1
    s_cbranch_scc1 L_st11_ok
    s_sleep 0
    s_branch L_st11
L_st11_ok:
    ds_read_b128 v[224:227], v20 offset:16384
    ds_read_b128 v[228:231], v20 offset:18432
    ds_read_b128 v[232:235], v20 offset:20480
    ds_read_b128 v[236:239], v20 offset:22528
    s_waitcnt vmcnt(21)
    v_mfma_f32_16x16x32_bf16 v[128:131], v[240:243], v[216:219], v[128:131]
    v_mfma_f32_16x16x32_bf16 v[132:135], v[244:247], v[216:219], v[132:135]
    v_mfma_f32_16x16x32_bf16 v[136:139], v[248:251], v[216:219], v[136:139]
    v_mfma_f32_16x16x32_bf16 v[140:143], v[252:255], v[216:219], v[140:143]
    buffer_load_dwordx4 v[216:219], v29, s[12:15], s49 offen offset:2048 sc1
    buffer_load_dwordx4 v19, s[28:31], s21 offen offset:3072  lds
    v_mfma_f32_16x16x32_bf16 v[144:147], v[240:243], v[220:223], v[144:147]
    v_mfma_f32_16x16x32_bf16 v[148:151], v[244:247], v[220:223], v[148:151]
    v_mfma_f32_16x16x32_bf16 v[152:155], v[248:251], v[220:223], v[152:155]
    v_mfma_f32_16x16x32_bf16 v[156:159], v[252:255], v[220:223], v[156:159]
    buffer_load_dwordx4 v[220:223], v29, s[12:15], s49 offen offset:3072 sc1
    ds_read_b128 v[240:243], v21 offset:16384
    ds_read_b128 v[244:247], v21 offset:18432
    ds_read_b128 v[248:251], v21 offset:20480
    ds_read_b128 v[252:255], v21 offset:22528
    s_waitcnt vmcnt(21) lgkmcnt(4)
    v_mfma_f32_16x16x32_bf16 v[128:131], v[224:227], v[160:163], v[128:131]
    v_mfma_f32_16x16x32_bf16 v[132:135], v[228:231], v[160:163], v[132:135]
    v_mfma_f32_16x16x32_bf16 v[136:139], v[232:235], v[160:163], v[136:139]
    v_mfma_f32_16x16x32_bf16 v[140:143], v[236:239], v[160:163], v[140:143]
    s_xor_b32 s49, s54, 14
    s_lshl_b32 s49, s49, 15
    s_add_u32 s49, s49, s50
    buffer_load_dwordx4 v[160:163], v28, s[12:15], s49 offen offset:0 sc1
    s_add_u32 m0, s23, 81920
    s_xor_b32 s21, s54, 15
    s_lshl_b32 s21, s21, 7
    buffer_load_dwordx4 v16, s[28:31], s21 offen offset:0  lds
    v_mfma_f32_16x16x32_bf16 v[144:147], v[224:227], v[164:167], v[144:147]
    v_mfma_f32_16x16x32_bf16 v[148:151], v[228:231], v[164:167], v[148:151]
    v_mfma_f32_16x16x32_bf16 v[152:155], v[232:235], v[164:167], v[152:155]
    v_mfma_f32_16x16x32_bf16 v[156:159], v[236:239], v[164:167], v[156:159]
    buffer_load_dwordx4 v[164:167], v28, s[12:15], s49 offen offset:1024 sc1
    ds_read_b128 v[224:227], v20 offset:24576
    ds_read_b128 v[228:231], v20 offset:26624
    ds_read_b128 v[232:235], v20 offset:28672
    ds_read_b128 v[236:239], v20 offset:30720
    s_waitcnt vmcnt(16) lgkmcnt(4)
    s_mov_b64 exec, 1
    ds_add_u32 v32, v33 offset:16
    s_mov_b64 exec, -1
    v_mfma_f32_16x16x32_bf16 v[128:131], v[240:243], v[168:171], v[128:131]
    v_mfma_f32_16x16x32_bf16 v[132:135], v[244:247], v[168:171], v[132:135]
    v_mfma_f32_16x16x32_bf16 v[136:139], v[248:251], v[168:171], v[136:139]
    v_mfma_f32_16x16x32_bf16 v[140:143], v[252:255], v[168:171], v[140:143]
    buffer_load_dwordx4 v[168:171], v28, s[12:15], s49 offen offset:2048 sc1
    buffer_load_dwordx4 v17, s[28:31], s21 offen offset:1024  lds
    v_mfma_f32_16x16x32_bf16 v[144:147], v[240:243], v[172:175], v[144:147]
    v_mfma_f32_16x16x32_bf16 v[148:151], v[244:247], v[172:175], v[148:151]
    v_mfma_f32_16x16x32_bf16 v[152:155], v[248:251], v[172:175], v[152:155]
    v_mfma_f32_16x16x32_bf16 v[156:159], v[252:255], v[172:175], v[156:159]
    buffer_load_dwordx4 v[172:175], v28, s[12:15], s49 offen offset:3072 sc1
    ds_read_b128 v[240:243], v21 offset:24576
    ds_read_b128 v[244:247], v21 offset:26624
    ds_read_b128 v[248:251], v21 offset:28672
    ds_read_b128 v[252:255], v21 offset:30720
    s_waitcnt vmcnt(21) lgkmcnt(4)
    v_mfma_f32_16x16x32_bf16 v[128:131], v[224:227], v[176:179], v[128:131]
    v_mfma_f32_16x16x32_bf16 v[132:135], v[228:231], v[176:179], v[132:135]
    v_mfma_f32_16x16x32_bf16 v[136:139], v[232:235], v[176:179], v[136:139]
    v_mfma_f32_16x16x32_bf16 v[140:143], v[236:239], v[176:179], v[140:143]
    ds_read_b32 v34, v32 offset:16
    buffer_load_dwordx4 v[176:179], v29, s[12:15], s49 offen offset:0 sc1
    buffer_load_dwordx4 v18, s[28:31], s21 offen offset:2048  lds
    v_mfma_f32_16x16x32_bf16 v[144:147], v[224:227], v[180:183], v[144:147]
    v_mfma_f32_16x16x32_bf16 v[148:151], v[228:231], v[180:183], v[148:151]
    v_mfma_f32_16x16x32_bf16 v[152:155], v[232:235], v[180:183], v[152:155]
    v_mfma_f32_16x16x32_bf16 v[156:159], v[236:239], v[180:183], v[156:159]
    buffer_load_dwordx4 v[180:183], v29, s[12:15], s49 offen offset:1024 sc1
    s_waitcnt lgkmcnt(0)
    v_readfirstlane_b32 s38, v34
    s_nop 1
    s_cmp_ge_u32 s38, 48
    s_cbranch_scc1 L_st12_ok
L_st12:
    ds_read_b32 v34, v32 offset:16
    s_waitcnt lgkmcnt(0)
    v_readfirstlane_b32 s38, v34
    s_nop 1
    s_cmp_ge_u32 s38, 48
    s_cbranch_scc1 L_st12_ok
    s_sub_u32 s96, s96, 1
    s_cbranch_scc1 L_st12_ok
    s_sleep 0
    s_branch L_st12
L_st12_ok:
    ds_read_b128 v[224:227], v20 offset:32768
    ds_read_b128 v[228:231], v20 offset:34816
    ds_read_b128 v[232:235], v20 offset:36864
    ds_read_b128 v[236:239], v20 offset:38912
    s_waitcnt vmcnt(21)
    v_mfma_f32_16x16x32_bf16 v[128:131], v[240:243], v[184:187], v[128:131]
    v_mfma_f32_16x16x32_bf16 v[132:135], v[244:247], v[184:187], v[132:135]
    v_mfma_f32_16x16x32_bf16 v[136:139], v[248:251], v[184:187], v[136:139]
    v_mfma_f32_16x16x32_bf16 v[140:143], v[252:255], v[184:187], v[140:143]
    buffer_load_dwordx4 v[184:187], v29, s[12:15], s49 offen offset:2048 sc1
    buffer_load_dwordx4 v19, s[28:31], s21 offen offset:3072  lds
    v_mfma_f32_16x16x32_bf16 v[144:147], v[240:243], v[188:191], v[144:147]
    v_mfma_f32_16x16x32_bf16 v[148:151], v[244:247], v[188:191], v[148:151]
    v_mfma_f32_16x16x32_bf16 v[152:155], v[248:251], v[188:191], v[152:155]
    v_mfma_f32_16x16x32_bf16 v[156:159], v[252:255], v[188:191], v[156:159]
    buffer_load_dwordx4 v[188:191], v29, s[12:15], s49 offen offset:3072 sc1
    ds_read_b128 v[240:243], v21 offset:32768
    ds_read_b128 v[244:247], v21 offset:34816
    ds_read_b128 v[248:251], v21 offset:36864
    ds_read_b128 v[252:255], v21 offset:38912
    s_waitcnt vmcnt(21) lgkmcnt(4)
    v_mfma_f32_16x16x32_bf16 v[128:131], v[224:227], v[192:195], v[128:131]
    v_mfma_f32_16x16x32_bf16 v[132:135], v[228:231], v[192:195], v[132:135]
    v_mfma_f32_16x16x32_bf16 v[136:139], v[232:235], v[192:195], v[136:139]
    v_mfma_f32_16x16x32_bf16 v[140:143], v[236:239], v[192:195], v[140:143]
    s_xor_b32 s49, s54, 15
    s_lshl_b32 s49, s49, 15
    s_add_u32 s49, s49, s50
    buffer_load_dwordx4 v[192:195], v28, s[12:15], s49 offen offset:0 sc1
    v_mfma_f32_16x16x32_bf16 v[144:147], v[224:227], v[196:199], v[144:147]
    v_mfma_f32_16x16x32_bf16 v[148:151], v[228:231], v[196:199], v[148:151]
    v_mfma_f32_16x16x32_bf16 v[152:155], v[232:235], v[196:199], v[152:155]
    v_mfma_f32_16x16x32_bf16 v[156:159], v[236:239], v[196:199], v[156:159]
    buffer_load_dwordx4 v[196:199], v28, s[12:15], s49 offen offset:2048 sc1
    ds_read_b128 v[224:227], v20 offset:40960
    ds_read_b128 v[228:231], v20 offset:43008
    ds_read_b128 v[232:235], v20 offset:45056
    ds_read_b128 v[236:239], v20 offset:47104
    s_waitcnt vmcnt(15) lgkmcnt(4)
    s_mov_b64 exec, 1
    ds_add_u32 v32, v33 offset:16
    s_mov_b64 exec, -1
    v_mfma_f32_16x16x32_bf16 v[128:131], v[240:243], v[200:203], v[128:131]
    v_mfma_f32_16x16x32_bf16 v[132:135], v[244:247], v[200:203], v[132:135]
    v_mfma_f32_16x16x32_bf16 v[136:139], v[248:251], v[200:203], v[136:139]
    v_mfma_f32_16x16x32_bf16 v[140:143], v[252:255], v[200:203], v[140:143]
    buffer_load_dwordx4 v[200:203], v29, s[12:15], s49 offen offset:0 sc1
    v_mfma_f32_16x16x32_bf16 v[144:147], v[240:243], v[204:207], v[144:147]
    v_mfma_f32_16x16x32_bf16 v[148:151], v[244:247], v[204:207], v[148:151]
    v_mfma_f32_16x16x32_bf16 v[152:155], v[248:251], v[204:207], v[152:155]
    v_mfma_f32_16x16x32_bf16 v[156:159], v[252:255], v[204:207], v[156:159]
    buffer_load_dwordx4 v[204:207], v29, s[12:15], s49 offen offset:2048 sc1
    ds_read_b128 v[240:243], v21 offset:40960
    ds_read_b128 v[244:247], v21 offset:43008
    ds_read_b128 v[248:251], v21 offset:45056
    ds_read_b128 v[252:255], v21 offset:47104
    s_waitcnt vmcnt(19) lgkmcnt(4)
    v_mfma_f32_16x16x32_bf16 v[128:131], v[224:227], v[208:211], v[128:131]
    v_mfma_f32_16x16x32_bf16 v[132:135], v[228:231], v[208:211], v[132:135]
    v_mfma_f32_16x16x32_bf16 v[136:139], v[232:235], v[208:211], v[136:139]
    v_mfma_f32_16x16x32_bf16 v[140:143], v[236:239], v[208:211], v[140:143]
    ds_read_b32 v34, v32 offset:16
    buffer_load_dwordx4 v[208:211], v28, s[12:15], s49 offen offset:1024 sc1
    v_mfma_f32_16x16x32_bf16 v[144:147], v[224:227], v[212:215], v[144:147]
    v_mfma_f32_16x16x32_bf16 v[148:151], v[228:231], v[212:215], v[148:151]
    v_mfma_f32_16x16x32_bf16 v[152:155], v[232:235], v[212:215], v[152:155]
    v_mfma_f32_16x16x32_bf16 v[156:159], v[236:239], v[212:215], v[156:159]
    buffer_load_dwordx4 v[212:215], v28, s[12:15], s49 offen offset:3072 sc1
    s_waitcnt lgkmcnt(0)
    v_readfirstlane_b32 s38, v34
    s_nop 1
    s_cmp_ge_u32 s38, 52
    s_cbranch_scc1 L_st13_ok
L_st13:
    ds_read_b32 v34, v32 offset:16
    s_waitcnt lgkmcnt(0)
    v_readfirstlane_b32 s38, v34
    s_nop 1
    s_cmp_ge_u32 s38, 52
    s_cbranch_scc1 L_st13_ok
    s_sub_u32 s96, s96, 1
    s_cbranch_scc1 L_st13_ok
    s_sleep 0
    s_branch L_st13
L_st13_ok:
    ds_read_b128 v[224:227], v20 offset:49152
    ds_read_b128 v[228:231], v20 offset:51200
    ds_read_b128 v[232:235], v20 offset:53248
    ds_read_b128 v[236:239], v20 offset:55296
    s_waitcnt vmcnt(18)
    v_mfma_f32_16x16x32_bf16 v[128:131], v[240:243], v[216:219], v[128:131]
    v_mfma_f32_16x16x32_bf16 v[132:135], v[244:247], v[216:219], v[132:135]
    v_mfma_f32_16x16x32_bf16 v[136:139], v[248:251], v[216:219], v[136:139]
    v_mfma_f32_16x16x32_bf16 v[140:143], v[252:255], v[216:219], v[140:143]
    buffer_load_dwordx4 v[216:219], v29, s[12:15], s49 offen offset:1024 sc1
    v_mfma_f32_16x16x32_bf16 v[144:147], v[240:243], v[220:223], v[144:147]
    v_mfma_f32_16x16x32_bf16 v[148:151], v[244:247], v[220:223], v[148:151]
    v_mfma_f32_16x16x32_bf16 v[152:155], v[248:251], v[220:223], v[152:155]
    v_mfma_f32_16x16x32_bf16 v[156:159], v[252:255], v[220:223], v[156:159]
    buffer_load_dwordx4 v[220:223], v29, s[12:15], s49 offen offset:3072 sc1
    ds_read_b128 v[240:243], v21 offset:49152
    ds_read_b128 v[244:247], v21 offset:51200
    ds_read_b128 v[248:251], v21 offset:53248
    ds_read_b128 v[252:255], v21 offset:55296
    s_waitcnt vmcnt(17) lgkmcnt(4)
    v_mfma_f32_16x16x32_bf16 v[128:131], v[224:227], v[160:163], v[128:131]
    v_mfma_f32_16x16x32_bf16 v[132:135], v[228:231], v[160:163], v[132:135]
    v_mfma_f32_16x16x32_bf16 v[136:139], v[232:235], v[160:163], v[136:139]
    v_mfma_f32_16x16x32_bf16 v[140:143], v[236:239], v[160:163], v[140:143]
    v_mfma_f32_16x16x32_bf16 v[144:147], v[224:227], v[164:167], v[144:147]
    v_mfma_f32_16x16x32_bf16 v[148:151], v[228:231], v[164:167], v[148:151]
    v_mfma_f32_16x16x32_bf16 v[152:155], v[232:235], v[164:167], v[152:155]
    v_mfma_f32_16x16x32_bf16 v[156:159], v[236:239], v[164:167], v[156:159]
    ds_read_b128 v[224:227], v20 offset:57344
    ds_read_b128 v[228:231], v20 offset:59392
    ds_read_b128 v[232:235], v20 offset:61440
    ds_read_b128 v[236:239], v20 offset:63488
    s_waitcnt vmcnt(9) lgkmcnt(4)
    s_mov_b64 exec, 1
    ds_add_u32 v32, v33 offset:16
    s_mov_b64 exec, -1
    v_mfma_f32_16x16x32_bf16 v[128:131], v[240:243], v[168:171], v[128:131]
    v_mfma_f32_16x16x32_bf16 v[132:135], v[244:247], v[168:171], v[132:135]
    v_mfma_f32_16x16x32_bf16 v[136:139], v[248:251], v[168:171], v[136:139]
    v_mfma_f32_16x16x32_bf16 v[140:143], v[252:255], v[168:171], v[140:143]
    v_mfma_f32_16x16x32_bf16 v[144:147], v[240:243], v[172:175], v[144:147]
    v_mfma_f32_16x16x32_bf16 v[148:151], v[244:247], v[172:175], v[148:151]
    v_mfma_f32_16x16x32_bf16 v[152:155], v[248:251], v[172:175], v[152:155]
    v_mfma_f32_16x16x32_bf16 v[156:159], v[252:255], v[172:175], v[156:159]
    ds_read_b128 v[240:243], v21 offset:57344
    ds_read_b128 v[244:247], v21 offset:59392
    ds_read_b128 v[248:251], v21 offset:61440
    ds_read_b128 v[252:255], v21 offset:63488
    s_waitcnt vmcnt(11) lgkmcnt(4)
    v_mfma_f32_16x16x32_bf16 v[128:131], v[224:227], v[176:179], v[128:131]
    v_mfma_f32_16x16x32_bf16 v[132:135], v[228:231], v[176:179], v[132:135]
    v_mfma_f32_16x16x32_bf16 v[136:139], v[232:235], v[176:179], v[136:139]
    v_mfma_f32_16x16x32_bf16 v[140:143], v[236:239], v[176:179], v[140:143]
    ds_read_b32 v34, v32 offset:16
    v_mfma_f32_16x16x32_bf16 v[144:147], v[224:227], v[180:183], v[144:147]
    v_mfma_f32_16x16x32_bf16 v[148:151], v[228:231], v[180:183], v[148:151]
    v_mfma_f32_16x16x32_bf16 v[152:155], v[232:235], v[180:183], v[152:155]
    v_mfma_f32_16x16x32_bf16 v[156:159], v[236:239], v[180:183], v[156:159]
    s_waitcnt lgkmcnt(0)
    v_readfirstlane_b32 s38, v34
    s_nop 1
    s_cmp_ge_u32 s38, 56
    s_cbranch_scc1 L_st14_ok
L_st14:
    ds_read_b32 v34, v32 offset:16
    s_waitcnt lgkmcnt(0)
    v_readfirstlane_b32 s38, v34
    s_nop 1
    s_cmp_ge_u32 s38, 56
    s_cbranch_scc1 L_st14_ok
    s_sub_u32 s96, s96, 1
    s_cbranch_scc1 L_st14_ok
    s_sleep 0
    s_branch L_st14
L_st14_ok:
    ds_read_b128 v[224:227], v22 offset:16384
    ds_read_b128 v[228:231], v22 offset:18432
    ds_read_b128 v[232:235], v22 offset:20480
    ds_read_b128 v[236:239], v22 offset:22528
    s_waitcnt vmcnt(8)
    v_mfma_f32_16x16x32_bf16 v[128:131], v[240:243], v[184:187], v[128:131]
    v_mfma_f32_16x16x32_bf16 v[132:135], v[244:247], v[184:187], v[132:135]
    v_mfma_f32_16x16x32_bf16 v[136:139], v[248:251], v[184:187], v[136:139]
    v_mfma_f32_16x16x32_bf16 v[140:143], v[252:255], v[184:187], v[140:143]
    v_mfma_f32_16x16x32_bf16 v[144:147], v[240:243], v[188:191], v[144:147]
    v_mfma_f32_16x16x32_bf16 v[148:151], v[244:247], v[188:191], v[148:151]
    v_mfma_f32_16x16x32_bf16 v[152:155], v[248:251], v[188:191], v[152:155]
    v_mfma_f32_16x16x32_bf16 v[156:159], v[252:255], v[188:191], v[156:159]
    ds_read_b128 v[240:243], v23 offset:16384
    ds_read_b128 v[244:247], v23 offset:18432
    ds_read_b128 v[248:251], v23 offset:20480
    ds_read_b128 v[252:255], v23 offset:22528
    s_waitcnt vmcnt(7) lgkmcnt(4)
    v_mfma_f32_16x16x32_bf16 v[128:131], v[224:227], v[192:195], v[128:131]
    v_mfma_f32_16x16x32_bf16 v[132:135], v[228:231], v[192:195], v[132:135]
    v_mfma_f32_16x16x32_bf16 v[136:139], v[232:235], v[192:195], v[136:139]
    v_mfma_f32_16x16x32_bf16 v[140:143], v[236:239], v[192:195], v[140:143]
    ds_read_b128 v[224:227], v22 offset:24576
    ds_read_b128 v[228:231], v22 offset:26624
    ds_read_b128 v[232:235], v22 offset:28672
    ds_read_b128 v[236:239], v22 offset:30720
    s_waitcnt vmcnt(6) lgkmcnt(4)
    v_mfma_f32_16x16x32_bf16 v[128:131], v[240:243], v[196:199], v[128:131]
    v_mfma_f32_16x16x32_bf16 v[132:135], v[244:247], v[196:199], v[132:135]
    v_mfma_f32_16x16x32_bf16 v[136:139], v[248:251], v[196:199], v[136:139]
    v_mfma_f32_16x16x32_bf16 v[140:143], v[252:255], v[196:199], v[140:143]
    ds_read_b128 v[240:243], v23 offset:24576
    ds_read_b128 v[244:247], v23 offset:26624
    ds_read_b128 v[248:251], v23 offset:28672
    ds_read_b128 v[252:255], v23 offset:30720
    s_waitcnt vmcnt(5) lgkmcnt(4)
    v_mfma_f32_16x16x32_bf16 v[128:131], v[224:227], v[200:203], v[128:131]
    v_mfma_f32_16x16x32_bf16 v[132:135], v[228:231], v[200:203], v[132:135]
    v_mfma_f32_16x16x32_bf16 v[136:139], v[232:235], v[200:203], v[136:139]
    v_mfma_f32_16x16x32_bf16 v[140:143], v[236:239], v[200:203], v[140:143]
    ds_read_b128 v[224:227], v22 offset:16384
    ds_read_b128 v[228:231], v22 offset:18432
    ds_read_b128 v[232:235], v22 offset:20480
    ds_read_b128 v[236:239], v22 offset:22528
    s_waitcnt vmcnt(4) lgkmcnt(4)
    v_mfma_f32_16x16x32_bf16 v[128:131], v[240:243], v[204:207], v[128:131]
    v_mfma_f32_16x16x32_bf16 v[132:135], v[244:247], v[204:207], v[132:135]
    v_mfma_f32_16x16x32_bf16 v[136:139], v[248:251], v[204:207], v[136:139]
    v_mfma_f32_16x16x32_bf16 v[140:143], v[252:255], v[204:207], v[140:143]
L_topw:
    ds_read_b32 v34, v32 offset:32
    s_waitcnt lgkmcnt(0)
    v_readfirstlane_b32 s38, v34
    s_nop 1
    s_cmp_ge_u32 s38, 1
    s_cbranch_scc1 L_topw_ok
    s_sub_u32 s96, s96, 1
    s_cbranch_scc1 L_topw_ok
    s_sleep 1
    s_branch L_topw
L_topw_ok:
    ds_read_b32 v60, v47
    s_sub_u32 s38, 2047, s51
    s_waitcnt lgkmcnt(0)
    v_and_b32 v60, 0x7ff, v60
    v_sub_u32 v60, s38, v60
    v_cmp_gt_u32 vcc, 32, v60
    s_nop 1
    s_and_b32 s57, vcc_lo, 0xff
L_fix:
    s_cmp_eq_u32 s57, 0
    s_cbranch_scc1 L_fixd
    s_ff1_i32_b32 s8, s57
    s_bitset0_b32 s57, s8
    v_readlane_b32 s9, v60, s8
    v_lshl_add_u32 v52, s8, 2, v32
L_dfw:
    ds_read_b32 v53, v52 offset:36
    s_waitcnt lgkmcnt(0)
    v_readfirstlane_b32 s38, v53
    s_nop 1
    s_cmp_ge_u32 s38, 1
    s_cbranch_scc1 L_dfw_ok
    s_sub_u32 s96, s96, 1
    s_cbranch_scc1 L_dfw_ok
    s_sleep 2
    s_branch L_dfw
L_dfw_ok:
    s_lshl_b32 s38, s8, 8
    s_add_u32 s38, s38, 75776
    v_lshl_add_u32 v52, v26, 4, s38
    ds_read_b128 v[48:51], v52
    s_and_b32 s38, s9, 3
    s_lshl_b32 s38, s38, 4
    s_lshl_b64 s[10:11], 0xffff, s38
    s_lshr_b32 s9, s9, 2
    s_waitcnt lgkmcnt(0)
    s_mov_b64 exec, s[10:11]
    s_cmp_lg_u32 s9, 0
    s_cbranch_scc1 L_fx0
    v_pk_add_f32 v[72:73], v[72:73], v[48:49]
    v_pk_add_f32 v[74:75], v[74:75], v[50:51]
L_fx0:
    s_cmp_lg_u32 s9, 1
    s_cbranch_scc1 L_fx1
    v_pk_add_f32 v[76:77], v[76:77], v[48:49]
    v_pk_add_f32 v[78:79], v[78:79], v[50:51]
L_fx1:
    s_cmp_lg_u32 s9, 2
    s_cbranch_scc1 L_fx2
    v_pk_add_f32 v[88:89], v[88:89], v[48:49]
    v_pk_add_f32 v[90:91], v[90:91], v[50:51]
L_fx2:
    s_cmp_lg_u32 s9, 3
    s_cbranch_scc1 L_fx3
    v_pk_add_f32 v[92:93], v[92:93], v[48:49]
    v_pk_add_f32 v[94:95], v[94:95], v[50:51]
L_fx3:
    s_cmp_lg_u32 s9, 4
    s_cbranch_scc1 L_fx4
    v_pk_add_f32 v[104:105], v[104:105], v[48:49]
    v_pk_add_f32 v[106:107], v[106:107], v[50:51]
L_fx4:
    s_cmp_lg_u32 s9, 5
    s_cbranch_scc1 L_fx5
    v_pk_add_f32 v[108:109], v[108:109], v[48:49]
    v_pk_add_f32 v[110:111], v[110:111], v[50:51]
L_fx5:
    s_cmp_lg_u32 s9, 6
    s_cbranch_scc1 L_fx6
    v_pk_add_f32 v[120:121], v[120:121], v[48:49]
    v_pk_add_f32 v[122:123], v[122:123], v[50:51]
L_fx6:
    s_cmp_lg_u32 s9, 7
    s_cbranch_scc1 L_fx7
    v_pk_add_f32 v[124:125], v[124:125], v[48:49]
    v_pk_add_f32 v[126:127], v[126:127], v[50:51]
L_fx7:
    s_mov_b64 exec, -1
    s_branch L_fix
L_fixd:
    s_nop 7
    ds_write_b128 v44, v[128:131] offset:0
    ds_write_b128 v44, v[132:135] offset:64
    ds_write_b128 v44, v[136:139] offset:128
    ds_write_b128 v44, v[140:143] offset:192
    ds_read_b128 v[160:163], v45 offset:0
    ds_read_b128 v[164:167], v45 offset:1088
    ds_read_b128 v[168:171], v45 offset:2176
    ds_read_b128 v[172:175], v45 offset:3264
    s_waitcnt lgkmcnt(3)
    v_pk_fma_f32 v[160:161], v[36:37], v[160:161], v[72:73] op_sel:[0,0,0] op_sel_hi:[0,1,1]
    v_pk_fma_f32 v[162:163], v[36:37], v[162:163], v[74:75] op_sel:[0,0,0] op_sel_hi:[0,1,1]
    buffer_store_dwordx4 v[160:163], v46, s[32:35], s56 offen sc1 nt
    s_add_u32 s56, s56, 16384
    s_waitcnt lgkmcnt(2)
    v_pk_fma_f32 v[164:165], v[36:37], v[164:165], v[76:77] op_sel:[1,0,0] op_sel_hi:[1,1,1]
    v_pk_fma_f32 v[166:167], v[36:37], v[166:167], v[78:79] op_sel:[1,0,0] op_sel_hi:[1,1,1]
    buffer_store_dwordx4 v[164:167], v46, s[32:35], s56 offen sc1 nt
    s_add_u32 s56, s56, 16384
    s_waitcnt lgkmcnt(1)
    v_pk_fma_f32 v[168:169], v[38:39], v[168:169], v[88:89] op_sel:[0,0,0] op_sel_hi:[0,1,1]
    v_pk_fma_f32 v[170:171], v[38:39], v[170:171], v[90:91] op_sel:[0,0,0] op_sel_hi:[0,1,1]
    buffer_store_dwordx4 v[168:171], v46, s[32:35], s56 offen sc1 nt
    s_add_u32 s56, s56, 16384
    s_waitcnt lgkmcnt(0)
    v_pk_fma_f32 v[172:173], v[38:39], v[172:173], v[92:93] op_sel:[1,0,0] op_sel_hi:[1,1,1]
    v_pk_fma_f32 v[174:175], v[38:39], v[174:175], v[94:95] op_sel:[1,0,0] op_sel_hi:[1,1,1]
    buffer_store_dwordx4 v[172:175], v46, s[32:35], s56 offen sc1 nt
    s_add_u32 s56, s56, 16384
    ds_read_b128 v[240:243], v23 offset:16384
    ds_read_b128 v[244:247], v23 offset:18432
    ds_read_b128 v[248:251], v23 offset:20480
    ds_read_b128 v[252:255], v23 offset:22528
    s_waitcnt vmcnt(7) lgkmcnt(4)
    v_mfma_f32_16x16x32_bf16 v[144:147], v[224:227], v[208:211], v[144:147]
    v_mfma_f32_16x16x32_bf16 v[148:151], v[228:231], v[208:211], v[148:151]
    v_mfma_f32_16x16x32_bf16 v[152:155], v[232:235], v[208:211], v[152:155]
    v_mfma_f32_16x16x32_bf16 v[156:159], v[236:239], v[208:211], v[156:159]
    ds_read_b128 v[224:227], v22 offset:24576
    ds_read_b128 v[228:231], v22 offset:26624
    ds_read_b128 v[232:235], v22 offset:28672
    ds_read_b128 v[236:239], v22 offset:30720
    s_waitcnt vmcnt(6) lgkmcnt(4)
    v_mfma_f32_16x16x32_bf16 v[144:147], v[240:243], v[212:215], v[144:147]
    v_mfma_f32_16x16x32_bf16 v[148:151], v[244:247], v[212:215], v[148:151]
    v_mfma_f32_16x16x32_bf16 v[152:155], v[248:251], v[212:215], v[152:155]
    v_mfma_f32_16x16x32_bf16 v[156:159], v[252:255], v[212:215], v[156:159]
    ds_read_b128 v[240:243], v23 offset:24576
    ds_read_b128 v[244:247], v23 offset:26624
    ds_read_b128 v[248:251], v23 offset:28672
    ds_read_b128 v[252:255], v23 offset:30720
    s_waitcnt vmcnt(5) lgkmcnt(4)
    v_mfma_f32_16x16x32_bf16 v[144:147], v[224:227], v[216:219], v[144:147]
    v_mfma_f32_16x16x32_bf16 v[148:151], v[228:231], v[216:219], v[148:151]
    v_mfma_f32_16x16x32_bf16 v[152:155], v[232:235], v[216:219], v[152:155]
    v_mfma_f32_16x16x32_bf16 v[156:159], v[236:239], v[216:219], v[156:159]
    s_waitcnt vmcnt(4) lgkmcnt(0)
    v_mfma_f32_16x16x32_bf16 v[144:147], v[240:243], v[220:223], v[144:147]
    v_mfma_f32_16x16x32_bf16 v[148:151], v[244:247], v[220:223], v[148:151]
    v_mfma_f32_16x16x32_bf16 v[152:155], v[248:251], v[220:223], v[152:155]
    v_mfma_f32_16x16x32_bf16 v[156:159], v[252:255], v[220:223], v[156:159]
    s_nop 7
    ds_write_b128 v44, v[144:147] offset:4352
    ds_write_b128 v44, v[148:151] offset:4416
    ds_write_b128 v44, v[152:155] offset:4480
    ds_write_b128 v44, v[156:159] offset:4544
    ds_read_b128 v[176:179], v45 offset:4352
    ds_read_b128 v[180:183], v45 offset:5440
    ds_read_b128 v[184:187], v45 offset:6528
    ds_read_b128 v[188:191], v45 offset:7616
    s_waitcnt lgkmcnt(3)
    v_pk_fma_f32 v[176:177], v[40:41], v[176:177], v[104:105] op_sel:[0,0,0] op_sel_hi:[0,1,1]
    v_pk_fma_f32 v[178:179], v[40:41], v[178:179], v[106:107] op_sel:[0,0,0] op_sel_hi:[0,1,1]
    buffer_store_dwordx4 v[176:179], v46, s[32:35], s56 offen sc1 nt
    s_add_u32 s56, s56, 16384
    s_waitcnt lgkmcnt(2)
    v_pk_fma_f32 v[180:181], v[40:41], v[180:181], v[108:109] op_sel:[1,0,0] op_sel_hi:[1,1,1]
    v_pk_fma_f32 v[182:183], v[40:41], v[182:183], v[110:111] op_sel:[1,0,0] op_sel_hi:[1,1,1]
    buffer_store_dwordx4 v[180:183], v46, s[32:35], s56 offen sc1 nt
    s_add_u32 s56, s56, 16384
    s_waitcnt lgkmcnt(1)
    v_pk_fma_f32 v[184:185], v[42:43], v[184:185], v[120:121] op_sel:[0,0,0] op_sel_hi:[0,1,1]
    v_pk_fma_f32 v[186:187], v[42:43], v[186:187], v[122:123] op_sel:[0,0,0] op_sel_hi:[0,1,1]
    buffer_store_dwordx4 v[184:187], v46, s[32:35], s56 offen sc1 nt
    s_add_u32 s56, s56, 16384
    s_waitcnt lgkmcnt(0)
    v_pk_fma_f32 v[188:189], v[42:43], v[188:189], v[124:125] op_sel:[1,0,0] op_sel_hi:[1,1,1]
    v_pk_fma_f32 v[190:191], v[42:43], v[190:191], v[126:127] op_sel:[1,0,0] op_sel_hi:[1,1,1]
    buffer_store_dwordx4 v[188:191], v46, s[32:35], s56 offen sc1 nt
    s_add_u32 s56, s56, 16384
    s_endpgm
L_code_end:
.section .rodata,"a"
.p2align 6
.amdhsa_kernel gated_mix__ssm_conv_s5__moe_arch_mod__prompt_kernel
  .amdhsa_next_free_vgpr 256
  .amdhsa_next_free_sgpr 102
  .amdhsa_accum_offset 256
  .amdhsa_group_segment_fixed_size 0
  .amdhsa_kernarg_size 144
  .amdhsa_user_sgpr_count 2
  .amdhsa_user_sgpr_kernarg_segment_ptr 1
  .amdhsa_system_sgpr_workgroup_id_x 1
  .amdhsa_float_denorm_mode_32 3
.end_amdhsa_kernel
```
